```python
import torch

def _softmax(x, axis=-1):
    return torch.softmax(x, dim=axis)
def _gelu(x):
    return torch.nn.functional.gelu(x, approximate="tanh")
def _silu(x):
    return torch.nn.functional.silu(x)
def _sigmoid(x):
    return torch.sigmoid(x)
def _layernorm(x, axis=-1, eps=1e-5):
    m = x.mean(dim=axis, keepdim=True)
    v = x.var(dim=axis, keepdim=True, unbiased=False)
    return (x - m) / torch.sqrt(v + eps)
def _scatter_add(tgt, idx, src, axis=0):
    return tgt.clone().index_add_(axis, idx, src)
def _segment_sum(src, seg, n):
    out = torch.zeros((n,) + src.shape[1:], dtype=src.dtype)
    return out.index_add_(0, seg, src)
def _pad(x, pw):
    flat = tuple(v for pair in reversed(pw) for v in pair)
    return torch.nn.functional.pad(x, flat)

kernel_name = 'concat_heads__mha_block_cached__gqa_block_cached__near_ridge'

def setup_inputs():

    _w = (lambda a: (lambda t: t.to(torch.bfloat16) if t.is_floating_point() else t)(torch.as_tensor(a)))
    def _A_setup():
        B, Sq, D = 16, 160, 448
        H, Sk, Dh = 16, 512, 256
        return {
            "x": _w((lambda *s: torch.randn(*s, dtype=torch.bfloat16) * 0.8)(B, Sq, D)),
            "k_cache": _w((lambda *s: torch.randn(*s, dtype=torch.bfloat16) * 0.8)(B, H, Sk, Dh)),
            "v_cache": _w((lambda *s: torch.randn(*s, dtype=torch.bfloat16) * 0.05)(B, H, Sk, Dh)),
            "wq": _w((lambda *s: torch.randn(*s, dtype=torch.bfloat16) * 0.8)(D, H * Dh) * (D ** -0.5)),
            "wo": _w((lambda *s: torch.randn(*s, dtype=torch.bfloat16) * 0.05)(H * Dh, D) * ((H * Dh) ** -0.5)),
        }
    _A_in = _A_setup()

    def _B_setup():
        B, Sq, D = 16, 160, 448
        Hq, Hkv, Sk, Dh = 16, 16, 512, 256
        assert Hq % Hkv == 0, (Hq, Hkv)
        return {
            "x": _w((lambda *s: torch.randn(*s, dtype=torch.bfloat16) * 0.8)(B, Sq, D)),
            "k_cache": _w((lambda *s: torch.randn(*s, dtype=torch.bfloat16) * 0.8)(B, Hkv, Sk, Dh)),
            "v_cache": _w((lambda *s: torch.randn(*s, dtype=torch.bfloat16) * 0.05)(B, Hkv, Sk, Dh)),
            "wq": _w((lambda *s: torch.randn(*s, dtype=torch.bfloat16) * 0.8)(D, Hq * Dh) * (D ** -0.5)),
            "wo": _w((lambda *s: torch.randn(*s, dtype=torch.bfloat16) * 0.05)(Hq * Dh, D) * ((Hq * Dh) ** -0.5)),
        }
    _B_in = _B_setup()

    return {
        "A_x": _A_in["x"],
        "A_k_cache": _A_in["k_cache"],
        "A_v_cache": _A_in["v_cache"],
        "A_wq": _A_in["wq"],
        "A_wo": _A_in["wo"],
        "B_x": _B_in["x"],
        "B_k_cache": _B_in["k_cache"],
        "B_v_cache": _B_in["v_cache"],
        "B_wq": _B_in["wq"],
        "B_wo": _B_in["wo"],
    }

def reference(A_x, A_k_cache, A_v_cache, A_wq, A_wo, B_x, B_k_cache, B_v_cache, B_wq, B_wo):
    def _A_ref(x, k_cache, v_cache, wq, wo):
        B, Sq, D = x.shape
        H, Dh = 16, 256
        q = (lambda x, *d: x.permute(*d))((x @ wq).reshape(B, Sq, H, Dh), 0, 2, 1, 3)
        scores = torch.einsum("bhqd,bhkd->bhqk", q, k_cache) * (Dh ** -0.5)
        p = _softmax(scores, axis=-1)
        o = torch.einsum("bhqk,bhkd->bhqd", p, v_cache)
        return (lambda x, *d: x.permute(*d))(o, 0, 2, 1, 3).reshape(B, Sq, H * Dh) @ wo

    def _B_ref(x, k_cache, v_cache, wq, wo):
        B, Sq, D = x.shape
        Hq, Dh = 16, 256
        Hkv = k_cache.shape[1]
        rep = Hq // Hkv
        q = (lambda x, *d: x.permute(*d))((x @ wq).reshape(B, Sq, Hq, Dh), 0, 2, 1, 3)
        k = (lambda x, n, axis: torch.repeat_interleave(x, n, dim=axis))(k_cache, rep, axis=1)
        v = (lambda x, n, axis: torch.repeat_interleave(x, n, dim=axis))(v_cache, rep, axis=1)
        scores = torch.einsum("bhqd,bhkd->bhqk", q, k) * (Dh ** -0.5)
        p = _softmax(scores, axis=-1)
        o = torch.einsum("bhqk,bhkd->bhqd", p, v)
        return (lambda x, *d: x.permute(*d))(o, 0, 2, 1, 3).reshape(B, Sq, Hq * Dh) @ wo

    a = _A_ref(A_x, A_k_cache, A_v_cache, A_wq, A_wo)
    b = _B_ref(B_x, B_k_cache, B_v_cache, B_wq, B_wo)
    return torch.concatenate([a, b], axis=-1)
```

```asm
; @launch grid=(256,1,1) block=(256,1,1) lds=163840
.amdgcn_target "amdgcn-amd-amdhsa--gfx950"
.text
.globl concat_heads__mha_block_cached__gqa_block_cached__near_ridge_kernel
.p2align 8
.type concat_heads__mha_block_cached__gqa_block_cached__near_ridge_kernel,@function
concat_heads__mha_block_cached__gqa_block_cached__near_ridge_kernel:
 s_cmp_lt_u32 s2, 256
 s_cbranch_scc1 L_go
 s_endpgm
L_go:
 s_mov_b32 s3, 0
 s_mov_b32 s4, 0
 s_mov_b64 vcc, 0
L_restart:
 s_load_dwordx16 s[64:79], s[0:1], 0
 s_load_dwordx8 s[80:87], s[0:1], 64
 s_load_dwordx2 s[88:89], s[0:1], 96
 v_lshrrev_b32 v68, 6, v0
 v_and_b32 v73, 63, v0
 v_readfirstlane_b32 s5, v68
 s_and_b32 s49, s2, 7
 s_lshr_b32 s53, s2, 3
 s_and_b32 s59, s53, 1
 s_lshr_b32 s58, s53, 1
 s_lshr_b32 s57, s49, 2
 s_and_b32 s52, s49, 3
 s_lshl_b32 s52, s52, 1
 s_add_u32 s59, s59, s52
 s_and_b32 s52, s49, 3
 s_lshr_b32 s52, s52, 2
 s_lshl_b32 s52, s52, 4
 s_add_u32 s58, s58, s52
 s_and_b32 s94, s5, 1
 s_lshr_b32 s54, s5, 1
 s_mul_i32 s40, s5, 0x1080
 s_lshl_b32 s41, s5, 10
 s_lshl_b32 s61, s59, 0
 s_add_u32 s61, s61, 0
 s_mul_i32 s49, s3, 8
 s_add_u32 s49, s49, s61
 s_lshl_b32 s42, s49, 18
 s_lshl_b32 s44, s49, 9
 s_add_u32 s49, s58, s59
 s_mul_i32 s50, s49, 37
 s_lshr_b32 s50, s50, 8
 s_mul_i32 s50, s50, 7
 s_sub_u32 s50, s49, s50
 s_lshl_b32 s50, s50, 2
 s_lshr_b32 s45, 0x6543210, s50
 s_and_b32 s45, s45, 7
 s_lshl_b32 s45, s45, 7
 s_lshl_b32 s49, s45, 12
 s_add_u32 s44, s44, s49
 v_lshrrev_b32 v77, 5, v73
 v_and_b32 v69, 31, v73
 v_lshlrev_b32 v69, 4, v69
 s_lshl_b32 s49, s94, 1
 s_add_u32 s49, s49, s54
 s_lshl_b32 s49, s49, 15
 v_lshl_add_u32 v70, v77, 17, v69
 v_add_u32 v17, s49, v70
 s_lshl_b32 s49, s94, 2
 v_lshrrev_b32 v75, 4, v73
 v_add_u32 v71, s49, v75
 v_and_b32 v72, 7, v73
 v_xor_b32 v71, v71, v72
 v_lshlrev_b32 v71, 4, v71
 v_lshrrev_b32 v72, 3, v0
 v_mul_u32_u24 v72, 0x380, v72
 v_add_u32 v18, v71, v72
 v_lshlrev_b32 v68, 7, v73
 v_and_b32 v79, 3, v73
 s_mul_i32 s50, s58, 0x23000
 s_getpc_b64 s[36:37]
L_pc:
 s_mov_b32 s38, L_codeend-L_pc
 s_lshl_b32 s49, s53, 2
 s_add_u32 s49, s49, s5
 s_mul_i32 s49, s49, 0x380
 v_min_u32 v71, 0x480, v68
 v_add_u32 v71, s49, v71
 v_min_u32 v30, s38, v71
 v_mov_b32 v31, 0
 v_lshl_add_u64 v[30:31], v[30:31], 0, s[36:37]
 global_load_dword v35, v[30:31], off
 s_waitcnt lgkmcnt(0)
 s_cmp_eq_u32 s57, 0
 s_cselect_b64 s[64:65], s[64:65], s[74:75]
 s_cselect_b64 s[66:67], s[66:67], s[76:77]
 s_cselect_b64 s[68:69], s[68:69], s[78:79]
 s_cselect_b64 s[70:71], s[70:71], s[80:81]
 s_cselect_b64 s[72:73], s[72:73], s[82:83]
 s_add_u32 s8, s64, s50
 s_addc_u32 s9, s65, 0
 s_mov_b32 s10, 0x23000
 s_mov_b32 s11, 0x20000
 s_add_u32 s12, s70, 0
 s_addc_u32 s13, s71, 0
 s_mov_b32 s14, 0x380000
 s_mov_b32 s15, 0x20000
 s_add_u32 m0, s41, 0x11600
 s_add_u32 s56, s45, 0
 buffer_load_dwordx4 v18, s[8:11], s56 offen offset:0 lds
 s_add_u32 m0, s41, 0x12600
 s_add_u32 s56, s45, 0x7000
 buffer_load_dwordx4 v18, s[8:11], s56 offen offset:0 lds
 s_add_u32 m0, s41, 0x13600
 s_add_u32 s56, s45, 0xe000
 buffer_load_dwordx4 v18, s[8:11], s56 offen offset:0 lds
 s_add_u32 m0, s41, 0x14600
 s_add_u32 s56, s45, 0x15000
 buffer_load_dwordx4 v18, s[8:11], s56 offen offset:0 lds
 s_add_u32 m0, s41, 0x15600
 s_add_u32 s56, s45, 0x1c000
 buffer_load_dwordx4 v18, s[8:11], s56 offen offset:0 lds
 s_add_u32 s45, s45, 0x80
 s_sub_u32 s56, s45, 0x380
 s_min_u32 s45, s45, s56
 s_add_u32 m0, s40, 0x16600
 s_add_u32 s56, s44, 0
 buffer_load_dwordx4 v17, s[12:15], s56 offen offset:0 lds
 s_add_u32 s56, s44, 0x1be0
 buffer_load_dwordx4 v17, s[12:15], s56 offen offset:1056 lds
 s_add_u32 s56, s44, 0x37c0
 buffer_load_dwordx4 v17, s[12:15], s56 offen offset:2112 lds
 s_add_u32 s56, s44, 0x53a0
 buffer_load_dwordx4 v17, s[12:15], s56 offen offset:3168 lds
 s_mov_b32 s43, s42
 s_lshl_b32 s49, s5, 11
 v_lshl_add_u32 v70, v77, 13, v69
 v_add_u32 v16, s49, v70
 s_lshl_b32 s49, s58, 22
 s_add_u32 s16, s66, s49
 s_addc_u32 s17, s67, 0
 s_mov_b32 s18, 0x400000
 s_mov_b32 s19, 0x20000
 s_add_u32 s20, s68, s49
 s_addc_u32 s21, s69, 0
 s_mov_b32 s22, 0x400000
 s_mov_b32 s23, 0x20000
 v_and_b32 v74, 15, v73
 v_and_b32 v76, 1, v75
 v_bfe_u32 v78, v73, 2, 2
 v_lshl_add_u32 v76, v76, 2, v78
 v_mul_u32_u24 v76, 0x420, v76
 v_lshl_add_u32 v76, v77, 9, v76
 v_and_b32 v71, 1, v79
 v_lshl_add_u32 v70, v71, 4, v76
 v_lshrrev_b32 v71, 1, v79
 v_lshl_add_u32 v70, v71, 3, v70
 s_xor_b32 s49, s94, 0
 s_lshl_b32 s49, s49, 7
 s_add_u32 s50, s49, 0x16600
 v_add_u32 v10, s50, v70
 s_xor_b32 s49, s94, 1
 s_lshl_b32 s49, s49, 7
 s_add_u32 s50, s49, 0x16600
 v_add_u32 v11, s50, v70
 v_bfe_u32 v68, v73, 1, 3
 v_xor_b32 v68, v68, v75
 v_lshlrev_b32 v69, 7, v74
 s_lshl_b32 s49, s5, 12
 s_add_u32 s49, s49, 0xc600
 s_lshl_b32 s50, s54, 11
 s_add_u32 s50, s50, 0x10600
 v_xor_b32 v70, 0, v68
 v_lshl_add_u32 v70, v70, 4, v69
 v_add_u32 v12, s49, v70
 v_add_u32 v14, s50, v70
 v_xor_b32 v70, 4, v68
 v_lshl_add_u32 v70, v70, 4, v69
 v_add_u32 v13, s49, v70
 v_add_u32 v15, s50, v70
 s_add_u32 m0, s40, 0x1a800
 s_add_u32 s56, s44, 0x40000
 buffer_load_dwordx4 v17, s[12:15], s56 offen offset:0 lds
 s_add_u32 s56, s44, 0x41be0
 buffer_load_dwordx4 v17, s[12:15], s56 offen offset:1056 lds
 s_add_u32 s56, s44, 0x437c0
 buffer_load_dwordx4 v17, s[12:15], s56 offen offset:2112 lds
 s_add_u32 s56, s44, 0x453a0
 buffer_load_dwordx4 v17, s[12:15], s56 offen offset:3168 lds
 s_add_u32 s44, s44, 0x80000
 s_sub_u32 s56, s44, 0x380000
 s_min_u32 s44, s44, s56
 s_add_u32 m0, s41, 0xc600
 s_add_u32 s56, s45, 0
 buffer_load_dwordx4 v18, s[8:11], s56 offen offset:0 lds
 s_add_u32 m0, s41, 0xd600
 s_add_u32 s56, s45, 0x7000
 buffer_load_dwordx4 v18, s[8:11], s56 offen offset:0 lds
 s_add_u32 m0, s41, 0xe600
 s_add_u32 s56, s45, 0xe000
 buffer_load_dwordx4 v18, s[8:11], s56 offen offset:0 lds
 s_add_u32 m0, s41, 0xf600
 s_add_u32 s56, s45, 0x15000
 buffer_load_dwordx4 v18, s[8:11], s56 offen offset:0 lds
 s_add_u32 m0, s41, 0x10600
 s_add_u32 s56, s45, 0x1c000
 buffer_load_dwordx4 v18, s[8:11], s56 offen offset:0 lds
 s_add_u32 s45, s45, 0x80
 s_sub_u32 s56, s45, 0x380
 s_min_u32 s45, s45, s56
 s_waitcnt vmcnt(9)
 s_barrier
 ds_read_b64_tr_b16 a[160:161], v10 offset:0
 ds_read_b64_tr_b16 a[162:163], v10 offset:8448
 ds_read_b64_tr_b16 a[164:165], v11 offset:0
 ds_read_b64_tr_b16 a[166:167], v11 offset:8448
 ds_read_b64_tr_b16 a[168:169], v10 offset:32
 ds_read_b64_tr_b16 a[170:171], v10 offset:8480
 ds_read_b64_tr_b16 a[172:173], v11 offset:32
 ds_read_b64_tr_b16 a[174:175], v11 offset:8480
 ds_read_b64_tr_b16 a[176:177], v10 offset:64
 ds_read_b64_tr_b16 a[178:179], v10 offset:8512
 ds_read_b64_tr_b16 a[180:181], v11 offset:64
 ds_read_b64_tr_b16 a[182:183], v11 offset:8512
 ds_read_b128 v[44:47], v12 offset:20480
 ds_read_b128 v[48:51], v12 offset:22528
 ds_read_b128 v[52:55], v14 offset:20480
 s_waitcnt lgkmcnt(2)
 v_mfma_f32_16x16x32_bf16 v[96:99], a[160:163], v[44:47], 0
 s_add_u32 m0, s40, 0x1ea00
 ds_read_b64_tr_b16 a[184:185], v10 offset:96
 ds_read_b64_tr_b16 a[186:187], v10 offset:8544
 s_waitcnt lgkmcnt(2)
 v_mfma_f32_16x16x32_bf16 v[224:227], a[160:163], v[52:55], 0
 s_add_u32 s56, s44, 0
 ds_read_b128 v[56:59], v13 offset:20480
 buffer_load_dwordx4 v17, s[12:15], s56 offen offset:0 lds
 v_mfma_f32_16x16x32_bf16 v[104:107], a[160:163], v[48:51], 0
 v_mfma_f32_16x16x32_bf16 v[136:139], a[164:167], v[48:51], 0
 ds_read_b64_tr_b16 a[188:189], v11 offset:96
 ds_read_b64_tr_b16 a[190:191], v11 offset:8544
 v_mfma_f32_16x16x32_bf16 v[128:131], a[164:167], v[44:47], 0
 v_mfma_f32_16x16x32_bf16 v[100:103], a[168:171], v[44:47], 0
 s_add_u32 s56, s44, 0x1be0
 ds_read_b64_tr_b16 a[160:161], v10 offset:256
 ds_read_b64_tr_b16 a[162:163], v10 offset:8704
 v_mfma_f32_16x16x32_bf16 v[228:231], a[168:171], v[52:55], 0
 ds_read_b128 v[60:63], v13 offset:22528
 buffer_load_dwordx4 v17, s[12:15], s56 offen offset:1056 lds
 v_mfma_f32_16x16x32_bf16 v[108:111], a[168:171], v[48:51], 0
 v_mfma_f32_16x16x32_bf16 v[140:143], a[172:175], v[48:51], 0
 ds_read_b64_tr_b16 a[164:165], v11 offset:256
 ds_read_b64_tr_b16 a[166:167], v11 offset:8704
 v_mfma_f32_16x16x32_bf16 v[132:135], a[172:175], v[44:47], 0
 v_mfma_f32_16x16x32_bf16 v[112:115], a[176:179], v[44:47], 0
 s_add_u32 s56, s44, 0x37c0
 ds_read_b64_tr_b16 a[168:169], v10 offset:288
 ds_read_b64_tr_b16 a[170:171], v10 offset:8736
 v_mfma_f32_16x16x32_bf16 v[232:235], a[176:179], v[52:55], 0
 ds_read_b128 v[64:67], v15 offset:20480
 buffer_load_dwordx4 v17, s[12:15], s56 offen offset:2112 lds
 v_mfma_f32_16x16x32_bf16 v[120:123], a[176:179], v[48:51], 0
 v_mfma_f32_16x16x32_bf16 v[152:155], a[180:183], v[48:51], 0
 ds_read_b64_tr_b16 a[172:173], v11 offset:288
 ds_read_b64_tr_b16 a[174:175], v11 offset:8736
 v_mfma_f32_16x16x32_bf16 v[144:147], a[180:183], v[44:47], 0
 s_waitcnt lgkmcnt(10)
 v_mfma_f32_16x16x32_bf16 v[116:119], a[184:187], v[44:47], 0
 s_add_u32 s56, s44, 0x53a0
 ds_read_b64_tr_b16 a[176:177], v10 offset:320
 ds_read_b64_tr_b16 a[178:179], v10 offset:8768
 v_mfma_f32_16x16x32_bf16 v[236:239], a[184:187], v[52:55], 0
 buffer_load_dwordx4 v17, s[12:15], s56 offen offset:3168 lds
 v_mfma_f32_16x16x32_bf16 v[124:127], a[184:187], v[48:51], 0
 v_mfma_f32_16x16x32_bf16 v[156:159], a[188:191], v[48:51], 0
 ds_read_b64_tr_b16 a[180:181], v11 offset:320
 ds_read_b64_tr_b16 a[182:183], v11 offset:8768
 v_mfma_f32_16x16x32_bf16 v[148:151], a[188:191], v[44:47], 0
 s_waitcnt lgkmcnt(9)
 v_mfma_f32_16x16x32_bf16 v[160:163], a[160:163], v[44:47], 0
 ds_read_b64_tr_b16 a[184:185], v10 offset:352
 ds_read_b64_tr_b16 a[186:187], v10 offset:8800
 v_mfma_f32_16x16x32_bf16 v[240:243], a[160:163], v[52:55], 0
 v_mfma_f32_16x16x32_bf16 v[168:171], a[160:163], v[48:51], 0
 v_mfma_f32_16x16x32_bf16 v[200:203], a[164:167], v[48:51], 0
 ds_read_b64_tr_b16 a[188:189], v11 offset:352
 ds_read_b64_tr_b16 a[190:191], v11 offset:8800
 v_mfma_f32_16x16x32_bf16 v[192:195], a[164:167], v[44:47], 0
 s_waitcnt lgkmcnt(8)
 v_mfma_f32_16x16x32_bf16 v[164:167], a[168:171], v[44:47], 0
 s_waitcnt vmcnt(9)
 s_barrier
 ds_read_b64_tr_b16 a[160:161], v10 offset:16896
 ds_read_b64_tr_b16 a[162:163], v10 offset:25344
 v_mfma_f32_16x16x32_bf16 v[244:247], a[168:171], v[52:55], 0
 s_add_u32 m0, s40, 0x22c00
 v_mfma_f32_16x16x32_bf16 v[172:175], a[168:171], v[48:51], 0
 s_add_u32 s56, s44, 0x40000
 buffer_load_dwordx4 v17, s[12:15], s56 offen offset:0 lds
 v_mfma_f32_16x16x32_bf16 v[204:207], a[172:175], v[48:51], 0
 s_add_u32 s56, s44, 0x41be0
 ds_read_b64_tr_b16 a[164:165], v11 offset:16896
 ds_read_b64_tr_b16 a[166:167], v11 offset:25344
 v_mfma_f32_16x16x32_bf16 v[196:199], a[172:175], v[44:47], 0
 s_waitcnt lgkmcnt(8)
 buffer_load_dwordx4 v17, s[12:15], s56 offen offset:1056 lds
 v_mfma_f32_16x16x32_bf16 v[176:179], a[176:179], v[44:47], 0
 s_add_u32 s56, s44, 0x437c0
 ds_read_b64_tr_b16 a[168:169], v10 offset:16928
 ds_read_b64_tr_b16 a[170:171], v10 offset:25376
 v_mfma_f32_16x16x32_bf16 v[248:251], a[176:179], v[52:55], 0
 buffer_load_dwordx4 v17, s[12:15], s56 offen offset:2112 lds
 v_mfma_f32_16x16x32_bf16 v[184:187], a[176:179], v[48:51], 0
 v_mfma_f32_16x16x32_bf16 v[216:219], a[180:183], v[48:51], 0
 s_add_u32 s56, s44, 0x453a0
 ds_read_b64_tr_b16 a[172:173], v11 offset:16928
 ds_read_b64_tr_b16 a[174:175], v11 offset:25376
 v_mfma_f32_16x16x32_bf16 v[208:211], a[180:183], v[44:47], 0
 s_waitcnt lgkmcnt(8)
 buffer_load_dwordx4 v17, s[12:15], s56 offen offset:3168 lds
 v_mfma_f32_16x16x32_bf16 v[180:183], a[184:187], v[44:47], 0
 s_add_u32 s44, s44, 0x80000
 ds_read_b64_tr_b16 a[176:177], v10 offset:16960
 ds_read_b64_tr_b16 a[178:179], v10 offset:25408
 v_mfma_f32_16x16x32_bf16 v[252:255], a[184:187], v[52:55], 0
 s_sub_u32 s56, s44, 0x380000
 v_mfma_f32_16x16x32_bf16 v[188:191], a[184:187], v[48:51], 0
 s_min_u32 s44, s44, s56
 v_mfma_f32_16x16x32_bf16 v[220:223], a[188:191], v[48:51], 0
 s_add_u32 m0, s41, 0x11600
 ds_read_b64_tr_b16 a[180:181], v11 offset:16960
 ds_read_b64_tr_b16 a[182:183], v11 offset:25408
 v_mfma_f32_16x16x32_bf16 v[212:215], a[188:191], v[44:47], 0
 s_waitcnt lgkmcnt(8)
 v_mfma_f32_16x16x32_bf16 v[96:99], a[160:163], v[56:59], v[96:99]
 s_add_u32 s56, s45, 0
 ds_read_b64_tr_b16 a[184:185], v10 offset:16992
 ds_read_b64_tr_b16 a[186:187], v10 offset:25440
 v_mfma_f32_16x16x32_bf16 v[224:227], a[160:163], v[64:67], v[224:227]
 s_add_u32 s28, s72, 0
 s_addc_u32 s29, s73, 0
 buffer_load_dwordx4 v18, s[8:11], s56 offen offset:0 lds
 v_mfma_f32_16x16x32_bf16 v[104:107], a[160:163], v[60:63], v[104:107]
 s_add_u32 m0, s41, 0x12600
 s_mov_b32 s30, 0x380000
 s_mov_b32 s31, 0x20000
 v_mfma_f32_16x16x32_bf16 v[136:139], a[164:167], v[60:63], v[136:139]
 s_add_u32 s56, s45, 0x7000
 ds_read_b64_tr_b16 a[188:189], v11 offset:16992
 ds_read_b64_tr_b16 a[190:191], v11 offset:25440
 v_mfma_f32_16x16x32_bf16 v[128:131], a[164:167], v[56:59], v[128:131]
 s_waitcnt lgkmcnt(8)
 s_lshl_b32 s60, s57, 4
 buffer_load_dwordx4 v18, s[8:11], s56 offen offset:0 lds
 v_mfma_f32_16x16x32_bf16 v[100:103], a[168:171], v[56:59], v[100:103]
 s_add_u32 m0, s41, 0x13600
 ds_read_b64_tr_b16 a[160:161], v10 offset:17152
 ds_read_b64_tr_b16 a[162:163], v10 offset:25600
 v_mfma_f32_16x16x32_bf16 v[228:231], a[168:171], v[64:67], v[228:231]
 s_add_u32 s56, s45, 0xe000
 s_add_u32 s60, s60, s58
 buffer_load_dwordx4 v18, s[8:11], s56 offen offset:0 lds
 v_mfma_f32_16x16x32_bf16 v[108:111], a[168:171], v[60:63], v[108:111]
 s_xor_b32 s56, s42, 0
 s_mul_i32 s49, s60, 0x118000
 v_mfma_f32_16x16x32_bf16 v[140:143], a[172:175], v[60:63], v[140:143]
 s_add_u32 m0, s40, 0
 ds_read_b64_tr_b16 a[164:165], v11 offset:17152
 ds_read_b64_tr_b16 a[166:167], v11 offset:25600
 v_mfma_f32_16x16x32_bf16 v[132:135], a[172:175], v[56:59], v[132:135]
 s_waitcnt lgkmcnt(8)
 buffer_load_dwordx4 v16, s[16:19], s56 offen offset:0 nt lds
 v_mfma_f32_16x16x32_bf16 v[112:115], a[176:179], v[56:59], v[112:115]
 s_add_u32 m0, s40, 0x220
 ds_read_b64_tr_b16 a[168:169], v10 offset:17184
 ds_read_b64_tr_b16 a[170:171], v10 offset:25632
 v_mfma_f32_16x16x32_bf16 v[232:235], a[176:179], v[64:67], v[232:235]
 s_add_u32 s24, s88, s49
 s_addc_u32 s25, s89, 0
 buffer_load_dwordx4 v16, s[16:19], s56 offen offset:512 nt lds
 v_mfma_f32_16x16x32_bf16 v[120:123], a[176:179], v[60:63], v[120:123]
 s_add_u32 m0, s40, 0x440
 s_mov_b32 s26, 0x118000
 s_mov_b32 s27, 0x20000
 v_mfma_f32_16x16x32_bf16 v[152:155], a[180:183], v[60:63], v[152:155]
 s_lshl_b32 s49, s60, 2
 ds_read_b64_tr_b16 a[172:173], v11 offset:17184
 ds_read_b64_tr_b16 a[174:175], v11 offset:25632
 v_mfma_f32_16x16x32_bf16 v[144:147], a[180:183], v[56:59], v[144:147]
 s_waitcnt lgkmcnt(8)
 s_add_u32 s49, s49, 0
 buffer_load_dwordx4 v16, s[16:19], s56 offen offset:1024 nt lds
 v_mfma_f32_16x16x32_bf16 v[116:119], a[184:187], v[56:59], v[116:119]
 s_add_u32 m0, s40, 0x660
 ds_read_b64_tr_b16 a[176:177], v10 offset:17216
 ds_read_b64_tr_b16 a[178:179], v10 offset:25664
 v_mfma_f32_16x16x32_bf16 v[236:239], a[184:187], v[64:67], v[236:239]
 s_lshl_b32 s49, s49, 8
 s_add_u32 s49, s49, 0x2800000
 buffer_load_dwordx4 v16, s[16:19], s56 offen offset:1536 nt lds
 v_mfma_f32_16x16x32_bf16 v[124:127], a[184:187], v[60:63], v[124:127]
 s_xor_b32 s56, s42, 0x4000
 s_add_u32 s36, s88, s49
 s_addc_u32 s37, s89, 0
 v_mfma_f32_16x16x32_bf16 v[156:159], a[188:191], v[60:63], v[156:159]
 s_add_u32 m0, s40, 0x4200
 ds_read_b64_tr_b16 a[180:181], v11 offset:17216
 ds_read_b64_tr_b16 a[182:183], v11 offset:25664
 v_mfma_f32_16x16x32_bf16 v[148:151], a[188:191], v[56:59], v[148:151]
 s_waitcnt lgkmcnt(8)
 s_mov_b32 s38, 0x100
 buffer_load_dwordx4 v16, s[16:19], s56 offen offset:0 nt lds
 v_mfma_f32_16x16x32_bf16 v[160:163], a[160:163], v[56:59], v[160:163]
 s_add_u32 m0, s40, 0x4420
 ds_read_b64_tr_b16 a[184:185], v10 offset:17248
 ds_read_b64_tr_b16 a[186:187], v10 offset:25696
 v_mfma_f32_16x16x32_bf16 v[240:243], a[160:163], v[64:67], v[240:243]
 s_mov_b32 s39, 0x20000
 s_mul_i32 s49, s58, 0x46000
 buffer_load_dwordx4 v16, s[16:19], s56 offen offset:512 nt lds
 v_mfma_f32_16x16x32_bf16 v[168:171], a[160:163], v[60:63], v[168:171]
 s_add_u32 m0, s40, 0x4640
 s_mul_i32 s52, s57, 0x380
 s_add_u32 s49, s49, s52
 v_mfma_f32_16x16x32_bf16 v[200:203], a[164:167], v[60:63], v[200:203]
 ds_read_b64_tr_b16 a[188:189], v11 offset:17248
 ds_read_b64_tr_b16 a[190:191], v11 offset:25696
 v_mfma_f32_16x16x32_bf16 v[192:195], a[164:167], v[56:59], v[192:195]
 s_waitcnt lgkmcnt(8)
 buffer_load_dwordx4 v16, s[16:19], s56 offen offset:1024 nt lds
 s_add_u32 m0, s40, 0x4860
 s_nop 0
 buffer_load_dwordx4 v16, s[16:19], s56 offen offset:1536 nt lds
 v_mfma_f32_16x16x32_bf16 v[164:167], a[168:171], v[56:59], v[164:167]
 s_mov_b64 exec, 0
 s_cmp_eq_u32 s5, 0
 s_cbranch_scc1 L_pad0
 s_cmp_eq_u32 s5, 1
 s_cbranch_scc1 L_pad1
 s_cmp_eq_u32 s5, 2
 s_cbranch_scc1 L_pad2
 s_branch L_pad3
L_e0_back:
 s_mov_b64 exec, -1
 s_branch L_main
 .p2align 12
L_main:
 s_waitcnt vmcnt(15)
 s_barrier
 ds_read_b64_tr_b16 a[160:161], v10 offset:33792
 ds_read_b64_tr_b16 a[162:163], v10 offset:42240
 v_mfma_f32_16x16x32_bf16 v[244:247], a[168:171], v[64:67], v[244:247]
L_pad0:
 s_cbranch_execz L_pad4
 s_add_u32 m0, s41, 0x14600
 ds_read_b128 v[44:47], v12 offset:0
 v_mfma_f32_16x16x32_bf16 v[172:175], a[168:171], v[60:63], v[172:175]
 s_add_u32 s56, s45, 0x15000
 ds_read_b128 v[48:51], v12 offset:2048
 buffer_load_dwordx4 v18, s[8:11], s56 offen offset:0 lds
 v_mfma_f32_16x16x32_bf16 v[204:207], a[172:175], v[60:63], v[204:207]
 ds_read_b64_tr_b16 a[164:165], v11 offset:33792
 ds_read_b64_tr_b16 a[166:167], v11 offset:42240
 v_mfma_f32_16x16x32_bf16 v[196:199], a[172:175], v[56:59], v[196:199]
 s_waitcnt lgkmcnt(10)
 ds_read_b128 v[52:55], v14 offset:0
 v_mfma_f32_16x16x32_bf16 v[176:179], a[176:179], v[56:59], v[176:179]
 s_add_u32 m0, s41, 0x15600
 ds_read_b64_tr_b16 a[168:169], v10 offset:33824
 ds_read_b64_tr_b16 a[170:171], v10 offset:42272
 v_mfma_f32_16x16x32_bf16 v[248:251], a[176:179], v[64:67], v[248:251]
 s_add_u32 s56, s45, 0x1c000
 buffer_load_dwordx4 v18, s[8:11], s56 offen offset:0 lds
 v_mfma_f32_16x16x32_bf16 v[184:187], a[176:179], v[60:63], v[184:187]
 s_add_u32 s32, s84, s49
 s_addc_u32 s33, s85, 0
 s_mov_b32 s34, 0x45c80
 v_mfma_f32_16x16x32_bf16 v[216:219], a[180:183], v[60:63], v[216:219]
 s_add_u32 s45, s45, 0x80
 ds_read_b64_tr_b16 a[172:173], v11 offset:33824
 ds_read_b64_tr_b16 a[174:175], v11 offset:42272
 v_mfma_f32_16x16x32_bf16 v[208:211], a[180:183], v[56:59], v[208:211]
 s_waitcnt lgkmcnt(11)
 s_mov_b32 s35, 0x20000
 s_lshl_b32 s49, s60, 3
 v_mfma_f32_16x16x32_bf16 v[180:183], a[184:187], v[56:59], v[180:183]
 s_sub_u32 s56, s45, 0x380
 ds_read_b64_tr_b16 a[176:177], v10 offset:33856
 ds_read_b64_tr_b16 a[178:179], v10 offset:42304
 v_mfma_f32_16x16x32_bf16 v[252:255], a[184:187], v[64:67], v[252:255]
 s_min_u32 s45, s45, s56
 s_add_u32 s84, s86, s49
 s_addc_u32 s85, s87, 0
 v_mfma_f32_16x16x32_bf16 v[188:191], a[184:187], v[60:63], v[188:191]
 s_add_u32 m0, s40, 0x16600
 s_mov_b32 s86, 8
 s_mov_b32 s87, 0x20000
 v_mfma_f32_16x16x32_bf16 v[220:223], a[188:191], v[60:63], v[220:223]
 s_add_u32 s56, s44, 0
 ds_read_b64_tr_b16 a[180:181], v11 offset:33856
 ds_read_b64_tr_b16 a[182:183], v11 offset:42304
 v_mfma_f32_16x16x32_bf16 v[212:215], a[188:191], v[56:59], v[212:215]
 s_waitcnt lgkmcnt(9)
 s_mov_b32 s6, 0x3db8aa3b
 buffer_load_dwordx4 v17, s[12:15], s56 offen offset:0 lds
 v_mfma_f32_16x16x32_bf16 v[96:99], a[160:163], v[44:47], v[96:99]
 s_add_u32 s56, s44, 0x1be0
 ds_read_b64_tr_b16 a[184:185], v10 offset:33888
 ds_read_b64_tr_b16 a[186:187], v10 offset:42336
 s_waitcnt lgkmcnt(10)
 v_mfma_f32_16x16x32_bf16 v[224:227], a[160:163], v[52:55], v[224:227]
 s_mov_b32 s7, 0x3db8aa3b
 ds_read_b128 v[56:59], v13 offset:0
 buffer_load_dwordx4 v17, s[12:15], s56 offen offset:1056 lds
 v_mfma_f32_16x16x32_bf16 v[104:107], a[160:163], v[48:51], v[104:107]
 s_add_u32 s56, s44, 0x37c0
 s_mul_i32 s61, s61, 0x38000
 buffer_load_dwordx4 v17, s[12:15], s56 offen offset:2112 lds
 v_mfma_f32_16x16x32_bf16 v[136:139], a[164:167], v[48:51], v[136:139]
 s_add_u32 s56, s44, 0x53a0
 ds_read_b64_tr_b16 a[188:189], v11 offset:33888
 ds_read_b64_tr_b16 a[190:191], v11 offset:42336
 v_mfma_f32_16x16x32_bf16 v[128:131], a[164:167], v[44:47], v[128:131]
 s_waitcnt lgkmcnt(9)
 s_mul_i32 s49, s58, 37
 buffer_load_dwordx4 v17, s[12:15], s56 offen offset:3168 lds
 v_mfma_f32_16x16x32_bf16 v[100:103], a[168:171], v[44:47], v[100:103]
 s_lshr_b32 s49, s49, 8
 ds_read_b64_tr_b16 a[160:161], v10 offset:34048
 ds_read_b64_tr_b16 a[162:163], v10 offset:42496
 v_mfma_f32_16x16x32_bf16 v[228:231], a[168:171], v[52:55], v[228:231]
 s_mul_i32 s49, s49, 7
 s_sub_u32 s101, s58, s49
 ds_read_b128 v[60:63], v13 offset:2048
 v_mfma_f32_16x16x32_bf16 v[108:111], a[168:171], v[48:51], v[108:111]
 s_xor_b32 s56, s42, 0x8000
 s_mul_i32 s101, s101, 0x80
 s_mov_b32 s100, s101
 v_mfma_f32_16x16x32_bf16 v[140:143], a[172:175], v[48:51], v[140:143]
 s_add_u32 m0, s40, 0x8400
 ds_read_b64_tr_b16 a[164:165], v11 offset:34048
 ds_read_b64_tr_b16 a[166:167], v11 offset:42496
 v_mfma_f32_16x16x32_bf16 v[132:135], a[172:175], v[44:47], v[132:135]
 s_waitcnt lgkmcnt(10)
 buffer_load_dwordx4 v16, s[16:19], s56 offen offset:0 nt lds
 v_lshlrev_b32 v1, 4, v73
 v_mfma_f32_16x16x32_bf16 v[112:115], a[176:179], v[44:47], v[112:115]
 s_add_u32 m0, s40, 0x8620
 ds_read_b64_tr_b16 a[168:169], v10 offset:34080
 ds_read_b64_tr_b16 a[170:171], v10 offset:42528
 v_mfma_f32_16x16x32_bf16 v[232:235], a[176:179], v[52:55], v[232:235]
 ds_read_b128 v[64:67], v15 offset:0
 buffer_load_dwordx4 v16, s[16:19], s56 offen offset:512 nt lds
 v_mfma_f32_16x16x32_bf16 v[120:123], a[176:179], v[48:51], v[120:123]
 v_lshl_add_u32 v69, v79, 3, v76
 v_and_b32 v71, 7, v73
 v_mfma_f32_16x16x32_bf16 v[152:155], a[180:183], v[48:51], v[152:155]
 ds_read_b64_tr_b16 a[172:173], v11 offset:34080
 ds_read_b64_tr_b16 a[174:175], v11 offset:42528
 v_mfma_f32_16x16x32_bf16 v[144:147], a[180:183], v[44:47], v[144:147]
 s_waitcnt lgkmcnt(10)
 v_mul_u32_u24 v71, 0x420, v71
 v_bfe_u32 v72, v73, 3, 1
 v_mfma_f32_16x16x32_bf16 v[116:119], a[184:187], v[44:47], v[116:119]
 s_add_u32 m0, s40, 0x8840
 ds_read_b64_tr_b16 a[176:177], v10 offset:34112
 ds_read_b64_tr_b16 a[178:179], v10 offset:42560
 v_mfma_f32_16x16x32_bf16 v[236:239], a[184:187], v[52:55], v[236:239]
 buffer_load_dwordx4 v16, s[16:19], s56 offen offset:1024 nt lds
 v_lshl_add_u32 v71, v72, 9, v71
 v_mfma_f32_16x16x32_bf16 v[124:127], a[184:187], v[48:51], v[124:127]
 s_add_u32 m0, s40, 0x8a60
 v_lshl_add_u32 v71, v75, 4, v71
 v_mfma_f32_16x16x32_bf16 v[156:159], a[188:191], v[48:51], v[156:159]
 s_xor_b32 s49, s94, 0
 ds_read_b64_tr_b16 a[180:181], v11 offset:34112
 ds_read_b64_tr_b16 a[182:183], v11 offset:42560
 v_mfma_f32_16x16x32_bf16 v[148:151], a[188:191], v[44:47], v[148:151]
 s_waitcnt lgkmcnt(9)
 s_lshl_b32 s49, s49, 7
 buffer_load_dwordx4 v16, s[16:19], s56 offen offset:1536 nt lds
 v_mfma_f32_16x16x32_bf16 v[160:163], a[160:163], v[44:47], v[160:163]
 s_xor_b32 s52, s94, 0
 ds_read_b64_tr_b16 a[184:185], v10 offset:34144
 ds_read_b64_tr_b16 a[186:187], v10 offset:42592
 v_mfma_f32_16x16x32_bf16 v[240:243], a[160:163], v[52:55], v[240:243]
 s_mul_i32 s52, s52, 0x2100
 s_add_u32 s52, s52, s49
 v_add_u32 v6, s52, v71
 v_mfma_f32_16x16x32_bf16 v[168:171], a[160:163], v[48:51], v[168:171]
 s_add_u32 s52, s52, 0x16600
 v_add_u32 v2, s52, v69
 v_mfma_f32_16x16x32_bf16 v[200:203], a[164:167], v[48:51], v[200:203]
 s_xor_b32 s52, s94, 1
 ds_read_b64_tr_b16 a[188:189], v11 offset:34144
 ds_read_b64_tr_b16 a[190:191], v11 offset:42592
 v_mfma_f32_16x16x32_bf16 v[192:195], a[164:167], v[44:47], v[192:195]
 s_waitcnt lgkmcnt(8)
 s_mul_i32 s52, s52, 0x2100
 s_add_u32 s52, s52, s49
 v_mfma_f32_16x16x32_bf16 v[164:167], a[168:171], v[44:47], v[164:167]
 s_waitcnt vmcnt(21)
 s_barrier
 ds_read_b64_tr_b16 a[160:161], v10 offset:50688
 ds_read_b64_tr_b16 a[162:163], v10 offset:59136
 v_mfma_f32_16x16x32_bf16 v[244:247], a[168:171], v[52:55], v[244:247]
 s_add_u32 m0, s40, 0x1a800
 v_add_u32 v8, s52, v71
 v_mfma_f32_16x16x32_bf16 v[172:175], a[168:171], v[48:51], v[172:175]
 s_add_u32 s56, s44, 0x40000
 s_add_u32 s52, s52, 0x16600
 buffer_load_dwordx4 v17, s[12:15], s56 offen offset:0 lds
 v_mfma_f32_16x16x32_bf16 v[204:207], a[172:175], v[48:51], v[204:207]
 ds_read_b64_tr_b16 a[164:165], v11 offset:50688
 ds_read_b64_tr_b16 a[166:167], v11 offset:59136
 v_mfma_f32_16x16x32_bf16 v[196:199], a[172:175], v[44:47], v[196:199]
 s_waitcnt lgkmcnt(8)
 v_add_u32 v4, s52, v69
 v_mfma_f32_16x16x32_bf16 v[176:179], a[176:179], v[44:47], v[176:179]
 s_xor_b32 s49, s94, 1
 ds_read_b64_tr_b16 a[168:169], v10 offset:50720
 ds_read_b64_tr_b16 a[170:171], v10 offset:59168
 v_mfma_f32_16x16x32_bf16 v[248:251], a[176:179], v[52:55], v[248:251]
 s_add_u32 s56, s44, 0x41be0
 s_lshl_b32 s49, s49, 7
 buffer_load_dwordx4 v17, s[12:15], s56 offen offset:1056 lds
 v_mfma_f32_16x16x32_bf16 v[184:187], a[176:179], v[48:51], v[184:187]
 s_xor_b32 s52, s94, 0
 s_mul_i32 s52, s52, 0x2100
 s_add_u32 s52, s52, s49
 v_mfma_f32_16x16x32_bf16 v[216:219], a[180:183], v[48:51], v[216:219]
 ds_read_b64_tr_b16 a[172:173], v11 offset:50720
 ds_read_b64_tr_b16 a[174:175], v11 offset:59168
 v_mfma_f32_16x16x32_bf16 v[208:211], a[180:183], v[44:47], v[208:211]
 s_waitcnt lgkmcnt(8)
 v_add_u32 v7, s52, v71
 v_mfma_f32_16x16x32_bf16 v[180:183], a[184:187], v[44:47], v[180:183]
 s_add_u32 s52, s52, 0x16600
 ds_read_b64_tr_b16 a[176:177], v10 offset:50752
 ds_read_b64_tr_b16 a[178:179], v10 offset:59200
 v_mfma_f32_16x16x32_bf16 v[252:255], a[184:187], v[52:55], v[252:255]
 s_add_u32 s56, s44, 0x437c0
 buffer_load_dwordx4 v17, s[12:15], s56 offen offset:2112 lds
 v_add_u32 v3, s52, v69
 v_mfma_f32_16x16x32_bf16 v[188:191], a[184:187], v[48:51], v[188:191]
 s_xor_b32 s52, s94, 1
 s_mul_i32 s52, s52, 0x2100
 s_add_u32 s52, s52, s49
 v_mfma_f32_16x16x32_bf16 v[220:223], a[188:191], v[48:51], v[220:223]
 ds_read_b64_tr_b16 a[180:181], v11 offset:50752
 ds_read_b64_tr_b16 a[182:183], v11 offset:59200
 v_mfma_f32_16x16x32_bf16 v[212:215], a[188:191], v[44:47], v[212:215]
 s_waitcnt lgkmcnt(8)
 v_add_u32 v9, s52, v71
 v_mfma_f32_16x16x32_bf16 v[96:99], a[160:163], v[56:59], v[96:99]
 s_add_u32 s52, s52, 0x16600
 ds_read_b64_tr_b16 a[184:185], v10 offset:50784
 ds_read_b64_tr_b16 a[186:187], v10 offset:59232
 v_mfma_f32_16x16x32_bf16 v[224:227], a[160:163], v[64:67], v[224:227]
 s_add_u32 s56, s44, 0x453a0
 buffer_load_dwordx4 v17, s[12:15], s56 offen offset:3168 lds
 v_add_u32 v5, s52, v69
 v_mfma_f32_16x16x32_bf16 v[104:107], a[160:163], v[60:63], v[104:107]
 s_xor_b32 s52, s5, 1
 s_lshl_b32 s49, s5, 12
 s_add_u32 s49, s49, 0x11600
 v_mfma_f32_16x16x32_bf16 v[136:139], a[164:167], v[60:63], v[136:139]
 ds_read_b64_tr_b16 a[188:189], v11 offset:50784
 ds_read_b64_tr_b16 a[190:191], v11 offset:59232
 v_mfma_f32_16x16x32_bf16 v[128:131], a[164:167], v[56:59], v[128:131]
 s_waitcnt lgkmcnt(8)
 v_add_u32 v19, s49, v1
 v_mfma_f32_16x16x32_bf16 v[100:103], a[168:171], v[56:59], v[100:103]
 s_lshl_b32 s49, s52, 12
 ds_read_b64_tr_b16 a[160:161], v10 offset:50944
 ds_read_b64_tr_b16 a[162:163], v10 offset:59392
 v_mfma_f32_16x16x32_bf16 v[228:231], a[168:171], v[64:67], v[228:231]
 s_add_u32 s44, s44, 0x80000
 s_add_u32 s49, s49, 0x11600
 v_add_u32 v20, s49, v1
 v_mfma_f32_16x16x32_bf16 v[108:111], a[168:171], v[60:63], v[108:111]
 s_sub_u32 s56, s44, 0x380000
 v_lshlrev_b32 v68, 3, v73
 v_mfma_f32_16x16x32_bf16 v[140:143], a[172:175], v[60:63], v[140:143]
 s_min_u32 s44, s44, s56
 ds_read_b64_tr_b16 a[164:165], v11 offset:50944
 ds_read_b64_tr_b16 a[166:167], v11 offset:59392
 v_mfma_f32_16x16x32_bf16 v[132:135], a[172:175], v[56:59], v[132:135]
 s_waitcnt lgkmcnt(8)
 s_lshl_b32 s49, s5, 9
 s_add_u32 s49, s49, 0x26e00
 v_mfma_f32_16x16x32_bf16 v[112:115], a[176:179], v[56:59], v[112:115]
 s_add_u32 m0, s41, 0xc600
 ds_read_b64_tr_b16 a[168:169], v10 offset:50976
 ds_read_b64_tr_b16 a[170:171], v10 offset:59424
 v_mfma_f32_16x16x32_bf16 v[232:235], a[176:179], v[64:67], v[232:235]
 s_add_u32 s56, s45, 0
 buffer_load_dwordx4 v18, s[8:11], s56 offen offset:0 lds
 v_add_u32 v21, s49, v68
 v_mfma_f32_16x16x32_bf16 v[120:123], a[176:179], v[60:63], v[120:123]
 s_add_u32 m0, s41, 0xd600
 s_lshl_b32 s49, s52, 9
 s_add_u32 s49, s49, 0x26e00
 v_mfma_f32_16x16x32_bf16 v[152:155], a[180:183], v[60:63], v[152:155]
 s_add_u32 s56, s45, 0x7000
 ds_read_b64_tr_b16 a[172:173], v11 offset:50976
 ds_read_b64_tr_b16 a[174:175], v11 offset:59424
 v_mfma_f32_16x16x32_bf16 v[144:147], a[180:183], v[56:59], v[144:147]
 s_waitcnt lgkmcnt(8)
 buffer_load_dwordx4 v18, s[8:11], s56 offen offset:0 lds
 v_add_u32 v22, s49, v68
 v_mfma_f32_16x16x32_bf16 v[116:119], a[184:187], v[56:59], v[116:119]
 ds_read_b64_tr_b16 a[176:177], v10 offset:51008
 ds_read_b64_tr_b16 a[178:179], v10 offset:59456
 v_mfma_f32_16x16x32_bf16 v[236:239], a[184:187], v[64:67], v[236:239]
 s_add_u32 m0, s41, 0xe600
 v_lshlrev_b32 v68, 2, v74
 v_mfma_f32_16x16x32_bf16 v[124:127], a[184:187], v[60:63], v[124:127]
 s_add_u32 s56, s45, 0xe000
 s_lshl_b32 s49, s5, 6
 buffer_load_dwordx4 v18, s[8:11], s56 offen offset:0 lds
 v_mfma_f32_16x16x32_bf16 v[156:159], a[188:191], v[60:63], v[156:159]
 s_add_u32 s49, s49, 0x27e00
 ds_read_b64_tr_b16 a[180:181], v11 offset:51008
 ds_read_b64_tr_b16 a[182:183], v11 offset:59456
 v_mfma_f32_16x16x32_bf16 v[148:151], a[188:191], v[56:59], v[148:151]
 s_waitcnt lgkmcnt(8)
 v_add_u32 v23, s49, v68
 v_mfma_f32_16x16x32_bf16 v[160:163], a[160:163], v[56:59], v[160:163]
 s_lshl_b32 s49, s52, 6
 ds_read_b64_tr_b16 a[184:185], v10 offset:51040
 ds_read_b64_tr_b16 a[186:187], v10 offset:59488
 v_mfma_f32_16x16x32_bf16 v[240:243], a[160:163], v[64:67], v[240:243]
 s_add_u32 s49, s49, 0x27e00
 v_add_u32 v24, s49, v68
 v_mfma_f32_16x16x32_bf16 v[168:171], a[160:163], v[60:63], v[168:171]
 s_lshl_b32 s49, s5, 2
 s_add_u32 s49, s49, 0x27f00
 v_mov_b32 v25, s49
 v_mfma_f32_16x16x32_bf16 v[200:203], a[164:167], v[60:63], v[200:203]
 ds_read_b64_tr_b16 a[188:189], v11 offset:51040
 ds_read_b64_tr_b16 a[190:191], v11 offset:59488
 v_mfma_f32_16x16x32_bf16 v[192:195], a[164:167], v[56:59], v[192:195]
 s_waitcnt lgkmcnt(8)
 v_mov_b32 v26, 0x27f00
 v_lshlrev_b32 v28, 12, v73
 v_mfma_f32_16x16x32_bf16 v[164:167], a[168:171], v[56:59], v[164:167]
 s_waitcnt vmcnt(11)
 s_barrier
 ds_read_b64_tr_b16 a[160:161], v10 offset:0
 ds_read_b64_tr_b16 a[162:163], v10 offset:8448
 v_mfma_f32_16x16x32_bf16 v[244:247], a[168:171], v[64:67], v[244:247]
 s_add_u32 m0, s41, 0xf600
 ds_read_b128 v[44:47], v12 offset:20480
 v_lshlrev_b32 v27, 12, v0
 v_mfma_f32_16x16x32_bf16 v[172:175], a[168:171], v[60:63], v[172:175]
 s_add_u32 s56, s45, 0x15000
 ds_read_b128 v[48:51], v12 offset:22528
 buffer_load_dwordx4 v18, s[8:11], s56 offen offset:0 lds
 v_mfma_f32_16x16x32_bf16 v[204:207], a[172:175], v[60:63], v[204:207]
 s_add_u32 s55, s59, s4
 ds_read_b64_tr_b16 a[164:165], v11 offset:0
 ds_read_b64_tr_b16 a[166:167], v11 offset:8448
 v_mfma_f32_16x16x32_bf16 v[196:199], a[172:175], v[56:59], v[196:199]
 s_waitcnt lgkmcnt(10)
 s_lshl_b32 s55, s55, 12
 ds_read_b128 v[52:55], v14 offset:20480
 v_mfma_f32_16x16x32_bf16 v[176:179], a[176:179], v[56:59], v[176:179]
 ds_read_b64_tr_b16 a[168:169], v10 offset:32
 ds_read_b64_tr_b16 a[170:171], v10 offset:8480
 v_mfma_f32_16x16x32_bf16 v[248:251], a[176:179], v[64:67], v[248:251]
 s_add_u32 m0, s41, 0x10600
 v_mov_b32 v29, 0
 v_mfma_f32_16x16x32_bf16 v[184:187], a[176:179], v[60:63], v[184:187]
 s_add_u32 s56, s45, 0x1c000
 buffer_load_dwordx4 v18, s[8:11], s56 offen offset:0 lds
 buffer_store_dword v29, v27, s[36:39], s55 offen offset:0 sc1
 v_mfma_f32_16x16x32_bf16 v[216:219], a[180:183], v[60:63], v[216:219]
 s_mul_i32 s46, s5, 0xa000
 ds_read_b64_tr_b16 a[172:173], v11 offset:32
 ds_read_b64_tr_b16 a[174:175], v11 offset:8480
 v_mfma_f32_16x16x32_bf16 v[208:211], a[180:183], v[56:59], v[208:211]
 s_waitcnt lgkmcnt(11)
 s_lshr_b32 s90, s5, 1
 s_add_u32 s90, s90, 8
 v_mfma_f32_16x16x32_bf16 v[180:183], a[184:187], v[56:59], v[180:183]
 s_add_u32 s51, s59, 0
 ds_read_b64_tr_b16 a[176:177], v10 offset:64
 ds_read_b64_tr_b16 a[178:179], v10 offset:8512
 v_mfma_f32_16x16x32_bf16 v[252:255], a[184:187], v[64:67], v[252:255]
 s_mul_i32 s52, s51, 52
 s_lshr_b32 s52, s52, 8
 s_lshl_b32 s69, s52, 7
 v_mfma_f32_16x16x32_bf16 v[188:191], a[184:187], v[60:63], v[188:191]
 s_add_u32 s45, s45, 0x80
 s_add_u32 s69, s69, s101
 s_sub_u32 s53, s69, 0x380
 v_mfma_f32_16x16x32_bf16 v[220:223], a[188:191], v[60:63], v[220:223]
 s_sub_u32 s56, s45, 0x380
 ds_read_b64_tr_b16 a[180:181], v11 offset:64
 ds_read_b64_tr_b16 a[182:183], v11 offset:8512
 v_mfma_f32_16x16x32_bf16 v[212:215], a[188:191], v[56:59], v[212:215]
 s_waitcnt lgkmcnt(9)
 s_min_u32 s69, s69, s53
 s_mul_i32 s53, s52, 15
 v_mfma_f32_16x16x32_bf16 v[96:99], a[160:163], v[44:47], v[96:99]
 s_min_u32 s45, s45, s56
 ds_read_b64_tr_b16 a[184:185], v10 offset:96
 ds_read_b64_tr_b16 a[186:187], v10 offset:8544
 s_waitcnt lgkmcnt(10)
 v_mfma_f32_16x16x32_bf16 v[224:227], a[160:163], v[52:55], v[224:227]
 s_add_u32 m0, s40, 0x1ea00
 s_add_u32 s53, s53, s51
 ds_read_b128 v[56:59], v13 offset:20480
 v_mfma_f32_16x16x32_bf16 v[104:107], a[160:163], v[48:51], v[104:107]
 s_add_u32 s56, s44, 0
 s_lshl_b32 s53, s53, 13
 buffer_load_dwordx4 v17, s[12:15], s56 offen offset:0 lds
 v_mfma_f32_16x16x32_bf16 v[136:139], a[164:167], v[48:51], v[136:139]
 s_add_u32 s56, s44, 0x1be0
 ds_read_b64_tr_b16 a[188:189], v11 offset:96
 ds_read_b64_tr_b16 a[190:191], v11 offset:8544
 v_mfma_f32_16x16x32_bf16 v[128:131], a[164:167], v[44:47], v[128:131]
 s_waitcnt lgkmcnt(9)
 s_add_u32 s64, s53, s46
 buffer_load_dwordx4 v17, s[12:15], s56 offen offset:1056 lds
 v_mfma_f32_16x16x32_bf16 v[100:103], a[168:171], v[44:47], v[100:103]
 s_mul_i32 s52, s52, 5
 ds_read_b64_tr_b16 a[160:161], v10 offset:256
 ds_read_b64_tr_b16 a[162:163], v10 offset:8704
 v_mfma_f32_16x16x32_bf16 v[228:231], a[168:171], v[52:55], v[228:231]
 s_sub_u32 s52, s51, s52
 ds_read_b128 v[60:63], v13 offset:22528
 v_mfma_f32_16x16x32_bf16 v[108:111], a[168:171], v[48:51], v[108:111]
 s_cmp_ge_u32 s52, 3
 s_cselect_b32 s53, 1, 0
 s_mul_i32 s49, s53, 3
 v_mfma_f32_16x16x32_bf16 v[140:143], a[172:175], v[48:51], v[140:143]
 s_sub_u32 s52, s52, s49
 ds_read_b64_tr_b16 a[164:165], v11 offset:256
 ds_read_b64_tr_b16 a[166:167], v11 offset:8704
 v_mfma_f32_16x16x32_bf16 v[132:135], a[172:175], v[44:47], v[132:135]
 s_waitcnt lgkmcnt(10)
 s_xor_b32 s53, s53, s94
 s_lshl_b32 s53, s53, 6
 v_mfma_f32_16x16x32_bf16 v[112:115], a[176:179], v[44:47], v[112:115]
 s_add_u32 s56, s44, 0x37c0
 ds_read_b64_tr_b16 a[168:169], v10 offset:288
 ds_read_b64_tr_b16 a[170:171], v10 offset:8736
 v_mfma_f32_16x16x32_bf16 v[232:235], a[176:179], v[52:55], v[232:235]
 s_add_u32 s69, s69, s53
 ds_read_b128 v[64:67], v15 offset:20480
 buffer_load_dwordx4 v17, s[12:15], s56 offen offset:2112 lds
 v_mfma_f32_16x16x32_bf16 v[120:123], a[176:179], v[48:51], v[120:123]
 s_lshl_b32 s53, s5, 1
 s_add_u32 s53, s53, s52
 v_mfma_f32_16x16x32_bf16 v[152:155], a[180:183], v[48:51], v[152:155]
 ds_read_b64_tr_b16 a[172:173], v11 offset:288
 ds_read_b64_tr_b16 a[174:175], v11 offset:8736
 v_mfma_f32_16x16x32_bf16 v[144:147], a[180:183], v[44:47], v[144:147]
 s_waitcnt lgkmcnt(10)
 s_cmp_eq_u32 s52, 2
 s_cselect_b32 s53, s90, s53
 v_mfma_f32_16x16x32_bf16 v[116:119], a[184:187], v[44:47], v[116:119]
 s_add_u32 s56, s44, 0x53a0
 ds_read_b64_tr_b16 a[176:177], v10 offset:320
 ds_read_b64_tr_b16 a[178:179], v10 offset:8768
 v_mfma_f32_16x16x32_bf16 v[236:239], a[184:187], v[52:55], v[236:239]
 s_mul_i32 s53, s53, 0x7000
 s_add_u32 s69, s69, s53
 buffer_load_dwordx4 v17, s[12:15], s56 offen offset:3168 lds
 v_mfma_f32_16x16x32_bf16 v[124:127], a[184:187], v[48:51], v[124:127]
 s_cmp_lt_u32 s51, 8
 s_cselect_b32 s69, s69, 0x10000000
 s_cselect_b32 s64, s64, 0x10000000
 v_mfma_f32_16x16x32_bf16 v[156:159], a[188:191], v[48:51], v[156:159]
 s_add_u32 s51, s59, 8
 ds_read_b64_tr_b16 a[180:181], v11 offset:320
 ds_read_b64_tr_b16 a[182:183], v11 offset:8768
 v_mfma_f32_16x16x32_bf16 v[148:151], a[188:191], v[44:47], v[148:151]
 s_waitcnt lgkmcnt(9)
 s_mul_i32 s52, s51, 52
 s_lshr_b32 s52, s52, 8
 v_mfma_f32_16x16x32_bf16 v[160:163], a[160:163], v[44:47], v[160:163]
 s_lshl_b32 s70, s52, 7
 ds_read_b64_tr_b16 a[184:185], v10 offset:352
 ds_read_b64_tr_b16 a[186:187], v10 offset:8800
 v_mfma_f32_16x16x32_bf16 v[240:243], a[160:163], v[52:55], v[240:243]
 s_add_u32 s70, s70, s101
 s_sub_u32 s53, s70, 0x380
 s_min_u32 s70, s70, s53
 v_mfma_f32_16x16x32_bf16 v[168:171], a[160:163], v[48:51], v[168:171]
 s_mul_i32 s53, s52, 15
 s_add_u32 s53, s53, s51
 s_lshl_b32 s53, s53, 13
 v_mfma_f32_16x16x32_bf16 v[200:203], a[164:167], v[48:51], v[200:203]
 s_add_u32 s65, s53, s46
 ds_read_b64_tr_b16 a[188:189], v11 offset:352
 ds_read_b64_tr_b16 a[190:191], v11 offset:8800
 v_mfma_f32_16x16x32_bf16 v[192:195], a[164:167], v[44:47], v[192:195]
 s_waitcnt lgkmcnt(8)
 s_mul_i32 s52, s52, 5
 s_sub_u32 s52, s51, s52
 v_mfma_f32_16x16x32_bf16 v[164:167], a[168:171], v[44:47], v[164:167]
 s_waitcnt vmcnt(10)
 s_barrier
 ds_read_b64_tr_b16 a[160:161], v10 offset:16896
 ds_read_b64_tr_b16 a[162:163], v10 offset:25344
 v_mfma_f32_16x16x32_bf16 v[244:247], a[168:171], v[52:55], v[244:247]
 s_add_u32 m0, s40, 0x22c00
 s_cmp_ge_u32 s52, 3
 s_cselect_b32 s53, 1, 0
 v_mfma_f32_16x16x32_bf16 v[172:175], a[168:171], v[48:51], v[172:175]
 s_add_u32 s56, s44, 0x40000
 s_mul_i32 s49, s53, 3
 buffer_load_dwordx4 v17, s[12:15], s56 offen offset:0 lds
 v_mfma_f32_16x16x32_bf16 v[204:207], a[172:175], v[48:51], v[204:207]
 s_sub_u32 s52, s52, s49
 ds_read_b64_tr_b16 a[164:165], v11 offset:16896
 ds_read_b64_tr_b16 a[166:167], v11 offset:25344
 v_mfma_f32_16x16x32_bf16 v[196:199], a[172:175], v[44:47], v[196:199]
 s_waitcnt lgkmcnt(8)
 s_xor_b32 s53, s53, s94
 s_lshl_b32 s53, s53, 6
 v_mfma_f32_16x16x32_bf16 v[176:179], a[176:179], v[44:47], v[176:179]
 s_add_u32 s70, s70, s53
 ds_read_b64_tr_b16 a[168:169], v10 offset:16928
 ds_read_b64_tr_b16 a[170:171], v10 offset:25376
 v_mfma_f32_16x16x32_bf16 v[248:251], a[176:179], v[52:55], v[248:251]
 s_add_u32 s56, s44, 0x41be0
 s_lshl_b32 s53, s5, 1
 buffer_load_dwordx4 v17, s[12:15], s56 offen offset:1056 lds
 v_mfma_f32_16x16x32_bf16 v[184:187], a[176:179], v[48:51], v[184:187]
 s_add_u32 s53, s53, s52
 s_cmp_eq_u32 s52, 2
 s_cselect_b32 s53, s90, s53
 v_mfma_f32_16x16x32_bf16 v[216:219], a[180:183], v[48:51], v[216:219]
 s_mul_i32 s53, s53, 0x7000
 ds_read_b64_tr_b16 a[172:173], v11 offset:16928
 ds_read_b64_tr_b16 a[174:175], v11 offset:25376
 v_mfma_f32_16x16x32_bf16 v[208:211], a[180:183], v[44:47], v[208:211]
 s_waitcnt lgkmcnt(8)
 s_add_u32 s70, s70, s53
 v_mfma_f32_16x16x32_bf16 v[180:183], a[184:187], v[44:47], v[180:183]
 ds_read_b64_tr_b16 a[176:177], v10 offset:16960
 ds_read_b64_tr_b16 a[178:179], v10 offset:25408
 v_mfma_f32_16x16x32_bf16 v[252:255], a[184:187], v[52:55], v[252:255]
 s_add_u32 s56, s44, 0x437c0
 buffer_load_dwordx4 v17, s[12:15], s56 offen offset:2112 lds
 v_mfma_f32_16x16x32_bf16 v[188:191], a[184:187], v[48:51], v[188:191]
 s_cmp_lt_u32 s51, 15
 s_cselect_b32 s70, s70, 0x10000000
 s_cselect_b32 s65, s65, 0x10000000
 v_mfma_f32_16x16x32_bf16 v[220:223], a[188:191], v[48:51], v[220:223]
 s_add_u32 s51, s59, 15
 ds_read_b64_tr_b16 a[180:181], v11 offset:16960
 ds_read_b64_tr_b16 a[182:183], v11 offset:25408
 v_mfma_f32_16x16x32_bf16 v[212:215], a[188:191], v[44:47], v[212:215]
 s_waitcnt lgkmcnt(8)
 s_mul_i32 s52, s51, 52
 s_lshr_b32 s52, s52, 8
 v_mfma_f32_16x16x32_bf16 v[96:99], a[160:163], v[56:59], v[96:99]
 s_lshl_b32 s71, s52, 7
 ds_read_b64_tr_b16 a[184:185], v10 offset:16992
 ds_read_b64_tr_b16 a[186:187], v10 offset:25440
 v_mfma_f32_16x16x32_bf16 v[224:227], a[160:163], v[64:67], v[224:227]
 s_add_u32 s56, s44, 0x453a0
 s_add_u32 s71, s71, s101
 buffer_load_dwordx4 v17, s[12:15], s56 offen offset:3168 lds
 v_mfma_f32_16x16x32_bf16 v[104:107], a[160:163], v[60:63], v[104:107]
 s_sub_u32 s53, s71, 0x380
 s_min_u32 s71, s71, s53
 s_mul_i32 s53, s52, 15
 v_mfma_f32_16x16x32_bf16 v[136:139], a[164:167], v[60:63], v[136:139]
 s_add_u32 s53, s53, s51
 ds_read_b64_tr_b16 a[188:189], v11 offset:16992
 ds_read_b64_tr_b16 a[190:191], v11 offset:25440
 v_mfma_f32_16x16x32_bf16 v[128:131], a[164:167], v[56:59], v[128:131]
 s_waitcnt lgkmcnt(8)
 s_lshl_b32 s53, s53, 13
 s_add_u32 s66, s53, s46
 v_mfma_f32_16x16x32_bf16 v[100:103], a[168:171], v[56:59], v[100:103]
 s_mul_i32 s52, s52, 5
 ds_read_b64_tr_b16 a[160:161], v10 offset:17152
 ds_read_b64_tr_b16 a[162:163], v10 offset:25600
 v_mfma_f32_16x16x32_bf16 v[228:231], a[168:171], v[64:67], v[228:231]
 s_add_u32 s44, s44, 0x80000
 s_sub_u32 s52, s51, s52
 v_mfma_f32_16x16x32_bf16 v[108:111], a[168:171], v[60:63], v[108:111]
 s_sub_u32 s56, s44, 0x380000
 s_cmp_ge_u32 s52, 3
 s_cselect_b32 s53, 1, 0
 v_mfma_f32_16x16x32_bf16 v[140:143], a[172:175], v[60:63], v[140:143]
 s_min_u32 s44, s44, s56
 ds_read_b64_tr_b16 a[164:165], v11 offset:17152
 ds_read_b64_tr_b16 a[166:167], v11 offset:25600
 v_mfma_f32_16x16x32_bf16 v[132:135], a[172:175], v[56:59], v[132:135]
 s_waitcnt lgkmcnt(8)
 s_mul_i32 s49, s53, 3
 s_sub_u32 s52, s52, s49
 v_mfma_f32_16x16x32_bf16 v[112:115], a[176:179], v[56:59], v[112:115]
 s_add_u32 m0, s41, 0x11600
 ds_read_b64_tr_b16 a[168:169], v10 offset:17184
 ds_read_b64_tr_b16 a[170:171], v10 offset:25632
 v_mfma_f32_16x16x32_bf16 v[232:235], a[176:179], v[64:67], v[232:235]
 s_add_u32 s56, s45, 0
 s_xor_b32 s53, s53, s94
 buffer_load_dwordx4 v18, s[8:11], s56 offen offset:0 lds
 v_mfma_f32_16x16x32_bf16 v[120:123], a[176:179], v[60:63], v[120:123]
 s_add_u32 m0, s41, 0x12600
 s_lshl_b32 s53, s53, 6
 s_add_u32 s71, s71, s53
 v_mfma_f32_16x16x32_bf16 v[152:155], a[180:183], v[60:63], v[152:155]
 s_add_u32 s56, s45, 0x7000
 ds_read_b64_tr_b16 a[172:173], v11 offset:17184
 ds_read_b64_tr_b16 a[174:175], v11 offset:25632
 v_mfma_f32_16x16x32_bf16 v[144:147], a[180:183], v[56:59], v[144:147]
 s_waitcnt lgkmcnt(8)
 s_lshl_b32 s53, s5, 1
 buffer_load_dwordx4 v18, s[8:11], s56 offen offset:0 lds
 v_mfma_f32_16x16x32_bf16 v[116:119], a[184:187], v[56:59], v[116:119]
 s_add_u32 s53, s53, s52
 ds_read_b64_tr_b16 a[176:177], v10 offset:17216
 ds_read_b64_tr_b16 a[178:179], v10 offset:25664
 v_mfma_f32_16x16x32_bf16 v[236:239], a[184:187], v[64:67], v[236:239]
 s_add_u32 m0, s41, 0x13600
 s_cmp_eq_u32 s52, 2
 s_cselect_b32 s53, s90, s53
 v_mfma_f32_16x16x32_bf16 v[124:127], a[184:187], v[60:63], v[124:127]
 s_add_u32 s56, s45, 0xe000
 s_mul_i32 s53, s53, 0x7000
 buffer_load_dwordx4 v18, s[8:11], s56 offen offset:0 lds
 v_mfma_f32_16x16x32_bf16 v[156:159], a[188:191], v[60:63], v[156:159]
 s_add_u32 s71, s71, s53
 ds_read_b64_tr_b16 a[180:181], v11 offset:17216
 ds_read_b64_tr_b16 a[182:183], v11 offset:25664
 v_mfma_f32_16x16x32_bf16 v[148:151], a[188:191], v[56:59], v[148:151]
 s_waitcnt lgkmcnt(8)
 s_cmp_lt_u32 s51, 20
 s_cselect_b32 s71, s71, 0x10000000
 s_cselect_b32 s66, s66, 0x10000000
 v_mfma_f32_16x16x32_bf16 v[160:163], a[160:163], v[56:59], v[160:163]
 s_add_u32 s51, s59, 20
 ds_read_b64_tr_b16 a[184:185], v10 offset:17248
 ds_read_b64_tr_b16 a[186:187], v10 offset:25696
 v_mfma_f32_16x16x32_bf16 v[240:243], a[160:163], v[64:67], v[240:243]
 s_mul_i32 s52, s51, 52
 s_lshr_b32 s52, s52, 8
 s_lshl_b32 s72, s52, 7
 v_mfma_f32_16x16x32_bf16 v[168:171], a[160:163], v[60:63], v[168:171]
 s_add_u32 s72, s72, s101
 s_sub_u32 s53, s72, 0x380
 s_min_u32 s72, s72, s53
 v_mfma_f32_16x16x32_bf16 v[200:203], a[164:167], v[60:63], v[200:203]
L_pad1:
 s_cbranch_execz L_pad5
 s_mul_i32 s53, s52, 15
 ds_read_b64_tr_b16 a[188:189], v11 offset:17248
 ds_read_b64_tr_b16 a[190:191], v11 offset:25696
 v_mfma_f32_16x16x32_bf16 v[192:195], a[164:167], v[56:59], v[192:195]
 s_waitcnt lgkmcnt(8)
 s_add_u32 s53, s53, s51
 s_lshl_b32 s53, s53, 13
 v_mfma_f32_16x16x32_bf16 v[164:167], a[168:171], v[56:59], v[164:167]
 s_waitcnt vmcnt(7)
 s_barrier
 ds_read_b64_tr_b16 a[160:161], v10 offset:33792
 ds_read_b64_tr_b16 a[162:163], v10 offset:42240
 v_mfma_f32_16x16x32_bf16 v[244:247], a[168:171], v[64:67], v[244:247]
 s_add_u32 m0, s41, 0x14600
 s_add_u32 s67, s53, s46
 ds_read_b128 v[44:47], v12 offset:0
 v_mfma_f32_16x16x32_bf16 v[172:175], a[168:171], v[60:63], v[172:175]
 s_add_u32 s56, s45, 0x15000
 ds_read_b128 v[48:51], v12 offset:2048
 buffer_load_dwordx4 v18, s[8:11], s56 offen offset:0 lds
 v_mfma_f32_16x16x32_bf16 v[204:207], a[172:175], v[60:63], v[204:207]
 s_mul_i32 s52, s52, 5
 ds_read_b64_tr_b16 a[164:165], v11 offset:33792
 ds_read_b64_tr_b16 a[166:167], v11 offset:42240
 v_mfma_f32_16x16x32_bf16 v[196:199], a[172:175], v[56:59], v[196:199]
 s_waitcnt lgkmcnt(10)
 s_sub_u32 s52, s51, s52
 ds_read_b128 v[52:55], v14 offset:0
 v_mfma_f32_16x16x32_bf16 v[176:179], a[176:179], v[56:59], v[176:179]
 ds_read_b64_tr_b16 a[168:169], v10 offset:33824
 ds_read_b64_tr_b16 a[170:171], v10 offset:42272
 v_mfma_f32_16x16x32_bf16 v[248:251], a[176:179], v[64:67], v[248:251]
 s_add_u32 m0, s41, 0x15600
 s_cmp_ge_u32 s52, 3
 s_cselect_b32 s53, 1, 0
 v_mfma_f32_16x16x32_bf16 v[184:187], a[176:179], v[60:63], v[184:187]
 s_add_u32 s56, s45, 0x1c000
 s_mul_i32 s49, s53, 3
 buffer_load_dwordx4 v18, s[8:11], s56 offen offset:0 lds
 v_mfma_f32_16x16x32_bf16 v[216:219], a[180:183], v[60:63], v[216:219]
 s_sub_u32 s52, s52, s49
 ds_read_b64_tr_b16 a[172:173], v11 offset:33824
 ds_read_b64_tr_b16 a[174:175], v11 offset:42272
 v_mfma_f32_16x16x32_bf16 v[208:211], a[180:183], v[56:59], v[208:211]
 s_waitcnt lgkmcnt(11)
 s_xor_b32 s53, s53, s94
 s_lshl_b32 s53, s53, 6
 v_mfma_f32_16x16x32_bf16 v[180:183], a[184:187], v[56:59], v[180:183]
 s_add_u32 s72, s72, s53
 ds_read_b64_tr_b16 a[176:177], v10 offset:33856
 ds_read_b64_tr_b16 a[178:179], v10 offset:42304
 v_mfma_f32_16x16x32_bf16 v[252:255], a[184:187], v[64:67], v[252:255]
 s_lshl_b32 s53, s5, 1
 s_add_u32 s53, s53, s52
 v_mfma_f32_16x16x32_bf16 v[188:191], a[184:187], v[60:63], v[188:191]
 s_add_u32 s45, s45, 0x80
 s_cmp_eq_u32 s52, 2
 s_cselect_b32 s53, s90, s53
 v_mfma_f32_16x16x32_bf16 v[220:223], a[188:191], v[60:63], v[220:223]
 s_sub_u32 s56, s45, 0x380
 ds_read_b64_tr_b16 a[180:181], v11 offset:33856
 ds_read_b64_tr_b16 a[182:183], v11 offset:42304
 v_mfma_f32_16x16x32_bf16 v[212:215], a[188:191], v[56:59], v[212:215]
 s_waitcnt lgkmcnt(9)
 s_mul_i32 s53, s53, 0x7000
 s_add_u32 s72, s72, s53
 v_mfma_f32_16x16x32_bf16 v[96:99], a[160:163], v[44:47], v[96:99]
 s_min_u32 s45, s45, s56
 ds_read_b64_tr_b16 a[184:185], v10 offset:33888
 ds_read_b64_tr_b16 a[186:187], v10 offset:42336
 s_waitcnt lgkmcnt(10)
 v_mfma_f32_16x16x32_bf16 v[224:227], a[160:163], v[52:55], v[224:227]
 s_add_u32 m0, s40, 0x16600
 ds_read_b128 v[56:59], v13 offset:0
 v_mfma_f32_16x16x32_bf16 v[104:107], a[160:163], v[48:51], v[104:107]
 s_add_u32 s56, s44, 0
 buffer_load_dwordx4 v17, s[12:15], s56 offen offset:0 lds
 v_mfma_f32_16x16x32_bf16 v[136:139], a[164:167], v[48:51], v[136:139]
 s_add_u32 s56, s44, 0x1be0
 ds_read_b64_tr_b16 a[188:189], v11 offset:33888
 ds_read_b64_tr_b16 a[190:191], v11 offset:42336
 v_mfma_f32_16x16x32_bf16 v[128:131], a[164:167], v[44:47], v[128:131]
 s_waitcnt lgkmcnt(9)
 buffer_load_dwordx4 v17, s[12:15], s56 offen offset:1056 lds
 v_mfma_f32_16x16x32_bf16 v[100:103], a[168:171], v[44:47], v[100:103]
 ds_read_b64_tr_b16 a[160:161], v10 offset:34048
 ds_read_b64_tr_b16 a[162:163], v10 offset:42496
 v_mfma_f32_16x16x32_bf16 v[228:231], a[168:171], v[52:55], v[228:231]
 ds_read_b128 v[60:63], v13 offset:2048
 v_mfma_f32_16x16x32_bf16 v[108:111], a[168:171], v[48:51], v[108:111]
 s_cmp_lt_u32 s51, 28
 s_cselect_b32 s72, s72, 0x10000000
 s_cselect_b32 s67, s67, 0x10000000
 v_mfma_f32_16x16x32_bf16 v[140:143], a[172:175], v[48:51], v[140:143]
 s_add_u32 s51, s59, 28
 ds_read_b64_tr_b16 a[164:165], v11 offset:34048
 ds_read_b64_tr_b16 a[166:167], v11 offset:42496
 v_mfma_f32_16x16x32_bf16 v[132:135], a[172:175], v[44:47], v[132:135]
 s_waitcnt lgkmcnt(10)
 s_mul_i32 s52, s51, 52
 s_lshr_b32 s52, s52, 8
 v_mfma_f32_16x16x32_bf16 v[112:115], a[176:179], v[44:47], v[112:115]
 s_add_u32 s56, s44, 0x37c0
 ds_read_b64_tr_b16 a[168:169], v10 offset:34080
 ds_read_b64_tr_b16 a[170:171], v10 offset:42528
 v_mfma_f32_16x16x32_bf16 v[232:235], a[176:179], v[52:55], v[232:235]
 s_lshl_b32 s73, s52, 7
 ds_read_b128 v[64:67], v15 offset:0
 buffer_load_dwordx4 v17, s[12:15], s56 offen offset:2112 lds
 v_mfma_f32_16x16x32_bf16 v[120:123], a[176:179], v[48:51], v[120:123]
 s_add_u32 s73, s73, s101
 s_sub_u32 s53, s73, 0x380
 s_min_u32 s73, s73, s53
 v_mfma_f32_16x16x32_bf16 v[152:155], a[180:183], v[48:51], v[152:155]
 s_mul_i32 s53, s52, 15
 ds_read_b64_tr_b16 a[172:173], v11 offset:34080
 ds_read_b64_tr_b16 a[174:175], v11 offset:42528
 v_mfma_f32_16x16x32_bf16 v[144:147], a[180:183], v[44:47], v[144:147]
 s_waitcnt lgkmcnt(10)
 s_add_u32 s53, s53, s51
 s_lshl_b32 s53, s53, 13
 v_mfma_f32_16x16x32_bf16 v[116:119], a[184:187], v[44:47], v[116:119]
 s_add_u32 s56, s44, 0x53a0
 ds_read_b64_tr_b16 a[176:177], v10 offset:34112
 ds_read_b64_tr_b16 a[178:179], v10 offset:42560
 v_mfma_f32_16x16x32_bf16 v[236:239], a[184:187], v[52:55], v[236:239]
 s_add_u32 s68, s53, s46
 s_mul_i32 s52, s52, 5
 buffer_load_dwordx4 v17, s[12:15], s56 offen offset:3168 lds
 v_mfma_f32_16x16x32_bf16 v[124:127], a[184:187], v[48:51], v[124:127]
 s_sub_u32 s52, s51, s52
 s_cmp_ge_u32 s52, 3
 s_cselect_b32 s53, 1, 0
 v_mfma_f32_16x16x32_bf16 v[156:159], a[188:191], v[48:51], v[156:159]
 s_mul_i32 s49, s53, 3
 ds_read_b64_tr_b16 a[180:181], v11 offset:34112
 ds_read_b64_tr_b16 a[182:183], v11 offset:42560
 v_mfma_f32_16x16x32_bf16 v[148:151], a[188:191], v[44:47], v[148:151]
 s_waitcnt lgkmcnt(9)
 s_sub_u32 s52, s52, s49
 s_xor_b32 s53, s53, s94
 v_mfma_f32_16x16x32_bf16 v[160:163], a[160:163], v[44:47], v[160:163]
 s_lshl_b32 s53, s53, 6
 ds_read_b64_tr_b16 a[184:185], v10 offset:34144
 ds_read_b64_tr_b16 a[186:187], v10 offset:42592
 v_mfma_f32_16x16x32_bf16 v[240:243], a[160:163], v[52:55], v[240:243]
 s_add_u32 s73, s73, s53
 s_lshl_b32 s53, s5, 1
 s_add_u32 s53, s53, s52
 v_mfma_f32_16x16x32_bf16 v[168:171], a[160:163], v[48:51], v[168:171]
 s_cmp_eq_u32 s52, 2
 s_cselect_b32 s53, s90, s53
 s_mul_i32 s53, s53, 0x7000
 v_mfma_f32_16x16x32_bf16 v[200:203], a[164:167], v[48:51], v[200:203]
 s_add_u32 s73, s73, s53
 ds_read_b64_tr_b16 a[188:189], v11 offset:34144
 ds_read_b64_tr_b16 a[190:191], v11 offset:42592
 v_mfma_f32_16x16x32_bf16 v[192:195], a[164:167], v[44:47], v[192:195]
 s_waitcnt lgkmcnt(8)
 s_cmp_lt_u32 s51, 35
 s_cselect_b32 s73, s73, 0x10000000
 s_cselect_b32 s68, s68, 0x10000000
 v_mfma_f32_16x16x32_bf16 v[164:167], a[168:171], v[44:47], v[164:167]
 s_waitcnt vmcnt(9)
 s_barrier
 ds_read_b64_tr_b16 a[160:161], v10 offset:50688
 ds_read_b64_tr_b16 a[162:163], v10 offset:59136
 v_mfma_f32_16x16x32_bf16 v[244:247], a[168:171], v[52:55], v[244:247]
 s_add_u32 m0, s40, 0x1a800
 s_xor_b32 s51, s94, 0
 s_lshl_b32 s51, s51, 9
 v_mfma_f32_16x16x32_bf16 v[172:175], a[168:171], v[48:51], v[172:175]
 s_add_u32 s56, s44, 0x40000
 s_xor_b32 s52, s94, 0
 buffer_load_dwordx4 v17, s[12:15], s56 offen offset:0 lds
 v_mfma_f32_16x16x32_bf16 v[204:207], a[172:175], v[48:51], v[204:207]
 s_lshl_b32 s52, s52, 6
 ds_read_b64_tr_b16 a[164:165], v11 offset:50688
 ds_read_b64_tr_b16 a[166:167], v11 offset:59136
 v_mfma_f32_16x16x32_bf16 v[196:199], a[172:175], v[44:47], v[196:199]
 s_waitcnt lgkmcnt(8)
 s_add_u32 s48, s51, s52
 s_xor_b32 s51, s94, 0
 v_mfma_f32_16x16x32_bf16 v[176:179], a[176:179], v[44:47], v[176:179]
 s_lshl_b32 s51, s51, 9
 ds_read_b64_tr_b16 a[168:169], v10 offset:50720
 ds_read_b64_tr_b16 a[170:171], v10 offset:59168
 v_mfma_f32_16x16x32_bf16 v[248:251], a[176:179], v[52:55], v[248:251]
 s_add_u32 s56, s44, 0x41be0
 s_xor_b32 s52, s94, 1
 buffer_load_dwordx4 v17, s[12:15], s56 offen offset:1056 lds
 v_mfma_f32_16x16x32_bf16 v[184:187], a[176:179], v[48:51], v[184:187]
 s_lshl_b32 s52, s52, 6
 s_add_u32 s92, s51, s52
 s_xor_b32 s51, s94, 1
 v_mfma_f32_16x16x32_bf16 v[216:219], a[180:183], v[48:51], v[216:219]
 s_lshl_b32 s51, s51, 9
 ds_read_b64_tr_b16 a[172:173], v11 offset:50720
 ds_read_b64_tr_b16 a[174:175], v11 offset:59168
 v_mfma_f32_16x16x32_bf16 v[208:211], a[180:183], v[44:47], v[208:211]
 s_waitcnt lgkmcnt(8)
 s_xor_b32 s52, s94, 0
 s_lshl_b32 s52, s52, 6
 v_mfma_f32_16x16x32_bf16 v[180:183], a[184:187], v[44:47], v[180:183]
 s_add_u32 s93, s51, s52
 ds_read_b64_tr_b16 a[176:177], v10 offset:50752
 ds_read_b64_tr_b16 a[178:179], v10 offset:59200
 v_mfma_f32_16x16x32_bf16 v[252:255], a[184:187], v[52:55], v[252:255]
 s_add_u32 s56, s44, 0x437c0
 s_xor_b32 s51, s94, 1
 buffer_load_dwordx4 v17, s[12:15], s56 offen offset:2112 lds
 v_mfma_f32_16x16x32_bf16 v[188:191], a[184:187], v[48:51], v[188:191]
 s_lshl_b32 s51, s51, 9
 s_xor_b32 s52, s94, 1
 s_lshl_b32 s52, s52, 6
 v_mfma_f32_16x16x32_bf16 v[220:223], a[188:191], v[48:51], v[220:223]
 s_add_u32 s95, s51, s52
 ds_read_b64_tr_b16 a[180:181], v11 offset:50752
 ds_read_b64_tr_b16 a[182:183], v11 offset:59200
 v_mfma_f32_16x16x32_bf16 v[212:215], a[188:191], v[44:47], v[212:215]
 s_waitcnt lgkmcnt(8)
 s_mul_i32 s51, s5, 0xe00
 s_add_u32 s61, s61, s51
 v_mfma_f32_16x16x32_bf16 v[96:99], a[160:163], v[56:59], v[96:99]
 ds_read_b64_tr_b16 a[184:185], v10 offset:50784
 ds_read_b64_tr_b16 a[186:187], v10 offset:59232
 v_mfma_f32_16x16x32_bf16 v[224:227], a[160:163], v[64:67], v[224:227]
 s_add_u32 s56, s44, 0x453a0
 buffer_load_dwordx4 v17, s[12:15], s56 offen offset:3168 lds
 v_mfma_f32_16x16x32_bf16 v[104:107], a[160:163], v[60:63], v[104:107]
 v_mfma_f32_16x16x32_bf16 v[136:139], a[164:167], v[60:63], v[136:139]
 ds_read_b64_tr_b16 a[188:189], v11 offset:50784
 ds_read_b64_tr_b16 a[190:191], v11 offset:59232
 v_mfma_f32_16x16x32_bf16 v[128:131], a[164:167], v[56:59], v[128:131]
 s_waitcnt lgkmcnt(8)
 v_mfma_f32_16x16x32_bf16 v[100:103], a[168:171], v[56:59], v[100:103]
 ds_read_b64_tr_b16 a[160:161], v10 offset:50944
 ds_read_b64_tr_b16 a[162:163], v10 offset:59392
 v_mfma_f32_16x16x32_bf16 v[228:231], a[168:171], v[64:67], v[228:231]
 s_add_u32 s44, s44, 0x80000
 v_mfma_f32_16x16x32_bf16 v[108:111], a[168:171], v[60:63], v[108:111]
 s_sub_u32 s56, s44, 0x380000
 v_mfma_f32_16x16x32_bf16 v[140:143], a[172:175], v[60:63], v[140:143]
 s_min_u32 s44, s44, s56
 ds_read_b64_tr_b16 a[164:165], v11 offset:50944
 ds_read_b64_tr_b16 a[166:167], v11 offset:59392
 v_mfma_f32_16x16x32_bf16 v[132:135], a[172:175], v[56:59], v[132:135]
 s_waitcnt lgkmcnt(8)
 v_mfma_f32_16x16x32_bf16 v[112:115], a[176:179], v[56:59], v[112:115]
 s_add_u32 m0, s41, 0xc600
 ds_read_b64_tr_b16 a[168:169], v10 offset:50976
 ds_read_b64_tr_b16 a[170:171], v10 offset:59424
 v_mfma_f32_16x16x32_bf16 v[232:235], a[176:179], v[64:67], v[232:235]
 s_add_u32 s56, s45, 0
 buffer_load_dwordx4 v18, s[8:11], s56 offen offset:0 lds
 v_mfma_f32_16x16x32_bf16 v[120:123], a[176:179], v[60:63], v[120:123]
 s_add_u32 m0, s41, 0xd600
 v_mfma_f32_16x16x32_bf16 v[152:155], a[180:183], v[60:63], v[152:155]
 s_add_u32 s56, s45, 0x7000
 ds_read_b64_tr_b16 a[172:173], v11 offset:50976
 ds_read_b64_tr_b16 a[174:175], v11 offset:59424
 v_mfma_f32_16x16x32_bf16 v[144:147], a[180:183], v[56:59], v[144:147]
 s_waitcnt lgkmcnt(8)
 buffer_load_dwordx4 v18, s[8:11], s56 offen offset:0 lds
 v_mfma_f32_16x16x32_bf16 v[116:119], a[184:187], v[56:59], v[116:119]
 ds_read_b64_tr_b16 a[176:177], v10 offset:51008
 ds_read_b64_tr_b16 a[178:179], v10 offset:59456
 v_mfma_f32_16x16x32_bf16 v[236:239], a[184:187], v[64:67], v[236:239]
 s_add_u32 m0, s41, 0xe600
 v_mfma_f32_16x16x32_bf16 v[124:127], a[184:187], v[60:63], v[124:127]
 s_add_u32 s56, s45, 0xe000
 buffer_load_dwordx4 v18, s[8:11], s56 offen offset:0 lds
 v_mfma_f32_16x16x32_bf16 v[156:159], a[188:191], v[60:63], v[156:159]
 ds_read_b64_tr_b16 a[180:181], v11 offset:51008
 ds_read_b64_tr_b16 a[182:183], v11 offset:59456
 v_mfma_f32_16x16x32_bf16 v[148:151], a[188:191], v[56:59], v[148:151]
 s_waitcnt lgkmcnt(8)
 v_mfma_f32_16x16x32_bf16 v[160:163], a[160:163], v[56:59], v[160:163]
 ds_read_b64_tr_b16 a[184:185], v10 offset:51040
 ds_read_b64_tr_b16 a[186:187], v10 offset:59488
 v_mfma_f32_16x16x32_bf16 v[240:243], a[160:163], v[64:67], v[240:243]
 v_mfma_f32_16x16x32_bf16 v[168:171], a[160:163], v[60:63], v[168:171]
 v_mfma_f32_16x16x32_bf16 v[200:203], a[164:167], v[60:63], v[200:203]
 ds_read_b64_tr_b16 a[188:189], v11 offset:51040
 ds_read_b64_tr_b16 a[190:191], v11 offset:59488
 v_mfma_f32_16x16x32_bf16 v[192:195], a[164:167], v[56:59], v[192:195]
 s_waitcnt lgkmcnt(8)
 v_mfma_f32_16x16x32_bf16 v[164:167], a[168:171], v[56:59], v[164:167]
 s_waitcnt vmcnt(7)
 s_barrier
 ds_read_b64_tr_b16 a[160:161], v10 offset:0
 ds_read_b64_tr_b16 a[162:163], v10 offset:8448
 v_mfma_f32_16x16x32_bf16 v[244:247], a[168:171], v[64:67], v[244:247]
 s_add_u32 m0, s41, 0xf600
 ds_read_b128 v[44:47], v12 offset:20480
 v_mfma_f32_16x16x32_bf16 v[172:175], a[168:171], v[60:63], v[172:175]
 s_add_u32 s56, s45, 0x15000
 ds_read_b128 v[48:51], v12 offset:22528
 buffer_load_dwordx4 v18, s[8:11], s56 offen offset:0 lds
 v_mfma_f32_16x16x32_bf16 v[204:207], a[172:175], v[60:63], v[204:207]
 ds_read_b64_tr_b16 a[164:165], v11 offset:0
 ds_read_b64_tr_b16 a[166:167], v11 offset:8448
 v_mfma_f32_16x16x32_bf16 v[196:199], a[172:175], v[56:59], v[196:199]
 s_waitcnt lgkmcnt(10)
 ds_read_b128 v[52:55], v14 offset:20480
 v_mfma_f32_16x16x32_bf16 v[176:179], a[176:179], v[56:59], v[176:179]
 ds_read_b64_tr_b16 a[168:169], v10 offset:32
 ds_read_b64_tr_b16 a[170:171], v10 offset:8480
 v_mfma_f32_16x16x32_bf16 v[248:251], a[176:179], v[64:67], v[248:251]
 s_add_u32 m0, s41, 0x10600
 v_mfma_f32_16x16x32_bf16 v[184:187], a[176:179], v[60:63], v[184:187]
 s_add_u32 s56, s45, 0x1c000
 buffer_load_dwordx4 v18, s[8:11], s56 offen offset:0 lds
 v_mfma_f32_16x16x32_bf16 v[216:219], a[180:183], v[60:63], v[216:219]
 ds_read_b64_tr_b16 a[172:173], v11 offset:32
 ds_read_b64_tr_b16 a[174:175], v11 offset:8480
 v_mfma_f32_16x16x32_bf16 v[208:211], a[180:183], v[56:59], v[208:211]
 s_waitcnt lgkmcnt(11)
 v_mfma_f32_16x16x32_bf16 v[180:183], a[184:187], v[56:59], v[180:183]
 ds_read_b64_tr_b16 a[176:177], v10 offset:64
 ds_read_b64_tr_b16 a[178:179], v10 offset:8512
 v_mfma_f32_16x16x32_bf16 v[252:255], a[184:187], v[64:67], v[252:255]
 v_mfma_f32_16x16x32_bf16 v[188:191], a[184:187], v[60:63], v[188:191]
 s_add_u32 s45, s45, 0x80
 v_mfma_f32_16x16x32_bf16 v[220:223], a[188:191], v[60:63], v[220:223]
 s_sub_u32 s56, s45, 0x380
 ds_read_b64_tr_b16 a[180:181], v11 offset:64
 ds_read_b64_tr_b16 a[182:183], v11 offset:8512
 v_mfma_f32_16x16x32_bf16 v[212:215], a[188:191], v[56:59], v[212:215]
 s_waitcnt lgkmcnt(9)
 v_mfma_f32_16x16x32_bf16 v[96:99], a[160:163], v[44:47], v[96:99]
 s_min_u32 s45, s45, s56
 ds_read_b64_tr_b16 a[184:185], v10 offset:96
 ds_read_b64_tr_b16 a[186:187], v10 offset:8544
 s_waitcnt lgkmcnt(10)
 v_mfma_f32_16x16x32_bf16 v[224:227], a[160:163], v[52:55], v[224:227]
 s_add_u32 m0, s40, 0x1ea00
 ds_read_b128 v[56:59], v13 offset:20480
 v_mfma_f32_16x16x32_bf16 v[104:107], a[160:163], v[48:51], v[104:107]
 s_add_u32 s56, s44, 0
 buffer_load_dwordx4 v17, s[12:15], s56 offen offset:0 lds
 v_mfma_f32_16x16x32_bf16 v[136:139], a[164:167], v[48:51], v[136:139]
 s_add_u32 s56, s44, 0x1be0
 ds_read_b64_tr_b16 a[188:189], v11 offset:96
 ds_read_b64_tr_b16 a[190:191], v11 offset:8544
 v_mfma_f32_16x16x32_bf16 v[128:131], a[164:167], v[44:47], v[128:131]
 s_waitcnt lgkmcnt(9)
 buffer_load_dwordx4 v17, s[12:15], s56 offen offset:1056 lds
 v_mfma_f32_16x16x32_bf16 v[100:103], a[168:171], v[44:47], v[100:103]
 ds_read_b64_tr_b16 a[160:161], v10 offset:256
 ds_read_b64_tr_b16 a[162:163], v10 offset:8704
 v_mfma_f32_16x16x32_bf16 v[228:231], a[168:171], v[52:55], v[228:231]
 ds_read_b128 v[60:63], v13 offset:22528
 v_mfma_f32_16x16x32_bf16 v[108:111], a[168:171], v[48:51], v[108:111]
 v_mfma_f32_16x16x32_bf16 v[140:143], a[172:175], v[48:51], v[140:143]
 ds_read_b64_tr_b16 a[164:165], v11 offset:256
 ds_read_b64_tr_b16 a[166:167], v11 offset:8704
 v_mfma_f32_16x16x32_bf16 v[132:135], a[172:175], v[44:47], v[132:135]
 s_waitcnt lgkmcnt(10)
 v_mfma_f32_16x16x32_bf16 v[112:115], a[176:179], v[44:47], v[112:115]
 s_add_u32 s56, s44, 0x37c0
 ds_read_b64_tr_b16 a[168:169], v10 offset:288
 ds_read_b64_tr_b16 a[170:171], v10 offset:8736
 v_mfma_f32_16x16x32_bf16 v[232:235], a[176:179], v[52:55], v[232:235]
 ds_read_b128 v[64:67], v15 offset:20480
 buffer_load_dwordx4 v17, s[12:15], s56 offen offset:2112 lds
 v_mfma_f32_16x16x32_bf16 v[120:123], a[176:179], v[48:51], v[120:123]
 v_mfma_f32_16x16x32_bf16 v[152:155], a[180:183], v[48:51], v[152:155]
 ds_read_b64_tr_b16 a[172:173], v11 offset:288
 ds_read_b64_tr_b16 a[174:175], v11 offset:8736
 v_mfma_f32_16x16x32_bf16 v[144:147], a[180:183], v[44:47], v[144:147]
 s_waitcnt lgkmcnt(10)
 v_mfma_f32_16x16x32_bf16 v[116:119], a[184:187], v[44:47], v[116:119]
 s_add_u32 s56, s44, 0x53a0
 ds_read_b64_tr_b16 a[176:177], v10 offset:320
 ds_read_b64_tr_b16 a[178:179], v10 offset:8768
 v_mfma_f32_16x16x32_bf16 v[236:239], a[184:187], v[52:55], v[236:239]
 buffer_load_dwordx4 v17, s[12:15], s56 offen offset:3168 lds
 v_mfma_f32_16x16x32_bf16 v[124:127], a[184:187], v[48:51], v[124:127]
 v_mfma_f32_16x16x32_bf16 v[156:159], a[188:191], v[48:51], v[156:159]
 ds_read_b64_tr_b16 a[180:181], v11 offset:320
 ds_read_b64_tr_b16 a[182:183], v11 offset:8768
 v_mfma_f32_16x16x32_bf16 v[148:151], a[188:191], v[44:47], v[148:151]
 s_waitcnt lgkmcnt(9)
 v_mfma_f32_16x16x32_bf16 v[160:163], a[160:163], v[44:47], v[160:163]
 ds_read_b64_tr_b16 a[184:185], v10 offset:352
 ds_read_b64_tr_b16 a[186:187], v10 offset:8800
 v_mfma_f32_16x16x32_bf16 v[240:243], a[160:163], v[52:55], v[240:243]
 v_mfma_f32_16x16x32_bf16 v[168:171], a[160:163], v[48:51], v[168:171]
 v_mfma_f32_16x16x32_bf16 v[200:203], a[164:167], v[48:51], v[200:203]
 ds_read_b64_tr_b16 a[188:189], v11 offset:352
 ds_read_b64_tr_b16 a[190:191], v11 offset:8800
 v_mfma_f32_16x16x32_bf16 v[192:195], a[164:167], v[44:47], v[192:195]
 s_waitcnt lgkmcnt(8)
 v_mfma_f32_16x16x32_bf16 v[164:167], a[168:171], v[44:47], v[164:167]
 s_waitcnt vmcnt(9)
 s_barrier
 ds_read_b64_tr_b16 a[160:161], v10 offset:16896
 ds_read_b64_tr_b16 a[162:163], v10 offset:25344
 v_mfma_f32_16x16x32_bf16 v[244:247], a[168:171], v[52:55], v[244:247]
 s_add_u32 m0, s40, 0x22c00
 v_mfma_f32_16x16x32_bf16 v[172:175], a[168:171], v[48:51], v[172:175]
 s_add_u32 s56, s44, 0x40000
 buffer_load_dwordx4 v17, s[12:15], s56 offen offset:0 lds
 v_mfma_f32_16x16x32_bf16 v[204:207], a[172:175], v[48:51], v[204:207]
 ds_read_b64_tr_b16 a[164:165], v11 offset:16896
 ds_read_b64_tr_b16 a[166:167], v11 offset:25344
 v_mfma_f32_16x16x32_bf16 v[196:199], a[172:175], v[44:47], v[196:199]
 s_waitcnt lgkmcnt(8)
 v_mfma_f32_16x16x32_bf16 v[176:179], a[176:179], v[44:47], v[176:179]
 ds_read_b64_tr_b16 a[168:169], v10 offset:16928
 ds_read_b64_tr_b16 a[170:171], v10 offset:25376
 v_mfma_f32_16x16x32_bf16 v[248:251], a[176:179], v[52:55], v[248:251]
 s_add_u32 s56, s44, 0x41be0
 buffer_load_dwordx4 v17, s[12:15], s56 offen offset:1056 lds
 v_mfma_f32_16x16x32_bf16 v[184:187], a[176:179], v[48:51], v[184:187]
 v_mfma_f32_16x16x32_bf16 v[216:219], a[180:183], v[48:51], v[216:219]
 ds_read_b64_tr_b16 a[172:173], v11 offset:16928
 ds_read_b64_tr_b16 a[174:175], v11 offset:25376
 v_mfma_f32_16x16x32_bf16 v[208:211], a[180:183], v[44:47], v[208:211]
 s_waitcnt lgkmcnt(8)
 v_mfma_f32_16x16x32_bf16 v[180:183], a[184:187], v[44:47], v[180:183]
 ds_read_b64_tr_b16 a[176:177], v10 offset:16960
 ds_read_b64_tr_b16 a[178:179], v10 offset:25408
 v_mfma_f32_16x16x32_bf16 v[252:255], a[184:187], v[52:55], v[252:255]
 s_add_u32 s56, s44, 0x437c0
 buffer_load_dwordx4 v17, s[12:15], s56 offen offset:2112 lds
 v_mfma_f32_16x16x32_bf16 v[188:191], a[184:187], v[48:51], v[188:191]
 v_mfma_f32_16x16x32_bf16 v[220:223], a[188:191], v[48:51], v[220:223]
 ds_read_b64_tr_b16 a[180:181], v11 offset:16960
 ds_read_b64_tr_b16 a[182:183], v11 offset:25408
 v_mfma_f32_16x16x32_bf16 v[212:215], a[188:191], v[44:47], v[212:215]
 s_waitcnt lgkmcnt(8)
 v_mfma_f32_16x16x32_bf16 v[96:99], a[160:163], v[56:59], v[96:99]
 ds_read_b64_tr_b16 a[184:185], v10 offset:16992
 ds_read_b64_tr_b16 a[186:187], v10 offset:25440
 v_mfma_f32_16x16x32_bf16 v[224:227], a[160:163], v[64:67], v[224:227]
 s_add_u32 s56, s44, 0x453a0
 buffer_load_dwordx4 v17, s[12:15], s56 offen offset:3168 lds
 v_mfma_f32_16x16x32_bf16 v[104:107], a[160:163], v[60:63], v[104:107]
 v_mfma_f32_16x16x32_bf16 v[136:139], a[164:167], v[60:63], v[136:139]
 ds_read_b64_tr_b16 a[188:189], v11 offset:16992
 ds_read_b64_tr_b16 a[190:191], v11 offset:25440
 v_mfma_f32_16x16x32_bf16 v[128:131], a[164:167], v[56:59], v[128:131]
 s_waitcnt lgkmcnt(8)
 v_mfma_f32_16x16x32_bf16 v[100:103], a[168:171], v[56:59], v[100:103]
 ds_read_b64_tr_b16 a[160:161], v10 offset:17152
 ds_read_b64_tr_b16 a[162:163], v10 offset:25600
 v_mfma_f32_16x16x32_bf16 v[228:231], a[168:171], v[64:67], v[228:231]
 s_add_u32 s44, s44, 0x80000
 v_mfma_f32_16x16x32_bf16 v[108:111], a[168:171], v[60:63], v[108:111]
 s_sub_u32 s56, s44, 0x380000
 v_mfma_f32_16x16x32_bf16 v[140:143], a[172:175], v[60:63], v[140:143]
 s_min_u32 s44, s44, s56
 ds_read_b64_tr_b16 a[164:165], v11 offset:17152
 ds_read_b64_tr_b16 a[166:167], v11 offset:25600
 v_mfma_f32_16x16x32_bf16 v[132:135], a[172:175], v[56:59], v[132:135]
 s_waitcnt lgkmcnt(8)
 v_mfma_f32_16x16x32_bf16 v[112:115], a[176:179], v[56:59], v[112:115]
 s_add_u32 m0, s41, 0x11600
 ds_read_b64_tr_b16 a[168:169], v10 offset:17184
 ds_read_b64_tr_b16 a[170:171], v10 offset:25632
 v_mfma_f32_16x16x32_bf16 v[232:235], a[176:179], v[64:67], v[232:235]
 s_add_u32 s56, s45, 0
 buffer_load_dwordx4 v18, s[8:11], s56 offen offset:0 lds
 v_mfma_f32_16x16x32_bf16 v[120:123], a[176:179], v[60:63], v[120:123]
 s_add_u32 m0, s41, 0x12600
 v_mfma_f32_16x16x32_bf16 v[152:155], a[180:183], v[60:63], v[152:155]
 s_add_u32 s56, s45, 0x7000
 ds_read_b64_tr_b16 a[172:173], v11 offset:17184
 ds_read_b64_tr_b16 a[174:175], v11 offset:25632
 v_mfma_f32_16x16x32_bf16 v[144:147], a[180:183], v[56:59], v[144:147]
 s_waitcnt lgkmcnt(8)
 buffer_load_dwordx4 v18, s[8:11], s56 offen offset:0 lds
 v_mfma_f32_16x16x32_bf16 v[116:119], a[184:187], v[56:59], v[116:119]
 ds_read_b64_tr_b16 a[176:177], v10 offset:17216
 ds_read_b64_tr_b16 a[178:179], v10 offset:25664
 v_mfma_f32_16x16x32_bf16 v[236:239], a[184:187], v[64:67], v[236:239]
 s_add_u32 m0, s41, 0x13600
 v_mfma_f32_16x16x32_bf16 v[124:127], a[184:187], v[60:63], v[124:127]
 s_add_u32 s56, s45, 0xe000
 buffer_load_dwordx4 v18, s[8:11], s56 offen offset:0 lds
 v_mfma_f32_16x16x32_bf16 v[156:159], a[188:191], v[60:63], v[156:159]
 ds_read_b64_tr_b16 a[180:181], v11 offset:17216
 ds_read_b64_tr_b16 a[182:183], v11 offset:25664
 v_mfma_f32_16x16x32_bf16 v[148:151], a[188:191], v[56:59], v[148:151]
 s_waitcnt lgkmcnt(8)
 v_mfma_f32_16x16x32_bf16 v[160:163], a[160:163], v[56:59], v[160:163]
 ds_read_b64_tr_b16 a[184:185], v10 offset:17248
 ds_read_b64_tr_b16 a[186:187], v10 offset:25696
 v_mfma_f32_16x16x32_bf16 v[240:243], a[160:163], v[64:67], v[240:243]
 v_mfma_f32_16x16x32_bf16 v[168:171], a[160:163], v[60:63], v[168:171]
 v_mfma_f32_16x16x32_bf16 v[200:203], a[164:167], v[60:63], v[200:203]
 ds_read_b64_tr_b16 a[188:189], v11 offset:17248
 ds_read_b64_tr_b16 a[190:191], v11 offset:25696
 v_mfma_f32_16x16x32_bf16 v[192:195], a[164:167], v[56:59], v[192:195]
 s_waitcnt lgkmcnt(8)
 v_mfma_f32_16x16x32_bf16 v[164:167], a[168:171], v[56:59], v[164:167]
 s_waitcnt vmcnt(7)
 s_barrier
 ds_read_b64_tr_b16 a[160:161], v10 offset:33792
 ds_read_b64_tr_b16 a[162:163], v10 offset:42240
 v_mfma_f32_16x16x32_bf16 v[244:247], a[168:171], v[64:67], v[244:247]
 s_add_u32 m0, s41, 0x14600
 ds_read_b128 v[44:47], v12 offset:0
 v_mfma_f32_16x16x32_bf16 v[172:175], a[168:171], v[60:63], v[172:175]
 s_add_u32 s56, s45, 0x15000
 ds_read_b128 v[48:51], v12 offset:2048
 buffer_load_dwordx4 v18, s[8:11], s56 offen offset:0 lds
 v_mfma_f32_16x16x32_bf16 v[204:207], a[172:175], v[60:63], v[204:207]
 ds_read_b64_tr_b16 a[164:165], v11 offset:33792
 ds_read_b64_tr_b16 a[166:167], v11 offset:42240
 v_mfma_f32_16x16x32_bf16 v[196:199], a[172:175], v[56:59], v[196:199]
 s_waitcnt lgkmcnt(10)
 ds_read_b128 v[52:55], v14 offset:0
 v_mfma_f32_16x16x32_bf16 v[176:179], a[176:179], v[56:59], v[176:179]
 ds_read_b64_tr_b16 a[168:169], v10 offset:33824
 ds_read_b64_tr_b16 a[170:171], v10 offset:42272
 v_mfma_f32_16x16x32_bf16 v[248:251], a[176:179], v[64:67], v[248:251]
 s_add_u32 m0, s41, 0x15600
 v_mfma_f32_16x16x32_bf16 v[184:187], a[176:179], v[60:63], v[184:187]
 s_add_u32 s56, s45, 0x1c000
 buffer_load_dwordx4 v18, s[8:11], s56 offen offset:0 lds
 v_mfma_f32_16x16x32_bf16 v[216:219], a[180:183], v[60:63], v[216:219]
 ds_read_b64_tr_b16 a[172:173], v11 offset:33824
 ds_read_b64_tr_b16 a[174:175], v11 offset:42272
 v_mfma_f32_16x16x32_bf16 v[208:211], a[180:183], v[56:59], v[208:211]
 s_waitcnt lgkmcnt(11)
 v_mfma_f32_16x16x32_bf16 v[180:183], a[184:187], v[56:59], v[180:183]
 ds_read_b64_tr_b16 a[176:177], v10 offset:33856
 ds_read_b64_tr_b16 a[178:179], v10 offset:42304
 v_mfma_f32_16x16x32_bf16 v[252:255], a[184:187], v[64:67], v[252:255]
 v_mfma_f32_16x16x32_bf16 v[188:191], a[184:187], v[60:63], v[188:191]
 s_add_u32 s45, s45, 0x80
 v_mfma_f32_16x16x32_bf16 v[220:223], a[188:191], v[60:63], v[220:223]
 s_sub_u32 s56, s45, 0x380
 ds_read_b64_tr_b16 a[180:181], v11 offset:33856
 ds_read_b64_tr_b16 a[182:183], v11 offset:42304
 v_mfma_f32_16x16x32_bf16 v[212:215], a[188:191], v[56:59], v[212:215]
 s_waitcnt lgkmcnt(9)
 v_mfma_f32_16x16x32_bf16 v[96:99], a[160:163], v[44:47], v[96:99]
 s_min_u32 s45, s45, s56
 ds_read_b64_tr_b16 a[184:185], v10 offset:33888
 ds_read_b64_tr_b16 a[186:187], v10 offset:42336
 s_waitcnt lgkmcnt(10)
 v_mfma_f32_16x16x32_bf16 v[224:227], a[160:163], v[52:55], v[224:227]
 s_add_u32 m0, s40, 0x16600
 ds_read_b128 v[56:59], v13 offset:0
 v_mfma_f32_16x16x32_bf16 v[104:107], a[160:163], v[48:51], v[104:107]
 s_add_u32 s56, s44, 0
 buffer_load_dwordx4 v17, s[12:15], s56 offen offset:0 lds
 v_mfma_f32_16x16x32_bf16 v[136:139], a[164:167], v[48:51], v[136:139]
 s_add_u32 s56, s44, 0x1be0
 ds_read_b64_tr_b16 a[188:189], v11 offset:33888
 ds_read_b64_tr_b16 a[190:191], v11 offset:42336
 v_mfma_f32_16x16x32_bf16 v[128:131], a[164:167], v[44:47], v[128:131]
 s_waitcnt lgkmcnt(9)
 buffer_load_dwordx4 v17, s[12:15], s56 offen offset:1056 lds
 v_mfma_f32_16x16x32_bf16 v[100:103], a[168:171], v[44:47], v[100:103]
 ds_read_b64_tr_b16 a[160:161], v10 offset:34048
 ds_read_b64_tr_b16 a[162:163], v10 offset:42496
 v_mfma_f32_16x16x32_bf16 v[228:231], a[168:171], v[52:55], v[228:231]
 ds_read_b128 v[60:63], v13 offset:2048
 v_mfma_f32_16x16x32_bf16 v[108:111], a[168:171], v[48:51], v[108:111]
 v_mfma_f32_16x16x32_bf16 v[140:143], a[172:175], v[48:51], v[140:143]
 ds_read_b64_tr_b16 a[164:165], v11 offset:34048
 ds_read_b64_tr_b16 a[166:167], v11 offset:42496
 v_mfma_f32_16x16x32_bf16 v[132:135], a[172:175], v[44:47], v[132:135]
 s_waitcnt lgkmcnt(10)
 v_mfma_f32_16x16x32_bf16 v[112:115], a[176:179], v[44:47], v[112:115]
 s_add_u32 s56, s44, 0x37c0
 ds_read_b64_tr_b16 a[168:169], v10 offset:34080
 ds_read_b64_tr_b16 a[170:171], v10 offset:42528
 v_mfma_f32_16x16x32_bf16 v[232:235], a[176:179], v[52:55], v[232:235]
 ds_read_b128 v[64:67], v15 offset:0
 buffer_load_dwordx4 v17, s[12:15], s56 offen offset:2112 lds
 v_mfma_f32_16x16x32_bf16 v[120:123], a[176:179], v[48:51], v[120:123]
L_pad2:
 s_cbranch_execz L_e0_back
 v_mfma_f32_16x16x32_bf16 v[152:155], a[180:183], v[48:51], v[152:155]
 ds_read_b64_tr_b16 a[172:173], v11 offset:34080
 ds_read_b64_tr_b16 a[174:175], v11 offset:42528
 v_mfma_f32_16x16x32_bf16 v[144:147], a[180:183], v[44:47], v[144:147]
 s_waitcnt lgkmcnt(10)
 v_mfma_f32_16x16x32_bf16 v[116:119], a[184:187], v[44:47], v[116:119]
 s_add_u32 s56, s44, 0x53a0
 ds_read_b64_tr_b16 a[176:177], v10 offset:34112
 ds_read_b64_tr_b16 a[178:179], v10 offset:42560
 v_mfma_f32_16x16x32_bf16 v[236:239], a[184:187], v[52:55], v[236:239]
 buffer_load_dwordx4 v17, s[12:15], s56 offen offset:3168 lds
 v_mfma_f32_16x16x32_bf16 v[124:127], a[184:187], v[48:51], v[124:127]
 v_mfma_f32_16x16x32_bf16 v[156:159], a[188:191], v[48:51], v[156:159]
 ds_read_b64_tr_b16 a[180:181], v11 offset:34112
 ds_read_b64_tr_b16 a[182:183], v11 offset:42560
 v_mfma_f32_16x16x32_bf16 v[148:151], a[188:191], v[44:47], v[148:151]
 s_waitcnt lgkmcnt(9)
 v_mfma_f32_16x16x32_bf16 v[160:163], a[160:163], v[44:47], v[160:163]
 ds_read_b64_tr_b16 a[184:185], v10 offset:34144
 ds_read_b64_tr_b16 a[186:187], v10 offset:42592
 v_mfma_f32_16x16x32_bf16 v[240:243], a[160:163], v[52:55], v[240:243]
 v_mfma_f32_16x16x32_bf16 v[168:171], a[160:163], v[48:51], v[168:171]
 v_mfma_f32_16x16x32_bf16 v[200:203], a[164:167], v[48:51], v[200:203]
 ds_read_b64_tr_b16 a[188:189], v11 offset:34144
 ds_read_b64_tr_b16 a[190:191], v11 offset:42592
 v_mfma_f32_16x16x32_bf16 v[192:195], a[164:167], v[44:47], v[192:195]
 s_waitcnt lgkmcnt(8)
 v_mfma_f32_16x16x32_bf16 v[164:167], a[168:171], v[44:47], v[164:167]
 s_waitcnt vmcnt(9)
 s_barrier
 ds_read_b64_tr_b16 a[160:161], v10 offset:50688
 ds_read_b64_tr_b16 a[162:163], v10 offset:59136
 v_mfma_f32_16x16x32_bf16 v[244:247], a[168:171], v[52:55], v[244:247]
 s_add_u32 m0, s40, 0x1a800
 v_mfma_f32_16x16x32_bf16 v[172:175], a[168:171], v[48:51], v[172:175]
 s_add_u32 s56, s44, 0x40000
 buffer_load_dwordx4 v17, s[12:15], s56 offen offset:0 lds
 v_mfma_f32_16x16x32_bf16 v[204:207], a[172:175], v[48:51], v[204:207]
 ds_read_b64_tr_b16 a[164:165], v11 offset:50688
 ds_read_b64_tr_b16 a[166:167], v11 offset:59136
 v_mfma_f32_16x16x32_bf16 v[196:199], a[172:175], v[44:47], v[196:199]
 s_waitcnt lgkmcnt(8)
 v_mfma_f32_16x16x32_bf16 v[176:179], a[176:179], v[44:47], v[176:179]
 s_add_u32 s56, s44, 0x41be0
 ds_read_b64_tr_b16 a[168:169], v10 offset:50720
 ds_read_b64_tr_b16 a[170:171], v10 offset:59168
 v_mfma_f32_16x16x32_bf16 v[248:251], a[176:179], v[52:55], v[248:251]
 buffer_load_dwordx4 v17, s[12:15], s56 offen offset:1056 lds
 v_mfma_f32_16x16x32_bf16 v[184:187], a[176:179], v[48:51], v[184:187]
 v_mfma_f32_16x16x32_bf16 v[216:219], a[180:183], v[48:51], v[216:219]
 ds_read_b64_tr_b16 a[172:173], v11 offset:50720
 ds_read_b64_tr_b16 a[174:175], v11 offset:59168
 v_mfma_f32_16x16x32_bf16 v[208:211], a[180:183], v[44:47], v[208:211]
 s_waitcnt lgkmcnt(8)
 v_mfma_f32_16x16x32_bf16 v[180:183], a[184:187], v[44:47], v[180:183]
 s_add_u32 s56, s44, 0x437c0
 ds_read_b64_tr_b16 a[176:177], v10 offset:50752
 ds_read_b64_tr_b16 a[178:179], v10 offset:59200
 v_mfma_f32_16x16x32_bf16 v[252:255], a[184:187], v[52:55], v[252:255]
 buffer_load_dwordx4 v17, s[12:15], s56 offen offset:2112 lds
 v_mfma_f32_16x16x32_bf16 v[188:191], a[184:187], v[48:51], v[188:191]
 v_mfma_f32_16x16x32_bf16 v[220:223], a[188:191], v[48:51], v[220:223]
 ds_read_b64_tr_b16 a[180:181], v11 offset:50752
 ds_read_b64_tr_b16 a[182:183], v11 offset:59200
 v_mfma_f32_16x16x32_bf16 v[212:215], a[188:191], v[44:47], v[212:215]
 s_waitcnt lgkmcnt(8)
 v_mfma_f32_16x16x32_bf16 v[96:99], a[160:163], v[56:59], v[96:99]
 s_add_u32 s56, s44, 0x453a0
 ds_read_b64_tr_b16 a[184:185], v10 offset:50784
 ds_read_b64_tr_b16 a[186:187], v10 offset:59232
 v_mfma_f32_16x16x32_bf16 v[224:227], a[160:163], v[64:67], v[224:227]
 buffer_load_dwordx4 v17, s[12:15], s56 offen offset:3168 lds
 v_mfma_f32_16x16x32_bf16 v[104:107], a[160:163], v[60:63], v[104:107]
 v_mfma_f32_16x16x32_bf16 v[136:139], a[164:167], v[60:63], v[136:139]
 s_add_u32 s44, s44, 0x80000
 ds_read_b64_tr_b16 a[188:189], v11 offset:50784
 ds_read_b64_tr_b16 a[190:191], v11 offset:59232
 v_mfma_f32_16x16x32_bf16 v[128:131], a[164:167], v[56:59], v[128:131]
 s_waitcnt lgkmcnt(8)
 v_mfma_f32_16x16x32_bf16 v[100:103], a[168:171], v[56:59], v[100:103]
 s_sub_u32 s56, s44, 0x380000
 ds_read_b64_tr_b16 a[160:161], v10 offset:50944
 ds_read_b64_tr_b16 a[162:163], v10 offset:59392
 v_mfma_f32_16x16x32_bf16 v[228:231], a[168:171], v[64:67], v[228:231]
 s_min_u32 s44, s44, s56
 v_mfma_f32_16x16x32_bf16 v[108:111], a[168:171], v[60:63], v[108:111]
 s_add_u32 s44, s44, 0x1000
 v_mfma_f32_16x16x32_bf16 v[140:143], a[172:175], v[60:63], v[140:143]
 s_and_b32 s44, s44, 0x7ffff
 ds_read_b64_tr_b16 a[164:165], v11 offset:50944
 ds_read_b64_tr_b16 a[166:167], v11 offset:59392
 v_mfma_f32_16x16x32_bf16 v[132:135], a[172:175], v[56:59], v[132:135]
 s_waitcnt lgkmcnt(8)
 v_mfma_f32_16x16x32_bf16 v[112:115], a[176:179], v[56:59], v[112:115]
 s_add_u32 s56, s58, s59
 ds_read_b64_tr_b16 a[168:169], v10 offset:50976
 ds_read_b64_tr_b16 a[170:171], v10 offset:59424
 v_mfma_f32_16x16x32_bf16 v[232:235], a[176:179], v[64:67], v[232:235]
 s_mul_i32 s47, s56, 0x56
 v_mfma_f32_16x16x32_bf16 v[120:123], a[176:179], v[60:63], v[120:123]
 s_lshr_b32 s47, s47, 8
 v_mfma_f32_16x16x32_bf16 v[152:155], a[180:183], v[60:63], v[152:155]
 s_mul_i32 s47, s47, 3
 ds_read_b64_tr_b16 a[172:173], v11 offset:50976
 ds_read_b64_tr_b16 a[174:175], v11 offset:59424
 v_mfma_f32_16x16x32_bf16 v[144:147], a[180:183], v[56:59], v[144:147]
 s_waitcnt lgkmcnt(8)
 v_mfma_f32_16x16x32_bf16 v[116:119], a[184:187], v[56:59], v[116:119]
 s_sub_u32 s47, s56, s47
 ds_read_b64_tr_b16 a[176:177], v10 offset:51008
 ds_read_b64_tr_b16 a[178:179], v10 offset:59456
 v_mfma_f32_16x16x32_bf16 v[236:239], a[184:187], v[64:67], v[236:239]
 s_lshl_b32 s47, s47, 2
 v_mfma_f32_16x16x32_bf16 v[124:127], a[184:187], v[60:63], v[124:127]
 s_lshr_b32 s45, 0x520, s47
 v_mfma_f32_16x16x32_bf16 v[156:159], a[188:191], v[60:63], v[156:159]
 s_and_b32 s45, s45, 7
 ds_read_b64_tr_b16 a[180:181], v11 offset:51008
 ds_read_b64_tr_b16 a[182:183], v11 offset:59456
 v_mfma_f32_16x16x32_bf16 v[148:151], a[188:191], v[56:59], v[148:151]
 s_waitcnt lgkmcnt(8)
 v_mfma_f32_16x16x32_bf16 v[160:163], a[160:163], v[56:59], v[160:163]
 s_lshl_b32 s45, s45, 7
 ds_read_b64_tr_b16 a[184:185], v10 offset:51040
 ds_read_b64_tr_b16 a[186:187], v10 offset:59488
 v_mfma_f32_16x16x32_bf16 v[240:243], a[160:163], v[64:67], v[240:243]
 s_lshl_b32 s56, s45, 12
 v_mfma_f32_16x16x32_bf16 v[168:171], a[160:163], v[60:63], v[168:171]
 s_add_u32 s44, s44, s56
 v_mfma_f32_16x16x32_bf16 v[200:203], a[164:167], v[60:63], v[200:203]
 s_xor_b32 s56, s42, 0xc000
 ds_read_b64_tr_b16 a[188:189], v11 offset:51040
 ds_read_b64_tr_b16 a[190:191], v11 offset:59488
 v_mfma_f32_16x16x32_bf16 v[192:195], a[164:167], v[56:59], v[192:195]
 s_waitcnt lgkmcnt(8)
 s_add_u32 m0, s40, 0xc600
 s_nop 0
 buffer_load_dwordx4 v16, s[16:19], s56 offen offset:0 nt lds
 s_add_u32 m0, s40, 0xc820
 s_nop 0
 buffer_load_dwordx4 v16, s[16:19], s56 offen offset:512 nt lds
 s_add_u32 m0, s40, 0xca40
 s_nop 0
 buffer_load_dwordx4 v16, s[16:19], s56 offen offset:1024 nt lds
 s_add_u32 m0, s40, 0xcc60
 s_nop 0
 buffer_load_dwordx4 v16, s[16:19], s56 offen offset:1536 nt lds
 v_mfma_f32_16x16x32_bf16 v[164:167], a[168:171], v[56:59], v[164:167]
 s_waitcnt vmcnt(8)
 s_barrier
 ds_read_b64_tr_b16 a[160:161], v10 offset:0
 ds_read_b64_tr_b16 a[162:163], v10 offset:8448
 v_mfma_f32_16x16x32_bf16 v[244:247], a[168:171], v[64:67], v[244:247]
 s_xor_b32 s56, s43, 0x8000
 ds_read_b128 v[44:47], v12 offset:20480
 v_mov_b32 v29, 1
 v_mfma_f32_16x16x32_bf16 v[172:175], a[168:171], v[60:63], v[172:175]
 s_add_u32 m0, s40, 0x1ea00
 ds_read_b128 v[48:51], v12 offset:22528
 buffer_atomic_add v29, v27, s[84:87], s55 offen
 v_mfma_f32_16x16x32_bf16 v[204:207], a[172:175], v[60:63], v[204:207]
 ds_read_b64_tr_b16 a[164:165], v11 offset:0
 ds_read_b64_tr_b16 a[166:167], v11 offset:8448
 v_mfma_f32_16x16x32_bf16 v[196:199], a[172:175], v[56:59], v[196:199]
 s_waitcnt lgkmcnt(10)
 ds_read_b128 v[52:55], v14 offset:20480
 buffer_load_dwordx4 v16, s[20:23], s56 offen offset:0 nt lds
 v_mfma_f32_16x16x32_bf16 v[176:179], a[176:179], v[56:59], v[176:179]
 ds_read_b64_tr_b16 a[168:169], v10 offset:32
 ds_read_b64_tr_b16 a[170:171], v10 offset:8480
 v_mfma_f32_16x16x32_bf16 v[248:251], a[176:179], v[64:67], v[248:251]
 v_mfma_f32_16x16x32_bf16 v[184:187], a[176:179], v[60:63], v[184:187]
 v_mfma_f32_16x16x32_bf16 v[216:219], a[180:183], v[60:63], v[216:219]
 ds_read_b64_tr_b16 a[172:173], v11 offset:32
 ds_read_b64_tr_b16 a[174:175], v11 offset:8480
 v_mfma_f32_16x16x32_bf16 v[208:211], a[180:183], v[56:59], v[208:211]
 s_waitcnt lgkmcnt(11)
 v_mfma_f32_16x16x32_bf16 v[180:183], a[184:187], v[56:59], v[180:183]
 s_add_u32 m0, s40, 0x1ec20
 ds_read_b64_tr_b16 a[176:177], v10 offset:64
 ds_read_b64_tr_b16 a[178:179], v10 offset:8512
 v_mfma_f32_16x16x32_bf16 v[252:255], a[184:187], v[64:67], v[252:255]
 buffer_load_dwordx4 v16, s[20:23], s56 offen offset:512 nt lds
 v_mfma_f32_16x16x32_bf16 v[188:191], a[184:187], v[60:63], v[188:191]
 v_mfma_f32_16x16x32_bf16 v[220:223], a[188:191], v[60:63], v[220:223]
 ds_read_b64_tr_b16 a[180:181], v11 offset:64
 ds_read_b64_tr_b16 a[182:183], v11 offset:8512
 v_mfma_f32_16x16x32_bf16 v[212:215], a[188:191], v[56:59], v[212:215]
 s_waitcnt lgkmcnt(9)
 v_mfma_f32_16x16x32_bf16 v[96:99], a[160:163], v[44:47], v[96:99]
 ds_read_b64_tr_b16 a[184:185], v10 offset:96
 ds_read_b64_tr_b16 a[186:187], v10 offset:8544
 s_waitcnt lgkmcnt(10)
 v_mfma_f32_16x16x32_bf16 v[224:227], a[160:163], v[52:55], v[224:227]
 ds_read_b128 v[56:59], v13 offset:20480
 v_mfma_f32_16x16x32_bf16 v[104:107], a[160:163], v[48:51], v[104:107]
 v_mfma_f32_16x16x32_bf16 v[136:139], a[164:167], v[48:51], v[136:139]
 s_add_u32 m0, s40, 0x1ee40
 ds_read_b64_tr_b16 a[188:189], v11 offset:96
 ds_read_b64_tr_b16 a[190:191], v11 offset:8544
 v_mfma_f32_16x16x32_bf16 v[128:131], a[164:167], v[44:47], v[128:131]
 s_waitcnt lgkmcnt(9)
 buffer_load_dwordx4 v16, s[20:23], s56 offen offset:1024 nt lds
 v_mfma_f32_16x16x32_bf16 v[100:103], a[168:171], v[44:47], v[100:103]
 ds_read_b64_tr_b16 a[160:161], v10 offset:256
 ds_read_b64_tr_b16 a[162:163], v10 offset:8704
 v_mfma_f32_16x16x32_bf16 v[228:231], a[168:171], v[52:55], v[228:231]
 ds_read_b128 v[60:63], v13 offset:22528
 v_mfma_f32_16x16x32_bf16 v[108:111], a[168:171], v[48:51], v[108:111]
 v_mfma_f32_16x16x32_bf16 v[140:143], a[172:175], v[48:51], v[140:143]
 ds_read_b64_tr_b16 a[164:165], v11 offset:256
 ds_read_b64_tr_b16 a[166:167], v11 offset:8704
 v_mfma_f32_16x16x32_bf16 v[132:135], a[172:175], v[44:47], v[132:135]
 s_waitcnt lgkmcnt(10)
 v_mfma_f32_16x16x32_bf16 v[112:115], a[176:179], v[44:47], v[112:115]
 ds_read_b64_tr_b16 a[168:169], v10 offset:288
 ds_read_b64_tr_b16 a[170:171], v10 offset:8736
 v_mfma_f32_16x16x32_bf16 v[232:235], a[176:179], v[52:55], v[232:235]
 ds_read_b128 v[64:67], v15 offset:20480
 v_mfma_f32_16x16x32_bf16 v[120:123], a[176:179], v[48:51], v[120:123]
 s_add_u32 m0, s40, 0x1f060
 v_mfma_f32_16x16x32_bf16 v[152:155], a[180:183], v[48:51], v[152:155]
 ds_read_b64_tr_b16 a[172:173], v11 offset:288
 ds_read_b64_tr_b16 a[174:175], v11 offset:8736
 v_mfma_f32_16x16x32_bf16 v[144:147], a[180:183], v[44:47], v[144:147]
 s_waitcnt lgkmcnt(10)
 buffer_load_dwordx4 v16, s[20:23], s56 offen offset:1536 nt lds
 v_mfma_f32_16x16x32_bf16 v[116:119], a[184:187], v[44:47], v[116:119]
 ds_read_b64_tr_b16 a[176:177], v10 offset:320
 ds_read_b64_tr_b16 a[178:179], v10 offset:8768
 v_mfma_f32_16x16x32_bf16 v[236:239], a[184:187], v[52:55], v[236:239]
 v_mfma_f32_16x16x32_bf16 v[124:127], a[184:187], v[48:51], v[124:127]
 v_mfma_f32_16x16x32_bf16 v[156:159], a[188:191], v[48:51], v[156:159]
 ds_read_b64_tr_b16 a[180:181], v11 offset:320
 ds_read_b64_tr_b16 a[182:183], v11 offset:8768
 v_mfma_f32_16x16x32_bf16 v[148:151], a[188:191], v[44:47], v[148:151]
 s_waitcnt lgkmcnt(9)
 v_mfma_f32_16x16x32_bf16 v[160:163], a[160:163], v[44:47], v[160:163]
 ds_read_b64_tr_b16 a[184:185], v10 offset:352
 ds_read_b64_tr_b16 a[186:187], v10 offset:8800
 v_mfma_f32_16x16x32_bf16 v[240:243], a[160:163], v[52:55], v[240:243]
 v_mfma_f32_16x16x32_bf16 v[168:171], a[160:163], v[48:51], v[168:171]
 v_mfma_f32_16x16x32_bf16 v[200:203], a[164:167], v[48:51], v[200:203]
 ds_read_b64_tr_b16 a[188:189], v11 offset:352
 ds_read_b64_tr_b16 a[190:191], v11 offset:8800
 v_mfma_f32_16x16x32_bf16 v[192:195], a[164:167], v[44:47], v[192:195]
 s_waitcnt lgkmcnt(8)
 v_mfma_f32_16x16x32_bf16 v[164:167], a[168:171], v[44:47], v[164:167]
 s_waitcnt vmcnt(9)
 s_barrier
 ds_read_b64_tr_b16 a[160:161], v10 offset:16896
 ds_read_b64_tr_b16 a[162:163], v10 offset:25344
 v_mfma_f32_16x16x32_bf16 v[244:247], a[168:171], v[52:55], v[244:247]
 s_xor_b32 s56, s43, 0xc000
 v_mfma_f32_16x16x32_bf16 v[172:175], a[168:171], v[48:51], v[172:175]
 s_add_u32 m0, s40, 0x22c00
 v_mfma_f32_16x16x32_bf16 v[204:207], a[172:175], v[48:51], v[204:207]
 ds_read_b64_tr_b16 a[164:165], v10 offset:16928
 ds_read_b64_tr_b16 a[166:167], v10 offset:25376
 v_mfma_f32_16x16x32_bf16 v[196:199], a[172:175], v[44:47], v[196:199]
 s_waitcnt lgkmcnt(8)
 buffer_load_dwordx4 v16, s[20:23], s56 offen offset:0 nt lds
 v_mfma_f32_16x16x32_bf16 v[176:179], a[176:179], v[44:47], v[176:179]
 ds_read_b64_tr_b16 a[168:169], v10 offset:16960
 ds_read_b64_tr_b16 a[170:171], v10 offset:25408
 v_mfma_f32_16x16x32_bf16 v[248:251], a[176:179], v[52:55], v[248:251]
 v_mfma_f32_16x16x32_bf16 v[184:187], a[176:179], v[48:51], v[184:187]
 v_mfma_f32_16x16x32_bf16 v[216:219], a[180:183], v[48:51], v[216:219]
 ds_read_b64_tr_b16 a[172:173], v10 offset:16992
 ds_read_b64_tr_b16 a[174:175], v10 offset:25440
 v_mfma_f32_16x16x32_bf16 v[208:211], a[180:183], v[44:47], v[208:211]
 s_waitcnt lgkmcnt(8)
 v_mfma_f32_16x16x32_bf16 v[180:183], a[184:187], v[44:47], v[180:183]
 s_add_u32 m0, s40, 0x22e20
 ds_read_b64_tr_b16 a[176:177], v10 offset:17152
 ds_read_b64_tr_b16 a[178:179], v10 offset:25600
 v_mfma_f32_16x16x32_bf16 v[252:255], a[184:187], v[52:55], v[252:255]
 buffer_load_dwordx4 v16, s[20:23], s56 offen offset:512 nt lds
 v_mfma_f32_16x16x32_bf16 v[188:191], a[184:187], v[48:51], v[188:191]
 v_mfma_f32_16x16x32_bf16 v[220:223], a[188:191], v[48:51], v[220:223]
 ds_read_b64_tr_b16 a[180:181], v10 offset:17184
 ds_read_b64_tr_b16 a[182:183], v10 offset:25632
 v_mfma_f32_16x16x32_bf16 v[212:215], a[188:191], v[44:47], v[212:215]
 s_waitcnt lgkmcnt(8)
 v_mfma_f32_16x16x32_bf16 v[96:99], a[160:163], v[56:59], v[96:99]
 ds_read_b64_tr_b16 a[184:185], v10 offset:17216
 ds_read_b64_tr_b16 a[186:187], v10 offset:25664
 v_mfma_f32_16x16x32_bf16 v[224:227], a[160:163], v[64:67], v[224:227]
 v_mfma_f32_16x16x32_bf16 v[104:107], a[160:163], v[60:63], v[104:107]
 v_mfma_f32_16x16x32_bf16 v[108:111], a[164:167], v[60:63], v[108:111]
 ds_read_b64_tr_b16 a[188:189], v10 offset:17248
 ds_read_b64_tr_b16 a[190:191], v10 offset:25696
 v_mfma_f32_16x16x32_bf16 v[228:231], a[164:167], v[64:67], v[228:231]
 v_mfma_f32_16x16x32_bf16 v[100:103], a[164:167], v[56:59], v[100:103]
 s_waitcnt lgkmcnt(8)
 v_mfma_f32_16x16x32_bf16 v[112:115], a[168:171], v[56:59], v[112:115]
 s_add_u32 m0, s40, 0x23040
 ds_read_b64_tr_b16 a[160:161], v11 offset:16896
 ds_read_b64_tr_b16 a[162:163], v11 offset:25344
 v_mfma_f32_16x16x32_bf16 v[232:235], a[168:171], v[64:67], v[232:235]
 buffer_load_dwordx4 v16, s[20:23], s56 offen offset:1024 nt lds
 v_mul_f32 v224, s6, v224
 v_mfma_f32_16x16x32_bf16 v[120:123], a[168:171], v[60:63], v[120:123]
 v_mul_f32 v225, s6, v225
 v_mul_f32 v226, s6, v226
 v_mfma_f32_16x16x32_bf16 v[124:127], a[172:175], v[60:63], v[124:127]
 ds_read_b64_tr_b16 a[164:165], v11 offset:16928
 ds_read_b64_tr_b16 a[166:167], v11 offset:25376
 v_mfma_f32_16x16x32_bf16 v[236:239], a[172:175], v[64:67], v[236:239]
 v_mul_f32 v227, s6, v227
 v_mul_f32 v228, s6, v228
 v_mfma_f32_16x16x32_bf16 v[116:119], a[172:175], v[56:59], v[116:119]
 s_waitcnt lgkmcnt(8)
 v_mul_f32 v229, s6, v229
 v_mul_f32 v230, s6, v230
 v_mfma_f32_16x16x32_bf16 v[160:163], a[176:179], v[56:59], v[160:163]
 ds_read_b64_tr_b16 a[168:169], v11 offset:16960
 ds_read_b64_tr_b16 a[170:171], v11 offset:25408
 v_mfma_f32_16x16x32_bf16 v[240:243], a[176:179], v[64:67], v[240:243]
 v_mul_f32 v231, s6, v231
 v_cvt_pk_bf16_f32 v224, v224, v225
 v_mfma_f32_16x16x32_bf16 v[168:171], a[176:179], v[60:63], v[168:171]
 s_add_u32 m0, s40, 0x23260
 v_cvt_pk_bf16_f32 v225, v226, v227
 v_cvt_pk_bf16_f32 v226, v228, v229
 v_mfma_f32_16x16x32_bf16 v[172:175], a[180:183], v[60:63], v[172:175]
 ds_read_b64_tr_b16 a[172:173], v11 offset:16992
 ds_read_b64_tr_b16 a[174:175], v11 offset:25440
 v_mfma_f32_16x16x32_bf16 v[244:247], a[180:183], v[64:67], v[244:247]
 buffer_load_dwordx4 v16, s[20:23], s56 offen offset:1536 nt lds
 v_cvt_pk_bf16_f32 v227, v230, v231
 v_mfma_f32_16x16x32_bf16 v[164:167], a[180:183], v[56:59], v[164:167]
 s_waitcnt lgkmcnt(8)
 v_permlane32_swap_b32 v224, v226
 v_mfma_f32_16x16x32_bf16 v[176:179], a[184:187], v[56:59], v[176:179]
 ds_read_b64_tr_b16 a[176:177], v11 offset:17152
 ds_read_b64_tr_b16 a[178:179], v11 offset:25600
 v_mfma_f32_16x16x32_bf16 v[248:251], a[184:187], v[64:67], v[248:251]
 v_permlane32_swap_b32 v225, v227
 v_mfma_f32_16x16x32_bf16 v[184:187], a[184:187], v[60:63], v[184:187]
 v_mul_f32 v232, s6, v232
 v_mul_f32 v233, s6, v233
 v_mfma_f32_16x16x32_bf16 v[188:191], a[188:191], v[60:63], v[188:191]
 ds_read_b64_tr_b16 a[180:181], v11 offset:17184
 ds_read_b64_tr_b16 a[182:183], v11 offset:25632
 v_mfma_f32_16x16x32_bf16 v[252:255], a[188:191], v[64:67], v[252:255]
 v_mul_f32 v234, s6, v234
 v_mul_f32 v235, s6, v235
 v_mfma_f32_16x16x32_bf16 v[180:183], a[188:191], v[56:59], v[180:183]
 s_waitcnt lgkmcnt(8)
 v_mul_f32 v236, s6, v236
 v_mul_f32 v237, s6, v237
 v_mfma_f32_16x16x32_bf16 v[128:131], a[160:163], v[56:59], v[128:131]
 ds_read_b64_tr_b16 a[184:185], v11 offset:17216
 ds_read_b64_tr_b16 a[186:187], v11 offset:25664
 v_mfma_f32_16x16x32_bf16 v[136:139], a[160:163], v[60:63], v[136:139]
 v_mul_f32 v238, s6, v238
 v_mul_f32 v239, s6, v239
 v_mfma_f32_16x16x32_bf16 v[140:143], a[164:167], v[60:63], v[140:143]
 ds_read_b64_tr_b16 a[188:189], v11 offset:17248
 ds_read_b64_tr_b16 a[190:191], v11 offset:25696
 v_mfma_f32_16x16x32_bf16 v[132:135], a[164:167], v[56:59], v[132:135]
 s_waitcnt lgkmcnt(8)
 v_cvt_pk_bf16_f32 v232, v232, v233
 v_cvt_pk_bf16_f32 v233, v234, v235
 v_mfma_f32_16x16x32_bf16 v[144:147], a[168:171], v[56:59], v[144:147]
 s_barrier
 ds_read_b128 a[160:163], v6 offset:0
 v_mfma_f32_16x16x32_bf16 v[152:155], a[168:171], v[60:63], v[152:155]
 s_xor_b32 s56, s43, 0
 v_cvt_pk_bf16_f32 v234, v236, v237
 v_cvt_pk_bf16_f32 v235, v238, v239
 v_mfma_f32_16x16x32_bf16 v[156:159], a[172:175], v[60:63], v[156:159]
 s_add_u32 m0, s40, 0x16600
 ds_read_b128 a[164:167], v6 offset:64
 v_mfma_f32_16x16x32_bf16 v[148:151], a[172:175], v[56:59], v[148:151]
 s_waitcnt lgkmcnt(6)
 v_permlane32_swap_b32 v232, v234
 v_mfma_f32_16x16x32_bf16 v[192:195], a[176:179], v[56:59], v[192:195]
 ds_read_b128 a[168:171], v8 offset:0
 buffer_load_dwordx4 v16, s[20:23], s56 offen offset:0 nt lds
 v_mfma_f32_16x16x32_bf16 v[200:203], a[176:179], v[60:63], v[200:203]
 v_permlane32_swap_b32 v233, v235
 v_mfma_f32_16x16x32_bf16 v[204:207], a[180:183], v[60:63], v[204:207]
 ds_read_b128 a[172:175], v8 offset:64
 v_mul_f32 v240, s6, v240
 v_mfma_f32_16x16x32_bf16 v[196:199], a[180:183], v[56:59], v[196:199]
 s_waitcnt lgkmcnt(4)
 v_mul_f32 v241, s6, v241
 v_mul_f32 v242, s6, v242
 v_mfma_f32_16x16x32_bf16 v[208:211], a[184:187], v[56:59], v[208:211]
 ds_read_b128 a[176:179], v7 offset:0
 v_mul_f32 v243, s6, v243
 v_mfma_f32_16x16x32_bf16 v[216:219], a[184:187], v[60:63], v[216:219]
 s_add_u32 m0, s40, 0x16820
 v_mul_f32 v244, s6, v244
 v_mul_f32 v245, s6, v245
 v_mfma_f32_16x16x32_bf16 v[220:223], a[188:191], v[60:63], v[220:223]
 ds_read_b128 a[180:183], v7 offset:64
 v_mul_f32 v246, s6, v246
 v_mfma_f32_16x16x32_bf16 v[212:215], a[188:191], v[56:59], v[212:215]
 s_waitcnt lgkmcnt(4)
 v_mul_f32 v247, s6, v247
 v_cvt_pk_bf16_f32 v240, v240, v241
 v_cvt_pk_bf16_f32 v241, v242, v243
 v_cvt_pk_bf16_f32 v242, v244, v245
 v_cvt_pk_bf16_f32 v243, v246, v247
 s_nop 0
 v_permlane32_swap_b32 v240, v242
 v_permlane32_swap_b32 v241, v243
 v_mul_f32 v248, s6, v248
 v_mul_f32 v249, s6, v249
 v_mul_f32 v250, s6, v250
 v_mul_f32 v251, s6, v251
 v_mul_f32 v252, s6, v252
 v_mul_f32 v253, s6, v253
 v_mul_f32 v254, s6, v254
 v_mul_f32 v255, s6, v255
 v_cvt_pk_bf16_f32 v248, v248, v249
 v_cvt_pk_bf16_f32 v249, v250, v251
 v_cvt_pk_bf16_f32 v250, v252, v253
 v_cvt_pk_bf16_f32 v251, v254, v255
 s_nop 0
 v_permlane32_swap_b32 v248, v250
 v_permlane32_swap_b32 v249, v251
 ds_write_b128 v19, v[224:227] offset:0
 v_pk_mul_f32 v[96:97], v[96:97], s[6:7]
 v_pk_mul_f32 v[98:99], v[98:99], s[6:7]
 v_pk_mul_f32 v[100:101], v[100:101], s[6:7]
 v_pk_mul_f32 v[102:103], v[102:103], s[6:7]
 v_cvt_pk_bf16_f32 v96, v96, v97
 v_cvt_pk_bf16_f32 v97, v98, v99
 v_cvt_pk_bf16_f32 v98, v100, v101
 v_cvt_pk_bf16_f32 v99, v102, v103
 ds_write_b128 v19, v[232:235] offset:1024
 v_pk_mul_f32 v[104:105], v[104:105], s[6:7]
 v_pk_mul_f32 v[106:107], v[106:107], s[6:7]
 v_pk_mul_f32 v[108:109], v[108:109], s[6:7]
 v_pk_mul_f32 v[110:111], v[110:111], s[6:7]
 v_cvt_pk_bf16_f32 v104, v104, v105
 v_cvt_pk_bf16_f32 v105, v106, v107
 v_cvt_pk_bf16_f32 v106, v108, v109
 v_cvt_pk_bf16_f32 v107, v110, v111
 v_permlane32_swap_b32 v96, v98
 v_permlane32_swap_b32 v97, v99
 ds_write_b128 v19, v[240:243] offset:2048
 v_pk_mul_f32 v[112:113], v[112:113], s[6:7]
 v_pk_mul_f32 v[114:115], v[114:115], s[6:7]
 v_pk_mul_f32 v[116:117], v[116:117], s[6:7]
 v_pk_mul_f32 v[118:119], v[118:119], s[6:7]
 v_cvt_pk_bf16_f32 v112, v112, v113
 v_cvt_pk_bf16_f32 v113, v114, v115
 v_cvt_pk_bf16_f32 v114, v116, v117
 v_cvt_pk_bf16_f32 v115, v118, v119
 v_permlane32_swap_b32 v104, v106
 v_permlane32_swap_b32 v105, v107
 ds_write_b128 v19, v[248:251] offset:3072
 v_pk_mul_f32 v[120:121], v[120:121], s[6:7]
 v_pk_mul_f32 v[122:123], v[122:123], s[6:7]
 v_pk_mul_f32 v[124:125], v[124:125], s[6:7]
 v_pk_mul_f32 v[126:127], v[126:127], s[6:7]
 v_cvt_pk_bf16_f32 v120, v120, v121
 v_cvt_pk_bf16_f32 v121, v122, v123
 v_cvt_pk_bf16_f32 v122, v124, v125
 v_cvt_pk_bf16_f32 v123, v126, v127
 v_permlane32_swap_b32 v112, v114
 v_permlane32_swap_b32 v113, v115
 v_pk_mul_f32 v[160:161], v[160:161], s[6:7]
 v_pk_mul_f32 v[162:163], v[162:163], s[6:7]
 v_pk_mul_f32 v[164:165], v[164:165], s[6:7]
 v_pk_mul_f32 v[166:167], v[166:167], s[6:7]
 v_cvt_pk_bf16_f32 v160, v160, v161
 v_cvt_pk_bf16_f32 v161, v162, v163
 v_cvt_pk_bf16_f32 v162, v164, v165
 v_cvt_pk_bf16_f32 v163, v166, v167
 v_permlane32_swap_b32 v120, v122
 v_permlane32_swap_b32 v121, v123
 v_pk_mul_f32 v[168:169], v[168:169], s[6:7]
 v_pk_mul_f32 v[170:171], v[170:171], s[6:7]
 v_pk_mul_f32 v[172:173], v[172:173], s[6:7]
 v_pk_mul_f32 v[174:175], v[174:175], s[6:7]
 v_cvt_pk_bf16_f32 v168, v168, v169
 v_cvt_pk_bf16_f32 v169, v170, v171
 v_cvt_pk_bf16_f32 v170, v172, v173
 v_cvt_pk_bf16_f32 v171, v174, v175
 v_permlane32_swap_b32 v160, v162
 v_permlane32_swap_b32 v161, v163
 v_pk_mul_f32 v[176:177], v[176:177], s[6:7]
 v_pk_mul_f32 v[178:179], v[178:179], s[6:7]
 v_pk_mul_f32 v[180:181], v[180:181], s[6:7]
 v_pk_mul_f32 v[182:183], v[182:183], s[6:7]
 v_cvt_pk_bf16_f32 v176, v176, v177
 v_cvt_pk_bf16_f32 v177, v178, v179
 v_cvt_pk_bf16_f32 v178, v180, v181
 v_cvt_pk_bf16_f32 v179, v182, v183
 v_permlane32_swap_b32 v168, v170
 v_permlane32_swap_b32 v169, v171
 s_waitcnt lgkmcnt(0)
 s_barrier
 ds_read_b128 v[228:231], v20 offset:0
 ds_read_b128 v[236:239], v20 offset:1024
 ds_read_b128 v[244:247], v20 offset:2048
 ds_read_b128 v[252:255], v20 offset:3072
 v_pk_mul_f32 v[184:185], v[184:185], s[6:7]
 v_pk_mul_f32 v[186:187], v[186:187], s[6:7]
 v_pk_mul_f32 v[188:189], v[188:189], s[6:7]
 v_pk_mul_f32 v[190:191], v[190:191], s[6:7]
 v_cvt_pk_bf16_f32 v184, v184, v185
 v_cvt_pk_bf16_f32 v185, v186, v187
 v_cvt_pk_bf16_f32 v186, v188, v189
 v_cvt_pk_bf16_f32 v187, v190, v191
 v_permlane32_swap_b32 v176, v178
 v_permlane32_swap_b32 v177, v179
 v_pk_mul_f32 v[128:129], v[128:129], s[6:7]
 v_pk_mul_f32 v[130:131], v[130:131], s[6:7]
 v_pk_mul_f32 v[132:133], v[132:133], s[6:7]
 v_pk_mul_f32 v[134:135], v[134:135], s[6:7]
 v_cvt_pk_bf16_f32 v128, v128, v129
 v_cvt_pk_bf16_f32 v129, v130, v131
 v_cvt_pk_bf16_f32 v130, v132, v133
 v_cvt_pk_bf16_f32 v131, v134, v135
 v_permlane32_swap_b32 v184, v186
 v_permlane32_swap_b32 v185, v187
 v_pk_mul_f32 v[136:137], v[136:137], s[6:7]
 v_pk_mul_f32 v[138:139], v[138:139], s[6:7]
 v_pk_mul_f32 v[140:141], v[140:141], s[6:7]
 v_pk_mul_f32 v[142:143], v[142:143], s[6:7]
 v_cvt_pk_bf16_f32 v136, v136, v137
 v_cvt_pk_bf16_f32 v137, v138, v139
 v_cvt_pk_bf16_f32 v138, v140, v141
 v_cvt_pk_bf16_f32 v139, v142, v143
 v_permlane32_swap_b32 v128, v130
 v_permlane32_swap_b32 v129, v131
 v_pk_mul_f32 v[144:145], v[144:145], s[6:7]
 v_pk_mul_f32 v[146:147], v[146:147], s[6:7]
 v_pk_mul_f32 v[148:149], v[148:149], s[6:7]
 v_pk_mul_f32 v[150:151], v[150:151], s[6:7]
 v_cvt_pk_bf16_f32 v144, v144, v145
 v_cvt_pk_bf16_f32 v145, v146, v147
 v_cvt_pk_bf16_f32 v146, v148, v149
 v_cvt_pk_bf16_f32 v147, v150, v151
 v_permlane32_swap_b32 v136, v138
 v_permlane32_swap_b32 v137, v139
 v_pk_mul_f32 v[152:153], v[152:153], s[6:7]
 v_pk_mul_f32 v[154:155], v[154:155], s[6:7]
 v_pk_mul_f32 v[156:157], v[156:157], s[6:7]
 v_pk_mul_f32 v[158:159], v[158:159], s[6:7]
 v_cvt_pk_bf16_f32 v152, v152, v153
 v_cvt_pk_bf16_f32 v153, v154, v155
 v_cvt_pk_bf16_f32 v154, v156, v157
 v_cvt_pk_bf16_f32 v155, v158, v159
 v_permlane32_swap_b32 v144, v146
 v_permlane32_swap_b32 v145, v147
 v_permlane32_swap_b32 v152, v154
 v_permlane32_swap_b32 v153, v155
 v_mfma_f32_16x16x32_bf16 v[56:59], a[160:163], v[96:99], 0
 ds_read_b128 a[184:187], v9 offset:0
 buffer_load_dwordx4 v16, s[20:23], s56 offen offset:512 nt lds
 v_mfma_f32_16x16x32_bf16 v[56:59], a[164:167], v[112:115], v[56:59]
 v_mul_f32 v192, s6, v192
 v_mul_f32 v193, s6, v193
 v_mfma_f32_16x16x32_bf16 v[64:67], a[164:167], v[120:123], 0
 v_mul_f32 v194, s6, v194
 v_mul_f32 v195, s6, v195
 v_mfma_f32_16x16x32_bf16 v[64:67], a[160:163], v[104:107], v[64:67]
 ds_read_b128 a[188:191], v9 offset:64
 v_mul_f32 v196, s6, v196
 v_mfma_f32_16x16x32_bf16 v[72:75], a[160:163], v[224:227], 0
 v_mul_f32 v197, s6, v197
 v_mul_f32 v198, s6, v198
 v_mfma_f32_16x16x32_bf16 v[72:75], a[164:167], v[232:235], v[72:75]
 v_mul_f32 v199, s6, v199
 v_cvt_pk_bf16_f32 v192, v192, v193
 v_mfma_f32_16x16x32_bf16 v[60:63], a[168:171], v[96:99], 0
 s_add_u32 m0, s40, 0x16a40
 ds_read_b128 a[160:163], v6 offset:256
 v_cvt_pk_bf16_f32 v193, v194, v195
 v_mfma_f32_16x16x32_bf16 v[60:63], a[172:175], v[112:115], v[60:63]
L_pad3:
 s_cbranch_execz L_e0_back
 buffer_load_dwordx4 v16, s[20:23], s56 offen offset:1024 nt lds
 v_cvt_pk_bf16_f32 v194, v196, v197
 v_mfma_f32_16x16x32_bf16 v[68:71], a[172:175], v[120:123], 0
 ds_read_b128 a[164:167], v6 offset:320
 v_cvt_pk_bf16_f32 v195, v198, v199
 v_mfma_f32_16x16x32_bf16 v[68:71], a[168:171], v[104:107], v[68:71]
 v_permlane32_swap_b32 v192, v194
 v_mfma_f32_16x16x32_bf16 v[56:59], a[176:179], v[128:131], v[56:59]
 ds_read_b128 a[168:171], v8 offset:256
 v_mfma_f32_16x16x32_bf16 v[56:59], a[180:183], v[144:147], v[56:59]
 v_permlane32_swap_b32 v193, v195
 v_mfma_f32_16x16x32_bf16 v[64:67], a[180:183], v[152:155], v[64:67]
 v_mul_f32 v200, s6, v200
 v_mul_f32 v201, s6, v201
 v_mfma_f32_16x16x32_bf16 v[64:67], a[176:179], v[136:139], v[64:67]
 s_add_u32 m0, s40, 0x16c60
 ds_read_b128 a[172:175], v8 offset:320
 v_mul_f32 v202, s6, v202
 s_waitcnt lgkmcnt(9)
 v_mfma_f32_16x16x32_bf16 v[72:75], a[176:179], v[228:231], v[72:75]
 buffer_load_dwordx4 v16, s[20:23], s56 offen offset:1536 nt lds
 v_mul_f32 v203, s6, v203
 s_waitcnt lgkmcnt(8)
 v_mfma_f32_16x16x32_bf16 v[72:75], a[180:183], v[236:239], v[72:75]
 s_waitcnt lgkmcnt(4)
 v_mul_f32 v204, s6, v204
 v_mul_f32 v205, s6, v205
 v_mfma_f32_16x16x32_bf16 v[60:63], a[184:187], v[128:131], v[60:63]
 ds_read_b128 a[176:179], v7 offset:256
 v_mul_f32 v206, s6, v206
 v_mfma_f32_16x16x32_bf16 v[60:63], a[188:191], v[144:147], v[60:63]
 v_mul_f32 v207, s6, v207
 v_cvt_pk_bf16_f32 v200, v200, v201
 v_mfma_f32_16x16x32_bf16 v[68:71], a[188:191], v[152:155], v[68:71]
 ds_read_b128 a[180:183], v7 offset:320
 v_cvt_pk_bf16_f32 v201, v202, v203
 v_mfma_f32_16x16x32_bf16 v[68:71], a[184:187], v[136:139], v[68:71]
 s_waitcnt lgkmcnt(4)
 v_cvt_pk_bf16_f32 v202, v204, v205
 v_cvt_pk_bf16_f32 v203, v206, v207
 v_mfma_f32_16x16x32_bf16 v[56:59], a[160:163], v[160:163], v[56:59]
 ds_read_b128 a[184:187], v9 offset:256
 v_mfma_f32_16x16x32_bf16 v[56:59], a[164:167], v[176:179], v[56:59]
 v_permlane32_swap_b32 v200, v202
 v_mfma_f32_16x16x32_bf16 v[64:67], a[164:167], v[184:187], v[64:67]
 v_permlane32_swap_b32 v201, v203
 v_mfma_f32_16x16x32_bf16 v[64:67], a[160:163], v[168:171], v[64:67]
 ds_read_b128 a[188:191], v9 offset:320
 v_mul_f32 v208, s6, v208
 v_mfma_f32_16x16x32_bf16 v[72:75], a[160:163], v[240:243], v[72:75]
 v_mul_f32 v209, s6, v209
 v_mul_f32 v210, s6, v210
 v_mfma_f32_16x16x32_bf16 v[72:75], a[164:167], v[248:251], v[72:75]
 s_waitcnt lgkmcnt(4)
 v_mul_f32 v211, s6, v211
 v_mul_f32 v212, s6, v212
 v_mfma_f32_16x16x32_bf16 v[60:63], a[168:171], v[160:163], v[60:63]
 s_cmp_eq_u32 s3, 1
 s_cbranch_scc1 L_hop
L_hop_ret:
 s_barrier
 ds_read_b128 a[160:163], v6 offset:16896
 v_mfma_f32_16x16x32_bf16 v[60:63], a[172:175], v[176:179], v[60:63]
 s_xor_b32 s56, s43, 0x4000
 v_mul_f32 v213, s6, v213
 v_mul_f32 v214, s6, v214
 v_mfma_f32_16x16x32_bf16 v[68:71], a[172:175], v[184:187], v[68:71]
 s_add_u32 m0, s40, 0x1a800
 ds_read_b128 a[164:167], v6 offset:16960
 v_mul_f32 v215, s6, v215
 v_mfma_f32_16x16x32_bf16 v[68:71], a[168:171], v[168:171], v[68:71]
 s_waitcnt lgkmcnt(4)
 v_cvt_pk_bf16_f32 v208, v208, v209
 v_cvt_pk_bf16_f32 v209, v210, v211
 v_cvt_pk_bf16_f32 v210, v212, v213
 v_cvt_pk_bf16_f32 v211, v214, v215
 s_nop 0
 v_permlane32_swap_b32 v208, v210
 v_permlane32_swap_b32 v209, v211
 v_mul_f32 v216, s6, v216
 v_mul_f32 v217, s6, v217
 v_mul_f32 v218, s6, v218
 v_mul_f32 v219, s6, v219
 v_mul_f32 v220, s6, v220
 v_mul_f32 v221, s6, v221
 v_mul_f32 v222, s6, v222
 v_mul_f32 v223, s6, v223
 v_cvt_pk_bf16_f32 v216, v216, v217
 v_cvt_pk_bf16_f32 v217, v218, v219
 v_cvt_pk_bf16_f32 v218, v220, v221
 v_cvt_pk_bf16_f32 v219, v222, v223
 s_nop 0
 v_permlane32_swap_b32 v216, v218
 v_permlane32_swap_b32 v217, v219
 v_mfma_f32_16x16x32_bf16 v[56:59], a[176:179], v[192:195], v[56:59]
 ds_read_b128 a[168:171], v8 offset:16896
 buffer_load_dwordx4 v16, s[20:23], s56 offen offset:0 nt lds
 v_mfma_f32_16x16x32_bf16 v[56:59], a[180:183], v[208:211], v[56:59]
 v_mfma_f32_16x16x32_bf16 v[64:67], a[180:183], v[216:219], v[64:67]
 v_mfma_f32_16x16x32_bf16 v[64:67], a[176:179], v[200:203], v[64:67]
 ds_read_b128 a[172:175], v8 offset:16960
 v_mfma_f32_16x16x32_bf16 v[72:75], a[176:179], v[244:247], v[72:75]
 v_mfma_f32_16x16x32_bf16 v[72:75], a[180:183], v[252:255], v[72:75]
 s_waitcnt lgkmcnt(4)
 v_mfma_f32_16x16x32_bf16 v[60:63], a[184:187], v[192:195], v[60:63]
 s_add_u32 m0, s40, 0x1aa20
 ds_read_b128 a[176:179], v7 offset:16896
 v_mfma_f32_16x16x32_bf16 v[60:63], a[188:191], v[208:211], v[60:63]
 buffer_load_dwordx4 v16, s[20:23], s56 offen offset:512 nt lds
 v_mfma_f32_16x16x32_bf16 v[68:71], a[188:191], v[216:219], v[68:71]
 ds_read_b128 a[180:183], v7 offset:16960
 v_mfma_f32_16x16x32_bf16 v[68:71], a[184:187], v[200:203], v[68:71]
 s_waitcnt lgkmcnt(4)
 v_mfma_f32_16x16x32_bf16 v[100:103], a[160:163], v[96:99], 0
 ds_read_b128 a[184:187], v9 offset:16896
 v_mfma_f32_16x16x32_bf16 v[100:103], a[164:167], v[112:115], v[100:103]
 v_mfma_f32_16x16x32_bf16 v[116:119], a[164:167], v[120:123], 0
 s_cbranch_vccnz L_stub_0_B0
L_stub_0_B0_ret:
 v_mfma_f32_16x16x32_bf16 v[116:119], a[160:163], v[104:107], v[116:119]
 ds_read_b128 a[188:191], v9 offset:16960
 v_max3_f32 v79, v72, v73, v74
 v_mfma_f32_16x16x32_bf16 v[132:135], a[160:163], v[224:227], 0
 s_add_u32 m0, s40, 0x1ac40
 v_max_f32 v79, v79, v75
 v_mov_b32 v77, v79
 v_mfma_f32_16x16x32_bf16 v[132:135], a[164:167], v[232:235], v[132:135]
 s_waitcnt lgkmcnt(4)
 v_permlane32_swap_b32 v77, v79
 v_mfma_f32_16x16x32_bf16 v[108:111], a[168:171], v[96:99], 0
 ds_read_b128 a[160:163], v6 offset:17152
 v_max_f32 v79, v79, v77
 v_mfma_f32_16x16x32_bf16 v[108:111], a[172:175], v[112:115], v[108:111]
 buffer_load_dwordx4 v16, s[20:23], s56 offen offset:1024 nt lds
 v_mov_b32 v77, v79
 v_mfma_f32_16x16x32_bf16 v[124:127], a[172:175], v[120:123], 0
 ds_read_b128 a[164:167], v6 offset:17216
 v_max3_f32 v78, v56, v57, v58
 v_mfma_f32_16x16x32_bf16 v[124:127], a[168:171], v[104:107], v[124:127]
 s_waitcnt lgkmcnt(4)
 v_permlane16_swap_b32 v77, v79
 v_mfma_f32_16x16x32_bf16 v[100:103], a[176:179], v[128:131], v[100:103]
 ds_read_b128 a[168:171], v8 offset:17152
 v_max_f32 v79, v79, v77
 v_mfma_f32_16x16x32_bf16 v[100:103], a[180:183], v[144:147], v[100:103]
 ds_write_b32 v23, v79 offset:0
 v_max3_f32 v78, v78, v59, v60
 v_mfma_f32_16x16x32_bf16 v[116:119], a[180:183], v[152:155], v[116:119]
 v_max3_f32 v78, v78, v61, v62
 v_max_f32 v78, v78, v63
 v_mfma_f32_16x16x32_bf16 v[116:119], a[176:179], v[136:139], v[116:119]
 s_add_u32 m0, s40, 0x1ae60
 ds_read_b128 a[172:175], v8 offset:17216
 v_mov_b32 v76, v78
 v_mfma_f32_16x16x32_bf16 v[132:135], a[176:179], v[228:231], v[132:135]
 buffer_load_dwordx4 v16, s[20:23], s56 offen offset:1536 nt lds
 v_mfma_f32_16x16x32_bf16 v[132:135], a[180:183], v[236:239], v[132:135]
 s_waitcnt lgkmcnt(5)
 v_permlane32_swap_b32 v76, v78
 v_mfma_f32_16x16x32_bf16 v[108:111], a[184:187], v[128:131], v[108:111]
 ds_read_b128 a[176:179], v7 offset:17152
 v_max_f32 v78, v78, v76
 v_mfma_f32_16x16x32_bf16 v[108:111], a[188:191], v[144:147], v[108:111]
 v_mov_b32 v76, v78
 v_mfma_f32_16x16x32_bf16 v[124:127], a[188:191], v[152:155], v[124:127]
 ds_read_b128 a[180:183], v7 offset:17216
 v_mfma_f32_16x16x32_bf16 v[124:127], a[184:187], v[136:139], v[124:127]
 s_waitcnt lgkmcnt(5)
 v_permlane16_swap_b32 v76, v78
 v_mfma_f32_16x16x32_bf16 v[100:103], a[160:163], v[160:163], v[100:103]
 ds_read_b128 a[184:187], v9 offset:17152
 v_max_f32 v78, v78, v76
 v_mfma_f32_16x16x32_bf16 v[100:103], a[164:167], v[176:179], v[100:103]
 v_cndmask_b32_e64 v44, -v78, 0, vcc
 v_mov_b32 v45, v44
 v_mfma_f32_16x16x32_bf16 v[116:119], a[164:167], v[184:187], v[116:119]
 v_mov_b32 v46, v44
 v_mov_b32 v47, v44
 v_mfma_f32_16x16x32_bf16 v[116:119], a[160:163], v[168:171], v[116:119]
 ds_read_b128 a[188:191], v9 offset:17216
 v_max3_f32 v78, v64, v65, v66
 v_mfma_f32_16x16x32_bf16 v[132:135], a[160:163], v[240:243], v[132:135]
 v_max3_f32 v78, v78, v67, v68
 v_max3_f32 v78, v78, v69, v70
 v_mfma_f32_16x16x32_bf16 v[132:135], a[164:167], v[248:251], v[132:135]
 s_waitcnt lgkmcnt(4)
 v_max_f32 v78, v78, v71
 v_mov_b32 v76, v78
 v_mfma_f32_16x16x32_bf16 v[108:111], a[168:171], v[160:163], v[108:111]
 s_barrier
 ds_read_b128 a[160:163], v6 offset:33792
 v_mfma_f32_16x16x32_bf16 v[108:111], a[172:175], v[176:179], v[108:111]
 s_xor_b32 s56, s42, 0x10000
 ds_read_b32 v77, v24 offset:0
 v_mfma_f32_16x16x32_bf16 v[124:127], a[172:175], v[184:187], v[124:127]
 s_add_u32 m0, s40, 0
 ds_read_b128 a[164:167], v6 offset:33856
 v_mfma_f32_16x16x32_bf16 v[124:127], a[168:171], v[168:171], v[124:127]
 s_waitcnt lgkmcnt(5)
 v_permlane32_swap_b32 v76, v78
 v_mfma_f32_16x16x32_bf16 v[100:103], a[176:179], v[192:195], v[100:103]
 s_waitcnt vmcnt(4)
 ds_read_b128 a[168:171], v8 offset:33792
 v_max_f32 v78, v78, v76
 v_mfma_f32_16x16x32_bf16 v[100:103], a[180:183], v[208:211], v[100:103]
 buffer_load_dwordx4 v16, s[16:19], s56 offen offset:0 nt lds
 v_mov_b32 v76, v78
 v_mfma_f32_16x16x32_bf16 v[116:119], a[180:183], v[216:219], v[116:119]
 s_nop 0
 v_permlane16_swap_b32 v76, v78
 v_mfma_f32_16x16x32_bf16 v[116:119], a[176:179], v[200:203], v[116:119]
 ds_read_b128 a[172:175], v8 offset:33856
 v_max_f32 v78, v78, v76
 v_mfma_f32_16x16x32_bf16 v[132:135], a[176:179], v[244:247], v[132:135]
 v_cndmask_b32_e64 v48, -v78, 0, vcc
 v_mov_b32 v49, v48
 v_mfma_f32_16x16x32_bf16 v[132:135], a[180:183], v[252:255], v[132:135]
 s_waitcnt lgkmcnt(5)
 v_mov_b32 v50, v48
 v_mov_b32 v51, v48
 v_mfma_f32_16x16x32_bf16 v[108:111], a[184:187], v[192:195], v[108:111]
 ds_read_b128 a[176:179], v7 offset:33792
 s_waitcnt lgkmcnt(4)
 v_max_f32 v79, v79, v77
 v_mfma_f32_16x16x32_bf16 v[108:111], a[188:191], v[208:211], v[108:111]
 s_add_u32 m0, s40, 0x220
 v_cndmask_b32_e64 v52, -v79, 0, vcc
 v_mov_b32 v53, v52
 v_mfma_f32_16x16x32_bf16 v[124:127], a[188:191], v[216:219], v[124:127]
 s_waitcnt vmcnt(4)
 ds_read_b128 a[180:183], v7 offset:33856
 v_mov_b32 v54, v52
 v_mfma_f32_16x16x32_bf16 v[124:127], a[184:187], v[200:203], v[124:127]
 s_waitcnt lgkmcnt(4)
 v_mov_b32 v55, v52
 v_add_f32 v72, v72, v52
 v_mfma_f32_16x16x32_bf16 v[140:143], a[160:163], v[96:99], v[44:47]
 ds_read_b128 a[184:187], v9 offset:33792
 v_add_f32 v73, v73, v52
 v_mfma_f32_16x16x32_bf16 v[140:143], a[164:167], v[112:115], v[140:143]
 v_add_f32 v74, v74, v52
 v_add_f32 v75, v75, v52
 v_mfma_f32_16x16x32_bf16 v[156:159], a[164:167], v[120:123], v[48:51]
 s_cbranch_vccnz L_stub_1_B0
L_stub_1_B0_ret:
 buffer_load_dwordx4 v16, s[16:19], s56 offen offset:512 nt lds
 v_mfma_f32_16x16x32_bf16 v[156:159], a[160:163], v[104:107], v[156:159]
 ds_read_b128 a[188:191], v9 offset:33856
 v_add_f32 v56, v56, v44
 v_mfma_f32_16x16x32_bf16 v[172:175], a[160:163], v[224:227], 0
 v_exp_f32 v72, v72
 v_mfma_f32_16x16x32_bf16 v[172:175], a[164:167], v[232:235], v[172:175]
 s_waitcnt lgkmcnt(4)
 v_exp_f32 v73, v73
 v_mfma_f32_16x16x32_bf16 v[148:151], a[168:171], v[96:99], v[44:47]
 ds_read_b128 a[160:163], v6 offset:34048
 v_add_f32 v57, v57, v44
 v_mfma_f32_16x16x32_bf16 v[148:151], a[172:175], v[112:115], v[148:151]
 s_add_u32 m0, s40, 0x440
 v_exp_f32 v74, v74
 v_mfma_f32_16x16x32_bf16 v[164:167], a[172:175], v[120:123], v[48:51]
 s_waitcnt vmcnt(4)
 ds_read_b128 a[164:167], v6 offset:34112
 v_add_f32 v58, v58, v44
 v_mfma_f32_16x16x32_bf16 v[164:167], a[168:171], v[104:107], v[164:167]
 s_waitcnt lgkmcnt(4)
 v_exp_f32 v75, v75
 v_mfma_f32_16x16x32_bf16 v[140:143], a[176:179], v[128:131], v[140:143]
 ds_read_b128 a[168:171], v8 offset:34048
 v_add_f32 v34, v72, v73
 v_mfma_f32_16x16x32_bf16 v[140:143], a[180:183], v[144:147], v[140:143]
 v_cvt_pk_bf16_f32 v72, v72, v73
 v_add_f32 v34, v34, v74
 v_mfma_f32_16x16x32_bf16 v[156:159], a[180:183], v[152:155], v[156:159]
 v_add_f32 v34, v34, v75
 v_cvt_pk_bf16_f32 v73, v74, v75
 v_mfma_f32_16x16x32_bf16 v[156:159], a[176:179], v[136:139], v[156:159]
 ds_read_b128 a[172:175], v8 offset:34112
 ds_write_b64 v21, v[72:73] offset:0
 v_mfma_f32_16x16x32_bf16 v[172:175], a[176:179], v[228:231], v[172:175]
 buffer_load_dwordx4 v16, s[16:19], s56 offen offset:1024 nt lds
 v_add_f32 v59, v59, v44
 v_mfma_f32_16x16x32_bf16 v[172:175], a[180:183], v[236:239], v[172:175]
 s_waitcnt lgkmcnt(5)
 v_add_f32 v60, v60, v44
 v_add_f32 v61, v61, v44
 v_mfma_f32_16x16x32_bf16 v[148:151], a[184:187], v[128:131], v[148:151]
 ds_read_b128 a[176:179], v7 offset:34048
 v_add_f32 v62, v62, v44
 v_mfma_f32_16x16x32_bf16 v[148:151], a[188:191], v[144:147], v[148:151]
 s_add_u32 m0, s40, 0x660
 v_add_f32 v63, v63, v44
 v_add_f32 v64, v64, v48
 v_mfma_f32_16x16x32_bf16 v[164:167], a[188:191], v[152:155], v[164:167]
 s_waitcnt vmcnt(4)
 ds_read_b128 a[180:183], v7 offset:34112
 v_add_f32 v65, v65, v48
 v_mfma_f32_16x16x32_bf16 v[164:167], a[184:187], v[136:139], v[164:167]
 s_waitcnt lgkmcnt(5)
 buffer_load_dwordx4 v16, s[16:19], s56 offen offset:1536 nt lds
 v_add_f32 v66, v66, v48
 v_mfma_f32_16x16x32_bf16 v[140:143], a[160:163], v[160:163], v[140:143]
 ds_read_b128 a[184:187], v9 offset:34048
 v_add_f32 v67, v67, v48
 v_mfma_f32_16x16x32_bf16 v[140:143], a[164:167], v[176:179], v[140:143]
 v_add_f32 v68, v68, v48
 v_add_f32 v69, v69, v48
 v_mfma_f32_16x16x32_bf16 v[156:159], a[164:167], v[184:187], v[156:159]
 v_add_f32 v70, v70, v48
 v_add_f32 v71, v71, v48
 v_mfma_f32_16x16x32_bf16 v[156:159], a[160:163], v[168:171], v[156:159]
 ds_read_b128 a[188:191], v9 offset:34112
 v_add_f32 v132, v132, v52
 v_mfma_f32_16x16x32_bf16 v[172:175], a[160:163], v[240:243], v[172:175]
 v_exp_f32 v56, v56
 v_mfma_f32_16x16x32_bf16 v[172:175], a[164:167], v[248:251], v[172:175]
 s_waitcnt lgkmcnt(5)
 v_exp_f32 v57, v57
 v_mfma_f32_16x16x32_bf16 v[148:151], a[168:171], v[160:163], v[148:151]
 s_waitcnt lgkmcnt(4)
 s_barrier
 ds_read_b64_tr_b16 a[160:161], v2 offset:0
 ds_read_b64_tr_b16 a[162:163], v4 offset:0
 v_mfma_f32_16x16x32_bf16 v[148:151], a[172:175], v[176:179], v[148:151]
 ds_read_b64 v[74:75], v22 offset:0
 v_add_f32 v32, v56, v57
 v_mfma_f32_16x16x32_bf16 v[164:167], a[172:175], v[184:187], v[164:167]
 ds_read_b64_tr_b16 a[164:165], v3 offset:0
 ds_read_b64_tr_b16 a[166:167], v5 offset:0
 v_mfma_f32_16x16x32_bf16 v[164:167], a[168:171], v[168:171], v[164:167]
 s_waitcnt lgkmcnt(7)
 v_exp_f32 v58, v58
 v_mfma_f32_16x16x32_bf16 v[140:143], a[176:179], v[192:195], v[140:143]
 ds_read_b64_tr_b16 a[168:169], v2 offset:32
 ds_read_b64_tr_b16 a[170:171], v4 offset:32
 v_mfma_f32_16x16x32_bf16 v[140:143], a[180:183], v[208:211], v[140:143]
 v_exp_f32 v59, v59
 v_mfma_f32_16x16x32_bf16 v[156:159], a[180:183], v[216:219], v[156:159]
 s_xor_b32 s56, s42, 0x14000
 v_exp_f32 v60, v60
 v_mfma_f32_16x16x32_bf16 v[156:159], a[176:179], v[200:203], v[156:159]
 s_add_u32 m0, s40, 0x4200
 ds_read_b64_tr_b16 a[172:173], v3 offset:32
 ds_read_b64_tr_b16 a[174:175], v5 offset:32
 v_mfma_f32_16x16x32_bf16 v[172:175], a[176:179], v[244:247], v[172:175]
 s_waitcnt vmcnt(4)
 v_exp_f32 v61, v61
 v_mfma_f32_16x16x32_bf16 v[172:175], a[180:183], v[252:255], v[172:175]
 s_waitcnt lgkmcnt(9)
 v_exp_f32 v62, v62
 v_mfma_f32_16x16x32_bf16 v[148:151], a[184:187], v[192:195], v[148:151]
 ds_read_b64_tr_b16 a[176:177], v2 offset:64
 ds_read_b64_tr_b16 a[178:179], v4 offset:64
 v_mfma_f32_16x16x32_bf16 v[148:151], a[188:191], v[208:211], v[148:151]
 v_exp_f32 v63, v63
 v_mfma_f32_16x16x32_bf16 v[164:167], a[188:191], v[216:219], v[164:167]
 ds_read_b64_tr_b16 a[180:181], v3 offset:64
 ds_read_b64_tr_b16 a[182:183], v5 offset:64
 v_exp_f32 v64, v64
 v_exp_f32 v65, v65
 v_exp_f32 v66, v66
 v_exp_f32 v67, v67
 v_exp_f32 v68, v68
 v_exp_f32 v69, v69
 v_exp_f32 v70, v70
 v_exp_f32 v71, v71
 v_cvt_pk_bf16_f32 v56, v56, v57
 v_add_f32 v32, v32, v58
 v_add_f32 v32, v32, v59
 v_cvt_pk_bf16_f32 v57, v58, v59
 v_add_f32 v32, v32, v60
 v_add_f32 v32, v32, v61
 v_cvt_pk_bf16_f32 v58, v60, v61
 v_add_f32 v32, v32, v62
 v_add_f32 v32, v32, v63
 v_cvt_pk_bf16_f32 v59, v62, v63
 v_add_f32 v33, v64, v65
 v_cvt_pk_bf16_f32 v64, v64, v65
 v_add_f32 v33, v33, v66
 v_add_f32 v33, v33, v67
 v_cvt_pk_bf16_f32 v65, v66, v67
 v_add_f32 v33, v33, v68
 v_add_f32 v33, v33, v69
 v_cvt_pk_bf16_f32 v66, v68, v69
 v_add_f32 v33, v33, v70
 v_add_f32 v33, v33, v71
 v_cvt_pk_bf16_f32 v67, v70, v71
 v_mfma_f32_16x16x32_bf16 v[164:167], a[184:187], v[200:203], v[164:167]
 s_waitcnt lgkmcnt(8)
 buffer_load_dwordx4 v16, s[16:19], s56 offen offset:0 nt lds
 v_add_f32 v133, v133, v52
 v_mfma_f32_16x16x32_bf16 a[0:3], a[160:163], v[56:59], 0
 ds_read_b64_tr_b16 a[184:185], v2 offset:96
 ds_read_b64_tr_b16 a[186:187], v4 offset:96
 v_mfma_f32_16x16x32_bf16 a[128:131], a[160:163], v[72:75], 0
 v_add_f32 v134, v134, v52
 v_add_f32 v135, v135, v52
 v_mfma_f32_16x16x32_bf16 a[8:11], a[160:163], v[64:67], 0
 s_cbranch_vccnz L_stub_2_B0
L_stub_2_B0_ret:
 v_add_f32 v100, v100, v44
 v_mfma_f32_16x16x32_bf16 a[40:43], a[164:167], v[64:67], 0
 s_add_u32 m0, s40, 0x4420
 ds_read_b64_tr_b16 a[188:189], v3 offset:96
 ds_read_b64_tr_b16 a[190:191], v5 offset:96
 v_mfma_f32_16x16x32_bf16 a[32:35], a[164:167], v[56:59], 0
 s_waitcnt lgkmcnt(8)
 v_exp_f32 v132, v132
 v_mfma_f32_16x16x32_bf16 a[4:7], a[168:171], v[56:59], 0
 s_waitcnt vmcnt(4)
 ds_read_b64_tr_b16 a[160:161], v2 offset:256
 ds_read_b64_tr_b16 a[162:163], v4 offset:256
 v_mfma_f32_16x16x32_bf16 a[132:135], a[168:171], v[72:75], 0
 buffer_load_dwordx4 v16, s[16:19], s56 offen offset:512 nt lds
 v_add_f32 v101, v101, v44
 v_mfma_f32_16x16x32_bf16 a[12:15], a[168:171], v[64:67], 0
 v_exp_f32 v133, v133
 v_mfma_f32_16x16x32_bf16 a[44:47], a[172:175], v[64:67], 0
 ds_read_b64_tr_b16 a[164:165], v3 offset:256
 ds_read_b64_tr_b16 a[166:167], v5 offset:256
 v_mfma_f32_16x16x32_bf16 a[36:39], a[172:175], v[56:59], 0
 s_waitcnt lgkmcnt(8)
 v_exp_f32 v134, v134
 v_mfma_f32_16x16x32_bf16 a[16:19], a[176:179], v[56:59], 0
 ds_read_b64_tr_b16 a[168:169], v2 offset:288
 ds_read_b64_tr_b16 a[170:171], v4 offset:288
 v_mfma_f32_16x16x32_bf16 a[136:139], a[176:179], v[72:75], 0
 v_exp_f32 v135, v135
 v_mfma_f32_16x16x32_bf16 a[24:27], a[176:179], v[64:67], 0
 s_add_u32 m0, s40, 0x4640
 v_add_f32 v34, v34, v132
 v_add_f32 v34, v34, v133
 v_mfma_f32_16x16x32_bf16 a[56:59], a[180:183], v[64:67], 0
 s_waitcnt vmcnt(4)
 ds_read_b64_tr_b16 a[172:173], v3 offset:288
 ds_read_b64_tr_b16 a[174:175], v5 offset:288
 v_mfma_f32_16x16x32_bf16 a[48:51], a[180:183], v[56:59], 0
 s_waitcnt lgkmcnt(8)
 buffer_load_dwordx4 v16, s[16:19], s56 offen offset:1024 nt lds
 global_load_dword v35, v[30:31], off
 v_mfma_f32_16x16x32_bf16 a[20:23], a[184:187], v[56:59], 0
 ds_read_b64_tr_b16 a[176:177], v2 offset:320
 ds_read_b64_tr_b16 a[178:179], v4 offset:320
 v_mfma_f32_16x16x32_bf16 a[140:143], a[184:187], v[72:75], 0
 v_cvt_pk_bf16_f32 v132, v132, v133
 v_add_f32 v34, v34, v134
 v_mfma_f32_16x16x32_bf16 a[28:31], a[184:187], v[64:67], 0
 v_add_f32 v34, v34, v135
 v_cvt_pk_bf16_f32 v133, v134, v135
 v_mfma_f32_16x16x32_bf16 a[60:63], a[188:191], v[64:67], 0
 ds_read_b64_tr_b16 a[180:181], v3 offset:320
 ds_read_b64_tr_b16 a[182:183], v5 offset:320
 v_mfma_f32_16x16x32_bf16 a[52:55], a[188:191], v[56:59], 0
 s_waitcnt lgkmcnt(8)
 ds_write_b64 v21, v[132:133] offset:2048
 v_add_f32 v102, v102, v44
 v_mfma_f32_16x16x32_bf16 a[64:67], a[160:163], v[56:59], 0
 ds_read_b64_tr_b16 a[184:185], v2 offset:352
 ds_read_b64_tr_b16 a[186:187], v4 offset:352
 v_mfma_f32_16x16x32_bf16 a[144:147], a[160:163], v[72:75], 0
 v_add_f32 v103, v103, v44
 v_add_f32 v108, v108, v44
 v_mfma_f32_16x16x32_bf16 a[72:75], a[160:163], v[64:67], 0
 v_add_f32 v109, v109, v44
 v_add_f32 v110, v110, v44
 v_mfma_f32_16x16x32_bf16 a[104:107], a[164:167], v[64:67], 0
 ds_read_b64_tr_b16 a[188:189], v3 offset:352
 ds_read_b64_tr_b16 a[190:191], v5 offset:352
 v_mfma_f32_16x16x32_bf16 a[96:99], a[164:167], v[56:59], 0
 s_waitcnt lgkmcnt(9)
 v_add_f32 v111, v111, v44
 v_add_f32 v116, v116, v48
 v_mfma_f32_16x16x32_bf16 a[68:71], a[168:171], v[56:59], 0
 s_waitcnt lgkmcnt(4)
 s_barrier
 ds_read_b128 a[160:163], v6 offset:50688
 v_mfma_f32_16x16x32_bf16 a[148:151], a[168:171], v[72:75], 0
 v_add_f32 v117, v117, v48
 v_add_f32 v118, v118, v48
 v_mfma_f32_16x16x32_bf16 a[76:79], a[168:171], v[64:67], 0
 s_xor_b32 s56, s42, 0x14000
 v_add_f32 v119, v119, v48
 v_add_f32 v124, v124, v48
 v_mfma_f32_16x16x32_bf16 a[108:111], a[172:175], v[64:67], 0
 s_add_u32 m0, s40, 0x4860
 ds_read_b128 a[164:167], v6 offset:50752
 v_add_f32 v125, v125, v48
 v_mfma_f32_16x16x32_bf16 a[100:103], a[172:175], v[56:59], 0
 v_add_f32 v126, v126, v48
 v_add_f32 v127, v127, v48
 v_mfma_f32_16x16x32_bf16 a[80:83], a[176:179], v[56:59], 0
 s_waitcnt vmcnt(4)
 ds_read_b128 a[168:171], v8 offset:50688
 v_add_f32 v172, v172, v52
 v_mfma_f32_16x16x32_bf16 a[152:155], a[176:179], v[72:75], 0
 buffer_load_dwordx4 v16, s[16:19], s56 offen offset:1536 nt lds
 v_add_f32 v173, v173, v52
 v_mfma_f32_16x16x32_bf16 a[88:91], a[176:179], v[64:67], 0
 v_exp_f32 v100, v100
 v_mfma_f32_16x16x32_bf16 a[120:123], a[180:183], v[64:67], 0
 ds_read_b128 a[172:175], v8 offset:50752
 v_add_f32 v32, v32, v100
 v_mfma_f32_16x16x32_bf16 a[112:115], a[180:183], v[56:59], 0
 s_waitcnt lgkmcnt(4)
 v_exp_f32 v101, v101
 v_mfma_f32_16x16x32_bf16 a[84:87], a[184:187], v[56:59], 0
 ds_read_b128 a[176:179], v7 offset:50688
 v_add_f32 v32, v32, v101
 v_mfma_f32_16x16x32_bf16 a[156:159], a[184:187], v[72:75], 0
 v_exp_f32 v102, v102
 v_mfma_f32_16x16x32_bf16 a[92:95], a[184:187], v[64:67], 0
 v_exp_f32 v103, v103
 v_mfma_f32_16x16x32_bf16 a[124:127], a[188:191], v[64:67], 0
 s_xor_b32 s56, s42, 0x18000
 ds_read_b128 a[180:183], v7 offset:50752
 v_cvt_pk_bf16_f32 v100, v100, v101
 v_mfma_f32_16x16x32_bf16 a[116:119], a[188:191], v[56:59], 0
 s_waitcnt lgkmcnt(4)
 v_exp_f32 v108, v108
 v_mfma_f32_16x16x32_bf16 v[56:59], a[160:163], v[96:99], v[44:47]
 s_add_u32 m0, s40, 0x8400
 ds_read_b128 a[184:187], v9 offset:50688
 v_add_f32 v32, v32, v102
 v_mfma_f32_16x16x32_bf16 v[56:59], a[164:167], v[112:115], v[56:59]
 s_waitcnt vmcnt(4)
 v_exp_f32 v109, v109
 v_mfma_f32_16x16x32_bf16 v[64:67], a[164:167], v[120:123], v[48:51]
 buffer_load_dwordx4 v16, s[16:19], s56 offen offset:0 nt lds
 v_add_f32 v32, v32, v103
 v_mfma_f32_16x16x32_bf16 v[64:67], a[160:163], v[104:107], v[64:67]
 ds_read_b128 a[188:191], v9 offset:50752
 v_cvt_pk_bf16_f32 v101, v102, v103
 v_mfma_f32_16x16x32_bf16 v[72:75], a[160:163], v[224:227], v[52:55]
 v_exp_f32 v110, v110
 v_mfma_f32_16x16x32_bf16 v[72:75], a[164:167], v[232:235], v[72:75]
 s_waitcnt lgkmcnt(4)
 v_exp_f32 v111, v111
 v_mfma_f32_16x16x32_bf16 v[60:63], a[168:171], v[96:99], v[44:47]
 ds_read_b128 a[160:163], v6 offset:50944
 v_add_f32 v32, v32, v108
 v_mfma_f32_16x16x32_bf16 v[60:63], a[172:175], v[112:115], v[60:63]
 v_exp_f32 v116, v116
 v_mfma_f32_16x16x32_bf16 v[68:71], a[172:175], v[120:123], v[48:51]
 s_add_u32 m0, s40, 0x8620
 ds_read_b128 a[164:167], v6 offset:51008
 v_add_f32 v32, v32, v109
 v_mfma_f32_16x16x32_bf16 v[68:71], a[168:171], v[104:107], v[68:71]
 s_waitcnt lgkmcnt(4)
 v_exp_f32 v117, v117
 v_mfma_f32_16x16x32_bf16 v[56:59], a[176:179], v[128:131], v[56:59]
 s_waitcnt vmcnt(4)
 ds_read_b128 a[168:171], v8 offset:50944
 v_cvt_pk_bf16_f32 v102, v108, v109
 v_mfma_f32_16x16x32_bf16 v[56:59], a[180:183], v[144:147], v[56:59]
 buffer_load_dwordx4 v16, s[16:19], s56 offen offset:512 nt lds
 v_add_f32 v32, v32, v110
 v_mfma_f32_16x16x32_bf16 v[64:67], a[180:183], v[152:155], v[64:67]
 v_exp_f32 v118, v118
 v_mfma_f32_16x16x32_bf16 v[64:67], a[176:179], v[136:139], v[64:67]
 ds_read_b128 a[172:175], v8 offset:51008
 v_add_f32 v32, v32, v111
 v_mfma_f32_16x16x32_bf16 v[72:75], a[176:179], v[228:231], v[72:75]
 v_exp_f32 v119, v119
 v_mfma_f32_16x16x32_bf16 v[72:75], a[180:183], v[236:239], v[72:75]
 s_waitcnt lgkmcnt(4)
 v_exp_f32 v124, v124
 v_mfma_f32_16x16x32_bf16 v[60:63], a[184:187], v[128:131], v[60:63]
 ds_read_b128 a[176:179], v7 offset:50944
 v_cvt_pk_bf16_f32 v103, v110, v111
 v_mfma_f32_16x16x32_bf16 v[60:63], a[188:191], v[144:147], v[60:63]
 v_exp_f32 v125, v125
 v_mfma_f32_16x16x32_bf16 v[68:71], a[188:191], v[152:155], v[68:71]
 ds_read_b128 a[180:183], v7 offset:51008
 v_add_f32 v33, v33, v116
 v_mfma_f32_16x16x32_bf16 v[68:71], a[184:187], v[136:139], v[68:71]
 s_waitcnt lgkmcnt(4)
 v_exp_f32 v126, v126
 v_mfma_f32_16x16x32_bf16 v[56:59], a[160:163], v[160:163], v[56:59]
 s_add_u32 m0, s40, 0x8840
 ds_read_b128 a[184:187], v9 offset:50944
 v_add_f32 v33, v33, v117
 v_mfma_f32_16x16x32_bf16 v[56:59], a[164:167], v[176:179], v[56:59]
 s_waitcnt vmcnt(4)
 v_exp_f32 v127, v127
 v_mfma_f32_16x16x32_bf16 v[64:67], a[164:167], v[184:187], v[64:67]
 buffer_load_dwordx4 v16, s[16:19], s56 offen offset:1024 nt lds
 v_cvt_pk_bf16_f32 v116, v116, v117
 v_mfma_f32_16x16x32_bf16 v[64:67], a[160:163], v[168:171], v[64:67]
 ds_read_b128 a[188:191], v9 offset:51008
 v_add_f32 v33, v33, v118
 v_mfma_f32_16x16x32_bf16 v[72:75], a[160:163], v[240:243], v[72:75]
 v_add_f32 v33, v33, v119
 v_cvt_pk_bf16_f32 v117, v118, v119
 v_mfma_f32_16x16x32_bf16 v[72:75], a[164:167], v[248:251], v[72:75]
 s_waitcnt lgkmcnt(4)
 v_add_f32 v33, v33, v124
 v_add_f32 v33, v33, v125
 v_mfma_f32_16x16x32_bf16 v[60:63], a[168:171], v[160:163], v[60:63]
 s_barrier
 ds_read_b64_tr_b16 a[160:161], v2 offset:16896
 ds_read_b64_tr_b16 a[162:163], v4 offset:16896
 v_mfma_f32_16x16x32_bf16 v[60:63], a[172:175], v[176:179], v[60:63]
 ds_read_b64 v[134:135], v22 offset:2048
 v_cvt_pk_bf16_f32 v118, v124, v125
 v_mfma_f32_16x16x32_bf16 v[68:71], a[172:175], v[184:187], v[68:71]
 ds_read_b64_tr_b16 a[164:165], v3 offset:16896
 ds_read_b64_tr_b16 a[166:167], v5 offset:16896
 v_mfma_f32_16x16x32_bf16 v[68:71], a[168:171], v[168:171], v[68:71]
 s_waitcnt lgkmcnt(7)
 v_add_f32 v33, v33, v126
 v_add_f32 v33, v33, v127
 v_mfma_f32_16x16x32_bf16 v[56:59], a[176:179], v[192:195], v[56:59]
 ds_read_b64_tr_b16 a[168:169], v2 offset:16928
 ds_read_b64_tr_b16 a[170:171], v4 offset:16928
 v_mfma_f32_16x16x32_bf16 v[56:59], a[180:183], v[208:211], v[56:59]
 v_cvt_pk_bf16_f32 v119, v126, v127
 v_add_f32 v174, v174, v52
 v_mfma_f32_16x16x32_bf16 v[64:67], a[180:183], v[216:219], v[64:67]
 v_add_f32 v175, v175, v52
 v_mfma_f32_16x16x32_bf16 v[64:67], a[176:179], v[200:203], v[64:67]
 ds_read_b64_tr_b16 a[172:173], v3 offset:16928
 ds_read_b64_tr_b16 a[174:175], v5 offset:16928
 v_mfma_f32_16x16x32_bf16 v[72:75], a[176:179], v[244:247], v[72:75]
 s_xor_b32 s56, s42, 0x18000
 v_exp_f32 v172, v172
 v_mfma_f32_16x16x32_bf16 v[72:75], a[180:183], v[252:255], v[72:75]
 s_waitcnt lgkmcnt(9)
 v_exp_f32 v173, v173
 v_mfma_f32_16x16x32_bf16 v[60:63], a[184:187], v[192:195], v[60:63]
 s_add_u32 m0, s40, 0x8a60
 ds_read_b64_tr_b16 a[176:177], v2 offset:16960
 ds_read_b64_tr_b16 a[178:179], v4 offset:16960
 v_mfma_f32_16x16x32_bf16 v[60:63], a[188:191], v[208:211], v[60:63]
 s_waitcnt vmcnt(4)
 v_exp_f32 v174, v174
 v_mfma_f32_16x16x32_bf16 v[68:71], a[188:191], v[216:219], v[68:71]
 ds_read_b64_tr_b16 a[180:181], v3 offset:16960
 ds_read_b64_tr_b16 a[182:183], v5 offset:16960
 v_mfma_f32_16x16x32_bf16 v[68:71], a[184:187], v[200:203], v[68:71]
 s_waitcnt lgkmcnt(8)
 buffer_load_dwordx4 v16, s[16:19], s56 offen offset:1536 nt lds
 v_mfma_f32_16x16x32_bf16 a[0:3], a[160:163], v[100:103], a[0:3]
L_pad4:
 s_cbranch_execz L_e0_back
 ds_read_b64_tr_b16 a[184:185], v2 offset:16992
 ds_read_b64_tr_b16 a[186:187], v4 offset:16992
 v_mfma_f32_16x16x32_bf16 a[128:131], a[160:163], v[132:135], a[128:131]
 v_exp_f32 v175, v175
 v_mfma_f32_16x16x32_bf16 a[8:11], a[160:163], v[116:119], a[8:11]
 s_cbranch_vccnz L_stub_3_B0
L_stub_3_B0_ret:
 v_add_f32 v34, v34, v172
 v_mfma_f32_16x16x32_bf16 a[40:43], a[164:167], v[116:119], a[40:43]
 ds_read_b64_tr_b16 a[188:189], v3 offset:16992
 ds_read_b64_tr_b16 a[190:191], v5 offset:16992
 v_mfma_f32_16x16x32_bf16 a[32:35], a[164:167], v[100:103], a[32:35]
 s_waitcnt lgkmcnt(8)
 v_add_f32 v34, v34, v173
 v_cvt_pk_bf16_f32 v172, v172, v173
 v_mfma_f32_16x16x32_bf16 a[4:7], a[168:171], v[100:103], a[4:7]
 s_xor_b32 s56, s43, 0x10000
 ds_read_b64_tr_b16 a[160:161], v2 offset:17152
 ds_read_b64_tr_b16 a[162:163], v4 offset:17152
 v_mfma_f32_16x16x32_bf16 a[132:135], a[168:171], v[132:135], a[132:135]
 s_add_u32 m0, s40, 0x16600
 v_add_f32 v34, v34, v174
 v_add_f32 v34, v34, v175
 v_mfma_f32_16x16x32_bf16 a[12:15], a[168:171], v[116:119], a[12:15]
 s_waitcnt vmcnt(4)
 v_cvt_pk_bf16_f32 v173, v174, v175
 v_mfma_f32_16x16x32_bf16 a[44:47], a[172:175], v[116:119], a[44:47]
 ds_read_b64_tr_b16 a[164:165], v3 offset:17152
 ds_read_b64_tr_b16 a[166:167], v5 offset:17152
 v_mfma_f32_16x16x32_bf16 a[36:39], a[172:175], v[100:103], a[36:39]
 s_waitcnt lgkmcnt(8)
 buffer_load_dwordx4 v16, s[20:23], s56 offen offset:0 nt lds
 ds_write_b64 v21, v[172:173] offset:0
 v_mfma_f32_16x16x32_bf16 a[16:19], a[176:179], v[100:103], a[16:19]
 ds_read_b64_tr_b16 a[168:169], v2 offset:17184
 ds_read_b64_tr_b16 a[170:171], v4 offset:17184
 v_mfma_f32_16x16x32_bf16 a[136:139], a[176:179], v[132:135], a[136:139]
 v_exp_f32 v140, v140
 v_mfma_f32_16x16x32_bf16 a[24:27], a[176:179], v[116:119], a[24:27]
 v_exp_f32 v141, v141
 v_mfma_f32_16x16x32_bf16 a[56:59], a[180:183], v[116:119], a[56:59]
 ds_read_b64_tr_b16 a[172:173], v3 offset:17184
 ds_read_b64_tr_b16 a[174:175], v5 offset:17184
 v_mfma_f32_16x16x32_bf16 a[48:51], a[180:183], v[100:103], a[48:51]
 s_waitcnt lgkmcnt(9)
 v_exp_f32 v142, v142
 v_mfma_f32_16x16x32_bf16 a[20:23], a[184:187], v[100:103], a[20:23]
 s_add_u32 m0, s40, 0x16820
 ds_read_b64_tr_b16 a[176:177], v2 offset:17216
 ds_read_b64_tr_b16 a[178:179], v4 offset:17216
 v_mfma_f32_16x16x32_bf16 a[140:143], a[184:187], v[132:135], a[140:143]
 s_waitcnt vmcnt(4)
 v_exp_f32 v143, v143
 v_mfma_f32_16x16x32_bf16 a[28:31], a[184:187], v[116:119], a[28:31]
 buffer_load_dwordx4 v16, s[20:23], s56 offen offset:512 nt lds
 v_add_f32 v32, v32, v140
 v_mfma_f32_16x16x32_bf16 a[60:63], a[188:191], v[116:119], a[60:63]
 ds_read_b64_tr_b16 a[180:181], v3 offset:17216
 ds_read_b64_tr_b16 a[182:183], v5 offset:17216
 v_mfma_f32_16x16x32_bf16 a[52:55], a[188:191], v[100:103], a[52:55]
 s_waitcnt lgkmcnt(9)
 v_exp_f32 v148, v148
 v_mfma_f32_16x16x32_bf16 a[64:67], a[160:163], v[100:103], a[64:67]
 ds_read_b64_tr_b16 a[184:185], v2 offset:17248
 ds_read_b64_tr_b16 a[186:187], v4 offset:17248
 v_mfma_f32_16x16x32_bf16 a[144:147], a[160:163], v[132:135], a[144:147]
 v_exp_f32 v149, v149
 v_mfma_f32_16x16x32_bf16 a[72:75], a[160:163], v[116:119], a[72:75]
 v_exp_f32 v150, v150
 v_mfma_f32_16x16x32_bf16 a[104:107], a[164:167], v[116:119], a[104:107]
 ds_read_b64_tr_b16 a[188:189], v3 offset:17248
 ds_read_b64_tr_b16 a[190:191], v5 offset:17248
 v_mfma_f32_16x16x32_bf16 a[96:99], a[164:167], v[100:103], a[96:99]
 s_waitcnt lgkmcnt(8)
 v_exp_f32 v151, v151
 v_mfma_f32_16x16x32_bf16 a[68:71], a[168:171], v[100:103], a[68:71]
 s_barrier
 ds_read_b128 a[160:163], v6 offset:0
 v_mfma_f32_16x16x32_bf16 a[148:151], a[168:171], v[132:135], a[148:151]
 v_exp_f32 v156, v156
 v_mfma_f32_16x16x32_bf16 a[76:79], a[168:171], v[116:119], a[76:79]
 v_exp_f32 v157, v157
 v_mfma_f32_16x16x32_bf16 a[108:111], a[172:175], v[116:119], a[108:111]
 ds_read_b128 a[164:167], v6 offset:64
 v_add_f32 v32, v32, v141
 v_mfma_f32_16x16x32_bf16 a[100:103], a[172:175], v[100:103], a[100:103]
 s_waitcnt lgkmcnt(6)
 v_exp_f32 v158, v158
 v_mfma_f32_16x16x32_bf16 a[80:83], a[176:179], v[100:103], a[80:83]
 s_xor_b32 s56, s43, 0x10000
 ds_read_b128 a[168:171], v8 offset:0
 v_cvt_pk_bf16_f32 v140, v140, v141
 v_mfma_f32_16x16x32_bf16 a[152:155], a[176:179], v[132:135], a[152:155]
 s_add_u32 m0, s40, 0x16a40
 v_exp_f32 v159, v159
 v_mfma_f32_16x16x32_bf16 a[88:91], a[176:179], v[116:119], a[88:91]
 s_waitcnt vmcnt(4)
 v_exp_f32 v164, v164
 v_mfma_f32_16x16x32_bf16 a[120:123], a[180:183], v[116:119], a[120:123]
 ds_read_b128 a[172:175], v8 offset:64
 buffer_load_dwordx4 v16, s[20:23], s56 offen offset:1024 nt lds
 v_mfma_f32_16x16x32_bf16 a[112:115], a[180:183], v[100:103], a[112:115]
 s_waitcnt lgkmcnt(4)
 v_exp_f32 v165, v165
 v_mfma_f32_16x16x32_bf16 a[84:87], a[184:187], v[100:103], a[84:87]
 ds_read_b128 a[176:179], v7 offset:0
 v_add_f32 v32, v32, v142
 v_mfma_f32_16x16x32_bf16 a[156:159], a[184:187], v[132:135], a[156:159]
 v_exp_f32 v166, v166
 v_mfma_f32_16x16x32_bf16 a[92:95], a[184:187], v[116:119], a[92:95]
 v_exp_f32 v167, v167
 v_mfma_f32_16x16x32_bf16 a[124:127], a[188:191], v[116:119], a[124:127]
 ds_read_b128 a[180:183], v7 offset:64
 v_add_f32 v32, v32, v143
 v_mfma_f32_16x16x32_bf16 a[116:119], a[188:191], v[100:103], a[116:119]
 s_waitcnt lgkmcnt(4)
 v_cvt_pk_bf16_f32 v141, v142, v143
 v_add_f32 v32, v32, v148
 v_mfma_f32_16x16x32_bf16 v[100:103], a[160:163], v[96:99], v[44:47]
 s_add_u32 m0, s40, 0x16c60
 ds_read_b128 a[184:187], v9 offset:0
 v_add_f32 v32, v32, v149
 v_mfma_f32_16x16x32_bf16 v[100:103], a[164:167], v[112:115], v[100:103]
 s_waitcnt vmcnt(4)
 v_cvt_pk_bf16_f32 v142, v148, v149
 v_add_f32 v32, v32, v150
 v_mfma_f32_16x16x32_bf16 v[116:119], a[164:167], v[120:123], v[48:51]
 buffer_load_dwordx4 v16, s[20:23], s56 offen offset:1536 nt lds
 v_add_f32 v32, v32, v151
 v_mfma_f32_16x16x32_bf16 v[116:119], a[160:163], v[104:107], v[116:119]
 ds_read_b128 a[188:191], v9 offset:64
 v_cvt_pk_bf16_f32 v143, v150, v151
 v_mfma_f32_16x16x32_bf16 v[132:135], a[160:163], v[224:227], v[52:55]
 v_add_f32 v33, v33, v156
 v_add_f32 v33, v33, v157
 v_mfma_f32_16x16x32_bf16 v[132:135], a[164:167], v[232:235], v[132:135]
 s_waitcnt lgkmcnt(4)
 v_cvt_pk_bf16_f32 v156, v156, v157
 v_add_f32 v33, v33, v158
 v_mfma_f32_16x16x32_bf16 v[108:111], a[168:171], v[96:99], v[44:47]
 ds_read_b128 a[160:163], v6 offset:256
 v_add_f32 v33, v33, v159
 v_mfma_f32_16x16x32_bf16 v[108:111], a[172:175], v[112:115], v[108:111]
 v_cvt_pk_bf16_f32 v157, v158, v159
 v_add_f32 v33, v33, v164
 v_mfma_f32_16x16x32_bf16 v[124:127], a[172:175], v[120:123], v[48:51]
 ds_read_b128 a[164:167], v6 offset:320
 v_add_f32 v33, v33, v165
 v_mfma_f32_16x16x32_bf16 v[124:127], a[168:171], v[104:107], v[124:127]
 s_waitcnt lgkmcnt(4)
 v_cvt_pk_bf16_f32 v158, v164, v165
 v_add_f32 v33, v33, v166
 v_mfma_f32_16x16x32_bf16 v[100:103], a[176:179], v[128:131], v[100:103]
 s_xor_b32 s56, s42, 0x1c000
 ds_read_b128 a[168:171], v8 offset:256
 v_add_f32 v33, v33, v167
 v_mfma_f32_16x16x32_bf16 v[100:103], a[180:183], v[144:147], v[100:103]
 s_add_u32 m0, s40, 0xc600
 v_cvt_pk_bf16_f32 v159, v166, v167
 v_mfma_f32_16x16x32_bf16 v[116:119], a[180:183], v[152:155], v[116:119]
 s_waitcnt vmcnt(4)
 v_exp_f32 v72, v72
 v_mfma_f32_16x16x32_bf16 v[116:119], a[176:179], v[136:139], v[116:119]
 ds_read_b128 a[172:175], v8 offset:320
 buffer_load_dwordx4 v16, s[16:19], s56 offen offset:0 nt lds
 v_mfma_f32_16x16x32_bf16 v[132:135], a[176:179], v[228:231], v[132:135]
 v_exp_f32 v73, v73
 v_mfma_f32_16x16x32_bf16 v[132:135], a[180:183], v[236:239], v[132:135]
 s_waitcnt lgkmcnt(4)
 v_exp_f32 v74, v74
 v_mfma_f32_16x16x32_bf16 v[108:111], a[184:187], v[128:131], v[108:111]
 ds_read_b128 a[176:179], v7 offset:256
 v_mfma_f32_16x16x32_bf16 v[108:111], a[188:191], v[144:147], v[108:111]
 v_exp_f32 v75, v75
 v_mfma_f32_16x16x32_bf16 v[124:127], a[188:191], v[152:155], v[124:127]
 ds_read_b128 a[180:183], v7 offset:320
 v_add_f32 v34, v34, v72
 v_mfma_f32_16x16x32_bf16 v[124:127], a[184:187], v[136:139], v[124:127]
 s_waitcnt lgkmcnt(4)
 v_add_f32 v34, v34, v73
 v_cvt_pk_bf16_f32 v72, v72, v73
 v_mfma_f32_16x16x32_bf16 v[100:103], a[160:163], v[160:163], v[100:103]
 ds_read_b128 a[184:187], v9 offset:256
 v_add_f32 v34, v34, v74
 v_mfma_f32_16x16x32_bf16 v[100:103], a[164:167], v[176:179], v[100:103]
 s_add_u32 m0, s40, 0xc820
 v_add_f32 v34, v34, v75
 v_cvt_pk_bf16_f32 v73, v74, v75
 v_mfma_f32_16x16x32_bf16 v[116:119], a[164:167], v[184:187], v[116:119]
 s_waitcnt vmcnt(4)
 ds_write_b64 v21, v[72:73] offset:2048
 v_mfma_f32_16x16x32_bf16 v[116:119], a[160:163], v[168:171], v[116:119]
 ds_read_b128 a[188:191], v9 offset:320
 buffer_load_dwordx4 v16, s[16:19], s56 offen offset:512 nt lds
 v_mfma_f32_16x16x32_bf16 v[132:135], a[160:163], v[240:243], v[132:135]
 v_exp_f32 v56, v56
 v_mfma_f32_16x16x32_bf16 v[132:135], a[164:167], v[248:251], v[132:135]
 s_waitcnt lgkmcnt(5)
 v_exp_f32 v57, v57
 v_mfma_f32_16x16x32_bf16 v[108:111], a[168:171], v[160:163], v[108:111]
 s_waitcnt lgkmcnt(1)
 s_barrier
 ds_read_b64_tr_b16 a[160:161], v2 offset:33792
 ds_read_b64_tr_b16 a[162:163], v4 offset:33792
 v_mfma_f32_16x16x32_bf16 v[108:111], a[172:175], v[176:179], v[108:111]
 ds_read_b64 v[174:175], v22 offset:0
 v_add_f32 v32, v32, v56
 v_mfma_f32_16x16x32_bf16 v[124:127], a[172:175], v[184:187], v[124:127]
 ds_read_b64_tr_b16 a[164:165], v3 offset:33792
 ds_read_b64_tr_b16 a[166:167], v5 offset:33792
 v_mfma_f32_16x16x32_bf16 v[124:127], a[168:171], v[168:171], v[124:127]
 v_exp_f32 v58, v58
 v_mfma_f32_16x16x32_bf16 v[100:103], a[176:179], v[192:195], v[100:103]
 ds_read_b64_tr_b16 a[168:169], v2 offset:33824
 ds_read_b64_tr_b16 a[170:171], v4 offset:33824
 v_mfma_f32_16x16x32_bf16 v[100:103], a[180:183], v[208:211], v[100:103]
 v_exp_f32 v59, v59
 v_mfma_f32_16x16x32_bf16 v[116:119], a[180:183], v[216:219], v[116:119]
 v_exp_f32 v60, v60
 v_mfma_f32_16x16x32_bf16 v[116:119], a[176:179], v[200:203], v[116:119]
 ds_read_b64_tr_b16 a[172:173], v3 offset:33824
 ds_read_b64_tr_b16 a[174:175], v5 offset:33824
 v_mfma_f32_16x16x32_bf16 v[132:135], a[176:179], v[244:247], v[132:135]
 v_exp_f32 v61, v61
 v_mfma_f32_16x16x32_bf16 v[132:135], a[180:183], v[252:255], v[132:135]
 s_waitcnt lgkmcnt(9)
 v_exp_f32 v62, v62
 v_mfma_f32_16x16x32_bf16 v[108:111], a[184:187], v[192:195], v[108:111]
 s_xor_b32 s56, s42, 0x1c000
 ds_read_b64_tr_b16 a[176:177], v2 offset:33856
 ds_read_b64_tr_b16 a[178:179], v4 offset:33856
 v_mfma_f32_16x16x32_bf16 v[108:111], a[188:191], v[208:211], v[108:111]
 s_add_u32 m0, s40, 0xca40
 v_exp_f32 v63, v63
 v_mfma_f32_16x16x32_bf16 v[124:127], a[188:191], v[216:219], v[124:127]
 s_waitcnt vmcnt(4)
 ds_read_b64_tr_b16 a[180:181], v3 offset:33856
 ds_read_b64_tr_b16 a[182:183], v5 offset:33856
 v_mfma_f32_16x16x32_bf16 v[124:127], a[184:187], v[200:203], v[124:127]
 s_waitcnt lgkmcnt(8)
 buffer_load_dwordx4 v16, s[16:19], s56 offen offset:1024 nt lds
 v_add_f32 v32, v32, v57
 v_mfma_f32_16x16x32_bf16 a[0:3], a[160:163], v[140:143], a[0:3]
 ds_read_b64_tr_b16 a[184:185], v2 offset:33888
 ds_read_b64_tr_b16 a[186:187], v4 offset:33888
 v_mfma_f32_16x16x32_bf16 a[128:131], a[160:163], v[172:175], a[128:131]
 v_exp_f32 v64, v64
 v_mfma_f32_16x16x32_bf16 a[8:11], a[160:163], v[156:159], a[8:11]
 s_cbranch_vccnz L_stub_4_B0
L_stub_4_B0_ret:
 v_cvt_pk_bf16_f32 v56, v56, v57
 v_mfma_f32_16x16x32_bf16 a[40:43], a[164:167], v[156:159], a[40:43]
 ds_read_b64_tr_b16 a[188:189], v3 offset:33888
 ds_read_b64_tr_b16 a[190:191], v5 offset:33888
 v_mfma_f32_16x16x32_bf16 a[32:35], a[164:167], v[140:143], a[32:35]
 s_waitcnt lgkmcnt(8)
 v_exp_f32 v65, v65
 v_mfma_f32_16x16x32_bf16 a[4:7], a[168:171], v[140:143], a[4:7]
 s_add_u32 m0, s40, 0xcc60
 ds_read_b64_tr_b16 a[160:161], v2 offset:34048
 ds_read_b64_tr_b16 a[162:163], v4 offset:34048
 v_mfma_f32_16x16x32_bf16 a[132:135], a[168:171], v[172:175], a[132:135]
 s_waitcnt vmcnt(4)
 v_exp_f32 v66, v66
 v_mfma_f32_16x16x32_bf16 a[12:15], a[168:171], v[156:159], a[12:15]
 buffer_load_dwordx4 v16, s[16:19], s56 offen offset:1536 nt lds
 v_add_f32 v32, v32, v58
 v_mfma_f32_16x16x32_bf16 a[44:47], a[172:175], v[156:159], a[44:47]
 ds_read_b64_tr_b16 a[164:165], v3 offset:34048
 ds_read_b64_tr_b16 a[166:167], v5 offset:34048
 v_mfma_f32_16x16x32_bf16 a[36:39], a[172:175], v[140:143], a[36:39]
 s_waitcnt lgkmcnt(8)
 v_exp_f32 v67, v67
 v_mfma_f32_16x16x32_bf16 a[16:19], a[176:179], v[140:143], a[16:19]
 ds_read_b64_tr_b16 a[168:169], v2 offset:34080
 ds_read_b64_tr_b16 a[170:171], v4 offset:34080
 v_mfma_f32_16x16x32_bf16 a[136:139], a[176:179], v[172:175], a[136:139]
 v_exp_f32 v68, v68
 v_mfma_f32_16x16x32_bf16 a[24:27], a[176:179], v[156:159], a[24:27]
 v_exp_f32 v69, v69
 v_mfma_f32_16x16x32_bf16 a[56:59], a[180:183], v[156:159], a[56:59]
 ds_read_b64_tr_b16 a[172:173], v3 offset:34080
 ds_read_b64_tr_b16 a[174:175], v5 offset:34080
 v_mfma_f32_16x16x32_bf16 a[48:51], a[180:183], v[140:143], a[48:51]
 s_waitcnt lgkmcnt(8)
 v_exp_f32 v70, v70
 v_mfma_f32_16x16x32_bf16 a[20:23], a[184:187], v[140:143], a[20:23]
 s_xor_b32 s56, s43, 0x14000
 ds_read_b64_tr_b16 a[176:177], v2 offset:34112
 ds_read_b64_tr_b16 a[178:179], v4 offset:34112
 v_mfma_f32_16x16x32_bf16 a[140:143], a[184:187], v[172:175], a[140:143]
 s_add_u32 m0, s40, 0x1a800
 v_exp_f32 v71, v71
 v_mfma_f32_16x16x32_bf16 a[28:31], a[184:187], v[156:159], a[28:31]
 s_waitcnt vmcnt(4)
 v_add_f32 v32, v32, v59
 v_cvt_pk_bf16_f32 v57, v58, v59
 v_mfma_f32_16x16x32_bf16 a[60:63], a[188:191], v[156:159], a[60:63]
 ds_read_b64_tr_b16 a[180:181], v3 offset:34112
 ds_read_b64_tr_b16 a[182:183], v5 offset:34112
 v_mfma_f32_16x16x32_bf16 a[52:55], a[188:191], v[140:143], a[52:55]
 s_waitcnt lgkmcnt(8)
 buffer_load_dwordx4 v16, s[20:23], s56 offen offset:0 nt lds
 v_add_f32 v32, v32, v60
 v_mfma_f32_16x16x32_bf16 a[64:67], a[160:163], v[140:143], a[64:67]
 ds_read_b64_tr_b16 a[184:185], v2 offset:34144
 ds_read_b64_tr_b16 a[186:187], v4 offset:34144
 v_mfma_f32_16x16x32_bf16 a[144:147], a[160:163], v[172:175], a[144:147]
 v_add_f32 v32, v32, v61
 v_cvt_pk_bf16_f32 v58, v60, v61
 v_mfma_f32_16x16x32_bf16 a[72:75], a[160:163], v[156:159], a[72:75]
 v_add_f32 v32, v32, v62
 v_add_f32 v32, v32, v63
 v_mfma_f32_16x16x32_bf16 a[104:107], a[164:167], v[156:159], a[104:107]
 ds_read_b64_tr_b16 a[188:189], v3 offset:34144
 ds_read_b64_tr_b16 a[190:191], v5 offset:34144
 v_mfma_f32_16x16x32_bf16 a[96:99], a[164:167], v[140:143], a[96:99]
 s_waitcnt lgkmcnt(8)
 v_cvt_pk_bf16_f32 v59, v62, v63
 v_add_f32 v33, v33, v64
 v_mfma_f32_16x16x32_bf16 a[68:71], a[168:171], v[140:143], a[68:71]
 s_barrier
 ds_read_b128 a[160:163], v6 offset:16896
 v_mfma_f32_16x16x32_bf16 a[148:151], a[168:171], v[172:175], a[148:151]
 v_add_f32 v33, v33, v65
 v_cvt_pk_bf16_f32 v64, v64, v65
 v_mfma_f32_16x16x32_bf16 a[76:79], a[168:171], v[156:159], a[76:79]
 v_add_f32 v33, v33, v66
 v_add_f32 v33, v33, v67
 v_mfma_f32_16x16x32_bf16 a[108:111], a[172:175], v[156:159], a[108:111]
 ds_read_b128 a[164:167], v6 offset:16960
 v_cvt_pk_bf16_f32 v65, v66, v67
 v_mfma_f32_16x16x32_bf16 a[100:103], a[172:175], v[140:143], a[100:103]
 s_waitcnt lgkmcnt(6)
 v_add_f32 v33, v33, v68
 v_add_f32 v33, v33, v69
 v_mfma_f32_16x16x32_bf16 a[80:83], a[176:179], v[140:143], a[80:83]
 ds_read_b128 a[168:171], v8 offset:16896
 v_cvt_pk_bf16_f32 v66, v68, v69
 v_mfma_f32_16x16x32_bf16 a[152:155], a[176:179], v[172:175], a[152:155]
 s_xor_b32 s56, s43, 0x14000
 v_add_f32 v33, v33, v70
 v_add_f32 v33, v33, v71
 v_mfma_f32_16x16x32_bf16 a[88:91], a[176:179], v[156:159], a[88:91]
 s_add_u32 m0, s40, 0x1aa20
 v_cvt_pk_bf16_f32 v67, v70, v71
 v_mfma_f32_16x16x32_bf16 a[120:123], a[180:183], v[156:159], a[120:123]
 s_waitcnt vmcnt(4)
 ds_read_b128 a[172:175], v8 offset:16960
 v_mfma_f32_16x16x32_bf16 a[112:115], a[180:183], v[140:143], a[112:115]
 s_waitcnt lgkmcnt(4)
 buffer_load_dwordx4 v16, s[20:23], s56 offen offset:512 nt lds
 v_mfma_f32_16x16x32_bf16 a[84:87], a[184:187], v[140:143], a[84:87]
 ds_read_b128 a[176:179], v7 offset:16896
 v_mfma_f32_16x16x32_bf16 a[156:159], a[184:187], v[172:175], a[156:159]
 v_exp_f32 v132, v132
 v_mfma_f32_16x16x32_bf16 a[92:95], a[184:187], v[156:159], a[92:95]
 v_exp_f32 v133, v133
 v_mfma_f32_16x16x32_bf16 a[124:127], a[188:191], v[156:159], a[124:127]
 ds_read_b128 a[180:183], v7 offset:16960
 v_mfma_f32_16x16x32_bf16 a[116:119], a[188:191], v[140:143], a[116:119]
 s_waitcnt lgkmcnt(4)
 v_exp_f32 v134, v134
 v_mfma_f32_16x16x32_bf16 v[140:143], a[160:163], v[96:99], v[44:47]
 ds_read_b128 a[184:187], v9 offset:16896
 v_mfma_f32_16x16x32_bf16 v[140:143], a[164:167], v[112:115], v[140:143]
 s_add_u32 m0, s40, 0x1ac40
 v_exp_f32 v135, v135
 v_mfma_f32_16x16x32_bf16 v[156:159], a[164:167], v[120:123], v[48:51]
 s_waitcnt vmcnt(4)
 v_add_f32 v34, v34, v132
 v_add_f32 v34, v34, v133
 v_mfma_f32_16x16x32_bf16 v[156:159], a[160:163], v[104:107], v[156:159]
 ds_read_b128 a[188:191], v9 offset:16960
 buffer_load_dwordx4 v16, s[20:23], s56 offen offset:1024 nt lds
 v_mfma_f32_16x16x32_bf16 v[172:175], a[160:163], v[224:227], v[52:55]
 v_cvt_pk_bf16_f32 v132, v132, v133
 v_add_f32 v34, v34, v134
 v_mfma_f32_16x16x32_bf16 v[172:175], a[164:167], v[232:235], v[172:175]
 s_waitcnt lgkmcnt(4)
 v_add_f32 v34, v34, v135
 v_cvt_pk_bf16_f32 v133, v134, v135
 v_mfma_f32_16x16x32_bf16 v[148:151], a[168:171], v[96:99], v[44:47]
 ds_read_b128 a[160:163], v6 offset:17152
 ds_write_b64 v21, v[132:133] offset:0
 v_mfma_f32_16x16x32_bf16 v[148:151], a[172:175], v[112:115], v[148:151]
 v_exp_f32 v100, v100
 v_mfma_f32_16x16x32_bf16 v[164:167], a[172:175], v[120:123], v[48:51]
 ds_read_b128 a[164:167], v6 offset:17216
 v_add_f32 v32, v32, v100
 v_mfma_f32_16x16x32_bf16 v[164:167], a[168:171], v[104:107], v[164:167]
 s_waitcnt lgkmcnt(5)
 v_exp_f32 v101, v101
 v_mfma_f32_16x16x32_bf16 v[140:143], a[176:179], v[128:131], v[140:143]
 ds_read_b128 a[168:171], v8 offset:17152
 v_add_f32 v32, v32, v101
 v_mfma_f32_16x16x32_bf16 v[140:143], a[180:183], v[144:147], v[140:143]
 v_exp_f32 v102, v102
 v_mfma_f32_16x16x32_bf16 v[156:159], a[180:183], v[152:155], v[156:159]
 s_add_u32 m0, s40, 0x1ae60
 v_exp_f32 v103, v103
 v_mfma_f32_16x16x32_bf16 v[156:159], a[176:179], v[136:139], v[156:159]
 s_waitcnt vmcnt(4)
 ds_read_b128 a[172:175], v8 offset:17216
 v_cvt_pk_bf16_f32 v100, v100, v101
 v_mfma_f32_16x16x32_bf16 v[172:175], a[176:179], v[228:231], v[172:175]
 buffer_load_dwordx4 v16, s[20:23], s56 offen offset:1536 nt lds
 v_add_f32 v32, v32, v102
 v_mfma_f32_16x16x32_bf16 v[172:175], a[180:183], v[236:239], v[172:175]
 s_waitcnt lgkmcnt(5)
 v_exp_f32 v108, v108
 v_mfma_f32_16x16x32_bf16 v[148:151], a[184:187], v[128:131], v[148:151]
 ds_read_b128 a[176:179], v7 offset:17152
 v_add_f32 v32, v32, v103
 v_mfma_f32_16x16x32_bf16 v[148:151], a[188:191], v[144:147], v[148:151]
 v_exp_f32 v109, v109
 v_mfma_f32_16x16x32_bf16 v[164:167], a[188:191], v[152:155], v[164:167]
 ds_read_b128 a[180:183], v7 offset:17216
 v_cvt_pk_bf16_f32 v101, v102, v103
 v_mfma_f32_16x16x32_bf16 v[164:167], a[184:187], v[136:139], v[164:167]
 s_waitcnt lgkmcnt(4)
 v_exp_f32 v110, v110
 v_mfma_f32_16x16x32_bf16 v[140:143], a[160:163], v[160:163], v[140:143]
 ds_read_b128 a[184:187], v9 offset:17152
 v_add_f32 v32, v32, v108
 v_mfma_f32_16x16x32_bf16 v[140:143], a[164:167], v[176:179], v[140:143]
 v_exp_f32 v111, v111
 v_mfma_f32_16x16x32_bf16 v[156:159], a[164:167], v[184:187], v[156:159]
 v_exp_f32 v116, v116
 v_mfma_f32_16x16x32_bf16 v[156:159], a[160:163], v[168:171], v[156:159]
 ds_read_b128 a[188:191], v9 offset:17216
 v_add_f32 v32, v32, v109
 v_mfma_f32_16x16x32_bf16 v[172:175], a[160:163], v[240:243], v[172:175]
 v_exp_f32 v117, v117
 v_mfma_f32_16x16x32_bf16 v[172:175], a[164:167], v[248:251], v[172:175]
 s_waitcnt lgkmcnt(4)
 v_exp_f32 v118, v118
 v_mfma_f32_16x16x32_bf16 v[148:151], a[168:171], v[160:163], v[148:151]
 s_barrier
 ds_read_b64_tr_b16 a[160:161], v2 offset:50688
 ds_read_b64_tr_b16 a[162:163], v4 offset:50688
 v_mfma_f32_16x16x32_bf16 v[148:151], a[172:175], v[176:179], v[148:151]
 s_xor_b32 s56, s42, 0x20000
 ds_read_b64 v[74:75], v22 offset:2048
 v_cvt_pk_bf16_f32 v102, v108, v109
 v_mfma_f32_16x16x32_bf16 v[164:167], a[172:175], v[184:187], v[164:167]
 s_add_u32 m0, s40, 0
 ds_read_b64_tr_b16 a[164:165], v3 offset:50688
 ds_read_b64_tr_b16 a[166:167], v5 offset:50688
 v_mfma_f32_16x16x32_bf16 v[164:167], a[168:171], v[168:171], v[164:167]
 s_waitcnt lgkmcnt(7)
 v_exp_f32 v119, v119
 v_mfma_f32_16x16x32_bf16 v[140:143], a[176:179], v[192:195], v[140:143]
 s_waitcnt vmcnt(4)
 ds_read_b64_tr_b16 a[168:169], v2 offset:50720
 ds_read_b64_tr_b16 a[170:171], v4 offset:50720
 v_mfma_f32_16x16x32_bf16 v[140:143], a[180:183], v[208:211], v[140:143]
 buffer_load_dwordx4 v16, s[16:19], s56 offen offset:0 nt lds
 v_add_f32 v32, v32, v110
 v_mfma_f32_16x16x32_bf16 v[156:159], a[180:183], v[216:219], v[156:159]
 v_exp_f32 v124, v124
 v_mfma_f32_16x16x32_bf16 v[156:159], a[176:179], v[200:203], v[156:159]
 ds_read_b64_tr_b16 a[172:173], v3 offset:50720
 ds_read_b64_tr_b16 a[174:175], v5 offset:50720
 v_mfma_f32_16x16x32_bf16 v[172:175], a[176:179], v[244:247], v[172:175]
 v_exp_f32 v125, v125
 v_mfma_f32_16x16x32_bf16 v[172:175], a[180:183], v[252:255], v[172:175]
 s_waitcnt lgkmcnt(9)
 v_exp_f32 v126, v126
 v_mfma_f32_16x16x32_bf16 v[148:151], a[184:187], v[192:195], v[148:151]
 ds_read_b64_tr_b16 a[176:177], v2 offset:50752
 ds_read_b64_tr_b16 a[178:179], v4 offset:50752
 v_mfma_f32_16x16x32_bf16 v[148:151], a[188:191], v[208:211], v[148:151]
 s_add_u32 m0, s40, 0x220
 v_exp_f32 v127, v127
 v_mfma_f32_16x16x32_bf16 v[164:167], a[188:191], v[216:219], v[164:167]
 s_waitcnt vmcnt(4)
 ds_read_b64_tr_b16 a[180:181], v3 offset:50752
 ds_read_b64_tr_b16 a[182:183], v5 offset:50752
 v_mfma_f32_16x16x32_bf16 v[164:167], a[184:187], v[200:203], v[164:167]
 s_waitcnt lgkmcnt(8)
 buffer_load_dwordx4 v16, s[16:19], s56 offen offset:512 nt lds
 v_add_f32 v32, v32, v111
 v_mfma_f32_16x16x32_bf16 a[0:3], a[160:163], v[56:59], a[0:3]
 ds_read_b64_tr_b16 a[184:185], v2 offset:50784
 ds_read_b64_tr_b16 a[186:187], v4 offset:50784
 v_mfma_f32_16x16x32_bf16 a[128:131], a[160:163], v[72:75], a[128:131]
 v_cvt_pk_bf16_f32 v103, v110, v111
 v_add_f32 v33, v33, v116
 v_mfma_f32_16x16x32_bf16 a[8:11], a[160:163], v[64:67], a[8:11]
 s_cbranch_vccnz L_stub_5_B0
L_stub_5_B0_ret:
 v_add_f32 v33, v33, v117
 v_mfma_f32_16x16x32_bf16 a[40:43], a[164:167], v[64:67], a[40:43]
 ds_read_b64_tr_b16 a[188:189], v3 offset:50784
 ds_read_b64_tr_b16 a[190:191], v5 offset:50784
 v_mfma_f32_16x16x32_bf16 a[32:35], a[164:167], v[56:59], a[32:35]
 s_waitcnt lgkmcnt(8)
 v_cvt_pk_bf16_f32 v116, v116, v117
 v_add_f32 v33, v33, v118
 v_mfma_f32_16x16x32_bf16 a[4:7], a[168:171], v[56:59], a[4:7]
 ds_read_b64_tr_b16 a[160:161], v2 offset:50944
 ds_read_b64_tr_b16 a[162:163], v4 offset:50944
 v_mfma_f32_16x16x32_bf16 a[132:135], a[168:171], v[72:75], a[132:135]
 v_add_f32 v33, v33, v119
 v_cvt_pk_bf16_f32 v117, v118, v119
 v_mfma_f32_16x16x32_bf16 a[12:15], a[168:171], v[64:67], a[12:15]
 s_add_u32 m0, s40, 0x440
 v_add_f32 v33, v33, v124
 v_add_f32 v33, v33, v125
 v_mfma_f32_16x16x32_bf16 a[44:47], a[172:175], v[64:67], a[44:47]
 s_waitcnt vmcnt(4)
 ds_read_b64_tr_b16 a[164:165], v3 offset:50944
 ds_read_b64_tr_b16 a[166:167], v5 offset:50944
 v_mfma_f32_16x16x32_bf16 a[36:39], a[172:175], v[56:59], a[36:39]
 s_waitcnt lgkmcnt(8)
 buffer_load_dwordx4 v16, s[16:19], s56 offen offset:1024 nt lds
 v_cvt_pk_bf16_f32 v118, v124, v125
 v_mfma_f32_16x16x32_bf16 a[16:19], a[176:179], v[56:59], a[16:19]
 ds_read_b64_tr_b16 a[168:169], v2 offset:50976
 ds_read_b64_tr_b16 a[170:171], v4 offset:50976
 v_mfma_f32_16x16x32_bf16 a[136:139], a[176:179], v[72:75], a[136:139]
 v_add_f32 v33, v33, v126
 v_add_f32 v33, v33, v127
 v_mfma_f32_16x16x32_bf16 a[24:27], a[176:179], v[64:67], a[24:27]
 v_cvt_pk_bf16_f32 v119, v126, v127
 v_mfma_f32_16x16x32_bf16 a[56:59], a[180:183], v[64:67], a[56:59]
 ds_read_b64_tr_b16 a[172:173], v3 offset:50976
 ds_read_b64_tr_b16 a[174:175], v5 offset:50976
 v_mfma_f32_16x16x32_bf16 a[48:51], a[180:183], v[56:59], a[48:51]
 s_waitcnt lgkmcnt(8)
 v_exp_f32 v172, v172
 v_mfma_f32_16x16x32_bf16 a[20:23], a[184:187], v[56:59], a[20:23]
 ds_read_b64_tr_b16 a[176:177], v2 offset:51008
 ds_read_b64_tr_b16 a[178:179], v4 offset:51008
 v_mfma_f32_16x16x32_bf16 a[140:143], a[184:187], v[72:75], a[140:143]
 v_exp_f32 v173, v173
 v_mfma_f32_16x16x32_bf16 a[28:31], a[184:187], v[64:67], a[28:31]
 s_add_u32 m0, s40, 0x660
 v_exp_f32 v174, v174
 v_mfma_f32_16x16x32_bf16 a[60:63], a[188:191], v[64:67], a[60:63]
 s_waitcnt vmcnt(4)
 ds_read_b64_tr_b16 a[180:181], v3 offset:51008
 ds_read_b64_tr_b16 a[182:183], v5 offset:51008
 v_mfma_f32_16x16x32_bf16 a[52:55], a[188:191], v[56:59], a[52:55]
 s_waitcnt lgkmcnt(8)
 buffer_load_dwordx4 v16, s[16:19], s56 offen offset:1536 nt lds
 v_mfma_f32_16x16x32_bf16 a[64:67], a[160:163], v[56:59], a[64:67]
 ds_read_b64_tr_b16 a[184:185], v2 offset:51040
 ds_read_b64_tr_b16 a[186:187], v4 offset:51040
 v_mfma_f32_16x16x32_bf16 a[144:147], a[160:163], v[72:75], a[144:147]
 v_exp_f32 v175, v175
 v_mfma_f32_16x16x32_bf16 a[72:75], a[160:163], v[64:67], a[72:75]
 v_add_f32 v34, v34, v172
 v_add_f32 v34, v34, v173
 v_mfma_f32_16x16x32_bf16 a[104:107], a[164:167], v[64:67], a[104:107]
 ds_read_b64_tr_b16 a[188:189], v3 offset:51040
 ds_read_b64_tr_b16 a[190:191], v5 offset:51040
 v_mfma_f32_16x16x32_bf16 a[96:99], a[164:167], v[56:59], a[96:99]
 s_waitcnt lgkmcnt(8)
 v_cvt_pk_bf16_f32 v172, v172, v173
 v_add_f32 v34, v34, v174
 v_mfma_f32_16x16x32_bf16 a[68:71], a[168:171], v[56:59], a[68:71]
 s_mov_b64 exec, 0
 s_cmp_eq_u32 s5, 0
 s_cbranch_scc1 L_pad6
 s_cmp_eq_u32 s5, 1
 s_cbranch_scc1 L_pad7
 s_cmp_eq_u32 s5, 2
 s_cbranch_scc1 L_pad8
 s_branch L_e1_back
L_e1_back:
 s_mov_b64 exec, -1
 s_barrier
 ds_read_b128 a[160:163], v6 offset:33792
 v_mfma_f32_16x16x32_bf16 a[148:151], a[168:171], v[72:75], a[148:151]
 v_add_f32 v34, v34, v175
 v_cvt_pk_bf16_f32 v173, v174, v175
 v_mfma_f32_16x16x32_bf16 a[76:79], a[168:171], v[64:67], a[76:79]
 ds_write_b64 v21, v[172:173] offset:2048
 v_mfma_f32_16x16x32_bf16 a[108:111], a[172:175], v[64:67], a[108:111]
 ds_read_b128 a[164:167], v6 offset:33856
 v_mfma_f32_16x16x32_bf16 a[100:103], a[172:175], v[56:59], a[100:103]
 s_waitcnt lgkmcnt(7)
 v_exp_f32 v140, v140
 v_mfma_f32_16x16x32_bf16 a[80:83], a[176:179], v[56:59], a[80:83]
 ds_read_b128 a[168:171], v8 offset:33792
 v_add_f32 v32, v32, v140
 v_mfma_f32_16x16x32_bf16 a[152:155], a[176:179], v[72:75], a[152:155]
 v_exp_f32 v141, v141
 v_mfma_f32_16x16x32_bf16 a[88:91], a[176:179], v[64:67], a[88:91]
 s_xor_b32 s56, s43, 0x18000
 v_exp_f32 v142, v142
 v_mfma_f32_16x16x32_bf16 a[120:123], a[180:183], v[64:67], a[120:123]
 s_add_u32 m0, s40, 0x1ea00
 ds_read_b128 a[172:175], v8 offset:33856
 v_add_f32 v32, v32, v141
 v_mfma_f32_16x16x32_bf16 a[112:115], a[180:183], v[56:59], a[112:115]
 s_waitcnt lgkmcnt(5)
 v_exp_f32 v143, v143
 v_mfma_f32_16x16x32_bf16 a[84:87], a[184:187], v[56:59], a[84:87]
 s_waitcnt vmcnt(4)
 ds_read_b128 a[176:179], v7 offset:33792
 v_cvt_pk_bf16_f32 v140, v140, v141
 v_mfma_f32_16x16x32_bf16 a[156:159], a[184:187], v[72:75], a[156:159]
 buffer_load_dwordx4 v16, s[20:23], s56 offen offset:0 nt lds
 v_add_f32 v32, v32, v142
 v_mfma_f32_16x16x32_bf16 a[92:95], a[184:187], v[64:67], a[92:95]
 v_exp_f32 v148, v148
 v_mfma_f32_16x16x32_bf16 a[124:127], a[188:191], v[64:67], a[124:127]
 ds_read_b128 a[180:183], v7 offset:33856
 v_add_f32 v32, v32, v143
 v_mfma_f32_16x16x32_bf16 a[116:119], a[188:191], v[56:59], a[116:119]
 s_waitcnt lgkmcnt(4)
 v_exp_f32 v149, v149
 v_mfma_f32_16x16x32_bf16 v[56:59], a[160:163], v[96:99], v[44:47]
 ds_read_b128 a[184:187], v9 offset:33792
 v_cvt_pk_bf16_f32 v141, v142, v143
 v_mfma_f32_16x16x32_bf16 v[56:59], a[164:167], v[112:115], v[56:59]
L_pad5:
 s_cbranch_execz L_e0_back
 v_exp_f32 v150, v150
 v_mfma_f32_16x16x32_bf16 v[64:67], a[164:167], v[120:123], v[48:51]
 v_exp_f32 v151, v151
 v_mfma_f32_16x16x32_bf16 v[64:67], a[160:163], v[104:107], v[64:67]
 s_add_u32 m0, s40, 0x1ec20
 ds_read_b128 a[188:191], v9 offset:33856
 v_add_f32 v32, v32, v148
 v_mfma_f32_16x16x32_bf16 v[72:75], a[160:163], v[224:227], v[52:55]
 s_waitcnt vmcnt(4)
 v_exp_f32 v156, v156
 v_mfma_f32_16x16x32_bf16 v[72:75], a[164:167], v[232:235], v[72:75]
 s_waitcnt lgkmcnt(4)
 buffer_load_dwordx4 v16, s[20:23], s56 offen offset:512 nt lds
 v_add_f32 v32, v32, v149
 v_mfma_f32_16x16x32_bf16 v[60:63], a[168:171], v[96:99], v[44:47]
 ds_read_b128 a[160:163], v6 offset:34048
 v_cvt_pk_bf16_f32 v142, v148, v149
 v_mfma_f32_16x16x32_bf16 v[60:63], a[172:175], v[112:115], v[60:63]
 v_exp_f32 v157, v157
 v_mfma_f32_16x16x32_bf16 v[68:71], a[172:175], v[120:123], v[48:51]
 ds_read_b128 a[164:167], v6 offset:34112
 v_add_f32 v32, v32, v150
 v_mfma_f32_16x16x32_bf16 v[68:71], a[168:171], v[104:107], v[68:71]
 s_waitcnt lgkmcnt(4)
 v_exp_f32 v158, v158
 v_mfma_f32_16x16x32_bf16 v[56:59], a[176:179], v[128:131], v[56:59]
 ds_read_b128 a[168:171], v8 offset:34048
 v_add_f32 v32, v32, v151
 v_mfma_f32_16x16x32_bf16 v[56:59], a[180:183], v[144:147], v[56:59]
 v_exp_f32 v159, v159
 v_mfma_f32_16x16x32_bf16 v[64:67], a[180:183], v[152:155], v[64:67]
 v_exp_f32 v164, v164
 v_mfma_f32_16x16x32_bf16 v[64:67], a[176:179], v[136:139], v[64:67]
 s_add_u32 m0, s40, 0x1ee40
 ds_read_b128 a[172:175], v8 offset:34112
 v_cvt_pk_bf16_f32 v143, v150, v151
 v_mfma_f32_16x16x32_bf16 v[72:75], a[176:179], v[228:231], v[72:75]
 s_waitcnt vmcnt(4)
 v_exp_f32 v165, v165
 v_mfma_f32_16x16x32_bf16 v[72:75], a[180:183], v[236:239], v[72:75]
 s_waitcnt lgkmcnt(4)
 buffer_load_dwordx4 v16, s[20:23], s56 offen offset:1024 nt lds
 v_add_f32 v33, v33, v156
 v_mfma_f32_16x16x32_bf16 v[60:63], a[184:187], v[128:131], v[60:63]
 ds_read_b128 a[176:179], v7 offset:34048
 v_add_f32 v33, v33, v157
 v_mfma_f32_16x16x32_bf16 v[60:63], a[188:191], v[144:147], v[60:63]
 v_exp_f32 v166, v166
 v_mfma_f32_16x16x32_bf16 v[68:71], a[188:191], v[152:155], v[68:71]
 ds_read_b128 a[180:183], v7 offset:34112
 v_cvt_pk_bf16_f32 v156, v156, v157
 v_mfma_f32_16x16x32_bf16 v[68:71], a[184:187], v[136:139], v[68:71]
 s_waitcnt lgkmcnt(4)
 v_exp_f32 v167, v167
 v_mfma_f32_16x16x32_bf16 v[56:59], a[160:163], v[160:163], v[56:59]
 ds_read_b128 a[184:187], v9 offset:34048
 v_add_f32 v33, v33, v158
 v_mfma_f32_16x16x32_bf16 v[56:59], a[164:167], v[176:179], v[56:59]
 v_add_f32 v33, v33, v159
 v_cvt_pk_bf16_f32 v157, v158, v159
 v_mfma_f32_16x16x32_bf16 v[64:67], a[164:167], v[184:187], v[64:67]
 v_add_f32 v33, v33, v164
 v_add_f32 v33, v33, v165
 v_mfma_f32_16x16x32_bf16 v[64:67], a[160:163], v[168:171], v[64:67]
 ds_read_b128 a[188:191], v9 offset:34112
 v_cvt_pk_bf16_f32 v158, v164, v165
 v_mfma_f32_16x16x32_bf16 v[72:75], a[160:163], v[240:243], v[72:75]
 v_add_f32 v33, v33, v166
 v_add_f32 v33, v33, v167
 v_mfma_f32_16x16x32_bf16 v[72:75], a[164:167], v[248:251], v[72:75]
 s_waitcnt lgkmcnt(4)
 v_cvt_pk_bf16_f32 v159, v166, v167
 v_mfma_f32_16x16x32_bf16 v[60:63], a[168:171], v[160:163], v[60:63]
 s_barrier
 ds_read_b64_tr_b16 a[160:161], v2 offset:0
 ds_read_b64_tr_b16 a[162:163], v4 offset:0
 v_mfma_f32_16x16x32_bf16 v[60:63], a[172:175], v[176:179], v[60:63]
 ds_read_b64 v[134:135], v22 offset:0
 v_mfma_f32_16x16x32_bf16 v[68:71], a[172:175], v[184:187], v[68:71]
 ds_read_b64_tr_b16 a[164:165], v3 offset:0
 ds_read_b64_tr_b16 a[166:167], v5 offset:0
 v_mfma_f32_16x16x32_bf16 v[68:71], a[168:171], v[168:171], v[68:71]
 s_waitcnt lgkmcnt(7)
 v_mfma_f32_16x16x32_bf16 v[56:59], a[176:179], v[192:195], v[56:59]
 s_xor_b32 s56, s43, 0x18000
 ds_read_b64_tr_b16 a[168:169], v2 offset:32
 ds_read_b64_tr_b16 a[170:171], v4 offset:32
 v_mfma_f32_16x16x32_bf16 v[56:59], a[180:183], v[208:211], v[56:59]
 s_add_u32 m0, s40, 0x1f060
 v_mfma_f32_16x16x32_bf16 v[64:67], a[180:183], v[216:219], v[64:67]
 s_waitcnt vmcnt(4)
 v_mfma_f32_16x16x32_bf16 v[64:67], a[176:179], v[200:203], v[64:67]
 ds_read_b64_tr_b16 a[172:173], v3 offset:32
 ds_read_b64_tr_b16 a[174:175], v5 offset:32
 v_mfma_f32_16x16x32_bf16 v[72:75], a[176:179], v[244:247], v[72:75]
 buffer_load_dwordx4 v16, s[20:23], s56 offen offset:1536 nt lds
 v_mfma_f32_16x16x32_bf16 v[72:75], a[180:183], v[252:255], v[72:75]
 s_waitcnt lgkmcnt(9)
 v_mfma_f32_16x16x32_bf16 v[60:63], a[184:187], v[192:195], v[60:63]
 ds_read_b64_tr_b16 a[176:177], v2 offset:64
 ds_read_b64_tr_b16 a[178:179], v4 offset:64
 v_mfma_f32_16x16x32_bf16 v[60:63], a[188:191], v[208:211], v[60:63]
 v_mfma_f32_16x16x32_bf16 v[68:71], a[188:191], v[216:219], v[68:71]
 ds_read_b64_tr_b16 a[180:181], v3 offset:64
 ds_read_b64_tr_b16 a[182:183], v5 offset:64
 v_mfma_f32_16x16x32_bf16 v[68:71], a[184:187], v[200:203], v[68:71]
 s_waitcnt lgkmcnt(8)
 v_mfma_f32_16x16x32_bf16 a[0:3], a[160:163], v[100:103], a[0:3]
 s_xor_b32 s56, s42, 0x24000
 ds_read_b64_tr_b16 a[184:185], v2 offset:96
 ds_read_b64_tr_b16 a[186:187], v4 offset:96
 v_mfma_f32_16x16x32_bf16 a[128:131], a[160:163], v[132:135], a[128:131]
 s_add_u32 m0, s40, 0x4200
 v_mfma_f32_16x16x32_bf16 a[8:11], a[160:163], v[116:119], a[8:11]
 s_cbranch_vccnz L_stub_6_B0
L_stub_6_B0_ret:
 v_mfma_f32_16x16x32_bf16 a[40:43], a[164:167], v[116:119], a[40:43]
 s_waitcnt vmcnt(4)
 ds_read_b64_tr_b16 a[188:189], v3 offset:96
 ds_read_b64_tr_b16 a[190:191], v5 offset:96
 v_mfma_f32_16x16x32_bf16 a[32:35], a[164:167], v[100:103], a[32:35]
 s_waitcnt lgkmcnt(8)
 buffer_load_dwordx4 v16, s[16:19], s56 offen offset:0 nt lds
 v_mfma_f32_16x16x32_bf16 a[4:7], a[168:171], v[100:103], a[4:7]
 ds_read_b64_tr_b16 a[160:161], v2 offset:256
 ds_read_b64_tr_b16 a[162:163], v4 offset:256
 v_mfma_f32_16x16x32_bf16 a[132:135], a[168:171], v[132:135], a[132:135]
 v_exp_f32 v72, v72
 v_mfma_f32_16x16x32_bf16 a[12:15], a[168:171], v[116:119], a[12:15]
 v_exp_f32 v73, v73
 v_mfma_f32_16x16x32_bf16 a[44:47], a[172:175], v[116:119], a[44:47]
 ds_read_b64_tr_b16 a[164:165], v3 offset:256
 ds_read_b64_tr_b16 a[166:167], v5 offset:256
 v_mfma_f32_16x16x32_bf16 a[36:39], a[172:175], v[100:103], a[36:39]
 s_waitcnt lgkmcnt(8)
 v_exp_f32 v74, v74
 v_mfma_f32_16x16x32_bf16 a[16:19], a[176:179], v[100:103], a[16:19]
 s_add_u32 m0, s40, 0x4420
 ds_read_b64_tr_b16 a[168:169], v2 offset:288
 ds_read_b64_tr_b16 a[170:171], v4 offset:288
 v_mfma_f32_16x16x32_bf16 a[136:139], a[176:179], v[132:135], a[136:139]
 s_waitcnt vmcnt(4)
 v_exp_f32 v75, v75
 v_mfma_f32_16x16x32_bf16 a[24:27], a[176:179], v[116:119], a[24:27]
 buffer_load_dwordx4 v16, s[16:19], s56 offen offset:512 nt lds
 v_add_f32 v34, v34, v72
 v_mfma_f32_16x16x32_bf16 a[56:59], a[180:183], v[116:119], a[56:59]
 ds_read_b64_tr_b16 a[172:173], v3 offset:288
 ds_read_b64_tr_b16 a[174:175], v5 offset:288
 v_mfma_f32_16x16x32_bf16 a[48:51], a[180:183], v[100:103], a[48:51]
 s_waitcnt lgkmcnt(8)
 v_add_f32 v34, v34, v73
 v_cvt_pk_bf16_f32 v72, v72, v73
 v_mfma_f32_16x16x32_bf16 a[20:23], a[184:187], v[100:103], a[20:23]
 ds_read_b64_tr_b16 a[176:177], v2 offset:320
 ds_read_b64_tr_b16 a[178:179], v4 offset:320
 v_mfma_f32_16x16x32_bf16 a[140:143], a[184:187], v[132:135], a[140:143]
 v_add_f32 v34, v34, v74
 v_add_f32 v34, v34, v75
 v_mfma_f32_16x16x32_bf16 a[28:31], a[184:187], v[116:119], a[28:31]
 v_cvt_pk_bf16_f32 v73, v74, v75
 v_mfma_f32_16x16x32_bf16 a[60:63], a[188:191], v[116:119], a[60:63]
 ds_read_b64_tr_b16 a[180:181], v3 offset:320
 ds_read_b64_tr_b16 a[182:183], v5 offset:320
 v_mfma_f32_16x16x32_bf16 a[52:55], a[188:191], v[100:103], a[52:55]
 s_waitcnt lgkmcnt(8)
 v_exp_f32 v56, v56
 v_mfma_f32_16x16x32_bf16 a[64:67], a[160:163], v[100:103], a[64:67]
 s_add_u32 m0, s40, 0x4640
 ds_read_b64_tr_b16 a[184:185], v2 offset:352
 ds_read_b64_tr_b16 a[186:187], v4 offset:352
 v_mfma_f32_16x16x32_bf16 a[144:147], a[160:163], v[132:135], a[144:147]
 s_waitcnt vmcnt(4)
 v_exp_f32 v57, v57
 v_mfma_f32_16x16x32_bf16 a[72:75], a[160:163], v[116:119], a[72:75]
 buffer_load_dwordx4 v16, s[16:19], s56 offen offset:1024 nt lds
 v_add_f32 v32, v32, v56
 v_mfma_f32_16x16x32_bf16 a[104:107], a[164:167], v[116:119], a[104:107]
 ds_read_b64_tr_b16 a[188:189], v3 offset:352
 ds_read_b64_tr_b16 a[190:191], v5 offset:352
 v_mfma_f32_16x16x32_bf16 a[96:99], a[164:167], v[100:103], a[96:99]
 s_waitcnt lgkmcnt(8)
 v_exp_f32 v58, v58
 v_mfma_f32_16x16x32_bf16 a[68:71], a[168:171], v[100:103], a[68:71]
 s_barrier
 ds_read_b128 a[160:163], v6 offset:50688
 v_mfma_f32_16x16x32_bf16 a[148:151], a[168:171], v[132:135], a[148:151]
 ds_write_b64 v21, v[72:73] offset:0
 v_add_f32 v32, v32, v57
 v_mfma_f32_16x16x32_bf16 a[76:79], a[168:171], v[116:119], a[76:79]
 v_exp_f32 v59, v59
 v_mfma_f32_16x16x32_bf16 a[108:111], a[172:175], v[116:119], a[108:111]
 ds_read_b128 a[164:167], v6 offset:50752
 v_cvt_pk_bf16_f32 v56, v56, v57
 v_mfma_f32_16x16x32_bf16 a[100:103], a[172:175], v[100:103], a[100:103]
 s_waitcnt lgkmcnt(7)
 v_exp_f32 v60, v60
 v_mfma_f32_16x16x32_bf16 a[80:83], a[176:179], v[100:103], a[80:83]
 ds_read_b128 a[168:171], v8 offset:50688
 v_add_f32 v32, v32, v58
 v_mfma_f32_16x16x32_bf16 a[152:155], a[176:179], v[132:135], a[152:155]
 v_exp_f32 v61, v61
 v_mfma_f32_16x16x32_bf16 a[88:91], a[176:179], v[116:119], a[88:91]
 v_exp_f32 v62, v62
 v_mfma_f32_16x16x32_bf16 a[120:123], a[180:183], v[116:119], a[120:123]
 ds_read_b128 a[172:175], v8 offset:50752
 v_add_f32 v32, v32, v59
 v_mfma_f32_16x16x32_bf16 a[112:115], a[180:183], v[100:103], a[112:115]
 s_waitcnt lgkmcnt(5)
 v_exp_f32 v63, v63
 v_mfma_f32_16x16x32_bf16 a[84:87], a[184:187], v[100:103], a[84:87]
 s_xor_b32 s56, s42, 0x24000
 ds_read_b128 a[176:179], v7 offset:50688
 v_cvt_pk_bf16_f32 v57, v58, v59
 v_mfma_f32_16x16x32_bf16 a[156:159], a[184:187], v[132:135], a[156:159]
 s_add_u32 m0, s40, 0x4860
 v_exp_f32 v64, v64
 v_mfma_f32_16x16x32_bf16 a[92:95], a[184:187], v[116:119], a[92:95]
 s_waitcnt vmcnt(4)
 v_exp_f32 v65, v65
 v_mfma_f32_16x16x32_bf16 a[124:127], a[188:191], v[116:119], a[124:127]
 ds_read_b128 a[180:183], v7 offset:50752
 buffer_load_dwordx4 v16, s[16:19], s56 offen offset:1536 nt lds
 v_mfma_f32_16x16x32_bf16 a[116:119], a[188:191], v[100:103], a[116:119]
 s_waitcnt lgkmcnt(4)
 v_exp_f32 v66, v66
 v_mfma_f32_16x16x32_bf16 v[100:103], a[160:163], v[96:99], v[44:47]
 ds_read_b128 a[184:187], v9 offset:50688
 v_add_f32 v32, v32, v60
 v_mfma_f32_16x16x32_bf16 v[100:103], a[164:167], v[112:115], v[100:103]
 v_exp_f32 v67, v67
 v_mfma_f32_16x16x32_bf16 v[116:119], a[164:167], v[120:123], v[48:51]
 v_exp_f32 v68, v68
 v_mfma_f32_16x16x32_bf16 v[116:119], a[160:163], v[104:107], v[116:119]
 ds_read_b128 a[188:191], v9 offset:50752
 v_add_f32 v32, v32, v61
 v_mfma_f32_16x16x32_bf16 v[132:135], a[160:163], v[224:227], v[52:55]
 v_exp_f32 v69, v69
 v_mfma_f32_16x16x32_bf16 v[132:135], a[164:167], v[232:235], v[132:135]
 s_waitcnt lgkmcnt(4)
 v_exp_f32 v70, v70
 v_mfma_f32_16x16x32_bf16 v[108:111], a[168:171], v[96:99], v[44:47]
 s_xor_b32 s56, s43, 0x1c000
 ds_read_b128 a[160:163], v6 offset:50944
 v_cvt_pk_bf16_f32 v58, v60, v61
 v_mfma_f32_16x16x32_bf16 v[108:111], a[172:175], v[112:115], v[108:111]
 s_add_u32 m0, s40, 0x22c00
 v_exp_f32 v71, v71
 v_mfma_f32_16x16x32_bf16 v[124:127], a[172:175], v[120:123], v[48:51]
 s_waitcnt vmcnt(4)
 ds_read_b128 a[164:167], v6 offset:51008
 v_add_f32 v32, v32, v62
 v_mfma_f32_16x16x32_bf16 v[124:127], a[168:171], v[104:107], v[124:127]
 s_waitcnt lgkmcnt(4)
 buffer_load_dwordx4 v16, s[20:23], s56 offen offset:0 nt lds
 v_add_f32 v32, v32, v63
 v_mfma_f32_16x16x32_bf16 v[100:103], a[176:179], v[128:131], v[100:103]
 ds_read_b128 a[168:171], v8 offset:50944
 v_cvt_pk_bf16_f32 v59, v62, v63
 v_mfma_f32_16x16x32_bf16 v[100:103], a[180:183], v[144:147], v[100:103]
 v_add_f32 v33, v33, v64
 v_add_f32 v33, v33, v65
 v_mfma_f32_16x16x32_bf16 v[116:119], a[180:183], v[152:155], v[116:119]
 v_cvt_pk_bf16_f32 v64, v64, v65
 v_add_f32 v33, v33, v66
 v_mfma_f32_16x16x32_bf16 v[116:119], a[176:179], v[136:139], v[116:119]
 ds_read_b128 a[172:175], v8 offset:51008
 v_add_f32 v33, v33, v67
 v_mfma_f32_16x16x32_bf16 v[132:135], a[176:179], v[228:231], v[132:135]
 v_cvt_pk_bf16_f32 v65, v66, v67
 v_add_f32 v33, v33, v68
 v_mfma_f32_16x16x32_bf16 v[132:135], a[180:183], v[236:239], v[132:135]
 s_waitcnt lgkmcnt(4)
 v_add_f32 v33, v33, v69
 v_cvt_pk_bf16_f32 v66, v68, v69
 v_mfma_f32_16x16x32_bf16 v[108:111], a[184:187], v[128:131], v[108:111]
 s_add_u32 m0, s40, 0x22e20
 ds_read_b128 a[176:179], v7 offset:50944
 v_add_f32 v33, v33, v70
 v_mfma_f32_16x16x32_bf16 v[108:111], a[188:191], v[144:147], v[108:111]
 s_waitcnt vmcnt(4)
 v_add_f32 v33, v33, v71
 v_cvt_pk_bf16_f32 v67, v70, v71
 v_mfma_f32_16x16x32_bf16 v[124:127], a[188:191], v[152:155], v[124:127]
 ds_read_b128 a[180:183], v7 offset:51008
 buffer_load_dwordx4 v16, s[20:23], s56 offen offset:512 nt lds
 v_mfma_f32_16x16x32_bf16 v[124:127], a[184:187], v[136:139], v[124:127]
 s_waitcnt lgkmcnt(4)
 v_mfma_f32_16x16x32_bf16 v[100:103], a[160:163], v[160:163], v[100:103]
 ds_read_b128 a[184:187], v9 offset:50944
 v_mfma_f32_16x16x32_bf16 v[100:103], a[164:167], v[176:179], v[100:103]
 v_mfma_f32_16x16x32_bf16 v[116:119], a[164:167], v[184:187], v[116:119]
 v_mfma_f32_16x16x32_bf16 v[116:119], a[160:163], v[168:171], v[116:119]
 ds_read_b128 a[188:191], v9 offset:51008
 v_mfma_f32_16x16x32_bf16 v[132:135], a[160:163], v[240:243], v[132:135]
 v_mfma_f32_16x16x32_bf16 v[132:135], a[164:167], v[248:251], v[132:135]
 s_waitcnt lgkmcnt(4)
 v_mfma_f32_16x16x32_bf16 v[108:111], a[168:171], v[160:163], v[108:111]
 s_barrier
 ds_read_b64_tr_b16 a[160:161], v2 offset:16896
 ds_read_b64_tr_b16 a[162:163], v4 offset:16896
 v_mfma_f32_16x16x32_bf16 v[108:111], a[172:175], v[176:179], v[108:111]
 ds_read_b64 v[174:175], v22 offset:2048
 v_mfma_f32_16x16x32_bf16 v[124:127], a[172:175], v[184:187], v[124:127]
 ds_read_b64_tr_b16 a[164:165], v3 offset:16896
 ds_read_b64_tr_b16 a[166:167], v5 offset:16896
 v_mfma_f32_16x16x32_bf16 v[124:127], a[168:171], v[168:171], v[124:127]
 s_waitcnt lgkmcnt(7)
 v_mfma_f32_16x16x32_bf16 v[100:103], a[176:179], v[192:195], v[100:103]
 s_xor_b32 s56, s43, 0x1c000
 ds_read_b64_tr_b16 a[168:169], v2 offset:16928
 ds_read_b64_tr_b16 a[170:171], v4 offset:16928
 v_mfma_f32_16x16x32_bf16 v[100:103], a[180:183], v[208:211], v[100:103]
 s_add_u32 m0, s40, 0x23040
 v_mfma_f32_16x16x32_bf16 v[116:119], a[180:183], v[216:219], v[116:119]
 s_waitcnt vmcnt(4)
 v_mfma_f32_16x16x32_bf16 v[116:119], a[176:179], v[200:203], v[116:119]
 ds_read_b64_tr_b16 a[172:173], v3 offset:16928
 ds_read_b64_tr_b16 a[174:175], v5 offset:16928
 v_mfma_f32_16x16x32_bf16 v[132:135], a[176:179], v[244:247], v[132:135]
 buffer_load_dwordx4 v16, s[20:23], s56 offen offset:1024 nt lds
 v_mfma_f32_16x16x32_bf16 v[132:135], a[180:183], v[252:255], v[132:135]
 s_waitcnt lgkmcnt(9)
 v_mfma_f32_16x16x32_bf16 v[108:111], a[184:187], v[192:195], v[108:111]
 ds_read_b64_tr_b16 a[176:177], v2 offset:16960
 ds_read_b64_tr_b16 a[178:179], v4 offset:16960
 v_mfma_f32_16x16x32_bf16 v[108:111], a[188:191], v[208:211], v[108:111]
 v_mfma_f32_16x16x32_bf16 v[124:127], a[188:191], v[216:219], v[124:127]
 ds_read_b64_tr_b16 a[180:181], v3 offset:16960
 ds_read_b64_tr_b16 a[182:183], v5 offset:16960
 v_mfma_f32_16x16x32_bf16 v[124:127], a[184:187], v[200:203], v[124:127]
 s_waitcnt lgkmcnt(8)
 v_mfma_f32_16x16x32_bf16 a[0:3], a[160:163], v[140:143], a[0:3]
 s_add_u32 m0, s40, 0x23260
 ds_read_b64_tr_b16 a[184:185], v2 offset:16992
 ds_read_b64_tr_b16 a[186:187], v4 offset:16992
 v_mfma_f32_16x16x32_bf16 a[128:131], a[160:163], v[172:175], a[128:131]
 s_waitcnt vmcnt(4)
 v_mfma_f32_16x16x32_bf16 a[8:11], a[160:163], v[156:159], a[8:11]
 s_cbranch_vccnz L_stub_7_B0
L_stub_7_B0_ret:
 buffer_load_dwordx4 v16, s[20:23], s56 offen offset:1536 nt lds
 v_mfma_f32_16x16x32_bf16 a[40:43], a[164:167], v[156:159], a[40:43]
 ds_read_b64_tr_b16 a[188:189], v3 offset:16992
 ds_read_b64_tr_b16 a[190:191], v5 offset:16992
 v_mfma_f32_16x16x32_bf16 a[32:35], a[164:167], v[140:143], a[32:35]
 s_waitcnt lgkmcnt(8)
 v_exp_f32 v132, v132
 v_mfma_f32_16x16x32_bf16 a[4:7], a[168:171], v[140:143], a[4:7]
 ds_read_b64_tr_b16 a[160:161], v2 offset:17152
 ds_read_b64_tr_b16 a[162:163], v4 offset:17152
 v_mfma_f32_16x16x32_bf16 a[132:135], a[168:171], v[172:175], a[132:135]
 v_exp_f32 v133, v133
 v_mfma_f32_16x16x32_bf16 a[12:15], a[168:171], v[156:159], a[12:15]
 v_exp_f32 v134, v134
 v_mfma_f32_16x16x32_bf16 a[44:47], a[172:175], v[156:159], a[44:47]
 ds_read_b64_tr_b16 a[164:165], v3 offset:17152
 ds_read_b64_tr_b16 a[166:167], v5 offset:17152
 v_mfma_f32_16x16x32_bf16 a[36:39], a[172:175], v[140:143], a[36:39]
 s_waitcnt lgkmcnt(8)
 v_exp_f32 v135, v135
 v_mfma_f32_16x16x32_bf16 a[16:19], a[176:179], v[140:143], a[16:19]
 s_xor_b32 s56, s42, 0x28000
 ds_read_b64_tr_b16 a[168:169], v2 offset:17184
 ds_read_b64_tr_b16 a[170:171], v4 offset:17184
 v_mfma_f32_16x16x32_bf16 a[136:139], a[176:179], v[172:175], a[136:139]
 s_add_u32 m0, s40, 0x8400
 v_add_f32 v34, v34, v132
 v_add_f32 v34, v34, v133
 v_mfma_f32_16x16x32_bf16 a[24:27], a[176:179], v[156:159], a[24:27]
 s_waitcnt vmcnt(4)
 v_cvt_pk_bf16_f32 v132, v132, v133
 v_add_f32 v34, v34, v134
 v_mfma_f32_16x16x32_bf16 a[56:59], a[180:183], v[156:159], a[56:59]
 ds_read_b64_tr_b16 a[172:173], v3 offset:17184
 ds_read_b64_tr_b16 a[174:175], v5 offset:17184
 v_mfma_f32_16x16x32_bf16 a[48:51], a[180:183], v[140:143], a[48:51]
 s_waitcnt lgkmcnt(8)
 buffer_load_dwordx4 v16, s[16:19], s56 offen offset:0 nt lds
 v_add_f32 v34, v34, v135
 v_mfma_f32_16x16x32_bf16 a[20:23], a[184:187], v[140:143], a[20:23]
 ds_read_b64_tr_b16 a[176:177], v2 offset:17216
 ds_read_b64_tr_b16 a[178:179], v4 offset:17216
 v_mfma_f32_16x16x32_bf16 a[140:143], a[184:187], v[172:175], a[140:143]
 v_cvt_pk_bf16_f32 v133, v134, v135
 v_mfma_f32_16x16x32_bf16 a[28:31], a[184:187], v[156:159], a[28:31]
 v_exp_f32 v100, v100
 v_mfma_f32_16x16x32_bf16 a[60:63], a[188:191], v[156:159], a[60:63]
 ds_read_b64_tr_b16 a[180:181], v3 offset:17216
 ds_read_b64_tr_b16 a[182:183], v5 offset:17216
 v_mfma_f32_16x16x32_bf16 a[52:55], a[188:191], v[140:143], a[52:55]
 s_waitcnt lgkmcnt(8)
 v_exp_f32 v101, v101
 v_mfma_f32_16x16x32_bf16 a[64:67], a[160:163], v[140:143], a[64:67]
 s_add_u32 m0, s40, 0x8620
 ds_read_b64_tr_b16 a[184:185], v2 offset:17248
 ds_read_b64_tr_b16 a[186:187], v4 offset:17248
 v_mfma_f32_16x16x32_bf16 a[144:147], a[160:163], v[172:175], a[144:147]
 s_waitcnt vmcnt(4)
 v_exp_f32 v102, v102
 v_mfma_f32_16x16x32_bf16 a[72:75], a[160:163], v[156:159], a[72:75]
 buffer_load_dwordx4 v16, s[16:19], s56 offen offset:512 nt lds
 v_add_f32 v32, v32, v100
 v_mfma_f32_16x16x32_bf16 a[104:107], a[164:167], v[156:159], a[104:107]
 ds_read_b64_tr_b16 a[188:189], v3 offset:17248
 ds_read_b64_tr_b16 a[190:191], v5 offset:17248
 v_mfma_f32_16x16x32_bf16 a[96:99], a[164:167], v[140:143], a[96:99]
 s_waitcnt lgkmcnt(8)
 v_exp_f32 v103, v103
 v_mfma_f32_16x16x32_bf16 a[68:71], a[168:171], v[140:143], a[68:71]
 s_barrier
 ds_read_b128 a[160:163], v6 offset:0
 v_mfma_f32_16x16x32_bf16 a[148:151], a[168:171], v[172:175], a[148:151]
 ds_write_b64 v21, v[132:133] offset:2048
 v_add_f32 v32, v32, v101
 v_mfma_f32_16x16x32_bf16 a[76:79], a[168:171], v[156:159], a[76:79]
 v_exp_f32 v108, v108
 v_mfma_f32_16x16x32_bf16 a[108:111], a[172:175], v[156:159], a[108:111]
 ds_read_b128 a[164:167], v6 offset:64
 v_cvt_pk_bf16_f32 v100, v100, v101
 v_mfma_f32_16x16x32_bf16 a[100:103], a[172:175], v[140:143], a[100:103]
 s_waitcnt lgkmcnt(7)
 v_exp_f32 v109, v109
 v_mfma_f32_16x16x32_bf16 a[80:83], a[176:179], v[140:143], a[80:83]
 ds_read_b128 a[168:171], v8 offset:0
 v_add_f32 v32, v32, v102
 v_mfma_f32_16x16x32_bf16 a[152:155], a[176:179], v[172:175], a[152:155]
 v_exp_f32 v110, v110
 v_mfma_f32_16x16x32_bf16 a[88:91], a[176:179], v[156:159], a[88:91]
 v_exp_f32 v111, v111
 v_mfma_f32_16x16x32_bf16 a[120:123], a[180:183], v[156:159], a[120:123]
 ds_read_b128 a[172:175], v8 offset:64
 v_add_f32 v32, v32, v103
 v_mfma_f32_16x16x32_bf16 a[112:115], a[180:183], v[140:143], a[112:115]
 s_waitcnt lgkmcnt(5)
 v_exp_f32 v116, v116
 v_mfma_f32_16x16x32_bf16 a[84:87], a[184:187], v[140:143], a[84:87]
 ds_read_b128 a[176:179], v7 offset:0
 v_cvt_pk_bf16_f32 v101, v102, v103
 v_mfma_f32_16x16x32_bf16 a[156:159], a[184:187], v[172:175], a[156:159]
 s_xor_b32 s56, s42, 0x28000
 v_exp_f32 v117, v117
 v_mfma_f32_16x16x32_bf16 a[92:95], a[184:187], v[156:159], a[92:95]
 s_add_u32 m0, s40, 0x8840
 v_exp_f32 v118, v118
 v_mfma_f32_16x16x32_bf16 a[124:127], a[188:191], v[156:159], a[124:127]
 s_waitcnt vmcnt(4)
 ds_read_b128 a[180:183], v7 offset:64
 v_add_f32 v32, v32, v108
 v_mfma_f32_16x16x32_bf16 a[116:119], a[188:191], v[140:143], a[116:119]
 s_waitcnt lgkmcnt(4)
 buffer_load_dwordx4 v16, s[16:19], s56 offen offset:1024 nt lds
 v_add_f32 v32, v32, v109
 v_mfma_f32_16x16x32_bf16 v[140:143], a[160:163], v[96:99], v[44:47]
 ds_read_b128 a[184:187], v9 offset:0
 v_cvt_pk_bf16_f32 v102, v108, v109
 v_mfma_f32_16x16x32_bf16 v[140:143], a[164:167], v[112:115], v[140:143]
 v_exp_f32 v119, v119
 v_mfma_f32_16x16x32_bf16 v[156:159], a[164:167], v[120:123], v[48:51]
 v_exp_f32 v124, v124
 v_mfma_f32_16x16x32_bf16 v[156:159], a[160:163], v[104:107], v[156:159]
 ds_read_b128 a[188:191], v9 offset:64
 v_add_f32 v32, v32, v110
 v_mfma_f32_16x16x32_bf16 v[172:175], a[160:163], v[224:227], v[52:55]
 v_exp_f32 v125, v125
 v_mfma_f32_16x16x32_bf16 v[172:175], a[164:167], v[232:235], v[172:175]
 s_waitcnt lgkmcnt(4)
 v_exp_f32 v126, v126
 v_mfma_f32_16x16x32_bf16 v[148:151], a[168:171], v[96:99], v[44:47]
 s_add_u32 m0, s40, 0x8a60
 ds_read_b128 a[160:163], v6 offset:256
 v_add_f32 v32, v32, v111
 v_mfma_f32_16x16x32_bf16 v[148:151], a[172:175], v[112:115], v[148:151]
 s_waitcnt vmcnt(4)
 v_exp_f32 v127, v127
 v_mfma_f32_16x16x32_bf16 v[164:167], a[172:175], v[120:123], v[48:51]
 ds_read_b128 a[164:167], v6 offset:320
 buffer_load_dwordx4 v16, s[16:19], s56 offen offset:1536 nt lds
 v_mfma_f32_16x16x32_bf16 v[164:167], a[168:171], v[104:107], v[164:167]
 s_waitcnt lgkmcnt(4)
 v_cvt_pk_bf16_f32 v103, v110, v111
 v_add_f32 v33, v33, v116
 v_mfma_f32_16x16x32_bf16 v[140:143], a[176:179], v[128:131], v[140:143]
 ds_read_b128 a[168:171], v8 offset:256
 v_add_f32 v33, v33, v117
 v_mfma_f32_16x16x32_bf16 v[140:143], a[180:183], v[144:147], v[140:143]
 v_cvt_pk_bf16_f32 v116, v116, v117
 v_add_f32 v33, v33, v118
 v_mfma_f32_16x16x32_bf16 v[156:159], a[180:183], v[152:155], v[156:159]
 v_add_f32 v33, v33, v119
 v_cvt_pk_bf16_f32 v117, v118, v119
 v_mfma_f32_16x16x32_bf16 v[156:159], a[176:179], v[136:139], v[156:159]
 ds_read_b128 a[172:175], v8 offset:320
 v_add_f32 v33, v33, v124
 v_mfma_f32_16x16x32_bf16 v[172:175], a[176:179], v[228:231], v[172:175]
 v_add_f32 v33, v33, v125
 v_cvt_pk_bf16_f32 v118, v124, v125
 v_mfma_f32_16x16x32_bf16 v[172:175], a[180:183], v[236:239], v[172:175]
 s_waitcnt lgkmcnt(4)
 v_add_f32 v33, v33, v126
 v_add_f32 v33, v33, v127
 v_mfma_f32_16x16x32_bf16 v[148:151], a[184:187], v[128:131], v[148:151]
 ds_read_b128 a[176:179], v7 offset:256
 v_cvt_pk_bf16_f32 v119, v126, v127
 v_mfma_f32_16x16x32_bf16 v[148:151], a[188:191], v[144:147], v[148:151]
 s_xor_b32 s56, s43, 0x20000
 v_mfma_f32_16x16x32_bf16 v[164:167], a[188:191], v[152:155], v[164:167]
 s_add_u32 m0, s40, 0x16600
 ds_read_b128 a[180:183], v7 offset:320
 v_mfma_f32_16x16x32_bf16 v[164:167], a[184:187], v[136:139], v[164:167]
 s_waitcnt lgkmcnt(4)
 v_mfma_f32_16x16x32_bf16 v[140:143], a[160:163], v[160:163], v[140:143]
 s_waitcnt vmcnt(4)
 ds_read_b128 a[184:187], v9 offset:256
 v_mfma_f32_16x16x32_bf16 v[140:143], a[164:167], v[176:179], v[140:143]
 buffer_load_dwordx4 v16, s[20:23], s56 offen offset:0 nt lds
 v_mfma_f32_16x16x32_bf16 v[156:159], a[164:167], v[184:187], v[156:159]
 v_mfma_f32_16x16x32_bf16 v[156:159], a[160:163], v[168:171], v[156:159]
 ds_read_b128 a[188:191], v9 offset:320
 v_mfma_f32_16x16x32_bf16 v[172:175], a[160:163], v[240:243], v[172:175]
 v_mfma_f32_16x16x32_bf16 v[172:175], a[164:167], v[248:251], v[172:175]
 s_waitcnt lgkmcnt(4)
 v_mfma_f32_16x16x32_bf16 v[148:151], a[168:171], v[160:163], v[148:151]
 s_barrier
 ds_read_b64_tr_b16 a[160:161], v2 offset:33792
 ds_read_b64_tr_b16 a[162:163], v4 offset:33792
 v_mfma_f32_16x16x32_bf16 v[148:151], a[172:175], v[176:179], v[148:151]
 ds_read_b64 v[74:75], v22 offset:0
 v_mfma_f32_16x16x32_bf16 v[164:167], a[172:175], v[184:187], v[164:167]
 ds_read_b64_tr_b16 a[164:165], v3 offset:33792
 ds_read_b64_tr_b16 a[166:167], v5 offset:33792
 v_mfma_f32_16x16x32_bf16 v[164:167], a[168:171], v[168:171], v[164:167]
 s_waitcnt lgkmcnt(7)
 v_mfma_f32_16x16x32_bf16 v[140:143], a[176:179], v[192:195], v[140:143]
 ds_read_b64_tr_b16 a[168:169], v2 offset:33824
 ds_read_b64_tr_b16 a[170:171], v4 offset:33824
 v_mfma_f32_16x16x32_bf16 v[140:143], a[180:183], v[208:211], v[140:143]
 v_mfma_f32_16x16x32_bf16 v[156:159], a[180:183], v[216:219], v[156:159]
 s_xor_b32 s56, s43, 0x20000
 v_mfma_f32_16x16x32_bf16 v[156:159], a[176:179], v[200:203], v[156:159]
 s_add_u32 m0, s40, 0x16820
 ds_read_b64_tr_b16 a[172:173], v3 offset:33824
 ds_read_b64_tr_b16 a[174:175], v5 offset:33824
 v_mfma_f32_16x16x32_bf16 v[172:175], a[176:179], v[244:247], v[172:175]
 s_waitcnt vmcnt(4)
 v_mfma_f32_16x16x32_bf16 v[172:175], a[180:183], v[252:255], v[172:175]
 s_waitcnt lgkmcnt(9)
 buffer_load_dwordx4 v16, s[20:23], s56 offen offset:512 nt lds
 v_mfma_f32_16x16x32_bf16 v[148:151], a[184:187], v[192:195], v[148:151]
 ds_read_b64_tr_b16 a[176:177], v2 offset:33856
 ds_read_b64_tr_b16 a[178:179], v4 offset:33856
 v_mfma_f32_16x16x32_bf16 v[148:151], a[188:191], v[208:211], v[148:151]
 v_mfma_f32_16x16x32_bf16 v[164:167], a[188:191], v[216:219], v[164:167]
 ds_read_b64_tr_b16 a[180:181], v3 offset:33856
 ds_read_b64_tr_b16 a[182:183], v5 offset:33856
 v_mfma_f32_16x16x32_bf16 v[164:167], a[184:187], v[200:203], v[164:167]
 s_waitcnt lgkmcnt(8)
 v_mfma_f32_16x16x32_bf16 a[0:3], a[160:163], v[56:59], a[0:3]
 ds_read_b64_tr_b16 a[184:185], v2 offset:33888
 ds_read_b64_tr_b16 a[186:187], v4 offset:33888
 v_mfma_f32_16x16x32_bf16 a[128:131], a[160:163], v[72:75], a[128:131]
 v_mfma_f32_16x16x32_bf16 a[8:11], a[160:163], v[64:67], a[8:11]
 s_cbranch_vccnz L_stub_8_B0
L_stub_8_B0_ret:
 v_mfma_f32_16x16x32_bf16 a[40:43], a[164:167], v[64:67], a[40:43]
 s_add_u32 m0, s40, 0x16a40
 ds_read_b64_tr_b16 a[188:189], v3 offset:33888
 ds_read_b64_tr_b16 a[190:191], v5 offset:33888
 v_mfma_f32_16x16x32_bf16 a[32:35], a[164:167], v[56:59], a[32:35]
 s_waitcnt lgkmcnt(8)
 v_exp_f32 v172, v172
 v_mfma_f32_16x16x32_bf16 a[4:7], a[168:171], v[56:59], a[4:7]
 s_waitcnt vmcnt(4)
 ds_read_b64_tr_b16 a[160:161], v2 offset:34048
 ds_read_b64_tr_b16 a[162:163], v4 offset:34048
 v_mfma_f32_16x16x32_bf16 a[132:135], a[168:171], v[72:75], a[132:135]
 buffer_load_dwordx4 v16, s[20:23], s56 offen offset:1024 nt lds
 v_mfma_f32_16x16x32_bf16 a[12:15], a[168:171], v[64:67], a[12:15]
 v_exp_f32 v173, v173
 v_mfma_f32_16x16x32_bf16 a[44:47], a[172:175], v[64:67], a[44:47]
 ds_read_b64_tr_b16 a[164:165], v3 offset:34048
 ds_read_b64_tr_b16 a[166:167], v5 offset:34048
 v_mfma_f32_16x16x32_bf16 a[36:39], a[172:175], v[56:59], a[36:39]
 s_waitcnt lgkmcnt(8)
 v_exp_f32 v174, v174
 v_mfma_f32_16x16x32_bf16 a[16:19], a[176:179], v[56:59], a[16:19]
 ds_read_b64_tr_b16 a[168:169], v2 offset:34080
 ds_read_b64_tr_b16 a[170:171], v4 offset:34080
 v_mfma_f32_16x16x32_bf16 a[136:139], a[176:179], v[72:75], a[136:139]
 v_exp_f32 v175, v175
 v_mfma_f32_16x16x32_bf16 a[24:27], a[176:179], v[64:67], a[24:27]
 s_add_u32 m0, s40, 0x16c60
 v_add_f32 v34, v34, v172
 v_add_f32 v34, v34, v173
 v_mfma_f32_16x16x32_bf16 a[56:59], a[180:183], v[64:67], a[56:59]
 s_waitcnt vmcnt(4)
 ds_read_b64_tr_b16 a[172:173], v3 offset:34080
 ds_read_b64_tr_b16 a[174:175], v5 offset:34080
 v_mfma_f32_16x16x32_bf16 a[48:51], a[180:183], v[56:59], a[48:51]
 s_waitcnt lgkmcnt(8)
 buffer_load_dwordx4 v16, s[20:23], s56 offen offset:1536 nt lds
 v_cvt_pk_bf16_f32 v172, v172, v173
 v_mfma_f32_16x16x32_bf16 a[20:23], a[184:187], v[56:59], a[20:23]
L_pad6:
 s_cbranch_execz L_e1_back
 ds_read_b64_tr_b16 a[176:177], v2 offset:34112
 ds_read_b64_tr_b16 a[178:179], v4 offset:34112
 v_mfma_f32_16x16x32_bf16 a[140:143], a[184:187], v[72:75], a[140:143]
 v_add_f32 v34, v34, v174
 v_add_f32 v34, v34, v175
 v_mfma_f32_16x16x32_bf16 a[28:31], a[184:187], v[64:67], a[28:31]
 v_cvt_pk_bf16_f32 v173, v174, v175
 v_mfma_f32_16x16x32_bf16 a[60:63], a[188:191], v[64:67], a[60:63]
 ds_read_b64_tr_b16 a[180:181], v3 offset:34112
 ds_read_b64_tr_b16 a[182:183], v5 offset:34112
 v_mfma_f32_16x16x32_bf16 a[52:55], a[188:191], v[56:59], a[52:55]
 s_waitcnt lgkmcnt(8)
 v_exp_f32 v140, v140
 v_mfma_f32_16x16x32_bf16 a[64:67], a[160:163], v[56:59], a[64:67]
 ds_read_b64_tr_b16 a[184:185], v2 offset:34144
 ds_read_b64_tr_b16 a[186:187], v4 offset:34144
 v_mfma_f32_16x16x32_bf16 a[144:147], a[160:163], v[72:75], a[144:147]
 v_exp_f32 v141, v141
 v_mfma_f32_16x16x32_bf16 a[72:75], a[160:163], v[64:67], a[72:75]
 v_exp_f32 v142, v142
 v_mfma_f32_16x16x32_bf16 a[104:107], a[164:167], v[64:67], a[104:107]
 ds_read_b64_tr_b16 a[188:189], v3 offset:34144
 ds_read_b64_tr_b16 a[190:191], v5 offset:34144
 v_mfma_f32_16x16x32_bf16 a[96:99], a[164:167], v[56:59], a[96:99]
 s_waitcnt lgkmcnt(8)
 v_exp_f32 v143, v143
 v_mfma_f32_16x16x32_bf16 a[68:71], a[168:171], v[56:59], a[68:71]
 s_barrier
 ds_read_b128 a[160:163], v6 offset:16896
 v_mfma_f32_16x16x32_bf16 a[148:151], a[168:171], v[72:75], a[148:151]
 ds_write_b64 v21, v[172:173] offset:0
 v_add_f32 v32, v32, v140
 v_mfma_f32_16x16x32_bf16 a[76:79], a[168:171], v[64:67], a[76:79]
 s_xor_b32 s56, s42, 0x2c000
 v_exp_f32 v148, v148
 v_mfma_f32_16x16x32_bf16 a[108:111], a[172:175], v[64:67], a[108:111]
 s_add_u32 m0, s40, 0xc600
 ds_read_b128 a[164:167], v6 offset:16960
 v_add_f32 v32, v32, v141
 v_mfma_f32_16x16x32_bf16 a[100:103], a[172:175], v[56:59], a[100:103]
 s_waitcnt lgkmcnt(7)
 v_exp_f32 v149, v149
 v_mfma_f32_16x16x32_bf16 a[80:83], a[176:179], v[56:59], a[80:83]
 s_waitcnt vmcnt(4)
 ds_read_b128 a[168:171], v8 offset:16896
 v_cvt_pk_bf16_f32 v140, v140, v141
 v_mfma_f32_16x16x32_bf16 a[152:155], a[176:179], v[72:75], a[152:155]
 buffer_load_dwordx4 v16, s[16:19], s56 offen offset:0 nt lds
 v_add_f32 v32, v32, v142
 v_mfma_f32_16x16x32_bf16 a[88:91], a[176:179], v[64:67], a[88:91]
 v_exp_f32 v150, v150
 v_mfma_f32_16x16x32_bf16 a[120:123], a[180:183], v[64:67], a[120:123]
 ds_read_b128 a[172:175], v8 offset:16960
 v_add_f32 v32, v32, v143
 v_mfma_f32_16x16x32_bf16 a[112:115], a[180:183], v[56:59], a[112:115]
 s_waitcnt lgkmcnt(5)
 v_exp_f32 v151, v151
 v_mfma_f32_16x16x32_bf16 a[84:87], a[184:187], v[56:59], a[84:87]
 ds_read_b128 a[176:179], v7 offset:16896
 v_cvt_pk_bf16_f32 v141, v142, v143
 v_mfma_f32_16x16x32_bf16 a[156:159], a[184:187], v[72:75], a[156:159]
 v_exp_f32 v156, v156
 v_mfma_f32_16x16x32_bf16 a[92:95], a[184:187], v[64:67], a[92:95]
 s_add_u32 m0, s40, 0xc820
 v_exp_f32 v157, v157
 v_mfma_f32_16x16x32_bf16 a[124:127], a[188:191], v[64:67], a[124:127]
 s_waitcnt vmcnt(4)
 ds_read_b128 a[180:183], v7 offset:16960
 v_add_f32 v32, v32, v148
 v_mfma_f32_16x16x32_bf16 a[116:119], a[188:191], v[56:59], a[116:119]
 s_waitcnt lgkmcnt(4)
 buffer_load_dwordx4 v16, s[16:19], s56 offen offset:512 nt lds
 v_add_f32 v32, v32, v149
 v_mfma_f32_16x16x32_bf16 v[56:59], a[160:163], v[96:99], v[44:47]
 ds_read_b128 a[184:187], v9 offset:16896
 v_cvt_pk_bf16_f32 v142, v148, v149
 v_mfma_f32_16x16x32_bf16 v[56:59], a[164:167], v[112:115], v[56:59]
 v_exp_f32 v158, v158
 v_mfma_f32_16x16x32_bf16 v[64:67], a[164:167], v[120:123], v[48:51]
 v_exp_f32 v159, v159
 v_mfma_f32_16x16x32_bf16 v[64:67], a[160:163], v[104:107], v[64:67]
 ds_read_b128 a[188:191], v9 offset:16960
 v_add_f32 v32, v32, v150
 v_mfma_f32_16x16x32_bf16 v[72:75], a[160:163], v[224:227], v[52:55]
 v_exp_f32 v164, v164
 v_mfma_f32_16x16x32_bf16 v[72:75], a[164:167], v[232:235], v[72:75]
 s_waitcnt lgkmcnt(4)
 v_exp_f32 v165, v165
 v_mfma_f32_16x16x32_bf16 v[60:63], a[168:171], v[96:99], v[44:47]
 ds_read_b128 a[160:163], v6 offset:17152
 v_add_f32 v32, v32, v151
 v_mfma_f32_16x16x32_bf16 v[60:63], a[172:175], v[112:115], v[60:63]
 v_exp_f32 v166, v166
 v_mfma_f32_16x16x32_bf16 v[68:71], a[172:175], v[120:123], v[48:51]
 s_add_u32 m0, s40, 0xca40
 ds_read_b128 a[164:167], v6 offset:17216
 v_cvt_pk_bf16_f32 v143, v150, v151
 v_mfma_f32_16x16x32_bf16 v[68:71], a[168:171], v[104:107], v[68:71]
 s_waitcnt lgkmcnt(4)
 v_exp_f32 v167, v167
 v_mfma_f32_16x16x32_bf16 v[56:59], a[176:179], v[128:131], v[56:59]
 s_waitcnt vmcnt(4)
 ds_read_b128 a[168:171], v8 offset:17152
 v_add_f32 v33, v33, v156
 v_mfma_f32_16x16x32_bf16 v[56:59], a[180:183], v[144:147], v[56:59]
 buffer_load_dwordx4 v16, s[16:19], s56 offen offset:1024 nt lds
 v_add_f32 v33, v33, v157
 v_mfma_f32_16x16x32_bf16 v[64:67], a[180:183], v[152:155], v[64:67]
 v_cvt_pk_bf16_f32 v156, v156, v157
 v_add_f32 v33, v33, v158
 v_mfma_f32_16x16x32_bf16 v[64:67], a[176:179], v[136:139], v[64:67]
 ds_read_b128 a[172:175], v8 offset:17216
 v_add_f32 v33, v33, v159
 v_mfma_f32_16x16x32_bf16 v[72:75], a[176:179], v[228:231], v[72:75]
 v_cvt_pk_bf16_f32 v157, v158, v159
 v_add_f32 v33, v33, v164
 v_mfma_f32_16x16x32_bf16 v[72:75], a[180:183], v[236:239], v[72:75]
 s_waitcnt lgkmcnt(4)
 v_add_f32 v33, v33, v165
 v_cvt_pk_bf16_f32 v158, v164, v165
 v_mfma_f32_16x16x32_bf16 v[60:63], a[184:187], v[128:131], v[60:63]
 ds_read_b128 a[176:179], v7 offset:17152
 v_add_f32 v33, v33, v166
 v_mfma_f32_16x16x32_bf16 v[60:63], a[188:191], v[144:147], v[60:63]
 v_add_f32 v33, v33, v167
 v_cvt_pk_bf16_f32 v159, v166, v167
 v_mfma_f32_16x16x32_bf16 v[68:71], a[188:191], v[152:155], v[68:71]
 ds_read_b128 a[180:183], v7 offset:17216
 v_mfma_f32_16x16x32_bf16 v[68:71], a[184:187], v[136:139], v[68:71]
 s_waitcnt lgkmcnt(4)
 v_mfma_f32_16x16x32_bf16 v[56:59], a[160:163], v[160:163], v[56:59]
 s_add_u32 m0, s40, 0xcc60
 ds_read_b128 a[184:187], v9 offset:17152
 v_mfma_f32_16x16x32_bf16 v[56:59], a[164:167], v[176:179], v[56:59]
 s_waitcnt vmcnt(4)
 v_mfma_f32_16x16x32_bf16 v[64:67], a[164:167], v[184:187], v[64:67]
 buffer_load_dwordx4 v16, s[16:19], s56 offen offset:1536 nt lds
 v_mfma_f32_16x16x32_bf16 v[64:67], a[160:163], v[168:171], v[64:67]
 ds_read_b128 a[188:191], v9 offset:17216
 v_mfma_f32_16x16x32_bf16 v[72:75], a[160:163], v[240:243], v[72:75]
 v_mfma_f32_16x16x32_bf16 v[72:75], a[164:167], v[248:251], v[72:75]
 s_waitcnt lgkmcnt(4)
 v_mfma_f32_16x16x32_bf16 v[60:63], a[168:171], v[160:163], v[60:63]
 s_barrier
 ds_read_b64_tr_b16 a[160:161], v2 offset:50688
 ds_read_b64_tr_b16 a[162:163], v4 offset:50688
 v_mfma_f32_16x16x32_bf16 v[60:63], a[172:175], v[176:179], v[60:63]
 ds_read_b64 v[134:135], v22 offset:2048
 v_mfma_f32_16x16x32_bf16 v[68:71], a[172:175], v[184:187], v[68:71]
 ds_read_b64_tr_b16 a[164:165], v3 offset:50688
 ds_read_b64_tr_b16 a[166:167], v5 offset:50688
 v_mfma_f32_16x16x32_bf16 v[68:71], a[168:171], v[168:171], v[68:71]
 s_waitcnt lgkmcnt(7)
 v_mfma_f32_16x16x32_bf16 v[56:59], a[176:179], v[192:195], v[56:59]
 ds_read_b64_tr_b16 a[168:169], v2 offset:50720
 ds_read_b64_tr_b16 a[170:171], v4 offset:50720
 v_mfma_f32_16x16x32_bf16 v[56:59], a[180:183], v[208:211], v[56:59]
 v_mfma_f32_16x16x32_bf16 v[64:67], a[180:183], v[216:219], v[64:67]
 v_mfma_f32_16x16x32_bf16 v[64:67], a[176:179], v[200:203], v[64:67]
 ds_read_b64_tr_b16 a[172:173], v3 offset:50720
 ds_read_b64_tr_b16 a[174:175], v5 offset:50720
 v_mfma_f32_16x16x32_bf16 v[72:75], a[176:179], v[244:247], v[72:75]
 s_xor_b32 s56, s43, 0x24000
 v_mfma_f32_16x16x32_bf16 v[72:75], a[180:183], v[252:255], v[72:75]
 s_waitcnt lgkmcnt(9)
 v_mfma_f32_16x16x32_bf16 v[60:63], a[184:187], v[192:195], v[60:63]
 s_add_u32 m0, s40, 0x1a800
 ds_read_b64_tr_b16 a[176:177], v2 offset:50752
 ds_read_b64_tr_b16 a[178:179], v4 offset:50752
 v_mfma_f32_16x16x32_bf16 v[60:63], a[188:191], v[208:211], v[60:63]
 s_waitcnt vmcnt(4)
 v_mfma_f32_16x16x32_bf16 v[68:71], a[188:191], v[216:219], v[68:71]
 ds_read_b64_tr_b16 a[180:181], v3 offset:50752
 ds_read_b64_tr_b16 a[182:183], v5 offset:50752
 v_mfma_f32_16x16x32_bf16 v[68:71], a[184:187], v[200:203], v[68:71]
 s_waitcnt lgkmcnt(8)
 buffer_load_dwordx4 v16, s[20:23], s56 offen offset:0 nt lds
 v_mfma_f32_16x16x32_bf16 a[0:3], a[160:163], v[100:103], a[0:3]
 ds_read_b64_tr_b16 a[184:185], v2 offset:50784
 ds_read_b64_tr_b16 a[186:187], v4 offset:50784
 v_mfma_f32_16x16x32_bf16 a[128:131], a[160:163], v[132:135], a[128:131]
 v_mfma_f32_16x16x32_bf16 a[8:11], a[160:163], v[116:119], a[8:11]
 s_cbranch_vccnz L_stub_9_B0
L_stub_9_B0_ret:
 v_mfma_f32_16x16x32_bf16 a[40:43], a[164:167], v[116:119], a[40:43]
 ds_read_b64_tr_b16 a[188:189], v3 offset:50784
 ds_read_b64_tr_b16 a[190:191], v5 offset:50784
 v_mfma_f32_16x16x32_bf16 a[32:35], a[164:167], v[100:103], a[32:35]
 s_waitcnt lgkmcnt(8)
 v_exp_f32 v72, v72
 v_mfma_f32_16x16x32_bf16 a[4:7], a[168:171], v[100:103], a[4:7]
 s_add_u32 m0, s40, 0x1aa20
 ds_read_b64_tr_b16 a[160:161], v2 offset:50944
 ds_read_b64_tr_b16 a[162:163], v4 offset:50944
 v_mfma_f32_16x16x32_bf16 a[132:135], a[168:171], v[132:135], a[132:135]
 s_waitcnt vmcnt(4)
 v_exp_f32 v73, v73
 v_mfma_f32_16x16x32_bf16 a[12:15], a[168:171], v[116:119], a[12:15]
 buffer_load_dwordx4 v16, s[20:23], s56 offen offset:512 nt lds
 v_mfma_f32_16x16x32_bf16 a[44:47], a[172:175], v[116:119], a[44:47]
 ds_read_b64_tr_b16 a[164:165], v3 offset:50944
 ds_read_b64_tr_b16 a[166:167], v5 offset:50944
 v_mfma_f32_16x16x32_bf16 a[36:39], a[172:175], v[100:103], a[36:39]
 s_waitcnt lgkmcnt(8)
 v_exp_f32 v74, v74
 v_mfma_f32_16x16x32_bf16 a[16:19], a[176:179], v[100:103], a[16:19]
 ds_read_b64_tr_b16 a[168:169], v2 offset:50976
 ds_read_b64_tr_b16 a[170:171], v4 offset:50976
 v_mfma_f32_16x16x32_bf16 a[136:139], a[176:179], v[132:135], a[136:139]
 v_exp_f32 v75, v75
 v_mfma_f32_16x16x32_bf16 a[24:27], a[176:179], v[116:119], a[24:27]
 v_add_f32 v34, v34, v72
 v_add_f32 v34, v34, v73
 v_mfma_f32_16x16x32_bf16 a[56:59], a[180:183], v[116:119], a[56:59]
 ds_read_b64_tr_b16 a[172:173], v3 offset:50976
 ds_read_b64_tr_b16 a[174:175], v5 offset:50976
 v_mfma_f32_16x16x32_bf16 a[48:51], a[180:183], v[100:103], a[48:51]
 s_waitcnt lgkmcnt(8)
 v_cvt_pk_bf16_f32 v72, v72, v73
 v_add_f32 v34, v34, v74
 v_mfma_f32_16x16x32_bf16 a[20:23], a[184:187], v[100:103], a[20:23]
 s_add_u32 m0, s40, 0x1ac40
 ds_read_b64_tr_b16 a[176:177], v2 offset:51008
 ds_read_b64_tr_b16 a[178:179], v4 offset:51008
 v_mfma_f32_16x16x32_bf16 a[140:143], a[184:187], v[132:135], a[140:143]
 s_waitcnt vmcnt(4)
 v_add_f32 v34, v34, v75
 v_cvt_pk_bf16_f32 v73, v74, v75
 v_mfma_f32_16x16x32_bf16 a[28:31], a[184:187], v[116:119], a[28:31]
 buffer_load_dwordx4 v16, s[20:23], s56 offen offset:1024 nt lds
 v_mfma_f32_16x16x32_bf16 a[60:63], a[188:191], v[116:119], a[60:63]
 ds_read_b64_tr_b16 a[180:181], v3 offset:51008
 ds_read_b64_tr_b16 a[182:183], v5 offset:51008
 v_mfma_f32_16x16x32_bf16 a[52:55], a[188:191], v[100:103], a[52:55]
 s_waitcnt lgkmcnt(8)
 v_exp_f32 v56, v56
 v_mfma_f32_16x16x32_bf16 a[64:67], a[160:163], v[100:103], a[64:67]
 ds_read_b64_tr_b16 a[184:185], v2 offset:51040
 ds_read_b64_tr_b16 a[186:187], v4 offset:51040
 v_mfma_f32_16x16x32_bf16 a[144:147], a[160:163], v[132:135], a[144:147]
 v_exp_f32 v57, v57
 v_mfma_f32_16x16x32_bf16 a[72:75], a[160:163], v[116:119], a[72:75]
 v_exp_f32 v58, v58
 v_mfma_f32_16x16x32_bf16 a[104:107], a[164:167], v[116:119], a[104:107]
 ds_read_b64_tr_b16 a[188:189], v3 offset:51040
 ds_read_b64_tr_b16 a[190:191], v5 offset:51040
 v_mfma_f32_16x16x32_bf16 a[96:99], a[164:167], v[100:103], a[96:99]
 s_waitcnt lgkmcnt(8)
 v_exp_f32 v59, v59
 v_mfma_f32_16x16x32_bf16 a[68:71], a[168:171], v[100:103], a[68:71]
 s_barrier
 ds_read_b128 a[160:163], v6 offset:33792
 v_mfma_f32_16x16x32_bf16 a[148:151], a[168:171], v[132:135], a[148:151]
 ds_write_b64 v21, v[72:73] offset:2048
 v_add_f32 v32, v32, v56
 v_mfma_f32_16x16x32_bf16 a[76:79], a[168:171], v[116:119], a[76:79]
 v_exp_f32 v60, v60
 v_mfma_f32_16x16x32_bf16 a[108:111], a[172:175], v[116:119], a[108:111]
 ds_read_b128 a[164:167], v6 offset:33856
 v_add_f32 v32, v32, v57
 v_mfma_f32_16x16x32_bf16 a[100:103], a[172:175], v[100:103], a[100:103]
 s_waitcnt lgkmcnt(7)
 v_exp_f32 v61, v61
 v_mfma_f32_16x16x32_bf16 a[80:83], a[176:179], v[100:103], a[80:83]
 s_xor_b32 s56, s43, 0x24000
 ds_read_b128 a[168:171], v8 offset:33792
 v_cvt_pk_bf16_f32 v56, v56, v57
 v_mfma_f32_16x16x32_bf16 a[152:155], a[176:179], v[132:135], a[152:155]
 s_add_u32 m0, s40, 0x1ae60
 v_exp_f32 v62, v62
 v_mfma_f32_16x16x32_bf16 a[88:91], a[176:179], v[116:119], a[88:91]
 s_waitcnt vmcnt(4)
 v_exp_f32 v63, v63
 v_mfma_f32_16x16x32_bf16 a[120:123], a[180:183], v[116:119], a[120:123]
 ds_read_b128 a[172:175], v8 offset:33856
 buffer_load_dwordx4 v16, s[20:23], s56 offen offset:1536 nt lds
 v_mfma_f32_16x16x32_bf16 a[112:115], a[180:183], v[100:103], a[112:115]
 s_waitcnt lgkmcnt(5)
 v_exp_f32 v64, v64
 v_mfma_f32_16x16x32_bf16 a[84:87], a[184:187], v[100:103], a[84:87]
 ds_read_b128 a[176:179], v7 offset:33792
 v_add_f32 v32, v32, v58
 v_mfma_f32_16x16x32_bf16 a[156:159], a[184:187], v[132:135], a[156:159]
 v_exp_f32 v65, v65
 v_mfma_f32_16x16x32_bf16 a[92:95], a[184:187], v[116:119], a[92:95]
 v_exp_f32 v66, v66
 v_mfma_f32_16x16x32_bf16 a[124:127], a[188:191], v[116:119], a[124:127]
 ds_read_b128 a[180:183], v7 offset:33856
 v_add_f32 v32, v32, v59
 v_mfma_f32_16x16x32_bf16 a[116:119], a[188:191], v[100:103], a[116:119]
 s_waitcnt lgkmcnt(4)
 v_exp_f32 v67, v67
 v_mfma_f32_16x16x32_bf16 v[100:103], a[160:163], v[96:99], v[44:47]
 s_xor_b32 s56, s42, 0x30000
 ds_read_b128 a[184:187], v9 offset:33792
 v_cvt_pk_bf16_f32 v57, v58, v59
 v_mfma_f32_16x16x32_bf16 v[100:103], a[164:167], v[112:115], v[100:103]
 s_add_u32 m0, s40, 0
 v_exp_f32 v68, v68
 v_mfma_f32_16x16x32_bf16 v[116:119], a[164:167], v[120:123], v[48:51]
 s_waitcnt vmcnt(4)
 v_exp_f32 v69, v69
 v_mfma_f32_16x16x32_bf16 v[116:119], a[160:163], v[104:107], v[116:119]
 ds_read_b128 a[188:191], v9 offset:33856
 buffer_load_dwordx4 v16, s[16:19], s56 offen offset:0 nt lds
 v_mfma_f32_16x16x32_bf16 v[132:135], a[160:163], v[224:227], v[52:55]
 v_exp_f32 v70, v70
 v_mfma_f32_16x16x32_bf16 v[132:135], a[164:167], v[232:235], v[132:135]
 s_waitcnt lgkmcnt(4)
 v_exp_f32 v71, v71
 v_mfma_f32_16x16x32_bf16 v[108:111], a[168:171], v[96:99], v[44:47]
 ds_read_b128 a[160:163], v6 offset:34048
 v_add_f32 v32, v32, v60
 v_mfma_f32_16x16x32_bf16 v[108:111], a[172:175], v[112:115], v[108:111]
 v_add_f32 v32, v32, v61
 v_cvt_pk_bf16_f32 v58, v60, v61
 v_mfma_f32_16x16x32_bf16 v[124:127], a[172:175], v[120:123], v[48:51]
 ds_read_b128 a[164:167], v6 offset:34112
 v_add_f32 v32, v32, v62
 v_mfma_f32_16x16x32_bf16 v[124:127], a[168:171], v[104:107], v[124:127]
 s_waitcnt lgkmcnt(4)
 v_add_f32 v32, v32, v63
 v_cvt_pk_bf16_f32 v59, v62, v63
 v_mfma_f32_16x16x32_bf16 v[100:103], a[176:179], v[128:131], v[100:103]
 s_add_u32 m0, s40, 0x220
 ds_read_b128 a[168:171], v8 offset:34048
 v_add_f32 v33, v33, v64
 v_mfma_f32_16x16x32_bf16 v[100:103], a[180:183], v[144:147], v[100:103]
 s_waitcnt vmcnt(4)
 v_add_f32 v33, v33, v65
 v_cvt_pk_bf16_f32 v64, v64, v65
 v_mfma_f32_16x16x32_bf16 v[116:119], a[180:183], v[152:155], v[116:119]
 buffer_load_dwordx4 v16, s[16:19], s56 offen offset:512 nt lds
 v_add_f32 v33, v33, v66
 v_mfma_f32_16x16x32_bf16 v[116:119], a[176:179], v[136:139], v[116:119]
 ds_read_b128 a[172:175], v8 offset:34112
 v_add_f32 v33, v33, v67
 v_mfma_f32_16x16x32_bf16 v[132:135], a[176:179], v[228:231], v[132:135]
 v_cvt_pk_bf16_f32 v65, v66, v67
 v_add_f32 v33, v33, v68
 v_mfma_f32_16x16x32_bf16 v[132:135], a[180:183], v[236:239], v[132:135]
 s_waitcnt lgkmcnt(4)
 v_add_f32 v33, v33, v69
 v_cvt_pk_bf16_f32 v66, v68, v69
 v_mfma_f32_16x16x32_bf16 v[108:111], a[184:187], v[128:131], v[108:111]
 ds_read_b128 a[176:179], v7 offset:34048
 v_add_f32 v33, v33, v70
 v_mfma_f32_16x16x32_bf16 v[108:111], a[188:191], v[144:147], v[108:111]
 v_add_f32 v33, v33, v71
 v_cvt_pk_bf16_f32 v67, v70, v71
 v_mfma_f32_16x16x32_bf16 v[124:127], a[188:191], v[152:155], v[124:127]
 ds_read_b128 a[180:183], v7 offset:34112
 v_mfma_f32_16x16x32_bf16 v[124:127], a[184:187], v[136:139], v[124:127]
 s_waitcnt lgkmcnt(4)
 v_mfma_f32_16x16x32_bf16 v[100:103], a[160:163], v[160:163], v[100:103]
 s_add_u32 m0, s40, 0x440
 ds_read_b128 a[184:187], v9 offset:34048
 v_mfma_f32_16x16x32_bf16 v[100:103], a[164:167], v[176:179], v[100:103]
 s_waitcnt vmcnt(4)
 v_mfma_f32_16x16x32_bf16 v[116:119], a[164:167], v[184:187], v[116:119]
 buffer_load_dwordx4 v16, s[16:19], s56 offen offset:1024 nt lds
 v_mfma_f32_16x16x32_bf16 v[116:119], a[160:163], v[168:171], v[116:119]
 ds_read_b128 a[188:191], v9 offset:34112
 v_mfma_f32_16x16x32_bf16 v[132:135], a[160:163], v[240:243], v[132:135]
 v_mfma_f32_16x16x32_bf16 v[132:135], a[164:167], v[248:251], v[132:135]
 s_waitcnt lgkmcnt(4)
 v_mfma_f32_16x16x32_bf16 v[108:111], a[168:171], v[160:163], v[108:111]
 s_barrier
 ds_read_b64_tr_b16 a[160:161], v2 offset:0
 ds_read_b64_tr_b16 a[162:163], v4 offset:0
 v_mfma_f32_16x16x32_bf16 v[108:111], a[172:175], v[176:179], v[108:111]
 ds_read_b64 v[174:175], v22 offset:0
 v_mfma_f32_16x16x32_bf16 v[124:127], a[172:175], v[184:187], v[124:127]
 ds_read_b64_tr_b16 a[164:165], v3 offset:0
 ds_read_b64_tr_b16 a[166:167], v5 offset:0
 v_mfma_f32_16x16x32_bf16 v[124:127], a[168:171], v[168:171], v[124:127]
 s_waitcnt lgkmcnt(7)
 v_mfma_f32_16x16x32_bf16 v[100:103], a[176:179], v[192:195], v[100:103]
 ds_read_b64_tr_b16 a[168:169], v2 offset:32
 ds_read_b64_tr_b16 a[170:171], v4 offset:32
 v_mfma_f32_16x16x32_bf16 v[100:103], a[180:183], v[208:211], v[100:103]
 v_mfma_f32_16x16x32_bf16 v[116:119], a[180:183], v[216:219], v[116:119]
 v_mfma_f32_16x16x32_bf16 v[116:119], a[176:179], v[200:203], v[116:119]
 ds_read_b64_tr_b16 a[172:173], v3 offset:32
 ds_read_b64_tr_b16 a[174:175], v5 offset:32
 v_mfma_f32_16x16x32_bf16 v[132:135], a[176:179], v[244:247], v[132:135]
 v_mfma_f32_16x16x32_bf16 v[132:135], a[180:183], v[252:255], v[132:135]
 s_waitcnt lgkmcnt(9)
 v_mfma_f32_16x16x32_bf16 v[108:111], a[184:187], v[192:195], v[108:111]
 s_xor_b32 s56, s42, 0x30000
 ds_read_b64_tr_b16 a[176:177], v2 offset:64
 ds_read_b64_tr_b16 a[178:179], v4 offset:64
 v_mfma_f32_16x16x32_bf16 v[108:111], a[188:191], v[208:211], v[108:111]
 s_add_u32 m0, s40, 0x660
 v_mfma_f32_16x16x32_bf16 v[124:127], a[188:191], v[216:219], v[124:127]
 s_waitcnt vmcnt(4)
 ds_read_b64_tr_b16 a[180:181], v3 offset:64
 ds_read_b64_tr_b16 a[182:183], v5 offset:64
 v_mfma_f32_16x16x32_bf16 v[124:127], a[184:187], v[200:203], v[124:127]
 s_waitcnt lgkmcnt(8)
 buffer_load_dwordx4 v16, s[16:19], s56 offen offset:1536 nt lds
 v_mfma_f32_16x16x32_bf16 a[0:3], a[160:163], v[140:143], a[0:3]
 ds_read_b64_tr_b16 a[184:185], v2 offset:96
 ds_read_b64_tr_b16 a[186:187], v4 offset:96
 v_mfma_f32_16x16x32_bf16 a[128:131], a[160:163], v[172:175], a[128:131]
 v_mfma_f32_16x16x32_bf16 a[8:11], a[160:163], v[156:159], a[8:11]
 s_cbranch_vccnz L_stub_10_B0
L_stub_10_B0_ret:
 v_mfma_f32_16x16x32_bf16 a[40:43], a[164:167], v[156:159], a[40:43]
 ds_read_b64_tr_b16 a[188:189], v3 offset:96
 ds_read_b64_tr_b16 a[190:191], v5 offset:96
 v_mfma_f32_16x16x32_bf16 a[32:35], a[164:167], v[140:143], a[32:35]
 s_waitcnt lgkmcnt(8)
 v_exp_f32 v132, v132
 v_mfma_f32_16x16x32_bf16 a[4:7], a[168:171], v[140:143], a[4:7]
 s_xor_b32 s56, s43, 0x28000
 ds_read_b64_tr_b16 a[160:161], v2 offset:256
 ds_read_b64_tr_b16 a[162:163], v4 offset:256
 v_mfma_f32_16x16x32_bf16 a[132:135], a[168:171], v[172:175], a[132:135]
 s_add_u32 m0, s40, 0x1ea00
 v_exp_f32 v133, v133
 v_mfma_f32_16x16x32_bf16 a[12:15], a[168:171], v[156:159], a[12:15]
 s_waitcnt vmcnt(4)
 v_exp_f32 v134, v134
 v_mfma_f32_16x16x32_bf16 a[44:47], a[172:175], v[156:159], a[44:47]
 ds_read_b64_tr_b16 a[164:165], v3 offset:256
 ds_read_b64_tr_b16 a[166:167], v5 offset:256
 v_mfma_f32_16x16x32_bf16 a[36:39], a[172:175], v[140:143], a[36:39]
 s_waitcnt lgkmcnt(8)
 buffer_load_dwordx4 v16, s[20:23], s56 offen offset:0 nt lds
 v_mfma_f32_16x16x32_bf16 a[16:19], a[176:179], v[140:143], a[16:19]
 ds_read_b64_tr_b16 a[168:169], v2 offset:288
 ds_read_b64_tr_b16 a[170:171], v4 offset:288
 v_mfma_f32_16x16x32_bf16 a[136:139], a[176:179], v[172:175], a[136:139]
 v_exp_f32 v135, v135
 v_mfma_f32_16x16x32_bf16 a[24:27], a[176:179], v[156:159], a[24:27]
 v_add_f32 v34, v34, v132
 v_add_f32 v34, v34, v133
 v_mfma_f32_16x16x32_bf16 a[56:59], a[180:183], v[156:159], a[56:59]
 ds_read_b64_tr_b16 a[172:173], v3 offset:288
 ds_read_b64_tr_b16 a[174:175], v5 offset:288
 v_mfma_f32_16x16x32_bf16 a[48:51], a[180:183], v[140:143], a[48:51]
 s_waitcnt lgkmcnt(8)
 v_cvt_pk_bf16_f32 v132, v132, v133
 v_add_f32 v34, v34, v134
 v_mfma_f32_16x16x32_bf16 a[20:23], a[184:187], v[140:143], a[20:23]
 s_add_u32 m0, s40, 0x1ec20
 ds_read_b64_tr_b16 a[176:177], v2 offset:320
 ds_read_b64_tr_b16 a[178:179], v4 offset:320
 v_mfma_f32_16x16x32_bf16 a[140:143], a[184:187], v[172:175], a[140:143]
 s_waitcnt vmcnt(4)
 v_add_f32 v34, v34, v135
 v_cvt_pk_bf16_f32 v133, v134, v135
 v_mfma_f32_16x16x32_bf16 a[28:31], a[184:187], v[156:159], a[28:31]
 buffer_load_dwordx4 v16, s[20:23], s56 offen offset:512 nt lds
 v_mfma_f32_16x16x32_bf16 a[60:63], a[188:191], v[156:159], a[60:63]
 ds_read_b64_tr_b16 a[180:181], v3 offset:320
 ds_read_b64_tr_b16 a[182:183], v5 offset:320
 v_mfma_f32_16x16x32_bf16 a[52:55], a[188:191], v[140:143], a[52:55]
 s_waitcnt lgkmcnt(8)
 v_exp_f32 v100, v100
 v_mfma_f32_16x16x32_bf16 a[64:67], a[160:163], v[140:143], a[64:67]
 ds_read_b64_tr_b16 a[184:185], v2 offset:352
 ds_read_b64_tr_b16 a[186:187], v4 offset:352
 v_mfma_f32_16x16x32_bf16 a[144:147], a[160:163], v[172:175], a[144:147]
 v_exp_f32 v101, v101
 v_mfma_f32_16x16x32_bf16 a[72:75], a[160:163], v[156:159], a[72:75]
 v_exp_f32 v102, v102
 v_mfma_f32_16x16x32_bf16 a[104:107], a[164:167], v[156:159], a[104:107]
 ds_read_b64_tr_b16 a[188:189], v3 offset:352
 ds_read_b64_tr_b16 a[190:191], v5 offset:352
 v_mfma_f32_16x16x32_bf16 a[96:99], a[164:167], v[140:143], a[96:99]
 s_waitcnt lgkmcnt(8)
 v_exp_f32 v103, v103
 v_mfma_f32_16x16x32_bf16 a[68:71], a[168:171], v[140:143], a[68:71]
 s_barrier
 ds_read_b128 a[160:163], v6 offset:50688
 v_mfma_f32_16x16x32_bf16 a[148:151], a[168:171], v[172:175], a[148:151]
 ds_write_b64 v21, v[132:133] offset:0
 v_add_f32 v32, v32, v100
 v_mfma_f32_16x16x32_bf16 a[76:79], a[168:171], v[156:159], a[76:79]
 v_exp_f32 v108, v108
 v_mfma_f32_16x16x32_bf16 a[108:111], a[172:175], v[156:159], a[108:111]
 ds_read_b128 a[164:167], v6 offset:50752
 v_add_f32 v32, v32, v101
 v_mfma_f32_16x16x32_bf16 a[100:103], a[172:175], v[140:143], a[100:103]
 s_waitcnt lgkmcnt(7)
 v_exp_f32 v109, v109
 v_mfma_f32_16x16x32_bf16 a[80:83], a[176:179], v[140:143], a[80:83]
 s_xor_b32 s56, s43, 0x28000
 ds_read_b128 a[168:171], v8 offset:50688
 v_cvt_pk_bf16_f32 v100, v100, v101
 v_mfma_f32_16x16x32_bf16 a[152:155], a[176:179], v[172:175], a[152:155]
 s_add_u32 m0, s40, 0x1ee40
 v_exp_f32 v110, v110
 v_mfma_f32_16x16x32_bf16 a[88:91], a[176:179], v[156:159], a[88:91]
 s_waitcnt vmcnt(4)
 v_exp_f32 v111, v111
 v_mfma_f32_16x16x32_bf16 a[120:123], a[180:183], v[156:159], a[120:123]
 ds_read_b128 a[172:175], v8 offset:50752
 buffer_load_dwordx4 v16, s[20:23], s56 offen offset:1024 nt lds
 v_mfma_f32_16x16x32_bf16 a[112:115], a[180:183], v[140:143], a[112:115]
 s_waitcnt lgkmcnt(5)
 v_exp_f32 v116, v116
 v_mfma_f32_16x16x32_bf16 a[84:87], a[184:187], v[140:143], a[84:87]
 ds_read_b128 a[176:179], v7 offset:50688
 v_add_f32 v32, v32, v102
 v_mfma_f32_16x16x32_bf16 a[156:159], a[184:187], v[172:175], a[156:159]
 v_exp_f32 v117, v117
 v_mfma_f32_16x16x32_bf16 a[92:95], a[184:187], v[156:159], a[92:95]
 v_exp_f32 v118, v118
 v_mfma_f32_16x16x32_bf16 a[124:127], a[188:191], v[156:159], a[124:127]
 ds_read_b128 a[180:183], v7 offset:50752
 v_add_f32 v32, v32, v103
 v_mfma_f32_16x16x32_bf16 a[116:119], a[188:191], v[140:143], a[116:119]
 s_waitcnt lgkmcnt(4)
 v_exp_f32 v119, v119
 v_mfma_f32_16x16x32_bf16 v[140:143], a[160:163], v[96:99], v[44:47]
 ds_read_b128 a[184:187], v9 offset:50688
 v_cvt_pk_bf16_f32 v101, v102, v103
 v_mfma_f32_16x16x32_bf16 v[140:143], a[164:167], v[112:115], v[140:143]
 s_add_u32 m0, s40, 0x1f060
 v_exp_f32 v124, v124
 v_mfma_f32_16x16x32_bf16 v[156:159], a[164:167], v[120:123], v[48:51]
 s_waitcnt vmcnt(4)
 v_exp_f32 v125, v125
 v_mfma_f32_16x16x32_bf16 v[156:159], a[160:163], v[104:107], v[156:159]
 ds_read_b128 a[188:191], v9 offset:50752
 buffer_load_dwordx4 v16, s[20:23], s56 offen offset:1536 nt lds
 v_mfma_f32_16x16x32_bf16 v[172:175], a[160:163], v[224:227], v[52:55]
 v_exp_f32 v126, v126
 v_mfma_f32_16x16x32_bf16 v[172:175], a[164:167], v[232:235], v[172:175]
 s_waitcnt lgkmcnt(4)
 v_exp_f32 v127, v127
 v_mfma_f32_16x16x32_bf16 v[148:151], a[168:171], v[96:99], v[44:47]
 ds_read_b128 a[160:163], v6 offset:50944
 v_add_f32 v32, v32, v108
 v_mfma_f32_16x16x32_bf16 v[148:151], a[172:175], v[112:115], v[148:151]
 v_add_f32 v32, v32, v109
 v_cvt_pk_bf16_f32 v102, v108, v109
 v_mfma_f32_16x16x32_bf16 v[164:167], a[172:175], v[120:123], v[48:51]
 ds_read_b128 a[164:167], v6 offset:51008
 v_add_f32 v32, v32, v110
 v_mfma_f32_16x16x32_bf16 v[164:167], a[168:171], v[104:107], v[164:167]
 s_waitcnt lgkmcnt(4)
 v_add_f32 v32, v32, v111
 v_cvt_pk_bf16_f32 v103, v110, v111
 v_mfma_f32_16x16x32_bf16 v[140:143], a[176:179], v[128:131], v[140:143]
 ds_read_b128 a[168:171], v8 offset:50944
 v_add_f32 v33, v33, v116
 v_mfma_f32_16x16x32_bf16 v[140:143], a[180:183], v[144:147], v[140:143]
 s_xor_b32 s56, s42, 0x34000
 v_add_f32 v33, v33, v117
 v_cvt_pk_bf16_f32 v116, v116, v117
 v_mfma_f32_16x16x32_bf16 v[156:159], a[180:183], v[152:155], v[156:159]
 s_add_u32 m0, s40, 0x4200
 v_add_f32 v33, v33, v118
 v_add_f32 v33, v33, v119
 v_mfma_f32_16x16x32_bf16 v[156:159], a[176:179], v[136:139], v[156:159]
 s_waitcnt vmcnt(4)
 ds_read_b128 a[172:175], v8 offset:51008
 v_cvt_pk_bf16_f32 v117, v118, v119
 v_mfma_f32_16x16x32_bf16 v[172:175], a[176:179], v[228:231], v[172:175]
 buffer_load_dwordx4 v16, s[16:19], s56 offen offset:0 nt lds
 v_add_f32 v33, v33, v124
 v_mfma_f32_16x16x32_bf16 v[172:175], a[180:183], v[236:239], v[172:175]
 s_waitcnt lgkmcnt(4)
 v_add_f32 v33, v33, v125
 v_cvt_pk_bf16_f32 v118, v124, v125
 v_mfma_f32_16x16x32_bf16 v[148:151], a[184:187], v[128:131], v[148:151]
 ds_read_b128 a[176:179], v7 offset:50944
 v_add_f32 v33, v33, v126
 v_mfma_f32_16x16x32_bf16 v[148:151], a[188:191], v[144:147], v[148:151]
 v_add_f32 v33, v33, v127
 v_cvt_pk_bf16_f32 v119, v126, v127
 v_mfma_f32_16x16x32_bf16 v[164:167], a[188:191], v[152:155], v[164:167]
 ds_read_b128 a[180:183], v7 offset:51008
 v_mfma_f32_16x16x32_bf16 v[164:167], a[184:187], v[136:139], v[164:167]
 s_waitcnt lgkmcnt(4)
 v_mfma_f32_16x16x32_bf16 v[140:143], a[160:163], v[160:163], v[140:143]
 ds_read_b128 a[184:187], v9 offset:50944
 v_mfma_f32_16x16x32_bf16 v[140:143], a[164:167], v[176:179], v[140:143]
 v_mfma_f32_16x16x32_bf16 v[156:159], a[164:167], v[184:187], v[156:159]
 v_mfma_f32_16x16x32_bf16 v[156:159], a[160:163], v[168:171], v[156:159]
 ds_read_b128 a[188:191], v9 offset:51008
 v_mfma_f32_16x16x32_bf16 v[172:175], a[160:163], v[240:243], v[172:175]
 v_mfma_f32_16x16x32_bf16 v[172:175], a[164:167], v[248:251], v[172:175]
 s_waitcnt lgkmcnt(4)
 v_mfma_f32_16x16x32_bf16 v[148:151], a[168:171], v[160:163], v[148:151]
 s_barrier
 ds_read_b64_tr_b16 a[160:161], v2 offset:16896
 ds_read_b64_tr_b16 a[162:163], v4 offset:16896
 v_mfma_f32_16x16x32_bf16 v[148:151], a[172:175], v[176:179], v[148:151]
 s_xor_b32 s56, s42, 0x34000
 ds_read_b64 v[74:75], v22 offset:2048
 v_mfma_f32_16x16x32_bf16 v[164:167], a[172:175], v[184:187], v[164:167]
 s_add_u32 m0, s40, 0x4420
 ds_read_b64_tr_b16 a[164:165], v3 offset:16896
 ds_read_b64_tr_b16 a[166:167], v5 offset:16896
 v_mfma_f32_16x16x32_bf16 v[164:167], a[168:171], v[168:171], v[164:167]
 s_waitcnt lgkmcnt(7)
 v_mfma_f32_16x16x32_bf16 v[140:143], a[176:179], v[192:195], v[140:143]
 s_waitcnt vmcnt(4)
 ds_read_b64_tr_b16 a[168:169], v2 offset:16928
 ds_read_b64_tr_b16 a[170:171], v4 offset:16928
 v_mfma_f32_16x16x32_bf16 v[140:143], a[180:183], v[208:211], v[140:143]
L_pad7:
 s_cbranch_execz L_e1_back
 buffer_load_dwordx4 v16, s[16:19], s56 offen offset:512 nt lds
 v_mfma_f32_16x16x32_bf16 v[156:159], a[180:183], v[216:219], v[156:159]
 v_mfma_f32_16x16x32_bf16 v[156:159], a[176:179], v[200:203], v[156:159]
 ds_read_b64_tr_b16 a[172:173], v3 offset:16928
 ds_read_b64_tr_b16 a[174:175], v5 offset:16928
 v_mfma_f32_16x16x32_bf16 v[172:175], a[176:179], v[244:247], v[172:175]
 v_mfma_f32_16x16x32_bf16 v[172:175], a[180:183], v[252:255], v[172:175]
 s_waitcnt lgkmcnt(9)
 v_mfma_f32_16x16x32_bf16 v[148:151], a[184:187], v[192:195], v[148:151]
 ds_read_b64_tr_b16 a[176:177], v2 offset:16960
 ds_read_b64_tr_b16 a[178:179], v4 offset:16960
 v_mfma_f32_16x16x32_bf16 v[148:151], a[188:191], v[208:211], v[148:151]
 s_add_u32 m0, s40, 0x4640
 v_mfma_f32_16x16x32_bf16 v[164:167], a[188:191], v[216:219], v[164:167]
 s_waitcnt vmcnt(4)
 ds_read_b64_tr_b16 a[180:181], v3 offset:16960
 ds_read_b64_tr_b16 a[182:183], v5 offset:16960
 v_mfma_f32_16x16x32_bf16 v[164:167], a[184:187], v[200:203], v[164:167]
 s_waitcnt lgkmcnt(8)
 buffer_load_dwordx4 v16, s[16:19], s56 offen offset:1024 nt lds
 v_mfma_f32_16x16x32_bf16 a[0:3], a[160:163], v[56:59], a[0:3]
 ds_read_b64_tr_b16 a[184:185], v2 offset:16992
 ds_read_b64_tr_b16 a[186:187], v4 offset:16992
 v_mfma_f32_16x16x32_bf16 a[128:131], a[160:163], v[72:75], a[128:131]
 v_mfma_f32_16x16x32_bf16 a[8:11], a[160:163], v[64:67], a[8:11]
 s_cbranch_vccnz L_stub_11_B0
L_stub_11_B0_ret:
 v_mfma_f32_16x16x32_bf16 a[40:43], a[164:167], v[64:67], a[40:43]
 ds_read_b64_tr_b16 a[188:189], v3 offset:16992
 ds_read_b64_tr_b16 a[190:191], v5 offset:16992
 v_mfma_f32_16x16x32_bf16 a[32:35], a[164:167], v[56:59], a[32:35]
 s_waitcnt lgkmcnt(8)
 v_exp_f32 v172, v172
 v_mfma_f32_16x16x32_bf16 a[4:7], a[168:171], v[56:59], a[4:7]
 ds_read_b64_tr_b16 a[160:161], v2 offset:17152
 ds_read_b64_tr_b16 a[162:163], v4 offset:17152
 v_mfma_f32_16x16x32_bf16 a[132:135], a[168:171], v[72:75], a[132:135]
 v_exp_f32 v173, v173
 v_mfma_f32_16x16x32_bf16 a[12:15], a[168:171], v[64:67], a[12:15]
 s_add_u32 m0, s40, 0x4860
 v_exp_f32 v174, v174
 v_mfma_f32_16x16x32_bf16 a[44:47], a[172:175], v[64:67], a[44:47]
 s_waitcnt vmcnt(4)
 ds_read_b64_tr_b16 a[164:165], v3 offset:17152
 ds_read_b64_tr_b16 a[166:167], v5 offset:17152
 v_mfma_f32_16x16x32_bf16 a[36:39], a[172:175], v[56:59], a[36:39]
 s_waitcnt lgkmcnt(8)
 buffer_load_dwordx4 v16, s[16:19], s56 offen offset:1536 nt lds
 v_mfma_f32_16x16x32_bf16 a[16:19], a[176:179], v[56:59], a[16:19]
 ds_read_b64_tr_b16 a[168:169], v2 offset:17184
 ds_read_b64_tr_b16 a[170:171], v4 offset:17184
 v_mfma_f32_16x16x32_bf16 a[136:139], a[176:179], v[72:75], a[136:139]
 v_exp_f32 v175, v175
 v_mfma_f32_16x16x32_bf16 a[24:27], a[176:179], v[64:67], a[24:27]
 v_add_f32 v34, v34, v172
 v_add_f32 v34, v34, v173
 v_mfma_f32_16x16x32_bf16 a[56:59], a[180:183], v[64:67], a[56:59]
 ds_read_b64_tr_b16 a[172:173], v3 offset:17184
 ds_read_b64_tr_b16 a[174:175], v5 offset:17184
 v_mfma_f32_16x16x32_bf16 a[48:51], a[180:183], v[56:59], a[48:51]
 s_waitcnt lgkmcnt(8)
 v_cvt_pk_bf16_f32 v172, v172, v173
 v_add_f32 v34, v34, v174
 v_mfma_f32_16x16x32_bf16 a[20:23], a[184:187], v[56:59], a[20:23]
 ds_read_b64_tr_b16 a[176:177], v2 offset:17216
 ds_read_b64_tr_b16 a[178:179], v4 offset:17216
 v_mfma_f32_16x16x32_bf16 a[140:143], a[184:187], v[72:75], a[140:143]
 v_add_f32 v34, v34, v175
 v_cvt_pk_bf16_f32 v173, v174, v175
 v_mfma_f32_16x16x32_bf16 a[28:31], a[184:187], v[64:67], a[28:31]
 s_xor_b32 s56, s43, 0x2c000
 v_exp_f32 v140, v140
 v_mfma_f32_16x16x32_bf16 a[60:63], a[188:191], v[64:67], a[60:63]
 s_add_u32 m0, s40, 0x22c00
 ds_read_b64_tr_b16 a[180:181], v3 offset:17216
 ds_read_b64_tr_b16 a[182:183], v5 offset:17216
 v_mfma_f32_16x16x32_bf16 a[52:55], a[188:191], v[56:59], a[52:55]
 s_waitcnt lgkmcnt(8)
 v_exp_f32 v141, v141
 v_mfma_f32_16x16x32_bf16 a[64:67], a[160:163], v[56:59], a[64:67]
 s_waitcnt vmcnt(4)
 ds_read_b64_tr_b16 a[184:185], v2 offset:17248
 ds_read_b64_tr_b16 a[186:187], v4 offset:17248
 v_mfma_f32_16x16x32_bf16 a[144:147], a[160:163], v[72:75], a[144:147]
 buffer_load_dwordx4 v16, s[20:23], s56 offen offset:0 nt lds
 v_add_f32 v32, v32, v140
 v_mfma_f32_16x16x32_bf16 a[72:75], a[160:163], v[64:67], a[72:75]
 v_exp_f32 v142, v142
 v_mfma_f32_16x16x32_bf16 a[104:107], a[164:167], v[64:67], a[104:107]
 ds_read_b64_tr_b16 a[188:189], v3 offset:17248
 ds_read_b64_tr_b16 a[190:191], v5 offset:17248
 v_mfma_f32_16x16x32_bf16 a[96:99], a[164:167], v[56:59], a[96:99]
 s_waitcnt lgkmcnt(8)
 v_exp_f32 v143, v143
 v_mfma_f32_16x16x32_bf16 a[68:71], a[168:171], v[56:59], a[68:71]
 s_barrier
 ds_read_b128 a[160:163], v6 offset:0
 v_mfma_f32_16x16x32_bf16 a[148:151], a[168:171], v[72:75], a[148:151]
 ds_write_b64 v21, v[172:173] offset:2048
 v_add_f32 v32, v32, v141
 v_mfma_f32_16x16x32_bf16 a[76:79], a[168:171], v[64:67], a[76:79]
 v_exp_f32 v148, v148
 v_mfma_f32_16x16x32_bf16 a[108:111], a[172:175], v[64:67], a[108:111]
 ds_read_b128 a[164:167], v6 offset:64
 v_cvt_pk_bf16_f32 v140, v140, v141
 v_mfma_f32_16x16x32_bf16 a[100:103], a[172:175], v[56:59], a[100:103]
 s_waitcnt lgkmcnt(7)
 v_exp_f32 v149, v149
 v_mfma_f32_16x16x32_bf16 a[80:83], a[176:179], v[56:59], a[80:83]
 ds_read_b128 a[168:171], v8 offset:0
 v_add_f32 v32, v32, v142
 v_mfma_f32_16x16x32_bf16 a[152:155], a[176:179], v[72:75], a[152:155]
 v_exp_f32 v150, v150
 v_mfma_f32_16x16x32_bf16 a[88:91], a[176:179], v[64:67], a[88:91]
 s_xor_b32 s56, s43, 0x2c000
 v_exp_f32 v151, v151
 v_mfma_f32_16x16x32_bf16 a[120:123], a[180:183], v[64:67], a[120:123]
 s_add_u32 m0, s40, 0x22e20
 ds_read_b128 a[172:175], v8 offset:64
 v_add_f32 v32, v32, v143
 v_mfma_f32_16x16x32_bf16 a[112:115], a[180:183], v[56:59], a[112:115]
 s_waitcnt lgkmcnt(5)
 v_exp_f32 v156, v156
 v_mfma_f32_16x16x32_bf16 a[84:87], a[184:187], v[56:59], a[84:87]
 s_waitcnt vmcnt(4)
 ds_read_b128 a[176:179], v7 offset:0
 v_cvt_pk_bf16_f32 v141, v142, v143
 v_mfma_f32_16x16x32_bf16 a[156:159], a[184:187], v[72:75], a[156:159]
 buffer_load_dwordx4 v16, s[20:23], s56 offen offset:512 nt lds
 v_add_f32 v32, v32, v148
 v_mfma_f32_16x16x32_bf16 a[92:95], a[184:187], v[64:67], a[92:95]
 v_exp_f32 v157, v157
 v_mfma_f32_16x16x32_bf16 a[124:127], a[188:191], v[64:67], a[124:127]
 ds_read_b128 a[180:183], v7 offset:64
 v_add_f32 v32, v32, v149
 v_mfma_f32_16x16x32_bf16 a[116:119], a[188:191], v[56:59], a[116:119]
 s_waitcnt lgkmcnt(4)
 v_exp_f32 v158, v158
 v_mfma_f32_16x16x32_bf16 v[56:59], a[160:163], v[96:99], v[44:47]
 ds_read_b128 a[184:187], v9 offset:0
 v_cvt_pk_bf16_f32 v142, v148, v149
 v_mfma_f32_16x16x32_bf16 v[56:59], a[164:167], v[112:115], v[56:59]
 v_exp_f32 v159, v159
 v_mfma_f32_16x16x32_bf16 v[64:67], a[164:167], v[120:123], v[48:51]
 v_exp_f32 v164, v164
 v_mfma_f32_16x16x32_bf16 v[64:67], a[160:163], v[104:107], v[64:67]
 s_add_u32 m0, s40, 0x23040
 ds_read_b128 a[188:191], v9 offset:64
 v_add_f32 v32, v32, v150
 v_mfma_f32_16x16x32_bf16 v[72:75], a[160:163], v[224:227], v[52:55]
 s_waitcnt vmcnt(4)
 v_exp_f32 v165, v165
 v_mfma_f32_16x16x32_bf16 v[72:75], a[164:167], v[232:235], v[72:75]
 s_waitcnt lgkmcnt(4)
 buffer_load_dwordx4 v16, s[20:23], s56 offen offset:1024 nt lds
 v_add_f32 v32, v32, v151
 v_mfma_f32_16x16x32_bf16 v[60:63], a[168:171], v[96:99], v[44:47]
 ds_read_b128 a[160:163], v6 offset:256
 v_cvt_pk_bf16_f32 v143, v150, v151
 v_mfma_f32_16x16x32_bf16 v[60:63], a[172:175], v[112:115], v[60:63]
 v_exp_f32 v166, v166
 v_mfma_f32_16x16x32_bf16 v[68:71], a[172:175], v[120:123], v[48:51]
 ds_read_b128 a[164:167], v6 offset:320
 v_add_f32 v33, v33, v156
 v_mfma_f32_16x16x32_bf16 v[68:71], a[168:171], v[104:107], v[68:71]
 s_waitcnt lgkmcnt(4)
 v_exp_f32 v167, v167
 v_mfma_f32_16x16x32_bf16 v[56:59], a[176:179], v[128:131], v[56:59]
 ds_read_b128 a[168:171], v8 offset:256
 v_add_f32 v33, v33, v157
 v_mfma_f32_16x16x32_bf16 v[56:59], a[180:183], v[144:147], v[56:59]
 v_cvt_pk_bf16_f32 v156, v156, v157
 v_add_f32 v33, v33, v158
 v_mfma_f32_16x16x32_bf16 v[64:67], a[180:183], v[152:155], v[64:67]
 v_add_f32 v33, v33, v159
 v_cvt_pk_bf16_f32 v157, v158, v159
 v_mfma_f32_16x16x32_bf16 v[64:67], a[176:179], v[136:139], v[64:67]
 s_add_u32 m0, s40, 0x23260
 ds_read_b128 a[172:175], v8 offset:320
 v_add_f32 v33, v33, v164
 v_mfma_f32_16x16x32_bf16 v[72:75], a[176:179], v[228:231], v[72:75]
 s_waitcnt vmcnt(4)
 v_add_f32 v33, v33, v165
 v_cvt_pk_bf16_f32 v158, v164, v165
 v_mfma_f32_16x16x32_bf16 v[72:75], a[180:183], v[236:239], v[72:75]
 s_waitcnt lgkmcnt(4)
 buffer_load_dwordx4 v16, s[20:23], s56 offen offset:1536 nt lds
 v_add_f32 v33, v33, v166
 v_mfma_f32_16x16x32_bf16 v[60:63], a[184:187], v[128:131], v[60:63]
 ds_read_b128 a[176:179], v7 offset:256
 v_add_f32 v33, v33, v167
 v_mfma_f32_16x16x32_bf16 v[60:63], a[188:191], v[144:147], v[60:63]
 v_cvt_pk_bf16_f32 v159, v166, v167
 v_mfma_f32_16x16x32_bf16 v[68:71], a[188:191], v[152:155], v[68:71]
 ds_read_b128 a[180:183], v7 offset:320
 v_mfma_f32_16x16x32_bf16 v[68:71], a[184:187], v[136:139], v[68:71]
 s_waitcnt lgkmcnt(4)
 v_mfma_f32_16x16x32_bf16 v[56:59], a[160:163], v[160:163], v[56:59]
 ds_read_b128 a[184:187], v9 offset:256
 v_mfma_f32_16x16x32_bf16 v[56:59], a[164:167], v[176:179], v[56:59]
 v_mfma_f32_16x16x32_bf16 v[64:67], a[164:167], v[184:187], v[64:67]
 v_mfma_f32_16x16x32_bf16 v[64:67], a[160:163], v[168:171], v[64:67]
 ds_read_b128 a[188:191], v9 offset:320
 v_mfma_f32_16x16x32_bf16 v[72:75], a[160:163], v[240:243], v[72:75]
 v_mfma_f32_16x16x32_bf16 v[72:75], a[164:167], v[248:251], v[72:75]
 s_waitcnt lgkmcnt(4)
 v_mfma_f32_16x16x32_bf16 v[60:63], a[168:171], v[160:163], v[60:63]
 s_barrier
 ds_read_b64_tr_b16 a[160:161], v2 offset:33792
 ds_read_b64_tr_b16 a[162:163], v4 offset:33792
 v_mfma_f32_16x16x32_bf16 v[60:63], a[172:175], v[176:179], v[60:63]
 ds_read_b64 v[134:135], v22 offset:0
 v_mfma_f32_16x16x32_bf16 v[68:71], a[172:175], v[184:187], v[68:71]
 ds_read_b64_tr_b16 a[164:165], v3 offset:33792
 ds_read_b64_tr_b16 a[166:167], v5 offset:33792
 v_mfma_f32_16x16x32_bf16 v[68:71], a[168:171], v[168:171], v[68:71]
 s_waitcnt lgkmcnt(7)
 v_mfma_f32_16x16x32_bf16 v[56:59], a[176:179], v[192:195], v[56:59]
 s_xor_b32 s56, s42, 0x38000
 ds_read_b64_tr_b16 a[168:169], v2 offset:33824
 ds_read_b64_tr_b16 a[170:171], v4 offset:33824
 v_mfma_f32_16x16x32_bf16 v[56:59], a[180:183], v[208:211], v[56:59]
 s_add_u32 m0, s40, 0x8400
 v_mfma_f32_16x16x32_bf16 v[64:67], a[180:183], v[216:219], v[64:67]
 s_waitcnt vmcnt(4)
 v_mfma_f32_16x16x32_bf16 v[64:67], a[176:179], v[200:203], v[64:67]
 ds_read_b64_tr_b16 a[172:173], v3 offset:33824
 ds_read_b64_tr_b16 a[174:175], v5 offset:33824
 v_mfma_f32_16x16x32_bf16 v[72:75], a[176:179], v[244:247], v[72:75]
 buffer_load_dwordx4 v16, s[16:19], s56 offen offset:0 nt lds
 v_mfma_f32_16x16x32_bf16 v[72:75], a[180:183], v[252:255], v[72:75]
 s_waitcnt lgkmcnt(9)
 v_mfma_f32_16x16x32_bf16 v[60:63], a[184:187], v[192:195], v[60:63]
 ds_read_b64_tr_b16 a[176:177], v2 offset:33856
 ds_read_b64_tr_b16 a[178:179], v4 offset:33856
 v_mfma_f32_16x16x32_bf16 v[60:63], a[188:191], v[208:211], v[60:63]
 v_mfma_f32_16x16x32_bf16 v[68:71], a[188:191], v[216:219], v[68:71]
 s_add_u32 m0, s40, 0x8620
 ds_read_b64_tr_b16 a[180:181], v3 offset:33856
 ds_read_b64_tr_b16 a[182:183], v5 offset:33856
 v_mfma_f32_16x16x32_bf16 v[68:71], a[184:187], v[200:203], v[68:71]
 s_waitcnt lgkmcnt(8)
 v_mfma_f32_16x16x32_bf16 a[0:3], a[160:163], v[100:103], a[0:3]
 s_waitcnt vmcnt(4)
 ds_read_b64_tr_b16 a[184:185], v2 offset:33888
 ds_read_b64_tr_b16 a[186:187], v4 offset:33888
 v_mfma_f32_16x16x32_bf16 a[128:131], a[160:163], v[132:135], a[128:131]
 buffer_load_dwordx4 v16, s[16:19], s56 offen offset:512 nt lds
 v_mfma_f32_16x16x32_bf16 a[8:11], a[160:163], v[116:119], a[8:11]
 s_cbranch_vccnz L_stub_12_B0
L_stub_12_B0_ret:
 v_mfma_f32_16x16x32_bf16 a[40:43], a[164:167], v[116:119], a[40:43]
 ds_read_b64_tr_b16 a[188:189], v3 offset:33888
 ds_read_b64_tr_b16 a[190:191], v5 offset:33888
 v_mfma_f32_16x16x32_bf16 a[32:35], a[164:167], v[100:103], a[32:35]
 s_waitcnt lgkmcnt(8)
 v_exp_f32 v72, v72
 v_mfma_f32_16x16x32_bf16 a[4:7], a[168:171], v[100:103], a[4:7]
 ds_read_b64_tr_b16 a[160:161], v2 offset:34048
 ds_read_b64_tr_b16 a[162:163], v4 offset:34048
 v_mfma_f32_16x16x32_bf16 a[132:135], a[168:171], v[132:135], a[132:135]
 v_exp_f32 v73, v73
 v_mfma_f32_16x16x32_bf16 a[12:15], a[168:171], v[116:119], a[12:15]
 v_exp_f32 v74, v74
 v_mfma_f32_16x16x32_bf16 a[44:47], a[172:175], v[116:119], a[44:47]
 s_add_u32 m0, s40, 0x8840
 ds_read_b64_tr_b16 a[164:165], v3 offset:34048
 ds_read_b64_tr_b16 a[166:167], v5 offset:34048
 v_mfma_f32_16x16x32_bf16 a[36:39], a[172:175], v[100:103], a[36:39]
 s_waitcnt lgkmcnt(8)
 v_exp_f32 v75, v75
 v_mfma_f32_16x16x32_bf16 a[16:19], a[176:179], v[100:103], a[16:19]
 s_waitcnt vmcnt(4)
 ds_read_b64_tr_b16 a[168:169], v2 offset:34080
 ds_read_b64_tr_b16 a[170:171], v4 offset:34080
 v_mfma_f32_16x16x32_bf16 a[136:139], a[176:179], v[132:135], a[136:139]
 buffer_load_dwordx4 v16, s[16:19], s56 offen offset:1024 nt lds
 v_add_f32 v34, v34, v72
 v_mfma_f32_16x16x32_bf16 a[24:27], a[176:179], v[116:119], a[24:27]
 v_add_f32 v34, v34, v73
 v_cvt_pk_bf16_f32 v72, v72, v73
 v_mfma_f32_16x16x32_bf16 a[56:59], a[180:183], v[116:119], a[56:59]
 ds_read_b64_tr_b16 a[172:173], v3 offset:34080
 ds_read_b64_tr_b16 a[174:175], v5 offset:34080
 v_mfma_f32_16x16x32_bf16 a[48:51], a[180:183], v[100:103], a[48:51]
 s_waitcnt lgkmcnt(8)
 v_add_f32 v34, v34, v74
 v_add_f32 v34, v34, v75
 v_mfma_f32_16x16x32_bf16 a[20:23], a[184:187], v[100:103], a[20:23]
 ds_read_b64_tr_b16 a[176:177], v2 offset:34112
 ds_read_b64_tr_b16 a[178:179], v4 offset:34112
 v_mfma_f32_16x16x32_bf16 a[140:143], a[184:187], v[132:135], a[140:143]
 v_cvt_pk_bf16_f32 v73, v74, v75
 v_mfma_f32_16x16x32_bf16 a[28:31], a[184:187], v[116:119], a[28:31]
 v_exp_f32 v56, v56
 v_mfma_f32_16x16x32_bf16 a[60:63], a[188:191], v[116:119], a[60:63]
 s_add_u32 m0, s40, 0x8a60
 ds_read_b64_tr_b16 a[180:181], v3 offset:34112
 ds_read_b64_tr_b16 a[182:183], v5 offset:34112
 v_mfma_f32_16x16x32_bf16 a[52:55], a[188:191], v[100:103], a[52:55]
 s_waitcnt lgkmcnt(8)
 v_exp_f32 v57, v57
 v_mfma_f32_16x16x32_bf16 a[64:67], a[160:163], v[100:103], a[64:67]
 s_waitcnt vmcnt(4)
 ds_read_b64_tr_b16 a[184:185], v2 offset:34144
 ds_read_b64_tr_b16 a[186:187], v4 offset:34144
 v_mfma_f32_16x16x32_bf16 a[144:147], a[160:163], v[132:135], a[144:147]
 buffer_load_dwordx4 v16, s[16:19], s56 offen offset:1536 nt lds
 v_add_f32 v32, v32, v56
 v_mfma_f32_16x16x32_bf16 a[72:75], a[160:163], v[116:119], a[72:75]
 v_exp_f32 v58, v58
 v_mfma_f32_16x16x32_bf16 a[104:107], a[164:167], v[116:119], a[104:107]
 ds_read_b64_tr_b16 a[188:189], v3 offset:34144
 ds_read_b64_tr_b16 a[190:191], v5 offset:34144
 v_mfma_f32_16x16x32_bf16 a[96:99], a[164:167], v[100:103], a[96:99]
 s_waitcnt lgkmcnt(8)
 v_exp_f32 v59, v59
 v_mfma_f32_16x16x32_bf16 a[68:71], a[168:171], v[100:103], a[68:71]
 s_barrier
 ds_read_b128 a[160:163], v6 offset:16896
 v_mfma_f32_16x16x32_bf16 a[148:151], a[168:171], v[132:135], a[148:151]
 ds_write_b64 v21, v[72:73] offset:0
 v_add_f32 v32, v32, v57
 v_mfma_f32_16x16x32_bf16 a[76:79], a[168:171], v[116:119], a[76:79]
 v_exp_f32 v60, v60
 v_mfma_f32_16x16x32_bf16 a[108:111], a[172:175], v[116:119], a[108:111]
 ds_read_b128 a[164:167], v6 offset:16960
 v_cvt_pk_bf16_f32 v56, v56, v57
 v_mfma_f32_16x16x32_bf16 a[100:103], a[172:175], v[100:103], a[100:103]
 s_waitcnt lgkmcnt(7)
 v_exp_f32 v61, v61
 v_mfma_f32_16x16x32_bf16 a[80:83], a[176:179], v[100:103], a[80:83]
 ds_read_b128 a[168:171], v8 offset:16896
 v_add_f32 v32, v32, v58
 v_mfma_f32_16x16x32_bf16 a[152:155], a[176:179], v[132:135], a[152:155]
 v_exp_f32 v62, v62
 v_mfma_f32_16x16x32_bf16 a[88:91], a[176:179], v[116:119], a[88:91]
 v_exp_f32 v63, v63
 v_mfma_f32_16x16x32_bf16 a[120:123], a[180:183], v[116:119], a[120:123]
 ds_read_b128 a[172:175], v8 offset:16960
 v_add_f32 v32, v32, v59
 v_mfma_f32_16x16x32_bf16 a[112:115], a[180:183], v[100:103], a[112:115]
 s_waitcnt lgkmcnt(5)
 v_exp_f32 v64, v64
 v_mfma_f32_16x16x32_bf16 a[84:87], a[184:187], v[100:103], a[84:87]
 s_xor_b32 s56, s43, 0x30000
 ds_read_b128 a[176:179], v7 offset:16896
 v_cvt_pk_bf16_f32 v57, v58, v59
 v_mfma_f32_16x16x32_bf16 a[156:159], a[184:187], v[132:135], a[156:159]
 s_add_u32 m0, s40, 0x16600
 v_exp_f32 v65, v65
 v_mfma_f32_16x16x32_bf16 a[92:95], a[184:187], v[116:119], a[92:95]
 s_waitcnt vmcnt(4)
 v_exp_f32 v66, v66
 v_mfma_f32_16x16x32_bf16 a[124:127], a[188:191], v[116:119], a[124:127]
 ds_read_b128 a[180:183], v7 offset:16960
 buffer_load_dwordx4 v16, s[20:23], s56 offen offset:0 nt lds
 v_mfma_f32_16x16x32_bf16 a[116:119], a[188:191], v[100:103], a[116:119]
 s_waitcnt lgkmcnt(4)
 v_exp_f32 v67, v67
 v_mfma_f32_16x16x32_bf16 v[100:103], a[160:163], v[96:99], v[44:47]
 ds_read_b128 a[184:187], v9 offset:16896
 v_add_f32 v32, v32, v60
 v_mfma_f32_16x16x32_bf16 v[100:103], a[164:167], v[112:115], v[100:103]
 v_exp_f32 v68, v68
 v_mfma_f32_16x16x32_bf16 v[116:119], a[164:167], v[120:123], v[48:51]
 v_exp_f32 v69, v69
 v_mfma_f32_16x16x32_bf16 v[116:119], a[160:163], v[104:107], v[116:119]
 ds_read_b128 a[188:191], v9 offset:16960
 v_add_f32 v32, v32, v61
 v_mfma_f32_16x16x32_bf16 v[132:135], a[160:163], v[224:227], v[52:55]
 s_add_u32 m0, s40, 0x16820
 v_exp_f32 v70, v70
 v_mfma_f32_16x16x32_bf16 v[132:135], a[164:167], v[232:235], v[132:135]
 s_waitcnt lgkmcnt(4)
 v_exp_f32 v71, v71
 v_mfma_f32_16x16x32_bf16 v[108:111], a[168:171], v[96:99], v[44:47]
 s_waitcnt vmcnt(4)
 ds_read_b128 a[160:163], v6 offset:17152
 v_cvt_pk_bf16_f32 v58, v60, v61
 v_mfma_f32_16x16x32_bf16 v[108:111], a[172:175], v[112:115], v[108:111]
 buffer_load_dwordx4 v16, s[20:23], s56 offen offset:512 nt lds
 v_add_f32 v32, v32, v62
 v_mfma_f32_16x16x32_bf16 v[124:127], a[172:175], v[120:123], v[48:51]
 ds_read_b128 a[164:167], v6 offset:17216
 v_add_f32 v32, v32, v63
 v_mfma_f32_16x16x32_bf16 v[124:127], a[168:171], v[104:107], v[124:127]
 s_waitcnt lgkmcnt(4)
 v_cvt_pk_bf16_f32 v59, v62, v63
 v_add_f32 v33, v33, v64
 v_mfma_f32_16x16x32_bf16 v[100:103], a[176:179], v[128:131], v[100:103]
 ds_read_b128 a[168:171], v8 offset:17152
 v_add_f32 v33, v33, v65
 v_mfma_f32_16x16x32_bf16 v[100:103], a[180:183], v[144:147], v[100:103]
 v_cvt_pk_bf16_f32 v64, v64, v65
 v_add_f32 v33, v33, v66
 v_mfma_f32_16x16x32_bf16 v[116:119], a[180:183], v[152:155], v[116:119]
 v_add_f32 v33, v33, v67
 v_cvt_pk_bf16_f32 v65, v66, v67
 v_mfma_f32_16x16x32_bf16 v[116:119], a[176:179], v[136:139], v[116:119]
 ds_read_b128 a[172:175], v8 offset:17216
 v_add_f32 v33, v33, v68
 v_mfma_f32_16x16x32_bf16 v[132:135], a[176:179], v[228:231], v[132:135]
 v_add_f32 v33, v33, v69
 v_cvt_pk_bf16_f32 v66, v68, v69
 v_mfma_f32_16x16x32_bf16 v[132:135], a[180:183], v[236:239], v[132:135]
 s_waitcnt lgkmcnt(4)
 v_add_f32 v33, v33, v70
 v_add_f32 v33, v33, v71
 v_mfma_f32_16x16x32_bf16 v[108:111], a[184:187], v[128:131], v[108:111]
 s_add_u32 m0, s40, 0x16a40
 ds_read_b128 a[176:179], v7 offset:17152
 v_cvt_pk_bf16_f32 v67, v70, v71
 v_mfma_f32_16x16x32_bf16 v[108:111], a[188:191], v[144:147], v[108:111]
 s_waitcnt vmcnt(4)
 v_mfma_f32_16x16x32_bf16 v[124:127], a[188:191], v[152:155], v[124:127]
 ds_read_b128 a[180:183], v7 offset:17216
 buffer_load_dwordx4 v16, s[20:23], s56 offen offset:1024 nt lds
 v_mfma_f32_16x16x32_bf16 v[124:127], a[184:187], v[136:139], v[124:127]
 s_waitcnt lgkmcnt(4)
 v_mfma_f32_16x16x32_bf16 v[100:103], a[160:163], v[160:163], v[100:103]
 ds_read_b128 a[184:187], v9 offset:17152
 v_mfma_f32_16x16x32_bf16 v[100:103], a[164:167], v[176:179], v[100:103]
 v_mfma_f32_16x16x32_bf16 v[116:119], a[164:167], v[184:187], v[116:119]
 v_mfma_f32_16x16x32_bf16 v[116:119], a[160:163], v[168:171], v[116:119]
 ds_read_b128 a[188:191], v9 offset:17216
 v_mfma_f32_16x16x32_bf16 v[132:135], a[160:163], v[240:243], v[132:135]
 v_mfma_f32_16x16x32_bf16 v[132:135], a[164:167], v[248:251], v[132:135]
 s_waitcnt lgkmcnt(4)
 v_mfma_f32_16x16x32_bf16 v[108:111], a[168:171], v[160:163], v[108:111]
 s_barrier
 ds_read_b64_tr_b16 a[160:161], v2 offset:50688
 ds_read_b64_tr_b16 a[162:163], v4 offset:50688
 v_mfma_f32_16x16x32_bf16 v[108:111], a[172:175], v[176:179], v[108:111]
 ds_read_b64 v[174:175], v22 offset:2048
 v_mfma_f32_16x16x32_bf16 v[124:127], a[172:175], v[184:187], v[124:127]
 ds_read_b64_tr_b16 a[164:165], v3 offset:50688
 ds_read_b64_tr_b16 a[166:167], v5 offset:50688
 v_mfma_f32_16x16x32_bf16 v[124:127], a[168:171], v[168:171], v[124:127]
 s_waitcnt lgkmcnt(7)
 v_mfma_f32_16x16x32_bf16 v[100:103], a[176:179], v[192:195], v[100:103]
 s_xor_b32 s56, s43, 0x30000
 ds_read_b64_tr_b16 a[168:169], v2 offset:50720
 ds_read_b64_tr_b16 a[170:171], v4 offset:50720
 v_mfma_f32_16x16x32_bf16 v[100:103], a[180:183], v[208:211], v[100:103]
 s_add_u32 m0, s40, 0x16c60
 v_mfma_f32_16x16x32_bf16 v[116:119], a[180:183], v[216:219], v[116:119]
 s_waitcnt vmcnt(4)
 v_mfma_f32_16x16x32_bf16 v[116:119], a[176:179], v[200:203], v[116:119]
 ds_read_b64_tr_b16 a[172:173], v3 offset:50720
 ds_read_b64_tr_b16 a[174:175], v5 offset:50720
 v_mfma_f32_16x16x32_bf16 v[132:135], a[176:179], v[244:247], v[132:135]
 buffer_load_dwordx4 v16, s[20:23], s56 offen offset:1536 nt lds
 v_mfma_f32_16x16x32_bf16 v[132:135], a[180:183], v[252:255], v[132:135]
 s_waitcnt lgkmcnt(9)
 v_mfma_f32_16x16x32_bf16 v[108:111], a[184:187], v[192:195], v[108:111]
 ds_read_b64_tr_b16 a[176:177], v2 offset:50752
 ds_read_b64_tr_b16 a[178:179], v4 offset:50752
 v_mfma_f32_16x16x32_bf16 v[108:111], a[188:191], v[208:211], v[108:111]
 v_mfma_f32_16x16x32_bf16 v[124:127], a[188:191], v[216:219], v[124:127]
 ds_read_b64_tr_b16 a[180:181], v3 offset:50752
 ds_read_b64_tr_b16 a[182:183], v5 offset:50752
 v_mfma_f32_16x16x32_bf16 v[124:127], a[184:187], v[200:203], v[124:127]
 s_waitcnt lgkmcnt(8)
 v_mfma_f32_16x16x32_bf16 a[0:3], a[160:163], v[140:143], a[0:3]
 s_xor_b32 s56, s42, 0x3c000
 ds_read_b64_tr_b16 a[184:185], v2 offset:50784
 ds_read_b64_tr_b16 a[186:187], v4 offset:50784
 v_mfma_f32_16x16x32_bf16 a[128:131], a[160:163], v[172:175], a[128:131]
 s_add_u32 m0, s40, 0xc600
 v_mfma_f32_16x16x32_bf16 a[8:11], a[160:163], v[156:159], a[8:11]
 s_cbranch_vccnz L_stub_13_B0
L_stub_13_B0_ret:
 v_mfma_f32_16x16x32_bf16 a[40:43], a[164:167], v[156:159], a[40:43]
 s_waitcnt vmcnt(4)
 ds_read_b64_tr_b16 a[188:189], v3 offset:50784
 ds_read_b64_tr_b16 a[190:191], v5 offset:50784
 v_mfma_f32_16x16x32_bf16 a[32:35], a[164:167], v[140:143], a[32:35]
 s_waitcnt lgkmcnt(8)
 buffer_load_dwordx4 v16, s[16:19], s56 offen offset:0 nt lds
 v_mfma_f32_16x16x32_bf16 a[4:7], a[168:171], v[140:143], a[4:7]
 ds_read_b64_tr_b16 a[160:161], v2 offset:50944
 ds_read_b64_tr_b16 a[162:163], v4 offset:50944
 v_mfma_f32_16x16x32_bf16 a[132:135], a[168:171], v[172:175], a[132:135]
 v_exp_f32 v132, v132
 v_mfma_f32_16x16x32_bf16 a[12:15], a[168:171], v[156:159], a[12:15]
 v_exp_f32 v133, v133
 v_mfma_f32_16x16x32_bf16 a[44:47], a[172:175], v[156:159], a[44:47]
 ds_read_b64_tr_b16 a[164:165], v3 offset:50944
 ds_read_b64_tr_b16 a[166:167], v5 offset:50944
 v_mfma_f32_16x16x32_bf16 a[36:39], a[172:175], v[140:143], a[36:39]
 s_waitcnt lgkmcnt(8)
 v_exp_f32 v134, v134
 v_mfma_f32_16x16x32_bf16 a[16:19], a[176:179], v[140:143], a[16:19]
 s_add_u32 m0, s40, 0xc820
 ds_read_b64_tr_b16 a[168:169], v2 offset:50976
 ds_read_b64_tr_b16 a[170:171], v4 offset:50976
 v_mfma_f32_16x16x32_bf16 a[136:139], a[176:179], v[172:175], a[136:139]
 s_waitcnt vmcnt(4)
 v_exp_f32 v135, v135
 v_mfma_f32_16x16x32_bf16 a[24:27], a[176:179], v[156:159], a[24:27]
 buffer_load_dwordx4 v16, s[16:19], s56 offen offset:512 nt lds
 v_add_f32 v34, v34, v132
 v_mfma_f32_16x16x32_bf16 a[56:59], a[180:183], v[156:159], a[56:59]
 ds_read_b64_tr_b16 a[172:173], v3 offset:50976
 ds_read_b64_tr_b16 a[174:175], v5 offset:50976
 v_mfma_f32_16x16x32_bf16 a[48:51], a[180:183], v[140:143], a[48:51]
 s_waitcnt lgkmcnt(8)
 v_add_f32 v34, v34, v133
 v_cvt_pk_bf16_f32 v132, v132, v133
 v_mfma_f32_16x16x32_bf16 a[20:23], a[184:187], v[140:143], a[20:23]
 ds_read_b64_tr_b16 a[176:177], v2 offset:51008
 ds_read_b64_tr_b16 a[178:179], v4 offset:51008
 v_mfma_f32_16x16x32_bf16 a[140:143], a[184:187], v[172:175], a[140:143]
 v_add_f32 v34, v34, v134
 v_add_f32 v34, v34, v135
 v_mfma_f32_16x16x32_bf16 a[28:31], a[184:187], v[156:159], a[28:31]
 v_cvt_pk_bf16_f32 v133, v134, v135
 v_mfma_f32_16x16x32_bf16 a[60:63], a[188:191], v[156:159], a[60:63]
 ds_read_b64_tr_b16 a[180:181], v3 offset:51008
 ds_read_b64_tr_b16 a[182:183], v5 offset:51008
 v_mfma_f32_16x16x32_bf16 a[52:55], a[188:191], v[140:143], a[52:55]
 s_waitcnt lgkmcnt(8)
 v_exp_f32 v100, v100
 v_mfma_f32_16x16x32_bf16 a[64:67], a[160:163], v[140:143], a[64:67]
 s_add_u32 m0, s40, 0xca40
 ds_read_b64_tr_b16 a[184:185], v2 offset:51040
 ds_read_b64_tr_b16 a[186:187], v4 offset:51040
 v_mfma_f32_16x16x32_bf16 a[144:147], a[160:163], v[172:175], a[144:147]
 s_waitcnt vmcnt(4)
 v_exp_f32 v101, v101
 v_mfma_f32_16x16x32_bf16 a[72:75], a[160:163], v[156:159], a[72:75]
 buffer_load_dwordx4 v16, s[16:19], s56 offen offset:1024 nt lds
 v_add_f32 v32, v32, v100
 v_mfma_f32_16x16x32_bf16 a[104:107], a[164:167], v[156:159], a[104:107]
 ds_read_b64_tr_b16 a[188:189], v3 offset:51040
 ds_read_b64_tr_b16 a[190:191], v5 offset:51040
 v_mfma_f32_16x16x32_bf16 a[96:99], a[164:167], v[140:143], a[96:99]
 s_waitcnt lgkmcnt(8)
 v_exp_f32 v102, v102
 v_mfma_f32_16x16x32_bf16 a[68:71], a[168:171], v[140:143], a[68:71]
 s_mov_b64 exec, 0
 s_cmp_eq_u32 s5, 0
 s_cbranch_scc1 L_pad9
 s_cmp_eq_u32 s5, 1
 s_cbranch_scc1 L_pad10
 s_cmp_eq_u32 s5, 2
 s_cbranch_scc1 L_pad11
 s_branch L_pad12
L_e2_back:
 s_mov_b64 exec, -1
 s_barrier
 ds_read_b128 a[160:163], v6 offset:33792
 v_mfma_f32_16x16x32_bf16 a[148:151], a[168:171], v[172:175], a[148:151]
 ds_write_b64 v21, v[132:133] offset:2048
 v_add_f32 v32, v32, v101
 v_mfma_f32_16x16x32_bf16 a[76:79], a[168:171], v[156:159], a[76:79]
 v_exp_f32 v103, v103
 v_mfma_f32_16x16x32_bf16 a[108:111], a[172:175], v[156:159], a[108:111]
 ds_read_b128 a[164:167], v6 offset:33856
 v_cvt_pk_bf16_f32 v100, v100, v101
 v_mfma_f32_16x16x32_bf16 a[100:103], a[172:175], v[140:143], a[100:103]
 s_waitcnt lgkmcnt(7)
 v_exp_f32 v108, v108
 v_mfma_f32_16x16x32_bf16 a[80:83], a[176:179], v[140:143], a[80:83]
 ds_read_b128 a[168:171], v8 offset:33792
 v_add_f32 v32, v32, v102
 v_mfma_f32_16x16x32_bf16 a[152:155], a[176:179], v[172:175], a[152:155]
 v_exp_f32 v109, v109
 v_mfma_f32_16x16x32_bf16 a[88:91], a[176:179], v[156:159], a[88:91]
 v_exp_f32 v110, v110
 v_mfma_f32_16x16x32_bf16 a[120:123], a[180:183], v[156:159], a[120:123]
 ds_read_b128 a[172:175], v8 offset:33856
 v_add_f32 v32, v32, v103
 v_mfma_f32_16x16x32_bf16 a[112:115], a[180:183], v[140:143], a[112:115]
 s_waitcnt lgkmcnt(5)
 v_exp_f32 v111, v111
 v_mfma_f32_16x16x32_bf16 a[84:87], a[184:187], v[140:143], a[84:87]
 s_xor_b32 s56, s42, 0x3c000
 ds_read_b128 a[176:179], v7 offset:33792
 v_cvt_pk_bf16_f32 v101, v102, v103
 v_mfma_f32_16x16x32_bf16 a[156:159], a[184:187], v[172:175], a[156:159]
 s_add_u32 m0, s40, 0xcc60
 v_exp_f32 v116, v116
 v_mfma_f32_16x16x32_bf16 a[92:95], a[184:187], v[156:159], a[92:95]
 s_waitcnt vmcnt(4)
 v_exp_f32 v117, v117
 v_mfma_f32_16x16x32_bf16 a[124:127], a[188:191], v[156:159], a[124:127]
 ds_read_b128 a[180:183], v7 offset:33856
 buffer_load_dwordx4 v16, s[16:19], s56 offen offset:1536 nt lds
 v_mfma_f32_16x16x32_bf16 a[116:119], a[188:191], v[140:143], a[116:119]
 s_waitcnt lgkmcnt(4)
 v_exp_f32 v118, v118
 v_mfma_f32_16x16x32_bf16 v[140:143], a[160:163], v[96:99], v[44:47]
 ds_read_b128 a[184:187], v9 offset:33792
 v_add_f32 v32, v32, v108
 v_mfma_f32_16x16x32_bf16 v[140:143], a[164:167], v[112:115], v[140:143]
 v_exp_f32 v119, v119
 v_mfma_f32_16x16x32_bf16 v[156:159], a[164:167], v[120:123], v[48:51]
 v_exp_f32 v124, v124
 v_mfma_f32_16x16x32_bf16 v[156:159], a[160:163], v[104:107], v[156:159]
 ds_read_b128 a[188:191], v9 offset:33856
 v_add_f32 v32, v32, v109
 v_mfma_f32_16x16x32_bf16 v[172:175], a[160:163], v[224:227], v[52:55]
 v_exp_f32 v125, v125
 v_mfma_f32_16x16x32_bf16 v[172:175], a[164:167], v[232:235], v[172:175]
 s_waitcnt lgkmcnt(4)
 v_exp_f32 v126, v126
 v_mfma_f32_16x16x32_bf16 v[148:151], a[168:171], v[96:99], v[44:47]
L_pad8:
 s_cbranch_execz L_e1_back
 s_add_u32 s42, s42, 0x200000
 ds_read_b128 a[160:163], v6 offset:34048
 v_cvt_pk_bf16_f32 v102, v108, v109
 v_mfma_f32_16x16x32_bf16 v[148:151], a[172:175], v[112:115], v[148:151]
 s_xor_b32 s56, s43, 0x34000
 v_exp_f32 v127, v127
 v_mfma_f32_16x16x32_bf16 v[164:167], a[172:175], v[120:123], v[48:51]
 s_add_u32 m0, s40, 0x1a800
 ds_read_b128 a[164:167], v6 offset:34112
 v_add_f32 v32, v32, v110
 v_mfma_f32_16x16x32_bf16 v[164:167], a[168:171], v[104:107], v[164:167]
 s_waitcnt lgkmcnt(4)
 v_add_f32 v32, v32, v111
 v_cvt_pk_bf16_f32 v103, v110, v111
 v_mfma_f32_16x16x32_bf16 v[140:143], a[176:179], v[128:131], v[140:143]
 s_waitcnt vmcnt(4)
 ds_read_b128 a[168:171], v8 offset:34048
 v_add_f32 v33, v33, v116
 v_mfma_f32_16x16x32_bf16 v[140:143], a[180:183], v[144:147], v[140:143]
 buffer_load_dwordx4 v16, s[20:23], s56 offen offset:0 nt lds
 v_add_f32 v33, v33, v117
 v_mfma_f32_16x16x32_bf16 v[156:159], a[180:183], v[152:155], v[156:159]
 v_cvt_pk_bf16_f32 v116, v116, v117
 v_add_f32 v33, v33, v118
 v_mfma_f32_16x16x32_bf16 v[156:159], a[176:179], v[136:139], v[156:159]
 ds_read_b128 a[172:175], v8 offset:34112
 v_add_f32 v33, v33, v119
 v_mfma_f32_16x16x32_bf16 v[172:175], a[176:179], v[228:231], v[172:175]
 v_cvt_pk_bf16_f32 v117, v118, v119
 v_add_f32 v33, v33, v124
 v_mfma_f32_16x16x32_bf16 v[172:175], a[180:183], v[236:239], v[172:175]
 s_waitcnt lgkmcnt(4)
 v_add_f32 v33, v33, v125
 v_cvt_pk_bf16_f32 v118, v124, v125
 v_mfma_f32_16x16x32_bf16 v[148:151], a[184:187], v[128:131], v[148:151]
 ds_read_b128 a[176:179], v7 offset:34048
 v_add_f32 v33, v33, v126
 v_mfma_f32_16x16x32_bf16 v[148:151], a[188:191], v[144:147], v[148:151]
 s_add_u32 m0, s40, 0x1aa20
 v_add_f32 v33, v33, v127
 v_cvt_pk_bf16_f32 v119, v126, v127
 v_mfma_f32_16x16x32_bf16 v[164:167], a[188:191], v[152:155], v[164:167]
 s_waitcnt vmcnt(4)
 ds_read_b128 a[180:183], v7 offset:34112
 v_mfma_f32_16x16x32_bf16 v[164:167], a[184:187], v[136:139], v[164:167]
 s_waitcnt lgkmcnt(4)
 buffer_load_dwordx4 v16, s[20:23], s56 offen offset:512 nt lds
 v_mfma_f32_16x16x32_bf16 v[140:143], a[160:163], v[160:163], v[140:143]
 ds_read_b128 a[184:187], v9 offset:34048
 v_mfma_f32_16x16x32_bf16 v[140:143], a[164:167], v[176:179], v[140:143]
 v_mfma_f32_16x16x32_bf16 v[156:159], a[164:167], v[184:187], v[156:159]
 v_mfma_f32_16x16x32_bf16 v[156:159], a[160:163], v[168:171], v[156:159]
 ds_read_b128 a[188:191], v9 offset:34112
 v_mfma_f32_16x16x32_bf16 v[172:175], a[160:163], v[240:243], v[172:175]
 v_mfma_f32_16x16x32_bf16 v[172:175], a[164:167], v[248:251], v[172:175]
 s_waitcnt lgkmcnt(4)
 v_mfma_f32_16x16x32_bf16 v[148:151], a[168:171], v[160:163], v[148:151]
 s_barrier
 ds_read_b64_tr_b16 a[160:161], v2 offset:0
 ds_read_b64_tr_b16 a[162:163], v4 offset:0
 v_mfma_f32_16x16x32_bf16 v[148:151], a[172:175], v[176:179], v[148:151]
 ds_read_b64 v[74:75], v22 offset:0
 v_mfma_f32_16x16x32_bf16 v[164:167], a[172:175], v[184:187], v[164:167]
 ds_read_b64_tr_b16 a[164:165], v3 offset:0
 ds_read_b64_tr_b16 a[166:167], v5 offset:0
 v_mfma_f32_16x16x32_bf16 v[164:167], a[168:171], v[168:171], v[164:167]
 s_waitcnt lgkmcnt(7)
 v_mfma_f32_16x16x32_bf16 v[140:143], a[176:179], v[192:195], v[140:143]
 ds_read_b64_tr_b16 a[168:169], v2 offset:32
 ds_read_b64_tr_b16 a[170:171], v4 offset:32
 v_mfma_f32_16x16x32_bf16 v[140:143], a[180:183], v[208:211], v[140:143]
 v_mfma_f32_16x16x32_bf16 v[156:159], a[180:183], v[216:219], v[156:159]
 s_xor_b32 s56, s43, 0x34000
 v_mfma_f32_16x16x32_bf16 v[156:159], a[176:179], v[200:203], v[156:159]
 s_add_u32 m0, s40, 0x1ac40
 ds_read_b64_tr_b16 a[172:173], v3 offset:32
 ds_read_b64_tr_b16 a[174:175], v5 offset:32
 v_mfma_f32_16x16x32_bf16 v[172:175], a[176:179], v[244:247], v[172:175]
 s_waitcnt vmcnt(4)
 v_mfma_f32_16x16x32_bf16 v[172:175], a[180:183], v[252:255], v[172:175]
 s_waitcnt lgkmcnt(9)
 buffer_load_dwordx4 v16, s[20:23], s56 offen offset:1024 nt lds
 v_mfma_f32_16x16x32_bf16 v[148:151], a[184:187], v[192:195], v[148:151]
 ds_read_b64_tr_b16 a[176:177], v2 offset:64
 ds_read_b64_tr_b16 a[178:179], v4 offset:64
 v_mfma_f32_16x16x32_bf16 v[148:151], a[188:191], v[208:211], v[148:151]
 v_mfma_f32_16x16x32_bf16 v[164:167], a[188:191], v[216:219], v[164:167]
 ds_read_b64_tr_b16 a[180:181], v3 offset:64
 ds_read_b64_tr_b16 a[182:183], v5 offset:64
 v_mfma_f32_16x16x32_bf16 v[164:167], a[184:187], v[200:203], v[164:167]
 s_waitcnt lgkmcnt(8)
 v_mfma_f32_16x16x32_bf16 a[0:3], a[160:163], v[56:59], a[0:3]
 ds_read_b64_tr_b16 a[184:185], v2 offset:96
 ds_read_b64_tr_b16 a[186:187], v4 offset:96
 v_mfma_f32_16x16x32_bf16 a[128:131], a[160:163], v[72:75], a[128:131]
 v_mfma_f32_16x16x32_bf16 a[8:11], a[160:163], v[64:67], a[8:11]
 s_cbranch_vccnz L_stub_14_B0
L_stub_14_B0_ret:
 v_mfma_f32_16x16x32_bf16 a[40:43], a[164:167], v[64:67], a[40:43]
 s_add_u32 m0, s40, 0x1ae60
 ds_read_b64_tr_b16 a[188:189], v3 offset:96
 ds_read_b64_tr_b16 a[190:191], v5 offset:96
 v_mfma_f32_16x16x32_bf16 a[32:35], a[164:167], v[56:59], a[32:35]
 s_waitcnt lgkmcnt(8)
 v_exp_f32 v172, v172
 v_mfma_f32_16x16x32_bf16 a[4:7], a[168:171], v[56:59], a[4:7]
 s_waitcnt vmcnt(4)
 ds_read_b64_tr_b16 a[160:161], v2 offset:256
 ds_read_b64_tr_b16 a[162:163], v4 offset:256
 v_mfma_f32_16x16x32_bf16 a[132:135], a[168:171], v[72:75], a[132:135]
 buffer_load_dwordx4 v16, s[20:23], s56 offen offset:1536 nt lds
 v_mfma_f32_16x16x32_bf16 a[12:15], a[168:171], v[64:67], a[12:15]
 v_exp_f32 v173, v173
 v_mfma_f32_16x16x32_bf16 a[44:47], a[172:175], v[64:67], a[44:47]
 ds_read_b64_tr_b16 a[164:165], v3 offset:256
 ds_read_b64_tr_b16 a[166:167], v5 offset:256
 v_mfma_f32_16x16x32_bf16 a[36:39], a[172:175], v[56:59], a[36:39]
 s_waitcnt lgkmcnt(8)
 v_exp_f32 v174, v174
 v_mfma_f32_16x16x32_bf16 a[16:19], a[176:179], v[56:59], a[16:19]
 ds_read_b64_tr_b16 a[168:169], v2 offset:288
 ds_read_b64_tr_b16 a[170:171], v4 offset:288
 v_mfma_f32_16x16x32_bf16 a[136:139], a[176:179], v[72:75], a[136:139]
 v_exp_f32 v175, v175
 v_mfma_f32_16x16x32_bf16 a[24:27], a[176:179], v[64:67], a[24:27]
 s_xor_b32 s56, s43, 0x38000
 v_add_f32 v34, v34, v172
 v_add_f32 v34, v34, v173
 v_mfma_f32_16x16x32_bf16 a[56:59], a[180:183], v[64:67], a[56:59]
 s_add_u32 m0, s40, 0x1ea00
 ds_read_b64_tr_b16 a[172:173], v3 offset:288
 ds_read_b64_tr_b16 a[174:175], v5 offset:288
 v_mfma_f32_16x16x32_bf16 a[48:51], a[180:183], v[56:59], a[48:51]
 s_waitcnt lgkmcnt(8)
 v_cvt_pk_bf16_f32 v172, v172, v173
 v_add_f32 v34, v34, v174
 v_mfma_f32_16x16x32_bf16 a[20:23], a[184:187], v[56:59], a[20:23]
 s_waitcnt vmcnt(4)
 ds_read_b64_tr_b16 a[176:177], v2 offset:320
 ds_read_b64_tr_b16 a[178:179], v4 offset:320
 v_mfma_f32_16x16x32_bf16 a[140:143], a[184:187], v[72:75], a[140:143]
 buffer_load_dwordx4 v16, s[20:23], s56 offen offset:0 nt lds
 v_add_f32 v34, v34, v175
 v_mfma_f32_16x16x32_bf16 a[28:31], a[184:187], v[64:67], a[28:31]
 v_cvt_pk_bf16_f32 v173, v174, v175
 v_mfma_f32_16x16x32_bf16 a[60:63], a[188:191], v[64:67], a[60:63]
 ds_read_b64_tr_b16 a[180:181], v3 offset:320
 ds_read_b64_tr_b16 a[182:183], v5 offset:320
 v_mfma_f32_16x16x32_bf16 a[52:55], a[188:191], v[56:59], a[52:55]
 s_waitcnt lgkmcnt(8)
 v_exp_f32 v140, v140
 v_mfma_f32_16x16x32_bf16 a[64:67], a[160:163], v[56:59], a[64:67]
 ds_read_b64_tr_b16 a[184:185], v2 offset:352
 ds_read_b64_tr_b16 a[186:187], v4 offset:352
 v_mfma_f32_16x16x32_bf16 a[144:147], a[160:163], v[72:75], a[144:147]
 v_exp_f32 v141, v141
 v_mfma_f32_16x16x32_bf16 a[72:75], a[160:163], v[64:67], a[72:75]
 v_exp_f32 v142, v142
 v_mfma_f32_16x16x32_bf16 a[104:107], a[164:167], v[64:67], a[104:107]
 ds_read_b64_tr_b16 a[188:189], v3 offset:352
 ds_read_b64_tr_b16 a[190:191], v5 offset:352
 v_mfma_f32_16x16x32_bf16 a[96:99], a[164:167], v[56:59], a[96:99]
 s_waitcnt lgkmcnt(8)
 v_exp_f32 v143, v143
 v_mfma_f32_16x16x32_bf16 a[68:71], a[168:171], v[56:59], a[68:71]
 s_barrier
 ds_read_b128 a[160:163], v6 offset:50688
 v_mfma_f32_16x16x32_bf16 a[148:151], a[168:171], v[72:75], a[148:151]
 ds_write_b64 v21, v[172:173] offset:0
 v_add_f32 v32, v32, v140
 v_mfma_f32_16x16x32_bf16 a[76:79], a[168:171], v[64:67], a[76:79]
 s_xor_b32 s56, s43, 0x38000
 v_exp_f32 v148, v148
 v_mfma_f32_16x16x32_bf16 a[108:111], a[172:175], v[64:67], a[108:111]
 s_add_u32 m0, s40, 0x1ec20
 ds_read_b128 a[164:167], v6 offset:50752
 v_add_f32 v32, v32, v141
 v_mfma_f32_16x16x32_bf16 a[100:103], a[172:175], v[56:59], a[100:103]
 s_waitcnt lgkmcnt(7)
 v_exp_f32 v149, v149
 v_mfma_f32_16x16x32_bf16 a[80:83], a[176:179], v[56:59], a[80:83]
 s_waitcnt vmcnt(4)
 ds_read_b128 a[168:171], v8 offset:50688
 v_cvt_pk_bf16_f32 v140, v140, v141
 v_mfma_f32_16x16x32_bf16 a[152:155], a[176:179], v[72:75], a[152:155]
 buffer_load_dwordx4 v16, s[20:23], s56 offen offset:512 nt lds
 v_add_f32 v32, v32, v142
 v_mfma_f32_16x16x32_bf16 a[88:91], a[176:179], v[64:67], a[88:91]
 v_exp_f32 v150, v150
 v_mfma_f32_16x16x32_bf16 a[120:123], a[180:183], v[64:67], a[120:123]
 ds_read_b128 a[172:175], v8 offset:50752
 v_add_f32 v32, v32, v143
 v_mfma_f32_16x16x32_bf16 a[112:115], a[180:183], v[56:59], a[112:115]
 s_waitcnt lgkmcnt(5)
 v_exp_f32 v151, v151
 v_mfma_f32_16x16x32_bf16 a[84:87], a[184:187], v[56:59], a[84:87]
 ds_read_b128 a[176:179], v7 offset:50688
 v_cvt_pk_bf16_f32 v141, v142, v143
 v_mfma_f32_16x16x32_bf16 a[156:159], a[184:187], v[72:75], a[156:159]
 v_exp_f32 v156, v156
 v_mfma_f32_16x16x32_bf16 a[92:95], a[184:187], v[64:67], a[92:95]
 s_add_u32 m0, s40, 0x1ee40
 v_exp_f32 v157, v157
 v_mfma_f32_16x16x32_bf16 a[124:127], a[188:191], v[64:67], a[124:127]
 s_waitcnt vmcnt(4)
 ds_read_b128 a[180:183], v7 offset:50752
 v_add_f32 v32, v32, v148
 v_mfma_f32_16x16x32_bf16 a[116:119], a[188:191], v[56:59], a[116:119]
 s_waitcnt lgkmcnt(4)
 buffer_load_dwordx4 v16, s[20:23], s56 offen offset:1024 nt lds
 v_add_f32 v32, v32, v149
 v_mfma_f32_16x16x32_bf16 v[56:59], a[160:163], v[96:99], v[44:47]
 ds_read_b128 a[184:187], v9 offset:50688
 v_cvt_pk_bf16_f32 v142, v148, v149
 v_mfma_f32_16x16x32_bf16 v[56:59], a[164:167], v[112:115], v[56:59]
 v_exp_f32 v158, v158
 v_mfma_f32_16x16x32_bf16 v[64:67], a[164:167], v[120:123], v[48:51]
 v_exp_f32 v159, v159
 v_mfma_f32_16x16x32_bf16 v[64:67], a[160:163], v[104:107], v[64:67]
 ds_read_b128 a[188:191], v9 offset:50752
 v_add_f32 v32, v32, v150
 v_mfma_f32_16x16x32_bf16 v[72:75], a[160:163], v[224:227], v[52:55]
 v_exp_f32 v164, v164
 v_mfma_f32_16x16x32_bf16 v[72:75], a[164:167], v[232:235], v[72:75]
 s_waitcnt lgkmcnt(4)
 v_exp_f32 v165, v165
 v_mfma_f32_16x16x32_bf16 v[60:63], a[168:171], v[96:99], v[44:47]
 ds_read_b128 a[160:163], v6 offset:50944
 v_add_f32 v32, v32, v151
 v_mfma_f32_16x16x32_bf16 v[60:63], a[172:175], v[112:115], v[60:63]
 v_exp_f32 v166, v166
 v_mfma_f32_16x16x32_bf16 v[68:71], a[172:175], v[120:123], v[48:51]
 s_add_u32 m0, s40, 0x1f060
 ds_read_b128 a[164:167], v6 offset:51008
 v_cvt_pk_bf16_f32 v143, v150, v151
 v_mfma_f32_16x16x32_bf16 v[68:71], a[168:171], v[104:107], v[68:71]
 s_waitcnt lgkmcnt(4)
 v_exp_f32 v167, v167
 v_mfma_f32_16x16x32_bf16 v[56:59], a[176:179], v[128:131], v[56:59]
 s_waitcnt vmcnt(4)
 ds_read_b128 a[168:171], v8 offset:50944
 v_add_f32 v33, v33, v156
 v_mfma_f32_16x16x32_bf16 v[56:59], a[180:183], v[144:147], v[56:59]
 buffer_load_dwordx4 v16, s[20:23], s56 offen offset:1536 nt lds
 v_add_f32 v33, v33, v157
 v_mfma_f32_16x16x32_bf16 v[64:67], a[180:183], v[152:155], v[64:67]
 v_cvt_pk_bf16_f32 v156, v156, v157
 v_add_f32 v33, v33, v158
 v_mfma_f32_16x16x32_bf16 v[64:67], a[176:179], v[136:139], v[64:67]
 ds_read_b128 a[172:175], v8 offset:51008
 v_add_f32 v33, v33, v159
 v_mfma_f32_16x16x32_bf16 v[72:75], a[176:179], v[228:231], v[72:75]
 v_cvt_pk_bf16_f32 v157, v158, v159
 v_add_f32 v33, v33, v164
 v_mfma_f32_16x16x32_bf16 v[72:75], a[180:183], v[236:239], v[72:75]
 s_waitcnt lgkmcnt(4)
 v_add_f32 v33, v33, v165
 v_cvt_pk_bf16_f32 v158, v164, v165
 v_mfma_f32_16x16x32_bf16 v[60:63], a[184:187], v[128:131], v[60:63]
 ds_read_b128 a[176:179], v7 offset:50944
 v_add_f32 v33, v33, v166
 v_mfma_f32_16x16x32_bf16 v[60:63], a[188:191], v[144:147], v[60:63]
 v_add_f32 v33, v33, v167
 v_cvt_pk_bf16_f32 v159, v166, v167
 v_mfma_f32_16x16x32_bf16 v[68:71], a[188:191], v[152:155], v[68:71]
 s_xor_b32 s56, s43, 0x3c000
 ds_read_b128 a[180:183], v7 offset:51008
 v_mfma_f32_16x16x32_bf16 v[68:71], a[184:187], v[136:139], v[68:71]
 s_waitcnt lgkmcnt(4)
 v_mfma_f32_16x16x32_bf16 v[56:59], a[160:163], v[160:163], v[56:59]
 s_add_u32 m0, s40, 0x22c00
 ds_read_b128 a[184:187], v9 offset:50944
 v_mfma_f32_16x16x32_bf16 v[56:59], a[164:167], v[176:179], v[56:59]
 s_waitcnt vmcnt(4)
 v_mfma_f32_16x16x32_bf16 v[64:67], a[164:167], v[184:187], v[64:67]
 buffer_load_dwordx4 v16, s[20:23], s56 offen offset:0 nt lds
 v_mfma_f32_16x16x32_bf16 v[64:67], a[160:163], v[168:171], v[64:67]
 ds_read_b128 a[188:191], v9 offset:51008
 v_mfma_f32_16x16x32_bf16 v[72:75], a[160:163], v[240:243], v[72:75]
 v_mfma_f32_16x16x32_bf16 v[72:75], a[164:167], v[248:251], v[72:75]
 s_waitcnt lgkmcnt(4)
 v_mfma_f32_16x16x32_bf16 v[60:63], a[168:171], v[160:163], v[60:63]
 s_barrier
 ds_read_b64_tr_b16 a[160:161], v2 offset:16896
 ds_read_b64_tr_b16 a[162:163], v4 offset:16896
 v_mfma_f32_16x16x32_bf16 v[60:63], a[172:175], v[176:179], v[60:63]
 s_xor_b32 s56, s43, 0x3c000
 ds_read_b64 v[134:135], v22 offset:2048
 v_mfma_f32_16x16x32_bf16 v[68:71], a[172:175], v[184:187], v[68:71]
 s_add_u32 m0, s40, 0x22e20
 ds_read_b64_tr_b16 a[164:165], v3 offset:16896
 ds_read_b64_tr_b16 a[166:167], v5 offset:16896
 v_mfma_f32_16x16x32_bf16 v[68:71], a[168:171], v[168:171], v[68:71]
 s_waitcnt lgkmcnt(7)
 v_mfma_f32_16x16x32_bf16 v[56:59], a[176:179], v[192:195], v[56:59]
 s_waitcnt vmcnt(4)
 ds_read_b64_tr_b16 a[168:169], v2 offset:16928
 ds_read_b64_tr_b16 a[170:171], v4 offset:16928
 v_mfma_f32_16x16x32_bf16 v[56:59], a[180:183], v[208:211], v[56:59]
 buffer_load_dwordx4 v16, s[20:23], s56 offen offset:512 nt lds
 v_mfma_f32_16x16x32_bf16 v[64:67], a[180:183], v[216:219], v[64:67]
 s_add_u32 m0, s40, 0x23040
 v_mfma_f32_16x16x32_bf16 v[64:67], a[176:179], v[200:203], v[64:67]
 s_waitcnt vmcnt(4)
 ds_read_b64_tr_b16 a[172:173], v3 offset:16928
 ds_read_b64_tr_b16 a[174:175], v5 offset:16928
 v_mfma_f32_16x16x32_bf16 v[72:75], a[176:179], v[244:247], v[72:75]
 buffer_load_dwordx4 v16, s[20:23], s56 offen offset:1024 nt lds
 v_mfma_f32_16x16x32_bf16 v[72:75], a[180:183], v[252:255], v[72:75]
 s_waitcnt lgkmcnt(9)
 v_mfma_f32_16x16x32_bf16 v[60:63], a[184:187], v[192:195], v[60:63]
 ds_read_b64_tr_b16 a[176:177], v2 offset:16960
 ds_read_b64_tr_b16 a[178:179], v4 offset:16960
 v_mfma_f32_16x16x32_bf16 v[60:63], a[188:191], v[208:211], v[60:63]
 v_mfma_f32_16x16x32_bf16 v[68:71], a[188:191], v[216:219], v[68:71]
 s_add_u32 m0, s40, 0x23260
 ds_read_b64_tr_b16 a[180:181], v3 offset:16960
 ds_read_b64_tr_b16 a[182:183], v5 offset:16960
 v_mfma_f32_16x16x32_bf16 v[68:71], a[184:187], v[200:203], v[68:71]
 s_waitcnt lgkmcnt(8)
 v_mfma_f32_16x16x32_bf16 a[0:3], a[160:163], v[100:103], a[0:3]
 s_waitcnt vmcnt(4)
 ds_read_b64_tr_b16 a[184:185], v2 offset:16992
 ds_read_b64_tr_b16 a[186:187], v4 offset:16992
 v_mfma_f32_16x16x32_bf16 a[128:131], a[160:163], v[132:135], a[128:131]
 buffer_load_dwordx4 v16, s[20:23], s56 offen offset:1536 nt lds
 v_mfma_f32_16x16x32_bf16 a[8:11], a[160:163], v[116:119], a[8:11]
 s_cbranch_vccnz L_stub_15_B0
L_stub_15_B0_ret:
 v_mfma_f32_16x16x32_bf16 a[40:43], a[164:167], v[116:119], a[40:43]
 ds_read_b64_tr_b16 a[188:189], v3 offset:16992
 ds_read_b64_tr_b16 a[190:191], v5 offset:16992
 v_mfma_f32_16x16x32_bf16 a[32:35], a[164:167], v[100:103], a[32:35]
 s_waitcnt lgkmcnt(8)
 v_exp_f32 v72, v72
 v_mfma_f32_16x16x32_bf16 a[4:7], a[168:171], v[100:103], a[4:7]
 s_add_u32 s43, s43, 0x200000
 ds_read_b64_tr_b16 a[160:161], v2 offset:17152
 ds_read_b64_tr_b16 a[162:163], v4 offset:17152
 v_mfma_f32_16x16x32_bf16 a[132:135], a[168:171], v[132:135], a[132:135]
 s_add_u32 m0, s41, 0x11600
 v_exp_f32 v73, v73
 v_mfma_f32_16x16x32_bf16 a[12:15], a[168:171], v[116:119], a[12:15]
 s_add_u32 s56, s45, 0
 buffer_load_dwordx4 v18, s[8:11], s56 offen offset:0 lds
 v_mfma_f32_16x16x32_bf16 a[44:47], a[172:175], v[116:119], a[44:47]
 ds_read_b64_tr_b16 a[164:165], v3 offset:17152
 ds_read_b64_tr_b16 a[166:167], v5 offset:17152
 v_mfma_f32_16x16x32_bf16 a[36:39], a[172:175], v[100:103], a[36:39]
 s_waitcnt lgkmcnt(8)
 v_exp_f32 v74, v74
 v_mfma_f32_16x16x32_bf16 a[16:19], a[176:179], v[100:103], a[16:19]
 s_add_u32 m0, s41, 0x12600
 ds_read_b64_tr_b16 a[168:169], v2 offset:17184
 ds_read_b64_tr_b16 a[170:171], v4 offset:17184
 v_mfma_f32_16x16x32_bf16 a[136:139], a[176:179], v[132:135], a[136:139]
 s_add_u32 s56, s45, 0x7000
 buffer_load_dwordx4 v18, s[8:11], s56 offen offset:0 lds
 v_mfma_f32_16x16x32_bf16 a[24:27], a[176:179], v[116:119], a[24:27]
 v_exp_f32 v75, v75
 v_mfma_f32_16x16x32_bf16 a[56:59], a[180:183], v[116:119], a[56:59]
 ds_read_b64_tr_b16 a[172:173], v3 offset:17184
 ds_read_b64_tr_b16 a[174:175], v5 offset:17184
 v_mfma_f32_16x16x32_bf16 a[48:51], a[180:183], v[100:103], a[48:51]
 s_waitcnt lgkmcnt(8)
 v_add_f32 v34, v34, v72
 v_add_f32 v34, v34, v73
 v_mfma_f32_16x16x32_bf16 a[20:23], a[184:187], v[100:103], a[20:23]
 s_add_u32 m0, s41, 0x13600
 ds_read_b64_tr_b16 a[176:177], v2 offset:17216
 ds_read_b64_tr_b16 a[178:179], v4 offset:17216
 v_mfma_f32_16x16x32_bf16 a[140:143], a[184:187], v[132:135], a[140:143]
 s_add_u32 s56, s45, 0xe000
 buffer_load_dwordx4 v18, s[8:11], s56 offen offset:0 lds
 v_cvt_pk_bf16_f32 v72, v72, v73
 v_mfma_f32_16x16x32_bf16 a[28:31], a[184:187], v[116:119], a[28:31]
 v_add_f32 v34, v34, v74
 v_add_f32 v34, v34, v75
 v_mfma_f32_16x16x32_bf16 a[60:63], a[188:191], v[116:119], a[60:63]
 ds_read_b64_tr_b16 a[180:181], v3 offset:17216
 ds_read_b64_tr_b16 a[182:183], v5 offset:17216
 v_mfma_f32_16x16x32_bf16 a[52:55], a[188:191], v[100:103], a[52:55]
 s_waitcnt lgkmcnt(8)
 v_cvt_pk_bf16_f32 v73, v74, v75
 v_mfma_f32_16x16x32_bf16 a[64:67], a[160:163], v[100:103], a[64:67]
 ds_read_b64_tr_b16 a[184:185], v2 offset:17248
 ds_read_b64_tr_b16 a[186:187], v4 offset:17248
 v_mfma_f32_16x16x32_bf16 a[144:147], a[160:163], v[132:135], a[144:147]
 v_exp_f32 v56, v56
 v_mfma_f32_16x16x32_bf16 a[72:75], a[160:163], v[116:119], a[72:75]
 v_exp_f32 v57, v57
 v_mfma_f32_16x16x32_bf16 a[104:107], a[164:167], v[116:119], a[104:107]
 ds_read_b64_tr_b16 a[188:189], v3 offset:17248
 ds_read_b64_tr_b16 a[190:191], v5 offset:17248
 v_mfma_f32_16x16x32_bf16 a[96:99], a[164:167], v[100:103], a[96:99]
 s_waitcnt lgkmcnt(8)
 v_exp_f32 v58, v58
 v_mfma_f32_16x16x32_bf16 a[68:71], a[168:171], v[100:103], a[68:71]
 s_waitcnt vmcnt(7)
 s_barrier
 ds_read_b64_tr_b16 a[160:161], v2 offset:33792
 ds_read_b64_tr_b16 a[162:163], v4 offset:33792
 v_mfma_f32_16x16x32_bf16 a[148:151], a[168:171], v[132:135], a[148:151]
 s_add_u32 m0, s41, 0x14600
 ds_read_b64 v[174:175], v22 offset:0
 ds_write_b64 v21, v[72:73] offset:2048
 v_mfma_f32_16x16x32_bf16 a[76:79], a[168:171], v[116:119], a[76:79]
 s_add_u32 s56, s45, 0x15000
 buffer_load_dwordx4 v18, s[8:11], s56 offen offset:0 lds
 v_add_f32 v32, v32, v56
 v_mfma_f32_16x16x32_bf16 a[108:111], a[172:175], v[116:119], a[108:111]
 ds_read_b64_tr_b16 a[164:165], v3 offset:33792
 ds_read_b64_tr_b16 a[166:167], v5 offset:33792
 v_mfma_f32_16x16x32_bf16 a[100:103], a[172:175], v[100:103], a[100:103]
 s_waitcnt lgkmcnt(10)
 v_exp_f32 v59, v59
 v_mfma_f32_16x16x32_bf16 a[80:83], a[176:179], v[100:103], a[80:83]
 ds_read_b64_tr_b16 a[168:169], v2 offset:33824
 ds_read_b64_tr_b16 a[170:171], v4 offset:33824
 v_mfma_f32_16x16x32_bf16 a[152:155], a[176:179], v[132:135], a[152:155]
 s_add_u32 m0, s41, 0x15600
 v_exp_f32 v60, v60
 v_mfma_f32_16x16x32_bf16 a[88:91], a[176:179], v[116:119], a[88:91]
 s_add_u32 s56, s45, 0x1c000
 buffer_load_dwordx4 v18, s[8:11], s56 offen offset:0 lds
 v_add_f32 v32, v32, v57
 v_mfma_f32_16x16x32_bf16 a[120:123], a[180:183], v[116:119], a[120:123]
 ds_read_b64_tr_b16 a[172:173], v3 offset:33824
 ds_read_b64_tr_b16 a[174:175], v5 offset:33824
 v_mfma_f32_16x16x32_bf16 a[112:115], a[180:183], v[100:103], a[112:115]
 s_waitcnt lgkmcnt(10)
 v_exp_f32 v61, v61
 v_mfma_f32_16x16x32_bf16 a[84:87], a[184:187], v[100:103], a[84:87]
 ds_read_b64_tr_b16 a[176:177], v2 offset:33856
 ds_read_b64_tr_b16 a[178:179], v4 offset:33856
 v_mfma_f32_16x16x32_bf16 a[156:159], a[184:187], v[132:135], a[156:159]
 v_exp_f32 v62, v62
 v_mfma_f32_16x16x32_bf16 a[92:95], a[184:187], v[116:119], a[92:95]
 s_add_u32 s45, s45, 0x80
 v_exp_f32 v63, v63
 v_mfma_f32_16x16x32_bf16 a[124:127], a[188:191], v[116:119], a[124:127]
 s_sub_u32 s56, s45, 0x380
 ds_read_b64_tr_b16 a[180:181], v3 offset:33856
 ds_read_b64_tr_b16 a[182:183], v5 offset:33856
 v_mfma_f32_16x16x32_bf16 a[116:119], a[188:191], v[100:103], a[116:119]
 s_waitcnt lgkmcnt(8)
 v_exp_f32 v64, v64
 v_mfma_f32_16x16x32_bf16 a[0:3], a[160:163], v[140:143], a[0:3]
 s_min_u32 s45, s45, s56
 ds_read_b64_tr_b16 a[184:185], v2 offset:33888
 ds_read_b64_tr_b16 a[186:187], v4 offset:33888
 v_mfma_f32_16x16x32_bf16 a[128:131], a[160:163], v[172:175], a[128:131]
 s_add_u32 m0, s40, 0x16600
 v_exp_f32 v65, v65
 v_mfma_f32_16x16x32_bf16 a[8:11], a[160:163], v[156:159], a[8:11]
 s_add_u32 s56, s44, 0
 buffer_load_dwordx4 v17, s[12:15], s56 offen offset:0 lds
 v_cvt_pk_bf16_f32 v56, v56, v57
 v_mfma_f32_16x16x32_bf16 a[40:43], a[164:167], v[156:159], a[40:43]
 s_add_u32 s56, s44, 0x1be0
 ds_read_b64_tr_b16 a[188:189], v3 offset:33888
 ds_read_b64_tr_b16 a[190:191], v5 offset:33888
 v_mfma_f32_16x16x32_bf16 a[32:35], a[164:167], v[140:143], a[32:35]
 s_waitcnt lgkmcnt(8)
 buffer_load_dwordx4 v17, s[12:15], s56 offen offset:1056 lds
 v_add_f32 v32, v32, v58
 v_mfma_f32_16x16x32_bf16 a[4:7], a[168:171], v[140:143], a[4:7]
 ds_read_b64_tr_b16 a[160:161], v2 offset:34048
 ds_read_b64_tr_b16 a[162:163], v4 offset:34048
 v_mfma_f32_16x16x32_bf16 a[132:135], a[168:171], v[172:175], a[132:135]
 v_exp_f32 v66, v66
 v_mfma_f32_16x16x32_bf16 a[12:15], a[168:171], v[156:159], a[12:15]
 v_exp_f32 v67, v67
 v_mfma_f32_16x16x32_bf16 a[44:47], a[172:175], v[156:159], a[44:47]
 ds_read_b64_tr_b16 a[164:165], v3 offset:34048
 ds_read_b64_tr_b16 a[166:167], v5 offset:34048
 v_mfma_f32_16x16x32_bf16 a[36:39], a[172:175], v[140:143], a[36:39]
 s_waitcnt lgkmcnt(8)
 v_exp_f32 v68, v68
 v_mfma_f32_16x16x32_bf16 a[16:19], a[176:179], v[140:143], a[16:19]
 s_add_u32 s56, s44, 0x37c0
 ds_read_b64_tr_b16 a[168:169], v2 offset:34080
 ds_read_b64_tr_b16 a[170:171], v4 offset:34080
 v_mfma_f32_16x16x32_bf16 a[136:139], a[176:179], v[172:175], a[136:139]
 buffer_load_dwordx4 v17, s[12:15], s56 offen offset:2112 lds
 v_add_f32 v32, v32, v59
 v_mfma_f32_16x16x32_bf16 a[24:27], a[176:179], v[156:159], a[24:27]
 v_exp_f32 v69, v69
 v_mfma_f32_16x16x32_bf16 a[56:59], a[180:183], v[156:159], a[56:59]
 ds_read_b64_tr_b16 a[172:173], v3 offset:34080
 ds_read_b64_tr_b16 a[174:175], v5 offset:34080
 v_mfma_f32_16x16x32_bf16 a[48:51], a[180:183], v[140:143], a[48:51]
 s_waitcnt lgkmcnt(8)
 v_exp_f32 v70, v70
 v_mfma_f32_16x16x32_bf16 a[20:23], a[184:187], v[140:143], a[20:23]
 s_add_u32 s56, s44, 0x53a0
 ds_read_b64_tr_b16 a[176:177], v2 offset:34112
 ds_read_b64_tr_b16 a[178:179], v4 offset:34112
 v_mfma_f32_16x16x32_bf16 a[140:143], a[184:187], v[172:175], a[140:143]
 buffer_load_dwordx4 v17, s[12:15], s56 offen offset:3168 lds
 v_cvt_pk_bf16_f32 v57, v58, v59
 v_mfma_f32_16x16x32_bf16 a[28:31], a[184:187], v[156:159], a[28:31]
 v_exp_f32 v71, v71
 v_mfma_f32_16x16x32_bf16 a[60:63], a[188:191], v[156:159], a[60:63]
 ds_read_b64_tr_b16 a[180:181], v3 offset:34112
 ds_read_b64_tr_b16 a[182:183], v5 offset:34112
 v_mfma_f32_16x16x32_bf16 a[52:55], a[188:191], v[140:143], a[52:55]
 s_waitcnt lgkmcnt(8)
 v_add_f32 v32, v32, v60
 v_add_f32 v32, v32, v61
 v_mfma_f32_16x16x32_bf16 a[64:67], a[160:163], v[140:143], a[64:67]
 ds_read_b64_tr_b16 a[184:185], v2 offset:34144
 ds_read_b64_tr_b16 a[186:187], v4 offset:34144
 v_mfma_f32_16x16x32_bf16 a[144:147], a[160:163], v[172:175], a[144:147]
 v_cvt_pk_bf16_f32 v58, v60, v61
 v_add_f32 v32, v32, v62
 v_mfma_f32_16x16x32_bf16 a[72:75], a[160:163], v[156:159], a[72:75]
 v_add_f32 v32, v32, v63
 v_cvt_pk_bf16_f32 v59, v62, v63
 v_mfma_f32_16x16x32_bf16 a[104:107], a[164:167], v[156:159], a[104:107]
 ds_read_b64_tr_b16 a[188:189], v3 offset:34144
 ds_read_b64_tr_b16 a[190:191], v5 offset:34144
 v_mfma_f32_16x16x32_bf16 a[96:99], a[164:167], v[140:143], a[96:99]
 s_waitcnt lgkmcnt(8)
 v_add_f32 v33, v33, v64
 v_add_f32 v33, v33, v65
 v_mfma_f32_16x16x32_bf16 a[68:71], a[168:171], v[140:143], a[68:71]
 s_waitcnt vmcnt(9)
 s_barrier
 ds_read_b64_tr_b16 a[160:161], v2 offset:50688
 ds_read_b64_tr_b16 a[162:163], v4 offset:50688
 v_mfma_f32_16x16x32_bf16 a[148:151], a[168:171], v[172:175], a[148:151]
 s_add_u32 m0, s40, 0x1a800
 ds_read_b64 v[74:75], v22 offset:2048
 v_cvt_pk_bf16_f32 v64, v64, v65
 v_mfma_f32_16x16x32_bf16 a[76:79], a[168:171], v[156:159], a[76:79]
 s_add_u32 s56, s44, 0x40000
 v_add_f32 v33, v33, v66
 v_add_f32 v33, v33, v67
 v_mfma_f32_16x16x32_bf16 a[108:111], a[172:175], v[156:159], a[108:111]
 ds_read_b64_tr_b16 a[164:165], v2 offset:50720
 ds_read_b64_tr_b16 a[166:167], v4 offset:50720
 v_mfma_f32_16x16x32_bf16 a[100:103], a[172:175], v[140:143], a[100:103]
 s_waitcnt lgkmcnt(9)
 v_cvt_pk_bf16_f32 v65, v66, v67
 v_add_f32 v33, v33, v68
 v_mfma_f32_16x16x32_bf16 a[80:83], a[176:179], v[140:143], a[80:83]
 ds_read_b64_tr_b16 a[168:169], v2 offset:50752
 ds_read_b64_tr_b16 a[170:171], v4 offset:50752
 v_mfma_f32_16x16x32_bf16 a[152:155], a[176:179], v[172:175], a[152:155]
 v_add_f32 v33, v33, v69
 v_cvt_pk_bf16_f32 v66, v68, v69
 v_mfma_f32_16x16x32_bf16 a[88:91], a[176:179], v[156:159], a[88:91]
 v_add_f32 v33, v33, v70
 v_add_f32 v33, v33, v71
 v_mfma_f32_16x16x32_bf16 a[120:123], a[180:183], v[156:159], a[120:123]
 ds_read_b64_tr_b16 a[172:173], v2 offset:50784
 ds_read_b64_tr_b16 a[174:175], v4 offset:50784
 v_mfma_f32_16x16x32_bf16 a[112:115], a[180:183], v[140:143], a[112:115]
 s_waitcnt lgkmcnt(9)
 v_cvt_pk_bf16_f32 v67, v70, v71
 v_add_f32 v78, v32, v33
 v_mfma_f32_16x16x32_bf16 a[84:87], a[184:187], v[140:143], a[84:87]
 ds_read_b64_tr_b16 a[176:177], v2 offset:50944
 ds_read_b64_tr_b16 a[178:179], v4 offset:50944
 v_mfma_f32_16x16x32_bf16 a[156:159], a[184:187], v[172:175], a[156:159]
 v_add_f32 v78, v78, v34
 v_mov_b32 v76, 0x4e800000
 v_mfma_f32_16x16x32_bf16 a[92:95], a[184:187], v[156:159], a[92:95]
 v_cmp_nlt_f32_e64 s[62:63], v78, v76
 s_cmp_lg_u64 s[62:63], 0
 s_cselect_b32 s49, 1, 0
 v_mfma_f32_16x16x32_bf16 a[124:127], a[188:191], v[156:159], a[124:127]
 ds_read_b64_tr_b16 a[180:181], v2 offset:50976
 ds_read_b64_tr_b16 a[182:183], v4 offset:50976
 v_mfma_f32_16x16x32_bf16 a[116:119], a[188:191], v[140:143], a[116:119]
 s_waitcnt lgkmcnt(8)
 buffer_load_dwordx4 v17, s[12:15], s56 offen offset:0 lds
 v_mov_b32 v78, s49
 v_mfma_f32_16x16x32_bf16 a[0:3], a[160:163], v[56:59], a[0:3]
 s_add_u32 s56, s44, 0x41be0
 ds_read_b64_tr_b16 a[184:185], v2 offset:51008
 ds_read_b64_tr_b16 a[186:187], v4 offset:51008
 v_mfma_f32_16x16x32_bf16 a[128:131], a[160:163], v[72:75], a[128:131]
 ds_write_b32 v25, v78 offset:0
 v_mov_b32 v76, v34
 v_mfma_f32_16x16x32_bf16 a[8:11], a[160:163], v[64:67], a[8:11]
 s_nop 0
 v_permlane32_swap_b32 v76, v34
 v_mfma_f32_16x16x32_bf16 a[12:15], a[164:167], v[64:67], a[12:15]
 ds_read_b64_tr_b16 a[188:189], v2 offset:51040
 ds_read_b64_tr_b16 a[190:191], v4 offset:51040
 v_mfma_f32_16x16x32_bf16 a[132:135], a[164:167], v[72:75], a[132:135]
L_pad9:
 s_cbranch_execz L_pad13
 v_add_f32 v34, v34, v76
 v_mov_b32 v76, v34
 v_mfma_f32_16x16x32_bf16 a[4:7], a[164:167], v[56:59], a[4:7]
 s_waitcnt lgkmcnt(9)
 v_permlane16_swap_b32 v76, v34
 v_mfma_f32_16x16x32_bf16 a[16:19], a[168:171], v[56:59], a[16:19]
 ds_read_b64_tr_b16 a[160:161], v3 offset:50688
 ds_read_b64_tr_b16 a[162:163], v5 offset:50688
 v_mfma_f32_16x16x32_bf16 a[136:139], a[168:171], v[72:75], a[136:139]
 buffer_load_dwordx4 v17, s[12:15], s56 offen offset:1056 lds
 v_add_f32 v34, v34, v76
 v_mfma_f32_16x16x32_bf16 a[24:27], a[168:171], v[64:67], a[24:27]
 s_add_u32 s56, s44, 0x437c0
 ds_write_b32 v23, v34 offset:0
 buffer_load_dwordx4 v17, s[12:15], s56 offen offset:2112 lds
 v_mfma_f32_16x16x32_bf16 a[28:31], a[172:175], v[64:67], a[28:31]
 s_add_u32 s56, s44, 0x453a0
 ds_read_b64_tr_b16 a[164:165], v3 offset:50720
 ds_read_b64_tr_b16 a[166:167], v5 offset:50720
 v_mfma_f32_16x16x32_bf16 a[140:143], a[172:175], v[72:75], a[140:143]
 buffer_load_dwordx4 v17, s[12:15], s56 offen offset:3168 lds
 v_mov_b32 v76, v32
 v_mfma_f32_16x16x32_bf16 a[20:23], a[172:175], v[56:59], a[20:23]
 s_waitcnt lgkmcnt(10)
 v_permlane32_swap_b32 v76, v32
 v_mfma_f32_16x16x32_bf16 a[64:67], a[176:179], v[56:59], a[64:67]
 s_add_u32 s44, s44, 0x80000
 ds_read_b64_tr_b16 a[168:169], v3 offset:50752
 ds_read_b64_tr_b16 a[170:171], v5 offset:50752
 v_mfma_f32_16x16x32_bf16 a[144:147], a[176:179], v[72:75], a[144:147]
 s_sub_u32 s56, s44, 0x380000
 v_add_f32 v32, v32, v76
 v_mov_b32 v76, v32
 v_mfma_f32_16x16x32_bf16 a[72:75], a[176:179], v[64:67], a[72:75]
 s_min_u32 s44, s44, s56
 v_permlane16_swap_b32 v76, v32
 v_mfma_f32_16x16x32_bf16 a[76:79], a[180:183], v[64:67], a[76:79]
 s_add_u32 m0, s41, 0xc600
 ds_read_b64_tr_b16 a[172:173], v3 offset:50784
 ds_read_b64_tr_b16 a[174:175], v5 offset:50784
 v_mfma_f32_16x16x32_bf16 a[148:151], a[180:183], v[72:75], a[148:151]
 s_add_u32 s56, s45, 0
 buffer_load_dwordx4 v18, s[8:11], s56 offen offset:0 lds
 v_add_f32 v32, v32, v76
 v_mfma_f32_16x16x32_bf16 a[68:71], a[180:183], v[56:59], a[68:71]
 s_waitcnt lgkmcnt(9)
 v_rcp_f32 v35, v32
 v_mfma_f32_16x16x32_bf16 a[80:83], a[184:187], v[56:59], a[80:83]
 s_add_u32 m0, s41, 0xd600
 ds_read_b64_tr_b16 a[176:177], v3 offset:50944
 ds_read_b64_tr_b16 a[178:179], v5 offset:50944
 v_mfma_f32_16x16x32_bf16 a[152:155], a[184:187], v[72:75], a[152:155]
 s_add_u32 s56, s45, 0x7000
 buffer_load_dwordx4 v18, s[8:11], s56 offen offset:0 lds
 v_mov_b32 v76, v33
 v_mfma_f32_16x16x32_bf16 a[88:91], a[184:187], v[64:67], a[88:91]
 s_add_u32 m0, s41, 0xe600
 v_permlane32_swap_b32 v76, v33
 v_mfma_f32_16x16x32_bf16 a[92:95], a[188:191], v[64:67], a[92:95]
 s_add_u32 s56, s45, 0xe000
 ds_read_b64_tr_b16 a[180:181], v3 offset:50976
 ds_read_b64_tr_b16 a[182:183], v5 offset:50976
 v_mfma_f32_16x16x32_bf16 a[156:159], a[188:191], v[72:75], a[156:159]
 buffer_load_dwordx4 v18, s[8:11], s56 offen offset:0 lds
 v_add_f32 v33, v33, v76
 v_mfma_f32_16x16x32_bf16 a[84:87], a[188:191], v[56:59], a[84:87]
 s_waitcnt lgkmcnt(8)
 v_mov_b32 v76, v33
 v_mfma_f32_16x16x32_bf16 a[32:35], a[160:163], v[56:59], a[32:35]
 s_xor_b32 s56, s42, 0
 ds_read_b64_tr_b16 a[184:185], v3 offset:51008
 ds_read_b64_tr_b16 a[186:187], v5 offset:51008
 v_mfma_f32_16x16x32_bf16 a[40:43], a[160:163], v[64:67], a[40:43]
 s_add_u32 m0, s40, 0
 v_permlane16_swap_b32 v76, v33
 v_mfma_f32_16x16x32_bf16 a[44:47], a[164:167], v[64:67], a[44:47]
 ds_read_b64_tr_b16 a[188:189], v3 offset:51040
 ds_read_b64_tr_b16 a[190:191], v5 offset:51040
 v_mfma_f32_16x16x32_bf16 a[36:39], a[164:167], v[56:59], a[36:39]
 s_waitcnt lgkmcnt(8)
 buffer_load_dwordx4 v16, s[16:19], s56 offen offset:0 nt lds
 s_add_u32 m0, s40, 0x220
 s_nop 0
 buffer_load_dwordx4 v16, s[16:19], s56 offen offset:512 nt lds
 s_add_u32 m0, s40, 0x440
 s_nop 0
 buffer_load_dwordx4 v16, s[16:19], s56 offen offset:1024 nt lds
 s_add_u32 m0, s40, 0x660
 s_nop 0
 buffer_load_dwordx4 v16, s[16:19], s56 offen offset:1536 nt lds
 v_mfma_f32_16x16x32_bf16 a[48:51], a[168:171], v[56:59], a[48:51]
 s_waitcnt vmcnt(11)
 s_barrier
 ds_read_b64_tr_b16 a[160:161], v10 offset:0
 ds_read_b64_tr_b16 a[162:163], v10 offset:8448
 v_mfma_f32_16x16x32_bf16 a[56:59], a[168:171], v[64:67], a[56:59]
 s_add_u32 m0, s41, 0xf600
 ds_read_b128 v[44:47], v12 offset:20480
 ds_read_b32 v77, v24 offset:0
 v_mfma_f32_16x16x32_bf16 a[60:63], a[172:175], v[64:67], a[60:63]
 ds_read_b64_tr_b16 a[164:165], v11 offset:0
 ds_read_b64_tr_b16 a[166:167], v11 offset:8448
 ds_read_b128 v[48:51], v12 offset:22528
 v_mfma_f32_16x16x32_bf16 a[52:55], a[172:175], v[56:59], a[52:55]
 s_waitcnt lgkmcnt(11)
 ds_read_b128 v[220:223], v26 offset:0
 v_add_f32 v33, v33, v76
 v_mfma_f32_16x16x32_bf16 a[96:99], a[176:179], v[56:59], a[96:99]
 ds_read_b64_tr_b16 a[168:169], v10 offset:32
 ds_read_b64_tr_b16 a[170:171], v10 offset:8480
 ds_read_b128 v[52:55], v14 offset:20480
 v_mfma_f32_16x16x32_bf16 a[104:107], a[176:179], v[64:67], a[104:107]
 s_add_u32 s56, s45, 0x15000
 buffer_load_dwordx4 v18, s[8:11], s56 offen offset:0 lds
 v_mfma_f32_16x16x32_bf16 a[108:111], a[180:183], v[64:67], a[108:111]
 s_add_u32 m0, s41, 0x10600
 ds_read_b64_tr_b16 a[172:173], v11 offset:32
 ds_read_b64_tr_b16 a[174:175], v11 offset:8480
 v_mfma_f32_16x16x32_bf16 a[100:103], a[180:183], v[56:59], a[100:103]
 s_waitcnt lgkmcnt(13)
 v_rcp_f32 v36, v33
 v_mfma_f32_16x16x32_bf16 a[112:115], a[184:187], v[56:59], a[112:115]
 s_add_u32 s56, s45, 0x1c000
 ds_read_b64_tr_b16 a[176:177], v10 offset:64
 ds_read_b64_tr_b16 a[178:179], v10 offset:8512
 v_mfma_f32_16x16x32_bf16 a[120:123], a[184:187], v[64:67], a[120:123]
 s_waitcnt lgkmcnt(7)
 v_or3_b32 v79, v220, v221, v222
 v_or_b32 v79, v79, v223
 v_mfma_f32_16x16x32_bf16 a[124:127], a[188:191], v[64:67], a[124:127]
 ds_read_b64_tr_b16 a[180:181], v11 offset:64
 ds_read_b64_tr_b16 a[182:183], v11 offset:8512
 v_mfma_f32_16x16x32_bf16 a[116:119], a[188:191], v[56:59], a[116:119]
 v_readfirstlane_b32 s50, v79
 s_or_b32 s50, s50, s4
 s_cbranch_scc1 L_fail_B0
L_fail_B0_ret:
 s_mov_b32 s3, 1
 v_mfma_f32_16x16x32_bf16 v[96:99], a[160:163], v[44:47], 0
 ds_read_b64_tr_b16 a[184:185], v10 offset:96
 ds_read_b64_tr_b16 a[186:187], v10 offset:8544
 s_waitcnt lgkmcnt(8)
 v_mfma_f32_16x16x32_bf16 v[224:227], a[160:163], v[52:55], 0
 ds_read_b128 v[56:59], v13 offset:20480
 buffer_load_dwordx4 v18, s[8:11], s56 offen offset:0 lds
 v_mfma_f32_16x16x32_bf16 v[104:107], a[160:163], v[48:51], 0
 s_add_u32 s45, s45, 0x80
 v_add_f32 v34, v34, v77
 v_mfma_f32_16x16x32_bf16 v[136:139], a[164:167], v[48:51], 0
 s_sub_u32 s56, s45, 0x380
 ds_read_b64_tr_b16 a[188:189], v11 offset:96
 ds_read_b64_tr_b16 a[190:191], v11 offset:8544
 v_mfma_f32_16x16x32_bf16 v[128:131], a[164:167], v[44:47], 0
 s_waitcnt lgkmcnt(9)
 v_rcp_f32 v37, v34
 v_mfma_f32_16x16x32_bf16 v[100:103], a[168:171], v[44:47], 0
 s_min_u32 s45, s45, s56
 ds_read_b64_tr_b16 a[160:161], v10 offset:256
 ds_read_b64_tr_b16 a[162:163], v10 offset:8704
 v_mfma_f32_16x16x32_bf16 v[228:231], a[168:171], v[52:55], 0
 s_add_u32 m0, s40, 0x1ea00
 ds_read_b128 v[60:63], v13 offset:22528
 v_accvgpr_read_b32 v68, a128
 v_mfma_f32_16x16x32_bf16 v[108:111], a[168:171], v[48:51], 0
 s_add_u32 s56, s44, 0
 buffer_load_dwordx4 v17, s[12:15], s56 offen offset:0 lds
 v_accvgpr_read_b32 v69, a129
 v_mfma_f32_16x16x32_bf16 v[140:143], a[172:175], v[48:51], 0
 s_add_u32 s56, s44, 0x1be0
 ds_read_b64_tr_b16 a[164:165], v11 offset:256
 ds_read_b64_tr_b16 a[166:167], v11 offset:8704
 v_mfma_f32_16x16x32_bf16 v[132:135], a[172:175], v[44:47], 0
 s_waitcnt lgkmcnt(10)
 buffer_load_dwordx4 v17, s[12:15], s56 offen offset:1056 lds
 v_accvgpr_read_b32 v70, a130
 v_mfma_f32_16x16x32_bf16 v[112:115], a[176:179], v[44:47], 0
 s_add_u32 s56, s44, 0x37c0
 ds_read_b64_tr_b16 a[168:169], v10 offset:288
 ds_read_b64_tr_b16 a[170:171], v10 offset:8736
 v_mfma_f32_16x16x32_bf16 v[232:235], a[176:179], v[52:55], 0
 ds_read_b128 v[64:67], v15 offset:20480
 buffer_load_dwordx4 v17, s[12:15], s56 offen offset:2112 lds
 v_mfma_f32_16x16x32_bf16 v[120:123], a[176:179], v[48:51], 0
 v_accvgpr_read_b32 v71, a131
 v_accvgpr_read_b32 v72, a132
 v_mfma_f32_16x16x32_bf16 v[152:155], a[180:183], v[48:51], 0
 ds_read_b64_tr_b16 a[172:173], v11 offset:288
 ds_read_b64_tr_b16 a[174:175], v11 offset:8736
 v_mfma_f32_16x16x32_bf16 v[144:147], a[180:183], v[44:47], 0
 s_waitcnt lgkmcnt(10)
 v_accvgpr_read_b32 v73, a133
 v_accvgpr_read_b32 v74, a134
 v_mfma_f32_16x16x32_bf16 v[116:119], a[184:187], v[44:47], 0
 s_add_u32 s56, s44, 0x53a0
 ds_read_b64_tr_b16 a[176:177], v10 offset:320
 ds_read_b64_tr_b16 a[178:179], v10 offset:8768
 v_mfma_f32_16x16x32_bf16 v[236:239], a[184:187], v[52:55], 0
 buffer_load_dwordx4 v17, s[12:15], s56 offen offset:3168 lds
 v_accvgpr_read_b32 v75, a135
 v_mfma_f32_16x16x32_bf16 v[124:127], a[184:187], v[48:51], 0
 v_mul_f32 v68, v37, v68
 v_mul_f32 v69, v37, v69
 v_mfma_f32_16x16x32_bf16 v[156:159], a[188:191], v[48:51], 0
 ds_read_b64_tr_b16 a[180:181], v11 offset:320
 ds_read_b64_tr_b16 a[182:183], v11 offset:8768
 v_mfma_f32_16x16x32_bf16 v[148:151], a[188:191], v[44:47], 0
 s_waitcnt lgkmcnt(9)
 v_mul_f32 v70, v37, v70
 v_mul_f32 v71, v37, v71
 v_mfma_f32_16x16x32_bf16 v[160:163], a[160:163], v[44:47], 0
 ds_read_b64_tr_b16 a[184:185], v10 offset:352
 ds_read_b64_tr_b16 a[186:187], v10 offset:8800
 v_mfma_f32_16x16x32_bf16 v[240:243], a[160:163], v[52:55], 0
 v_mul_f32 v72, v37, v72
 v_mul_f32 v73, v37, v73
 v_mfma_f32_16x16x32_bf16 v[168:171], a[160:163], v[48:51], 0
 v_mul_f32 v74, v37, v74
 v_mul_f32 v75, v37, v75
 v_mfma_f32_16x16x32_bf16 v[200:203], a[164:167], v[48:51], 0
 ds_read_b64_tr_b16 a[188:189], v11 offset:352
 ds_read_b64_tr_b16 a[190:191], v11 offset:8800
 v_mfma_f32_16x16x32_bf16 v[192:195], a[164:167], v[44:47], 0
 s_waitcnt lgkmcnt(8)
 v_cvt_pk_bf16_f32 v80, v68, v69
 v_cvt_pk_bf16_f32 v81, v70, v71
 v_mfma_f32_16x16x32_bf16 v[164:167], a[168:171], v[44:47], 0
 s_waitcnt vmcnt(13)
 s_barrier
 ds_read_b64_tr_b16 a[160:161], v10 offset:16896
 ds_read_b64_tr_b16 a[162:163], v10 offset:25344
 v_mfma_f32_16x16x32_bf16 v[244:247], a[168:171], v[52:55], 0
 s_add_u32 m0, s40, 0x22c00
 v_cvt_pk_bf16_f32 v82, v72, v73
 v_cvt_pk_bf16_f32 v83, v74, v75
 v_mfma_f32_16x16x32_bf16 v[172:175], a[168:171], v[48:51], 0
 s_add_u32 s56, s44, 0x40000
 buffer_load_dwordx4 v17, s[12:15], s56 offen offset:0 lds
 v_accvgpr_read_b32 v68, a136
 v_mfma_f32_16x16x32_bf16 v[204:207], a[172:175], v[48:51], 0
 ds_read_b64_tr_b16 a[164:165], v11 offset:16896
 ds_read_b64_tr_b16 a[166:167], v11 offset:25344
 v_mfma_f32_16x16x32_bf16 v[196:199], a[172:175], v[44:47], 0
 s_waitcnt lgkmcnt(8)
 v_accvgpr_read_b32 v69, a137
 v_accvgpr_read_b32 v70, a138
 v_mfma_f32_16x16x32_bf16 v[176:179], a[176:179], v[44:47], 0
 ds_read_b64_tr_b16 a[168:169], v10 offset:16928
 ds_read_b64_tr_b16 a[170:171], v10 offset:25376
 v_mfma_f32_16x16x32_bf16 v[248:251], a[176:179], v[52:55], 0
 s_add_u32 s56, s44, 0x41be0
 buffer_load_dwordx4 v17, s[12:15], s56 offen offset:1056 lds
 v_accvgpr_read_b32 v71, a139
 v_mfma_f32_16x16x32_bf16 v[184:187], a[176:179], v[48:51], 0
 v_accvgpr_read_b32 v72, a140
 v_accvgpr_read_b32 v73, a141
 v_mfma_f32_16x16x32_bf16 v[216:219], a[180:183], v[48:51], 0
 ds_read_b64_tr_b16 a[172:173], v11 offset:16928
 ds_read_b64_tr_b16 a[174:175], v11 offset:25376
 v_mfma_f32_16x16x32_bf16 v[208:211], a[180:183], v[44:47], 0
 s_waitcnt lgkmcnt(8)
 v_accvgpr_read_b32 v74, a142
 v_accvgpr_read_b32 v75, a143
 v_mfma_f32_16x16x32_bf16 v[180:183], a[184:187], v[44:47], 0
 ds_read_b64_tr_b16 a[176:177], v10 offset:16960
 ds_read_b64_tr_b16 a[178:179], v10 offset:25408
 v_mfma_f32_16x16x32_bf16 v[252:255], a[184:187], v[52:55], 0
 s_add_u32 s56, s44, 0x437c0
 buffer_load_dwordx4 v17, s[12:15], s56 offen offset:2112 lds
 v_mul_f32 v68, v37, v68
 v_mfma_f32_16x16x32_bf16 v[188:191], a[184:187], v[48:51], 0
 v_mul_f32 v69, v37, v69
 v_mul_f32 v70, v37, v70
 v_mfma_f32_16x16x32_bf16 v[220:223], a[188:191], v[48:51], 0
 ds_read_b64_tr_b16 a[180:181], v11 offset:16960
 ds_read_b64_tr_b16 a[182:183], v11 offset:25408
 v_mfma_f32_16x16x32_bf16 v[212:215], a[188:191], v[44:47], 0
 s_waitcnt lgkmcnt(8)
 v_mul_f32 v71, v37, v71
 v_mul_f32 v72, v37, v72
 v_mfma_f32_16x16x32_bf16 v[96:99], a[160:163], v[56:59], v[96:99]
 ds_read_b64_tr_b16 a[184:185], v10 offset:16992
 ds_read_b64_tr_b16 a[186:187], v10 offset:25440
 v_mfma_f32_16x16x32_bf16 v[224:227], a[160:163], v[64:67], v[224:227]
 s_add_u32 s56, s44, 0x453a0
 buffer_load_dwordx4 v17, s[12:15], s56 offen offset:3168 lds
 v_mul_f32 v73, v37, v73
 v_mfma_f32_16x16x32_bf16 v[104:107], a[160:163], v[60:63], v[104:107]
 v_mul_f32 v74, v37, v74
 v_mul_f32 v75, v37, v75
 v_mfma_f32_16x16x32_bf16 v[136:139], a[164:167], v[60:63], v[136:139]
 ds_read_b64_tr_b16 a[188:189], v11 offset:16992
 ds_read_b64_tr_b16 a[190:191], v11 offset:25440
 v_mfma_f32_16x16x32_bf16 v[128:131], a[164:167], v[56:59], v[128:131]
 s_waitcnt lgkmcnt(8)
 v_cvt_pk_bf16_f32 v84, v68, v69
 v_cvt_pk_bf16_f32 v85, v70, v71
 v_mfma_f32_16x16x32_bf16 v[100:103], a[168:171], v[56:59], v[100:103]
 ds_read_b64_tr_b16 a[160:161], v10 offset:17152
 ds_read_b64_tr_b16 a[162:163], v10 offset:25600
 v_mfma_f32_16x16x32_bf16 v[228:231], a[168:171], v[64:67], v[228:231]
 s_add_u32 s44, s44, 0x80000
 v_cvt_pk_bf16_f32 v86, v72, v73
 v_cvt_pk_bf16_f32 v87, v74, v75
 v_mfma_f32_16x16x32_bf16 v[108:111], a[168:171], v[60:63], v[108:111]
 s_sub_u32 s56, s44, 0x380000
 v_accvgpr_read_b32 v68, a144
 v_accvgpr_read_b32 v69, a145
 v_mfma_f32_16x16x32_bf16 v[140:143], a[172:175], v[60:63], v[140:143]
 s_min_u32 s44, s44, s56
 ds_read_b64_tr_b16 a[164:165], v11 offset:17152
 ds_read_b64_tr_b16 a[166:167], v11 offset:25600
 v_mfma_f32_16x16x32_bf16 v[132:135], a[172:175], v[56:59], v[132:135]
 s_waitcnt lgkmcnt(8)
 v_accvgpr_read_b32 v70, a146
 v_accvgpr_read_b32 v71, a147
 v_mfma_f32_16x16x32_bf16 v[112:115], a[176:179], v[56:59], v[112:115]
 s_add_u32 m0, s41, 0x11600
 ds_read_b64_tr_b16 a[168:169], v10 offset:17184
 ds_read_b64_tr_b16 a[170:171], v10 offset:25632
 v_mfma_f32_16x16x32_bf16 v[232:235], a[176:179], v[64:67], v[232:235]
 s_add_u32 s56, s45, 0
 buffer_load_dwordx4 v18, s[8:11], s56 offen offset:0 lds
 v_accvgpr_read_b32 v72, a148
 v_mfma_f32_16x16x32_bf16 v[120:123], a[176:179], v[60:63], v[120:123]
 s_add_u32 m0, s41, 0x12600
 v_accvgpr_read_b32 v73, a149
 v_accvgpr_read_b32 v74, a150
 v_mfma_f32_16x16x32_bf16 v[152:155], a[180:183], v[60:63], v[152:155]
 s_add_u32 s56, s45, 0x7000
 ds_read_b64_tr_b16 a[172:173], v11 offset:17184
 ds_read_b64_tr_b16 a[174:175], v11 offset:25632
 v_mfma_f32_16x16x32_bf16 v[144:147], a[180:183], v[56:59], v[144:147]
 s_waitcnt lgkmcnt(8)
 buffer_load_dwordx4 v18, s[8:11], s56 offen offset:0 lds
 v_accvgpr_read_b32 v75, a151
 v_mfma_f32_16x16x32_bf16 v[116:119], a[184:187], v[56:59], v[116:119]
 ds_read_b64_tr_b16 a[176:177], v10 offset:17216
 ds_read_b64_tr_b16 a[178:179], v10 offset:25664
 v_mfma_f32_16x16x32_bf16 v[236:239], a[184:187], v[64:67], v[236:239]
 s_add_u32 m0, s41, 0x13600
 v_mul_f32 v68, v37, v68
 v_mul_f32 v69, v37, v69
 v_mfma_f32_16x16x32_bf16 v[124:127], a[184:187], v[60:63], v[124:127]
 s_add_u32 s56, s45, 0xe000
 buffer_load_dwordx4 v18, s[8:11], s56 offen offset:0 lds
 v_mul_f32 v70, v37, v70
 v_mfma_f32_16x16x32_bf16 v[156:159], a[188:191], v[60:63], v[156:159]
 ds_read_b64_tr_b16 a[180:181], v11 offset:17216
 ds_read_b64_tr_b16 a[182:183], v11 offset:25664
 v_mfma_f32_16x16x32_bf16 v[148:151], a[188:191], v[56:59], v[148:151]
 s_waitcnt lgkmcnt(8)
 v_mul_f32 v71, v37, v71
 v_mul_f32 v72, v37, v72
 v_mfma_f32_16x16x32_bf16 v[160:163], a[160:163], v[56:59], v[160:163]
 ds_read_b64_tr_b16 a[184:185], v10 offset:17248
 ds_read_b64_tr_b16 a[186:187], v10 offset:25696
 v_mfma_f32_16x16x32_bf16 v[240:243], a[160:163], v[64:67], v[240:243]
 v_mul_f32 v73, v37, v73
 v_mul_f32 v74, v37, v74
 v_mfma_f32_16x16x32_bf16 v[168:171], a[160:163], v[60:63], v[168:171]
 v_mul_f32 v75, v37, v75
 v_cvt_pk_bf16_f32 v88, v68, v69
 v_mfma_f32_16x16x32_bf16 v[200:203], a[164:167], v[60:63], v[200:203]
 ds_read_b64_tr_b16 a[188:189], v11 offset:17248
 ds_read_b64_tr_b16 a[190:191], v11 offset:25696
 v_mfma_f32_16x16x32_bf16 v[192:195], a[164:167], v[56:59], v[192:195]
 s_waitcnt lgkmcnt(8)
 v_cvt_pk_bf16_f32 v89, v70, v71
 v_cvt_pk_bf16_f32 v90, v72, v73
 v_mfma_f32_16x16x32_bf16 v[164:167], a[168:171], v[56:59], v[164:167]
 s_waitcnt vmcnt(7)
 s_barrier
 ds_read_b64_tr_b16 a[160:161], v10 offset:33792
 ds_read_b64_tr_b16 a[162:163], v10 offset:42240
 v_mfma_f32_16x16x32_bf16 v[244:247], a[168:171], v[64:67], v[244:247]
 s_add_u32 m0, s41, 0x14600
 ds_read_b128 v[44:47], v12 offset:0
 v_cvt_pk_bf16_f32 v91, v74, v75
 v_mfma_f32_16x16x32_bf16 v[172:175], a[168:171], v[60:63], v[172:175]
 s_add_u32 s56, s45, 0x15000
 ds_read_b128 v[48:51], v12 offset:2048
 buffer_load_dwordx4 v18, s[8:11], s56 offen offset:0 lds
 v_mfma_f32_16x16x32_bf16 v[204:207], a[172:175], v[60:63], v[204:207]
 ds_read_b64_tr_b16 a[164:165], v11 offset:33792
 ds_read_b64_tr_b16 a[166:167], v11 offset:42240
 v_mfma_f32_16x16x32_bf16 v[196:199], a[172:175], v[56:59], v[196:199]
 s_waitcnt lgkmcnt(10)
 ds_read_b128 v[52:55], v14 offset:0
 v_accvgpr_read_b32 v68, a152
 v_mfma_f32_16x16x32_bf16 v[176:179], a[176:179], v[56:59], v[176:179]
 ds_read_b64_tr_b16 a[168:169], v10 offset:33824
 ds_read_b64_tr_b16 a[170:171], v10 offset:42272
 v_mfma_f32_16x16x32_bf16 v[248:251], a[176:179], v[64:67], v[248:251]
 s_add_u32 m0, s41, 0x15600
 v_accvgpr_read_b32 v69, a153
 v_accvgpr_read_b32 v70, a154
 v_mfma_f32_16x16x32_bf16 v[184:187], a[176:179], v[60:63], v[184:187]
 s_add_u32 s56, s45, 0x1c000
 buffer_load_dwordx4 v18, s[8:11], s56 offen offset:0 lds
 v_accvgpr_read_b32 v71, a155
 v_mfma_f32_16x16x32_bf16 v[216:219], a[180:183], v[60:63], v[216:219]
 ds_read_b64_tr_b16 a[172:173], v11 offset:33824
 ds_read_b64_tr_b16 a[174:175], v11 offset:42272
 v_mfma_f32_16x16x32_bf16 v[208:211], a[180:183], v[56:59], v[208:211]
 s_waitcnt lgkmcnt(11)
 v_accvgpr_read_b32 v72, a156
 v_accvgpr_read_b32 v73, a157
 v_mfma_f32_16x16x32_bf16 v[180:183], a[184:187], v[56:59], v[180:183]
 ds_read_b64_tr_b16 a[176:177], v10 offset:33856
 ds_read_b64_tr_b16 a[178:179], v10 offset:42304
 v_mfma_f32_16x16x32_bf16 v[252:255], a[184:187], v[64:67], v[252:255]
 v_accvgpr_read_b32 v74, a158
 v_accvgpr_read_b32 v75, a159
 v_mfma_f32_16x16x32_bf16 v[188:191], a[184:187], v[60:63], v[188:191]
 s_add_u32 s45, s45, 0x80
 v_mul_f32 v68, v37, v68
 v_mul_f32 v69, v37, v69
 v_mfma_f32_16x16x32_bf16 v[220:223], a[188:191], v[60:63], v[220:223]
 s_sub_u32 s56, s45, 0x380
 ds_read_b64_tr_b16 a[180:181], v11 offset:33856
 ds_read_b64_tr_b16 a[182:183], v11 offset:42304
 v_mfma_f32_16x16x32_bf16 v[212:215], a[188:191], v[56:59], v[212:215]
 s_waitcnt lgkmcnt(9)
 v_mul_f32 v70, v37, v70
 v_mul_f32 v71, v37, v71
 v_mfma_f32_16x16x32_bf16 v[96:99], a[160:163], v[44:47], v[96:99]
 s_min_u32 s45, s45, s56
 ds_read_b64_tr_b16 a[184:185], v10 offset:33888
 ds_read_b64_tr_b16 a[186:187], v10 offset:42336
 s_waitcnt lgkmcnt(10)
 v_mfma_f32_16x16x32_bf16 v[224:227], a[160:163], v[52:55], v[224:227]
 s_add_u32 m0, s40, 0x16600
 ds_read_b128 v[56:59], v13 offset:0
 v_mul_f32 v72, v37, v72
 v_mfma_f32_16x16x32_bf16 v[104:107], a[160:163], v[48:51], v[104:107]
 s_add_u32 s56, s44, 0
 buffer_load_dwordx4 v17, s[12:15], s56 offen offset:0 lds
 v_mul_f32 v73, v37, v73
 v_mfma_f32_16x16x32_bf16 v[136:139], a[164:167], v[48:51], v[136:139]
 s_add_u32 s56, s44, 0x1be0
 ds_read_b64_tr_b16 a[188:189], v11 offset:33888
 ds_read_b64_tr_b16 a[190:191], v11 offset:42336
 v_mfma_f32_16x16x32_bf16 v[128:131], a[164:167], v[44:47], v[128:131]
 s_waitcnt lgkmcnt(9)
 buffer_load_dwordx4 v17, s[12:15], s56 offen offset:1056 lds
 v_mul_f32 v74, v37, v74
 v_mfma_f32_16x16x32_bf16 v[100:103], a[168:171], v[44:47], v[100:103]
 ds_read_b64_tr_b16 a[160:161], v10 offset:34048
 ds_read_b64_tr_b16 a[162:163], v10 offset:42496
 v_mfma_f32_16x16x32_bf16 v[228:231], a[168:171], v[52:55], v[228:231]
 ds_read_b128 v[60:63], v13 offset:2048
 v_mul_f32 v75, v37, v75
 v_mfma_f32_16x16x32_bf16 v[108:111], a[168:171], v[48:51], v[108:111]
 v_cvt_pk_bf16_f32 v92, v68, v69
 v_cvt_pk_bf16_f32 v93, v70, v71
 v_mfma_f32_16x16x32_bf16 v[140:143], a[172:175], v[48:51], v[140:143]
 ds_read_b64_tr_b16 a[164:165], v11 offset:34048
 ds_read_b64_tr_b16 a[166:167], v11 offset:42496
 v_mfma_f32_16x16x32_bf16 v[132:135], a[172:175], v[44:47], v[132:135]
 s_waitcnt lgkmcnt(10)
 v_cvt_pk_bf16_f32 v94, v72, v73
 v_cvt_pk_bf16_f32 v95, v74, v75
 v_mfma_f32_16x16x32_bf16 v[112:115], a[176:179], v[44:47], v[112:115]
 s_add_u32 s56, s44, 0x37c0
 ds_read_b64_tr_b16 a[168:169], v10 offset:34080
 ds_read_b64_tr_b16 a[170:171], v10 offset:42528
 v_mfma_f32_16x16x32_bf16 v[232:235], a[176:179], v[52:55], v[232:235]
 ds_read_b128 v[64:67], v15 offset:0
 buffer_load_dwordx4 v17, s[12:15], s56 offen offset:2112 lds
 v_mfma_f32_16x16x32_bf16 v[120:123], a[176:179], v[48:51], v[120:123]
 v_accvgpr_read_b32 v68, a0
 v_accvgpr_read_b32 v69, a1
 v_mfma_f32_16x16x32_bf16 v[152:155], a[180:183], v[48:51], v[152:155]
 ds_read_b64_tr_b16 a[172:173], v11 offset:34080
 ds_read_b64_tr_b16 a[174:175], v11 offset:42528
 v_mfma_f32_16x16x32_bf16 v[144:147], a[180:183], v[44:47], v[144:147]
 s_waitcnt lgkmcnt(10)
 v_accvgpr_read_b32 v70, a2
 v_accvgpr_read_b32 v71, a3
 v_mfma_f32_16x16x32_bf16 v[116:119], a[184:187], v[44:47], v[116:119]
 s_add_u32 s56, s44, 0x53a0
 ds_read_b64_tr_b16 a[176:177], v10 offset:34112
 ds_read_b64_tr_b16 a[178:179], v10 offset:42560
 v_mfma_f32_16x16x32_bf16 v[236:239], a[184:187], v[52:55], v[236:239]
 buffer_load_dwordx4 v17, s[12:15], s56 offen offset:3168 lds
 v_accvgpr_read_b32 v72, a4
 v_mfma_f32_16x16x32_bf16 v[124:127], a[184:187], v[48:51], v[124:127]
 v_accvgpr_read_b32 v73, a5
 v_accvgpr_read_b32 v74, a6
 v_mfma_f32_16x16x32_bf16 v[156:159], a[188:191], v[48:51], v[156:159]
 ds_read_b64_tr_b16 a[180:181], v11 offset:34112
 ds_read_b64_tr_b16 a[182:183], v11 offset:42560
 v_mfma_f32_16x16x32_bf16 v[148:151], a[188:191], v[44:47], v[148:151]
 s_waitcnt lgkmcnt(9)
 v_accvgpr_read_b32 v75, a7
 v_mul_f32 v68, v35, v68
 v_mfma_f32_16x16x32_bf16 v[160:163], a[160:163], v[44:47], v[160:163]
 ds_read_b64_tr_b16 a[184:185], v10 offset:34144
 ds_read_b64_tr_b16 a[186:187], v10 offset:42592
 v_mfma_f32_16x16x32_bf16 v[240:243], a[160:163], v[52:55], v[240:243]
 v_mul_f32 v69, v35, v69
 v_mul_f32 v70, v35, v70
 v_mfma_f32_16x16x32_bf16 v[168:171], a[160:163], v[48:51], v[168:171]
 v_mul_f32 v71, v35, v71
 v_mul_f32 v72, v35, v72
 v_mfma_f32_16x16x32_bf16 v[200:203], a[164:167], v[48:51], v[200:203]
 ds_read_b64_tr_b16 a[188:189], v11 offset:34144
 ds_read_b64_tr_b16 a[190:191], v11 offset:42592
 v_mfma_f32_16x16x32_bf16 v[192:195], a[164:167], v[44:47], v[192:195]
 s_waitcnt lgkmcnt(8)
 v_mul_f32 v73, v35, v73
 v_mul_f32 v74, v35, v74
 v_mfma_f32_16x16x32_bf16 v[164:167], a[168:171], v[44:47], v[164:167]
 s_waitcnt vmcnt(9)
 s_barrier
 ds_read_b64_tr_b16 a[160:161], v10 offset:50688
 ds_read_b64_tr_b16 a[162:163], v10 offset:59136
 v_mfma_f32_16x16x32_bf16 v[244:247], a[168:171], v[52:55], v[244:247]
 s_add_u32 m0, s40, 0x1a800
 v_mul_f32 v75, v35, v75
 v_cvt_pk_bf16_f32 v68, v68, v69
 v_mfma_f32_16x16x32_bf16 v[172:175], a[168:171], v[48:51], v[172:175]
 s_add_u32 s56, s44, 0x40000
 buffer_load_dwordx4 v17, s[12:15], s56 offen offset:0 lds
 v_cvt_pk_bf16_f32 v69, v70, v71
 v_mfma_f32_16x16x32_bf16 v[204:207], a[172:175], v[48:51], v[204:207]
 ds_read_b64_tr_b16 a[164:165], v11 offset:50688
 ds_read_b64_tr_b16 a[166:167], v11 offset:59136
 v_mfma_f32_16x16x32_bf16 v[196:199], a[172:175], v[44:47], v[196:199]
 s_waitcnt lgkmcnt(8)
 v_cvt_pk_bf16_f32 v70, v72, v73
 v_cvt_pk_bf16_f32 v71, v74, v75
 v_mfma_f32_16x16x32_bf16 v[176:179], a[176:179], v[44:47], v[176:179]
 s_add_u32 s56, s44, 0x41be0
 ds_read_b64_tr_b16 a[168:169], v10 offset:50720
 ds_read_b64_tr_b16 a[170:171], v10 offset:59168
 v_mfma_f32_16x16x32_bf16 v[248:251], a[176:179], v[52:55], v[248:251]
 buffer_load_dwordx4 v17, s[12:15], s56 offen offset:1056 lds
 v_accvgpr_write_b32 a192, v68
 v_mfma_f32_16x16x32_bf16 v[184:187], a[176:179], v[48:51], v[184:187]
 s_add_u32 s56, s44, 0x437c0
 buffer_load_dwordx4 v17, s[12:15], s56 offen offset:2112 lds
 v_accvgpr_write_b32 a193, v69
 v_mfma_f32_16x16x32_bf16 v[216:219], a[180:183], v[48:51], v[216:219]
 ds_read_b64_tr_b16 a[172:173], v11 offset:50720
 ds_read_b64_tr_b16 a[174:175], v11 offset:59168
 v_mfma_f32_16x16x32_bf16 v[208:211], a[180:183], v[44:47], v[208:211]
 s_waitcnt lgkmcnt(8)
 v_accvgpr_write_b32 a194, v70
 v_accvgpr_write_b32 a195, v71
 v_mfma_f32_16x16x32_bf16 v[180:183], a[184:187], v[44:47], v[180:183]
 s_add_u32 s56, s44, 0x453a0
 ds_read_b64_tr_b16 a[176:177], v10 offset:50752
 ds_read_b64_tr_b16 a[178:179], v10 offset:59200
 v_mfma_f32_16x16x32_bf16 v[252:255], a[184:187], v[52:55], v[252:255]
 buffer_load_dwordx4 v17, s[12:15], s56 offen offset:3168 lds
 v_accvgpr_read_b32 v68, a8
 v_mfma_f32_16x16x32_bf16 v[188:191], a[184:187], v[48:51], v[188:191]
 v_accvgpr_read_b32 v69, a9
 v_accvgpr_read_b32 v70, a10
 v_mfma_f32_16x16x32_bf16 v[220:223], a[188:191], v[48:51], v[220:223]
 s_add_u32 s44, s44, 0x80000
 ds_read_b64_tr_b16 a[180:181], v11 offset:50752
 ds_read_b64_tr_b16 a[182:183], v11 offset:59200
 v_mfma_f32_16x16x32_bf16 v[212:215], a[188:191], v[44:47], v[212:215]
 s_waitcnt lgkmcnt(8)
 v_accvgpr_read_b32 v71, a11
 v_accvgpr_read_b32 v72, a12
 v_mfma_f32_16x16x32_bf16 v[96:99], a[160:163], v[56:59], v[96:99]
 s_sub_u32 s56, s44, 0x380000
 ds_read_b64_tr_b16 a[184:185], v10 offset:50784
 ds_read_b64_tr_b16 a[186:187], v10 offset:59232
 v_mfma_f32_16x16x32_bf16 v[224:227], a[160:163], v[64:67], v[224:227]
L_pad10:
 s_cbranch_execz L_pad14
 s_min_u32 s44, s44, s56
 v_accvgpr_read_b32 v73, a13
 v_accvgpr_read_b32 v74, a14
 v_mfma_f32_16x16x32_bf16 v[104:107], a[160:163], v[60:63], v[104:107]
 s_add_u32 m0, s41, 0xc600
 v_accvgpr_read_b32 v75, a15
 v_mul_f32 v68, v36, v68
 v_mfma_f32_16x16x32_bf16 v[136:139], a[164:167], v[60:63], v[136:139]
 s_add_u32 s56, s45, 0
 ds_read_b64_tr_b16 a[188:189], v11 offset:50784
 ds_read_b64_tr_b16 a[190:191], v11 offset:59232
 v_mfma_f32_16x16x32_bf16 v[128:131], a[164:167], v[56:59], v[128:131]
 s_waitcnt lgkmcnt(8)
 buffer_load_dwordx4 v18, s[8:11], s56 offen offset:0 lds
 v_mul_f32 v69, v36, v69
 v_mfma_f32_16x16x32_bf16 v[100:103], a[168:171], v[56:59], v[100:103]
 s_add_u32 m0, s41, 0xd600
 ds_read_b64_tr_b16 a[160:161], v10 offset:50944
 ds_read_b64_tr_b16 a[162:163], v10 offset:59392
 v_mfma_f32_16x16x32_bf16 v[228:231], a[168:171], v[64:67], v[228:231]
 s_add_u32 s56, s45, 0x7000
 buffer_load_dwordx4 v18, s[8:11], s56 offen offset:0 lds
 v_mul_f32 v70, v36, v70
 v_mfma_f32_16x16x32_bf16 v[108:111], a[168:171], v[60:63], v[108:111]
 s_add_u32 m0, s41, 0xe600
 v_mul_f32 v71, v36, v71
 v_mul_f32 v72, v36, v72
 v_mfma_f32_16x16x32_bf16 v[140:143], a[172:175], v[60:63], v[140:143]
 s_add_u32 s56, s45, 0xe000
 ds_read_b64_tr_b16 a[164:165], v11 offset:50944
 ds_read_b64_tr_b16 a[166:167], v11 offset:59392
 v_mfma_f32_16x16x32_bf16 v[132:135], a[172:175], v[56:59], v[132:135]
 s_waitcnt lgkmcnt(8)
 buffer_load_dwordx4 v18, s[8:11], s56 offen offset:0 lds
 v_mul_f32 v73, v36, v73
 v_mfma_f32_16x16x32_bf16 v[112:115], a[176:179], v[56:59], v[112:115]
 s_xor_b32 s56, s42, 0x4000
 ds_read_b64_tr_b16 a[168:169], v10 offset:50976
 ds_read_b64_tr_b16 a[170:171], v10 offset:59424
 v_mfma_f32_16x16x32_bf16 v[232:235], a[176:179], v[64:67], v[232:235]
 s_add_u32 m0, s40, 0x4200
 v_mul_f32 v74, v36, v74
 v_mul_f32 v75, v36, v75
 v_mfma_f32_16x16x32_bf16 v[120:123], a[176:179], v[60:63], v[120:123]
 buffer_load_dwordx4 v16, s[16:19], s56 offen offset:0 nt lds
 v_cvt_pk_bf16_f32 v68, v68, v69
 v_mfma_f32_16x16x32_bf16 v[152:155], a[180:183], v[60:63], v[152:155]
 s_add_u32 m0, s40, 0x4420
 ds_read_b64_tr_b16 a[172:173], v11 offset:50976
 ds_read_b64_tr_b16 a[174:175], v11 offset:59424
 v_mfma_f32_16x16x32_bf16 v[144:147], a[180:183], v[56:59], v[144:147]
 s_waitcnt lgkmcnt(8)
 buffer_load_dwordx4 v16, s[16:19], s56 offen offset:512 nt lds
 v_cvt_pk_bf16_f32 v69, v70, v71
 v_mfma_f32_16x16x32_bf16 v[116:119], a[184:187], v[56:59], v[116:119]
 s_add_u32 m0, s40, 0x4640
 ds_read_b64_tr_b16 a[176:177], v10 offset:51008
 ds_read_b64_tr_b16 a[178:179], v10 offset:59456
 v_mfma_f32_16x16x32_bf16 v[236:239], a[184:187], v[64:67], v[236:239]
 buffer_load_dwordx4 v16, s[16:19], s56 offen offset:1024 nt lds
 v_cvt_pk_bf16_f32 v70, v72, v73
 v_mfma_f32_16x16x32_bf16 v[124:127], a[184:187], v[60:63], v[124:127]
 s_add_u32 m0, s40, 0x4860
 v_cvt_pk_bf16_f32 v71, v74, v75
 v_accvgpr_write_b32 a196, v68
 v_mfma_f32_16x16x32_bf16 v[156:159], a[188:191], v[60:63], v[156:159]
 ds_read_b64_tr_b16 a[180:181], v11 offset:51008
 ds_read_b64_tr_b16 a[182:183], v11 offset:59456
 v_mfma_f32_16x16x32_bf16 v[148:151], a[188:191], v[56:59], v[148:151]
 s_waitcnt lgkmcnt(8)
 buffer_load_dwordx4 v16, s[16:19], s56 offen offset:1536 nt lds
 v_accvgpr_write_b32 a197, v69
 v_mfma_f32_16x16x32_bf16 v[160:163], a[160:163], v[56:59], v[160:163]
 ds_read_b64_tr_b16 a[184:185], v10 offset:51040
 ds_read_b64_tr_b16 a[186:187], v10 offset:59488
 v_mfma_f32_16x16x32_bf16 v[240:243], a[160:163], v[64:67], v[240:243]
 v_accvgpr_write_b32 a198, v70
 v_accvgpr_write_b32 a199, v71
 v_mfma_f32_16x16x32_bf16 v[168:171], a[160:163], v[60:63], v[168:171]
 v_accvgpr_read_b32 v68, a16
 v_accvgpr_read_b32 v69, a17
 v_mfma_f32_16x16x32_bf16 v[200:203], a[164:167], v[60:63], v[200:203]
 ds_read_b64_tr_b16 a[188:189], v11 offset:51040
 ds_read_b64_tr_b16 a[190:191], v11 offset:59488
 v_mfma_f32_16x16x32_bf16 v[192:195], a[164:167], v[56:59], v[192:195]
 s_waitcnt lgkmcnt(8)
 v_accvgpr_read_b32 v70, a18
 v_accvgpr_read_b32 v71, a19
 v_mfma_f32_16x16x32_bf16 v[164:167], a[168:171], v[56:59], v[164:167]
 s_waitcnt vmcnt(11)
 s_barrier
 ds_read_b64_tr_b16 a[160:161], v10 offset:0
 ds_read_b64_tr_b16 a[162:163], v10 offset:8448
 v_mfma_f32_16x16x32_bf16 v[244:247], a[168:171], v[64:67], v[244:247]
 s_add_u32 m0, s41, 0xf600
 ds_read_b128 v[44:47], v12 offset:20480
 v_accvgpr_read_b32 v72, a20
 v_mfma_f32_16x16x32_bf16 v[172:175], a[168:171], v[60:63], v[172:175]
 s_add_u32 s56, s45, 0x15000
 ds_read_b128 v[48:51], v12 offset:22528
 buffer_load_dwordx4 v18, s[8:11], s56 offen offset:0 lds
 v_mfma_f32_16x16x32_bf16 v[204:207], a[172:175], v[60:63], v[204:207]
 ds_read_b64_tr_b16 a[164:165], v11 offset:0
 ds_read_b64_tr_b16 a[166:167], v11 offset:8448
 v_mfma_f32_16x16x32_bf16 v[196:199], a[172:175], v[56:59], v[196:199]
 s_waitcnt lgkmcnt(10)
 ds_read_b128 v[52:55], v14 offset:20480
 v_accvgpr_read_b32 v73, a21
 v_mfma_f32_16x16x32_bf16 v[176:179], a[176:179], v[56:59], v[176:179]
 ds_read_b64_tr_b16 a[168:169], v10 offset:32
 ds_read_b64_tr_b16 a[170:171], v10 offset:8480
 v_mfma_f32_16x16x32_bf16 v[248:251], a[176:179], v[64:67], v[248:251]
 s_add_u32 m0, s41, 0x10600
 v_accvgpr_read_b32 v74, a22
 v_accvgpr_read_b32 v75, a23
 v_mfma_f32_16x16x32_bf16 v[184:187], a[176:179], v[60:63], v[184:187]
 s_add_u32 s56, s45, 0x1c000
 buffer_load_dwordx4 v18, s[8:11], s56 offen offset:0 lds
 v_mul_f32 v68, v35, v68
 v_mfma_f32_16x16x32_bf16 v[216:219], a[180:183], v[60:63], v[216:219]
 ds_read_b64_tr_b16 a[172:173], v11 offset:32
 ds_read_b64_tr_b16 a[174:175], v11 offset:8480
 v_mfma_f32_16x16x32_bf16 v[208:211], a[180:183], v[56:59], v[208:211]
 s_waitcnt lgkmcnt(11)
 v_mul_f32 v69, v35, v69
 v_mul_f32 v70, v35, v70
 v_mfma_f32_16x16x32_bf16 v[180:183], a[184:187], v[56:59], v[180:183]
 ds_read_b64_tr_b16 a[176:177], v10 offset:64
 ds_read_b64_tr_b16 a[178:179], v10 offset:8512
 v_mfma_f32_16x16x32_bf16 v[252:255], a[184:187], v[64:67], v[252:255]
 v_mul_f32 v71, v35, v71
 v_mul_f32 v72, v35, v72
 v_mfma_f32_16x16x32_bf16 v[188:191], a[184:187], v[60:63], v[188:191]
 s_add_u32 s45, s45, 0x80
 v_mul_f32 v73, v35, v73
 v_mul_f32 v74, v35, v74
 v_mfma_f32_16x16x32_bf16 v[220:223], a[188:191], v[60:63], v[220:223]
 s_sub_u32 s56, s45, 0x380
 ds_read_b64_tr_b16 a[180:181], v11 offset:64
 ds_read_b64_tr_b16 a[182:183], v11 offset:8512
 v_mfma_f32_16x16x32_bf16 v[212:215], a[188:191], v[56:59], v[212:215]
 s_waitcnt lgkmcnt(9)
 v_mul_f32 v75, v35, v75
 v_cvt_pk_bf16_f32 v68, v68, v69
 v_mfma_f32_16x16x32_bf16 v[96:99], a[160:163], v[44:47], v[96:99]
 s_min_u32 s45, s45, s56
 ds_read_b64_tr_b16 a[184:185], v10 offset:96
 ds_read_b64_tr_b16 a[186:187], v10 offset:8544
 s_waitcnt lgkmcnt(10)
 v_mfma_f32_16x16x32_bf16 v[224:227], a[160:163], v[52:55], v[224:227]
 s_add_u32 m0, s40, 0x1ea00
 ds_read_b128 v[56:59], v13 offset:20480
 v_cvt_pk_bf16_f32 v69, v70, v71
 v_mfma_f32_16x16x32_bf16 v[104:107], a[160:163], v[48:51], v[104:107]
 s_add_u32 s56, s44, 0
 buffer_load_dwordx4 v17, s[12:15], s56 offen offset:0 lds
 v_cvt_pk_bf16_f32 v70, v72, v73
 v_mfma_f32_16x16x32_bf16 v[136:139], a[164:167], v[48:51], v[136:139]
 s_add_u32 s56, s44, 0x1be0
 ds_read_b64_tr_b16 a[188:189], v11 offset:96
 ds_read_b64_tr_b16 a[190:191], v11 offset:8544
 v_mfma_f32_16x16x32_bf16 v[128:131], a[164:167], v[44:47], v[128:131]
 s_waitcnt lgkmcnt(9)
 buffer_load_dwordx4 v17, s[12:15], s56 offen offset:1056 lds
 v_cvt_pk_bf16_f32 v71, v74, v75
 v_mfma_f32_16x16x32_bf16 v[100:103], a[168:171], v[44:47], v[100:103]
 ds_read_b64_tr_b16 a[160:161], v10 offset:256
 ds_read_b64_tr_b16 a[162:163], v10 offset:8704
 v_mfma_f32_16x16x32_bf16 v[228:231], a[168:171], v[52:55], v[228:231]
 ds_read_b128 v[60:63], v13 offset:22528
 v_accvgpr_write_b32 a200, v68
 v_mfma_f32_16x16x32_bf16 v[108:111], a[168:171], v[48:51], v[108:111]
 v_accvgpr_write_b32 a201, v69
 v_accvgpr_write_b32 a202, v70
 v_mfma_f32_16x16x32_bf16 v[140:143], a[172:175], v[48:51], v[140:143]
 ds_read_b64_tr_b16 a[164:165], v11 offset:256
 ds_read_b64_tr_b16 a[166:167], v11 offset:8704
 v_mfma_f32_16x16x32_bf16 v[132:135], a[172:175], v[44:47], v[132:135]
 s_waitcnt lgkmcnt(10)
 v_accvgpr_write_b32 a203, v71
 v_accvgpr_read_b32 v68, a24
 v_mfma_f32_16x16x32_bf16 v[112:115], a[176:179], v[44:47], v[112:115]
 s_add_u32 s56, s44, 0x37c0
 ds_read_b64_tr_b16 a[168:169], v10 offset:288
 ds_read_b64_tr_b16 a[170:171], v10 offset:8736
 v_mfma_f32_16x16x32_bf16 v[232:235], a[176:179], v[52:55], v[232:235]
 ds_read_b128 v[64:67], v15 offset:20480
 buffer_load_dwordx4 v17, s[12:15], s56 offen offset:2112 lds
 v_mfma_f32_16x16x32_bf16 v[120:123], a[176:179], v[48:51], v[120:123]
 v_accvgpr_read_b32 v69, a25
 v_accvgpr_read_b32 v70, a26
 v_mfma_f32_16x16x32_bf16 v[152:155], a[180:183], v[48:51], v[152:155]
 ds_read_b64_tr_b16 a[172:173], v11 offset:288
 ds_read_b64_tr_b16 a[174:175], v11 offset:8736
 v_mfma_f32_16x16x32_bf16 v[144:147], a[180:183], v[44:47], v[144:147]
 s_waitcnt lgkmcnt(10)
 v_accvgpr_read_b32 v71, a27
 v_accvgpr_read_b32 v72, a28
 v_mfma_f32_16x16x32_bf16 v[116:119], a[184:187], v[44:47], v[116:119]
 s_add_u32 s56, s44, 0x53a0
 ds_read_b64_tr_b16 a[176:177], v10 offset:320
 ds_read_b64_tr_b16 a[178:179], v10 offset:8768
 v_mfma_f32_16x16x32_bf16 v[236:239], a[184:187], v[52:55], v[236:239]
 buffer_load_dwordx4 v17, s[12:15], s56 offen offset:3168 lds
 v_accvgpr_read_b32 v73, a29
 v_mfma_f32_16x16x32_bf16 v[124:127], a[184:187], v[48:51], v[124:127]
 v_accvgpr_read_b32 v74, a30
 v_accvgpr_read_b32 v75, a31
 v_mfma_f32_16x16x32_bf16 v[156:159], a[188:191], v[48:51], v[156:159]
 ds_read_b64_tr_b16 a[180:181], v11 offset:320
 ds_read_b64_tr_b16 a[182:183], v11 offset:8768
 v_mfma_f32_16x16x32_bf16 v[148:151], a[188:191], v[44:47], v[148:151]
 s_waitcnt lgkmcnt(9)
 v_mul_f32 v68, v36, v68
 v_mul_f32 v69, v36, v69
 v_mfma_f32_16x16x32_bf16 v[160:163], a[160:163], v[44:47], v[160:163]
 ds_read_b64_tr_b16 a[184:185], v10 offset:352
 ds_read_b64_tr_b16 a[186:187], v10 offset:8800
 v_mfma_f32_16x16x32_bf16 v[240:243], a[160:163], v[52:55], v[240:243]
 v_mul_f32 v70, v36, v70
 v_mul_f32 v71, v36, v71
 v_mfma_f32_16x16x32_bf16 v[168:171], a[160:163], v[48:51], v[168:171]
 v_mul_f32 v72, v36, v72
 v_mul_f32 v73, v36, v73
 v_mfma_f32_16x16x32_bf16 v[200:203], a[164:167], v[48:51], v[200:203]
 ds_read_b64_tr_b16 a[188:189], v11 offset:352
 ds_read_b64_tr_b16 a[190:191], v11 offset:8800
 v_mfma_f32_16x16x32_bf16 v[192:195], a[164:167], v[44:47], v[192:195]
 s_waitcnt lgkmcnt(8)
 v_mul_f32 v74, v36, v74
 v_mul_f32 v75, v36, v75
 v_mfma_f32_16x16x32_bf16 v[164:167], a[168:171], v[44:47], v[164:167]
 s_waitcnt vmcnt(13)
 s_barrier
 ds_read_b64_tr_b16 a[160:161], v10 offset:16896
 ds_read_b64_tr_b16 a[162:163], v10 offset:25344
 v_mfma_f32_16x16x32_bf16 v[244:247], a[168:171], v[52:55], v[244:247]
 s_add_u32 m0, s40, 0x22c00
 v_cvt_pk_bf16_f32 v68, v68, v69
 v_cvt_pk_bf16_f32 v69, v70, v71
 v_mfma_f32_16x16x32_bf16 v[172:175], a[168:171], v[48:51], v[172:175]
 s_add_u32 s56, s44, 0x40000
 buffer_load_dwordx4 v17, s[12:15], s56 offen offset:0 lds
 v_cvt_pk_bf16_f32 v70, v72, v73
 v_mfma_f32_16x16x32_bf16 v[204:207], a[172:175], v[48:51], v[204:207]
 ds_read_b64_tr_b16 a[164:165], v11 offset:16896
 ds_read_b64_tr_b16 a[166:167], v11 offset:25344
 v_mfma_f32_16x16x32_bf16 v[196:199], a[172:175], v[44:47], v[196:199]
 s_waitcnt lgkmcnt(8)
 v_cvt_pk_bf16_f32 v71, v74, v75
 v_accvgpr_write_b32 a204, v68
 v_mfma_f32_16x16x32_bf16 v[176:179], a[176:179], v[44:47], v[176:179]
 ds_read_b64_tr_b16 a[168:169], v10 offset:16928
 ds_read_b64_tr_b16 a[170:171], v10 offset:25376
 v_mfma_f32_16x16x32_bf16 v[248:251], a[176:179], v[52:55], v[248:251]
 s_add_u32 s56, s44, 0x41be0
 buffer_load_dwordx4 v17, s[12:15], s56 offen offset:1056 lds
 v_accvgpr_write_b32 a205, v69
 v_mfma_f32_16x16x32_bf16 v[184:187], a[176:179], v[48:51], v[184:187]
 v_accvgpr_write_b32 a206, v70
 v_accvgpr_write_b32 a207, v71
 v_mfma_f32_16x16x32_bf16 v[216:219], a[180:183], v[48:51], v[216:219]
 ds_read_b64_tr_b16 a[172:173], v11 offset:16928
 ds_read_b64_tr_b16 a[174:175], v11 offset:25376
 v_mfma_f32_16x16x32_bf16 v[208:211], a[180:183], v[44:47], v[208:211]
 s_waitcnt lgkmcnt(8)
 v_accvgpr_read_b32 v68, a32
 v_accvgpr_read_b32 v69, a33
 v_mfma_f32_16x16x32_bf16 v[180:183], a[184:187], v[44:47], v[180:183]
 ds_read_b64_tr_b16 a[176:177], v10 offset:16960
 ds_read_b64_tr_b16 a[178:179], v10 offset:25408
 v_mfma_f32_16x16x32_bf16 v[252:255], a[184:187], v[52:55], v[252:255]
 s_add_u32 s56, s44, 0x437c0
 buffer_load_dwordx4 v17, s[12:15], s56 offen offset:2112 lds
 v_accvgpr_read_b32 v70, a34
 v_mfma_f32_16x16x32_bf16 v[188:191], a[184:187], v[48:51], v[188:191]
 v_accvgpr_read_b32 v71, a35
 v_accvgpr_read_b32 v72, a36
 v_mfma_f32_16x16x32_bf16 v[220:223], a[188:191], v[48:51], v[220:223]
 ds_read_b64_tr_b16 a[180:181], v11 offset:16960
 ds_read_b64_tr_b16 a[182:183], v11 offset:25408
 v_mfma_f32_16x16x32_bf16 v[212:215], a[188:191], v[44:47], v[212:215]
 s_waitcnt lgkmcnt(8)
 v_accvgpr_read_b32 v73, a37
 v_accvgpr_read_b32 v74, a38
 v_mfma_f32_16x16x32_bf16 v[96:99], a[160:163], v[56:59], v[96:99]
 ds_read_b64_tr_b16 a[184:185], v10 offset:16992
 ds_read_b64_tr_b16 a[186:187], v10 offset:25440
 v_mfma_f32_16x16x32_bf16 v[224:227], a[160:163], v[64:67], v[224:227]
 s_add_u32 s56, s44, 0x453a0
 buffer_load_dwordx4 v17, s[12:15], s56 offen offset:3168 lds
 v_accvgpr_read_b32 v75, a39
 v_mfma_f32_16x16x32_bf16 v[104:107], a[160:163], v[60:63], v[104:107]
 v_mul_f32 v68, v35, v68
 v_mul_f32 v69, v35, v69
 v_mfma_f32_16x16x32_bf16 v[136:139], a[164:167], v[60:63], v[136:139]
 ds_read_b64_tr_b16 a[188:189], v11 offset:16992
 ds_read_b64_tr_b16 a[190:191], v11 offset:25440
 v_mfma_f32_16x16x32_bf16 v[128:131], a[164:167], v[56:59], v[128:131]
 s_waitcnt lgkmcnt(8)
 v_mul_f32 v70, v35, v70
 v_mul_f32 v71, v35, v71
 v_mfma_f32_16x16x32_bf16 v[100:103], a[168:171], v[56:59], v[100:103]
 ds_read_b64_tr_b16 a[160:161], v10 offset:17152
 ds_read_b64_tr_b16 a[162:163], v10 offset:25600
 v_mfma_f32_16x16x32_bf16 v[228:231], a[168:171], v[64:67], v[228:231]
 s_add_u32 s44, s44, 0x80000
 v_mul_f32 v72, v35, v72
 v_mul_f32 v73, v35, v73
 v_mfma_f32_16x16x32_bf16 v[108:111], a[168:171], v[60:63], v[108:111]
 s_sub_u32 s56, s44, 0x380000
 v_mul_f32 v74, v35, v74
 v_mul_f32 v75, v35, v75
 v_mfma_f32_16x16x32_bf16 v[140:143], a[172:175], v[60:63], v[140:143]
 s_min_u32 s44, s44, s56
 ds_read_b64_tr_b16 a[164:165], v11 offset:17152
 ds_read_b64_tr_b16 a[166:167], v11 offset:25600
 v_mfma_f32_16x16x32_bf16 v[132:135], a[172:175], v[56:59], v[132:135]
 s_waitcnt lgkmcnt(8)
 v_cvt_pk_bf16_f32 v68, v68, v69
 v_cvt_pk_bf16_f32 v69, v70, v71
 v_mfma_f32_16x16x32_bf16 v[112:115], a[176:179], v[56:59], v[112:115]
 s_add_u32 m0, s41, 0x11600
 ds_read_b64_tr_b16 a[168:169], v10 offset:17184
 ds_read_b64_tr_b16 a[170:171], v10 offset:25632
 v_mfma_f32_16x16x32_bf16 v[232:235], a[176:179], v[64:67], v[232:235]
 s_add_u32 s56, s45, 0
 buffer_load_dwordx4 v18, s[8:11], s56 offen offset:0 lds
 v_cvt_pk_bf16_f32 v70, v72, v73
 v_mfma_f32_16x16x32_bf16 v[120:123], a[176:179], v[60:63], v[120:123]
 s_add_u32 m0, s41, 0x12600
 v_cvt_pk_bf16_f32 v71, v74, v75
 v_accvgpr_write_b32 a208, v68
 v_mfma_f32_16x16x32_bf16 v[152:155], a[180:183], v[60:63], v[152:155]
 s_add_u32 s56, s45, 0x7000
 ds_read_b64_tr_b16 a[172:173], v11 offset:17184
 ds_read_b64_tr_b16 a[174:175], v11 offset:25632
 v_mfma_f32_16x16x32_bf16 v[144:147], a[180:183], v[56:59], v[144:147]
 s_waitcnt lgkmcnt(8)
 buffer_load_dwordx4 v18, s[8:11], s56 offen offset:0 lds
 v_accvgpr_write_b32 a209, v69
 v_mfma_f32_16x16x32_bf16 v[116:119], a[184:187], v[56:59], v[116:119]
 ds_read_b64_tr_b16 a[176:177], v10 offset:17216
 ds_read_b64_tr_b16 a[178:179], v10 offset:25664
 v_mfma_f32_16x16x32_bf16 v[236:239], a[184:187], v[64:67], v[236:239]
 s_add_u32 m0, s41, 0x13600
 v_accvgpr_write_b32 a210, v70
 v_accvgpr_write_b32 a211, v71
 v_mfma_f32_16x16x32_bf16 v[124:127], a[184:187], v[60:63], v[124:127]
 s_add_u32 s56, s45, 0xe000
 buffer_load_dwordx4 v18, s[8:11], s56 offen offset:0 lds
 v_accvgpr_read_b32 v68, a40
 v_mfma_f32_16x16x32_bf16 v[156:159], a[188:191], v[60:63], v[156:159]
 ds_read_b64_tr_b16 a[180:181], v11 offset:17216
 ds_read_b64_tr_b16 a[182:183], v11 offset:25664
 v_mfma_f32_16x16x32_bf16 v[148:151], a[188:191], v[56:59], v[148:151]
 s_waitcnt lgkmcnt(8)
 v_accvgpr_read_b32 v69, a41
 v_accvgpr_read_b32 v70, a42
 v_mfma_f32_16x16x32_bf16 v[160:163], a[160:163], v[56:59], v[160:163]
 ds_read_b64_tr_b16 a[184:185], v10 offset:17248
 ds_read_b64_tr_b16 a[186:187], v10 offset:25696
 v_mfma_f32_16x16x32_bf16 v[240:243], a[160:163], v[64:67], v[240:243]
 v_accvgpr_read_b32 v71, a43
 v_accvgpr_read_b32 v72, a44
 v_mfma_f32_16x16x32_bf16 v[168:171], a[160:163], v[60:63], v[168:171]
 v_accvgpr_read_b32 v73, a45
 v_accvgpr_read_b32 v74, a46
 v_mfma_f32_16x16x32_bf16 v[200:203], a[164:167], v[60:63], v[200:203]
 ds_read_b64_tr_b16 a[188:189], v11 offset:17248
 ds_read_b64_tr_b16 a[190:191], v11 offset:25696
 v_mfma_f32_16x16x32_bf16 v[192:195], a[164:167], v[56:59], v[192:195]
 s_waitcnt lgkmcnt(8)
 v_accvgpr_read_b32 v75, a47
 v_mul_f32 v68, v36, v68
 v_mfma_f32_16x16x32_bf16 v[164:167], a[168:171], v[56:59], v[164:167]
 s_waitcnt vmcnt(7)
 s_barrier
 ds_read_b64_tr_b16 a[160:161], v10 offset:33792
 ds_read_b64_tr_b16 a[162:163], v10 offset:42240
 v_mfma_f32_16x16x32_bf16 v[244:247], a[168:171], v[64:67], v[244:247]
 s_add_u32 m0, s41, 0x14600
 ds_read_b128 v[44:47], v12 offset:0
 v_mul_f32 v69, v36, v69
 v_mfma_f32_16x16x32_bf16 v[172:175], a[168:171], v[60:63], v[172:175]
 s_add_u32 s56, s45, 0x15000
 ds_read_b128 v[48:51], v12 offset:2048
 buffer_load_dwordx4 v18, s[8:11], s56 offen offset:0 lds
 v_mfma_f32_16x16x32_bf16 v[204:207], a[172:175], v[60:63], v[204:207]
 ds_read_b64_tr_b16 a[164:165], v11 offset:33792
 ds_read_b64_tr_b16 a[166:167], v11 offset:42240
 v_mfma_f32_16x16x32_bf16 v[196:199], a[172:175], v[56:59], v[196:199]
 s_waitcnt lgkmcnt(10)
 ds_read_b128 v[52:55], v14 offset:0
 v_mul_f32 v70, v36, v70
 v_mfma_f32_16x16x32_bf16 v[176:179], a[176:179], v[56:59], v[176:179]
 ds_read_b64_tr_b16 a[168:169], v10 offset:33824
 ds_read_b64_tr_b16 a[170:171], v10 offset:42272
 v_mfma_f32_16x16x32_bf16 v[248:251], a[176:179], v[64:67], v[248:251]
 s_add_u32 m0, s41, 0x15600
 v_mul_f32 v71, v36, v71
 v_mul_f32 v72, v36, v72
 v_mfma_f32_16x16x32_bf16 v[184:187], a[176:179], v[60:63], v[184:187]
 s_add_u32 s56, s45, 0x1c000
 buffer_load_dwordx4 v18, s[8:11], s56 offen offset:0 lds
 v_mul_f32 v73, v36, v73
 v_mfma_f32_16x16x32_bf16 v[216:219], a[180:183], v[60:63], v[216:219]
 ds_read_b64_tr_b16 a[172:173], v11 offset:33824
 ds_read_b64_tr_b16 a[174:175], v11 offset:42272
 v_mfma_f32_16x16x32_bf16 v[208:211], a[180:183], v[56:59], v[208:211]
 s_waitcnt lgkmcnt(11)
 v_mul_f32 v74, v36, v74
 v_mul_f32 v75, v36, v75
 v_mfma_f32_16x16x32_bf16 v[180:183], a[184:187], v[56:59], v[180:183]
 ds_read_b64_tr_b16 a[176:177], v10 offset:33856
 ds_read_b64_tr_b16 a[178:179], v10 offset:42304
 v_mfma_f32_16x16x32_bf16 v[252:255], a[184:187], v[64:67], v[252:255]
 v_cvt_pk_bf16_f32 v68, v68, v69
 v_cvt_pk_bf16_f32 v69, v70, v71
 v_mfma_f32_16x16x32_bf16 v[188:191], a[184:187], v[60:63], v[188:191]
 s_add_u32 s45, s45, 0x80
 v_cvt_pk_bf16_f32 v70, v72, v73
 v_cvt_pk_bf16_f32 v71, v74, v75
 v_mfma_f32_16x16x32_bf16 v[220:223], a[188:191], v[60:63], v[220:223]
 s_sub_u32 s56, s45, 0x380
 ds_read_b64_tr_b16 a[180:181], v11 offset:33856
 ds_read_b64_tr_b16 a[182:183], v11 offset:42304
 v_mfma_f32_16x16x32_bf16 v[212:215], a[188:191], v[56:59], v[212:215]
 s_waitcnt lgkmcnt(9)
 v_accvgpr_write_b32 a212, v68
 v_accvgpr_write_b32 a213, v69
 v_mfma_f32_16x16x32_bf16 v[96:99], a[160:163], v[44:47], v[96:99]
 s_min_u32 s45, s45, s56
 ds_read_b64_tr_b16 a[184:185], v10 offset:33888
 ds_read_b64_tr_b16 a[186:187], v10 offset:42336
 s_waitcnt lgkmcnt(10)
 v_mfma_f32_16x16x32_bf16 v[224:227], a[160:163], v[52:55], v[224:227]
 s_add_u32 m0, s40, 0x16600
 ds_read_b128 v[56:59], v13 offset:0
 v_accvgpr_write_b32 a214, v70
 v_mfma_f32_16x16x32_bf16 v[104:107], a[160:163], v[48:51], v[104:107]
 s_add_u32 s56, s44, 0
 buffer_load_dwordx4 v17, s[12:15], s56 offen offset:0 lds
 v_accvgpr_write_b32 a215, v71
 v_mfma_f32_16x16x32_bf16 v[136:139], a[164:167], v[48:51], v[136:139]
 s_add_u32 s56, s44, 0x1be0
 ds_read_b64_tr_b16 a[188:189], v11 offset:33888
 ds_read_b64_tr_b16 a[190:191], v11 offset:42336
 v_mfma_f32_16x16x32_bf16 v[128:131], a[164:167], v[44:47], v[128:131]
 s_waitcnt lgkmcnt(9)
 buffer_load_dwordx4 v17, s[12:15], s56 offen offset:1056 lds
 v_accvgpr_read_b32 v68, a48
 v_mfma_f32_16x16x32_bf16 v[100:103], a[168:171], v[44:47], v[100:103]
 ds_read_b64_tr_b16 a[160:161], v10 offset:34048
 ds_read_b64_tr_b16 a[162:163], v10 offset:42496
 v_mfma_f32_16x16x32_bf16 v[228:231], a[168:171], v[52:55], v[228:231]
 ds_read_b128 v[60:63], v13 offset:2048
 v_accvgpr_read_b32 v69, a49
 v_mfma_f32_16x16x32_bf16 v[108:111], a[168:171], v[48:51], v[108:111]
 v_accvgpr_read_b32 v70, a50
 v_accvgpr_read_b32 v71, a51
 v_mfma_f32_16x16x32_bf16 v[140:143], a[172:175], v[48:51], v[140:143]
 ds_read_b64_tr_b16 a[164:165], v11 offset:34048
 ds_read_b64_tr_b16 a[166:167], v11 offset:42496
 v_mfma_f32_16x16x32_bf16 v[132:135], a[172:175], v[44:47], v[132:135]
 s_waitcnt lgkmcnt(10)
 v_accvgpr_read_b32 v72, a52
 v_accvgpr_read_b32 v73, a53
 v_mfma_f32_16x16x32_bf16 v[112:115], a[176:179], v[44:47], v[112:115]
 s_add_u32 s56, s44, 0x37c0
 ds_read_b64_tr_b16 a[168:169], v10 offset:34080
 ds_read_b64_tr_b16 a[170:171], v10 offset:42528
 v_mfma_f32_16x16x32_bf16 v[232:235], a[176:179], v[52:55], v[232:235]
 ds_read_b128 v[64:67], v15 offset:0
 buffer_load_dwordx4 v17, s[12:15], s56 offen offset:2112 lds
 v_mfma_f32_16x16x32_bf16 v[120:123], a[176:179], v[48:51], v[120:123]
 v_accvgpr_read_b32 v74, a54
 v_accvgpr_read_b32 v75, a55
 v_mfma_f32_16x16x32_bf16 v[152:155], a[180:183], v[48:51], v[152:155]
 ds_read_b64_tr_b16 a[172:173], v11 offset:34080
 ds_read_b64_tr_b16 a[174:175], v11 offset:42528
 v_mfma_f32_16x16x32_bf16 v[144:147], a[180:183], v[44:47], v[144:147]
 s_waitcnt lgkmcnt(10)
 v_mul_f32 v68, v35, v68
 v_mul_f32 v69, v35, v69
 v_mfma_f32_16x16x32_bf16 v[116:119], a[184:187], v[44:47], v[116:119]
 s_add_u32 s56, s44, 0x53a0
 ds_read_b64_tr_b16 a[176:177], v10 offset:34112
 ds_read_b64_tr_b16 a[178:179], v10 offset:42560
 v_mfma_f32_16x16x32_bf16 v[236:239], a[184:187], v[52:55], v[236:239]
 buffer_load_dwordx4 v17, s[12:15], s56 offen offset:3168 lds
 v_mul_f32 v70, v35, v70
 v_mfma_f32_16x16x32_bf16 v[124:127], a[184:187], v[48:51], v[124:127]
 v_mul_f32 v71, v35, v71
 v_mul_f32 v72, v35, v72
 v_mfma_f32_16x16x32_bf16 v[156:159], a[188:191], v[48:51], v[156:159]
 ds_read_b64_tr_b16 a[180:181], v11 offset:34112
 ds_read_b64_tr_b16 a[182:183], v11 offset:42560
 v_mfma_f32_16x16x32_bf16 v[148:151], a[188:191], v[44:47], v[148:151]
 s_waitcnt lgkmcnt(9)
 v_mul_f32 v73, v35, v73
 v_mul_f32 v74, v35, v74
 v_mfma_f32_16x16x32_bf16 v[160:163], a[160:163], v[44:47], v[160:163]
 ds_read_b64_tr_b16 a[184:185], v10 offset:34144
 ds_read_b64_tr_b16 a[186:187], v10 offset:42592
 v_mfma_f32_16x16x32_bf16 v[240:243], a[160:163], v[52:55], v[240:243]
 v_mul_f32 v75, v35, v75
 v_cvt_pk_bf16_f32 v68, v68, v69
 v_mfma_f32_16x16x32_bf16 v[168:171], a[160:163], v[48:51], v[168:171]
 v_cvt_pk_bf16_f32 v69, v70, v71
 v_cvt_pk_bf16_f32 v70, v72, v73
 v_mfma_f32_16x16x32_bf16 v[200:203], a[164:167], v[48:51], v[200:203]
 ds_read_b64_tr_b16 a[188:189], v11 offset:34144
 ds_read_b64_tr_b16 a[190:191], v11 offset:42592
 v_mfma_f32_16x16x32_bf16 v[192:195], a[164:167], v[44:47], v[192:195]
 s_waitcnt lgkmcnt(8)
 v_cvt_pk_bf16_f32 v71, v74, v75
 v_accvgpr_write_b32 a216, v68
 v_mfma_f32_16x16x32_bf16 v[164:167], a[168:171], v[44:47], v[164:167]
 s_waitcnt vmcnt(9)
 s_barrier
 ds_read_b64_tr_b16 a[160:161], v10 offset:50688
 ds_read_b64_tr_b16 a[162:163], v10 offset:59136
 v_mfma_f32_16x16x32_bf16 v[244:247], a[168:171], v[52:55], v[244:247]
 s_add_u32 m0, s40, 0x1a800
 v_accvgpr_write_b32 a217, v69
 v_accvgpr_write_b32 a218, v70
 v_mfma_f32_16x16x32_bf16 v[172:175], a[168:171], v[48:51], v[172:175]
 s_add_u32 s56, s44, 0x40000
 buffer_load_dwordx4 v17, s[12:15], s56 offen offset:0 lds
 v_accvgpr_write_b32 a219, v71
 v_mfma_f32_16x16x32_bf16 v[204:207], a[172:175], v[48:51], v[204:207]
 ds_read_b64_tr_b16 a[164:165], v11 offset:50688
 ds_read_b64_tr_b16 a[166:167], v11 offset:59136
 v_mfma_f32_16x16x32_bf16 v[196:199], a[172:175], v[44:47], v[196:199]
 s_waitcnt lgkmcnt(8)
 v_accvgpr_read_b32 v68, a56
 v_accvgpr_read_b32 v69, a57
 v_mfma_f32_16x16x32_bf16 v[176:179], a[176:179], v[44:47], v[176:179]
 s_add_u32 s56, s44, 0x41be0
 ds_read_b64_tr_b16 a[168:169], v10 offset:50720
 ds_read_b64_tr_b16 a[170:171], v10 offset:59168
 v_mfma_f32_16x16x32_bf16 v[248:251], a[176:179], v[52:55], v[248:251]
 buffer_load_dwordx4 v17, s[12:15], s56 offen offset:1056 lds
 v_accvgpr_read_b32 v70, a58
 v_mfma_f32_16x16x32_bf16 v[184:187], a[176:179], v[48:51], v[184:187]
 s_add_u32 s56, s44, 0x437c0
 buffer_load_dwordx4 v17, s[12:15], s56 offen offset:2112 lds
 v_accvgpr_read_b32 v71, a59
 v_mfma_f32_16x16x32_bf16 v[216:219], a[180:183], v[48:51], v[216:219]
 ds_read_b64_tr_b16 a[172:173], v11 offset:50720
 ds_read_b64_tr_b16 a[174:175], v11 offset:59168
 v_mfma_f32_16x16x32_bf16 v[208:211], a[180:183], v[44:47], v[208:211]
 s_waitcnt lgkmcnt(8)
 v_accvgpr_read_b32 v72, a60
 v_accvgpr_read_b32 v73, a61
 v_mfma_f32_16x16x32_bf16 v[180:183], a[184:187], v[44:47], v[180:183]
 s_add_u32 s56, s44, 0x453a0
 ds_read_b64_tr_b16 a[176:177], v10 offset:50752
 ds_read_b64_tr_b16 a[178:179], v10 offset:59200
 v_mfma_f32_16x16x32_bf16 v[252:255], a[184:187], v[52:55], v[252:255]
L_pad11:
 s_cbranch_execz L_pad15
 buffer_load_dwordx4 v17, s[12:15], s56 offen offset:3168 lds
 v_accvgpr_read_b32 v74, a62
 v_mfma_f32_16x16x32_bf16 v[188:191], a[184:187], v[48:51], v[188:191]
 v_accvgpr_read_b32 v75, a63
 v_mul_f32 v68, v36, v68
 v_mfma_f32_16x16x32_bf16 v[220:223], a[188:191], v[48:51], v[220:223]
 s_add_u32 s44, s44, 0x80000
 ds_read_b64_tr_b16 a[180:181], v11 offset:50752
 ds_read_b64_tr_b16 a[182:183], v11 offset:59200
 v_mfma_f32_16x16x32_bf16 v[212:215], a[188:191], v[44:47], v[212:215]
 s_waitcnt lgkmcnt(8)
 v_mul_f32 v69, v36, v69
 v_mul_f32 v70, v36, v70
 v_mfma_f32_16x16x32_bf16 v[96:99], a[160:163], v[56:59], v[96:99]
 s_sub_u32 s56, s44, 0x380000
 ds_read_b64_tr_b16 a[184:185], v10 offset:50784
 ds_read_b64_tr_b16 a[186:187], v10 offset:59232
 v_mfma_f32_16x16x32_bf16 v[224:227], a[160:163], v[64:67], v[224:227]
 s_min_u32 s44, s44, s56
 v_mul_f32 v71, v36, v71
 v_mul_f32 v72, v36, v72
 v_mfma_f32_16x16x32_bf16 v[104:107], a[160:163], v[60:63], v[104:107]
 s_add_u32 m0, s41, 0xc600
 v_mul_f32 v73, v36, v73
 v_mul_f32 v74, v36, v74
 v_mfma_f32_16x16x32_bf16 v[136:139], a[164:167], v[60:63], v[136:139]
 s_add_u32 s56, s45, 0
 ds_read_b64_tr_b16 a[188:189], v11 offset:50784
 ds_read_b64_tr_b16 a[190:191], v11 offset:59232
 v_mfma_f32_16x16x32_bf16 v[128:131], a[164:167], v[56:59], v[128:131]
 s_waitcnt lgkmcnt(8)
 buffer_load_dwordx4 v18, s[8:11], s56 offen offset:0 lds
 v_mul_f32 v75, v36, v75
 v_mfma_f32_16x16x32_bf16 v[100:103], a[168:171], v[56:59], v[100:103]
 s_add_u32 m0, s41, 0xd600
 ds_read_b64_tr_b16 a[160:161], v10 offset:50944
 ds_read_b64_tr_b16 a[162:163], v10 offset:59392
 v_mfma_f32_16x16x32_bf16 v[228:231], a[168:171], v[64:67], v[228:231]
 s_add_u32 s56, s45, 0x7000
 buffer_load_dwordx4 v18, s[8:11], s56 offen offset:0 lds
 v_cvt_pk_bf16_f32 v68, v68, v69
 v_mfma_f32_16x16x32_bf16 v[108:111], a[168:171], v[60:63], v[108:111]
 s_add_u32 m0, s41, 0xe600
 v_cvt_pk_bf16_f32 v69, v70, v71
 v_cvt_pk_bf16_f32 v70, v72, v73
 v_mfma_f32_16x16x32_bf16 v[140:143], a[172:175], v[60:63], v[140:143]
 s_add_u32 s56, s45, 0xe000
 ds_read_b64_tr_b16 a[164:165], v11 offset:50944
 ds_read_b64_tr_b16 a[166:167], v11 offset:59392
 v_mfma_f32_16x16x32_bf16 v[132:135], a[172:175], v[56:59], v[132:135]
 s_waitcnt lgkmcnt(8)
 buffer_load_dwordx4 v18, s[8:11], s56 offen offset:0 lds
 v_cvt_pk_bf16_f32 v71, v74, v75
 v_mfma_f32_16x16x32_bf16 v[112:115], a[176:179], v[56:59], v[112:115]
 s_xor_b32 s56, s42, 0x8000
 ds_read_b64_tr_b16 a[168:169], v10 offset:50976
 ds_read_b64_tr_b16 a[170:171], v10 offset:59424
 v_mfma_f32_16x16x32_bf16 v[232:235], a[176:179], v[64:67], v[232:235]
 s_add_u32 m0, s40, 0x8400
 v_accvgpr_write_b32 a220, v68
 v_accvgpr_write_b32 a221, v69
 v_mfma_f32_16x16x32_bf16 v[120:123], a[176:179], v[60:63], v[120:123]
 buffer_load_dwordx4 v16, s[16:19], s56 offen offset:0 nt lds
 v_accvgpr_write_b32 a222, v70
 v_mfma_f32_16x16x32_bf16 v[152:155], a[180:183], v[60:63], v[152:155]
 s_add_u32 m0, s40, 0x8620
 ds_read_b64_tr_b16 a[172:173], v11 offset:50976
 ds_read_b64_tr_b16 a[174:175], v11 offset:59424
 v_mfma_f32_16x16x32_bf16 v[144:147], a[180:183], v[56:59], v[144:147]
 s_waitcnt lgkmcnt(8)
 buffer_load_dwordx4 v16, s[16:19], s56 offen offset:512 nt lds
 v_accvgpr_write_b32 a223, v71
 v_mfma_f32_16x16x32_bf16 v[116:119], a[184:187], v[56:59], v[116:119]
 s_add_u32 m0, s40, 0x8840
 ds_read_b64_tr_b16 a[176:177], v10 offset:51008
 ds_read_b64_tr_b16 a[178:179], v10 offset:59456
 v_mfma_f32_16x16x32_bf16 v[236:239], a[184:187], v[64:67], v[236:239]
 buffer_load_dwordx4 v16, s[16:19], s56 offen offset:1024 nt lds
 v_accvgpr_read_b32 v68, a64
 v_mfma_f32_16x16x32_bf16 v[124:127], a[184:187], v[60:63], v[124:127]
 s_add_u32 m0, s40, 0x8a60
 v_accvgpr_read_b32 v69, a65
 v_accvgpr_read_b32 v70, a66
 v_mfma_f32_16x16x32_bf16 v[156:159], a[188:191], v[60:63], v[156:159]
 ds_read_b64_tr_b16 a[180:181], v11 offset:51008
 ds_read_b64_tr_b16 a[182:183], v11 offset:59456
 v_mfma_f32_16x16x32_bf16 v[148:151], a[188:191], v[56:59], v[148:151]
 s_waitcnt lgkmcnt(8)
 buffer_load_dwordx4 v16, s[16:19], s56 offen offset:1536 nt lds
 v_accvgpr_read_b32 v71, a67
 v_mfma_f32_16x16x32_bf16 v[160:163], a[160:163], v[56:59], v[160:163]
 ds_read_b64_tr_b16 a[184:185], v10 offset:51040
 ds_read_b64_tr_b16 a[186:187], v10 offset:59488
 v_mfma_f32_16x16x32_bf16 v[240:243], a[160:163], v[64:67], v[240:243]
 v_accvgpr_read_b32 v72, a68
 v_accvgpr_read_b32 v73, a69
 v_mfma_f32_16x16x32_bf16 v[168:171], a[160:163], v[60:63], v[168:171]
 v_accvgpr_read_b32 v74, a70
 v_accvgpr_read_b32 v75, a71
 v_mfma_f32_16x16x32_bf16 v[200:203], a[164:167], v[60:63], v[200:203]
 ds_read_b64_tr_b16 a[188:189], v11 offset:51040
 ds_read_b64_tr_b16 a[190:191], v11 offset:59488
 v_mfma_f32_16x16x32_bf16 v[192:195], a[164:167], v[56:59], v[192:195]
 s_waitcnt lgkmcnt(8)
 v_mul_f32 v68, v35, v68
 v_mul_f32 v69, v35, v69
 v_mfma_f32_16x16x32_bf16 v[164:167], a[168:171], v[56:59], v[164:167]
 s_waitcnt vmcnt(11)
 s_barrier
 ds_read_b64_tr_b16 a[160:161], v10 offset:0
 ds_read_b64_tr_b16 a[162:163], v10 offset:8448
 v_mfma_f32_16x16x32_bf16 v[244:247], a[168:171], v[64:67], v[244:247]
 s_add_u32 m0, s41, 0xf600
 ds_read_b128 v[44:47], v12 offset:20480
 v_mul_f32 v70, v35, v70
 v_mfma_f32_16x16x32_bf16 v[172:175], a[168:171], v[60:63], v[172:175]
 s_add_u32 s56, s45, 0x15000
 ds_read_b128 v[48:51], v12 offset:22528
 buffer_load_dwordx4 v18, s[8:11], s56 offen offset:0 lds
 v_mfma_f32_16x16x32_bf16 v[204:207], a[172:175], v[60:63], v[204:207]
 ds_read_b64_tr_b16 a[164:165], v11 offset:0
 ds_read_b64_tr_b16 a[166:167], v11 offset:8448
 v_mfma_f32_16x16x32_bf16 v[196:199], a[172:175], v[56:59], v[196:199]
 s_waitcnt lgkmcnt(10)
 ds_read_b128 v[52:55], v14 offset:20480
 v_mul_f32 v71, v35, v71
 v_mfma_f32_16x16x32_bf16 v[176:179], a[176:179], v[56:59], v[176:179]
 ds_read_b64_tr_b16 a[168:169], v10 offset:32
 ds_read_b64_tr_b16 a[170:171], v10 offset:8480
 v_mfma_f32_16x16x32_bf16 v[248:251], a[176:179], v[64:67], v[248:251]
 s_add_u32 m0, s41, 0x10600
 v_mul_f32 v72, v35, v72
 v_mul_f32 v73, v35, v73
 v_mfma_f32_16x16x32_bf16 v[184:187], a[176:179], v[60:63], v[184:187]
 s_add_u32 s56, s45, 0x1c000
 buffer_load_dwordx4 v18, s[8:11], s56 offen offset:0 lds
 v_mul_f32 v74, v35, v74
 v_mfma_f32_16x16x32_bf16 v[216:219], a[180:183], v[60:63], v[216:219]
 ds_read_b64_tr_b16 a[172:173], v11 offset:32
 ds_read_b64_tr_b16 a[174:175], v11 offset:8480
 v_mfma_f32_16x16x32_bf16 v[208:211], a[180:183], v[56:59], v[208:211]
 s_waitcnt lgkmcnt(11)
 v_mul_f32 v75, v35, v75
 v_cvt_pk_bf16_f32 v68, v68, v69
 v_mfma_f32_16x16x32_bf16 v[180:183], a[184:187], v[56:59], v[180:183]
 ds_read_b64_tr_b16 a[176:177], v10 offset:64
 ds_read_b64_tr_b16 a[178:179], v10 offset:8512
 v_mfma_f32_16x16x32_bf16 v[252:255], a[184:187], v[64:67], v[252:255]
 v_cvt_pk_bf16_f32 v69, v70, v71
 v_cvt_pk_bf16_f32 v70, v72, v73
 v_mfma_f32_16x16x32_bf16 v[188:191], a[184:187], v[60:63], v[188:191]
 s_add_u32 s45, s45, 0x80
 v_cvt_pk_bf16_f32 v71, v74, v75
 v_accvgpr_write_b32 a224, v68
 v_mfma_f32_16x16x32_bf16 v[220:223], a[188:191], v[60:63], v[220:223]
 s_sub_u32 s56, s45, 0x380
 ds_read_b64_tr_b16 a[180:181], v11 offset:64
 ds_read_b64_tr_b16 a[182:183], v11 offset:8512
 v_mfma_f32_16x16x32_bf16 v[212:215], a[188:191], v[56:59], v[212:215]
 s_waitcnt lgkmcnt(9)
 v_accvgpr_write_b32 a225, v69
 v_accvgpr_write_b32 a226, v70
 v_mfma_f32_16x16x32_bf16 v[96:99], a[160:163], v[44:47], v[96:99]
 s_min_u32 s45, s45, s56
 ds_read_b64_tr_b16 a[184:185], v10 offset:96
 ds_read_b64_tr_b16 a[186:187], v10 offset:8544
 s_waitcnt lgkmcnt(10)
 v_mfma_f32_16x16x32_bf16 v[224:227], a[160:163], v[52:55], v[224:227]
 s_add_u32 m0, s40, 0x1ea00
 ds_read_b128 v[56:59], v13 offset:20480
 v_accvgpr_write_b32 a227, v71
 v_mfma_f32_16x16x32_bf16 v[104:107], a[160:163], v[48:51], v[104:107]
 s_add_u32 s56, s44, 0
 buffer_load_dwordx4 v17, s[12:15], s56 offen offset:0 lds
 v_accvgpr_read_b32 v68, a72
 v_mfma_f32_16x16x32_bf16 v[136:139], a[164:167], v[48:51], v[136:139]
 s_add_u32 s56, s44, 0x1be0
 ds_read_b64_tr_b16 a[188:189], v11 offset:96
 ds_read_b64_tr_b16 a[190:191], v11 offset:8544
 v_mfma_f32_16x16x32_bf16 v[128:131], a[164:167], v[44:47], v[128:131]
 s_waitcnt lgkmcnt(9)
 buffer_load_dwordx4 v17, s[12:15], s56 offen offset:1056 lds
 v_accvgpr_read_b32 v69, a73
 v_mfma_f32_16x16x32_bf16 v[100:103], a[168:171], v[44:47], v[100:103]
 ds_read_b64_tr_b16 a[160:161], v10 offset:256
 ds_read_b64_tr_b16 a[162:163], v10 offset:8704
 v_mfma_f32_16x16x32_bf16 v[228:231], a[168:171], v[52:55], v[228:231]
 ds_read_b128 v[60:63], v13 offset:22528
 v_accvgpr_read_b32 v70, a74
 v_mfma_f32_16x16x32_bf16 v[108:111], a[168:171], v[48:51], v[108:111]
 v_accvgpr_read_b32 v71, a75
 v_accvgpr_read_b32 v72, a76
 v_mfma_f32_16x16x32_bf16 v[140:143], a[172:175], v[48:51], v[140:143]
 ds_read_b64_tr_b16 a[164:165], v11 offset:256
 ds_read_b64_tr_b16 a[166:167], v11 offset:8704
 v_mfma_f32_16x16x32_bf16 v[132:135], a[172:175], v[44:47], v[132:135]
 s_waitcnt lgkmcnt(10)
 v_accvgpr_read_b32 v73, a77
 v_accvgpr_read_b32 v74, a78
 v_mfma_f32_16x16x32_bf16 v[112:115], a[176:179], v[44:47], v[112:115]
 s_add_u32 s56, s44, 0x37c0
 ds_read_b64_tr_b16 a[168:169], v10 offset:288
 ds_read_b64_tr_b16 a[170:171], v10 offset:8736
 v_mfma_f32_16x16x32_bf16 v[232:235], a[176:179], v[52:55], v[232:235]
 ds_read_b128 v[64:67], v15 offset:20480
 buffer_load_dwordx4 v17, s[12:15], s56 offen offset:2112 lds
 v_mfma_f32_16x16x32_bf16 v[120:123], a[176:179], v[48:51], v[120:123]
 v_accvgpr_read_b32 v75, a79
 v_mul_f32 v68, v36, v68
 v_mfma_f32_16x16x32_bf16 v[152:155], a[180:183], v[48:51], v[152:155]
 ds_read_b64_tr_b16 a[172:173], v11 offset:288
 ds_read_b64_tr_b16 a[174:175], v11 offset:8736
 v_mfma_f32_16x16x32_bf16 v[144:147], a[180:183], v[44:47], v[144:147]
 s_waitcnt lgkmcnt(10)
 v_mul_f32 v69, v36, v69
 v_mul_f32 v70, v36, v70
 v_mfma_f32_16x16x32_bf16 v[116:119], a[184:187], v[44:47], v[116:119]
 s_add_u32 s56, s44, 0x53a0
 ds_read_b64_tr_b16 a[176:177], v10 offset:320
 ds_read_b64_tr_b16 a[178:179], v10 offset:8768
 v_mfma_f32_16x16x32_bf16 v[236:239], a[184:187], v[52:55], v[236:239]
 buffer_load_dwordx4 v17, s[12:15], s56 offen offset:3168 lds
 v_mul_f32 v71, v36, v71
 v_mfma_f32_16x16x32_bf16 v[124:127], a[184:187], v[48:51], v[124:127]
 v_mul_f32 v72, v36, v72
 v_mul_f32 v73, v36, v73
 v_mfma_f32_16x16x32_bf16 v[156:159], a[188:191], v[48:51], v[156:159]
 ds_read_b64_tr_b16 a[180:181], v11 offset:320
 ds_read_b64_tr_b16 a[182:183], v11 offset:8768
 v_mfma_f32_16x16x32_bf16 v[148:151], a[188:191], v[44:47], v[148:151]
 s_waitcnt lgkmcnt(9)
 v_mul_f32 v74, v36, v74
 v_mul_f32 v75, v36, v75
 v_mfma_f32_16x16x32_bf16 v[160:163], a[160:163], v[44:47], v[160:163]
 ds_read_b64_tr_b16 a[184:185], v10 offset:352
 ds_read_b64_tr_b16 a[186:187], v10 offset:8800
 v_mfma_f32_16x16x32_bf16 v[240:243], a[160:163], v[52:55], v[240:243]
 v_cvt_pk_bf16_f32 v68, v68, v69
 v_cvt_pk_bf16_f32 v69, v70, v71
 v_mfma_f32_16x16x32_bf16 v[168:171], a[160:163], v[48:51], v[168:171]
 v_cvt_pk_bf16_f32 v70, v72, v73
 v_cvt_pk_bf16_f32 v71, v74, v75
 v_mfma_f32_16x16x32_bf16 v[200:203], a[164:167], v[48:51], v[200:203]
 ds_read_b64_tr_b16 a[188:189], v11 offset:352
 ds_read_b64_tr_b16 a[190:191], v11 offset:8800
 v_mfma_f32_16x16x32_bf16 v[192:195], a[164:167], v[44:47], v[192:195]
 s_waitcnt lgkmcnt(8)
 v_accvgpr_write_b32 a228, v68
 v_accvgpr_write_b32 a229, v69
 v_mfma_f32_16x16x32_bf16 v[164:167], a[168:171], v[44:47], v[164:167]
 s_waitcnt vmcnt(13)
 s_barrier
 ds_read_b64_tr_b16 a[160:161], v10 offset:16896
 ds_read_b64_tr_b16 a[162:163], v10 offset:25344
 v_mfma_f32_16x16x32_bf16 v[244:247], a[168:171], v[52:55], v[244:247]
 s_add_u32 m0, s40, 0x22c00
 v_accvgpr_write_b32 a230, v70
 v_accvgpr_write_b32 a231, v71
 v_mfma_f32_16x16x32_bf16 v[172:175], a[168:171], v[48:51], v[172:175]
 s_add_u32 s56, s44, 0x40000
 buffer_load_dwordx4 v17, s[12:15], s56 offen offset:0 lds
 v_accvgpr_read_b32 v68, a80
 v_mfma_f32_16x16x32_bf16 v[204:207], a[172:175], v[48:51], v[204:207]
 ds_read_b64_tr_b16 a[164:165], v11 offset:16896
 ds_read_b64_tr_b16 a[166:167], v11 offset:25344
 v_mfma_f32_16x16x32_bf16 v[196:199], a[172:175], v[44:47], v[196:199]
 s_waitcnt lgkmcnt(8)
 v_accvgpr_read_b32 v69, a81
 v_accvgpr_read_b32 v70, a82
 v_mfma_f32_16x16x32_bf16 v[176:179], a[176:179], v[44:47], v[176:179]
 ds_read_b64_tr_b16 a[168:169], v10 offset:16928
 ds_read_b64_tr_b16 a[170:171], v10 offset:25376
 v_mfma_f32_16x16x32_bf16 v[248:251], a[176:179], v[52:55], v[248:251]
 s_add_u32 s56, s44, 0x41be0
 buffer_load_dwordx4 v17, s[12:15], s56 offen offset:1056 lds
 v_accvgpr_read_b32 v71, a83
 v_mfma_f32_16x16x32_bf16 v[184:187], a[176:179], v[48:51], v[184:187]
 v_accvgpr_read_b32 v72, a84
 v_accvgpr_read_b32 v73, a85
 v_mfma_f32_16x16x32_bf16 v[216:219], a[180:183], v[48:51], v[216:219]
 ds_read_b64_tr_b16 a[172:173], v11 offset:16928
 ds_read_b64_tr_b16 a[174:175], v11 offset:25376
 v_mfma_f32_16x16x32_bf16 v[208:211], a[180:183], v[44:47], v[208:211]
 s_waitcnt lgkmcnt(8)
 v_accvgpr_read_b32 v74, a86
 v_accvgpr_read_b32 v75, a87
 v_mfma_f32_16x16x32_bf16 v[180:183], a[184:187], v[44:47], v[180:183]
 ds_read_b64_tr_b16 a[176:177], v10 offset:16960
 ds_read_b64_tr_b16 a[178:179], v10 offset:25408
 v_mfma_f32_16x16x32_bf16 v[252:255], a[184:187], v[52:55], v[252:255]
 s_add_u32 s56, s44, 0x437c0
 buffer_load_dwordx4 v17, s[12:15], s56 offen offset:2112 lds
 v_mul_f32 v68, v35, v68
 v_mfma_f32_16x16x32_bf16 v[188:191], a[184:187], v[48:51], v[188:191]
 v_mul_f32 v69, v35, v69
 v_mul_f32 v70, v35, v70
 v_mfma_f32_16x16x32_bf16 v[220:223], a[188:191], v[48:51], v[220:223]
 ds_read_b64_tr_b16 a[180:181], v11 offset:16960
 ds_read_b64_tr_b16 a[182:183], v11 offset:25408
 v_mfma_f32_16x16x32_bf16 v[212:215], a[188:191], v[44:47], v[212:215]
 s_waitcnt lgkmcnt(8)
 v_mul_f32 v71, v35, v71
 v_mul_f32 v72, v35, v72
 v_mfma_f32_16x16x32_bf16 v[96:99], a[160:163], v[56:59], v[96:99]
 ds_read_b64_tr_b16 a[184:185], v10 offset:16992
 ds_read_b64_tr_b16 a[186:187], v10 offset:25440
 v_mfma_f32_16x16x32_bf16 v[224:227], a[160:163], v[64:67], v[224:227]
 s_add_u32 s56, s44, 0x453a0
 buffer_load_dwordx4 v17, s[12:15], s56 offen offset:3168 lds
 v_mul_f32 v73, v35, v73
 v_mfma_f32_16x16x32_bf16 v[104:107], a[160:163], v[60:63], v[104:107]
 v_mul_f32 v74, v35, v74
 v_mul_f32 v75, v35, v75
 v_mfma_f32_16x16x32_bf16 v[136:139], a[164:167], v[60:63], v[136:139]
 ds_read_b64_tr_b16 a[188:189], v11 offset:16992
 ds_read_b64_tr_b16 a[190:191], v11 offset:25440
 v_mfma_f32_16x16x32_bf16 v[128:131], a[164:167], v[56:59], v[128:131]
 s_waitcnt lgkmcnt(8)
 v_cvt_pk_bf16_f32 v68, v68, v69
 v_cvt_pk_bf16_f32 v69, v70, v71
 v_mfma_f32_16x16x32_bf16 v[100:103], a[168:171], v[56:59], v[100:103]
 ds_read_b64_tr_b16 a[160:161], v10 offset:17152
 ds_read_b64_tr_b16 a[162:163], v10 offset:25600
 v_mfma_f32_16x16x32_bf16 v[228:231], a[168:171], v[64:67], v[228:231]
 s_add_u32 s44, s44, 0x80000
 v_cvt_pk_bf16_f32 v70, v72, v73
 v_cvt_pk_bf16_f32 v71, v74, v75
 v_mfma_f32_16x16x32_bf16 v[108:111], a[168:171], v[60:63], v[108:111]
 s_sub_u32 s56, s44, 0x380000
 v_accvgpr_write_b32 a232, v68
 v_accvgpr_write_b32 a233, v69
 v_mfma_f32_16x16x32_bf16 v[140:143], a[172:175], v[60:63], v[140:143]
 s_min_u32 s44, s44, s56
 ds_read_b64_tr_b16 a[164:165], v11 offset:17152
 ds_read_b64_tr_b16 a[166:167], v11 offset:25600
 v_mfma_f32_16x16x32_bf16 v[132:135], a[172:175], v[56:59], v[132:135]
 s_waitcnt lgkmcnt(8)
 v_accvgpr_write_b32 a234, v70
 v_accvgpr_write_b32 a235, v71
 v_mfma_f32_16x16x32_bf16 v[112:115], a[176:179], v[56:59], v[112:115]
 s_add_u32 m0, s41, 0x11600
 ds_read_b64_tr_b16 a[168:169], v10 offset:17184
 ds_read_b64_tr_b16 a[170:171], v10 offset:25632
 v_mfma_f32_16x16x32_bf16 v[232:235], a[176:179], v[64:67], v[232:235]
 s_add_u32 s56, s45, 0
 buffer_load_dwordx4 v18, s[8:11], s56 offen offset:0 lds
 v_accvgpr_read_b32 v68, a88
 v_mfma_f32_16x16x32_bf16 v[120:123], a[176:179], v[60:63], v[120:123]
 s_add_u32 m0, s41, 0x12600
 v_accvgpr_read_b32 v69, a89
 v_accvgpr_read_b32 v70, a90
 v_mfma_f32_16x16x32_bf16 v[152:155], a[180:183], v[60:63], v[152:155]
 s_add_u32 s56, s45, 0x7000
 ds_read_b64_tr_b16 a[172:173], v11 offset:17184
 ds_read_b64_tr_b16 a[174:175], v11 offset:25632
 v_mfma_f32_16x16x32_bf16 v[144:147], a[180:183], v[56:59], v[144:147]
 s_waitcnt lgkmcnt(8)
 buffer_load_dwordx4 v18, s[8:11], s56 offen offset:0 lds
 v_accvgpr_read_b32 v71, a91
 v_mfma_f32_16x16x32_bf16 v[116:119], a[184:187], v[56:59], v[116:119]
 ds_read_b64_tr_b16 a[176:177], v10 offset:17216
 ds_read_b64_tr_b16 a[178:179], v10 offset:25664
 v_mfma_f32_16x16x32_bf16 v[236:239], a[184:187], v[64:67], v[236:239]
 s_add_u32 m0, s41, 0x13600
 v_accvgpr_read_b32 v72, a92
 v_accvgpr_read_b32 v73, a93
 v_mfma_f32_16x16x32_bf16 v[124:127], a[184:187], v[60:63], v[124:127]
 s_add_u32 s56, s45, 0xe000
 buffer_load_dwordx4 v18, s[8:11], s56 offen offset:0 lds
 v_accvgpr_read_b32 v74, a94
 v_mfma_f32_16x16x32_bf16 v[156:159], a[188:191], v[60:63], v[156:159]
 ds_read_b64_tr_b16 a[180:181], v11 offset:17216
 ds_read_b64_tr_b16 a[182:183], v11 offset:25664
 v_mfma_f32_16x16x32_bf16 v[148:151], a[188:191], v[56:59], v[148:151]
 s_waitcnt lgkmcnt(8)
 v_accvgpr_read_b32 v75, a95
 v_mul_f32 v68, v36, v68
 v_mfma_f32_16x16x32_bf16 v[160:163], a[160:163], v[56:59], v[160:163]
 ds_read_b64_tr_b16 a[184:185], v10 offset:17248
 ds_read_b64_tr_b16 a[186:187], v10 offset:25696
 v_mfma_f32_16x16x32_bf16 v[240:243], a[160:163], v[64:67], v[240:243]
 v_mul_f32 v69, v36, v69
 v_mul_f32 v70, v36, v70
 v_mfma_f32_16x16x32_bf16 v[168:171], a[160:163], v[60:63], v[168:171]
 v_mul_f32 v71, v36, v71
 v_mul_f32 v72, v36, v72
 v_mfma_f32_16x16x32_bf16 v[200:203], a[164:167], v[60:63], v[200:203]
 ds_read_b64_tr_b16 a[188:189], v11 offset:17248
 ds_read_b64_tr_b16 a[190:191], v11 offset:25696
 v_mfma_f32_16x16x32_bf16 v[192:195], a[164:167], v[56:59], v[192:195]
 s_waitcnt lgkmcnt(8)
 v_mul_f32 v73, v36, v73
 v_mul_f32 v74, v36, v74
 v_mfma_f32_16x16x32_bf16 v[164:167], a[168:171], v[56:59], v[164:167]
 s_waitcnt vmcnt(7)
 s_barrier
 ds_read_b64_tr_b16 a[160:161], v10 offset:33792
 ds_read_b64_tr_b16 a[162:163], v10 offset:42240
 v_mfma_f32_16x16x32_bf16 v[244:247], a[168:171], v[64:67], v[244:247]
 s_add_u32 m0, s41, 0x14600
 ds_read_b128 v[44:47], v12 offset:0
 v_mul_f32 v75, v36, v75
 v_mfma_f32_16x16x32_bf16 v[172:175], a[168:171], v[60:63], v[172:175]
 s_add_u32 s56, s45, 0x15000
 ds_read_b128 v[48:51], v12 offset:2048
 buffer_load_dwordx4 v18, s[8:11], s56 offen offset:0 lds
 v_mfma_f32_16x16x32_bf16 v[204:207], a[172:175], v[60:63], v[204:207]
 ds_read_b64_tr_b16 a[164:165], v11 offset:33792
 ds_read_b64_tr_b16 a[166:167], v11 offset:42240
 v_mfma_f32_16x16x32_bf16 v[196:199], a[172:175], v[56:59], v[196:199]
 s_waitcnt lgkmcnt(10)
 ds_read_b128 v[52:55], v14 offset:0
 v_cvt_pk_bf16_f32 v68, v68, v69
 v_mfma_f32_16x16x32_bf16 v[176:179], a[176:179], v[56:59], v[176:179]
 ds_read_b64_tr_b16 a[168:169], v10 offset:33824
 ds_read_b64_tr_b16 a[170:171], v10 offset:42272
 v_mfma_f32_16x16x32_bf16 v[248:251], a[176:179], v[64:67], v[248:251]
 s_add_u32 m0, s41, 0x15600
 v_cvt_pk_bf16_f32 v69, v70, v71
 v_cvt_pk_bf16_f32 v70, v72, v73
 v_mfma_f32_16x16x32_bf16 v[184:187], a[176:179], v[60:63], v[184:187]
 s_add_u32 s56, s45, 0x1c000
 buffer_load_dwordx4 v18, s[8:11], s56 offen offset:0 lds
 v_cvt_pk_bf16_f32 v71, v74, v75
 v_mfma_f32_16x16x32_bf16 v[216:219], a[180:183], v[60:63], v[216:219]
 ds_read_b64_tr_b16 a[172:173], v11 offset:33824
 ds_read_b64_tr_b16 a[174:175], v11 offset:42272
 v_mfma_f32_16x16x32_bf16 v[208:211], a[180:183], v[56:59], v[208:211]
 s_waitcnt lgkmcnt(11)
 v_accvgpr_write_b32 a236, v68
 v_accvgpr_write_b32 a237, v69
 v_mfma_f32_16x16x32_bf16 v[180:183], a[184:187], v[56:59], v[180:183]
 ds_read_b64_tr_b16 a[176:177], v10 offset:33856
 ds_read_b64_tr_b16 a[178:179], v10 offset:42304
 v_mfma_f32_16x16x32_bf16 v[252:255], a[184:187], v[64:67], v[252:255]
 v_accvgpr_write_b32 a238, v70
 v_accvgpr_write_b32 a239, v71
 v_mfma_f32_16x16x32_bf16 v[188:191], a[184:187], v[60:63], v[188:191]
 s_add_u32 s45, s45, 0x80
 v_accvgpr_read_b32 v68, a96
 v_accvgpr_read_b32 v69, a97
 v_mfma_f32_16x16x32_bf16 v[220:223], a[188:191], v[60:63], v[220:223]
 s_sub_u32 s56, s45, 0x380
 ds_read_b64_tr_b16 a[180:181], v11 offset:33856
 ds_read_b64_tr_b16 a[182:183], v11 offset:42304
 v_mfma_f32_16x16x32_bf16 v[212:215], a[188:191], v[56:59], v[212:215]
 s_waitcnt lgkmcnt(9)
 v_accvgpr_read_b32 v70, a98
 v_accvgpr_read_b32 v71, a99
 v_mfma_f32_16x16x32_bf16 v[96:99], a[160:163], v[44:47], v[96:99]
 s_min_u32 s45, s45, s56
 ds_read_b64_tr_b16 a[184:185], v10 offset:33888
 ds_read_b64_tr_b16 a[186:187], v10 offset:42336
 s_waitcnt lgkmcnt(10)
 v_mfma_f32_16x16x32_bf16 v[224:227], a[160:163], v[52:55], v[224:227]
 s_add_u32 m0, s40, 0x16600
 ds_read_b128 v[56:59], v13 offset:0
 v_accvgpr_read_b32 v72, a100
 v_mfma_f32_16x16x32_bf16 v[104:107], a[160:163], v[48:51], v[104:107]
 s_add_u32 s56, s44, 0
 buffer_load_dwordx4 v17, s[12:15], s56 offen offset:0 lds
 v_accvgpr_read_b32 v73, a101
 v_mfma_f32_16x16x32_bf16 v[136:139], a[164:167], v[48:51], v[136:139]
 s_add_u32 s56, s44, 0x1be0
 ds_read_b64_tr_b16 a[188:189], v11 offset:33888
 ds_read_b64_tr_b16 a[190:191], v11 offset:42336
 v_mfma_f32_16x16x32_bf16 v[128:131], a[164:167], v[44:47], v[128:131]
 s_waitcnt lgkmcnt(9)
 buffer_load_dwordx4 v17, s[12:15], s56 offen offset:1056 lds
 v_accvgpr_read_b32 v74, a102
 v_mfma_f32_16x16x32_bf16 v[100:103], a[168:171], v[44:47], v[100:103]
 ds_read_b64_tr_b16 a[160:161], v10 offset:34048
 ds_read_b64_tr_b16 a[162:163], v10 offset:42496
 v_mfma_f32_16x16x32_bf16 v[228:231], a[168:171], v[52:55], v[228:231]
 ds_read_b128 v[60:63], v13 offset:2048
 v_accvgpr_read_b32 v75, a103
 v_mfma_f32_16x16x32_bf16 v[108:111], a[168:171], v[48:51], v[108:111]
 v_mul_f32 v68, v35, v68
 v_mul_f32 v69, v35, v69
 v_mfma_f32_16x16x32_bf16 v[140:143], a[172:175], v[48:51], v[140:143]
 ds_read_b64_tr_b16 a[164:165], v11 offset:34048
 ds_read_b64_tr_b16 a[166:167], v11 offset:42496
 v_mfma_f32_16x16x32_bf16 v[132:135], a[172:175], v[44:47], v[132:135]
 s_waitcnt lgkmcnt(10)
 v_mul_f32 v70, v35, v70
 v_mul_f32 v71, v35, v71
 v_mfma_f32_16x16x32_bf16 v[112:115], a[176:179], v[44:47], v[112:115]
 s_add_u32 s56, s44, 0x37c0
 ds_read_b64_tr_b16 a[168:169], v10 offset:34080
 ds_read_b64_tr_b16 a[170:171], v10 offset:42528
 v_mfma_f32_16x16x32_bf16 v[232:235], a[176:179], v[52:55], v[232:235]
 ds_read_b128 v[64:67], v15 offset:0
 buffer_load_dwordx4 v17, s[12:15], s56 offen offset:2112 lds
 v_mfma_f32_16x16x32_bf16 v[120:123], a[176:179], v[48:51], v[120:123]
 v_mul_f32 v72, v35, v72
 v_mul_f32 v73, v35, v73
 v_mfma_f32_16x16x32_bf16 v[152:155], a[180:183], v[48:51], v[152:155]
 ds_read_b64_tr_b16 a[172:173], v11 offset:34080
 ds_read_b64_tr_b16 a[174:175], v11 offset:42528
 v_mfma_f32_16x16x32_bf16 v[144:147], a[180:183], v[44:47], v[144:147]
 s_waitcnt lgkmcnt(10)
 v_mul_f32 v74, v35, v74
 v_mul_f32 v75, v35, v75
 v_mfma_f32_16x16x32_bf16 v[116:119], a[184:187], v[44:47], v[116:119]
 s_add_u32 s56, s44, 0x53a0
 ds_read_b64_tr_b16 a[176:177], v10 offset:34112
 ds_read_b64_tr_b16 a[178:179], v10 offset:42560
 v_mfma_f32_16x16x32_bf16 v[236:239], a[184:187], v[52:55], v[236:239]
 buffer_load_dwordx4 v17, s[12:15], s56 offen offset:3168 lds
 v_cvt_pk_bf16_f32 v68, v68, v69
 v_mfma_f32_16x16x32_bf16 v[124:127], a[184:187], v[48:51], v[124:127]
 v_cvt_pk_bf16_f32 v69, v70, v71
 v_cvt_pk_bf16_f32 v70, v72, v73
 v_mfma_f32_16x16x32_bf16 v[156:159], a[188:191], v[48:51], v[156:159]
 ds_read_b64_tr_b16 a[180:181], v11 offset:34112
 ds_read_b64_tr_b16 a[182:183], v11 offset:42560
 v_mfma_f32_16x16x32_bf16 v[148:151], a[188:191], v[44:47], v[148:151]
 s_waitcnt lgkmcnt(9)
 v_cvt_pk_bf16_f32 v71, v74, v75
 v_accvgpr_write_b32 a240, v68
 v_mfma_f32_16x16x32_bf16 v[160:163], a[160:163], v[44:47], v[160:163]
 ds_read_b64_tr_b16 a[184:185], v10 offset:34144
 ds_read_b64_tr_b16 a[186:187], v10 offset:42592
 v_mfma_f32_16x16x32_bf16 v[240:243], a[160:163], v[52:55], v[240:243]
 v_accvgpr_write_b32 a241, v69
 v_accvgpr_write_b32 a242, v70
 v_mfma_f32_16x16x32_bf16 v[168:171], a[160:163], v[48:51], v[168:171]
 v_accvgpr_write_b32 a243, v71
 v_accvgpr_read_b32 v68, a104
 v_mfma_f32_16x16x32_bf16 v[200:203], a[164:167], v[48:51], v[200:203]
 ds_read_b64_tr_b16 a[188:189], v11 offset:34144
 ds_read_b64_tr_b16 a[190:191], v11 offset:42592
 v_mfma_f32_16x16x32_bf16 v[192:195], a[164:167], v[44:47], v[192:195]
 s_waitcnt lgkmcnt(8)
 v_accvgpr_read_b32 v69, a105
 v_accvgpr_read_b32 v70, a106
 v_mfma_f32_16x16x32_bf16 v[164:167], a[168:171], v[44:47], v[164:167]
 s_waitcnt vmcnt(9)
 s_barrier
 ds_read_b64_tr_b16 a[160:161], v10 offset:50688
 ds_read_b64_tr_b16 a[162:163], v10 offset:59136
 v_mfma_f32_16x16x32_bf16 v[244:247], a[168:171], v[52:55], v[244:247]
 s_add_u32 m0, s40, 0x1a800
 v_accvgpr_read_b32 v71, a107
 v_accvgpr_read_b32 v72, a108
 v_mfma_f32_16x16x32_bf16 v[172:175], a[168:171], v[48:51], v[172:175]
 s_add_u32 s56, s44, 0x40000
 buffer_load_dwordx4 v17, s[12:15], s56 offen offset:0 lds
 v_accvgpr_read_b32 v73, a109
 v_mfma_f32_16x16x32_bf16 v[204:207], a[172:175], v[48:51], v[204:207]
 ds_read_b64_tr_b16 a[164:165], v11 offset:50688
 ds_read_b64_tr_b16 a[166:167], v11 offset:59136
 v_mfma_f32_16x16x32_bf16 v[196:199], a[172:175], v[44:47], v[196:199]
 s_waitcnt lgkmcnt(8)
 v_accvgpr_read_b32 v74, a110
 v_accvgpr_read_b32 v75, a111
 v_mfma_f32_16x16x32_bf16 v[176:179], a[176:179], v[44:47], v[176:179]
 s_add_u32 s56, s44, 0x41be0
 ds_read_b64_tr_b16 a[168:169], v10 offset:50720
 ds_read_b64_tr_b16 a[170:171], v10 offset:59168
 v_mfma_f32_16x16x32_bf16 v[248:251], a[176:179], v[52:55], v[248:251]
L_pad12:
 s_cbranch_execz L_e2_back
 buffer_load_dwordx4 v17, s[12:15], s56 offen offset:1056 lds
 v_mul_f32 v68, v36, v68
 v_mfma_f32_16x16x32_bf16 v[184:187], a[176:179], v[48:51], v[184:187]
 v_mul_f32 v69, v36, v69
 v_mul_f32 v70, v36, v70
 v_mfma_f32_16x16x32_bf16 v[216:219], a[180:183], v[48:51], v[216:219]
 ds_read_b64_tr_b16 a[172:173], v11 offset:50720
 ds_read_b64_tr_b16 a[174:175], v11 offset:59168
 v_mfma_f32_16x16x32_bf16 v[208:211], a[180:183], v[44:47], v[208:211]
 s_waitcnt lgkmcnt(8)
 v_mul_f32 v71, v36, v71
 v_mul_f32 v72, v36, v72
 v_mfma_f32_16x16x32_bf16 v[180:183], a[184:187], v[44:47], v[180:183]
 s_add_u32 s56, s44, 0x437c0
 ds_read_b64_tr_b16 a[176:177], v10 offset:50752
 ds_read_b64_tr_b16 a[178:179], v10 offset:59200
 v_mfma_f32_16x16x32_bf16 v[252:255], a[184:187], v[52:55], v[252:255]
 buffer_load_dwordx4 v17, s[12:15], s56 offen offset:2112 lds
 v_mul_f32 v73, v36, v73
 v_mfma_f32_16x16x32_bf16 v[188:191], a[184:187], v[48:51], v[188:191]
 v_mul_f32 v74, v36, v74
 v_mul_f32 v75, v36, v75
 v_mfma_f32_16x16x32_bf16 v[220:223], a[188:191], v[48:51], v[220:223]
 ds_read_b64_tr_b16 a[180:181], v11 offset:50752
 ds_read_b64_tr_b16 a[182:183], v11 offset:59200
 v_mfma_f32_16x16x32_bf16 v[212:215], a[188:191], v[44:47], v[212:215]
 s_waitcnt lgkmcnt(8)
 v_cvt_pk_bf16_f32 v68, v68, v69
 v_cvt_pk_bf16_f32 v69, v70, v71
 v_mfma_f32_16x16x32_bf16 v[96:99], a[160:163], v[56:59], v[96:99]
 s_add_u32 s56, s44, 0x453a0
 ds_read_b64_tr_b16 a[184:185], v10 offset:50784
 ds_read_b64_tr_b16 a[186:187], v10 offset:59232
 v_mfma_f32_16x16x32_bf16 v[224:227], a[160:163], v[64:67], v[224:227]
 buffer_load_dwordx4 v17, s[12:15], s56 offen offset:3168 lds
 v_cvt_pk_bf16_f32 v70, v72, v73
 v_mfma_f32_16x16x32_bf16 v[104:107], a[160:163], v[60:63], v[104:107]
 v_cvt_pk_bf16_f32 v71, v74, v75
 v_accvgpr_write_b32 a244, v68
 v_mfma_f32_16x16x32_bf16 v[136:139], a[164:167], v[60:63], v[136:139]
 s_add_u32 s44, s44, 0x80000
 ds_read_b64_tr_b16 a[188:189], v11 offset:50784
 ds_read_b64_tr_b16 a[190:191], v11 offset:59232
 v_mfma_f32_16x16x32_bf16 v[128:131], a[164:167], v[56:59], v[128:131]
 s_waitcnt lgkmcnt(8)
 v_accvgpr_write_b32 a245, v69
 v_accvgpr_write_b32 a246, v70
 v_mfma_f32_16x16x32_bf16 v[100:103], a[168:171], v[56:59], v[100:103]
 s_sub_u32 s56, s44, 0x380000
 ds_read_b64_tr_b16 a[160:161], v10 offset:50944
 ds_read_b64_tr_b16 a[162:163], v10 offset:59392
 v_mfma_f32_16x16x32_bf16 v[228:231], a[168:171], v[64:67], v[228:231]
 s_min_u32 s44, s44, s56
 v_accvgpr_write_b32 a247, v71
 v_accvgpr_read_b32 v68, a112
 v_mfma_f32_16x16x32_bf16 v[108:111], a[168:171], v[60:63], v[108:111]
 s_add_u32 s44, s44, 0x1000
 v_accvgpr_read_b32 v69, a113
 v_accvgpr_read_b32 v70, a114
 v_mfma_f32_16x16x32_bf16 v[140:143], a[172:175], v[60:63], v[140:143]
 s_xor_b32 s56, s42, 0xc000
 ds_read_b64_tr_b16 a[164:165], v11 offset:50944
 ds_read_b64_tr_b16 a[166:167], v11 offset:59392
 v_mfma_f32_16x16x32_bf16 v[132:135], a[172:175], v[56:59], v[132:135]
 s_waitcnt lgkmcnt(8)
 v_accvgpr_read_b32 v71, a115
 v_accvgpr_read_b32 v72, a116
 v_mfma_f32_16x16x32_bf16 v[112:115], a[176:179], v[56:59], v[112:115]
 s_add_u32 m0, s40, 0xc600
 ds_read_b64_tr_b16 a[168:169], v10 offset:50976
 ds_read_b64_tr_b16 a[170:171], v10 offset:59424
 v_mfma_f32_16x16x32_bf16 v[232:235], a[176:179], v[64:67], v[232:235]
 buffer_load_dwordx4 v16, s[16:19], s56 offen offset:0 nt lds
 v_accvgpr_read_b32 v73, a117
 v_mfma_f32_16x16x32_bf16 v[120:123], a[176:179], v[60:63], v[120:123]
 s_add_u32 m0, s40, 0xc820
 v_accvgpr_read_b32 v74, a118
 v_accvgpr_read_b32 v75, a119
 v_mfma_f32_16x16x32_bf16 v[152:155], a[180:183], v[60:63], v[152:155]
 ds_read_b64_tr_b16 a[172:173], v11 offset:50976
 ds_read_b64_tr_b16 a[174:175], v11 offset:59424
 v_mfma_f32_16x16x32_bf16 v[144:147], a[180:183], v[56:59], v[144:147]
 s_waitcnt lgkmcnt(8)
 buffer_load_dwordx4 v16, s[16:19], s56 offen offset:512 nt lds
 v_mul_f32 v68, v35, v68
 v_mfma_f32_16x16x32_bf16 v[116:119], a[184:187], v[56:59], v[116:119]
 s_add_u32 m0, s40, 0xca40
 ds_read_b64_tr_b16 a[176:177], v10 offset:51008
 ds_read_b64_tr_b16 a[178:179], v10 offset:59456
 v_mfma_f32_16x16x32_bf16 v[236:239], a[184:187], v[64:67], v[236:239]
 buffer_load_dwordx4 v16, s[16:19], s56 offen offset:1024 nt lds
 v_mul_f32 v69, v35, v69
 v_mfma_f32_16x16x32_bf16 v[124:127], a[184:187], v[60:63], v[124:127]
 s_add_u32 m0, s40, 0xcc60
 v_mul_f32 v70, v35, v70
 v_mul_f32 v71, v35, v71
 v_mfma_f32_16x16x32_bf16 v[156:159], a[188:191], v[60:63], v[156:159]
 ds_read_b64_tr_b16 a[180:181], v11 offset:51008
 ds_read_b64_tr_b16 a[182:183], v11 offset:59456
 v_mfma_f32_16x16x32_bf16 v[148:151], a[188:191], v[56:59], v[148:151]
 s_waitcnt lgkmcnt(8)
 buffer_load_dwordx4 v16, s[16:19], s56 offen offset:1536 nt lds
 v_mul_f32 v72, v35, v72
 v_mfma_f32_16x16x32_bf16 v[160:163], a[160:163], v[56:59], v[160:163]
 ds_read_b64_tr_b16 a[184:185], v10 offset:51040
 ds_read_b64_tr_b16 a[186:187], v10 offset:59488
 v_mfma_f32_16x16x32_bf16 v[240:243], a[160:163], v[64:67], v[240:243]
 v_mul_f32 v73, v35, v73
 v_mul_f32 v74, v35, v74
 v_mfma_f32_16x16x32_bf16 v[168:171], a[160:163], v[60:63], v[168:171]
 v_mul_f32 v75, v35, v75
 v_cvt_pk_bf16_f32 v68, v68, v69
 v_mfma_f32_16x16x32_bf16 v[200:203], a[164:167], v[60:63], v[200:203]
 ds_read_b64_tr_b16 a[188:189], v11 offset:51040
 ds_read_b64_tr_b16 a[190:191], v11 offset:59488
 v_mfma_f32_16x16x32_bf16 v[192:195], a[164:167], v[56:59], v[192:195]
 s_waitcnt lgkmcnt(8)
 v_cvt_pk_bf16_f32 v69, v70, v71
 v_cvt_pk_bf16_f32 v70, v72, v73
 v_mfma_f32_16x16x32_bf16 v[164:167], a[168:171], v[56:59], v[164:167]
 s_waitcnt vmcnt(8)
 s_barrier
 ds_read_b64_tr_b16 a[160:161], v10 offset:0
 ds_read_b64_tr_b16 a[162:163], v10 offset:8448
 v_mfma_f32_16x16x32_bf16 v[244:247], a[168:171], v[64:67], v[244:247]
 s_xor_b32 s56, s43, 0x8000
 ds_read_b128 v[44:47], v12 offset:20480
 v_cvt_pk_bf16_f32 v71, v74, v75
 v_mfma_f32_16x16x32_bf16 v[172:175], a[168:171], v[60:63], v[172:175]
 s_add_u32 m0, s40, 0x1ea00
 ds_read_b128 v[48:51], v12 offset:22528
 v_accvgpr_write_b32 a248, v68
 v_mfma_f32_16x16x32_bf16 v[204:207], a[172:175], v[60:63], v[204:207]
 ds_read_b64_tr_b16 a[164:165], v11 offset:0
 ds_read_b64_tr_b16 a[166:167], v11 offset:8448
 v_mfma_f32_16x16x32_bf16 v[196:199], a[172:175], v[56:59], v[196:199]
 s_waitcnt lgkmcnt(10)
 ds_read_b128 v[52:55], v14 offset:20480
 buffer_load_dwordx4 v16, s[20:23], s56 offen offset:0 nt lds
 v_mfma_f32_16x16x32_bf16 v[176:179], a[176:179], v[56:59], v[176:179]
 ds_read_b64_tr_b16 a[168:169], v10 offset:32
 ds_read_b64_tr_b16 a[170:171], v10 offset:8480
 v_mfma_f32_16x16x32_bf16 v[248:251], a[176:179], v[64:67], v[248:251]
 v_accvgpr_write_b32 a249, v69
 v_accvgpr_write_b32 a250, v70
 v_mfma_f32_16x16x32_bf16 v[184:187], a[176:179], v[60:63], v[184:187]
 v_accvgpr_write_b32 a251, v71
 v_accvgpr_read_b32 v68, a120
 v_mfma_f32_16x16x32_bf16 v[216:219], a[180:183], v[60:63], v[216:219]
 ds_read_b64_tr_b16 a[172:173], v11 offset:32
 ds_read_b64_tr_b16 a[174:175], v11 offset:8480
 v_mfma_f32_16x16x32_bf16 v[208:211], a[180:183], v[56:59], v[208:211]
 s_waitcnt lgkmcnt(11)
 v_accvgpr_read_b32 v69, a121
 v_accvgpr_read_b32 v70, a122
 v_mfma_f32_16x16x32_bf16 v[180:183], a[184:187], v[56:59], v[180:183]
 s_add_u32 m0, s40, 0x1ec20
 ds_read_b64_tr_b16 a[176:177], v10 offset:64
 ds_read_b64_tr_b16 a[178:179], v10 offset:8512
 v_mfma_f32_16x16x32_bf16 v[252:255], a[184:187], v[64:67], v[252:255]
 buffer_load_dwordx4 v16, s[20:23], s56 offen offset:512 nt lds
 v_accvgpr_read_b32 v71, a123
 v_mfma_f32_16x16x32_bf16 v[188:191], a[184:187], v[60:63], v[188:191]
 v_accvgpr_read_b32 v72, a124
 v_accvgpr_read_b32 v73, a125
 v_mfma_f32_16x16x32_bf16 v[220:223], a[188:191], v[60:63], v[220:223]
 ds_read_b64_tr_b16 a[180:181], v11 offset:64
 ds_read_b64_tr_b16 a[182:183], v11 offset:8512
 v_mfma_f32_16x16x32_bf16 v[212:215], a[188:191], v[56:59], v[212:215]
 s_waitcnt lgkmcnt(9)
 v_accvgpr_read_b32 v74, a126
 v_accvgpr_read_b32 v75, a127
 v_mfma_f32_16x16x32_bf16 v[96:99], a[160:163], v[44:47], v[96:99]
 ds_read_b64_tr_b16 a[184:185], v10 offset:96
 ds_read_b64_tr_b16 a[186:187], v10 offset:8544
 s_waitcnt lgkmcnt(10)
 v_mfma_f32_16x16x32_bf16 v[224:227], a[160:163], v[52:55], v[224:227]
 ds_read_b128 v[56:59], v13 offset:20480
 v_mul_f32 v68, v36, v68
 v_mfma_f32_16x16x32_bf16 v[104:107], a[160:163], v[48:51], v[104:107]
 v_mul_f32 v69, v36, v69
 v_mul_f32 v70, v36, v70
 v_mfma_f32_16x16x32_bf16 v[136:139], a[164:167], v[48:51], v[136:139]
 s_add_u32 m0, s40, 0x1ee40
 ds_read_b64_tr_b16 a[188:189], v11 offset:96
 ds_read_b64_tr_b16 a[190:191], v11 offset:8544
 v_mfma_f32_16x16x32_bf16 v[128:131], a[164:167], v[44:47], v[128:131]
 s_waitcnt lgkmcnt(9)
 buffer_load_dwordx4 v16, s[20:23], s56 offen offset:1024 nt lds
 v_mul_f32 v71, v36, v71
 v_mfma_f32_16x16x32_bf16 v[100:103], a[168:171], v[44:47], v[100:103]
 ds_read_b64_tr_b16 a[160:161], v10 offset:256
 ds_read_b64_tr_b16 a[162:163], v10 offset:8704
 v_mfma_f32_16x16x32_bf16 v[228:231], a[168:171], v[52:55], v[228:231]
 ds_read_b128 v[60:63], v13 offset:22528
 v_mul_f32 v72, v36, v72
 v_mfma_f32_16x16x32_bf16 v[108:111], a[168:171], v[48:51], v[108:111]
 v_mul_f32 v73, v36, v73
 v_mul_f32 v74, v36, v74
 v_mfma_f32_16x16x32_bf16 v[140:143], a[172:175], v[48:51], v[140:143]
 ds_read_b64_tr_b16 a[164:165], v11 offset:256
 ds_read_b64_tr_b16 a[166:167], v11 offset:8704
 v_mfma_f32_16x16x32_bf16 v[132:135], a[172:175], v[44:47], v[132:135]
 s_waitcnt lgkmcnt(10)
 v_mul_f32 v75, v36, v75
 v_cvt_pk_bf16_f32 v68, v68, v69
 v_mfma_f32_16x16x32_bf16 v[112:115], a[176:179], v[44:47], v[112:115]
 ds_read_b64_tr_b16 a[168:169], v10 offset:288
 ds_read_b64_tr_b16 a[170:171], v10 offset:8736
 v_mfma_f32_16x16x32_bf16 v[232:235], a[176:179], v[52:55], v[232:235]
 ds_read_b128 v[64:67], v15 offset:20480
 v_cvt_pk_bf16_f32 v69, v70, v71
 v_mfma_f32_16x16x32_bf16 v[120:123], a[176:179], v[48:51], v[120:123]
 s_add_u32 m0, s40, 0x1f060
 v_cvt_pk_bf16_f32 v70, v72, v73
 v_cvt_pk_bf16_f32 v71, v74, v75
 v_mfma_f32_16x16x32_bf16 v[152:155], a[180:183], v[48:51], v[152:155]
 ds_read_b64_tr_b16 a[172:173], v11 offset:288
 ds_read_b64_tr_b16 a[174:175], v11 offset:8736
 v_mfma_f32_16x16x32_bf16 v[144:147], a[180:183], v[44:47], v[144:147]
 s_waitcnt lgkmcnt(10)
 buffer_load_dwordx4 v16, s[20:23], s56 offen offset:1536 nt lds
 v_accvgpr_write_b32 a252, v68
 v_mfma_f32_16x16x32_bf16 v[116:119], a[184:187], v[44:47], v[116:119]
 ds_read_b64_tr_b16 a[176:177], v10 offset:320
 ds_read_b64_tr_b16 a[178:179], v10 offset:8768
 v_mfma_f32_16x16x32_bf16 v[236:239], a[184:187], v[52:55], v[236:239]
 v_accvgpr_write_b32 a253, v69
 v_accvgpr_write_b32 a254, v70
 v_mfma_f32_16x16x32_bf16 v[124:127], a[184:187], v[48:51], v[124:127]
 v_accvgpr_write_b32 a255, v71
 v_mfma_f32_16x16x32_bf16 v[156:159], a[188:191], v[48:51], v[156:159]
 ds_read_b64_tr_b16 a[180:181], v11 offset:320
 ds_read_b64_tr_b16 a[182:183], v11 offset:8768
 v_mfma_f32_16x16x32_bf16 v[148:151], a[188:191], v[44:47], v[148:151]
 s_waitcnt lgkmcnt(9)
 v_mfma_f32_16x16x32_bf16 v[160:163], a[160:163], v[44:47], v[160:163]
 ds_read_b64_tr_b16 a[184:185], v10 offset:352
 ds_read_b64_tr_b16 a[186:187], v10 offset:8800
 v_mfma_f32_16x16x32_bf16 v[240:243], a[160:163], v[52:55], v[240:243]
 v_mfma_f32_16x16x32_bf16 v[168:171], a[160:163], v[48:51], v[168:171]
 v_mfma_f32_16x16x32_bf16 v[200:203], a[164:167], v[48:51], v[200:203]
 ds_read_b64_tr_b16 a[188:189], v11 offset:352
 ds_read_b64_tr_b16 a[190:191], v11 offset:8800
 v_mfma_f32_16x16x32_bf16 v[192:195], a[164:167], v[44:47], v[192:195]
 s_waitcnt lgkmcnt(8)
 v_mfma_f32_16x16x32_bf16 v[164:167], a[168:171], v[44:47], v[164:167]
 s_waitcnt vmcnt(8)
 s_barrier
 ds_read_b64_tr_b16 a[160:161], v10 offset:16896
 ds_read_b64_tr_b16 a[162:163], v10 offset:25344
 v_mfma_f32_16x16x32_bf16 v[244:247], a[168:171], v[52:55], v[244:247]
 s_xor_b32 s56, s43, 0xc000
 v_mfma_f32_16x16x32_bf16 v[172:175], a[168:171], v[48:51], v[172:175]
 s_add_u32 m0, s40, 0x22c00
 v_mfma_f32_16x16x32_bf16 v[204:207], a[172:175], v[48:51], v[204:207]
 ds_read_b64_tr_b16 a[164:165], v10 offset:16928
 ds_read_b64_tr_b16 a[166:167], v10 offset:25376
 v_mfma_f32_16x16x32_bf16 v[196:199], a[172:175], v[44:47], v[196:199]
 s_waitcnt lgkmcnt(8)
 buffer_load_dwordx4 v16, s[20:23], s56 offen offset:0 nt lds
 v_mfma_f32_16x16x32_bf16 v[176:179], a[176:179], v[44:47], v[176:179]
 ds_read_b64_tr_b16 a[168:169], v10 offset:16960
 ds_read_b64_tr_b16 a[170:171], v10 offset:25408
 v_mfma_f32_16x16x32_bf16 v[248:251], a[176:179], v[52:55], v[248:251]
 v_mfma_f32_16x16x32_bf16 v[184:187], a[176:179], v[48:51], v[184:187]
 v_mfma_f32_16x16x32_bf16 v[216:219], a[180:183], v[48:51], v[216:219]
 ds_read_b64_tr_b16 a[172:173], v10 offset:16992
 ds_read_b64_tr_b16 a[174:175], v10 offset:25440
 v_mfma_f32_16x16x32_bf16 v[208:211], a[180:183], v[44:47], v[208:211]
 s_waitcnt lgkmcnt(8)
 v_mfma_f32_16x16x32_bf16 v[180:183], a[184:187], v[44:47], v[180:183]
 s_add_u32 m0, s40, 0x22e20
 ds_read_b64_tr_b16 a[176:177], v10 offset:17152
 ds_read_b64_tr_b16 a[178:179], v10 offset:25600
 v_mfma_f32_16x16x32_bf16 v[252:255], a[184:187], v[52:55], v[252:255]
 buffer_load_dwordx4 v16, s[20:23], s56 offen offset:512 nt lds
 v_mfma_f32_16x16x32_bf16 v[188:191], a[184:187], v[48:51], v[188:191]
 v_mfma_f32_16x16x32_bf16 v[220:223], a[188:191], v[48:51], v[220:223]
 ds_read_b64_tr_b16 a[180:181], v10 offset:17184
 ds_read_b64_tr_b16 a[182:183], v10 offset:25632
 v_mfma_f32_16x16x32_bf16 v[212:215], a[188:191], v[44:47], v[212:215]
 s_waitcnt lgkmcnt(8)
 v_mfma_f32_16x16x32_bf16 v[96:99], a[160:163], v[56:59], v[96:99]
 ds_read_b64_tr_b16 a[184:185], v10 offset:17216
 ds_read_b64_tr_b16 a[186:187], v10 offset:25664
 v_mfma_f32_16x16x32_bf16 v[224:227], a[160:163], v[64:67], v[224:227]
 v_mfma_f32_16x16x32_bf16 v[104:107], a[160:163], v[60:63], v[104:107]
 v_mfma_f32_16x16x32_bf16 v[108:111], a[164:167], v[60:63], v[108:111]
 ds_read_b64_tr_b16 a[188:189], v10 offset:17248
 ds_read_b64_tr_b16 a[190:191], v10 offset:25696
 v_mfma_f32_16x16x32_bf16 v[228:231], a[164:167], v[64:67], v[228:231]
 v_mfma_f32_16x16x32_bf16 v[100:103], a[164:167], v[56:59], v[100:103]
 s_waitcnt lgkmcnt(8)
 v_mfma_f32_16x16x32_bf16 v[112:115], a[168:171], v[56:59], v[112:115]
 s_add_u32 m0, s40, 0x23040
 ds_read_b64_tr_b16 a[160:161], v11 offset:16896
 ds_read_b64_tr_b16 a[162:163], v11 offset:25344
 v_mfma_f32_16x16x32_bf16 v[232:235], a[168:171], v[64:67], v[232:235]
 buffer_load_dwordx4 v16, s[20:23], s56 offen offset:1024 nt lds
 v_mul_f32 v224, s6, v224
 v_mfma_f32_16x16x32_bf16 v[120:123], a[168:171], v[60:63], v[120:123]
 v_mul_f32 v225, s6, v225
 v_mul_f32 v226, s6, v226
 v_mfma_f32_16x16x32_bf16 v[124:127], a[172:175], v[60:63], v[124:127]
 ds_read_b64_tr_b16 a[164:165], v11 offset:16928
 ds_read_b64_tr_b16 a[166:167], v11 offset:25376
 v_mfma_f32_16x16x32_bf16 v[236:239], a[172:175], v[64:67], v[236:239]
 v_mul_f32 v227, s6, v227
 v_mul_f32 v228, s6, v228
 v_mfma_f32_16x16x32_bf16 v[116:119], a[172:175], v[56:59], v[116:119]
 s_waitcnt lgkmcnt(8)
 v_mul_f32 v229, s6, v229
 v_mul_f32 v230, s6, v230
 v_mfma_f32_16x16x32_bf16 v[160:163], a[176:179], v[56:59], v[160:163]
 ds_read_b64_tr_b16 a[168:169], v11 offset:16960
 ds_read_b64_tr_b16 a[170:171], v11 offset:25408
 v_mfma_f32_16x16x32_bf16 v[240:243], a[176:179], v[64:67], v[240:243]
 v_mul_f32 v231, s6, v231
 v_cvt_pk_bf16_f32 v224, v224, v225
 v_mfma_f32_16x16x32_bf16 v[168:171], a[176:179], v[60:63], v[168:171]
 s_add_u32 m0, s40, 0x23260
 v_cvt_pk_bf16_f32 v225, v226, v227
 v_cvt_pk_bf16_f32 v226, v228, v229
 v_mfma_f32_16x16x32_bf16 v[172:175], a[180:183], v[60:63], v[172:175]
 ds_read_b64_tr_b16 a[172:173], v11 offset:16992
 ds_read_b64_tr_b16 a[174:175], v11 offset:25440
 v_mfma_f32_16x16x32_bf16 v[244:247], a[180:183], v[64:67], v[244:247]
 buffer_load_dwordx4 v16, s[20:23], s56 offen offset:1536 nt lds
 v_cvt_pk_bf16_f32 v227, v230, v231
 v_mfma_f32_16x16x32_bf16 v[164:167], a[180:183], v[56:59], v[164:167]
 s_waitcnt lgkmcnt(8)
 v_permlane32_swap_b32 v224, v226
 v_mfma_f32_16x16x32_bf16 v[176:179], a[184:187], v[56:59], v[176:179]
 ds_read_b64_tr_b16 a[176:177], v11 offset:17152
 ds_read_b64_tr_b16 a[178:179], v11 offset:25600
 v_mfma_f32_16x16x32_bf16 v[248:251], a[184:187], v[64:67], v[248:251]
 v_permlane32_swap_b32 v225, v227
 v_mfma_f32_16x16x32_bf16 v[184:187], a[184:187], v[60:63], v[184:187]
 v_mul_f32 v232, s6, v232
 v_mul_f32 v233, s6, v233
 v_mfma_f32_16x16x32_bf16 v[188:191], a[188:191], v[60:63], v[188:191]
 ds_read_b64_tr_b16 a[180:181], v11 offset:17184
 ds_read_b64_tr_b16 a[182:183], v11 offset:25632
 v_mfma_f32_16x16x32_bf16 v[252:255], a[188:191], v[64:67], v[252:255]
 v_mul_f32 v234, s6, v234
 v_mul_f32 v235, s6, v235
 v_mfma_f32_16x16x32_bf16 v[180:183], a[188:191], v[56:59], v[180:183]
 s_waitcnt lgkmcnt(8)
 v_mul_f32 v236, s6, v236
 v_mul_f32 v237, s6, v237
 v_mfma_f32_16x16x32_bf16 v[128:131], a[160:163], v[56:59], v[128:131]
 ds_read_b64_tr_b16 a[184:185], v11 offset:17216
 ds_read_b64_tr_b16 a[186:187], v11 offset:25664
 v_mfma_f32_16x16x32_bf16 v[136:139], a[160:163], v[60:63], v[136:139]
 v_mul_f32 v238, s6, v238
 v_mul_f32 v239, s6, v239
 v_mfma_f32_16x16x32_bf16 v[140:143], a[164:167], v[60:63], v[140:143]
 ds_read_b64_tr_b16 a[188:189], v11 offset:17248
 ds_read_b64_tr_b16 a[190:191], v11 offset:25696
 v_mfma_f32_16x16x32_bf16 v[132:135], a[164:167], v[56:59], v[132:135]
 s_waitcnt lgkmcnt(8)
 v_cvt_pk_bf16_f32 v232, v232, v233
 v_cvt_pk_bf16_f32 v233, v234, v235
 v_mfma_f32_16x16x32_bf16 v[144:147], a[168:171], v[56:59], v[144:147]
 s_barrier
 ds_read_b128 a[160:163], v6 offset:0
 v_mfma_f32_16x16x32_bf16 v[152:155], a[168:171], v[60:63], v[152:155]
 s_xor_b32 s56, s43, 0
 v_cvt_pk_bf16_f32 v234, v236, v237
 v_cvt_pk_bf16_f32 v235, v238, v239
 v_mfma_f32_16x16x32_bf16 v[156:159], a[172:175], v[60:63], v[156:159]
 s_add_u32 m0, s40, 0x16600
 ds_read_b128 a[164:167], v6 offset:64
 v_mfma_f32_16x16x32_bf16 v[148:151], a[172:175], v[56:59], v[148:151]
 s_waitcnt lgkmcnt(6)
 v_permlane32_swap_b32 v232, v234
 v_mfma_f32_16x16x32_bf16 v[192:195], a[176:179], v[56:59], v[192:195]
 ds_read_b128 a[168:171], v8 offset:0
 buffer_load_dwordx4 v16, s[20:23], s56 offen offset:0 nt lds
 v_mfma_f32_16x16x32_bf16 v[200:203], a[176:179], v[60:63], v[200:203]
 v_permlane32_swap_b32 v233, v235
 v_mfma_f32_16x16x32_bf16 v[204:207], a[180:183], v[60:63], v[204:207]
 ds_read_b128 a[172:175], v8 offset:64
 v_mul_f32 v240, s6, v240
 v_mfma_f32_16x16x32_bf16 v[196:199], a[180:183], v[56:59], v[196:199]
 s_waitcnt lgkmcnt(4)
 v_mul_f32 v241, s6, v241
 v_mul_f32 v242, s6, v242
 v_mfma_f32_16x16x32_bf16 v[208:211], a[184:187], v[56:59], v[208:211]
 ds_read_b128 a[176:179], v7 offset:0
 v_mul_f32 v243, s6, v243
 v_mfma_f32_16x16x32_bf16 v[216:219], a[184:187], v[60:63], v[216:219]
 s_add_u32 m0, s40, 0x16820
 v_mul_f32 v244, s6, v244
 v_mul_f32 v245, s6, v245
 v_mfma_f32_16x16x32_bf16 v[220:223], a[188:191], v[60:63], v[220:223]
 ds_read_b128 a[180:183], v7 offset:64
 v_mul_f32 v246, s6, v246
 v_mfma_f32_16x16x32_bf16 v[212:215], a[188:191], v[56:59], v[212:215]
 s_waitcnt lgkmcnt(4)
 v_mul_f32 v247, s6, v247
 v_cvt_pk_bf16_f32 v240, v240, v241
 v_cvt_pk_bf16_f32 v241, v242, v243
 v_cvt_pk_bf16_f32 v242, v244, v245
 v_cvt_pk_bf16_f32 v243, v246, v247
 s_nop 0
 v_permlane32_swap_b32 v240, v242
 v_permlane32_swap_b32 v241, v243
 v_mul_f32 v248, s6, v248
 v_mul_f32 v249, s6, v249
 v_mul_f32 v250, s6, v250
 v_mul_f32 v251, s6, v251
 v_mul_f32 v252, s6, v252
 v_mul_f32 v253, s6, v253
 v_mul_f32 v254, s6, v254
 v_mul_f32 v255, s6, v255
 v_cvt_pk_bf16_f32 v248, v248, v249
 v_cvt_pk_bf16_f32 v249, v250, v251
 v_cvt_pk_bf16_f32 v250, v252, v253
 v_cvt_pk_bf16_f32 v251, v254, v255
 s_nop 0
 v_permlane32_swap_b32 v248, v250
 v_permlane32_swap_b32 v249, v251
 ds_write_b128 v19, v[224:227] offset:0
 v_pk_mul_f32 v[96:97], v[96:97], s[6:7]
 v_pk_mul_f32 v[98:99], v[98:99], s[6:7]
 v_pk_mul_f32 v[100:101], v[100:101], s[6:7]
 v_pk_mul_f32 v[102:103], v[102:103], s[6:7]
 v_cvt_pk_bf16_f32 v96, v96, v97
 v_cvt_pk_bf16_f32 v97, v98, v99
 v_cvt_pk_bf16_f32 v98, v100, v101
 v_cvt_pk_bf16_f32 v99, v102, v103
 ds_write_b128 v19, v[232:235] offset:1024
 v_pk_mul_f32 v[104:105], v[104:105], s[6:7]
 v_pk_mul_f32 v[106:107], v[106:107], s[6:7]
 v_pk_mul_f32 v[108:109], v[108:109], s[6:7]
 v_pk_mul_f32 v[110:111], v[110:111], s[6:7]
 v_cvt_pk_bf16_f32 v104, v104, v105
 v_cvt_pk_bf16_f32 v105, v106, v107
 v_cvt_pk_bf16_f32 v106, v108, v109
 v_cvt_pk_bf16_f32 v107, v110, v111
 v_permlane32_swap_b32 v96, v98
 v_permlane32_swap_b32 v97, v99
 ds_write_b128 v19, v[240:243] offset:2048
 v_pk_mul_f32 v[112:113], v[112:113], s[6:7]
 v_pk_mul_f32 v[114:115], v[114:115], s[6:7]
 v_pk_mul_f32 v[116:117], v[116:117], s[6:7]
 v_pk_mul_f32 v[118:119], v[118:119], s[6:7]
 v_cvt_pk_bf16_f32 v112, v112, v113
 v_cvt_pk_bf16_f32 v113, v114, v115
 v_cvt_pk_bf16_f32 v114, v116, v117
 v_cvt_pk_bf16_f32 v115, v118, v119
 v_permlane32_swap_b32 v104, v106
 v_permlane32_swap_b32 v105, v107
 ds_write_b128 v19, v[248:251] offset:3072
 v_pk_mul_f32 v[120:121], v[120:121], s[6:7]
 v_pk_mul_f32 v[122:123], v[122:123], s[6:7]
 v_pk_mul_f32 v[124:125], v[124:125], s[6:7]
 v_pk_mul_f32 v[126:127], v[126:127], s[6:7]
 v_cvt_pk_bf16_f32 v120, v120, v121
 v_cvt_pk_bf16_f32 v121, v122, v123
 v_cvt_pk_bf16_f32 v122, v124, v125
 v_cvt_pk_bf16_f32 v123, v126, v127
 v_permlane32_swap_b32 v112, v114
 v_permlane32_swap_b32 v113, v115
 v_pk_mul_f32 v[160:161], v[160:161], s[6:7]
 v_pk_mul_f32 v[162:163], v[162:163], s[6:7]
 v_pk_mul_f32 v[164:165], v[164:165], s[6:7]
 v_pk_mul_f32 v[166:167], v[166:167], s[6:7]
 v_cvt_pk_bf16_f32 v160, v160, v161
 v_cvt_pk_bf16_f32 v161, v162, v163
 v_cvt_pk_bf16_f32 v162, v164, v165
 v_cvt_pk_bf16_f32 v163, v166, v167
 v_permlane32_swap_b32 v120, v122
 v_permlane32_swap_b32 v121, v123
 v_pk_mul_f32 v[168:169], v[168:169], s[6:7]
 v_pk_mul_f32 v[170:171], v[170:171], s[6:7]
 v_pk_mul_f32 v[172:173], v[172:173], s[6:7]
 v_pk_mul_f32 v[174:175], v[174:175], s[6:7]
 v_cvt_pk_bf16_f32 v168, v168, v169
 v_cvt_pk_bf16_f32 v169, v170, v171
 v_cvt_pk_bf16_f32 v170, v172, v173
 v_cvt_pk_bf16_f32 v171, v174, v175
 v_permlane32_swap_b32 v160, v162
 v_permlane32_swap_b32 v161, v163
 v_pk_mul_f32 v[176:177], v[176:177], s[6:7]
 v_pk_mul_f32 v[178:179], v[178:179], s[6:7]
 v_pk_mul_f32 v[180:181], v[180:181], s[6:7]
 v_pk_mul_f32 v[182:183], v[182:183], s[6:7]
 v_cvt_pk_bf16_f32 v176, v176, v177
 v_cvt_pk_bf16_f32 v177, v178, v179
 v_cvt_pk_bf16_f32 v178, v180, v181
 v_cvt_pk_bf16_f32 v179, v182, v183
 v_permlane32_swap_b32 v168, v170
 v_permlane32_swap_b32 v169, v171
 s_waitcnt lgkmcnt(0)
 s_barrier
 ds_read_b128 v[228:231], v20 offset:0
 ds_read_b128 v[236:239], v20 offset:1024
 ds_read_b128 v[244:247], v20 offset:2048
 ds_read_b128 v[252:255], v20 offset:3072
 v_pk_mul_f32 v[184:185], v[184:185], s[6:7]
 v_pk_mul_f32 v[186:187], v[186:187], s[6:7]
 v_pk_mul_f32 v[188:189], v[188:189], s[6:7]
 v_pk_mul_f32 v[190:191], v[190:191], s[6:7]
 v_cvt_pk_bf16_f32 v184, v184, v185
 v_cvt_pk_bf16_f32 v185, v186, v187
 v_cvt_pk_bf16_f32 v186, v188, v189
 v_cvt_pk_bf16_f32 v187, v190, v191
 v_permlane32_swap_b32 v176, v178
 v_permlane32_swap_b32 v177, v179
 v_pk_mul_f32 v[128:129], v[128:129], s[6:7]
 v_pk_mul_f32 v[130:131], v[130:131], s[6:7]
 v_pk_mul_f32 v[132:133], v[132:133], s[6:7]
 v_pk_mul_f32 v[134:135], v[134:135], s[6:7]
 v_cvt_pk_bf16_f32 v128, v128, v129
 v_cvt_pk_bf16_f32 v129, v130, v131
 v_cvt_pk_bf16_f32 v130, v132, v133
 v_cvt_pk_bf16_f32 v131, v134, v135
 v_permlane32_swap_b32 v184, v186
 v_permlane32_swap_b32 v185, v187
 v_pk_mul_f32 v[136:137], v[136:137], s[6:7]
 v_pk_mul_f32 v[138:139], v[138:139], s[6:7]
 v_pk_mul_f32 v[140:141], v[140:141], s[6:7]
 v_pk_mul_f32 v[142:143], v[142:143], s[6:7]
 v_cvt_pk_bf16_f32 v136, v136, v137
 v_cvt_pk_bf16_f32 v137, v138, v139
 v_cvt_pk_bf16_f32 v138, v140, v141
 v_cvt_pk_bf16_f32 v139, v142, v143
 v_permlane32_swap_b32 v128, v130
 v_permlane32_swap_b32 v129, v131
 v_pk_mul_f32 v[144:145], v[144:145], s[6:7]
 v_pk_mul_f32 v[146:147], v[146:147], s[6:7]
 v_pk_mul_f32 v[148:149], v[148:149], s[6:7]
 v_pk_mul_f32 v[150:151], v[150:151], s[6:7]
 v_cvt_pk_bf16_f32 v144, v144, v145
 v_cvt_pk_bf16_f32 v145, v146, v147
 v_cvt_pk_bf16_f32 v146, v148, v149
 v_cvt_pk_bf16_f32 v147, v150, v151
 v_permlane32_swap_b32 v136, v138
 v_permlane32_swap_b32 v137, v139
 v_pk_mul_f32 v[152:153], v[152:153], s[6:7]
 v_pk_mul_f32 v[154:155], v[154:155], s[6:7]
 v_pk_mul_f32 v[156:157], v[156:157], s[6:7]
 v_pk_mul_f32 v[158:159], v[158:159], s[6:7]
 v_cvt_pk_bf16_f32 v152, v152, v153
 v_cvt_pk_bf16_f32 v153, v154, v155
 v_cvt_pk_bf16_f32 v154, v156, v157
 v_cvt_pk_bf16_f32 v155, v158, v159
 v_permlane32_swap_b32 v144, v146
 v_permlane32_swap_b32 v145, v147
 v_permlane32_swap_b32 v152, v154
 v_permlane32_swap_b32 v153, v155
 v_mfma_f32_16x16x32_bf16 v[56:59], a[160:163], v[96:99], 0
 ds_read_b128 a[184:187], v9 offset:0
 buffer_load_dwordx4 v16, s[20:23], s56 offen offset:512 nt lds
 v_mfma_f32_16x16x32_bf16 v[56:59], a[164:167], v[112:115], v[56:59]
 v_mul_f32 v192, s6, v192
 v_mul_f32 v193, s6, v193
 v_mfma_f32_16x16x32_bf16 v[64:67], a[164:167], v[120:123], 0
 v_mul_f32 v194, s6, v194
 v_mul_f32 v195, s6, v195
 v_mfma_f32_16x16x32_bf16 v[64:67], a[160:163], v[104:107], v[64:67]
 ds_read_b128 a[188:191], v9 offset:64
 v_mul_f32 v196, s6, v196
 v_mfma_f32_16x16x32_bf16 v[72:75], a[160:163], v[224:227], 0
 v_mul_f32 v197, s6, v197
 v_mul_f32 v198, s6, v198
 v_mfma_f32_16x16x32_bf16 v[72:75], a[164:167], v[232:235], v[72:75]
 v_mul_f32 v199, s6, v199
 v_cvt_pk_bf16_f32 v192, v192, v193
 v_mfma_f32_16x16x32_bf16 v[60:63], a[168:171], v[96:99], 0
 s_add_u32 m0, s40, 0x16a40
 ds_read_b128 a[160:163], v6 offset:256
 v_cvt_pk_bf16_f32 v193, v194, v195
 v_mfma_f32_16x16x32_bf16 v[60:63], a[172:175], v[112:115], v[60:63]
L_pad13:
 s_cbranch_execz L_e2_back
 buffer_load_dwordx4 v16, s[20:23], s56 offen offset:1024 nt lds
 v_cvt_pk_bf16_f32 v194, v196, v197
 v_mfma_f32_16x16x32_bf16 v[68:71], a[172:175], v[120:123], 0
 ds_read_b128 a[164:167], v6 offset:320
 v_cvt_pk_bf16_f32 v195, v198, v199
 v_mfma_f32_16x16x32_bf16 v[68:71], a[168:171], v[104:107], v[68:71]
 v_permlane32_swap_b32 v192, v194
 v_mfma_f32_16x16x32_bf16 v[56:59], a[176:179], v[128:131], v[56:59]
 ds_read_b128 a[168:171], v8 offset:256
 v_mfma_f32_16x16x32_bf16 v[56:59], a[180:183], v[144:147], v[56:59]
 v_permlane32_swap_b32 v193, v195
 v_mfma_f32_16x16x32_bf16 v[64:67], a[180:183], v[152:155], v[64:67]
 v_mul_f32 v200, s6, v200
 v_mul_f32 v201, s6, v201
 v_mfma_f32_16x16x32_bf16 v[64:67], a[176:179], v[136:139], v[64:67]
 s_add_u32 m0, s40, 0x16c60
 ds_read_b128 a[172:175], v8 offset:320
 v_mul_f32 v202, s6, v202
 s_waitcnt lgkmcnt(9)
 v_mfma_f32_16x16x32_bf16 v[72:75], a[176:179], v[228:231], v[72:75]
 buffer_load_dwordx4 v16, s[20:23], s56 offen offset:1536 nt lds
 v_mul_f32 v203, s6, v203
 s_waitcnt lgkmcnt(8)
 v_mfma_f32_16x16x32_bf16 v[72:75], a[180:183], v[236:239], v[72:75]
 s_waitcnt lgkmcnt(4)
 v_mul_f32 v204, s6, v204
 v_mul_f32 v205, s6, v205
 v_mfma_f32_16x16x32_bf16 v[60:63], a[184:187], v[128:131], v[60:63]
 ds_read_b128 a[176:179], v7 offset:256
 v_mul_f32 v206, s6, v206
 v_mfma_f32_16x16x32_bf16 v[60:63], a[188:191], v[144:147], v[60:63]
 v_mul_f32 v207, s6, v207
 v_cvt_pk_bf16_f32 v200, v200, v201
 v_mfma_f32_16x16x32_bf16 v[68:71], a[188:191], v[152:155], v[68:71]
 ds_read_b128 a[180:183], v7 offset:320
 v_cvt_pk_bf16_f32 v201, v202, v203
 v_mfma_f32_16x16x32_bf16 v[68:71], a[184:187], v[136:139], v[68:71]
 s_waitcnt lgkmcnt(4)
 v_cvt_pk_bf16_f32 v202, v204, v205
 v_cvt_pk_bf16_f32 v203, v206, v207
 v_mfma_f32_16x16x32_bf16 v[56:59], a[160:163], v[160:163], v[56:59]
 ds_read_b128 a[184:187], v9 offset:256
 v_mfma_f32_16x16x32_bf16 v[56:59], a[164:167], v[176:179], v[56:59]
 v_permlane32_swap_b32 v200, v202
 v_mfma_f32_16x16x32_bf16 v[64:67], a[164:167], v[184:187], v[64:67]
 v_permlane32_swap_b32 v201, v203
 v_mfma_f32_16x16x32_bf16 v[64:67], a[160:163], v[168:171], v[64:67]
 ds_read_b128 a[188:191], v9 offset:320
 v_mul_f32 v208, s6, v208
 v_mfma_f32_16x16x32_bf16 v[72:75], a[160:163], v[240:243], v[72:75]
 v_mul_f32 v209, s6, v209
 v_mul_f32 v210, s6, v210
 v_mfma_f32_16x16x32_bf16 v[72:75], a[164:167], v[248:251], v[72:75]
 s_waitcnt lgkmcnt(4)
 v_mul_f32 v211, s6, v211
 v_mul_f32 v212, s6, v212
 v_mfma_f32_16x16x32_bf16 v[60:63], a[168:171], v[160:163], v[60:63]
L_tailB:
 s_barrier
 ds_read_b128 a[160:163], v6 offset:16896
 v_mfma_f32_16x16x32_bf16 v[60:63], a[172:175], v[176:179], v[60:63]
 s_xor_b32 s56, s43, 0x4000
 v_mul_f32 v213, s6, v213
 v_mul_f32 v214, s6, v214
 v_mfma_f32_16x16x32_bf16 v[68:71], a[172:175], v[184:187], v[68:71]
 s_add_u32 m0, s40, 0x1a800
 ds_read_b128 a[164:167], v6 offset:16960
 v_mul_f32 v215, s6, v215
 v_mfma_f32_16x16x32_bf16 v[68:71], a[168:171], v[168:171], v[68:71]
 s_waitcnt lgkmcnt(4)
 v_cvt_pk_bf16_f32 v208, v208, v209
 v_cvt_pk_bf16_f32 v209, v210, v211
 v_cvt_pk_bf16_f32 v210, v212, v213
 v_cvt_pk_bf16_f32 v211, v214, v215
 s_nop 0
 v_permlane32_swap_b32 v208, v210
 v_permlane32_swap_b32 v209, v211
 v_mul_f32 v216, s6, v216
 v_mul_f32 v217, s6, v217
 v_mul_f32 v218, s6, v218
 v_mul_f32 v219, s6, v219
 v_mul_f32 v220, s6, v220
 v_mul_f32 v221, s6, v221
 v_mul_f32 v222, s6, v222
 v_mul_f32 v223, s6, v223
 v_cvt_pk_bf16_f32 v216, v216, v217
 v_cvt_pk_bf16_f32 v217, v218, v219
 v_cvt_pk_bf16_f32 v218, v220, v221
 v_cvt_pk_bf16_f32 v219, v222, v223
 s_nop 0
 v_permlane32_swap_b32 v216, v218
 v_permlane32_swap_b32 v217, v219
 v_mfma_f32_16x16x32_bf16 v[56:59], a[176:179], v[192:195], v[56:59]
 ds_read_b128 a[168:171], v8 offset:16896
 buffer_load_dwordx4 v16, s[20:23], s56 offen offset:0 nt lds
 v_mfma_f32_16x16x32_bf16 v[56:59], a[180:183], v[208:211], v[56:59]
 v_mfma_f32_16x16x32_bf16 v[64:67], a[180:183], v[216:219], v[64:67]
 v_mfma_f32_16x16x32_bf16 v[64:67], a[176:179], v[200:203], v[64:67]
 ds_read_b128 a[172:175], v8 offset:16960
 v_mfma_f32_16x16x32_bf16 v[72:75], a[176:179], v[244:247], v[72:75]
 v_mfma_f32_16x16x32_bf16 v[72:75], a[180:183], v[252:255], v[72:75]
 s_waitcnt lgkmcnt(4)
 v_mfma_f32_16x16x32_bf16 v[60:63], a[184:187], v[192:195], v[60:63]
 s_add_u32 m0, s40, 0x1aa20
 ds_read_b128 a[176:179], v7 offset:16896
 v_mfma_f32_16x16x32_bf16 v[60:63], a[188:191], v[208:211], v[60:63]
 buffer_load_dwordx4 v16, s[20:23], s56 offen offset:512 nt lds
 v_mfma_f32_16x16x32_bf16 v[68:71], a[188:191], v[216:219], v[68:71]
 ds_read_b128 a[180:183], v7 offset:16960
 v_mfma_f32_16x16x32_bf16 v[68:71], a[184:187], v[200:203], v[68:71]
 s_waitcnt lgkmcnt(4)
 v_mfma_f32_16x16x32_bf16 v[100:103], a[160:163], v[96:99], 0
 ds_read_b128 a[184:187], v9 offset:16896
 v_mfma_f32_16x16x32_bf16 v[100:103], a[164:167], v[112:115], v[100:103]
 v_mfma_f32_16x16x32_bf16 v[116:119], a[164:167], v[120:123], 0
 s_cbranch_vccnz L_stub_0_B1
L_stub_0_B1_ret:
 v_mfma_f32_16x16x32_bf16 v[116:119], a[160:163], v[104:107], v[116:119]
 ds_read_b128 a[188:191], v9 offset:16960
 v_max3_f32 v79, v72, v73, v74
 v_mfma_f32_16x16x32_bf16 v[132:135], a[160:163], v[224:227], 0
 s_add_u32 m0, s40, 0x1ac40
 v_max_f32 v79, v79, v75
 v_mov_b32 v77, v79
 v_mfma_f32_16x16x32_bf16 v[132:135], a[164:167], v[232:235], v[132:135]
 s_waitcnt lgkmcnt(4)
 v_permlane32_swap_b32 v77, v79
 v_mfma_f32_16x16x32_bf16 v[108:111], a[168:171], v[96:99], 0
 ds_read_b128 a[160:163], v6 offset:17152
 v_max_f32 v79, v79, v77
 v_mfma_f32_16x16x32_bf16 v[108:111], a[172:175], v[112:115], v[108:111]
 buffer_load_dwordx4 v16, s[20:23], s56 offen offset:1024 nt lds
 v_mov_b32 v77, v79
 v_mfma_f32_16x16x32_bf16 v[124:127], a[172:175], v[120:123], 0
 ds_read_b128 a[164:167], v6 offset:17216
 v_max3_f32 v78, v56, v57, v58
 v_mfma_f32_16x16x32_bf16 v[124:127], a[168:171], v[104:107], v[124:127]
 s_waitcnt lgkmcnt(4)
 v_permlane16_swap_b32 v77, v79
 v_mfma_f32_16x16x32_bf16 v[100:103], a[176:179], v[128:131], v[100:103]
 ds_read_b128 a[168:171], v8 offset:17152
 v_max_f32 v79, v79, v77
 v_mfma_f32_16x16x32_bf16 v[100:103], a[180:183], v[144:147], v[100:103]
 ds_write_b32 v23, v79 offset:0
 v_max3_f32 v78, v78, v59, v60
 v_mfma_f32_16x16x32_bf16 v[116:119], a[180:183], v[152:155], v[116:119]
 v_max3_f32 v78, v78, v61, v62
 v_max_f32 v78, v78, v63
 v_mfma_f32_16x16x32_bf16 v[116:119], a[176:179], v[136:139], v[116:119]
 s_add_u32 m0, s40, 0x1ae60
 ds_read_b128 a[172:175], v8 offset:17216
 v_mov_b32 v76, v78
 v_mfma_f32_16x16x32_bf16 v[132:135], a[176:179], v[228:231], v[132:135]
 buffer_load_dwordx4 v16, s[20:23], s56 offen offset:1536 nt lds
 v_mfma_f32_16x16x32_bf16 v[132:135], a[180:183], v[236:239], v[132:135]
 s_waitcnt lgkmcnt(5)
 v_permlane32_swap_b32 v76, v78
 v_mfma_f32_16x16x32_bf16 v[108:111], a[184:187], v[128:131], v[108:111]
 ds_read_b128 a[176:179], v7 offset:17152
 v_max_f32 v78, v78, v76
 v_mfma_f32_16x16x32_bf16 v[108:111], a[188:191], v[144:147], v[108:111]
 v_mov_b32 v76, v78
 v_mfma_f32_16x16x32_bf16 v[124:127], a[188:191], v[152:155], v[124:127]
 ds_read_b128 a[180:183], v7 offset:17216
 v_mfma_f32_16x16x32_bf16 v[124:127], a[184:187], v[136:139], v[124:127]
 s_waitcnt lgkmcnt(5)
 v_permlane16_swap_b32 v76, v78
 v_mfma_f32_16x16x32_bf16 v[100:103], a[160:163], v[160:163], v[100:103]
 ds_read_b128 a[184:187], v9 offset:17152
 v_max_f32 v78, v78, v76
 v_mfma_f32_16x16x32_bf16 v[100:103], a[164:167], v[176:179], v[100:103]
 v_cndmask_b32_e64 v44, -v78, 0, vcc
 v_mov_b32 v45, v44
 v_mfma_f32_16x16x32_bf16 v[116:119], a[164:167], v[184:187], v[116:119]
 v_mov_b32 v46, v44
 v_mov_b32 v47, v44
 v_mfma_f32_16x16x32_bf16 v[116:119], a[160:163], v[168:171], v[116:119]
 ds_read_b128 a[188:191], v9 offset:17216
 v_max3_f32 v78, v64, v65, v66
 v_mfma_f32_16x16x32_bf16 v[132:135], a[160:163], v[240:243], v[132:135]
 v_max3_f32 v78, v78, v67, v68
 v_max3_f32 v78, v78, v69, v70
 v_mfma_f32_16x16x32_bf16 v[132:135], a[164:167], v[248:251], v[132:135]
 s_waitcnt lgkmcnt(4)
 v_max_f32 v78, v78, v71
 v_mov_b32 v76, v78
 v_mfma_f32_16x16x32_bf16 v[108:111], a[168:171], v[160:163], v[108:111]
 s_barrier
 ds_read_b128 a[160:163], v6 offset:33792
 v_mfma_f32_16x16x32_bf16 v[108:111], a[172:175], v[176:179], v[108:111]
 s_xor_b32 s56, s42, 0x10000
 ds_read_b32 v77, v24 offset:0
 v_mfma_f32_16x16x32_bf16 v[124:127], a[172:175], v[184:187], v[124:127]
 s_add_u32 m0, s40, 0
 ds_read_b128 a[164:167], v6 offset:33856
 v_mfma_f32_16x16x32_bf16 v[124:127], a[168:171], v[168:171], v[124:127]
 s_waitcnt lgkmcnt(5)
 v_permlane32_swap_b32 v76, v78
 v_mfma_f32_16x16x32_bf16 v[100:103], a[176:179], v[192:195], v[100:103]
 s_waitcnt vmcnt(3)
 ds_read_b128 a[168:171], v8 offset:33792
 v_max_f32 v78, v78, v76
 v_mfma_f32_16x16x32_bf16 v[100:103], a[180:183], v[208:211], v[100:103]
 buffer_load_dwordx4 v16, s[16:19], s56 offen offset:0 nt lds
 v_mov_b32 v76, v78
 v_mfma_f32_16x16x32_bf16 v[116:119], a[180:183], v[216:219], v[116:119]
 s_nop 0
 v_permlane16_swap_b32 v76, v78
 v_mfma_f32_16x16x32_bf16 v[116:119], a[176:179], v[200:203], v[116:119]
 ds_read_b128 a[172:175], v8 offset:33856
 v_max_f32 v78, v78, v76
 v_mfma_f32_16x16x32_bf16 v[132:135], a[176:179], v[244:247], v[132:135]
 v_cndmask_b32_e64 v48, -v78, 0, vcc
 v_mov_b32 v49, v48
 v_mfma_f32_16x16x32_bf16 v[132:135], a[180:183], v[252:255], v[132:135]
 s_waitcnt lgkmcnt(5)
 v_mov_b32 v50, v48
 v_mov_b32 v51, v48
 v_mfma_f32_16x16x32_bf16 v[108:111], a[184:187], v[192:195], v[108:111]
 ds_read_b128 a[176:179], v7 offset:33792
 s_waitcnt lgkmcnt(4)
 v_max_f32 v79, v79, v77
 v_mfma_f32_16x16x32_bf16 v[108:111], a[188:191], v[208:211], v[108:111]
 s_add_u32 m0, s40, 0x220
 v_cndmask_b32_e64 v52, -v79, 0, vcc
 v_mov_b32 v53, v52
 v_mfma_f32_16x16x32_bf16 v[124:127], a[188:191], v[216:219], v[124:127]
 ds_read_b128 a[180:183], v7 offset:33856
 v_mov_b32 v54, v52
 v_mfma_f32_16x16x32_bf16 v[124:127], a[184:187], v[200:203], v[124:127]
 s_waitcnt lgkmcnt(4)
 v_mov_b32 v55, v52
 v_add_f32 v72, v72, v52
 v_mfma_f32_16x16x32_bf16 v[140:143], a[160:163], v[96:99], v[44:47]
 ds_read_b128 a[184:187], v9 offset:33792
 v_add_f32 v73, v73, v52
 v_mfma_f32_16x16x32_bf16 v[140:143], a[164:167], v[112:115], v[140:143]
 v_add_f32 v74, v74, v52
 v_add_f32 v75, v75, v52
 v_mfma_f32_16x16x32_bf16 v[156:159], a[164:167], v[120:123], v[48:51]
 s_cbranch_vccnz L_stub_1_B1
L_stub_1_B1_ret:
 buffer_load_dwordx4 v16, s[16:19], s56 offen offset:512 nt lds
 v_mfma_f32_16x16x32_bf16 v[156:159], a[160:163], v[104:107], v[156:159]
 ds_read_b128 a[188:191], v9 offset:33856
 v_add_f32 v56, v56, v44
 v_mfma_f32_16x16x32_bf16 v[172:175], a[160:163], v[224:227], 0
 v_exp_f32 v72, v72
 v_mfma_f32_16x16x32_bf16 v[172:175], a[164:167], v[232:235], v[172:175]
 s_waitcnt lgkmcnt(4)
 v_exp_f32 v73, v73
 v_mfma_f32_16x16x32_bf16 v[148:151], a[168:171], v[96:99], v[44:47]
 ds_read_b128 a[160:163], v6 offset:34048
 v_add_f32 v57, v57, v44
 v_mfma_f32_16x16x32_bf16 v[148:151], a[172:175], v[112:115], v[148:151]
 s_add_u32 m0, s40, 0x440
 v_exp_f32 v74, v74
 v_mfma_f32_16x16x32_bf16 v[164:167], a[172:175], v[120:123], v[48:51]
 s_waitcnt vmcnt(4)
 ds_read_b128 a[164:167], v6 offset:34112
 v_add_f32 v58, v58, v44
 v_mfma_f32_16x16x32_bf16 v[164:167], a[168:171], v[104:107], v[164:167]
 s_waitcnt lgkmcnt(4)
 v_exp_f32 v75, v75
 v_mfma_f32_16x16x32_bf16 v[140:143], a[176:179], v[128:131], v[140:143]
 ds_read_b128 a[168:171], v8 offset:34048
 v_add_f32 v34, v72, v73
 v_mfma_f32_16x16x32_bf16 v[140:143], a[180:183], v[144:147], v[140:143]
 v_cvt_pk_bf16_f32 v72, v72, v73
 v_add_f32 v34, v34, v74
 v_mfma_f32_16x16x32_bf16 v[156:159], a[180:183], v[152:155], v[156:159]
 v_add_f32 v34, v34, v75
 v_cvt_pk_bf16_f32 v73, v74, v75
 v_mfma_f32_16x16x32_bf16 v[156:159], a[176:179], v[136:139], v[156:159]
 ds_read_b128 a[172:175], v8 offset:34112
 ds_write_b64 v21, v[72:73] offset:0
 v_mfma_f32_16x16x32_bf16 v[172:175], a[176:179], v[228:231], v[172:175]
 buffer_load_dwordx4 v16, s[16:19], s56 offen offset:1024 nt lds
 v_add_f32 v59, v59, v44
 v_mfma_f32_16x16x32_bf16 v[172:175], a[180:183], v[236:239], v[172:175]
 s_waitcnt lgkmcnt(5)
 v_add_f32 v60, v60, v44
 v_add_f32 v61, v61, v44
 v_mfma_f32_16x16x32_bf16 v[148:151], a[184:187], v[128:131], v[148:151]
 ds_read_b128 a[176:179], v7 offset:34048
 v_add_f32 v62, v62, v44
 v_mfma_f32_16x16x32_bf16 v[148:151], a[188:191], v[144:147], v[148:151]
 s_add_u32 m0, s40, 0x660
 v_add_f32 v63, v63, v44
 v_add_f32 v64, v64, v48
 v_mfma_f32_16x16x32_bf16 v[164:167], a[188:191], v[152:155], v[164:167]
 s_waitcnt vmcnt(4)
 ds_read_b128 a[180:183], v7 offset:34112
 v_add_f32 v65, v65, v48
 v_mfma_f32_16x16x32_bf16 v[164:167], a[184:187], v[136:139], v[164:167]
 s_waitcnt lgkmcnt(5)
 buffer_load_dwordx4 v16, s[16:19], s56 offen offset:1536 nt lds
 v_add_f32 v66, v66, v48
 v_mfma_f32_16x16x32_bf16 v[140:143], a[160:163], v[160:163], v[140:143]
 ds_read_b128 a[184:187], v9 offset:34048
 v_add_f32 v67, v67, v48
 v_mfma_f32_16x16x32_bf16 v[140:143], a[164:167], v[176:179], v[140:143]
 v_add_f32 v68, v68, v48
 v_add_f32 v69, v69, v48
 v_mfma_f32_16x16x32_bf16 v[156:159], a[164:167], v[184:187], v[156:159]
 v_add_f32 v70, v70, v48
 v_add_f32 v71, v71, v48
 v_mfma_f32_16x16x32_bf16 v[156:159], a[160:163], v[168:171], v[156:159]
 ds_read_b128 a[188:191], v9 offset:34112
 v_add_f32 v132, v132, v52
 v_mfma_f32_16x16x32_bf16 v[172:175], a[160:163], v[240:243], v[172:175]
 v_exp_f32 v56, v56
 v_mfma_f32_16x16x32_bf16 v[172:175], a[164:167], v[248:251], v[172:175]
 s_waitcnt lgkmcnt(5)
 v_exp_f32 v57, v57
 v_mfma_f32_16x16x32_bf16 v[148:151], a[168:171], v[160:163], v[148:151]
 s_waitcnt lgkmcnt(4)
 s_barrier
 ds_read_b64_tr_b16 a[160:161], v2 offset:0
 ds_read_b64_tr_b16 a[162:163], v4 offset:0
 v_mfma_f32_16x16x32_bf16 v[148:151], a[172:175], v[176:179], v[148:151]
 ds_read_b64 v[74:75], v22 offset:0
 v_add_f32 v32, v56, v57
 v_mfma_f32_16x16x32_bf16 v[164:167], a[172:175], v[184:187], v[164:167]
 ds_read_b64_tr_b16 a[164:165], v3 offset:0
 ds_read_b64_tr_b16 a[166:167], v5 offset:0
 v_mfma_f32_16x16x32_bf16 v[164:167], a[168:171], v[168:171], v[164:167]
 s_waitcnt lgkmcnt(7)
 v_exp_f32 v58, v58
 v_mfma_f32_16x16x32_bf16 v[140:143], a[176:179], v[192:195], v[140:143]
 ds_read_b64_tr_b16 a[168:169], v2 offset:32
 ds_read_b64_tr_b16 a[170:171], v4 offset:32
 v_mfma_f32_16x16x32_bf16 v[140:143], a[180:183], v[208:211], v[140:143]
 v_exp_f32 v59, v59
 v_mfma_f32_16x16x32_bf16 v[156:159], a[180:183], v[216:219], v[156:159]
 s_xor_b32 s56, s42, 0x14000
 v_exp_f32 v60, v60
 v_mfma_f32_16x16x32_bf16 v[156:159], a[176:179], v[200:203], v[156:159]
 s_add_u32 m0, s40, 0x4200
 ds_read_b64_tr_b16 a[172:173], v3 offset:32
 ds_read_b64_tr_b16 a[174:175], v5 offset:32
 v_mfma_f32_16x16x32_bf16 v[172:175], a[176:179], v[244:247], v[172:175]
 s_waitcnt vmcnt(3)
 v_exp_f32 v61, v61
 v_mfma_f32_16x16x32_bf16 v[172:175], a[180:183], v[252:255], v[172:175]
 s_waitcnt lgkmcnt(9)
 v_exp_f32 v62, v62
 v_mfma_f32_16x16x32_bf16 v[148:151], a[184:187], v[192:195], v[148:151]
 ds_read_b64_tr_b16 a[176:177], v2 offset:64
 ds_read_b64_tr_b16 a[178:179], v4 offset:64
 v_mfma_f32_16x16x32_bf16 v[148:151], a[188:191], v[208:211], v[148:151]
 v_exp_f32 v63, v63
 v_mfma_f32_16x16x32_bf16 v[164:167], a[188:191], v[216:219], v[164:167]
 ds_read_b64_tr_b16 a[180:181], v3 offset:64
 ds_read_b64_tr_b16 a[182:183], v5 offset:64
 v_exp_f32 v64, v64
 v_exp_f32 v65, v65
 v_exp_f32 v66, v66
 v_exp_f32 v67, v67
 v_exp_f32 v68, v68
 v_exp_f32 v69, v69
 v_exp_f32 v70, v70
 v_exp_f32 v71, v71
 v_cvt_pk_bf16_f32 v56, v56, v57
 v_add_f32 v32, v32, v58
 v_add_f32 v32, v32, v59
 v_cvt_pk_bf16_f32 v57, v58, v59
 v_add_f32 v32, v32, v60
 v_add_f32 v32, v32, v61
 v_cvt_pk_bf16_f32 v58, v60, v61
 v_add_f32 v32, v32, v62
 v_add_f32 v32, v32, v63
 v_cvt_pk_bf16_f32 v59, v62, v63
 v_add_f32 v33, v64, v65
 v_cvt_pk_bf16_f32 v64, v64, v65
 v_add_f32 v33, v33, v66
 v_add_f32 v33, v33, v67
 v_cvt_pk_bf16_f32 v65, v66, v67
 v_add_f32 v33, v33, v68
 v_add_f32 v33, v33, v69
 v_cvt_pk_bf16_f32 v66, v68, v69
 v_add_f32 v33, v33, v70
 v_add_f32 v33, v33, v71
 v_cvt_pk_bf16_f32 v67, v70, v71
 v_mfma_f32_16x16x32_bf16 v[164:167], a[184:187], v[200:203], v[164:167]
 s_waitcnt lgkmcnt(8)
 buffer_load_dwordx4 v16, s[16:19], s56 offen offset:0 nt lds
 v_add_f32 v133, v133, v52
 v_mfma_f32_16x16x32_bf16 a[0:3], a[160:163], v[56:59], 0
 ds_read_b64_tr_b16 a[184:185], v2 offset:96
 ds_read_b64_tr_b16 a[186:187], v4 offset:96
 v_mfma_f32_16x16x32_bf16 a[128:131], a[160:163], v[72:75], 0
 v_add_f32 v134, v134, v52
 v_add_f32 v135, v135, v52
 v_mfma_f32_16x16x32_bf16 a[8:11], a[160:163], v[64:67], 0
 s_cbranch_vccnz L_stub_2_B1
L_stub_2_B1_ret:
 v_add_f32 v100, v100, v44
 v_mfma_f32_16x16x32_bf16 a[40:43], a[164:167], v[64:67], 0
 s_add_u32 m0, s40, 0x4420
 ds_read_b64_tr_b16 a[188:189], v3 offset:96
 ds_read_b64_tr_b16 a[190:191], v5 offset:96
 v_mfma_f32_16x16x32_bf16 a[32:35], a[164:167], v[56:59], 0
 s_waitcnt lgkmcnt(8)
 v_exp_f32 v132, v132
 v_mfma_f32_16x16x32_bf16 a[4:7], a[168:171], v[56:59], 0
 ds_read_b64_tr_b16 a[160:161], v2 offset:256
 ds_read_b64_tr_b16 a[162:163], v4 offset:256
 v_mfma_f32_16x16x32_bf16 a[132:135], a[168:171], v[72:75], 0
 buffer_load_dwordx4 v16, s[16:19], s56 offen offset:512 nt lds
 v_add_f32 v101, v101, v44
 v_mfma_f32_16x16x32_bf16 a[12:15], a[168:171], v[64:67], 0
 v_exp_f32 v133, v133
 v_mfma_f32_16x16x32_bf16 a[44:47], a[172:175], v[64:67], 0
 ds_read_b64_tr_b16 a[164:165], v3 offset:256
 ds_read_b64_tr_b16 a[166:167], v5 offset:256
 v_mfma_f32_16x16x32_bf16 a[36:39], a[172:175], v[56:59], 0
 s_waitcnt lgkmcnt(8)
 v_exp_f32 v134, v134
 v_mfma_f32_16x16x32_bf16 a[16:19], a[176:179], v[56:59], 0
 ds_read_b64_tr_b16 a[168:169], v2 offset:288
 ds_read_b64_tr_b16 a[170:171], v4 offset:288
 v_mfma_f32_16x16x32_bf16 a[136:139], a[176:179], v[72:75], 0
 v_exp_f32 v135, v135
 v_mfma_f32_16x16x32_bf16 a[24:27], a[176:179], v[64:67], 0
 s_add_u32 m0, s40, 0x4640
 v_add_f32 v34, v34, v132
 v_add_f32 v34, v34, v133
 v_mfma_f32_16x16x32_bf16 a[56:59], a[180:183], v[64:67], 0
 s_waitcnt vmcnt(4)
 ds_read_b64_tr_b16 a[172:173], v3 offset:288
 ds_read_b64_tr_b16 a[174:175], v5 offset:288
 v_mfma_f32_16x16x32_bf16 a[48:51], a[180:183], v[56:59], 0
 s_waitcnt lgkmcnt(8)
 buffer_load_dwordx4 v16, s[16:19], s56 offen offset:1024 nt lds
 global_load_dword v35, v[30:31], off
 v_mfma_f32_16x16x32_bf16 a[20:23], a[184:187], v[56:59], 0
 ds_read_b64_tr_b16 a[176:177], v2 offset:320
 ds_read_b64_tr_b16 a[178:179], v4 offset:320
 v_mfma_f32_16x16x32_bf16 a[140:143], a[184:187], v[72:75], 0
 v_cvt_pk_bf16_f32 v132, v132, v133
 v_add_f32 v34, v34, v134
 v_mfma_f32_16x16x32_bf16 a[28:31], a[184:187], v[64:67], 0
 v_add_f32 v34, v34, v135
 v_cvt_pk_bf16_f32 v133, v134, v135
 v_mfma_f32_16x16x32_bf16 a[60:63], a[188:191], v[64:67], 0
 ds_read_b64_tr_b16 a[180:181], v3 offset:320
 ds_read_b64_tr_b16 a[182:183], v5 offset:320
 v_mfma_f32_16x16x32_bf16 a[52:55], a[188:191], v[56:59], 0
 s_waitcnt lgkmcnt(8)
 ds_write_b64 v21, v[132:133] offset:2048
 v_add_f32 v102, v102, v44
 v_mfma_f32_16x16x32_bf16 a[64:67], a[160:163], v[56:59], 0
 ds_read_b64_tr_b16 a[184:185], v2 offset:352
 ds_read_b64_tr_b16 a[186:187], v4 offset:352
 v_mfma_f32_16x16x32_bf16 a[144:147], a[160:163], v[72:75], 0
 v_add_f32 v103, v103, v44
 v_add_f32 v108, v108, v44
 v_mfma_f32_16x16x32_bf16 a[72:75], a[160:163], v[64:67], 0
 v_add_f32 v109, v109, v44
 v_add_f32 v110, v110, v44
 v_mfma_f32_16x16x32_bf16 a[104:107], a[164:167], v[64:67], 0
 ds_read_b64_tr_b16 a[188:189], v3 offset:352
 ds_read_b64_tr_b16 a[190:191], v5 offset:352
 v_mfma_f32_16x16x32_bf16 a[96:99], a[164:167], v[56:59], 0
 s_waitcnt lgkmcnt(9)
 v_add_f32 v111, v111, v44
 v_add_f32 v116, v116, v48
 v_mfma_f32_16x16x32_bf16 a[68:71], a[168:171], v[56:59], 0
 s_waitcnt lgkmcnt(4)
 s_barrier
 ds_read_b128 a[160:163], v6 offset:50688
 v_mfma_f32_16x16x32_bf16 a[148:151], a[168:171], v[72:75], 0
 v_add_f32 v117, v117, v48
 v_add_f32 v118, v118, v48
 v_mfma_f32_16x16x32_bf16 a[76:79], a[168:171], v[64:67], 0
 s_xor_b32 s56, s42, 0x14000
 v_add_f32 v119, v119, v48
 v_add_f32 v124, v124, v48
 v_mfma_f32_16x16x32_bf16 a[108:111], a[172:175], v[64:67], 0
 s_add_u32 m0, s40, 0x4860
 ds_read_b128 a[164:167], v6 offset:50752
 v_add_f32 v125, v125, v48
 v_mfma_f32_16x16x32_bf16 a[100:103], a[172:175], v[56:59], 0
 v_add_f32 v126, v126, v48
 v_add_f32 v127, v127, v48
 v_mfma_f32_16x16x32_bf16 a[80:83], a[176:179], v[56:59], 0
 s_waitcnt vmcnt(4)
 ds_read_b128 a[168:171], v8 offset:50688
 v_add_f32 v172, v172, v52
 v_mfma_f32_16x16x32_bf16 a[152:155], a[176:179], v[72:75], 0
 buffer_load_dwordx4 v16, s[16:19], s56 offen offset:1536 nt lds
 v_add_f32 v173, v173, v52
 v_mfma_f32_16x16x32_bf16 a[88:91], a[176:179], v[64:67], 0
 v_exp_f32 v100, v100
 v_mfma_f32_16x16x32_bf16 a[120:123], a[180:183], v[64:67], 0
 ds_read_b128 a[172:175], v8 offset:50752
 v_add_f32 v32, v32, v100
 v_mfma_f32_16x16x32_bf16 a[112:115], a[180:183], v[56:59], 0
 s_waitcnt lgkmcnt(4)
 v_exp_f32 v101, v101
 v_mfma_f32_16x16x32_bf16 a[84:87], a[184:187], v[56:59], 0
 ds_read_b128 a[176:179], v7 offset:50688
 v_add_f32 v32, v32, v101
 v_mfma_f32_16x16x32_bf16 a[156:159], a[184:187], v[72:75], 0
 v_exp_f32 v102, v102
 v_mfma_f32_16x16x32_bf16 a[92:95], a[184:187], v[64:67], 0
 v_exp_f32 v103, v103
 v_mfma_f32_16x16x32_bf16 a[124:127], a[188:191], v[64:67], 0
 s_xor_b32 s56, s42, 0x18000
 ds_read_b128 a[180:183], v7 offset:50752
 v_cvt_pk_bf16_f32 v100, v100, v101
 v_mfma_f32_16x16x32_bf16 a[116:119], a[188:191], v[56:59], 0
 s_waitcnt lgkmcnt(4)
 v_exp_f32 v108, v108
 v_mfma_f32_16x16x32_bf16 v[56:59], a[160:163], v[96:99], v[44:47]
 s_add_u32 m0, s40, 0x8400
 ds_read_b128 a[184:187], v9 offset:50688
 v_add_f32 v32, v32, v102
 v_mfma_f32_16x16x32_bf16 v[56:59], a[164:167], v[112:115], v[56:59]
 s_waitcnt vmcnt(3)
 v_exp_f32 v109, v109
 v_mfma_f32_16x16x32_bf16 v[64:67], a[164:167], v[120:123], v[48:51]
 buffer_load_dwordx4 v16, s[16:19], s56 offen offset:0 nt lds
 v_add_f32 v32, v32, v103
 v_mfma_f32_16x16x32_bf16 v[64:67], a[160:163], v[104:107], v[64:67]
 ds_read_b128 a[188:191], v9 offset:50752
 v_cvt_pk_bf16_f32 v101, v102, v103
 v_mfma_f32_16x16x32_bf16 v[72:75], a[160:163], v[224:227], v[52:55]
 v_exp_f32 v110, v110
 v_mfma_f32_16x16x32_bf16 v[72:75], a[164:167], v[232:235], v[72:75]
 s_waitcnt lgkmcnt(4)
 v_exp_f32 v111, v111
 v_mfma_f32_16x16x32_bf16 v[60:63], a[168:171], v[96:99], v[44:47]
 ds_read_b128 a[160:163], v6 offset:50944
 v_add_f32 v32, v32, v108
 v_mfma_f32_16x16x32_bf16 v[60:63], a[172:175], v[112:115], v[60:63]
 v_exp_f32 v116, v116
 v_mfma_f32_16x16x32_bf16 v[68:71], a[172:175], v[120:123], v[48:51]
 s_add_u32 m0, s40, 0x8620
 ds_read_b128 a[164:167], v6 offset:51008
 v_add_f32 v32, v32, v109
 v_mfma_f32_16x16x32_bf16 v[68:71], a[168:171], v[104:107], v[68:71]
 s_waitcnt lgkmcnt(4)
 v_exp_f32 v117, v117
 v_mfma_f32_16x16x32_bf16 v[56:59], a[176:179], v[128:131], v[56:59]
 ds_read_b128 a[168:171], v8 offset:50944
 v_cvt_pk_bf16_f32 v102, v108, v109
 v_mfma_f32_16x16x32_bf16 v[56:59], a[180:183], v[144:147], v[56:59]
 buffer_load_dwordx4 v16, s[16:19], s56 offen offset:512 nt lds
 v_add_f32 v32, v32, v110
 v_mfma_f32_16x16x32_bf16 v[64:67], a[180:183], v[152:155], v[64:67]
 v_exp_f32 v118, v118
 v_mfma_f32_16x16x32_bf16 v[64:67], a[176:179], v[136:139], v[64:67]
 ds_read_b128 a[172:175], v8 offset:51008
 v_add_f32 v32, v32, v111
 v_mfma_f32_16x16x32_bf16 v[72:75], a[176:179], v[228:231], v[72:75]
 v_exp_f32 v119, v119
 v_mfma_f32_16x16x32_bf16 v[72:75], a[180:183], v[236:239], v[72:75]
 s_waitcnt lgkmcnt(4)
 v_exp_f32 v124, v124
 v_mfma_f32_16x16x32_bf16 v[60:63], a[184:187], v[128:131], v[60:63]
 ds_read_b128 a[176:179], v7 offset:50944
 v_cvt_pk_bf16_f32 v103, v110, v111
 v_mfma_f32_16x16x32_bf16 v[60:63], a[188:191], v[144:147], v[60:63]
 v_exp_f32 v125, v125
 v_mfma_f32_16x16x32_bf16 v[68:71], a[188:191], v[152:155], v[68:71]
 ds_read_b128 a[180:183], v7 offset:51008
 v_add_f32 v33, v33, v116
 v_mfma_f32_16x16x32_bf16 v[68:71], a[184:187], v[136:139], v[68:71]
 s_waitcnt lgkmcnt(4)
 v_exp_f32 v126, v126
 v_mfma_f32_16x16x32_bf16 v[56:59], a[160:163], v[160:163], v[56:59]
 s_add_u32 m0, s40, 0x8840
 ds_read_b128 a[184:187], v9 offset:50944
 v_add_f32 v33, v33, v117
 v_mfma_f32_16x16x32_bf16 v[56:59], a[164:167], v[176:179], v[56:59]
 s_waitcnt vmcnt(4)
 v_exp_f32 v127, v127
 v_mfma_f32_16x16x32_bf16 v[64:67], a[164:167], v[184:187], v[64:67]
 buffer_load_dwordx4 v16, s[16:19], s56 offen offset:1024 nt lds
 v_cvt_pk_bf16_f32 v116, v116, v117
 v_mfma_f32_16x16x32_bf16 v[64:67], a[160:163], v[168:171], v[64:67]
 ds_read_b128 a[188:191], v9 offset:51008
 v_add_f32 v33, v33, v118
 v_mfma_f32_16x16x32_bf16 v[72:75], a[160:163], v[240:243], v[72:75]
 v_add_f32 v33, v33, v119
 v_cvt_pk_bf16_f32 v117, v118, v119
 v_mfma_f32_16x16x32_bf16 v[72:75], a[164:167], v[248:251], v[72:75]
 s_waitcnt lgkmcnt(4)
 v_add_f32 v33, v33, v124
 v_add_f32 v33, v33, v125
 v_mfma_f32_16x16x32_bf16 v[60:63], a[168:171], v[160:163], v[60:63]
 s_barrier
 ds_read_b64_tr_b16 a[160:161], v2 offset:16896
 ds_read_b64_tr_b16 a[162:163], v4 offset:16896
 v_mfma_f32_16x16x32_bf16 v[60:63], a[172:175], v[176:179], v[60:63]
 ds_read_b64 v[134:135], v22 offset:2048
 v_cvt_pk_bf16_f32 v118, v124, v125
 v_mfma_f32_16x16x32_bf16 v[68:71], a[172:175], v[184:187], v[68:71]
 ds_read_b64_tr_b16 a[164:165], v3 offset:16896
 ds_read_b64_tr_b16 a[166:167], v5 offset:16896
 v_mfma_f32_16x16x32_bf16 v[68:71], a[168:171], v[168:171], v[68:71]
 s_waitcnt lgkmcnt(7)
 v_add_f32 v33, v33, v126
 v_add_f32 v33, v33, v127
 v_mfma_f32_16x16x32_bf16 v[56:59], a[176:179], v[192:195], v[56:59]
 ds_read_b64_tr_b16 a[168:169], v2 offset:16928
 ds_read_b64_tr_b16 a[170:171], v4 offset:16928
 v_mfma_f32_16x16x32_bf16 v[56:59], a[180:183], v[208:211], v[56:59]
 v_cvt_pk_bf16_f32 v119, v126, v127
 v_add_f32 v174, v174, v52
 v_mfma_f32_16x16x32_bf16 v[64:67], a[180:183], v[216:219], v[64:67]
 v_add_f32 v175, v175, v52
 v_mfma_f32_16x16x32_bf16 v[64:67], a[176:179], v[200:203], v[64:67]
 ds_read_b64_tr_b16 a[172:173], v3 offset:16928
 ds_read_b64_tr_b16 a[174:175], v5 offset:16928
 v_mfma_f32_16x16x32_bf16 v[72:75], a[176:179], v[244:247], v[72:75]
 s_xor_b32 s56, s42, 0x18000
 v_exp_f32 v172, v172
 v_mfma_f32_16x16x32_bf16 v[72:75], a[180:183], v[252:255], v[72:75]
 s_waitcnt lgkmcnt(9)
 v_exp_f32 v173, v173
 v_mfma_f32_16x16x32_bf16 v[60:63], a[184:187], v[192:195], v[60:63]
 s_add_u32 m0, s40, 0x8a60
 ds_read_b64_tr_b16 a[176:177], v2 offset:16960
 ds_read_b64_tr_b16 a[178:179], v4 offset:16960
 v_mfma_f32_16x16x32_bf16 v[60:63], a[188:191], v[208:211], v[60:63]
 s_waitcnt vmcnt(4)
 v_exp_f32 v174, v174
 v_mfma_f32_16x16x32_bf16 v[68:71], a[188:191], v[216:219], v[68:71]
 ds_read_b64_tr_b16 a[180:181], v3 offset:16960
 ds_read_b64_tr_b16 a[182:183], v5 offset:16960
 v_mfma_f32_16x16x32_bf16 v[68:71], a[184:187], v[200:203], v[68:71]
 s_waitcnt lgkmcnt(8)
 buffer_load_dwordx4 v16, s[16:19], s56 offen offset:1536 nt lds
 v_mfma_f32_16x16x32_bf16 a[0:3], a[160:163], v[100:103], a[0:3]
 ds_read_b64_tr_b16 a[184:185], v2 offset:16992
 ds_read_b64_tr_b16 a[186:187], v4 offset:16992
 v_mfma_f32_16x16x32_bf16 a[128:131], a[160:163], v[132:135], a[128:131]
L_pad14:
 s_cbranch_execz L_e2_back
 v_exp_f32 v175, v175
 v_mfma_f32_16x16x32_bf16 a[8:11], a[160:163], v[116:119], a[8:11]
 s_cbranch_vccnz L_stub_3_B1
L_stub_3_B1_ret:
 v_add_f32 v34, v34, v172
 v_mfma_f32_16x16x32_bf16 a[40:43], a[164:167], v[116:119], a[40:43]
 ds_read_b64_tr_b16 a[188:189], v3 offset:16992
 ds_read_b64_tr_b16 a[190:191], v5 offset:16992
 v_mfma_f32_16x16x32_bf16 a[32:35], a[164:167], v[100:103], a[32:35]
 s_waitcnt lgkmcnt(8)
 v_add_f32 v34, v34, v173
 v_cvt_pk_bf16_f32 v172, v172, v173
 v_mfma_f32_16x16x32_bf16 a[4:7], a[168:171], v[100:103], a[4:7]
 s_xor_b32 s56, s43, 0x10000
 ds_read_b64_tr_b16 a[160:161], v2 offset:17152
 ds_read_b64_tr_b16 a[162:163], v4 offset:17152
 v_mfma_f32_16x16x32_bf16 a[132:135], a[168:171], v[132:135], a[132:135]
 s_add_u32 m0, s40, 0x16600
 v_add_f32 v34, v34, v174
 v_add_f32 v34, v34, v175
 v_mfma_f32_16x16x32_bf16 a[12:15], a[168:171], v[116:119], a[12:15]
 s_waitcnt vmcnt(4)
 v_cvt_pk_bf16_f32 v173, v174, v175
 v_mfma_f32_16x16x32_bf16 a[44:47], a[172:175], v[116:119], a[44:47]
 ds_read_b64_tr_b16 a[164:165], v3 offset:17152
 ds_read_b64_tr_b16 a[166:167], v5 offset:17152
 v_mfma_f32_16x16x32_bf16 a[36:39], a[172:175], v[100:103], a[36:39]
 s_waitcnt lgkmcnt(8)
 buffer_load_dwordx4 v16, s[20:23], s56 offen offset:0 nt lds
 ds_write_b64 v21, v[172:173] offset:0
 v_mfma_f32_16x16x32_bf16 a[16:19], a[176:179], v[100:103], a[16:19]
 ds_read_b64_tr_b16 a[168:169], v2 offset:17184
 ds_read_b64_tr_b16 a[170:171], v4 offset:17184
 v_mfma_f32_16x16x32_bf16 a[136:139], a[176:179], v[132:135], a[136:139]
 v_exp_f32 v140, v140
 v_mfma_f32_16x16x32_bf16 a[24:27], a[176:179], v[116:119], a[24:27]
 v_exp_f32 v141, v141
 v_mfma_f32_16x16x32_bf16 a[56:59], a[180:183], v[116:119], a[56:59]
 ds_read_b64_tr_b16 a[172:173], v3 offset:17184
 ds_read_b64_tr_b16 a[174:175], v5 offset:17184
 v_mfma_f32_16x16x32_bf16 a[48:51], a[180:183], v[100:103], a[48:51]
 s_waitcnt lgkmcnt(9)
 v_exp_f32 v142, v142
 v_mfma_f32_16x16x32_bf16 a[20:23], a[184:187], v[100:103], a[20:23]
 s_add_u32 m0, s40, 0x16820
 ds_read_b64_tr_b16 a[176:177], v2 offset:17216
 ds_read_b64_tr_b16 a[178:179], v4 offset:17216
 v_mfma_f32_16x16x32_bf16 a[140:143], a[184:187], v[132:135], a[140:143]
 s_waitcnt vmcnt(4)
 v_exp_f32 v143, v143
 v_mfma_f32_16x16x32_bf16 a[28:31], a[184:187], v[116:119], a[28:31]
 buffer_load_dwordx4 v16, s[20:23], s56 offen offset:512 nt lds
 v_add_f32 v32, v32, v140
 v_mfma_f32_16x16x32_bf16 a[60:63], a[188:191], v[116:119], a[60:63]
 ds_read_b64_tr_b16 a[180:181], v3 offset:17216
 ds_read_b64_tr_b16 a[182:183], v5 offset:17216
 v_mfma_f32_16x16x32_bf16 a[52:55], a[188:191], v[100:103], a[52:55]
 s_waitcnt lgkmcnt(9)
 v_exp_f32 v148, v148
 v_mfma_f32_16x16x32_bf16 a[64:67], a[160:163], v[100:103], a[64:67]
 ds_read_b64_tr_b16 a[184:185], v2 offset:17248
 ds_read_b64_tr_b16 a[186:187], v4 offset:17248
 v_mfma_f32_16x16x32_bf16 a[144:147], a[160:163], v[132:135], a[144:147]
 v_exp_f32 v149, v149
 v_mfma_f32_16x16x32_bf16 a[72:75], a[160:163], v[116:119], a[72:75]
 v_exp_f32 v150, v150
 v_mfma_f32_16x16x32_bf16 a[104:107], a[164:167], v[116:119], a[104:107]
 ds_read_b64_tr_b16 a[188:189], v3 offset:17248
 ds_read_b64_tr_b16 a[190:191], v5 offset:17248
 v_mfma_f32_16x16x32_bf16 a[96:99], a[164:167], v[100:103], a[96:99]
 s_waitcnt lgkmcnt(8)
 v_exp_f32 v151, v151
 v_mfma_f32_16x16x32_bf16 a[68:71], a[168:171], v[100:103], a[68:71]
 s_barrier
 ds_read_b128 a[160:163], v6 offset:0
 v_mfma_f32_16x16x32_bf16 a[148:151], a[168:171], v[132:135], a[148:151]
 v_exp_f32 v156, v156
 v_mfma_f32_16x16x32_bf16 a[76:79], a[168:171], v[116:119], a[76:79]
 v_exp_f32 v157, v157
 v_mfma_f32_16x16x32_bf16 a[108:111], a[172:175], v[116:119], a[108:111]
 ds_read_b128 a[164:167], v6 offset:64
 v_add_f32 v32, v32, v141
 v_mfma_f32_16x16x32_bf16 a[100:103], a[172:175], v[100:103], a[100:103]
 s_waitcnt lgkmcnt(6)
 v_exp_f32 v158, v158
 v_mfma_f32_16x16x32_bf16 a[80:83], a[176:179], v[100:103], a[80:83]
 s_xor_b32 s56, s43, 0x10000
 ds_read_b128 a[168:171], v8 offset:0
 v_cvt_pk_bf16_f32 v140, v140, v141
 v_mfma_f32_16x16x32_bf16 a[152:155], a[176:179], v[132:135], a[152:155]
 s_add_u32 m0, s40, 0x16a40
 v_exp_f32 v159, v159
 v_mfma_f32_16x16x32_bf16 a[88:91], a[176:179], v[116:119], a[88:91]
 s_waitcnt vmcnt(4)
 v_exp_f32 v164, v164
 v_mfma_f32_16x16x32_bf16 a[120:123], a[180:183], v[116:119], a[120:123]
 ds_read_b128 a[172:175], v8 offset:64
 buffer_load_dwordx4 v16, s[20:23], s56 offen offset:1024 nt lds
 v_mfma_f32_16x16x32_bf16 a[112:115], a[180:183], v[100:103], a[112:115]
 s_waitcnt lgkmcnt(4)
 v_exp_f32 v165, v165
 v_mfma_f32_16x16x32_bf16 a[84:87], a[184:187], v[100:103], a[84:87]
 ds_read_b128 a[176:179], v7 offset:0
 v_add_f32 v32, v32, v142
 v_mfma_f32_16x16x32_bf16 a[156:159], a[184:187], v[132:135], a[156:159]
 v_exp_f32 v166, v166
 v_mfma_f32_16x16x32_bf16 a[92:95], a[184:187], v[116:119], a[92:95]
 v_exp_f32 v167, v167
 v_mfma_f32_16x16x32_bf16 a[124:127], a[188:191], v[116:119], a[124:127]
 ds_read_b128 a[180:183], v7 offset:64
 v_add_f32 v32, v32, v143
 v_mfma_f32_16x16x32_bf16 a[116:119], a[188:191], v[100:103], a[116:119]
 s_waitcnt lgkmcnt(4)
 v_cvt_pk_bf16_f32 v141, v142, v143
 v_add_f32 v32, v32, v148
 v_mfma_f32_16x16x32_bf16 v[100:103], a[160:163], v[96:99], v[44:47]
 s_add_u32 m0, s40, 0x16c60
 ds_read_b128 a[184:187], v9 offset:0
 v_add_f32 v32, v32, v149
 v_mfma_f32_16x16x32_bf16 v[100:103], a[164:167], v[112:115], v[100:103]
 s_waitcnt vmcnt(4)
 v_cvt_pk_bf16_f32 v142, v148, v149
 v_add_f32 v32, v32, v150
 v_mfma_f32_16x16x32_bf16 v[116:119], a[164:167], v[120:123], v[48:51]
 buffer_load_dwordx4 v16, s[20:23], s56 offen offset:1536 nt lds
 v_add_f32 v32, v32, v151
 v_mfma_f32_16x16x32_bf16 v[116:119], a[160:163], v[104:107], v[116:119]
 ds_read_b128 a[188:191], v9 offset:64
 v_cvt_pk_bf16_f32 v143, v150, v151
 v_mfma_f32_16x16x32_bf16 v[132:135], a[160:163], v[224:227], v[52:55]
 v_add_f32 v33, v33, v156
 v_add_f32 v33, v33, v157
 v_mfma_f32_16x16x32_bf16 v[132:135], a[164:167], v[232:235], v[132:135]
 s_waitcnt lgkmcnt(4)
 v_cvt_pk_bf16_f32 v156, v156, v157
 v_add_f32 v33, v33, v158
 v_mfma_f32_16x16x32_bf16 v[108:111], a[168:171], v[96:99], v[44:47]
 ds_read_b128 a[160:163], v6 offset:256
 v_add_f32 v33, v33, v159
 v_mfma_f32_16x16x32_bf16 v[108:111], a[172:175], v[112:115], v[108:111]
 v_cvt_pk_bf16_f32 v157, v158, v159
 v_add_f32 v33, v33, v164
 v_mfma_f32_16x16x32_bf16 v[124:127], a[172:175], v[120:123], v[48:51]
 ds_read_b128 a[164:167], v6 offset:320
 v_add_f32 v33, v33, v165
 v_mfma_f32_16x16x32_bf16 v[124:127], a[168:171], v[104:107], v[124:127]
 s_waitcnt lgkmcnt(4)
 v_cvt_pk_bf16_f32 v158, v164, v165
 v_add_f32 v33, v33, v166
 v_mfma_f32_16x16x32_bf16 v[100:103], a[176:179], v[128:131], v[100:103]
 s_xor_b32 s56, s42, 0x1c000
 ds_read_b128 a[168:171], v8 offset:256
 v_add_f32 v33, v33, v167
 v_mfma_f32_16x16x32_bf16 v[100:103], a[180:183], v[144:147], v[100:103]
 s_add_u32 m0, s40, 0xc600
 v_cvt_pk_bf16_f32 v159, v166, v167
 v_mfma_f32_16x16x32_bf16 v[116:119], a[180:183], v[152:155], v[116:119]
 s_waitcnt vmcnt(3)
 v_exp_f32 v72, v72
 v_mfma_f32_16x16x32_bf16 v[116:119], a[176:179], v[136:139], v[116:119]
 ds_read_b128 a[172:175], v8 offset:320
 buffer_load_dwordx4 v16, s[16:19], s56 offen offset:0 nt lds
 v_mfma_f32_16x16x32_bf16 v[132:135], a[176:179], v[228:231], v[132:135]
 v_exp_f32 v73, v73
 v_mfma_f32_16x16x32_bf16 v[132:135], a[180:183], v[236:239], v[132:135]
 s_waitcnt lgkmcnt(4)
 v_exp_f32 v74, v74
 v_mfma_f32_16x16x32_bf16 v[108:111], a[184:187], v[128:131], v[108:111]
 ds_read_b128 a[176:179], v7 offset:256
 v_mfma_f32_16x16x32_bf16 v[108:111], a[188:191], v[144:147], v[108:111]
 v_exp_f32 v75, v75
 v_mfma_f32_16x16x32_bf16 v[124:127], a[188:191], v[152:155], v[124:127]
 ds_read_b128 a[180:183], v7 offset:320
 v_add_f32 v34, v34, v72
 v_mfma_f32_16x16x32_bf16 v[124:127], a[184:187], v[136:139], v[124:127]
 s_waitcnt lgkmcnt(4)
 v_add_f32 v34, v34, v73
 v_cvt_pk_bf16_f32 v72, v72, v73
 v_mfma_f32_16x16x32_bf16 v[100:103], a[160:163], v[160:163], v[100:103]
 ds_read_b128 a[184:187], v9 offset:256
 v_add_f32 v34, v34, v74
 v_mfma_f32_16x16x32_bf16 v[100:103], a[164:167], v[176:179], v[100:103]
 s_add_u32 m0, s40, 0xc820
 v_add_f32 v34, v34, v75
 v_cvt_pk_bf16_f32 v73, v74, v75
 v_mfma_f32_16x16x32_bf16 v[116:119], a[164:167], v[184:187], v[116:119]
 ds_write_b64 v21, v[72:73] offset:2048
 v_mfma_f32_16x16x32_bf16 v[116:119], a[160:163], v[168:171], v[116:119]
 ds_read_b128 a[188:191], v9 offset:320
 buffer_load_dwordx4 v16, s[16:19], s56 offen offset:512 nt lds
 v_mfma_f32_16x16x32_bf16 v[132:135], a[160:163], v[240:243], v[132:135]
 v_exp_f32 v56, v56
 v_mfma_f32_16x16x32_bf16 v[132:135], a[164:167], v[248:251], v[132:135]
 s_waitcnt lgkmcnt(5)
 v_exp_f32 v57, v57
 v_mfma_f32_16x16x32_bf16 v[108:111], a[168:171], v[160:163], v[108:111]
 s_waitcnt lgkmcnt(1)
 s_barrier
 ds_read_b64_tr_b16 a[160:161], v2 offset:33792
 ds_read_b64_tr_b16 a[162:163], v4 offset:33792
 v_mfma_f32_16x16x32_bf16 v[108:111], a[172:175], v[176:179], v[108:111]
 ds_read_b64 v[174:175], v22 offset:0
 v_add_f32 v32, v32, v56
 v_mfma_f32_16x16x32_bf16 v[124:127], a[172:175], v[184:187], v[124:127]
 ds_read_b64_tr_b16 a[164:165], v3 offset:33792
 ds_read_b64_tr_b16 a[166:167], v5 offset:33792
 v_mfma_f32_16x16x32_bf16 v[124:127], a[168:171], v[168:171], v[124:127]
 v_exp_f32 v58, v58
 v_mfma_f32_16x16x32_bf16 v[100:103], a[176:179], v[192:195], v[100:103]
 ds_read_b64_tr_b16 a[168:169], v2 offset:33824
 ds_read_b64_tr_b16 a[170:171], v4 offset:33824
 v_mfma_f32_16x16x32_bf16 v[100:103], a[180:183], v[208:211], v[100:103]
 v_exp_f32 v59, v59
 v_mfma_f32_16x16x32_bf16 v[116:119], a[180:183], v[216:219], v[116:119]
 v_exp_f32 v60, v60
 v_mfma_f32_16x16x32_bf16 v[116:119], a[176:179], v[200:203], v[116:119]
 ds_read_b64_tr_b16 a[172:173], v3 offset:33824
 ds_read_b64_tr_b16 a[174:175], v5 offset:33824
 v_mfma_f32_16x16x32_bf16 v[132:135], a[176:179], v[244:247], v[132:135]
 v_exp_f32 v61, v61
 v_mfma_f32_16x16x32_bf16 v[132:135], a[180:183], v[252:255], v[132:135]
 s_waitcnt lgkmcnt(9)
 v_exp_f32 v62, v62
 v_mfma_f32_16x16x32_bf16 v[108:111], a[184:187], v[192:195], v[108:111]
 s_xor_b32 s56, s42, 0x1c000
 ds_read_b64_tr_b16 a[176:177], v2 offset:33856
 ds_read_b64_tr_b16 a[178:179], v4 offset:33856
 v_mfma_f32_16x16x32_bf16 v[108:111], a[188:191], v[208:211], v[108:111]
 s_add_u32 m0, s40, 0xca40
 v_exp_f32 v63, v63
 v_mfma_f32_16x16x32_bf16 v[124:127], a[188:191], v[216:219], v[124:127]
 s_waitcnt vmcnt(4)
 ds_read_b64_tr_b16 a[180:181], v3 offset:33856
 ds_read_b64_tr_b16 a[182:183], v5 offset:33856
 v_mfma_f32_16x16x32_bf16 v[124:127], a[184:187], v[200:203], v[124:127]
 s_waitcnt lgkmcnt(8)
 buffer_load_dwordx4 v16, s[16:19], s56 offen offset:1024 nt lds
 v_add_f32 v32, v32, v57
 v_mfma_f32_16x16x32_bf16 a[0:3], a[160:163], v[140:143], a[0:3]
 ds_read_b64_tr_b16 a[184:185], v2 offset:33888
 ds_read_b64_tr_b16 a[186:187], v4 offset:33888
 v_mfma_f32_16x16x32_bf16 a[128:131], a[160:163], v[172:175], a[128:131]
 v_exp_f32 v64, v64
 v_mfma_f32_16x16x32_bf16 a[8:11], a[160:163], v[156:159], a[8:11]
 s_cbranch_vccnz L_stub_4_B1
L_stub_4_B1_ret:
 v_cvt_pk_bf16_f32 v56, v56, v57
 v_mfma_f32_16x16x32_bf16 a[40:43], a[164:167], v[156:159], a[40:43]
 ds_read_b64_tr_b16 a[188:189], v3 offset:33888
 ds_read_b64_tr_b16 a[190:191], v5 offset:33888
 v_mfma_f32_16x16x32_bf16 a[32:35], a[164:167], v[140:143], a[32:35]
 s_waitcnt lgkmcnt(8)
 v_exp_f32 v65, v65
 v_mfma_f32_16x16x32_bf16 a[4:7], a[168:171], v[140:143], a[4:7]
 s_add_u32 m0, s40, 0xcc60
 ds_read_b64_tr_b16 a[160:161], v2 offset:34048
 ds_read_b64_tr_b16 a[162:163], v4 offset:34048
 v_mfma_f32_16x16x32_bf16 a[132:135], a[168:171], v[172:175], a[132:135]
 s_waitcnt vmcnt(4)
 v_exp_f32 v66, v66
 v_mfma_f32_16x16x32_bf16 a[12:15], a[168:171], v[156:159], a[12:15]
 buffer_load_dwordx4 v16, s[16:19], s56 offen offset:1536 nt lds
 v_add_f32 v32, v32, v58
 v_mfma_f32_16x16x32_bf16 a[44:47], a[172:175], v[156:159], a[44:47]
 ds_read_b64_tr_b16 a[164:165], v3 offset:34048
 ds_read_b64_tr_b16 a[166:167], v5 offset:34048
 v_mfma_f32_16x16x32_bf16 a[36:39], a[172:175], v[140:143], a[36:39]
 s_waitcnt lgkmcnt(8)
 v_exp_f32 v67, v67
 v_mfma_f32_16x16x32_bf16 a[16:19], a[176:179], v[140:143], a[16:19]
 ds_read_b64_tr_b16 a[168:169], v2 offset:34080
 ds_read_b64_tr_b16 a[170:171], v4 offset:34080
 v_mfma_f32_16x16x32_bf16 a[136:139], a[176:179], v[172:175], a[136:139]
 v_exp_f32 v68, v68
 v_mfma_f32_16x16x32_bf16 a[24:27], a[176:179], v[156:159], a[24:27]
 v_exp_f32 v69, v69
 v_mfma_f32_16x16x32_bf16 a[56:59], a[180:183], v[156:159], a[56:59]
 ds_read_b64_tr_b16 a[172:173], v3 offset:34080
 ds_read_b64_tr_b16 a[174:175], v5 offset:34080
 v_mfma_f32_16x16x32_bf16 a[48:51], a[180:183], v[140:143], a[48:51]
 s_waitcnt lgkmcnt(8)
 v_exp_f32 v70, v70
 v_mfma_f32_16x16x32_bf16 a[20:23], a[184:187], v[140:143], a[20:23]
 s_xor_b32 s56, s43, 0x14000
 ds_read_b64_tr_b16 a[176:177], v2 offset:34112
 ds_read_b64_tr_b16 a[178:179], v4 offset:34112
 v_mfma_f32_16x16x32_bf16 a[140:143], a[184:187], v[172:175], a[140:143]
 s_add_u32 m0, s40, 0x1a800
 v_exp_f32 v71, v71
 v_mfma_f32_16x16x32_bf16 a[28:31], a[184:187], v[156:159], a[28:31]
 s_waitcnt vmcnt(4)
 v_add_f32 v32, v32, v59
 v_cvt_pk_bf16_f32 v57, v58, v59
 v_mfma_f32_16x16x32_bf16 a[60:63], a[188:191], v[156:159], a[60:63]
 ds_read_b64_tr_b16 a[180:181], v3 offset:34112
 ds_read_b64_tr_b16 a[182:183], v5 offset:34112
 v_mfma_f32_16x16x32_bf16 a[52:55], a[188:191], v[140:143], a[52:55]
 s_waitcnt lgkmcnt(8)
 buffer_load_dwordx4 v16, s[20:23], s56 offen offset:0 nt lds
 v_add_f32 v32, v32, v60
 v_mfma_f32_16x16x32_bf16 a[64:67], a[160:163], v[140:143], a[64:67]
 ds_read_b64_tr_b16 a[184:185], v2 offset:34144
 ds_read_b64_tr_b16 a[186:187], v4 offset:34144
 v_mfma_f32_16x16x32_bf16 a[144:147], a[160:163], v[172:175], a[144:147]
 v_add_f32 v32, v32, v61
 v_cvt_pk_bf16_f32 v58, v60, v61
 v_mfma_f32_16x16x32_bf16 a[72:75], a[160:163], v[156:159], a[72:75]
 v_add_f32 v32, v32, v62
 v_add_f32 v32, v32, v63
 v_mfma_f32_16x16x32_bf16 a[104:107], a[164:167], v[156:159], a[104:107]
 ds_read_b64_tr_b16 a[188:189], v3 offset:34144
 ds_read_b64_tr_b16 a[190:191], v5 offset:34144
 v_mfma_f32_16x16x32_bf16 a[96:99], a[164:167], v[140:143], a[96:99]
 s_waitcnt lgkmcnt(8)
 v_cvt_pk_bf16_f32 v59, v62, v63
 v_add_f32 v33, v33, v64
 v_mfma_f32_16x16x32_bf16 a[68:71], a[168:171], v[140:143], a[68:71]
 s_barrier
 ds_read_b128 a[160:163], v6 offset:16896
 v_mfma_f32_16x16x32_bf16 a[148:151], a[168:171], v[172:175], a[148:151]
 v_add_f32 v33, v33, v65
 v_cvt_pk_bf16_f32 v64, v64, v65
 v_mfma_f32_16x16x32_bf16 a[76:79], a[168:171], v[156:159], a[76:79]
 v_add_f32 v33, v33, v66
 v_add_f32 v33, v33, v67
 v_mfma_f32_16x16x32_bf16 a[108:111], a[172:175], v[156:159], a[108:111]
 ds_read_b128 a[164:167], v6 offset:16960
 v_cvt_pk_bf16_f32 v65, v66, v67
 v_mfma_f32_16x16x32_bf16 a[100:103], a[172:175], v[140:143], a[100:103]
 s_waitcnt lgkmcnt(6)
 v_add_f32 v33, v33, v68
 v_add_f32 v33, v33, v69
 v_mfma_f32_16x16x32_bf16 a[80:83], a[176:179], v[140:143], a[80:83]
 ds_read_b128 a[168:171], v8 offset:16896
 v_cvt_pk_bf16_f32 v66, v68, v69
 v_mfma_f32_16x16x32_bf16 a[152:155], a[176:179], v[172:175], a[152:155]
 s_xor_b32 s56, s43, 0x14000
 v_add_f32 v33, v33, v70
 v_add_f32 v33, v33, v71
 v_mfma_f32_16x16x32_bf16 a[88:91], a[176:179], v[156:159], a[88:91]
 s_add_u32 m0, s40, 0x1aa20
 v_cvt_pk_bf16_f32 v67, v70, v71
 v_mfma_f32_16x16x32_bf16 a[120:123], a[180:183], v[156:159], a[120:123]
 s_waitcnt vmcnt(4)
 ds_read_b128 a[172:175], v8 offset:16960
 v_mfma_f32_16x16x32_bf16 a[112:115], a[180:183], v[140:143], a[112:115]
 s_waitcnt lgkmcnt(4)
 buffer_load_dwordx4 v16, s[20:23], s56 offen offset:512 nt lds
 v_mfma_f32_16x16x32_bf16 a[84:87], a[184:187], v[140:143], a[84:87]
 ds_read_b128 a[176:179], v7 offset:16896
 v_mfma_f32_16x16x32_bf16 a[156:159], a[184:187], v[172:175], a[156:159]
 v_exp_f32 v132, v132
 v_mfma_f32_16x16x32_bf16 a[92:95], a[184:187], v[156:159], a[92:95]
 v_exp_f32 v133, v133
 v_mfma_f32_16x16x32_bf16 a[124:127], a[188:191], v[156:159], a[124:127]
 ds_read_b128 a[180:183], v7 offset:16960
 v_mfma_f32_16x16x32_bf16 a[116:119], a[188:191], v[140:143], a[116:119]
 s_waitcnt lgkmcnt(4)
 v_exp_f32 v134, v134
 v_mfma_f32_16x16x32_bf16 v[140:143], a[160:163], v[96:99], v[44:47]
 s_sub_u32 s51, s59, 1
 ds_read_b128 a[184:187], v9 offset:16896
 v_bfe_u32 v212, v0, 3, 3
 v_mfma_f32_16x16x32_bf16 v[140:143], a[164:167], v[112:115], v[140:143]
 s_add_u32 m0, s40, 0x1ac40
 v_exp_f32 v135, v135
 v_mfma_f32_16x16x32_bf16 v[156:159], a[164:167], v[120:123], v[48:51]
 s_waitcnt vmcnt(4)
 v_add_f32 v34, v34, v132
 v_add_f32 v34, v34, v133
 v_mfma_f32_16x16x32_bf16 v[156:159], a[160:163], v[104:107], v[156:159]
 s_and_b32 s51, s51, 7
 ds_read_b128 a[188:191], v9 offset:16960
 buffer_load_dwordx4 v16, s[20:23], s56 offen offset:1024 nt lds
 v_mfma_f32_16x16x32_bf16 v[172:175], a[160:163], v[224:227], v[52:55]
 s_lshl_b32 s52, s51, 10
 v_cvt_pk_bf16_f32 v132, v132, v133
 v_add_f32 v34, v34, v134
 v_mfma_f32_16x16x32_bf16 v[172:175], a[164:167], v[232:235], v[172:175]
 s_waitcnt lgkmcnt(4)
 v_add_f32 v34, v34, v135
 v_cvt_pk_bf16_f32 v133, v134, v135
 v_mfma_f32_16x16x32_bf16 v[148:151], a[168:171], v[96:99], v[44:47]
 s_add_u32 s52, s52, s46
 ds_read_b128 a[160:163], v6 offset:17152
 ds_write_b64 v21, v[132:133] offset:0
 v_mfma_f32_16x16x32_bf16 v[148:151], a[172:175], v[112:115], v[148:151]
 v_exp_f32 v100, v100
 v_mfma_f32_16x16x32_bf16 v[164:167], a[172:175], v[120:123], v[48:51]
 ds_read_b128 a[164:167], v6 offset:17216
 v_add_f32 v32, v32, v100
 v_mfma_f32_16x16x32_bf16 v[164:167], a[168:171], v[104:107], v[164:167]
 s_waitcnt lgkmcnt(5)
 v_exp_f32 v101, v101
 v_mfma_f32_16x16x32_bf16 v[140:143], a[176:179], v[128:131], v[140:143]
 ds_read_b128 a[168:171], v8 offset:17152
 v_add_f32 v32, v32, v101
 v_mfma_f32_16x16x32_bf16 v[140:143], a[180:183], v[144:147], v[140:143]
 v_exp_f32 v102, v102
 v_mfma_f32_16x16x32_bf16 v[156:159], a[180:183], v[152:155], v[156:159]
 s_add_u32 m0, s40, 0x1ae60
 v_exp_f32 v103, v103
 v_mfma_f32_16x16x32_bf16 v[156:159], a[176:179], v[136:139], v[156:159]
 s_waitcnt vmcnt(4)
 ds_read_b128 a[172:175], v8 offset:17216
 v_cvt_pk_bf16_f32 v100, v100, v101
 v_mfma_f32_16x16x32_bf16 v[172:175], a[176:179], v[228:231], v[172:175]
 buffer_load_dwordx4 v16, s[20:23], s56 offen offset:1536 nt lds
 v_add_f32 v32, v32, v102
 v_mfma_f32_16x16x32_bf16 v[172:175], a[180:183], v[236:239], v[172:175]
 s_waitcnt lgkmcnt(5)
 v_exp_f32 v108, v108
 v_mfma_f32_16x16x32_bf16 v[148:151], a[184:187], v[128:131], v[148:151]
 ds_read_b128 a[176:179], v7 offset:17152
 v_add_f32 v32, v32, v103
 v_mfma_f32_16x16x32_bf16 v[148:151], a[188:191], v[144:147], v[148:151]
 v_exp_f32 v109, v109
 v_mfma_f32_16x16x32_bf16 v[164:167], a[188:191], v[152:155], v[164:167]
 ds_read_b128 a[180:183], v7 offset:17216
 v_cvt_pk_bf16_f32 v101, v102, v103
 v_mfma_f32_16x16x32_bf16 v[164:167], a[184:187], v[136:139], v[164:167]
 s_waitcnt lgkmcnt(4)
 v_exp_f32 v110, v110
 v_mfma_f32_16x16x32_bf16 v[140:143], a[160:163], v[160:163], v[140:143]
 ds_read_b128 a[184:187], v9 offset:17152
 v_add_f32 v32, v32, v108
 v_mfma_f32_16x16x32_bf16 v[140:143], a[164:167], v[176:179], v[140:143]
 v_exp_f32 v111, v111
 v_mfma_f32_16x16x32_bf16 v[156:159], a[164:167], v[184:187], v[156:159]
 v_exp_f32 v116, v116
 v_mfma_f32_16x16x32_bf16 v[156:159], a[160:163], v[168:171], v[156:159]
 ds_read_b128 a[188:191], v9 offset:17216
 v_add_f32 v32, v32, v109
 v_mfma_f32_16x16x32_bf16 v[172:175], a[160:163], v[240:243], v[172:175]
 v_exp_f32 v117, v117
 v_mfma_f32_16x16x32_bf16 v[172:175], a[164:167], v[248:251], v[172:175]
 s_waitcnt lgkmcnt(4)
 v_exp_f32 v118, v118
 v_mfma_f32_16x16x32_bf16 v[148:151], a[168:171], v[160:163], v[148:151]
 s_barrier
 ds_read_b64_tr_b16 a[160:161], v2 offset:50688
 ds_read_b64_tr_b16 a[162:163], v4 offset:50688
 v_mfma_f32_16x16x32_bf16 v[148:151], a[172:175], v[176:179], v[148:151]
 s_xor_b32 s56, s42, 0x20000
 ds_read_b64 v[74:75], v22 offset:2048
 v_cvt_pk_bf16_f32 v102, v108, v109
 v_mfma_f32_16x16x32_bf16 v[164:167], a[172:175], v[184:187], v[164:167]
 s_add_u32 m0, s40, 0
 ds_read_b64_tr_b16 a[164:165], v3 offset:50688
 ds_read_b64_tr_b16 a[166:167], v5 offset:50688
 v_mfma_f32_16x16x32_bf16 v[164:167], a[168:171], v[168:171], v[164:167]
 s_waitcnt lgkmcnt(7)
 v_exp_f32 v119, v119
 v_mfma_f32_16x16x32_bf16 v[140:143], a[176:179], v[192:195], v[140:143]
 s_waitcnt vmcnt(3)
 ds_read_b64_tr_b16 a[168:169], v2 offset:50720
 ds_read_b64_tr_b16 a[170:171], v4 offset:50720
 v_mfma_f32_16x16x32_bf16 v[140:143], a[180:183], v[208:211], v[140:143]
 buffer_load_dwordx4 v16, s[16:19], s56 offen offset:0 nt lds
 v_add_f32 v32, v32, v110
 v_mfma_f32_16x16x32_bf16 v[156:159], a[180:183], v[216:219], v[156:159]
 v_exp_f32 v124, v124
 v_mfma_f32_16x16x32_bf16 v[156:159], a[176:179], v[200:203], v[156:159]
 ds_read_b64_tr_b16 a[172:173], v3 offset:50720
 ds_read_b64_tr_b16 a[174:175], v5 offset:50720
 v_mfma_f32_16x16x32_bf16 v[172:175], a[176:179], v[244:247], v[172:175]
 v_exp_f32 v125, v125
 v_mfma_f32_16x16x32_bf16 v[172:175], a[180:183], v[252:255], v[172:175]
 s_waitcnt lgkmcnt(9)
 v_exp_f32 v126, v126
 v_mfma_f32_16x16x32_bf16 v[148:151], a[184:187], v[192:195], v[148:151]
 ds_read_b64_tr_b16 a[176:177], v2 offset:50752
 ds_read_b64_tr_b16 a[178:179], v4 offset:50752
 v_mfma_f32_16x16x32_bf16 v[148:151], a[188:191], v[208:211], v[148:151]
 s_add_u32 m0, s40, 0x220
 v_exp_f32 v127, v127
 v_mfma_f32_16x16x32_bf16 v[164:167], a[188:191], v[216:219], v[164:167]
 ds_read_b64_tr_b16 a[180:181], v3 offset:50752
 ds_read_b64_tr_b16 a[182:183], v5 offset:50752
 v_mfma_f32_16x16x32_bf16 v[164:167], a[184:187], v[200:203], v[164:167]
 s_waitcnt lgkmcnt(8)
 buffer_load_dwordx4 v16, s[16:19], s56 offen offset:512 nt lds
 v_add_f32 v32, v32, v111
 v_mfma_f32_16x16x32_bf16 a[0:3], a[160:163], v[56:59], a[0:3]
 ds_read_b64_tr_b16 a[184:185], v2 offset:50784
 ds_read_b64_tr_b16 a[186:187], v4 offset:50784
 v_mfma_f32_16x16x32_bf16 a[128:131], a[160:163], v[72:75], a[128:131]
 v_cvt_pk_bf16_f32 v103, v110, v111
 v_add_f32 v33, v33, v116
 v_mfma_f32_16x16x32_bf16 a[8:11], a[160:163], v[64:67], a[8:11]
 s_cbranch_vccnz L_stub_5_B1
L_stub_5_B1_ret:
 v_add_f32 v33, v33, v117
 v_mfma_f32_16x16x32_bf16 a[40:43], a[164:167], v[64:67], a[40:43]
 ds_read_b64_tr_b16 a[188:189], v3 offset:50784
 ds_read_b64_tr_b16 a[190:191], v5 offset:50784
 v_mfma_f32_16x16x32_bf16 a[32:35], a[164:167], v[56:59], a[32:35]
 s_waitcnt lgkmcnt(8)
 v_cvt_pk_bf16_f32 v116, v116, v117
 v_add_f32 v33, v33, v118
 v_mfma_f32_16x16x32_bf16 a[4:7], a[168:171], v[56:59], a[4:7]
 ds_read_b64_tr_b16 a[160:161], v2 offset:50944
 ds_read_b64_tr_b16 a[162:163], v4 offset:50944
 v_mfma_f32_16x16x32_bf16 a[132:135], a[168:171], v[72:75], a[132:135]
 v_add_f32 v33, v33, v119
 v_cvt_pk_bf16_f32 v117, v118, v119
 v_mfma_f32_16x16x32_bf16 a[12:15], a[168:171], v[64:67], a[12:15]
 s_add_u32 m0, s40, 0x440
 v_add_f32 v33, v33, v124
 v_add_f32 v33, v33, v125
 v_mfma_f32_16x16x32_bf16 a[44:47], a[172:175], v[64:67], a[44:47]
 s_waitcnt vmcnt(4)
 ds_read_b64_tr_b16 a[164:165], v3 offset:50944
 ds_read_b64_tr_b16 a[166:167], v5 offset:50944
 v_mfma_f32_16x16x32_bf16 a[36:39], a[172:175], v[56:59], a[36:39]
 s_waitcnt lgkmcnt(8)
 buffer_load_dwordx4 v16, s[16:19], s56 offen offset:1024 nt lds
 v_cvt_pk_bf16_f32 v118, v124, v125
 v_mfma_f32_16x16x32_bf16 a[16:19], a[176:179], v[56:59], a[16:19]
 ds_read_b64_tr_b16 a[168:169], v2 offset:50976
 ds_read_b64_tr_b16 a[170:171], v4 offset:50976
 v_mfma_f32_16x16x32_bf16 a[136:139], a[176:179], v[72:75], a[136:139]
 v_add_f32 v33, v33, v126
 v_add_f32 v33, v33, v127
 v_mfma_f32_16x16x32_bf16 a[24:27], a[176:179], v[64:67], a[24:27]
 v_cvt_pk_bf16_f32 v119, v126, v127
 v_mul_u32_u24 v212, 0x3800, v212
 v_mfma_f32_16x16x32_bf16 a[56:59], a[180:183], v[64:67], a[56:59]
 ds_read_b64_tr_b16 a[172:173], v3 offset:50976
 ds_read_b64_tr_b16 a[174:175], v5 offset:50976
 v_mfma_f32_16x16x32_bf16 a[48:51], a[180:183], v[56:59], a[48:51]
 s_waitcnt lgkmcnt(8)
 v_exp_f32 v172, v172
 v_mfma_f32_16x16x32_bf16 a[20:23], a[184:187], v[56:59], a[20:23]
 ds_read_b64_tr_b16 a[176:177], v2 offset:51008
 ds_read_b64_tr_b16 a[178:179], v4 offset:51008
 v_mfma_f32_16x16x32_bf16 a[140:143], a[184:187], v[72:75], a[140:143]
 v_exp_f32 v173, v173
 v_mfma_f32_16x16x32_bf16 a[28:31], a[184:187], v[64:67], a[28:31]
 s_add_u32 m0, s40, 0x660
 v_exp_f32 v174, v174
 v_mfma_f32_16x16x32_bf16 a[60:63], a[188:191], v[64:67], a[60:63]
 s_waitcnt vmcnt(4)
 ds_read_b64_tr_b16 a[180:181], v3 offset:51008
 ds_read_b64_tr_b16 a[182:183], v5 offset:51008
 v_mfma_f32_16x16x32_bf16 a[52:55], a[188:191], v[56:59], a[52:55]
 s_waitcnt lgkmcnt(8)
 buffer_load_dwordx4 v16, s[16:19], s56 offen offset:1536 nt lds
 v_and_b32 v213, 7, v0
 v_mfma_f32_16x16x32_bf16 a[64:67], a[160:163], v[56:59], a[64:67]
 ds_read_b64_tr_b16 a[184:185], v2 offset:51040
 ds_read_b64_tr_b16 a[186:187], v4 offset:51040
 v_mfma_f32_16x16x32_bf16 a[144:147], a[160:163], v[72:75], a[144:147]
 v_exp_f32 v175, v175
 v_mfma_f32_16x16x32_bf16 a[72:75], a[160:163], v[64:67], a[72:75]
 v_add_f32 v34, v34, v172
 v_add_f32 v34, v34, v173
 v_mfma_f32_16x16x32_bf16 a[104:107], a[164:167], v[64:67], a[104:107]
 ds_read_b64_tr_b16 a[188:189], v3 offset:51040
 ds_read_b64_tr_b16 a[190:191], v5 offset:51040
 v_mfma_f32_16x16x32_bf16 a[96:99], a[164:167], v[56:59], a[96:99]
 s_waitcnt lgkmcnt(8)
 v_cvt_pk_bf16_f32 v172, v172, v173
 v_add_f32 v34, v34, v174
 v_mfma_f32_16x16x32_bf16 a[68:71], a[168:171], v[56:59], a[68:71]
 s_mov_b64 exec, 0
 s_cmp_eq_u32 s5, 0
 s_cbranch_scc1 L_pad16
 s_cmp_eq_u32 s5, 1
 s_cbranch_scc1 L_pad17
 s_cmp_eq_u32 s5, 2
 s_cbranch_scc1 L_pad18
 s_branch L_pad19
L_e3_back:
 s_mov_b64 exec, -1
 s_barrier
 ds_read_b128 a[160:163], v6 offset:33792
 v_mfma_f32_16x16x32_bf16 a[148:151], a[168:171], v[72:75], a[148:151]
 v_add_f32 v34, v34, v175
 v_cvt_pk_bf16_f32 v173, v174, v175
 v_mfma_f32_16x16x32_bf16 a[76:79], a[168:171], v[64:67], a[76:79]
 ds_write_b128 v19, v[80:83] offset:0
 ds_write_b64 v21, v[172:173] offset:2048
 v_mfma_f32_16x16x32_bf16 a[108:111], a[172:175], v[64:67], a[108:111]
 ds_read_b128 a[164:167], v6 offset:33856
 v_lshl_add_u32 v212, v213, 4, v212
 v_mfma_f32_16x16x32_bf16 a[100:103], a[172:175], v[56:59], a[100:103]
 s_waitcnt lgkmcnt(8)
 v_exp_f32 v140, v140
 v_mfma_f32_16x16x32_bf16 a[80:83], a[176:179], v[56:59], a[80:83]
 ds_read_b128 a[168:171], v8 offset:33792
 v_add_f32 v32, v32, v140
 v_mfma_f32_16x16x32_bf16 a[152:155], a[176:179], v[72:75], a[152:155]
 v_exp_f32 v141, v141
 v_mfma_f32_16x16x32_bf16 a[88:91], a[176:179], v[64:67], a[88:91]
 s_xor_b32 s56, s43, 0x18000
 v_exp_f32 v142, v142
 v_mfma_f32_16x16x32_bf16 a[120:123], a[180:183], v[64:67], a[120:123]
 s_add_u32 m0, s40, 0x1ea00
 ds_read_b128 a[172:175], v8 offset:33856
 v_add_f32 v32, v32, v141
 v_mfma_f32_16x16x32_bf16 a[112:115], a[180:183], v[56:59], a[112:115]
 s_waitcnt lgkmcnt(6)
 v_exp_f32 v143, v143
 v_mfma_f32_16x16x32_bf16 a[84:87], a[184:187], v[56:59], a[84:87]
 s_waitcnt vmcnt(4)
 ds_read_b128 a[176:179], v7 offset:33792
 v_cvt_pk_bf16_f32 v140, v140, v141
 v_mfma_f32_16x16x32_bf16 a[156:159], a[184:187], v[72:75], a[156:159]
 buffer_load_dwordx4 v16, s[20:23], s56 offen offset:0 nt lds
 v_add_f32 v32, v32, v142
 v_mfma_f32_16x16x32_bf16 a[92:95], a[184:187], v[64:67], a[92:95]
 v_exp_f32 v148, v148
 v_mfma_f32_16x16x32_bf16 a[124:127], a[188:191], v[64:67], a[124:127]
 ds_read_b128 a[180:183], v7 offset:33856
 v_add_f32 v32, v32, v143
 v_mfma_f32_16x16x32_bf16 a[116:119], a[188:191], v[56:59], a[116:119]
 s_waitcnt lgkmcnt(4)
 v_exp_f32 v149, v149
 v_mfma_f32_16x16x32_bf16 v[56:59], a[160:163], v[96:99], v[44:47]
 ds_read_b128 a[184:187], v9 offset:33792
 v_cvt_pk_bf16_f32 v141, v142, v143
 v_mfma_f32_16x16x32_bf16 v[56:59], a[164:167], v[112:115], v[56:59]
L_pad15:
 s_cbranch_execz L_e2_back
 v_exp_f32 v150, v150
 v_mfma_f32_16x16x32_bf16 v[64:67], a[164:167], v[120:123], v[48:51]
 v_exp_f32 v151, v151
 v_mfma_f32_16x16x32_bf16 v[64:67], a[160:163], v[104:107], v[64:67]
 s_add_u32 m0, s40, 0x1ec20
 ds_read_b128 a[188:191], v9 offset:33856
 v_add_f32 v32, v32, v148
 v_mfma_f32_16x16x32_bf16 v[72:75], a[160:163], v[224:227], v[52:55]
 s_waitcnt vmcnt(4)
 v_exp_f32 v156, v156
 v_mfma_f32_16x16x32_bf16 v[72:75], a[164:167], v[232:235], v[72:75]
 s_waitcnt lgkmcnt(4)
 buffer_load_dwordx4 v16, s[20:23], s56 offen offset:512 nt lds
 v_add_f32 v32, v32, v149
 v_mfma_f32_16x16x32_bf16 v[60:63], a[168:171], v[96:99], v[44:47]
 ds_read_b128 a[160:163], v6 offset:34048
 v_cvt_pk_bf16_f32 v142, v148, v149
 v_mfma_f32_16x16x32_bf16 v[60:63], a[172:175], v[112:115], v[60:63]
 v_exp_f32 v157, v157
 v_mfma_f32_16x16x32_bf16 v[68:71], a[172:175], v[120:123], v[48:51]
 ds_read_b128 a[164:167], v6 offset:34112
 v_add_f32 v32, v32, v150
 v_mfma_f32_16x16x32_bf16 v[68:71], a[168:171], v[104:107], v[68:71]
 s_waitcnt lgkmcnt(4)
 v_exp_f32 v158, v158
 v_mfma_f32_16x16x32_bf16 v[56:59], a[176:179], v[128:131], v[56:59]
 ds_read_b128 a[168:171], v8 offset:34048
 v_add_f32 v32, v32, v151
 v_mfma_f32_16x16x32_bf16 v[56:59], a[180:183], v[144:147], v[56:59]
 v_exp_f32 v159, v159
 v_mfma_f32_16x16x32_bf16 v[64:67], a[180:183], v[152:155], v[64:67]
 v_exp_f32 v164, v164
 v_mfma_f32_16x16x32_bf16 v[64:67], a[176:179], v[136:139], v[64:67]
 s_add_u32 m0, s40, 0x1ee40
 ds_read_b128 a[172:175], v8 offset:34112
 v_cvt_pk_bf16_f32 v143, v150, v151
 v_mfma_f32_16x16x32_bf16 v[72:75], a[176:179], v[228:231], v[72:75]
 s_waitcnt vmcnt(4)
 v_exp_f32 v165, v165
 v_mfma_f32_16x16x32_bf16 v[72:75], a[180:183], v[236:239], v[72:75]
 s_waitcnt lgkmcnt(4)
 buffer_load_dwordx4 v16, s[20:23], s56 offen offset:1024 nt lds
 v_add_f32 v33, v33, v156
 v_mfma_f32_16x16x32_bf16 v[60:63], a[184:187], v[128:131], v[60:63]
 ds_read_b128 a[176:179], v7 offset:34048
 v_add_f32 v33, v33, v157
 v_mfma_f32_16x16x32_bf16 v[60:63], a[188:191], v[144:147], v[60:63]
 v_exp_f32 v166, v166
 v_mfma_f32_16x16x32_bf16 v[68:71], a[188:191], v[152:155], v[68:71]
 ds_read_b128 a[180:183], v7 offset:34112
 v_cvt_pk_bf16_f32 v156, v156, v157
 v_mfma_f32_16x16x32_bf16 v[68:71], a[184:187], v[136:139], v[68:71]
 s_waitcnt lgkmcnt(4)
 v_exp_f32 v167, v167
 v_mfma_f32_16x16x32_bf16 v[56:59], a[160:163], v[160:163], v[56:59]
 ds_read_b128 a[184:187], v9 offset:34048
 v_add_f32 v33, v33, v158
 v_mfma_f32_16x16x32_bf16 v[56:59], a[164:167], v[176:179], v[56:59]
 v_add_f32 v33, v33, v159
 v_cvt_pk_bf16_f32 v157, v158, v159
 v_mfma_f32_16x16x32_bf16 v[64:67], a[164:167], v[184:187], v[64:67]
 v_add_f32 v33, v33, v164
 v_add_f32 v33, v33, v165
 v_mfma_f32_16x16x32_bf16 v[64:67], a[160:163], v[168:171], v[64:67]
 ds_read_b128 a[188:191], v9 offset:34112
 v_cvt_pk_bf16_f32 v158, v164, v165
 v_mfma_f32_16x16x32_bf16 v[72:75], a[160:163], v[240:243], v[72:75]
 v_add_f32 v33, v33, v166
 v_add_f32 v33, v33, v167
 v_mfma_f32_16x16x32_bf16 v[72:75], a[164:167], v[248:251], v[72:75]
 s_waitcnt lgkmcnt(4)
 v_cvt_pk_bf16_f32 v159, v166, v167
 v_add_u32 v17, s61, v212
 v_mfma_f32_16x16x32_bf16 v[60:63], a[168:171], v[160:163], v[60:63]
 s_barrier
 ds_read_b64_tr_b16 a[160:161], v2 offset:0
 ds_read_b64_tr_b16 a[162:163], v4 offset:0
 v_mfma_f32_16x16x32_bf16 v[60:63], a[172:175], v[176:179], v[60:63]
 ds_read_b64 v[134:135], v22 offset:0
 v_bfe_u32 v212, v0, 2, 4
 v_mfma_f32_16x16x32_bf16 v[68:71], a[172:175], v[184:187], v[68:71]
 ds_read_b64_tr_b16 a[164:165], v3 offset:0
 ds_read_b64_tr_b16 a[166:167], v5 offset:0
 v_mfma_f32_16x16x32_bf16 v[68:71], a[168:171], v[168:171], v[68:71]
 s_waitcnt lgkmcnt(7)
 v_mul_u32_u24 v212, 0x420, v212
 v_and_b32 v213, 3, v0
 v_mfma_f32_16x16x32_bf16 v[56:59], a[176:179], v[192:195], v[56:59]
 s_xor_b32 s56, s43, 0x18000
 ds_read_b64_tr_b16 a[168:169], v2 offset:32
 ds_read_b64_tr_b16 a[170:171], v4 offset:32
 v_mfma_f32_16x16x32_bf16 v[56:59], a[180:183], v[208:211], v[56:59]
 s_add_u32 m0, s40, 0x1f060
 v_lshl_add_u32 v212, v213, 3, v212
 v_add_u32 v18, 0x1000, v1
 v_mfma_f32_16x16x32_bf16 v[64:67], a[180:183], v[216:219], v[64:67]
 s_waitcnt vmcnt(4)
 v_and_b32 v196, 15, v0
 v_mul_u32_u24 v196, 0x700, v196
 v_mfma_f32_16x16x32_bf16 v[64:67], a[176:179], v[200:203], v[64:67]
 ds_read_b64_tr_b16 a[172:173], v3 offset:32
 ds_read_b64_tr_b16 a[174:175], v5 offset:32
 v_mfma_f32_16x16x32_bf16 v[72:75], a[176:179], v[244:247], v[72:75]
 buffer_load_dwordx4 v16, s[20:23], s56 offen offset:1536 nt lds
 v_bfe_u32 v197, v0, 4, 2
 v_mfma_f32_16x16x32_bf16 v[72:75], a[180:183], v[252:255], v[72:75]
 s_waitcnt lgkmcnt(9)
 v_lshl_add_u32 v10, v197, 4, v196
 v_and_b32 v196, 1, v0
 v_mfma_f32_16x16x32_bf16 v[60:63], a[184:187], v[192:195], v[60:63]
 ds_read_b64_tr_b16 a[176:177], v2 offset:64
 ds_read_b64_tr_b16 a[178:179], v4 offset:64
 v_mfma_f32_16x16x32_bf16 v[60:63], a[188:191], v[208:211], v[60:63]
 v_lshlrev_b32 v196, 4, v196
 v_mov_b32 v198, 0x3f80
 v_mfma_f32_16x16x32_bf16 v[68:71], a[188:191], v[216:219], v[68:71]
 ds_read_b64_tr_b16 a[180:181], v3 offset:64
 ds_read_b64_tr_b16 a[182:183], v5 offset:64
 v_mfma_f32_16x16x32_bf16 v[68:71], a[184:187], v[200:203], v[68:71]
 s_waitcnt lgkmcnt(8)
 v_lshlrev_b32 v196, v196, v198
 v_bfe_u32 v198, v0, 1, 3
 v_mfma_f32_16x16x32_bf16 a[0:3], a[160:163], v[100:103], a[0:3]
 s_xor_b32 s56, s42, 0x24000
 ds_read_b64_tr_b16 a[184:185], v2 offset:96
 ds_read_b64_tr_b16 a[186:187], v4 offset:96
 v_mfma_f32_16x16x32_bf16 a[128:131], a[160:163], v[132:135], a[128:131]
 s_add_u32 m0, s40, 0x4200
 v_and_b32 v199, 6, v198
 v_add_u32 v198, v199, v198
 v_mfma_f32_16x16x32_bf16 a[8:11], a[160:163], v[116:119], a[8:11]
 s_cbranch_vccnz L_stub_6_B1
L_stub_6_B1_ret:
 v_lshlrev_b32 v197, 1, v197
 v_mfma_f32_16x16x32_bf16 a[40:43], a[164:167], v[116:119], a[40:43]
 s_waitcnt vmcnt(3)
 ds_read_b64_tr_b16 a[188:189], v3 offset:96
 ds_read_b64_tr_b16 a[190:191], v5 offset:96
 v_mfma_f32_16x16x32_bf16 a[32:35], a[164:167], v[100:103], a[32:35]
 s_waitcnt lgkmcnt(8)
 buffer_load_dwordx4 v16, s[16:19], s56 offen offset:0 nt lds
 v_sub_u32 v198, v198, v197
 v_mfma_f32_16x16x32_bf16 a[4:7], a[168:171], v[100:103], a[4:7]
 ds_read_b64_tr_b16 a[160:161], v2 offset:256
 ds_read_b64_tr_b16 a[162:163], v4 offset:256
 v_mfma_f32_16x16x32_bf16 a[132:135], a[168:171], v[132:135], a[132:135]
 v_exp_f32 v72, v72
 v_mfma_f32_16x16x32_bf16 a[12:15], a[168:171], v[116:119], a[12:15]
 v_exp_f32 v73, v73
 v_mfma_f32_16x16x32_bf16 a[44:47], a[172:175], v[116:119], a[44:47]
 ds_read_b64_tr_b16 a[164:165], v3 offset:256
 ds_read_b64_tr_b16 a[166:167], v5 offset:256
 v_mfma_f32_16x16x32_bf16 a[36:39], a[172:175], v[100:103], a[36:39]
 s_waitcnt lgkmcnt(8)
 v_exp_f32 v74, v74
 v_mfma_f32_16x16x32_bf16 a[16:19], a[176:179], v[100:103], a[16:19]
 s_add_u32 m0, s40, 0x4420
 ds_read_b64_tr_b16 a[168:169], v2 offset:288
 ds_read_b64_tr_b16 a[170:171], v4 offset:288
 v_mfma_f32_16x16x32_bf16 a[136:139], a[176:179], v[132:135], a[136:139]
 v_exp_f32 v75, v75
 v_mfma_f32_16x16x32_bf16 a[24:27], a[176:179], v[116:119], a[24:27]
 buffer_load_dwordx4 v16, s[16:19], s56 offen offset:512 nt lds
 v_add_f32 v34, v34, v72
 v_mfma_f32_16x16x32_bf16 a[56:59], a[180:183], v[116:119], a[56:59]
 ds_read_b64_tr_b16 a[172:173], v3 offset:288
 ds_read_b64_tr_b16 a[174:175], v5 offset:288
 v_mfma_f32_16x16x32_bf16 a[48:51], a[180:183], v[100:103], a[48:51]
 s_waitcnt lgkmcnt(8)
 v_add_f32 v34, v34, v73
 v_cvt_pk_bf16_f32 v72, v72, v73
 v_mfma_f32_16x16x32_bf16 a[20:23], a[184:187], v[100:103], a[20:23]
 ds_read_b64_tr_b16 a[176:177], v2 offset:320
 ds_read_b64_tr_b16 a[178:179], v4 offset:320
 v_mfma_f32_16x16x32_bf16 a[140:143], a[184:187], v[132:135], a[140:143]
 v_add_f32 v34, v34, v74
 v_add_f32 v34, v34, v75
 v_mfma_f32_16x16x32_bf16 a[28:31], a[184:187], v[116:119], a[28:31]
 v_cvt_pk_bf16_f32 v73, v74, v75
 v_cmp_eq_u32_e64 s[74:75], 0, v198
 v_mfma_f32_16x16x32_bf16 a[60:63], a[188:191], v[116:119], a[60:63]
 ds_read_b64_tr_b16 a[180:181], v3 offset:320
 ds_read_b64_tr_b16 a[182:183], v5 offset:320
 v_mfma_f32_16x16x32_bf16 a[52:55], a[188:191], v[100:103], a[52:55]
 s_waitcnt lgkmcnt(8)
 v_exp_f32 v56, v56
 v_mfma_f32_16x16x32_bf16 a[64:67], a[160:163], v[100:103], a[64:67]
 s_add_u32 m0, s40, 0x4640
 ds_read_b64_tr_b16 a[184:185], v2 offset:352
 ds_read_b64_tr_b16 a[186:187], v4 offset:352
 v_mfma_f32_16x16x32_bf16 a[144:147], a[160:163], v[132:135], a[144:147]
 s_waitcnt vmcnt(4)
 v_exp_f32 v57, v57
 v_mfma_f32_16x16x32_bf16 a[72:75], a[160:163], v[116:119], a[72:75]
 buffer_load_dwordx4 v16, s[16:19], s56 offen offset:1024 nt lds
 v_add_f32 v32, v32, v56
 v_mfma_f32_16x16x32_bf16 a[104:107], a[164:167], v[116:119], a[104:107]
 ds_read_b64_tr_b16 a[188:189], v3 offset:352
 ds_read_b64_tr_b16 a[190:191], v5 offset:352
 v_mfma_f32_16x16x32_bf16 a[96:99], a[164:167], v[100:103], a[96:99]
 s_waitcnt lgkmcnt(8)
 v_exp_f32 v58, v58
 v_mfma_f32_16x16x32_bf16 a[68:71], a[168:171], v[100:103], a[68:71]
 s_barrier
 ds_read_b128 a[160:163], v6 offset:50688
 v_mfma_f32_16x16x32_bf16 a[148:151], a[168:171], v[132:135], a[148:151]
 ds_write_b64 v21, v[72:73] offset:0
 v_add_f32 v32, v32, v57
 v_mfma_f32_16x16x32_bf16 a[76:79], a[168:171], v[116:119], a[76:79]
 ds_write_b128 v19, v[84:87] offset:1024
 v_cvt_pk_bf16_f32 v56, v56, v57
 v_mfma_f32_16x16x32_bf16 a[108:111], a[172:175], v[116:119], a[108:111]
 ds_read_b128 a[164:167], v6 offset:50752
 v_add_f32 v32, v32, v58
 v_mfma_f32_16x16x32_bf16 a[100:103], a[172:175], v[100:103], a[100:103]
 s_waitcnt lgkmcnt(8)
 v_exp_f32 v59, v59
 v_mfma_f32_16x16x32_bf16 a[80:83], a[176:179], v[100:103], a[80:83]
 ds_read_b128 a[168:171], v8 offset:50688
 v_add_f32 v32, v32, v59
 v_mfma_f32_16x16x32_bf16 a[152:155], a[176:179], v[132:135], a[152:155]
 v_exp_f32 v60, v60
 v_mfma_f32_16x16x32_bf16 a[88:91], a[176:179], v[116:119], a[88:91]
 v_exp_f32 v61, v61
 v_mfma_f32_16x16x32_bf16 a[120:123], a[180:183], v[116:119], a[120:123]
 ds_read_b128 a[172:175], v8 offset:50752
 v_cvt_pk_bf16_f32 v57, v58, v59
 v_mfma_f32_16x16x32_bf16 a[112:115], a[180:183], v[100:103], a[112:115]
 s_waitcnt lgkmcnt(6)
 v_exp_f32 v62, v62
 v_mfma_f32_16x16x32_bf16 a[84:87], a[184:187], v[100:103], a[84:87]
 s_xor_b32 s56, s42, 0x24000
 ds_read_b128 a[176:179], v7 offset:50688
 v_add_f32 v32, v32, v60
 v_mfma_f32_16x16x32_bf16 a[156:159], a[184:187], v[132:135], a[156:159]
 s_add_u32 m0, s40, 0x4860
 v_exp_f32 v63, v63
 v_mfma_f32_16x16x32_bf16 a[92:95], a[184:187], v[116:119], a[92:95]
 s_waitcnt vmcnt(4)
 v_exp_f32 v64, v64
 v_mfma_f32_16x16x32_bf16 a[124:127], a[188:191], v[116:119], a[124:127]
 ds_read_b128 a[180:183], v7 offset:50752
 buffer_load_dwordx4 v16, s[16:19], s56 offen offset:1536 nt lds
 v_mfma_f32_16x16x32_bf16 a[116:119], a[188:191], v[100:103], a[116:119]
 s_waitcnt lgkmcnt(4)
 v_exp_f32 v65, v65
 v_mfma_f32_16x16x32_bf16 v[100:103], a[160:163], v[96:99], v[44:47]
 ds_read_b128 a[184:187], v9 offset:50688
 v_add_f32 v32, v32, v61
 v_mfma_f32_16x16x32_bf16 v[100:103], a[164:167], v[112:115], v[100:103]
 v_exp_f32 v66, v66
 v_mfma_f32_16x16x32_bf16 v[116:119], a[164:167], v[120:123], v[48:51]
 v_exp_f32 v67, v67
 v_mfma_f32_16x16x32_bf16 v[116:119], a[160:163], v[104:107], v[116:119]
 ds_read_b128 a[188:191], v9 offset:50752
 v_cvt_pk_bf16_f32 v58, v60, v61
 v_mfma_f32_16x16x32_bf16 v[132:135], a[160:163], v[224:227], v[52:55]
 v_exp_f32 v68, v68
 v_mfma_f32_16x16x32_bf16 v[132:135], a[164:167], v[232:235], v[132:135]
 s_waitcnt lgkmcnt(4)
 v_exp_f32 v69, v69
 v_mfma_f32_16x16x32_bf16 v[108:111], a[168:171], v[96:99], v[44:47]
 s_xor_b32 s56, s43, 0x1c000
 ds_read_b128 a[160:163], v6 offset:50944
 v_add_f32 v32, v32, v62
 v_mfma_f32_16x16x32_bf16 v[108:111], a[172:175], v[112:115], v[108:111]
 s_add_u32 m0, s40, 0x22c00
 v_exp_f32 v70, v70
 v_mfma_f32_16x16x32_bf16 v[124:127], a[172:175], v[120:123], v[48:51]
 s_waitcnt vmcnt(4)
 ds_read_b128 a[164:167], v6 offset:51008
 v_add_f32 v32, v32, v63
 v_mfma_f32_16x16x32_bf16 v[124:127], a[168:171], v[104:107], v[124:127]
 s_waitcnt lgkmcnt(4)
 buffer_load_dwordx4 v16, s[20:23], s56 offen offset:0 nt lds
 v_cvt_pk_bf16_f32 v59, v62, v63
 v_mfma_f32_16x16x32_bf16 v[100:103], a[176:179], v[128:131], v[100:103]
 ds_read_b128 a[168:171], v8 offset:50944
 v_add_f32 v33, v33, v64
 v_mfma_f32_16x16x32_bf16 v[100:103], a[180:183], v[144:147], v[100:103]
 v_exp_f32 v71, v71
 v_mfma_f32_16x16x32_bf16 v[116:119], a[180:183], v[152:155], v[116:119]
 v_add_f32 v33, v33, v65
 v_cvt_pk_bf16_f32 v64, v64, v65
 v_mfma_f32_16x16x32_bf16 v[116:119], a[176:179], v[136:139], v[116:119]
 ds_read_b128 a[172:175], v8 offset:51008
 v_add_f32 v33, v33, v66
 v_mfma_f32_16x16x32_bf16 v[132:135], a[176:179], v[228:231], v[132:135]
 v_add_f32 v33, v33, v67
 v_cvt_pk_bf16_f32 v65, v66, v67
 v_mfma_f32_16x16x32_bf16 v[132:135], a[180:183], v[236:239], v[132:135]
 s_waitcnt lgkmcnt(4)
 v_add_f32 v33, v33, v68
 v_add_f32 v33, v33, v69
 v_mfma_f32_16x16x32_bf16 v[108:111], a[184:187], v[128:131], v[108:111]
 s_add_u32 m0, s40, 0x22e20
 ds_read_b128 a[176:179], v7 offset:50944
 v_cvt_pk_bf16_f32 v66, v68, v69
 v_mfma_f32_16x16x32_bf16 v[108:111], a[188:191], v[144:147], v[108:111]
 s_waitcnt vmcnt(4)
 v_add_f32 v33, v33, v70
 v_add_f32 v33, v33, v71
 v_mfma_f32_16x16x32_bf16 v[124:127], a[188:191], v[152:155], v[124:127]
 ds_read_b128 a[180:183], v7 offset:51008
 buffer_load_dwordx4 v16, s[20:23], s56 offen offset:512 nt lds
 v_mfma_f32_16x16x32_bf16 v[124:127], a[184:187], v[136:139], v[124:127]
 s_waitcnt lgkmcnt(4)
 v_cvt_pk_bf16_f32 v67, v70, v71
 v_cndmask_b32_e64 v12, 0, v196, s[74:75]
 v_mfma_f32_16x16x32_bf16 v[100:103], a[160:163], v[160:163], v[100:103]
 ds_read_b128 a[184:187], v9 offset:50944
 v_cmp_eq_u32_e64 s[74:75], 1, v198
 v_mfma_f32_16x16x32_bf16 v[100:103], a[164:167], v[176:179], v[100:103]
 s_nop 0
 v_cndmask_b32_e64 v13, 0, v196, s[74:75]
 v_cmp_eq_u32_e64 s[74:75], 8, v198
 v_mfma_f32_16x16x32_bf16 v[116:119], a[164:167], v[184:187], v[116:119]
 s_nop 0
 v_cndmask_b32_e64 v14, 0, v196, s[74:75]
 v_cmp_eq_u32_e64 s[74:75], 9, v198
 v_mfma_f32_16x16x32_bf16 v[116:119], a[160:163], v[168:171], v[116:119]
 ds_read_b128 a[188:191], v9 offset:51008
 v_cndmask_b32_e64 v15, 0, v196, s[74:75]
 v_mfma_f32_16x16x32_bf16 v[132:135], a[160:163], v[240:243], v[132:135]
 s_cmp_eq_u32 s51, 7
 s_cselect_b32 s8, 0x10000000, s52
 v_cmp_eq_u32_e64 s[74:75], -2, v198
 v_mfma_f32_16x16x32_bf16 v[132:135], a[164:167], v[248:251], v[132:135]
 s_waitcnt lgkmcnt(4)
 v_cndmask_b32_e64 v204, 0, v196, s[74:75]
 v_cmp_eq_u32_e64 s[74:75], -1, v198
 v_mfma_f32_16x16x32_bf16 v[108:111], a[168:171], v[160:163], v[108:111]
 s_barrier
 ds_read_b64_tr_b16 a[160:161], v2 offset:16896
 ds_read_b64_tr_b16 a[162:163], v4 offset:16896
 v_mfma_f32_16x16x32_bf16 v[108:111], a[172:175], v[176:179], v[108:111]
 s_sub_u32 s51, s59, 2
 ds_read_b64 v[174:175], v22 offset:2048
 v_cndmask_b32_e64 v205, 0, v196, s[74:75]
 v_mfma_f32_16x16x32_bf16 v[124:127], a[172:175], v[184:187], v[124:127]
 s_and_b32 s51, s51, 7
 ds_read_b64_tr_b16 a[164:165], v3 offset:16896
 ds_read_b64_tr_b16 a[166:167], v5 offset:16896
 v_mfma_f32_16x16x32_bf16 v[124:127], a[168:171], v[168:171], v[124:127]
 s_waitcnt lgkmcnt(7)
 v_cmp_eq_u32_e64 s[74:75], 6, v198
 v_mfma_f32_16x16x32_bf16 v[100:103], a[176:179], v[192:195], v[100:103]
 s_xor_b32 s56, s43, 0x1c000
 ds_read_b64_tr_b16 a[168:169], v2 offset:16928
 ds_read_b64_tr_b16 a[170:171], v4 offset:16928
 v_mfma_f32_16x16x32_bf16 v[100:103], a[180:183], v[208:211], v[100:103]
 s_add_u32 m0, s40, 0x23040
 v_cndmask_b32_e64 v206, 0, v196, s[74:75]
 v_cmp_eq_u32_e64 s[74:75], 7, v198
 v_mfma_f32_16x16x32_bf16 v[116:119], a[180:183], v[216:219], v[116:119]
 s_waitcnt vmcnt(4)
 v_cndmask_b32_e64 v207, 0, v196, s[74:75]
 v_mfma_f32_16x16x32_bf16 v[116:119], a[176:179], v[200:203], v[116:119]
 s_lshl_b32 s52, s51, 10
 ds_read_b64_tr_b16 a[172:173], v3 offset:16928
 ds_read_b64_tr_b16 a[174:175], v5 offset:16928
 v_mfma_f32_16x16x32_bf16 v[132:135], a[176:179], v[244:247], v[132:135]
 s_add_u32 s52, s52, s46
 buffer_load_dwordx4 v16, s[20:23], s56 offen offset:1024 nt lds
 v_mfma_f32_16x16x32_bf16 v[132:135], a[180:183], v[252:255], v[132:135]
 s_waitcnt lgkmcnt(9)
 v_mfma_f32_16x16x32_bf16 v[108:111], a[184:187], v[192:195], v[108:111]
 ds_read_b64_tr_b16 a[176:177], v2 offset:16960
 ds_read_b64_tr_b16 a[178:179], v4 offset:16960
 v_mfma_f32_16x16x32_bf16 v[108:111], a[188:191], v[208:211], v[108:111]
 s_cmp_eq_u32 s51, 7
 s_cselect_b32 s9, 0x10000000, s52
 v_mfma_f32_16x16x32_bf16 v[124:127], a[188:191], v[216:219], v[124:127]
 s_sub_u32 s51, s59, 3
 ds_read_b64_tr_b16 a[180:181], v3 offset:16960
 ds_read_b64_tr_b16 a[182:183], v5 offset:16960
 v_mfma_f32_16x16x32_bf16 v[124:127], a[184:187], v[200:203], v[124:127]
 s_waitcnt lgkmcnt(8)
 v_mfma_f32_16x16x32_bf16 a[0:3], a[160:163], v[140:143], a[0:3]
 s_add_u32 m0, s40, 0x23260
 ds_read_b64_tr_b16 a[184:185], v2 offset:16992
 ds_read_b64_tr_b16 a[186:187], v4 offset:16992
 v_mfma_f32_16x16x32_bf16 a[128:131], a[160:163], v[172:175], a[128:131]
 s_waitcnt vmcnt(4)
 v_mfma_f32_16x16x32_bf16 a[8:11], a[160:163], v[156:159], a[8:11]
 s_cbranch_vccnz L_stub_7_B1
L_stub_7_B1_ret:
 buffer_load_dwordx4 v16, s[20:23], s56 offen offset:1536 nt lds
 v_mfma_f32_16x16x32_bf16 a[40:43], a[164:167], v[156:159], a[40:43]
 s_and_b32 s51, s51, 7
 ds_read_b64_tr_b16 a[188:189], v3 offset:16992
 ds_read_b64_tr_b16 a[190:191], v5 offset:16992
 v_mfma_f32_16x16x32_bf16 a[32:35], a[164:167], v[140:143], a[32:35]
 s_waitcnt lgkmcnt(8)
 v_exp_f32 v132, v132
 v_mfma_f32_16x16x32_bf16 a[4:7], a[168:171], v[140:143], a[4:7]
 s_lshl_b32 s52, s51, 10
 ds_read_b64_tr_b16 a[160:161], v2 offset:17152
 ds_read_b64_tr_b16 a[162:163], v4 offset:17152
 v_mfma_f32_16x16x32_bf16 a[132:135], a[168:171], v[172:175], a[132:135]
 s_add_u32 s52, s52, s46
 v_exp_f32 v133, v133
 v_mfma_f32_16x16x32_bf16 a[12:15], a[168:171], v[156:159], a[12:15]
 v_exp_f32 v134, v134
 v_mfma_f32_16x16x32_bf16 a[44:47], a[172:175], v[156:159], a[44:47]
 ds_read_b64_tr_b16 a[164:165], v3 offset:17152
 ds_read_b64_tr_b16 a[166:167], v5 offset:17152
 v_mfma_f32_16x16x32_bf16 a[36:39], a[172:175], v[140:143], a[36:39]
 s_waitcnt lgkmcnt(8)
 v_exp_f32 v135, v135
 v_mfma_f32_16x16x32_bf16 a[16:19], a[176:179], v[140:143], a[16:19]
 s_xor_b32 s56, s42, 0x28000
 ds_read_b64_tr_b16 a[168:169], v2 offset:17184
 ds_read_b64_tr_b16 a[170:171], v4 offset:17184
 v_mfma_f32_16x16x32_bf16 a[136:139], a[176:179], v[172:175], a[136:139]
 s_add_u32 m0, s40, 0x8400
 v_add_f32 v34, v34, v132
 v_add_f32 v34, v34, v133
 v_mfma_f32_16x16x32_bf16 a[24:27], a[176:179], v[156:159], a[24:27]
 s_waitcnt vmcnt(3)
 v_cvt_pk_bf16_f32 v132, v132, v133
 v_add_f32 v34, v34, v134
 v_mfma_f32_16x16x32_bf16 a[56:59], a[180:183], v[156:159], a[56:59]
 ds_read_b64_tr_b16 a[172:173], v3 offset:17184
 ds_read_b64_tr_b16 a[174:175], v5 offset:17184
 v_mfma_f32_16x16x32_bf16 a[48:51], a[180:183], v[140:143], a[48:51]
 s_waitcnt lgkmcnt(8)
 buffer_load_dwordx4 v16, s[16:19], s56 offen offset:0 nt lds
 v_add_f32 v34, v34, v135
 v_mfma_f32_16x16x32_bf16 a[20:23], a[184:187], v[140:143], a[20:23]
 ds_read_b64_tr_b16 a[176:177], v2 offset:17216
 ds_read_b64_tr_b16 a[178:179], v4 offset:17216
 v_mfma_f32_16x16x32_bf16 a[140:143], a[184:187], v[172:175], a[140:143]
 s_cmp_eq_u32 s51, 7
 s_cselect_b32 s10, 0x10000000, s52
 v_cvt_pk_bf16_f32 v133, v134, v135
 v_mfma_f32_16x16x32_bf16 a[28:31], a[184:187], v[156:159], a[28:31]
 s_sub_u32 s51, s59, 4
 v_exp_f32 v100, v100
 v_mfma_f32_16x16x32_bf16 a[60:63], a[188:191], v[156:159], a[60:63]
 s_and_b32 s51, s51, 7
 ds_read_b64_tr_b16 a[180:181], v3 offset:17216
 ds_read_b64_tr_b16 a[182:183], v5 offset:17216
 v_mfma_f32_16x16x32_bf16 a[52:55], a[188:191], v[140:143], a[52:55]
 s_waitcnt lgkmcnt(8)
 v_exp_f32 v101, v101
 v_mfma_f32_16x16x32_bf16 a[64:67], a[160:163], v[140:143], a[64:67]
 s_add_u32 m0, s40, 0x8620
 ds_read_b64_tr_b16 a[184:185], v2 offset:17248
 ds_read_b64_tr_b16 a[186:187], v4 offset:17248
 v_mfma_f32_16x16x32_bf16 a[144:147], a[160:163], v[172:175], a[144:147]
 v_exp_f32 v102, v102
 v_mfma_f32_16x16x32_bf16 a[72:75], a[160:163], v[156:159], a[72:75]
 s_lshl_b32 s52, s51, 10
 buffer_load_dwordx4 v16, s[16:19], s56 offen offset:512 nt lds
 v_add_f32 v32, v32, v100
 v_mfma_f32_16x16x32_bf16 a[104:107], a[164:167], v[156:159], a[104:107]
 s_add_u32 s52, s52, s46
 ds_read_b64_tr_b16 a[188:189], v3 offset:17248
 ds_read_b64_tr_b16 a[190:191], v5 offset:17248
 v_mfma_f32_16x16x32_bf16 a[96:99], a[164:167], v[140:143], a[96:99]
 s_waitcnt lgkmcnt(8)
 v_exp_f32 v103, v103
 v_mfma_f32_16x16x32_bf16 a[68:71], a[168:171], v[140:143], a[68:71]
 s_barrier
 ds_read_b128 a[160:163], v6 offset:0
 v_mfma_f32_16x16x32_bf16 a[148:151], a[168:171], v[172:175], a[148:151]
 ds_write_b64 v21, v[132:133] offset:2048
 v_add_f32 v32, v32, v101
 v_mfma_f32_16x16x32_bf16 a[76:79], a[168:171], v[156:159], a[76:79]
 ds_write_b128 v19, v[88:91] offset:2048
 v_cvt_pk_bf16_f32 v100, v100, v101
 v_mfma_f32_16x16x32_bf16 a[108:111], a[172:175], v[156:159], a[108:111]
 ds_read_b128 a[164:167], v6 offset:64
 v_add_f32 v32, v32, v102
 v_mfma_f32_16x16x32_bf16 a[100:103], a[172:175], v[140:143], a[100:103]
 s_waitcnt lgkmcnt(8)
 v_exp_f32 v108, v108
 v_mfma_f32_16x16x32_bf16 a[80:83], a[176:179], v[140:143], a[80:83]
 ds_read_b128 a[168:171], v8 offset:0
 v_add_f32 v32, v32, v103
 v_mfma_f32_16x16x32_bf16 a[152:155], a[176:179], v[172:175], a[152:155]
 v_exp_f32 v109, v109
 v_mfma_f32_16x16x32_bf16 a[88:91], a[176:179], v[156:159], a[88:91]
 v_exp_f32 v110, v110
 v_mfma_f32_16x16x32_bf16 a[120:123], a[180:183], v[156:159], a[120:123]
 ds_read_b128 a[172:175], v8 offset:64
 v_cvt_pk_bf16_f32 v101, v102, v103
 v_mfma_f32_16x16x32_bf16 a[112:115], a[180:183], v[140:143], a[112:115]
 s_waitcnt lgkmcnt(6)
 v_exp_f32 v111, v111
 v_mfma_f32_16x16x32_bf16 a[84:87], a[184:187], v[140:143], a[84:87]
 ds_read_b128 a[176:179], v7 offset:0
 v_add_f32 v32, v32, v108
 v_mfma_f32_16x16x32_bf16 a[156:159], a[184:187], v[172:175], a[156:159]
 s_xor_b32 s56, s42, 0x28000
 v_exp_f32 v116, v116
 v_mfma_f32_16x16x32_bf16 a[92:95], a[184:187], v[156:159], a[92:95]
 s_add_u32 m0, s40, 0x8840
 v_exp_f32 v117, v117
 v_mfma_f32_16x16x32_bf16 a[124:127], a[188:191], v[156:159], a[124:127]
 s_waitcnt vmcnt(4)
 ds_read_b128 a[180:183], v7 offset:64
 v_add_f32 v32, v32, v109
 v_mfma_f32_16x16x32_bf16 a[116:119], a[188:191], v[140:143], a[116:119]
 s_waitcnt lgkmcnt(4)
 buffer_load_dwordx4 v16, s[16:19], s56 offen offset:1024 nt lds
 v_cvt_pk_bf16_f32 v102, v108, v109
 v_mfma_f32_16x16x32_bf16 v[140:143], a[160:163], v[96:99], v[44:47]
 ds_read_b128 a[184:187], v9 offset:0
 v_add_f32 v32, v32, v110
 v_mfma_f32_16x16x32_bf16 v[140:143], a[164:167], v[112:115], v[140:143]
 v_exp_f32 v118, v118
 v_mfma_f32_16x16x32_bf16 v[156:159], a[164:167], v[120:123], v[48:51]
 v_exp_f32 v119, v119
 v_mfma_f32_16x16x32_bf16 v[156:159], a[160:163], v[104:107], v[156:159]
 ds_read_b128 a[188:191], v9 offset:64
 v_add_f32 v32, v32, v111
 v_mfma_f32_16x16x32_bf16 v[172:175], a[160:163], v[224:227], v[52:55]
 v_exp_f32 v124, v124
 v_mfma_f32_16x16x32_bf16 v[172:175], a[164:167], v[232:235], v[172:175]
 s_waitcnt lgkmcnt(4)
 v_exp_f32 v125, v125
 v_mfma_f32_16x16x32_bf16 v[148:151], a[168:171], v[96:99], v[44:47]
 s_add_u32 m0, s40, 0x8a60
 ds_read_b128 a[160:163], v6 offset:256
 v_cvt_pk_bf16_f32 v103, v110, v111
 v_mfma_f32_16x16x32_bf16 v[148:151], a[172:175], v[112:115], v[148:151]
 s_waitcnt vmcnt(4)
 v_exp_f32 v126, v126
 v_mfma_f32_16x16x32_bf16 v[164:167], a[172:175], v[120:123], v[48:51]
 ds_read_b128 a[164:167], v6 offset:320
 buffer_load_dwordx4 v16, s[16:19], s56 offen offset:1536 nt lds
 v_mfma_f32_16x16x32_bf16 v[164:167], a[168:171], v[104:107], v[164:167]
 s_waitcnt lgkmcnt(4)
 v_exp_f32 v127, v127
 v_mfma_f32_16x16x32_bf16 v[140:143], a[176:179], v[128:131], v[140:143]
 ds_read_b128 a[168:171], v8 offset:256
 v_add_f32 v33, v33, v116
 v_mfma_f32_16x16x32_bf16 v[140:143], a[180:183], v[144:147], v[140:143]
 v_add_f32 v33, v33, v117
 v_cvt_pk_bf16_f32 v116, v116, v117
 v_mfma_f32_16x16x32_bf16 v[156:159], a[180:183], v[152:155], v[156:159]
 v_add_f32 v33, v33, v118
 v_add_f32 v33, v33, v119
 v_mfma_f32_16x16x32_bf16 v[156:159], a[176:179], v[136:139], v[156:159]
 ds_read_b128 a[172:175], v8 offset:320
 v_cvt_pk_bf16_f32 v117, v118, v119
 v_mfma_f32_16x16x32_bf16 v[172:175], a[176:179], v[228:231], v[172:175]
 v_add_f32 v33, v33, v124
 v_add_f32 v33, v33, v125
 v_mfma_f32_16x16x32_bf16 v[172:175], a[180:183], v[236:239], v[172:175]
 s_waitcnt lgkmcnt(4)
 v_cvt_pk_bf16_f32 v118, v124, v125
 v_add_f32 v33, v33, v126
 v_mfma_f32_16x16x32_bf16 v[148:151], a[184:187], v[128:131], v[148:151]
 ds_read_b128 a[176:179], v7 offset:256
 v_add_f32 v33, v33, v127
 v_mfma_f32_16x16x32_bf16 v[148:151], a[188:191], v[144:147], v[148:151]
 s_xor_b32 s56, s43, 0x20000
 v_cvt_pk_bf16_f32 v119, v126, v127
 v_mfma_f32_16x16x32_bf16 v[164:167], a[188:191], v[152:155], v[164:167]
 s_add_u32 m0, s40, 0x16600
 ds_read_b128 a[180:183], v7 offset:320
 v_mfma_f32_16x16x32_bf16 v[164:167], a[184:187], v[136:139], v[164:167]
 s_waitcnt lgkmcnt(4)
 v_mfma_f32_16x16x32_bf16 v[140:143], a[160:163], v[160:163], v[140:143]
 s_waitcnt vmcnt(4)
 ds_read_b128 a[184:187], v9 offset:256
 v_mfma_f32_16x16x32_bf16 v[140:143], a[164:167], v[176:179], v[140:143]
 s_cmp_eq_u32 s51, 7
 s_cselect_b32 s11, 0x10000000, s52
 buffer_load_dwordx4 v16, s[20:23], s56 offen offset:0 nt lds
 v_mfma_f32_16x16x32_bf16 v[156:159], a[164:167], v[184:187], v[156:159]
 s_sub_u32 s51, s59, 5
 v_mfma_f32_16x16x32_bf16 v[156:159], a[160:163], v[168:171], v[156:159]
 s_and_b32 s51, s51, 7
 ds_read_b128 a[188:191], v9 offset:320
 v_mfma_f32_16x16x32_bf16 v[172:175], a[160:163], v[240:243], v[172:175]
 s_lshl_b32 s52, s51, 10
 v_mfma_f32_16x16x32_bf16 v[172:175], a[164:167], v[248:251], v[172:175]
 s_waitcnt lgkmcnt(4)
 v_mfma_f32_16x16x32_bf16 v[148:151], a[168:171], v[160:163], v[148:151]
 s_barrier
 ds_read_b64_tr_b16 a[160:161], v2 offset:33792
 ds_read_b64_tr_b16 a[162:163], v4 offset:33792
 v_mfma_f32_16x16x32_bf16 v[148:151], a[172:175], v[176:179], v[148:151]
 s_add_u32 s52, s52, s46
 ds_read_b64 v[74:75], v22 offset:0
 v_mfma_f32_16x16x32_bf16 v[164:167], a[172:175], v[184:187], v[164:167]
 ds_read_b64_tr_b16 a[164:165], v3 offset:33792
 ds_read_b64_tr_b16 a[166:167], v5 offset:33792
 v_mfma_f32_16x16x32_bf16 v[164:167], a[168:171], v[168:171], v[164:167]
 s_waitcnt lgkmcnt(7)
 v_mfma_f32_16x16x32_bf16 v[140:143], a[176:179], v[192:195], v[140:143]
 ds_read_b64_tr_b16 a[168:169], v2 offset:33824
 ds_read_b64_tr_b16 a[170:171], v4 offset:33824
 v_mfma_f32_16x16x32_bf16 v[140:143], a[180:183], v[208:211], v[140:143]
 s_cmp_eq_u32 s51, 7
 s_cselect_b32 s12, 0x10000000, s52
 v_mfma_f32_16x16x32_bf16 v[156:159], a[180:183], v[216:219], v[156:159]
 s_xor_b32 s56, s43, 0x20000
 v_mfma_f32_16x16x32_bf16 v[156:159], a[176:179], v[200:203], v[156:159]
 s_add_u32 m0, s40, 0x16820
 ds_read_b64_tr_b16 a[172:173], v3 offset:33824
 ds_read_b64_tr_b16 a[174:175], v5 offset:33824
 v_mfma_f32_16x16x32_bf16 v[172:175], a[176:179], v[244:247], v[172:175]
 s_waitcnt vmcnt(4)
 v_mfma_f32_16x16x32_bf16 v[172:175], a[180:183], v[252:255], v[172:175]
 s_waitcnt lgkmcnt(9)
 buffer_load_dwordx4 v16, s[20:23], s56 offen offset:512 nt lds
 v_mfma_f32_16x16x32_bf16 v[148:151], a[184:187], v[192:195], v[148:151]
L_pad16:
 s_cbranch_execz L_e3_back
 s_sub_u32 s51, s59, 6
 ds_read_b64_tr_b16 a[176:177], v2 offset:33856
 ds_read_b64_tr_b16 a[178:179], v4 offset:33856
 v_mfma_f32_16x16x32_bf16 v[148:151], a[188:191], v[208:211], v[148:151]
 s_and_b32 s51, s51, 7
 v_mfma_f32_16x16x32_bf16 v[164:167], a[188:191], v[216:219], v[164:167]
 s_lshl_b32 s52, s51, 10
 ds_read_b64_tr_b16 a[180:181], v3 offset:33856
 ds_read_b64_tr_b16 a[182:183], v5 offset:33856
 v_mfma_f32_16x16x32_bf16 v[164:167], a[184:187], v[200:203], v[164:167]
 s_waitcnt lgkmcnt(8)
 v_mfma_f32_16x16x32_bf16 a[0:3], a[160:163], v[56:59], a[0:3]
 s_add_u32 s52, s52, s46
 ds_read_b64_tr_b16 a[184:185], v2 offset:33888
 ds_read_b64_tr_b16 a[186:187], v4 offset:33888
 v_mfma_f32_16x16x32_bf16 a[128:131], a[160:163], v[72:75], a[128:131]
 s_cmp_eq_u32 s51, 7
 s_cselect_b32 s13, 0x10000000, s52
 v_mfma_f32_16x16x32_bf16 a[8:11], a[160:163], v[64:67], a[8:11]
 s_cbranch_vccnz L_stub_8_B1
L_stub_8_B1_ret:
 v_mfma_f32_16x16x32_bf16 a[40:43], a[164:167], v[64:67], a[40:43]
 s_add_u32 m0, s40, 0x16a40
 ds_read_b64_tr_b16 a[188:189], v3 offset:33888
 ds_read_b64_tr_b16 a[190:191], v5 offset:33888
 v_mfma_f32_16x16x32_bf16 a[32:35], a[164:167], v[56:59], a[32:35]
 s_waitcnt lgkmcnt(8)
 v_exp_f32 v172, v172
 v_mfma_f32_16x16x32_bf16 a[4:7], a[168:171], v[56:59], a[4:7]
 s_waitcnt vmcnt(4)
 ds_read_b64_tr_b16 a[160:161], v2 offset:34048
 ds_read_b64_tr_b16 a[162:163], v4 offset:34048
 v_mfma_f32_16x16x32_bf16 a[132:135], a[168:171], v[72:75], a[132:135]
 s_sub_u32 s51, s59, 7
 buffer_load_dwordx4 v16, s[20:23], s56 offen offset:1024 nt lds
 v_mfma_f32_16x16x32_bf16 a[12:15], a[168:171], v[64:67], a[12:15]
 s_and_b32 s51, s51, 7
 v_exp_f32 v173, v173
 v_mfma_f32_16x16x32_bf16 a[44:47], a[172:175], v[64:67], a[44:47]
 s_lshl_b32 s52, s51, 10
 ds_read_b64_tr_b16 a[164:165], v3 offset:34048
 ds_read_b64_tr_b16 a[166:167], v5 offset:34048
 v_mfma_f32_16x16x32_bf16 a[36:39], a[172:175], v[56:59], a[36:39]
 s_waitcnt lgkmcnt(8)
 v_exp_f32 v174, v174
 v_mfma_f32_16x16x32_bf16 a[16:19], a[176:179], v[56:59], a[16:19]
 s_add_u32 s52, s52, s46
 ds_read_b64_tr_b16 a[168:169], v2 offset:34080
 ds_read_b64_tr_b16 a[170:171], v4 offset:34080
 v_mfma_f32_16x16x32_bf16 a[136:139], a[176:179], v[72:75], a[136:139]
 v_exp_f32 v175, v175
 v_mfma_f32_16x16x32_bf16 a[24:27], a[176:179], v[64:67], a[24:27]
 s_add_u32 m0, s40, 0x16c60
 v_add_f32 v34, v34, v172
 v_add_f32 v34, v34, v173
 v_mfma_f32_16x16x32_bf16 a[56:59], a[180:183], v[64:67], a[56:59]
 s_waitcnt vmcnt(4)
 ds_read_b64_tr_b16 a[172:173], v3 offset:34080
 ds_read_b64_tr_b16 a[174:175], v5 offset:34080
 v_mfma_f32_16x16x32_bf16 a[48:51], a[180:183], v[56:59], a[48:51]
 s_waitcnt lgkmcnt(8)
 buffer_load_dwordx4 v16, s[20:23], s56 offen offset:1536 nt lds
 v_cvt_pk_bf16_f32 v172, v172, v173
 v_mfma_f32_16x16x32_bf16 a[20:23], a[184:187], v[56:59], a[20:23]
 ds_read_b64_tr_b16 a[176:177], v2 offset:34112
 ds_read_b64_tr_b16 a[178:179], v4 offset:34112
 v_mfma_f32_16x16x32_bf16 a[140:143], a[184:187], v[72:75], a[140:143]
 v_add_f32 v34, v34, v174
 v_add_f32 v34, v34, v175
 v_mfma_f32_16x16x32_bf16 a[28:31], a[184:187], v[64:67], a[28:31]
 s_cmp_eq_u32 s51, 7
 s_cselect_b32 s14, 0x10000000, s52
 v_cvt_pk_bf16_f32 v173, v174, v175
 v_mfma_f32_16x16x32_bf16 a[60:63], a[188:191], v[64:67], a[60:63]
 s_sub_u32 s51, s59, 8
 ds_read_b64_tr_b16 a[180:181], v3 offset:34112
 ds_read_b64_tr_b16 a[182:183], v5 offset:34112
 v_mfma_f32_16x16x32_bf16 a[52:55], a[188:191], v[56:59], a[52:55]
 s_waitcnt lgkmcnt(8)
 v_exp_f32 v140, v140
 v_mfma_f32_16x16x32_bf16 a[64:67], a[160:163], v[56:59], a[64:67]
 s_and_b32 s51, s51, 7
 ds_read_b64_tr_b16 a[184:185], v2 offset:34144
 ds_read_b64_tr_b16 a[186:187], v4 offset:34144
 v_mfma_f32_16x16x32_bf16 a[144:147], a[160:163], v[72:75], a[144:147]
 s_lshl_b32 s52, s51, 10
 v_exp_f32 v141, v141
 v_mfma_f32_16x16x32_bf16 a[72:75], a[160:163], v[64:67], a[72:75]
 s_add_u32 s52, s52, s46
 v_exp_f32 v142, v142
 v_mfma_f32_16x16x32_bf16 a[104:107], a[164:167], v[64:67], a[104:107]
 ds_read_b64_tr_b16 a[188:189], v3 offset:34144
 ds_read_b64_tr_b16 a[190:191], v5 offset:34144
 v_mfma_f32_16x16x32_bf16 a[96:99], a[164:167], v[56:59], a[96:99]
 s_waitcnt lgkmcnt(8)
 v_exp_f32 v143, v143
 v_mfma_f32_16x16x32_bf16 a[68:71], a[168:171], v[56:59], a[68:71]
 s_barrier
 ds_read_b128 a[160:163], v6 offset:16896
 v_mfma_f32_16x16x32_bf16 a[148:151], a[168:171], v[72:75], a[148:151]
 ds_write_b64 v21, v[172:173] offset:0
 v_add_f32 v32, v32, v140
 v_mfma_f32_16x16x32_bf16 a[76:79], a[168:171], v[64:67], a[76:79]
 s_xor_b32 s56, s42, 0x2c000
 ds_write_b128 v19, v[92:95] offset:3072
 v_add_f32 v32, v32, v141
 v_mfma_f32_16x16x32_bf16 a[108:111], a[172:175], v[64:67], a[108:111]
 s_add_u32 m0, s40, 0xc600
 ds_read_b128 a[164:167], v6 offset:16960
 v_cvt_pk_bf16_f32 v140, v140, v141
 v_mfma_f32_16x16x32_bf16 a[100:103], a[172:175], v[56:59], a[100:103]
 s_waitcnt lgkmcnt(8)
 v_exp_f32 v148, v148
 v_mfma_f32_16x16x32_bf16 a[80:83], a[176:179], v[56:59], a[80:83]
 s_waitcnt vmcnt(4)
 ds_read_b128 a[168:171], v8 offset:16896
 v_add_f32 v32, v32, v142
 v_mfma_f32_16x16x32_bf16 a[152:155], a[176:179], v[72:75], a[152:155]
 buffer_load_dwordx4 v16, s[16:19], s56 offen offset:0 nt lds
 v_add_f32 v32, v32, v143
 v_mfma_f32_16x16x32_bf16 a[88:91], a[176:179], v[64:67], a[88:91]
 v_exp_f32 v149, v149
 v_mfma_f32_16x16x32_bf16 a[120:123], a[180:183], v[64:67], a[120:123]
 ds_read_b128 a[172:175], v8 offset:16960
 v_cvt_pk_bf16_f32 v141, v142, v143
 v_mfma_f32_16x16x32_bf16 a[112:115], a[180:183], v[56:59], a[112:115]
 s_waitcnt lgkmcnt(6)
 v_exp_f32 v150, v150
 v_mfma_f32_16x16x32_bf16 a[84:87], a[184:187], v[56:59], a[84:87]
 ds_read_b128 a[176:179], v7 offset:16896
 v_add_f32 v32, v32, v148
 v_mfma_f32_16x16x32_bf16 a[156:159], a[184:187], v[72:75], a[156:159]
 v_exp_f32 v151, v151
 v_mfma_f32_16x16x32_bf16 a[92:95], a[184:187], v[64:67], a[92:95]
 s_add_u32 m0, s40, 0xc820
 v_exp_f32 v156, v156
 v_mfma_f32_16x16x32_bf16 a[124:127], a[188:191], v[64:67], a[124:127]
 s_waitcnt vmcnt(4)
 ds_read_b128 a[180:183], v7 offset:16960
 v_add_f32 v32, v32, v149
 v_mfma_f32_16x16x32_bf16 a[116:119], a[188:191], v[56:59], a[116:119]
 s_waitcnt lgkmcnt(4)
 buffer_load_dwordx4 v16, s[16:19], s56 offen offset:512 nt lds
 v_cvt_pk_bf16_f32 v142, v148, v149
 v_mfma_f32_16x16x32_bf16 v[56:59], a[160:163], v[96:99], v[44:47]
 ds_read_b128 a[184:187], v9 offset:16896
 v_add_f32 v32, v32, v150
 v_mfma_f32_16x16x32_bf16 v[56:59], a[164:167], v[112:115], v[56:59]
 v_exp_f32 v157, v157
 v_mfma_f32_16x16x32_bf16 v[64:67], a[164:167], v[120:123], v[48:51]
 v_exp_f32 v158, v158
 v_mfma_f32_16x16x32_bf16 v[64:67], a[160:163], v[104:107], v[64:67]
 ds_read_b128 a[188:191], v9 offset:16960
 v_add_f32 v32, v32, v151
 v_mfma_f32_16x16x32_bf16 v[72:75], a[160:163], v[224:227], v[52:55]
 v_exp_f32 v159, v159
 v_mfma_f32_16x16x32_bf16 v[72:75], a[164:167], v[232:235], v[72:75]
 s_waitcnt lgkmcnt(4)
 v_exp_f32 v164, v164
 v_mfma_f32_16x16x32_bf16 v[60:63], a[168:171], v[96:99], v[44:47]
 ds_read_b128 a[160:163], v6 offset:17152
 v_cvt_pk_bf16_f32 v143, v150, v151
 v_mfma_f32_16x16x32_bf16 v[60:63], a[172:175], v[112:115], v[60:63]
 v_exp_f32 v165, v165
 v_mfma_f32_16x16x32_bf16 v[68:71], a[172:175], v[120:123], v[48:51]
 s_add_u32 m0, s40, 0xca40
 ds_read_b128 a[164:167], v6 offset:17216
 v_add_f32 v33, v33, v156
 v_mfma_f32_16x16x32_bf16 v[68:71], a[168:171], v[104:107], v[68:71]
 s_waitcnt lgkmcnt(4)
 v_exp_f32 v166, v166
 v_mfma_f32_16x16x32_bf16 v[56:59], a[176:179], v[128:131], v[56:59]
 s_waitcnt vmcnt(4)
 ds_read_b128 a[168:171], v8 offset:17152
 v_add_f32 v33, v33, v157
 v_mfma_f32_16x16x32_bf16 v[56:59], a[180:183], v[144:147], v[56:59]
 buffer_load_dwordx4 v16, s[16:19], s56 offen offset:1024 nt lds
 v_cvt_pk_bf16_f32 v156, v156, v157
 v_mfma_f32_16x16x32_bf16 v[64:67], a[180:183], v[152:155], v[64:67]
 v_exp_f32 v167, v167
 v_mfma_f32_16x16x32_bf16 v[64:67], a[176:179], v[136:139], v[64:67]
 ds_read_b128 a[172:175], v8 offset:17216
 v_add_f32 v33, v33, v158
 v_mfma_f32_16x16x32_bf16 v[72:75], a[176:179], v[228:231], v[72:75]
 v_add_f32 v33, v33, v159
 v_cvt_pk_bf16_f32 v157, v158, v159
 v_mfma_f32_16x16x32_bf16 v[72:75], a[180:183], v[236:239], v[72:75]
 s_waitcnt lgkmcnt(4)
 v_add_f32 v33, v33, v164
 v_add_f32 v33, v33, v165
 v_mfma_f32_16x16x32_bf16 v[60:63], a[184:187], v[128:131], v[60:63]
 ds_read_b128 a[176:179], v7 offset:17152
 v_cvt_pk_bf16_f32 v158, v164, v165
 v_mfma_f32_16x16x32_bf16 v[60:63], a[188:191], v[144:147], v[60:63]
 v_add_f32 v33, v33, v166
 v_add_f32 v33, v33, v167
 v_mfma_f32_16x16x32_bf16 v[68:71], a[188:191], v[152:155], v[68:71]
 ds_read_b128 a[180:183], v7 offset:17216
 v_cvt_pk_bf16_f32 v159, v166, v167
 v_mfma_f32_16x16x32_bf16 v[68:71], a[184:187], v[136:139], v[68:71]
 s_waitcnt lgkmcnt(4)
 v_mfma_f32_16x16x32_bf16 v[56:59], a[160:163], v[160:163], v[56:59]
 s_add_u32 m0, s40, 0xcc60
 ds_read_b128 a[184:187], v9 offset:17152
 v_mfma_f32_16x16x32_bf16 v[56:59], a[164:167], v[176:179], v[56:59]
 s_waitcnt vmcnt(4)
 v_mfma_f32_16x16x32_bf16 v[64:67], a[164:167], v[184:187], v[64:67]
 s_cmp_eq_u32 s51, 7
 s_cselect_b32 s15, 0x10000000, s52
 buffer_load_dwordx4 v16, s[16:19], s56 offen offset:1536 nt lds
 v_mfma_f32_16x16x32_bf16 v[64:67], a[160:163], v[168:171], v[64:67]
 ds_read_b128 a[188:191], v9 offset:17216
 v_mfma_f32_16x16x32_bf16 v[72:75], a[160:163], v[240:243], v[72:75]
 v_mfma_f32_16x16x32_bf16 v[72:75], a[164:167], v[248:251], v[72:75]
 s_waitcnt lgkmcnt(4)
 v_mfma_f32_16x16x32_bf16 v[60:63], a[168:171], v[160:163], v[60:63]
 s_barrier
 ds_read_b64_tr_b16 a[160:161], v2 offset:50688
 ds_read_b64_tr_b16 a[162:163], v4 offset:50688
 v_mfma_f32_16x16x32_bf16 v[60:63], a[172:175], v[176:179], v[60:63]
 ds_read_b64 v[134:135], v22 offset:2048
 v_mfma_f32_16x16x32_bf16 v[68:71], a[172:175], v[184:187], v[68:71]
 ds_read_b64_tr_b16 a[164:165], v3 offset:50688
 ds_read_b64_tr_b16 a[166:167], v5 offset:50688
 v_mfma_f32_16x16x32_bf16 v[68:71], a[168:171], v[168:171], v[68:71]
 s_waitcnt lgkmcnt(7)
 v_mfma_f32_16x16x32_bf16 v[56:59], a[176:179], v[192:195], v[56:59]
 ds_read_b64_tr_b16 a[168:169], v2 offset:50720
 ds_read_b64_tr_b16 a[170:171], v4 offset:50720
 v_mfma_f32_16x16x32_bf16 v[56:59], a[180:183], v[208:211], v[56:59]
 v_mfma_f32_16x16x32_bf16 v[64:67], a[180:183], v[216:219], v[64:67]
 v_mfma_f32_16x16x32_bf16 v[64:67], a[176:179], v[200:203], v[64:67]
 ds_read_b64_tr_b16 a[172:173], v3 offset:50720
 ds_read_b64_tr_b16 a[174:175], v5 offset:50720
 v_mfma_f32_16x16x32_bf16 v[72:75], a[176:179], v[244:247], v[72:75]
 s_xor_b32 s56, s43, 0x24000
 v_mfma_f32_16x16x32_bf16 v[72:75], a[180:183], v[252:255], v[72:75]
 s_waitcnt lgkmcnt(9)
 v_mfma_f32_16x16x32_bf16 v[60:63], a[184:187], v[192:195], v[60:63]
 s_add_u32 m0, s40, 0x1a800
 ds_read_b64_tr_b16 a[176:177], v2 offset:50752
 ds_read_b64_tr_b16 a[178:179], v4 offset:50752
 v_mfma_f32_16x16x32_bf16 v[60:63], a[188:191], v[208:211], v[60:63]
 s_waitcnt vmcnt(4)
 v_mfma_f32_16x16x32_bf16 v[68:71], a[188:191], v[216:219], v[68:71]
 ds_read_b64_tr_b16 a[180:181], v3 offset:50752
 ds_read_b64_tr_b16 a[182:183], v5 offset:50752
 v_mfma_f32_16x16x32_bf16 v[68:71], a[184:187], v[200:203], v[68:71]
 s_waitcnt lgkmcnt(8)
 buffer_load_dwordx4 v16, s[20:23], s56 offen offset:0 nt lds
 v_mfma_f32_16x16x32_bf16 a[0:3], a[160:163], v[100:103], a[0:3]
 ds_read_b64_tr_b16 a[184:185], v2 offset:50784
 ds_read_b64_tr_b16 a[186:187], v4 offset:50784
 v_mfma_f32_16x16x32_bf16 a[128:131], a[160:163], v[132:135], a[128:131]
 v_mfma_f32_16x16x32_bf16 a[8:11], a[160:163], v[116:119], a[8:11]
 s_cbranch_vccnz L_stub_9_B1
L_stub_9_B1_ret:
 v_mfma_f32_16x16x32_bf16 a[40:43], a[164:167], v[116:119], a[40:43]
 ds_read_b64_tr_b16 a[188:189], v3 offset:50784
 ds_read_b64_tr_b16 a[190:191], v5 offset:50784
 v_mfma_f32_16x16x32_bf16 a[32:35], a[164:167], v[100:103], a[32:35]
 s_waitcnt lgkmcnt(8)
 v_exp_f32 v72, v72
 v_mfma_f32_16x16x32_bf16 a[4:7], a[168:171], v[100:103], a[4:7]
 s_add_u32 m0, s40, 0x1aa20
 ds_read_b64_tr_b16 a[160:161], v2 offset:50944
 ds_read_b64_tr_b16 a[162:163], v4 offset:50944
 v_mfma_f32_16x16x32_bf16 a[132:135], a[168:171], v[132:135], a[132:135]
 s_waitcnt vmcnt(4)
 v_exp_f32 v73, v73
 v_mfma_f32_16x16x32_bf16 a[12:15], a[168:171], v[116:119], a[12:15]
 buffer_load_dwordx4 v16, s[20:23], s56 offen offset:512 nt lds
 v_mfma_f32_16x16x32_bf16 a[44:47], a[172:175], v[116:119], a[44:47]
 ds_read_b64_tr_b16 a[164:165], v3 offset:50944
 ds_read_b64_tr_b16 a[166:167], v5 offset:50944
 v_mfma_f32_16x16x32_bf16 a[36:39], a[172:175], v[100:103], a[36:39]
 s_waitcnt lgkmcnt(8)
 v_exp_f32 v74, v74
 v_mfma_f32_16x16x32_bf16 a[16:19], a[176:179], v[100:103], a[16:19]
 ds_read_b64_tr_b16 a[168:169], v2 offset:50976
 ds_read_b64_tr_b16 a[170:171], v4 offset:50976
 v_mfma_f32_16x16x32_bf16 a[136:139], a[176:179], v[132:135], a[136:139]
 v_exp_f32 v75, v75
 v_mfma_f32_16x16x32_bf16 a[24:27], a[176:179], v[116:119], a[24:27]
 v_add_f32 v34, v34, v72
 v_add_f32 v34, v34, v73
 v_mfma_f32_16x16x32_bf16 a[56:59], a[180:183], v[116:119], a[56:59]
 ds_read_b64_tr_b16 a[172:173], v3 offset:50976
 ds_read_b64_tr_b16 a[174:175], v5 offset:50976
 v_mfma_f32_16x16x32_bf16 a[48:51], a[180:183], v[100:103], a[48:51]
 s_waitcnt lgkmcnt(8)
 v_cvt_pk_bf16_f32 v72, v72, v73
 v_add_f32 v34, v34, v74
 v_mfma_f32_16x16x32_bf16 a[20:23], a[184:187], v[100:103], a[20:23]
 s_add_u32 m0, s40, 0x1ac40
 ds_read_b64_tr_b16 a[176:177], v2 offset:51008
 ds_read_b64_tr_b16 a[178:179], v4 offset:51008
 v_mfma_f32_16x16x32_bf16 a[140:143], a[184:187], v[132:135], a[140:143]
 s_waitcnt vmcnt(4)
 v_add_f32 v34, v34, v75
 v_cvt_pk_bf16_f32 v73, v74, v75
 v_mfma_f32_16x16x32_bf16 a[28:31], a[184:187], v[116:119], a[28:31]
 buffer_load_dwordx4 v16, s[20:23], s56 offen offset:1024 nt lds
 v_mfma_f32_16x16x32_bf16 a[60:63], a[188:191], v[116:119], a[60:63]
 ds_read_b64_tr_b16 a[180:181], v3 offset:51008
 ds_read_b64_tr_b16 a[182:183], v5 offset:51008
 v_mfma_f32_16x16x32_bf16 a[52:55], a[188:191], v[100:103], a[52:55]
 s_waitcnt lgkmcnt(8)
 v_exp_f32 v56, v56
 v_mfma_f32_16x16x32_bf16 a[64:67], a[160:163], v[100:103], a[64:67]
 ds_read_b64_tr_b16 a[184:185], v2 offset:51040
 ds_read_b64_tr_b16 a[186:187], v4 offset:51040
 v_mfma_f32_16x16x32_bf16 a[144:147], a[160:163], v[132:135], a[144:147]
 v_exp_f32 v57, v57
 v_mfma_f32_16x16x32_bf16 a[72:75], a[160:163], v[116:119], a[72:75]
 v_exp_f32 v58, v58
 v_mfma_f32_16x16x32_bf16 a[104:107], a[164:167], v[116:119], a[104:107]
 ds_read_b64_tr_b16 a[188:189], v3 offset:51040
 ds_read_b64_tr_b16 a[190:191], v5 offset:51040
 v_mfma_f32_16x16x32_bf16 a[96:99], a[164:167], v[100:103], a[96:99]
 s_waitcnt lgkmcnt(8)
 v_exp_f32 v59, v59
 v_mfma_f32_16x16x32_bf16 a[68:71], a[168:171], v[100:103], a[68:71]
 s_barrier
 ds_read_b128 a[160:163], v6 offset:33792
 v_mfma_f32_16x16x32_bf16 a[148:151], a[168:171], v[132:135], a[148:151]
 ds_write_b64 v21, v[72:73] offset:2048
 v_add_f32 v32, v32, v56
 v_mfma_f32_16x16x32_bf16 a[76:79], a[168:171], v[116:119], a[76:79]
 v_exp_f32 v60, v60
 v_mfma_f32_16x16x32_bf16 a[108:111], a[172:175], v[116:119], a[108:111]
 ds_read_b128 a[164:167], v6 offset:33856
 v_add_f32 v32, v32, v57
 v_mfma_f32_16x16x32_bf16 a[100:103], a[172:175], v[100:103], a[100:103]
 s_waitcnt lgkmcnt(7)
 v_exp_f32 v61, v61
 v_mfma_f32_16x16x32_bf16 a[80:83], a[176:179], v[100:103], a[80:83]
 s_xor_b32 s56, s43, 0x24000
 ds_read_b128 a[168:171], v8 offset:33792
 v_cvt_pk_bf16_f32 v56, v56, v57
 v_mfma_f32_16x16x32_bf16 a[152:155], a[176:179], v[132:135], a[152:155]
 s_add_u32 m0, s40, 0x1ae60
 v_exp_f32 v62, v62
 v_mfma_f32_16x16x32_bf16 a[88:91], a[176:179], v[116:119], a[88:91]
 s_waitcnt vmcnt(4)
 v_exp_f32 v63, v63
 v_mfma_f32_16x16x32_bf16 a[120:123], a[180:183], v[116:119], a[120:123]
 ds_read_b128 a[172:175], v8 offset:33856
 buffer_load_dwordx4 v16, s[20:23], s56 offen offset:1536 nt lds
 v_mfma_f32_16x16x32_bf16 a[112:115], a[180:183], v[100:103], a[112:115]
 s_waitcnt lgkmcnt(5)
 v_exp_f32 v64, v64
 v_mfma_f32_16x16x32_bf16 a[84:87], a[184:187], v[100:103], a[84:87]
 ds_read_b128 a[176:179], v7 offset:33792
 v_add_f32 v32, v32, v58
 v_mfma_f32_16x16x32_bf16 a[156:159], a[184:187], v[132:135], a[156:159]
 v_exp_f32 v65, v65
 v_mfma_f32_16x16x32_bf16 a[92:95], a[184:187], v[116:119], a[92:95]
 v_exp_f32 v66, v66
 v_mfma_f32_16x16x32_bf16 a[124:127], a[188:191], v[116:119], a[124:127]
 ds_read_b128 a[180:183], v7 offset:33856
 v_add_f32 v32, v32, v59
 v_mfma_f32_16x16x32_bf16 a[116:119], a[188:191], v[100:103], a[116:119]
 s_waitcnt lgkmcnt(4)
 v_exp_f32 v67, v67
 v_mfma_f32_16x16x32_bf16 v[100:103], a[160:163], v[96:99], v[44:47]
 s_xor_b32 s56, s42, 0x30000
 ds_read_b128 a[184:187], v9 offset:33792
 v_cvt_pk_bf16_f32 v57, v58, v59
 v_mfma_f32_16x16x32_bf16 v[100:103], a[164:167], v[112:115], v[100:103]
 s_add_u32 m0, s40, 0
 v_exp_f32 v68, v68
 v_mfma_f32_16x16x32_bf16 v[116:119], a[164:167], v[120:123], v[48:51]
 v_exp_f32 v69, v69
 v_mfma_f32_16x16x32_bf16 v[116:119], a[160:163], v[104:107], v[116:119]
 ds_read_b128 a[188:191], v9 offset:33856
 buffer_load_dwordx4 v16, s[16:19], s56 offen offset:0 nt lds
 v_mfma_f32_16x16x32_bf16 v[132:135], a[160:163], v[224:227], v[52:55]
 v_exp_f32 v70, v70
 v_mfma_f32_16x16x32_bf16 v[132:135], a[164:167], v[232:235], v[132:135]
 s_waitcnt lgkmcnt(4)
 v_exp_f32 v71, v71
 v_mfma_f32_16x16x32_bf16 v[108:111], a[168:171], v[96:99], v[44:47]
 ds_read_b128 a[160:163], v6 offset:34048
 v_add_f32 v32, v32, v60
 v_mfma_f32_16x16x32_bf16 v[108:111], a[172:175], v[112:115], v[108:111]
 v_add_f32 v32, v32, v61
 v_cvt_pk_bf16_f32 v58, v60, v61
 v_mfma_f32_16x16x32_bf16 v[124:127], a[172:175], v[120:123], v[48:51]
 ds_read_b128 a[164:167], v6 offset:34112
 v_add_f32 v32, v32, v62
 v_mfma_f32_16x16x32_bf16 v[124:127], a[168:171], v[104:107], v[124:127]
 s_waitcnt lgkmcnt(4)
 v_add_f32 v32, v32, v63
 v_cvt_pk_bf16_f32 v59, v62, v63
 v_mfma_f32_16x16x32_bf16 v[100:103], a[176:179], v[128:131], v[100:103]
 s_add_u32 m0, s40, 0x220
 ds_read_b128 a[168:171], v8 offset:34048
 v_add_f32 v33, v33, v64
 v_mfma_f32_16x16x32_bf16 v[100:103], a[180:183], v[144:147], v[100:103]
 s_waitcnt vmcnt(5)
 v_add_f32 v33, v33, v65
 v_cvt_pk_bf16_f32 v64, v64, v65
 v_mfma_f32_16x16x32_bf16 v[116:119], a[180:183], v[152:155], v[116:119]
 buffer_load_dwordx4 v16, s[16:19], s56 offen offset:512 nt lds
 v_add_f32 v33, v33, v66
 v_mfma_f32_16x16x32_bf16 v[116:119], a[176:179], v[136:139], v[116:119]
 ds_read_b128 a[172:175], v8 offset:34112
 v_add_f32 v33, v33, v67
 v_mfma_f32_16x16x32_bf16 v[132:135], a[176:179], v[228:231], v[132:135]
 v_cvt_pk_bf16_f32 v65, v66, v67
 v_add_f32 v33, v33, v68
 v_mfma_f32_16x16x32_bf16 v[132:135], a[180:183], v[236:239], v[132:135]
 s_waitcnt lgkmcnt(4)
 v_add_f32 v33, v33, v69
 v_cvt_pk_bf16_f32 v66, v68, v69
 v_mfma_f32_16x16x32_bf16 v[108:111], a[184:187], v[128:131], v[108:111]
 ds_read_b128 a[176:179], v7 offset:34048
 v_add_f32 v33, v33, v70
 v_mfma_f32_16x16x32_bf16 v[108:111], a[188:191], v[144:147], v[108:111]
 v_add_f32 v33, v33, v71
 v_cvt_pk_bf16_f32 v67, v70, v71
 v_mfma_f32_16x16x32_bf16 v[124:127], a[188:191], v[152:155], v[124:127]
 ds_read_b128 a[180:183], v7 offset:34112
 v_mfma_f32_16x16x32_bf16 v[124:127], a[184:187], v[136:139], v[124:127]
 s_waitcnt lgkmcnt(4)
 v_mfma_f32_16x16x32_bf16 v[100:103], a[160:163], v[160:163], v[100:103]
 s_add_u32 m0, s40, 0x440
 ds_read_b128 a[184:187], v9 offset:34048
 v_mfma_f32_16x16x32_bf16 v[100:103], a[164:167], v[176:179], v[100:103]
 s_waitcnt vmcnt(5)
 v_mfma_f32_16x16x32_bf16 v[116:119], a[164:167], v[184:187], v[116:119]
 buffer_load_dwordx4 v16, s[16:19], s56 offen offset:1024 nt lds
 v_mfma_f32_16x16x32_bf16 v[116:119], a[160:163], v[168:171], v[116:119]
 ds_read_b128 a[188:191], v9 offset:34112
 v_mfma_f32_16x16x32_bf16 v[132:135], a[160:163], v[240:243], v[132:135]
 v_mfma_f32_16x16x32_bf16 v[132:135], a[164:167], v[248:251], v[132:135]
 s_waitcnt lgkmcnt(4)
 v_mfma_f32_16x16x32_bf16 v[108:111], a[168:171], v[160:163], v[108:111]
 s_barrier
 ds_read_b64_tr_b16 a[160:161], v2 offset:0
 ds_read_b64_tr_b16 a[162:163], v4 offset:0
 v_mfma_f32_16x16x32_bf16 v[108:111], a[172:175], v[176:179], v[108:111]
 ds_read_b64 v[174:175], v22 offset:0
 v_mfma_f32_16x16x32_bf16 v[124:127], a[172:175], v[184:187], v[124:127]
 ds_read_b64_tr_b16 a[164:165], v3 offset:0
 ds_read_b64_tr_b16 a[166:167], v5 offset:0
 v_mfma_f32_16x16x32_bf16 v[124:127], a[168:171], v[168:171], v[124:127]
 s_waitcnt lgkmcnt(7)
 v_mfma_f32_16x16x32_bf16 v[100:103], a[176:179], v[192:195], v[100:103]
 ds_read_b64_tr_b16 a[168:169], v2 offset:32
 ds_read_b64_tr_b16 a[170:171], v4 offset:32
 v_mfma_f32_16x16x32_bf16 v[100:103], a[180:183], v[208:211], v[100:103]
 v_mfma_f32_16x16x32_bf16 v[116:119], a[180:183], v[216:219], v[116:119]
 v_mfma_f32_16x16x32_bf16 v[116:119], a[176:179], v[200:203], v[116:119]
 ds_read_b64_tr_b16 a[172:173], v3 offset:32
 ds_read_b64_tr_b16 a[174:175], v5 offset:32
 v_mfma_f32_16x16x32_bf16 v[132:135], a[176:179], v[244:247], v[132:135]
 v_mfma_f32_16x16x32_bf16 v[132:135], a[180:183], v[252:255], v[132:135]
 s_waitcnt lgkmcnt(9)
 v_mfma_f32_16x16x32_bf16 v[108:111], a[184:187], v[192:195], v[108:111]
 s_xor_b32 s56, s42, 0x30000
 ds_read_b64_tr_b16 a[176:177], v2 offset:64
 ds_read_b64_tr_b16 a[178:179], v4 offset:64
 v_mfma_f32_16x16x32_bf16 v[108:111], a[188:191], v[208:211], v[108:111]
 s_add_u32 m0, s40, 0x660
 v_mfma_f32_16x16x32_bf16 v[124:127], a[188:191], v[216:219], v[124:127]
 s_waitcnt vmcnt(5)
 ds_read_b64_tr_b16 a[180:181], v3 offset:64
 ds_read_b64_tr_b16 a[182:183], v5 offset:64
 v_mfma_f32_16x16x32_bf16 v[124:127], a[184:187], v[200:203], v[124:127]
 s_waitcnt lgkmcnt(8)
 buffer_load_dwordx4 v16, s[16:19], s56 offen offset:1536 nt lds
 v_mfma_f32_16x16x32_bf16 a[0:3], a[160:163], v[140:143], a[0:3]
 ds_read_b64_tr_b16 a[184:185], v2 offset:96
 ds_read_b64_tr_b16 a[186:187], v4 offset:96
 v_mfma_f32_16x16x32_bf16 a[128:131], a[160:163], v[172:175], a[128:131]
 v_mfma_f32_16x16x32_bf16 a[8:11], a[160:163], v[156:159], a[8:11]
 s_cbranch_vccnz L_stub_10_B1
L_stub_10_B1_ret:
 v_mfma_f32_16x16x32_bf16 a[40:43], a[164:167], v[156:159], a[40:43]
 ds_read_b64_tr_b16 a[188:189], v3 offset:96
 ds_read_b64_tr_b16 a[190:191], v5 offset:96
 v_mfma_f32_16x16x32_bf16 a[32:35], a[164:167], v[140:143], a[32:35]
 s_waitcnt lgkmcnt(8)
 v_exp_f32 v132, v132
 v_mfma_f32_16x16x32_bf16 a[4:7], a[168:171], v[140:143], a[4:7]
 s_xor_b32 s56, s43, 0x28000
 ds_read_b64_tr_b16 a[160:161], v2 offset:256
 ds_read_b64_tr_b16 a[162:163], v4 offset:256
 v_mfma_f32_16x16x32_bf16 a[132:135], a[168:171], v[172:175], a[132:135]
 s_add_u32 m0, s40, 0x1ea00
 v_exp_f32 v133, v133
 v_mfma_f32_16x16x32_bf16 a[12:15], a[168:171], v[156:159], a[12:15]
 s_waitcnt vmcnt(4)
 v_exp_f32 v134, v134
 v_mfma_f32_16x16x32_bf16 a[44:47], a[172:175], v[156:159], a[44:47]
 ds_read_b64_tr_b16 a[164:165], v3 offset:256
 ds_read_b64_tr_b16 a[166:167], v5 offset:256
 v_mfma_f32_16x16x32_bf16 a[36:39], a[172:175], v[140:143], a[36:39]
 s_waitcnt lgkmcnt(8)
 buffer_load_dwordx4 v16, s[20:23], s56 offen offset:0 nt lds
 v_mfma_f32_16x16x32_bf16 a[16:19], a[176:179], v[140:143], a[16:19]
 ds_read_b64_tr_b16 a[168:169], v2 offset:288
 ds_read_b64_tr_b16 a[170:171], v4 offset:288
 v_mfma_f32_16x16x32_bf16 a[136:139], a[176:179], v[172:175], a[136:139]
 v_exp_f32 v135, v135
 v_mfma_f32_16x16x32_bf16 a[24:27], a[176:179], v[156:159], a[24:27]
 v_add_f32 v34, v34, v132
 v_add_f32 v34, v34, v133
 v_mfma_f32_16x16x32_bf16 a[56:59], a[180:183], v[156:159], a[56:59]
 ds_read_b64_tr_b16 a[172:173], v3 offset:288
 ds_read_b64_tr_b16 a[174:175], v5 offset:288
 v_mfma_f32_16x16x32_bf16 a[48:51], a[180:183], v[140:143], a[48:51]
 s_waitcnt lgkmcnt(8)
 v_cvt_pk_bf16_f32 v132, v132, v133
 v_add_f32 v34, v34, v134
 v_mfma_f32_16x16x32_bf16 a[20:23], a[184:187], v[140:143], a[20:23]
 s_add_u32 m0, s40, 0x1ec20
 ds_read_b64_tr_b16 a[176:177], v2 offset:320
 ds_read_b64_tr_b16 a[178:179], v4 offset:320
 v_mfma_f32_16x16x32_bf16 a[140:143], a[184:187], v[172:175], a[140:143]
 s_waitcnt vmcnt(4)
 v_add_f32 v34, v34, v135
 v_cvt_pk_bf16_f32 v133, v134, v135
 v_mfma_f32_16x16x32_bf16 a[28:31], a[184:187], v[156:159], a[28:31]
 buffer_load_dwordx4 v16, s[20:23], s56 offen offset:512 nt lds
 v_mfma_f32_16x16x32_bf16 a[60:63], a[188:191], v[156:159], a[60:63]
 ds_read_b64_tr_b16 a[180:181], v3 offset:320
 ds_read_b64_tr_b16 a[182:183], v5 offset:320
 v_mfma_f32_16x16x32_bf16 a[52:55], a[188:191], v[140:143], a[52:55]
 s_waitcnt lgkmcnt(8)
 v_exp_f32 v100, v100
 v_mfma_f32_16x16x32_bf16 a[64:67], a[160:163], v[140:143], a[64:67]
 ds_read_b64_tr_b16 a[184:185], v2 offset:352
 ds_read_b64_tr_b16 a[186:187], v4 offset:352
 v_mfma_f32_16x16x32_bf16 a[144:147], a[160:163], v[172:175], a[144:147]
 v_exp_f32 v101, v101
 v_mfma_f32_16x16x32_bf16 a[72:75], a[160:163], v[156:159], a[72:75]
 v_exp_f32 v102, v102
 v_mfma_f32_16x16x32_bf16 a[104:107], a[164:167], v[156:159], a[104:107]
 ds_read_b64_tr_b16 a[188:189], v3 offset:352
 ds_read_b64_tr_b16 a[190:191], v5 offset:352
 v_mfma_f32_16x16x32_bf16 a[96:99], a[164:167], v[140:143], a[96:99]
 s_waitcnt lgkmcnt(8)
 v_exp_f32 v103, v103
 v_mfma_f32_16x16x32_bf16 a[68:71], a[168:171], v[140:143], a[68:71]
 s_barrier
 ds_read_b128 a[160:163], v6 offset:50688
 v_mfma_f32_16x16x32_bf16 a[148:151], a[168:171], v[172:175], a[148:151]
 ds_write_b64 v21, v[132:133] offset:0
 v_add_f32 v32, v32, v100
 v_mfma_f32_16x16x32_bf16 a[76:79], a[168:171], v[156:159], a[76:79]
 v_exp_f32 v108, v108
 v_mfma_f32_16x16x32_bf16 a[108:111], a[172:175], v[156:159], a[108:111]
 ds_read_b128 a[164:167], v6 offset:50752
 v_add_f32 v32, v32, v101
 v_mfma_f32_16x16x32_bf16 a[100:103], a[172:175], v[140:143], a[100:103]
 s_waitcnt lgkmcnt(7)
 v_exp_f32 v109, v109
 v_mfma_f32_16x16x32_bf16 a[80:83], a[176:179], v[140:143], a[80:83]
 s_xor_b32 s56, s43, 0x28000
 ds_read_b128 a[168:171], v8 offset:50688
 v_cvt_pk_bf16_f32 v100, v100, v101
 v_mfma_f32_16x16x32_bf16 a[152:155], a[176:179], v[172:175], a[152:155]
 s_add_u32 m0, s40, 0x1ee40
 v_exp_f32 v110, v110
 v_mfma_f32_16x16x32_bf16 a[88:91], a[176:179], v[156:159], a[88:91]
 s_waitcnt vmcnt(4)
 v_exp_f32 v111, v111
 v_mfma_f32_16x16x32_bf16 a[120:123], a[180:183], v[156:159], a[120:123]
 ds_read_b128 a[172:175], v8 offset:50752
 buffer_load_dwordx4 v16, s[20:23], s56 offen offset:1024 nt lds
 v_mfma_f32_16x16x32_bf16 a[112:115], a[180:183], v[140:143], a[112:115]
 s_waitcnt lgkmcnt(5)
 v_exp_f32 v116, v116
 v_mfma_f32_16x16x32_bf16 a[84:87], a[184:187], v[140:143], a[84:87]
 ds_read_b128 a[176:179], v7 offset:50688
 v_add_f32 v32, v32, v102
 v_mfma_f32_16x16x32_bf16 a[156:159], a[184:187], v[172:175], a[156:159]
 v_exp_f32 v117, v117
 v_mfma_f32_16x16x32_bf16 a[92:95], a[184:187], v[156:159], a[92:95]
 v_exp_f32 v118, v118
 v_mfma_f32_16x16x32_bf16 a[124:127], a[188:191], v[156:159], a[124:127]
 ds_read_b128 a[180:183], v7 offset:50752
 v_add_f32 v32, v32, v103
 v_mfma_f32_16x16x32_bf16 a[116:119], a[188:191], v[140:143], a[116:119]
 s_waitcnt lgkmcnt(4)
 v_exp_f32 v119, v119
 v_mfma_f32_16x16x32_bf16 v[140:143], a[160:163], v[96:99], v[44:47]
 ds_read_b128 a[184:187], v9 offset:50688
 v_cvt_pk_bf16_f32 v101, v102, v103
 v_mfma_f32_16x16x32_bf16 v[140:143], a[164:167], v[112:115], v[140:143]
 s_add_u32 m0, s40, 0x1f060
 v_exp_f32 v124, v124
 v_mfma_f32_16x16x32_bf16 v[156:159], a[164:167], v[120:123], v[48:51]
 s_waitcnt vmcnt(4)
 v_exp_f32 v125, v125
 v_mfma_f32_16x16x32_bf16 v[156:159], a[160:163], v[104:107], v[156:159]
 ds_read_b128 a[188:191], v9 offset:50752
 buffer_load_dwordx4 v16, s[20:23], s56 offen offset:1536 nt lds
 v_mfma_f32_16x16x32_bf16 v[172:175], a[160:163], v[224:227], v[52:55]
 v_exp_f32 v126, v126
 v_mfma_f32_16x16x32_bf16 v[172:175], a[164:167], v[232:235], v[172:175]
 s_waitcnt lgkmcnt(4)
 v_exp_f32 v127, v127
 v_mfma_f32_16x16x32_bf16 v[148:151], a[168:171], v[96:99], v[44:47]
 ds_read_b128 a[160:163], v6 offset:50944
 v_add_f32 v32, v32, v108
 v_mfma_f32_16x16x32_bf16 v[148:151], a[172:175], v[112:115], v[148:151]
L_pad17:
 s_cbranch_execz L_e3_back
 v_add_f32 v32, v32, v109
 v_cvt_pk_bf16_f32 v102, v108, v109
 v_mfma_f32_16x16x32_bf16 v[164:167], a[172:175], v[120:123], v[48:51]
 ds_read_b128 a[164:167], v6 offset:51008
 v_add_f32 v32, v32, v110
 v_mfma_f32_16x16x32_bf16 v[164:167], a[168:171], v[104:107], v[164:167]
 s_waitcnt lgkmcnt(4)
 v_add_f32 v32, v32, v111
 v_cvt_pk_bf16_f32 v103, v110, v111
 v_mfma_f32_16x16x32_bf16 v[140:143], a[176:179], v[128:131], v[140:143]
 ds_read_b128 a[168:171], v8 offset:50944
 v_add_f32 v33, v33, v116
 v_mfma_f32_16x16x32_bf16 v[140:143], a[180:183], v[144:147], v[140:143]
 s_xor_b32 s56, s42, 0x34000
 v_add_f32 v33, v33, v117
 v_cvt_pk_bf16_f32 v116, v116, v117
 v_mfma_f32_16x16x32_bf16 v[156:159], a[180:183], v[152:155], v[156:159]
 s_add_u32 m0, s40, 0x4200
 v_add_f32 v33, v33, v118
 v_add_f32 v33, v33, v119
 v_mfma_f32_16x16x32_bf16 v[156:159], a[176:179], v[136:139], v[156:159]
 ds_read_b128 a[172:175], v8 offset:51008
 v_cvt_pk_bf16_f32 v117, v118, v119
 v_mfma_f32_16x16x32_bf16 v[172:175], a[176:179], v[228:231], v[172:175]
 buffer_load_dwordx4 v16, s[16:19], s56 offen offset:0 nt lds
 v_add_f32 v33, v33, v124
 v_mfma_f32_16x16x32_bf16 v[172:175], a[180:183], v[236:239], v[172:175]
 s_waitcnt lgkmcnt(4)
 v_add_f32 v33, v33, v125
 v_cvt_pk_bf16_f32 v118, v124, v125
 v_mfma_f32_16x16x32_bf16 v[148:151], a[184:187], v[128:131], v[148:151]
 ds_read_b128 a[176:179], v7 offset:50944
 v_add_f32 v33, v33, v126
 v_mfma_f32_16x16x32_bf16 v[148:151], a[188:191], v[144:147], v[148:151]
 v_add_f32 v33, v33, v127
 v_cvt_pk_bf16_f32 v119, v126, v127
 v_mfma_f32_16x16x32_bf16 v[164:167], a[188:191], v[152:155], v[164:167]
 ds_read_b128 a[180:183], v7 offset:51008
 v_mfma_f32_16x16x32_bf16 v[164:167], a[184:187], v[136:139], v[164:167]
 s_waitcnt lgkmcnt(4)
 v_mfma_f32_16x16x32_bf16 v[140:143], a[160:163], v[160:163], v[140:143]
 ds_read_b128 a[184:187], v9 offset:50944
 v_mfma_f32_16x16x32_bf16 v[140:143], a[164:167], v[176:179], v[140:143]
 v_mfma_f32_16x16x32_bf16 v[156:159], a[164:167], v[184:187], v[156:159]
 v_mfma_f32_16x16x32_bf16 v[156:159], a[160:163], v[168:171], v[156:159]
 ds_read_b128 a[188:191], v9 offset:51008
 v_mfma_f32_16x16x32_bf16 v[172:175], a[160:163], v[240:243], v[172:175]
 v_mfma_f32_16x16x32_bf16 v[172:175], a[164:167], v[248:251], v[172:175]
 s_waitcnt lgkmcnt(4)
 v_mfma_f32_16x16x32_bf16 v[148:151], a[168:171], v[160:163], v[148:151]
 s_barrier
 ds_read_b64_tr_b16 a[160:161], v2 offset:16896
 ds_read_b64_tr_b16 a[162:163], v4 offset:16896
 v_mfma_f32_16x16x32_bf16 v[148:151], a[172:175], v[176:179], v[148:151]
 s_xor_b32 s56, s42, 0x34000
 ds_read_b64 v[74:75], v22 offset:2048
 v_mfma_f32_16x16x32_bf16 v[164:167], a[172:175], v[184:187], v[164:167]
 s_add_u32 m0, s40, 0x4420
 ds_read_b64_tr_b16 a[164:165], v3 offset:16896
 ds_read_b64_tr_b16 a[166:167], v5 offset:16896
 v_mfma_f32_16x16x32_bf16 v[164:167], a[168:171], v[168:171], v[164:167]
 s_waitcnt lgkmcnt(7)
 v_mfma_f32_16x16x32_bf16 v[140:143], a[176:179], v[192:195], v[140:143]
 s_waitcnt vmcnt(5)
 ds_read_b64_tr_b16 a[168:169], v2 offset:16928
 ds_read_b64_tr_b16 a[170:171], v4 offset:16928
 v_mfma_f32_16x16x32_bf16 v[140:143], a[180:183], v[208:211], v[140:143]
 buffer_load_dwordx4 v16, s[16:19], s56 offen offset:512 nt lds
 v_mfma_f32_16x16x32_bf16 v[156:159], a[180:183], v[216:219], v[156:159]
 v_mfma_f32_16x16x32_bf16 v[156:159], a[176:179], v[200:203], v[156:159]
 ds_read_b64_tr_b16 a[172:173], v3 offset:16928
 ds_read_b64_tr_b16 a[174:175], v5 offset:16928
 v_mfma_f32_16x16x32_bf16 v[172:175], a[176:179], v[244:247], v[172:175]
 v_mfma_f32_16x16x32_bf16 v[172:175], a[180:183], v[252:255], v[172:175]
 s_waitcnt lgkmcnt(9)
 v_mfma_f32_16x16x32_bf16 v[148:151], a[184:187], v[192:195], v[148:151]
 ds_read_b64_tr_b16 a[176:177], v2 offset:16960
 ds_read_b64_tr_b16 a[178:179], v4 offset:16960
 v_mfma_f32_16x16x32_bf16 v[148:151], a[188:191], v[208:211], v[148:151]
 s_add_u32 m0, s40, 0x4640
 v_mfma_f32_16x16x32_bf16 v[164:167], a[188:191], v[216:219], v[164:167]
 s_waitcnt vmcnt(5)
 ds_read_b64_tr_b16 a[180:181], v3 offset:16960
 ds_read_b64_tr_b16 a[182:183], v5 offset:16960
 v_mfma_f32_16x16x32_bf16 v[164:167], a[184:187], v[200:203], v[164:167]
 s_waitcnt lgkmcnt(8)
 buffer_load_dwordx4 v16, s[16:19], s56 offen offset:1024 nt lds
 v_mfma_f32_16x16x32_bf16 a[0:3], a[160:163], v[56:59], a[0:3]
 ds_read_b64_tr_b16 a[184:185], v2 offset:16992
 ds_read_b64_tr_b16 a[186:187], v4 offset:16992
 v_mfma_f32_16x16x32_bf16 a[128:131], a[160:163], v[72:75], a[128:131]
 v_mfma_f32_16x16x32_bf16 a[8:11], a[160:163], v[64:67], a[8:11]
 s_cbranch_vccnz L_stub_11_B1
L_stub_11_B1_ret:
 v_mfma_f32_16x16x32_bf16 a[40:43], a[164:167], v[64:67], a[40:43]
 ds_read_b64_tr_b16 a[188:189], v3 offset:16992
 ds_read_b64_tr_b16 a[190:191], v5 offset:16992
 v_mfma_f32_16x16x32_bf16 a[32:35], a[164:167], v[56:59], a[32:35]
 s_waitcnt lgkmcnt(8)
 v_exp_f32 v172, v172
 v_mfma_f32_16x16x32_bf16 a[4:7], a[168:171], v[56:59], a[4:7]
 ds_read_b64_tr_b16 a[160:161], v2 offset:17152
 ds_read_b64_tr_b16 a[162:163], v4 offset:17152
 v_mfma_f32_16x16x32_bf16 a[132:135], a[168:171], v[72:75], a[132:135]
 v_exp_f32 v173, v173
 v_mfma_f32_16x16x32_bf16 a[12:15], a[168:171], v[64:67], a[12:15]
 s_add_u32 m0, s40, 0x4860
 v_exp_f32 v174, v174
 v_mfma_f32_16x16x32_bf16 a[44:47], a[172:175], v[64:67], a[44:47]
 s_waitcnt vmcnt(5)
 ds_read_b64_tr_b16 a[164:165], v3 offset:17152
 ds_read_b64_tr_b16 a[166:167], v5 offset:17152
 v_mfma_f32_16x16x32_bf16 a[36:39], a[172:175], v[56:59], a[36:39]
 s_waitcnt lgkmcnt(8)
 buffer_load_dwordx4 v16, s[16:19], s56 offen offset:1536 nt lds
 v_mfma_f32_16x16x32_bf16 a[16:19], a[176:179], v[56:59], a[16:19]
 ds_read_b64_tr_b16 a[168:169], v2 offset:17184
 ds_read_b64_tr_b16 a[170:171], v4 offset:17184
 v_mfma_f32_16x16x32_bf16 a[136:139], a[176:179], v[72:75], a[136:139]
 v_exp_f32 v175, v175
 v_mfma_f32_16x16x32_bf16 a[24:27], a[176:179], v[64:67], a[24:27]
 v_add_f32 v34, v34, v172
 v_add_f32 v34, v34, v173
 v_mfma_f32_16x16x32_bf16 a[56:59], a[180:183], v[64:67], a[56:59]
 ds_read_b64_tr_b16 a[172:173], v3 offset:17184
 ds_read_b64_tr_b16 a[174:175], v5 offset:17184
 v_mfma_f32_16x16x32_bf16 a[48:51], a[180:183], v[56:59], a[48:51]
 s_waitcnt lgkmcnt(8)
 v_cvt_pk_bf16_f32 v172, v172, v173
 v_add_f32 v34, v34, v174
 v_mfma_f32_16x16x32_bf16 a[20:23], a[184:187], v[56:59], a[20:23]
 ds_read_b64_tr_b16 a[176:177], v2 offset:17216
 ds_read_b64_tr_b16 a[178:179], v4 offset:17216
 v_mfma_f32_16x16x32_bf16 a[140:143], a[184:187], v[72:75], a[140:143]
 v_add_f32 v34, v34, v175
 v_cvt_pk_bf16_f32 v173, v174, v175
 v_mfma_f32_16x16x32_bf16 a[28:31], a[184:187], v[64:67], a[28:31]
 s_xor_b32 s56, s43, 0x2c000
 v_exp_f32 v140, v140
 v_mfma_f32_16x16x32_bf16 a[60:63], a[188:191], v[64:67], a[60:63]
 s_add_u32 m0, s40, 0x22c00
 ds_read_b64_tr_b16 a[180:181], v3 offset:17216
 ds_read_b64_tr_b16 a[182:183], v5 offset:17216
 v_mfma_f32_16x16x32_bf16 a[52:55], a[188:191], v[56:59], a[52:55]
 s_waitcnt lgkmcnt(8)
 v_exp_f32 v141, v141
 v_mfma_f32_16x16x32_bf16 a[64:67], a[160:163], v[56:59], a[64:67]
 s_waitcnt vmcnt(4)
 ds_read_b64_tr_b16 a[184:185], v2 offset:17248
 ds_read_b64_tr_b16 a[186:187], v4 offset:17248
 v_mfma_f32_16x16x32_bf16 a[144:147], a[160:163], v[72:75], a[144:147]
 buffer_load_dwordx4 v16, s[20:23], s56 offen offset:0 nt lds
 v_add_f32 v32, v32, v140
 v_mfma_f32_16x16x32_bf16 a[72:75], a[160:163], v[64:67], a[72:75]
 v_exp_f32 v142, v142
 v_mfma_f32_16x16x32_bf16 a[104:107], a[164:167], v[64:67], a[104:107]
 ds_read_b64_tr_b16 a[188:189], v3 offset:17248
 ds_read_b64_tr_b16 a[190:191], v5 offset:17248
 v_mfma_f32_16x16x32_bf16 a[96:99], a[164:167], v[56:59], a[96:99]
 s_waitcnt lgkmcnt(8)
 v_exp_f32 v143, v143
 v_mfma_f32_16x16x32_bf16 a[68:71], a[168:171], v[56:59], a[68:71]
 s_barrier
 ds_read_b128 a[160:163], v6 offset:0
 v_mfma_f32_16x16x32_bf16 a[148:151], a[168:171], v[72:75], a[148:151]
 ds_write_b64 v21, v[172:173] offset:2048
 v_add_f32 v32, v32, v141
 v_mfma_f32_16x16x32_bf16 a[76:79], a[168:171], v[64:67], a[76:79]
 v_exp_f32 v148, v148
 v_mfma_f32_16x16x32_bf16 a[108:111], a[172:175], v[64:67], a[108:111]
 ds_read_b128 a[164:167], v6 offset:64
 v_cvt_pk_bf16_f32 v140, v140, v141
 v_mfma_f32_16x16x32_bf16 a[100:103], a[172:175], v[56:59], a[100:103]
 s_waitcnt lgkmcnt(7)
 v_exp_f32 v149, v149
 v_mfma_f32_16x16x32_bf16 a[80:83], a[176:179], v[56:59], a[80:83]
 ds_read_b128 a[168:171], v8 offset:0
 v_add_f32 v32, v32, v142
 v_mfma_f32_16x16x32_bf16 a[152:155], a[176:179], v[72:75], a[152:155]
 v_exp_f32 v150, v150
 v_mfma_f32_16x16x32_bf16 a[88:91], a[176:179], v[64:67], a[88:91]
 s_xor_b32 s56, s43, 0x2c000
 v_exp_f32 v151, v151
 v_mfma_f32_16x16x32_bf16 a[120:123], a[180:183], v[64:67], a[120:123]
 s_add_u32 m0, s40, 0x22e20
 ds_read_b128 a[172:175], v8 offset:64
 v_add_f32 v32, v32, v143
 v_mfma_f32_16x16x32_bf16 a[112:115], a[180:183], v[56:59], a[112:115]
 s_waitcnt lgkmcnt(5)
 v_exp_f32 v156, v156
 v_mfma_f32_16x16x32_bf16 a[84:87], a[184:187], v[56:59], a[84:87]
 s_waitcnt vmcnt(4)
 ds_read_b128 a[176:179], v7 offset:0
 v_cvt_pk_bf16_f32 v141, v142, v143
 v_mfma_f32_16x16x32_bf16 a[156:159], a[184:187], v[72:75], a[156:159]
 buffer_load_dwordx4 v16, s[20:23], s56 offen offset:512 nt lds
 v_add_f32 v32, v32, v148
 v_mfma_f32_16x16x32_bf16 a[92:95], a[184:187], v[64:67], a[92:95]
 v_exp_f32 v157, v157
 v_mfma_f32_16x16x32_bf16 a[124:127], a[188:191], v[64:67], a[124:127]
 ds_read_b128 a[180:183], v7 offset:64
 v_add_f32 v32, v32, v149
 v_mfma_f32_16x16x32_bf16 a[116:119], a[188:191], v[56:59], a[116:119]
 s_waitcnt lgkmcnt(4)
 v_exp_f32 v158, v158
 v_mfma_f32_16x16x32_bf16 v[56:59], a[160:163], v[96:99], v[44:47]
 ds_read_b128 a[184:187], v9 offset:0
 v_cvt_pk_bf16_f32 v142, v148, v149
 v_mfma_f32_16x16x32_bf16 v[56:59], a[164:167], v[112:115], v[56:59]
 v_exp_f32 v159, v159
 v_mfma_f32_16x16x32_bf16 v[64:67], a[164:167], v[120:123], v[48:51]
 v_exp_f32 v164, v164
 v_mfma_f32_16x16x32_bf16 v[64:67], a[160:163], v[104:107], v[64:67]
 s_add_u32 m0, s40, 0x23040
 ds_read_b128 a[188:191], v9 offset:64
 v_add_f32 v32, v32, v150
 v_mfma_f32_16x16x32_bf16 v[72:75], a[160:163], v[224:227], v[52:55]
 s_waitcnt vmcnt(4)
 v_exp_f32 v165, v165
 v_mfma_f32_16x16x32_bf16 v[72:75], a[164:167], v[232:235], v[72:75]
 s_waitcnt lgkmcnt(4)
 buffer_load_dwordx4 v16, s[20:23], s56 offen offset:1024 nt lds
 v_add_f32 v32, v32, v151
 v_mfma_f32_16x16x32_bf16 v[60:63], a[168:171], v[96:99], v[44:47]
 ds_read_b128 a[160:163], v6 offset:256
 v_cvt_pk_bf16_f32 v143, v150, v151
 v_mfma_f32_16x16x32_bf16 v[60:63], a[172:175], v[112:115], v[60:63]
 v_exp_f32 v166, v166
 v_mfma_f32_16x16x32_bf16 v[68:71], a[172:175], v[120:123], v[48:51]
 ds_read_b128 a[164:167], v6 offset:320
 v_add_f32 v33, v33, v156
 v_mfma_f32_16x16x32_bf16 v[68:71], a[168:171], v[104:107], v[68:71]
 s_waitcnt lgkmcnt(4)
 v_exp_f32 v167, v167
 v_mfma_f32_16x16x32_bf16 v[56:59], a[176:179], v[128:131], v[56:59]
 ds_read_b128 a[168:171], v8 offset:256
 v_add_f32 v33, v33, v157
 v_mfma_f32_16x16x32_bf16 v[56:59], a[180:183], v[144:147], v[56:59]
 v_cvt_pk_bf16_f32 v156, v156, v157
 v_add_f32 v33, v33, v158
 v_mfma_f32_16x16x32_bf16 v[64:67], a[180:183], v[152:155], v[64:67]
 v_add_f32 v33, v33, v159
 v_cvt_pk_bf16_f32 v157, v158, v159
 v_mfma_f32_16x16x32_bf16 v[64:67], a[176:179], v[136:139], v[64:67]
 s_add_u32 m0, s40, 0x23260
 ds_read_b128 a[172:175], v8 offset:320
 v_add_f32 v33, v33, v164
 v_mfma_f32_16x16x32_bf16 v[72:75], a[176:179], v[228:231], v[72:75]
 s_waitcnt vmcnt(4)
 v_add_f32 v33, v33, v165
 v_cvt_pk_bf16_f32 v158, v164, v165
 v_mfma_f32_16x16x32_bf16 v[72:75], a[180:183], v[236:239], v[72:75]
 s_waitcnt lgkmcnt(4)
 buffer_load_dwordx4 v16, s[20:23], s56 offen offset:1536 nt lds
 v_add_f32 v33, v33, v166
 v_mfma_f32_16x16x32_bf16 v[60:63], a[184:187], v[128:131], v[60:63]
 ds_read_b128 a[176:179], v7 offset:256
 v_add_f32 v33, v33, v167
 v_mfma_f32_16x16x32_bf16 v[60:63], a[188:191], v[144:147], v[60:63]
 v_cvt_pk_bf16_f32 v159, v166, v167
 v_mfma_f32_16x16x32_bf16 v[68:71], a[188:191], v[152:155], v[68:71]
 ds_read_b128 a[180:183], v7 offset:320
 v_mfma_f32_16x16x32_bf16 v[68:71], a[184:187], v[136:139], v[68:71]
 s_waitcnt lgkmcnt(4)
 v_mfma_f32_16x16x32_bf16 v[56:59], a[160:163], v[160:163], v[56:59]
 ds_read_b128 a[184:187], v9 offset:256
 v_mfma_f32_16x16x32_bf16 v[56:59], a[164:167], v[176:179], v[56:59]
 v_mfma_f32_16x16x32_bf16 v[64:67], a[164:167], v[184:187], v[64:67]
 v_mfma_f32_16x16x32_bf16 v[64:67], a[160:163], v[168:171], v[64:67]
 ds_read_b128 a[188:191], v9 offset:320
 v_mfma_f32_16x16x32_bf16 v[72:75], a[160:163], v[240:243], v[72:75]
 v_mfma_f32_16x16x32_bf16 v[72:75], a[164:167], v[248:251], v[72:75]
 s_waitcnt lgkmcnt(4)
 v_mfma_f32_16x16x32_bf16 v[60:63], a[168:171], v[160:163], v[60:63]
 s_barrier
 ds_read_b64_tr_b16 a[160:161], v2 offset:33792
 ds_read_b64_tr_b16 a[162:163], v4 offset:33792
 v_mfma_f32_16x16x32_bf16 v[60:63], a[172:175], v[176:179], v[60:63]
 ds_read_b64 v[134:135], v22 offset:0
 v_mfma_f32_16x16x32_bf16 v[68:71], a[172:175], v[184:187], v[68:71]
 ds_read_b64_tr_b16 a[164:165], v3 offset:33792
 ds_read_b64_tr_b16 a[166:167], v5 offset:33792
 v_mfma_f32_16x16x32_bf16 v[68:71], a[168:171], v[168:171], v[68:71]
 s_waitcnt lgkmcnt(7)
 v_mfma_f32_16x16x32_bf16 v[56:59], a[176:179], v[192:195], v[56:59]
 s_xor_b32 s56, s42, 0x38000
 ds_read_b64_tr_b16 a[168:169], v2 offset:33824
 ds_read_b64_tr_b16 a[170:171], v4 offset:33824
 v_mfma_f32_16x16x32_bf16 v[56:59], a[180:183], v[208:211], v[56:59]
 s_add_u32 m0, s40, 0x8400
 v_mfma_f32_16x16x32_bf16 v[64:67], a[180:183], v[216:219], v[64:67]
 v_mfma_f32_16x16x32_bf16 v[64:67], a[176:179], v[200:203], v[64:67]
 ds_read_b64_tr_b16 a[172:173], v3 offset:33824
 ds_read_b64_tr_b16 a[174:175], v5 offset:33824
 v_mfma_f32_16x16x32_bf16 v[72:75], a[176:179], v[244:247], v[72:75]
 buffer_load_dwordx4 v16, s[16:19], s56 offen offset:0 nt lds
 v_mfma_f32_16x16x32_bf16 v[72:75], a[180:183], v[252:255], v[72:75]
 s_waitcnt lgkmcnt(9)
 v_mfma_f32_16x16x32_bf16 v[60:63], a[184:187], v[192:195], v[60:63]
 ds_read_b64_tr_b16 a[176:177], v2 offset:33856
 ds_read_b64_tr_b16 a[178:179], v4 offset:33856
 v_mfma_f32_16x16x32_bf16 v[60:63], a[188:191], v[208:211], v[60:63]
 v_mfma_f32_16x16x32_bf16 v[68:71], a[188:191], v[216:219], v[68:71]
 s_add_u32 m0, s40, 0x8620
 ds_read_b64_tr_b16 a[180:181], v3 offset:33856
 ds_read_b64_tr_b16 a[182:183], v5 offset:33856
 v_mfma_f32_16x16x32_bf16 v[68:71], a[184:187], v[200:203], v[68:71]
 s_waitcnt lgkmcnt(8)
 v_mfma_f32_16x16x32_bf16 a[0:3], a[160:163], v[100:103], a[0:3]
 s_waitcnt vmcnt(5)
 ds_read_b64_tr_b16 a[184:185], v2 offset:33888
 ds_read_b64_tr_b16 a[186:187], v4 offset:33888
 v_mfma_f32_16x16x32_bf16 a[128:131], a[160:163], v[132:135], a[128:131]
 buffer_load_dwordx4 v16, s[16:19], s56 offen offset:512 nt lds
 v_mfma_f32_16x16x32_bf16 a[8:11], a[160:163], v[116:119], a[8:11]
 s_cbranch_vccnz L_stub_12_B1
L_stub_12_B1_ret:
 v_mfma_f32_16x16x32_bf16 a[40:43], a[164:167], v[116:119], a[40:43]
 ds_read_b64_tr_b16 a[188:189], v3 offset:33888
 ds_read_b64_tr_b16 a[190:191], v5 offset:33888
 v_mfma_f32_16x16x32_bf16 a[32:35], a[164:167], v[100:103], a[32:35]
 s_waitcnt lgkmcnt(8)
 v_exp_f32 v72, v72
 v_mfma_f32_16x16x32_bf16 a[4:7], a[168:171], v[100:103], a[4:7]
 ds_read_b64_tr_b16 a[160:161], v2 offset:34048
 ds_read_b64_tr_b16 a[162:163], v4 offset:34048
 v_mfma_f32_16x16x32_bf16 a[132:135], a[168:171], v[132:135], a[132:135]
 v_exp_f32 v73, v73
 v_mfma_f32_16x16x32_bf16 a[12:15], a[168:171], v[116:119], a[12:15]
 v_exp_f32 v74, v74
 v_mfma_f32_16x16x32_bf16 a[44:47], a[172:175], v[116:119], a[44:47]
 s_add_u32 m0, s40, 0x8840
 ds_read_b64_tr_b16 a[164:165], v3 offset:34048
 ds_read_b64_tr_b16 a[166:167], v5 offset:34048
 v_mfma_f32_16x16x32_bf16 a[36:39], a[172:175], v[100:103], a[36:39]
 s_waitcnt lgkmcnt(8)
 v_exp_f32 v75, v75
 v_mfma_f32_16x16x32_bf16 a[16:19], a[176:179], v[100:103], a[16:19]
 s_waitcnt vmcnt(5)
 ds_read_b64_tr_b16 a[168:169], v2 offset:34080
 ds_read_b64_tr_b16 a[170:171], v4 offset:34080
 v_mfma_f32_16x16x32_bf16 a[136:139], a[176:179], v[132:135], a[136:139]
 buffer_load_dwordx4 v16, s[16:19], s56 offen offset:1024 nt lds
 v_add_f32 v34, v34, v72
 v_mfma_f32_16x16x32_bf16 a[24:27], a[176:179], v[116:119], a[24:27]
 v_add_f32 v34, v34, v73
 v_cvt_pk_bf16_f32 v72, v72, v73
 v_mfma_f32_16x16x32_bf16 a[56:59], a[180:183], v[116:119], a[56:59]
 ds_read_b64_tr_b16 a[172:173], v3 offset:34080
 ds_read_b64_tr_b16 a[174:175], v5 offset:34080
 v_mfma_f32_16x16x32_bf16 a[48:51], a[180:183], v[100:103], a[48:51]
 s_waitcnt lgkmcnt(8)
 v_add_f32 v34, v34, v74
 v_add_f32 v34, v34, v75
 v_mfma_f32_16x16x32_bf16 a[20:23], a[184:187], v[100:103], a[20:23]
 ds_read_b64_tr_b16 a[176:177], v2 offset:34112
 ds_read_b64_tr_b16 a[178:179], v4 offset:34112
 v_mfma_f32_16x16x32_bf16 a[140:143], a[184:187], v[132:135], a[140:143]
 v_cvt_pk_bf16_f32 v73, v74, v75
 v_mfma_f32_16x16x32_bf16 a[28:31], a[184:187], v[116:119], a[28:31]
 v_exp_f32 v56, v56
 v_mfma_f32_16x16x32_bf16 a[60:63], a[188:191], v[116:119], a[60:63]
 s_add_u32 m0, s40, 0x8a60
 ds_read_b64_tr_b16 a[180:181], v3 offset:34112
 ds_read_b64_tr_b16 a[182:183], v5 offset:34112
 v_mfma_f32_16x16x32_bf16 a[52:55], a[188:191], v[100:103], a[52:55]
 s_waitcnt lgkmcnt(8)
 v_exp_f32 v57, v57
 v_mfma_f32_16x16x32_bf16 a[64:67], a[160:163], v[100:103], a[64:67]
 s_waitcnt vmcnt(5)
 ds_read_b64_tr_b16 a[184:185], v2 offset:34144
 ds_read_b64_tr_b16 a[186:187], v4 offset:34144
 v_mfma_f32_16x16x32_bf16 a[144:147], a[160:163], v[132:135], a[144:147]
 buffer_load_dwordx4 v16, s[16:19], s56 offen offset:1536 nt lds
 v_add_f32 v32, v32, v56
 v_mfma_f32_16x16x32_bf16 a[72:75], a[160:163], v[116:119], a[72:75]
 v_exp_f32 v58, v58
 v_mfma_f32_16x16x32_bf16 a[104:107], a[164:167], v[116:119], a[104:107]
 ds_read_b64_tr_b16 a[188:189], v3 offset:34144
 ds_read_b64_tr_b16 a[190:191], v5 offset:34144
 v_mfma_f32_16x16x32_bf16 a[96:99], a[164:167], v[100:103], a[96:99]
 s_waitcnt lgkmcnt(8)
 v_exp_f32 v59, v59
 v_mfma_f32_16x16x32_bf16 a[68:71], a[168:171], v[100:103], a[68:71]
 s_barrier
 ds_read_b128 a[160:163], v6 offset:16896
 v_mfma_f32_16x16x32_bf16 a[148:151], a[168:171], v[132:135], a[148:151]
 ds_write_b64 v21, v[72:73] offset:0
 v_add_f32 v32, v32, v57
 v_mfma_f32_16x16x32_bf16 a[76:79], a[168:171], v[116:119], a[76:79]
 v_exp_f32 v60, v60
 v_mfma_f32_16x16x32_bf16 a[108:111], a[172:175], v[116:119], a[108:111]
 ds_read_b128 a[164:167], v6 offset:16960
 v_cvt_pk_bf16_f32 v56, v56, v57
 v_mfma_f32_16x16x32_bf16 a[100:103], a[172:175], v[100:103], a[100:103]
 s_waitcnt lgkmcnt(7)
 v_exp_f32 v61, v61
 v_mfma_f32_16x16x32_bf16 a[80:83], a[176:179], v[100:103], a[80:83]
 ds_read_b128 a[168:171], v8 offset:16896
 v_add_f32 v32, v32, v58
 v_mfma_f32_16x16x32_bf16 a[152:155], a[176:179], v[132:135], a[152:155]
 v_exp_f32 v62, v62
 v_mfma_f32_16x16x32_bf16 a[88:91], a[176:179], v[116:119], a[88:91]
 v_exp_f32 v63, v63
 v_mfma_f32_16x16x32_bf16 a[120:123], a[180:183], v[116:119], a[120:123]
 ds_read_b128 a[172:175], v8 offset:16960
 v_add_f32 v32, v32, v59
 v_mfma_f32_16x16x32_bf16 a[112:115], a[180:183], v[100:103], a[112:115]
 s_waitcnt lgkmcnt(5)
 v_exp_f32 v64, v64
 v_mfma_f32_16x16x32_bf16 a[84:87], a[184:187], v[100:103], a[84:87]
 s_xor_b32 s56, s43, 0x30000
 ds_read_b128 a[176:179], v7 offset:16896
 v_cvt_pk_bf16_f32 v57, v58, v59
 v_mfma_f32_16x16x32_bf16 a[156:159], a[184:187], v[132:135], a[156:159]
 s_add_u32 m0, s40, 0x16600
 v_exp_f32 v65, v65
 v_mfma_f32_16x16x32_bf16 a[92:95], a[184:187], v[116:119], a[92:95]
 s_waitcnt vmcnt(5)
 v_exp_f32 v66, v66
 v_mfma_f32_16x16x32_bf16 a[124:127], a[188:191], v[116:119], a[124:127]
 ds_read_b128 a[180:183], v7 offset:16960
 buffer_load_dwordx4 v16, s[20:23], s56 offen offset:0 nt lds
 v_mfma_f32_16x16x32_bf16 a[116:119], a[188:191], v[100:103], a[116:119]
 s_waitcnt lgkmcnt(4)
 v_exp_f32 v67, v67
 v_mfma_f32_16x16x32_bf16 v[100:103], a[160:163], v[96:99], v[44:47]
 ds_read_b128 a[184:187], v9 offset:16896
 v_add_f32 v32, v32, v60
 v_mfma_f32_16x16x32_bf16 v[100:103], a[164:167], v[112:115], v[100:103]
 v_exp_f32 v68, v68
 v_mfma_f32_16x16x32_bf16 v[116:119], a[164:167], v[120:123], v[48:51]
 v_exp_f32 v69, v69
 v_mfma_f32_16x16x32_bf16 v[116:119], a[160:163], v[104:107], v[116:119]
 ds_read_b128 a[188:191], v9 offset:16960
 v_add_f32 v32, v32, v61
 v_mfma_f32_16x16x32_bf16 v[132:135], a[160:163], v[224:227], v[52:55]
 s_add_u32 m0, s40, 0x16820
 v_exp_f32 v70, v70
 v_mfma_f32_16x16x32_bf16 v[132:135], a[164:167], v[232:235], v[132:135]
 s_waitcnt lgkmcnt(4)
 v_exp_f32 v71, v71
 v_mfma_f32_16x16x32_bf16 v[108:111], a[168:171], v[96:99], v[44:47]
 s_waitcnt vmcnt(5)
 ds_read_b128 a[160:163], v6 offset:17152
 v_cvt_pk_bf16_f32 v58, v60, v61
 v_mfma_f32_16x16x32_bf16 v[108:111], a[172:175], v[112:115], v[108:111]
 buffer_load_dwordx4 v16, s[20:23], s56 offen offset:512 nt lds
 v_add_f32 v32, v32, v62
 v_mfma_f32_16x16x32_bf16 v[124:127], a[172:175], v[120:123], v[48:51]
 ds_read_b128 a[164:167], v6 offset:17216
 v_add_f32 v32, v32, v63
 v_mfma_f32_16x16x32_bf16 v[124:127], a[168:171], v[104:107], v[124:127]
 s_waitcnt lgkmcnt(4)
 v_cvt_pk_bf16_f32 v59, v62, v63
 v_add_f32 v33, v33, v64
 v_mfma_f32_16x16x32_bf16 v[100:103], a[176:179], v[128:131], v[100:103]
 ds_read_b128 a[168:171], v8 offset:17152
 v_add_f32 v33, v33, v65
 v_mfma_f32_16x16x32_bf16 v[100:103], a[180:183], v[144:147], v[100:103]
 v_cvt_pk_bf16_f32 v64, v64, v65
 v_add_f32 v33, v33, v66
 v_mfma_f32_16x16x32_bf16 v[116:119], a[180:183], v[152:155], v[116:119]
 v_add_f32 v33, v33, v67
 v_cvt_pk_bf16_f32 v65, v66, v67
 v_mfma_f32_16x16x32_bf16 v[116:119], a[176:179], v[136:139], v[116:119]
 ds_read_b128 a[172:175], v8 offset:17216
 v_add_f32 v33, v33, v68
 v_mfma_f32_16x16x32_bf16 v[132:135], a[176:179], v[228:231], v[132:135]
 v_add_f32 v33, v33, v69
 v_cvt_pk_bf16_f32 v66, v68, v69
 v_mfma_f32_16x16x32_bf16 v[132:135], a[180:183], v[236:239], v[132:135]
 s_waitcnt lgkmcnt(4)
 v_add_f32 v33, v33, v70
 v_add_f32 v33, v33, v71
 v_mfma_f32_16x16x32_bf16 v[108:111], a[184:187], v[128:131], v[108:111]
 s_add_u32 m0, s40, 0x16a40
 ds_read_b128 a[176:179], v7 offset:17152
 v_cvt_pk_bf16_f32 v67, v70, v71
 v_mfma_f32_16x16x32_bf16 v[108:111], a[188:191], v[144:147], v[108:111]
 s_waitcnt vmcnt(5)
 v_mfma_f32_16x16x32_bf16 v[124:127], a[188:191], v[152:155], v[124:127]
 ds_read_b128 a[180:183], v7 offset:17216
 buffer_load_dwordx4 v16, s[20:23], s56 offen offset:1024 nt lds
 v_mfma_f32_16x16x32_bf16 v[124:127], a[184:187], v[136:139], v[124:127]
 s_waitcnt lgkmcnt(4)
 v_mfma_f32_16x16x32_bf16 v[100:103], a[160:163], v[160:163], v[100:103]
 ds_read_b128 a[184:187], v9 offset:17152
 v_mfma_f32_16x16x32_bf16 v[100:103], a[164:167], v[176:179], v[100:103]
 v_mfma_f32_16x16x32_bf16 v[116:119], a[164:167], v[184:187], v[116:119]
 v_mfma_f32_16x16x32_bf16 v[116:119], a[160:163], v[168:171], v[116:119]
 ds_read_b128 a[188:191], v9 offset:17216
 v_mfma_f32_16x16x32_bf16 v[132:135], a[160:163], v[240:243], v[132:135]
 v_mfma_f32_16x16x32_bf16 v[132:135], a[164:167], v[248:251], v[132:135]
 s_waitcnt lgkmcnt(4)
 v_mfma_f32_16x16x32_bf16 v[108:111], a[168:171], v[160:163], v[108:111]
 s_barrier
 ds_read_b64_tr_b16 a[160:161], v2 offset:50688
 ds_read_b64_tr_b16 a[162:163], v4 offset:50688
 v_mfma_f32_16x16x32_bf16 v[108:111], a[172:175], v[176:179], v[108:111]
 ds_read_b64 v[174:175], v22 offset:2048
 v_mfma_f32_16x16x32_bf16 v[124:127], a[172:175], v[184:187], v[124:127]
 ds_read_b64_tr_b16 a[164:165], v3 offset:50688
 ds_read_b64_tr_b16 a[166:167], v5 offset:50688
 v_mfma_f32_16x16x32_bf16 v[124:127], a[168:171], v[168:171], v[124:127]
 s_waitcnt lgkmcnt(7)
 v_mfma_f32_16x16x32_bf16 v[100:103], a[176:179], v[192:195], v[100:103]
 s_xor_b32 s56, s43, 0x30000
 ds_read_b64_tr_b16 a[168:169], v2 offset:50720
 ds_read_b64_tr_b16 a[170:171], v4 offset:50720
 v_mfma_f32_16x16x32_bf16 v[100:103], a[180:183], v[208:211], v[100:103]
 s_add_u32 m0, s40, 0x16c60
 v_mfma_f32_16x16x32_bf16 v[116:119], a[180:183], v[216:219], v[116:119]
 s_waitcnt vmcnt(5)
 v_mfma_f32_16x16x32_bf16 v[116:119], a[176:179], v[200:203], v[116:119]
 ds_read_b64_tr_b16 a[172:173], v3 offset:50720
 ds_read_b64_tr_b16 a[174:175], v5 offset:50720
 v_mfma_f32_16x16x32_bf16 v[132:135], a[176:179], v[244:247], v[132:135]
 buffer_load_dwordx4 v16, s[20:23], s56 offen offset:1536 nt lds
 v_mfma_f32_16x16x32_bf16 v[132:135], a[180:183], v[252:255], v[132:135]
 s_waitcnt lgkmcnt(9)
 v_mfma_f32_16x16x32_bf16 v[108:111], a[184:187], v[192:195], v[108:111]
 ds_read_b64_tr_b16 a[176:177], v2 offset:50752
 ds_read_b64_tr_b16 a[178:179], v4 offset:50752
 v_mfma_f32_16x16x32_bf16 v[108:111], a[188:191], v[208:211], v[108:111]
 v_mfma_f32_16x16x32_bf16 v[124:127], a[188:191], v[216:219], v[124:127]
 ds_read_b64_tr_b16 a[180:181], v3 offset:50752
 ds_read_b64_tr_b16 a[182:183], v5 offset:50752
 v_mfma_f32_16x16x32_bf16 v[124:127], a[184:187], v[200:203], v[124:127]
 s_waitcnt lgkmcnt(8)
 v_mfma_f32_16x16x32_bf16 a[0:3], a[160:163], v[140:143], a[0:3]
 s_xor_b32 s56, s42, 0x3c000
 ds_read_b64_tr_b16 a[184:185], v2 offset:50784
 ds_read_b64_tr_b16 a[186:187], v4 offset:50784
 v_mfma_f32_16x16x32_bf16 a[128:131], a[160:163], v[172:175], a[128:131]
 s_add_u32 m0, s40, 0xc600
 v_mfma_f32_16x16x32_bf16 a[8:11], a[160:163], v[156:159], a[8:11]
 s_cbranch_vccnz L_stub_13_B1
L_stub_13_B1_ret:
 v_mfma_f32_16x16x32_bf16 a[40:43], a[164:167], v[156:159], a[40:43]
 s_waitcnt vmcnt(5)
 ds_read_b64_tr_b16 a[188:189], v3 offset:50784
 ds_read_b64_tr_b16 a[190:191], v5 offset:50784
 v_mfma_f32_16x16x32_bf16 a[32:35], a[164:167], v[140:143], a[32:35]
 s_waitcnt lgkmcnt(8)
 buffer_load_dwordx4 v16, s[16:19], s56 offen offset:0 nt lds
 v_mfma_f32_16x16x32_bf16 a[4:7], a[168:171], v[140:143], a[4:7]
 ds_read_b64_tr_b16 a[160:161], v2 offset:50944
 ds_read_b64_tr_b16 a[162:163], v4 offset:50944
 v_mfma_f32_16x16x32_bf16 a[132:135], a[168:171], v[172:175], a[132:135]
 v_exp_f32 v132, v132
 v_mfma_f32_16x16x32_bf16 a[12:15], a[168:171], v[156:159], a[12:15]
 v_exp_f32 v133, v133
 v_mfma_f32_16x16x32_bf16 a[44:47], a[172:175], v[156:159], a[44:47]
 ds_read_b64_tr_b16 a[164:165], v3 offset:50944
 ds_read_b64_tr_b16 a[166:167], v5 offset:50944
 v_mfma_f32_16x16x32_bf16 a[36:39], a[172:175], v[140:143], a[36:39]
 s_waitcnt lgkmcnt(8)
 v_exp_f32 v134, v134
 v_mfma_f32_16x16x32_bf16 a[16:19], a[176:179], v[140:143], a[16:19]
 s_add_u32 m0, s40, 0xc820
 ds_read_b64_tr_b16 a[168:169], v2 offset:50976
 ds_read_b64_tr_b16 a[170:171], v4 offset:50976
 v_mfma_f32_16x16x32_bf16 a[136:139], a[176:179], v[172:175], a[136:139]
 s_waitcnt vmcnt(5)
 v_exp_f32 v135, v135
 v_mfma_f32_16x16x32_bf16 a[24:27], a[176:179], v[156:159], a[24:27]
 buffer_load_dwordx4 v16, s[16:19], s56 offen offset:512 nt lds
 v_add_f32 v34, v34, v132
 v_mfma_f32_16x16x32_bf16 a[56:59], a[180:183], v[156:159], a[56:59]
 ds_read_b64_tr_b16 a[172:173], v3 offset:50976
 ds_read_b64_tr_b16 a[174:175], v5 offset:50976
 v_mfma_f32_16x16x32_bf16 a[48:51], a[180:183], v[140:143], a[48:51]
 s_waitcnt lgkmcnt(8)
 v_add_f32 v34, v34, v133
 v_cvt_pk_bf16_f32 v132, v132, v133
 v_mfma_f32_16x16x32_bf16 a[20:23], a[184:187], v[140:143], a[20:23]
 ds_read_b64_tr_b16 a[176:177], v2 offset:51008
 ds_read_b64_tr_b16 a[178:179], v4 offset:51008
 v_mfma_f32_16x16x32_bf16 a[140:143], a[184:187], v[172:175], a[140:143]
 v_add_f32 v34, v34, v134
 v_add_f32 v34, v34, v135
 v_mfma_f32_16x16x32_bf16 a[28:31], a[184:187], v[156:159], a[28:31]
 v_cvt_pk_bf16_f32 v133, v134, v135
 v_mfma_f32_16x16x32_bf16 a[60:63], a[188:191], v[156:159], a[60:63]
 ds_read_b64_tr_b16 a[180:181], v3 offset:51008
 ds_read_b64_tr_b16 a[182:183], v5 offset:51008
 v_mfma_f32_16x16x32_bf16 a[52:55], a[188:191], v[140:143], a[52:55]
 s_waitcnt lgkmcnt(8)
 v_exp_f32 v100, v100
 v_mfma_f32_16x16x32_bf16 a[64:67], a[160:163], v[140:143], a[64:67]
 s_add_u32 m0, s40, 0xca40
 ds_read_b64_tr_b16 a[184:185], v2 offset:51040
 ds_read_b64_tr_b16 a[186:187], v4 offset:51040
 v_mfma_f32_16x16x32_bf16 a[144:147], a[160:163], v[172:175], a[144:147]
 s_waitcnt vmcnt(5)
 v_exp_f32 v101, v101
 v_mfma_f32_16x16x32_bf16 a[72:75], a[160:163], v[156:159], a[72:75]
L_pad18:
 s_cbranch_execz L_e3_back
 buffer_load_dwordx4 v16, s[16:19], s56 offen offset:1024 nt lds
 v_add_f32 v32, v32, v100
 v_mfma_f32_16x16x32_bf16 a[104:107], a[164:167], v[156:159], a[104:107]
 ds_read_b64_tr_b16 a[188:189], v3 offset:51040
 ds_read_b64_tr_b16 a[190:191], v5 offset:51040
 v_mfma_f32_16x16x32_bf16 a[96:99], a[164:167], v[140:143], a[96:99]
 s_waitcnt lgkmcnt(8)
 v_exp_f32 v102, v102
 v_mfma_f32_16x16x32_bf16 a[68:71], a[168:171], v[140:143], a[68:71]
 s_mov_b64 exec, 0
 s_cmp_eq_u32 s5, 0
 s_cbranch_scc1 L_pad20
 s_cmp_eq_u32 s5, 1
 s_cbranch_scc1 L_pad21
 s_cmp_eq_u32 s5, 2
 s_cbranch_scc1 L_pad22
 s_branch L_pad23
L_e4_back:
 s_mov_b64 exec, -1
 s_barrier
 ds_read_b128 a[160:163], v6 offset:33792
 v_mfma_f32_16x16x32_bf16 a[148:151], a[168:171], v[172:175], a[148:151]
 ds_write_b64 v21, v[132:133] offset:2048
 v_add_f32 v32, v32, v101
 v_mfma_f32_16x16x32_bf16 a[76:79], a[168:171], v[156:159], a[76:79]
 v_exp_f32 v103, v103
 v_mfma_f32_16x16x32_bf16 a[108:111], a[172:175], v[156:159], a[108:111]
 ds_read_b128 a[164:167], v6 offset:33856
 v_cvt_pk_bf16_f32 v100, v100, v101
 v_mfma_f32_16x16x32_bf16 a[100:103], a[172:175], v[140:143], a[100:103]
 s_waitcnt lgkmcnt(7)
 v_exp_f32 v108, v108
 v_mfma_f32_16x16x32_bf16 a[80:83], a[176:179], v[140:143], a[80:83]
 ds_read_b128 a[168:171], v8 offset:33792
 v_add_f32 v32, v32, v102
 v_mfma_f32_16x16x32_bf16 a[152:155], a[176:179], v[172:175], a[152:155]
 v_exp_f32 v109, v109
 v_mfma_f32_16x16x32_bf16 a[88:91], a[176:179], v[156:159], a[88:91]
 v_exp_f32 v110, v110
 v_mfma_f32_16x16x32_bf16 a[120:123], a[180:183], v[156:159], a[120:123]
 ds_read_b128 a[172:175], v8 offset:33856
 v_add_f32 v32, v32, v103
 v_mfma_f32_16x16x32_bf16 a[112:115], a[180:183], v[140:143], a[112:115]
 s_waitcnt lgkmcnt(5)
 v_exp_f32 v111, v111
 v_mfma_f32_16x16x32_bf16 a[84:87], a[184:187], v[140:143], a[84:87]
 s_xor_b32 s56, s42, 0x3c000
 ds_read_b128 a[176:179], v7 offset:33792
 v_cvt_pk_bf16_f32 v101, v102, v103
 v_mfma_f32_16x16x32_bf16 a[156:159], a[184:187], v[172:175], a[156:159]
 s_add_u32 m0, s40, 0xcc60
 v_exp_f32 v116, v116
 v_mfma_f32_16x16x32_bf16 a[92:95], a[184:187], v[156:159], a[92:95]
 s_waitcnt vmcnt(5)
 v_exp_f32 v117, v117
 v_mfma_f32_16x16x32_bf16 a[124:127], a[188:191], v[156:159], a[124:127]
 ds_read_b128 a[180:183], v7 offset:33856
 buffer_load_dwordx4 v16, s[16:19], s56 offen offset:1536 nt lds
 v_mfma_f32_16x16x32_bf16 a[116:119], a[188:191], v[140:143], a[116:119]
 s_waitcnt lgkmcnt(4)
 v_exp_f32 v118, v118
 v_mfma_f32_16x16x32_bf16 v[140:143], a[160:163], v[96:99], v[44:47]
 ds_read_b128 a[184:187], v9 offset:33792
 v_add_f32 v32, v32, v108
 v_mfma_f32_16x16x32_bf16 v[140:143], a[164:167], v[112:115], v[140:143]
 v_exp_f32 v119, v119
 v_mfma_f32_16x16x32_bf16 v[156:159], a[164:167], v[120:123], v[48:51]
 v_exp_f32 v124, v124
 v_mfma_f32_16x16x32_bf16 v[156:159], a[160:163], v[104:107], v[156:159]
 ds_read_b128 a[188:191], v9 offset:33856
 v_add_f32 v32, v32, v109
 v_mfma_f32_16x16x32_bf16 v[172:175], a[160:163], v[224:227], v[52:55]
 v_exp_f32 v125, v125
 v_mfma_f32_16x16x32_bf16 v[172:175], a[164:167], v[232:235], v[172:175]
 s_waitcnt lgkmcnt(4)
 v_exp_f32 v126, v126
 v_mfma_f32_16x16x32_bf16 v[148:151], a[168:171], v[96:99], v[44:47]
 s_add_u32 s42, s42, 0x200000
 ds_read_b128 a[160:163], v6 offset:34048
 v_cvt_pk_bf16_f32 v102, v108, v109
 v_mfma_f32_16x16x32_bf16 v[148:151], a[172:175], v[112:115], v[148:151]
 s_xor_b32 s56, s43, 0x34000
 v_exp_f32 v127, v127
 v_mfma_f32_16x16x32_bf16 v[164:167], a[172:175], v[120:123], v[48:51]
 s_add_u32 m0, s40, 0x1a800
 ds_read_b128 a[164:167], v6 offset:34112
 v_add_f32 v32, v32, v110
 v_mfma_f32_16x16x32_bf16 v[164:167], a[168:171], v[104:107], v[164:167]
 s_waitcnt lgkmcnt(4)
 v_add_f32 v32, v32, v111
 v_cvt_pk_bf16_f32 v103, v110, v111
 v_mfma_f32_16x16x32_bf16 v[140:143], a[176:179], v[128:131], v[140:143]
 s_waitcnt vmcnt(5)
 ds_read_b128 a[168:171], v8 offset:34048
 v_add_f32 v33, v33, v116
 v_mfma_f32_16x16x32_bf16 v[140:143], a[180:183], v[144:147], v[140:143]
 buffer_load_dwordx4 v16, s[20:23], s56 offen offset:0 nt lds
 v_add_f32 v33, v33, v117
 v_mfma_f32_16x16x32_bf16 v[156:159], a[180:183], v[152:155], v[156:159]
 v_cvt_pk_bf16_f32 v116, v116, v117
 v_add_f32 v33, v33, v118
 v_mfma_f32_16x16x32_bf16 v[156:159], a[176:179], v[136:139], v[156:159]
 ds_read_b128 a[172:175], v8 offset:34112
 v_add_f32 v33, v33, v119
 v_mfma_f32_16x16x32_bf16 v[172:175], a[176:179], v[228:231], v[172:175]
 v_cvt_pk_bf16_f32 v117, v118, v119
 v_add_f32 v33, v33, v124
 v_mfma_f32_16x16x32_bf16 v[172:175], a[180:183], v[236:239], v[172:175]
 s_waitcnt lgkmcnt(4)
 v_add_f32 v33, v33, v125
 v_cvt_pk_bf16_f32 v118, v124, v125
 v_mfma_f32_16x16x32_bf16 v[148:151], a[184:187], v[128:131], v[148:151]
 ds_read_b128 a[176:179], v7 offset:34048
 v_add_f32 v33, v33, v126
 v_mfma_f32_16x16x32_bf16 v[148:151], a[188:191], v[144:147], v[148:151]
 s_add_u32 m0, s40, 0x1aa20
 v_add_f32 v33, v33, v127
 v_cvt_pk_bf16_f32 v119, v126, v127
 v_mfma_f32_16x16x32_bf16 v[164:167], a[188:191], v[152:155], v[164:167]
 s_waitcnt vmcnt(5)
 ds_read_b128 a[180:183], v7 offset:34112
 v_mfma_f32_16x16x32_bf16 v[164:167], a[184:187], v[136:139], v[164:167]
 s_waitcnt lgkmcnt(4)
 buffer_load_dwordx4 v16, s[20:23], s56 offen offset:512 nt lds
 v_mfma_f32_16x16x32_bf16 v[140:143], a[160:163], v[160:163], v[140:143]
 ds_read_b128 a[184:187], v9 offset:34048
 v_mfma_f32_16x16x32_bf16 v[140:143], a[164:167], v[176:179], v[140:143]
 v_mfma_f32_16x16x32_bf16 v[156:159], a[164:167], v[184:187], v[156:159]
 v_mfma_f32_16x16x32_bf16 v[156:159], a[160:163], v[168:171], v[156:159]
 ds_read_b128 a[188:191], v9 offset:34112
 v_mfma_f32_16x16x32_bf16 v[172:175], a[160:163], v[240:243], v[172:175]
 v_mfma_f32_16x16x32_bf16 v[172:175], a[164:167], v[248:251], v[172:175]
 s_waitcnt lgkmcnt(4)
 v_mfma_f32_16x16x32_bf16 v[148:151], a[168:171], v[160:163], v[148:151]
 s_barrier
 ds_read_b64_tr_b16 a[160:161], v2 offset:0
 ds_read_b64_tr_b16 a[162:163], v4 offset:0
 v_mfma_f32_16x16x32_bf16 v[148:151], a[172:175], v[176:179], v[148:151]
 ds_read_b64 v[74:75], v22 offset:0
 v_mfma_f32_16x16x32_bf16 v[164:167], a[172:175], v[184:187], v[164:167]
 ds_read_b64_tr_b16 a[164:165], v3 offset:0
 ds_read_b64_tr_b16 a[166:167], v5 offset:0
 v_mfma_f32_16x16x32_bf16 v[164:167], a[168:171], v[168:171], v[164:167]
 s_waitcnt lgkmcnt(7)
 v_mfma_f32_16x16x32_bf16 v[140:143], a[176:179], v[192:195], v[140:143]
 ds_read_b64_tr_b16 a[168:169], v2 offset:32
 ds_read_b64_tr_b16 a[170:171], v4 offset:32
 v_mfma_f32_16x16x32_bf16 v[140:143], a[180:183], v[208:211], v[140:143]
 v_mfma_f32_16x16x32_bf16 v[156:159], a[180:183], v[216:219], v[156:159]
 s_xor_b32 s56, s43, 0x34000
 v_mfma_f32_16x16x32_bf16 v[156:159], a[176:179], v[200:203], v[156:159]
 s_add_u32 m0, s40, 0x1ac40
 ds_read_b64_tr_b16 a[172:173], v3 offset:32
 ds_read_b64_tr_b16 a[174:175], v5 offset:32
 v_mfma_f32_16x16x32_bf16 v[172:175], a[176:179], v[244:247], v[172:175]
 s_waitcnt vmcnt(5)
 v_mfma_f32_16x16x32_bf16 v[172:175], a[180:183], v[252:255], v[172:175]
 s_waitcnt lgkmcnt(9)
 buffer_load_dwordx4 v16, s[20:23], s56 offen offset:1024 nt lds
 v_mfma_f32_16x16x32_bf16 v[148:151], a[184:187], v[192:195], v[148:151]
 ds_read_b64_tr_b16 a[176:177], v2 offset:64
 ds_read_b64_tr_b16 a[178:179], v4 offset:64
 v_mfma_f32_16x16x32_bf16 v[148:151], a[188:191], v[208:211], v[148:151]
 v_mfma_f32_16x16x32_bf16 v[164:167], a[188:191], v[216:219], v[164:167]
 ds_read_b64_tr_b16 a[180:181], v3 offset:64
 ds_read_b64_tr_b16 a[182:183], v5 offset:64
 v_mfma_f32_16x16x32_bf16 v[164:167], a[184:187], v[200:203], v[164:167]
 s_waitcnt lgkmcnt(8)
 v_mfma_f32_16x16x32_bf16 a[0:3], a[160:163], v[56:59], a[0:3]
 ds_read_b64_tr_b16 a[184:185], v2 offset:96
 ds_read_b64_tr_b16 a[186:187], v4 offset:96
 v_mfma_f32_16x16x32_bf16 a[128:131], a[160:163], v[72:75], a[128:131]
 v_mfma_f32_16x16x32_bf16 a[8:11], a[160:163], v[64:67], a[8:11]
 s_cbranch_vccnz L_stub_14_B1
L_stub_14_B1_ret:
 v_mfma_f32_16x16x32_bf16 a[40:43], a[164:167], v[64:67], a[40:43]
 s_add_u32 m0, s40, 0x1ae60
 ds_read_b64_tr_b16 a[188:189], v3 offset:96
 ds_read_b64_tr_b16 a[190:191], v5 offset:96
 v_mfma_f32_16x16x32_bf16 a[32:35], a[164:167], v[56:59], a[32:35]
 s_waitcnt lgkmcnt(8)
 v_exp_f32 v172, v172
 v_mfma_f32_16x16x32_bf16 a[4:7], a[168:171], v[56:59], a[4:7]
 s_waitcnt vmcnt(5)
 ds_read_b64_tr_b16 a[160:161], v2 offset:256
 ds_read_b64_tr_b16 a[162:163], v4 offset:256
 v_mfma_f32_16x16x32_bf16 a[132:135], a[168:171], v[72:75], a[132:135]
 buffer_load_dwordx4 v16, s[20:23], s56 offen offset:1536 nt lds
 v_mfma_f32_16x16x32_bf16 a[12:15], a[168:171], v[64:67], a[12:15]
 v_exp_f32 v173, v173
 v_mfma_f32_16x16x32_bf16 a[44:47], a[172:175], v[64:67], a[44:47]
 ds_read_b64_tr_b16 a[164:165], v3 offset:256
 ds_read_b64_tr_b16 a[166:167], v5 offset:256
 v_mfma_f32_16x16x32_bf16 a[36:39], a[172:175], v[56:59], a[36:39]
 s_waitcnt lgkmcnt(8)
 v_exp_f32 v174, v174
 v_mfma_f32_16x16x32_bf16 a[16:19], a[176:179], v[56:59], a[16:19]
 ds_read_b64_tr_b16 a[168:169], v2 offset:288
 ds_read_b64_tr_b16 a[170:171], v4 offset:288
 v_mfma_f32_16x16x32_bf16 a[136:139], a[176:179], v[72:75], a[136:139]
 v_exp_f32 v175, v175
 v_mfma_f32_16x16x32_bf16 a[24:27], a[176:179], v[64:67], a[24:27]
 s_xor_b32 s56, s43, 0x38000
 v_add_f32 v34, v34, v172
 v_add_f32 v34, v34, v173
 v_mfma_f32_16x16x32_bf16 a[56:59], a[180:183], v[64:67], a[56:59]
 s_add_u32 m0, s40, 0x1ea00
 ds_read_b64_tr_b16 a[172:173], v3 offset:288
 ds_read_b64_tr_b16 a[174:175], v5 offset:288
 v_mfma_f32_16x16x32_bf16 a[48:51], a[180:183], v[56:59], a[48:51]
 s_waitcnt lgkmcnt(8)
 v_cvt_pk_bf16_f32 v172, v172, v173
 v_add_f32 v34, v34, v174
 v_mfma_f32_16x16x32_bf16 a[20:23], a[184:187], v[56:59], a[20:23]
 s_waitcnt vmcnt(5)
 ds_read_b64_tr_b16 a[176:177], v2 offset:320
 ds_read_b64_tr_b16 a[178:179], v4 offset:320
 v_mfma_f32_16x16x32_bf16 a[140:143], a[184:187], v[72:75], a[140:143]
 buffer_load_dwordx4 v16, s[20:23], s56 offen offset:0 nt lds
 v_add_f32 v34, v34, v175
 v_mfma_f32_16x16x32_bf16 a[28:31], a[184:187], v[64:67], a[28:31]
 v_cvt_pk_bf16_f32 v173, v174, v175
 v_mfma_f32_16x16x32_bf16 a[60:63], a[188:191], v[64:67], a[60:63]
 ds_read_b64_tr_b16 a[180:181], v3 offset:320
 ds_read_b64_tr_b16 a[182:183], v5 offset:320
 v_mfma_f32_16x16x32_bf16 a[52:55], a[188:191], v[56:59], a[52:55]
 s_waitcnt lgkmcnt(8)
 v_exp_f32 v140, v140
 v_mfma_f32_16x16x32_bf16 a[64:67], a[160:163], v[56:59], a[64:67]
 ds_read_b64_tr_b16 a[184:185], v2 offset:352
 ds_read_b64_tr_b16 a[186:187], v4 offset:352
 v_mfma_f32_16x16x32_bf16 a[144:147], a[160:163], v[72:75], a[144:147]
 v_exp_f32 v141, v141
 v_mfma_f32_16x16x32_bf16 a[72:75], a[160:163], v[64:67], a[72:75]
 v_exp_f32 v142, v142
 v_mfma_f32_16x16x32_bf16 a[104:107], a[164:167], v[64:67], a[104:107]
 ds_read_b64_tr_b16 a[188:189], v3 offset:352
 ds_read_b64_tr_b16 a[190:191], v5 offset:352
 v_mfma_f32_16x16x32_bf16 a[96:99], a[164:167], v[56:59], a[96:99]
 s_waitcnt lgkmcnt(8)
 v_exp_f32 v143, v143
 v_mfma_f32_16x16x32_bf16 a[68:71], a[168:171], v[56:59], a[68:71]
 s_waitcnt vmcnt(5)
 s_barrier
 ds_read_b128 a[160:163], v6 offset:50688
 v_mfma_f32_16x16x32_bf16 a[148:151], a[168:171], v[72:75], a[148:151]
 ds_write_b64 v21, v[172:173] offset:0
 v_add_f32 v32, v32, v140
 v_mfma_f32_16x16x32_bf16 a[76:79], a[168:171], v[64:67], a[76:79]
 s_xor_b32 s56, s43, 0x38000
 v_exp_f32 v148, v148
 v_mfma_f32_16x16x32_bf16 a[108:111], a[172:175], v[64:67], a[108:111]
 s_add_u32 m0, s40, 0x1ec20
 ds_read_b128 a[164:167], v6 offset:50752
 v_add_f32 v32, v32, v141
 v_mfma_f32_16x16x32_bf16 a[100:103], a[172:175], v[56:59], a[100:103]
 s_waitcnt lgkmcnt(7)
 v_exp_f32 v149, v149
 v_mfma_f32_16x16x32_bf16 a[80:83], a[176:179], v[56:59], a[80:83]
 ds_read_b128 a[168:171], v8 offset:50688
 v_cvt_pk_bf16_f32 v140, v140, v141
 v_mfma_f32_16x16x32_bf16 a[152:155], a[176:179], v[72:75], a[152:155]
 buffer_load_dwordx4 v16, s[20:23], s56 offen offset:512 nt lds
 v_add_f32 v32, v32, v142
 v_mfma_f32_16x16x32_bf16 a[88:91], a[176:179], v[64:67], a[88:91]
 v_exp_f32 v150, v150
 v_mfma_f32_16x16x32_bf16 a[120:123], a[180:183], v[64:67], a[120:123]
 ds_read_b128 a[172:175], v8 offset:50752
 v_add_f32 v32, v32, v143
 v_mfma_f32_16x16x32_bf16 a[112:115], a[180:183], v[56:59], a[112:115]
 s_waitcnt lgkmcnt(5)
 v_exp_f32 v151, v151
 v_mfma_f32_16x16x32_bf16 a[84:87], a[184:187], v[56:59], a[84:87]
 ds_read_b128 a[176:179], v7 offset:50688
 v_cvt_pk_bf16_f32 v141, v142, v143
 v_mfma_f32_16x16x32_bf16 a[156:159], a[184:187], v[72:75], a[156:159]
 v_exp_f32 v156, v156
 v_mfma_f32_16x16x32_bf16 a[92:95], a[184:187], v[64:67], a[92:95]
 s_add_u32 m0, s40, 0x1ee40
 v_exp_f32 v157, v157
 v_mfma_f32_16x16x32_bf16 a[124:127], a[188:191], v[64:67], a[124:127]
 s_waitcnt vmcnt(5)
 ds_read_b128 a[180:183], v7 offset:50752
 v_add_f32 v32, v32, v148
 v_mfma_f32_16x16x32_bf16 a[116:119], a[188:191], v[56:59], a[116:119]
 s_waitcnt lgkmcnt(4)
 buffer_load_dwordx4 v16, s[20:23], s56 offen offset:1024 nt lds
 v_add_f32 v32, v32, v149
 v_mfma_f32_16x16x32_bf16 v[56:59], a[160:163], v[96:99], v[44:47]
 ds_read_b128 a[184:187], v9 offset:50688
 v_cvt_pk_bf16_f32 v142, v148, v149
 v_mfma_f32_16x16x32_bf16 v[56:59], a[164:167], v[112:115], v[56:59]
 v_exp_f32 v158, v158
 v_mfma_f32_16x16x32_bf16 v[64:67], a[164:167], v[120:123], v[48:51]
 v_exp_f32 v159, v159
 v_mfma_f32_16x16x32_bf16 v[64:67], a[160:163], v[104:107], v[64:67]
 ds_read_b128 a[188:191], v9 offset:50752
 v_add_f32 v32, v32, v150
 v_mfma_f32_16x16x32_bf16 v[72:75], a[160:163], v[224:227], v[52:55]
 v_exp_f32 v164, v164
 v_mfma_f32_16x16x32_bf16 v[72:75], a[164:167], v[232:235], v[72:75]
 s_waitcnt lgkmcnt(4)
 v_exp_f32 v165, v165
 v_mfma_f32_16x16x32_bf16 v[60:63], a[168:171], v[96:99], v[44:47]
 ds_read_b128 a[160:163], v6 offset:50944
 v_add_f32 v32, v32, v151
 v_mfma_f32_16x16x32_bf16 v[60:63], a[172:175], v[112:115], v[60:63]
 v_exp_f32 v166, v166
 v_mfma_f32_16x16x32_bf16 v[68:71], a[172:175], v[120:123], v[48:51]
 s_add_u32 m0, s40, 0x1f060
 ds_read_b128 a[164:167], v6 offset:51008
 v_cvt_pk_bf16_f32 v143, v150, v151
 v_mfma_f32_16x16x32_bf16 v[68:71], a[168:171], v[104:107], v[68:71]
 s_waitcnt lgkmcnt(4)
 v_exp_f32 v167, v167
 v_mfma_f32_16x16x32_bf16 v[56:59], a[176:179], v[128:131], v[56:59]
 s_waitcnt vmcnt(5)
 ds_read_b128 a[168:171], v8 offset:50944
 v_add_f32 v33, v33, v156
 v_mfma_f32_16x16x32_bf16 v[56:59], a[180:183], v[144:147], v[56:59]
 buffer_load_dwordx4 v16, s[20:23], s56 offen offset:1536 nt lds
 v_add_f32 v33, v33, v157
 v_mfma_f32_16x16x32_bf16 v[64:67], a[180:183], v[152:155], v[64:67]
 v_cvt_pk_bf16_f32 v156, v156, v157
 v_add_f32 v33, v33, v158
 v_mfma_f32_16x16x32_bf16 v[64:67], a[176:179], v[136:139], v[64:67]
 ds_read_b128 a[172:175], v8 offset:51008
 v_add_f32 v33, v33, v159
 v_mfma_f32_16x16x32_bf16 v[72:75], a[176:179], v[228:231], v[72:75]
 v_cvt_pk_bf16_f32 v157, v158, v159
 v_add_f32 v33, v33, v164
 v_mfma_f32_16x16x32_bf16 v[72:75], a[180:183], v[236:239], v[72:75]
 s_waitcnt lgkmcnt(4)
 v_add_f32 v33, v33, v165
 v_cvt_pk_bf16_f32 v158, v164, v165
 v_mfma_f32_16x16x32_bf16 v[60:63], a[184:187], v[128:131], v[60:63]
 ds_read_b128 a[176:179], v7 offset:50944
 v_add_f32 v33, v33, v166
 v_mfma_f32_16x16x32_bf16 v[60:63], a[188:191], v[144:147], v[60:63]
 v_add_f32 v33, v33, v167
 v_cvt_pk_bf16_f32 v159, v166, v167
 v_mfma_f32_16x16x32_bf16 v[68:71], a[188:191], v[152:155], v[68:71]
 s_xor_b32 s56, s43, 0x3c000
 ds_read_b128 a[180:183], v7 offset:51008
 v_mfma_f32_16x16x32_bf16 v[68:71], a[184:187], v[136:139], v[68:71]
 s_waitcnt lgkmcnt(4)
 v_mfma_f32_16x16x32_bf16 v[56:59], a[160:163], v[160:163], v[56:59]
 s_add_u32 m0, s40, 0x22c00
 ds_read_b128 a[184:187], v9 offset:50944
 v_mfma_f32_16x16x32_bf16 v[56:59], a[164:167], v[176:179], v[56:59]
 s_waitcnt vmcnt(5)
 v_mfma_f32_16x16x32_bf16 v[64:67], a[164:167], v[184:187], v[64:67]
 buffer_load_dwordx4 v16, s[20:23], s56 offen offset:0 nt lds
 v_mfma_f32_16x16x32_bf16 v[64:67], a[160:163], v[168:171], v[64:67]
 ds_read_b128 a[188:191], v9 offset:51008
 v_mfma_f32_16x16x32_bf16 v[72:75], a[160:163], v[240:243], v[72:75]
 v_mfma_f32_16x16x32_bf16 v[72:75], a[164:167], v[248:251], v[72:75]
 s_waitcnt lgkmcnt(4)
 v_mfma_f32_16x16x32_bf16 v[60:63], a[168:171], v[160:163], v[60:63]
 s_waitcnt vmcnt(5)
 s_barrier
 ds_read_b64_tr_b16 a[160:161], v2 offset:16896
 ds_read_b64_tr_b16 a[162:163], v4 offset:16896
 v_mfma_f32_16x16x32_bf16 v[60:63], a[172:175], v[176:179], v[60:63]
 ds_read_b64 v[134:135], v22 offset:2048
 v_add_u32 v6, s48, v212
 v_mfma_f32_16x16x32_bf16 v[68:71], a[172:175], v[184:187], v[68:71]
 ds_read_b64_tr_b16 a[164:165], v3 offset:16896
 ds_read_b64_tr_b16 a[166:167], v5 offset:16896
 v_mfma_f32_16x16x32_bf16 v[68:71], a[168:171], v[168:171], v[68:71]
 s_waitcnt lgkmcnt(7)
 v_add_u32 v7, s92, v212
 v_add_u32 v8, s93, v212
 v_mfma_f32_16x16x32_bf16 v[56:59], a[176:179], v[192:195], v[56:59]
 ds_read_b64_tr_b16 a[168:169], v2 offset:16928
 ds_read_b64_tr_b16 a[170:171], v4 offset:16928
 v_mfma_f32_16x16x32_bf16 v[56:59], a[180:183], v[208:211], v[56:59]
 v_add_u32 v9, s95, v212
 v_mfma_f32_16x16x32_bf16 v[64:67], a[180:183], v[216:219], v[64:67]
 v_mfma_f32_16x16x32_bf16 v[64:67], a[176:179], v[200:203], v[64:67]
 ds_read_b64_tr_b16 a[172:173], v3 offset:16928
 ds_read_b64_tr_b16 a[174:175], v5 offset:16928
 v_mfma_f32_16x16x32_bf16 v[72:75], a[176:179], v[244:247], v[72:75]
 v_mfma_f32_16x16x32_bf16 v[72:75], a[180:183], v[252:255], v[72:75]
 s_waitcnt lgkmcnt(9)
 v_mfma_f32_16x16x32_bf16 v[60:63], a[184:187], v[192:195], v[60:63]
 ds_read_b64_tr_b16 a[176:177], v2 offset:16960
 ds_read_b64_tr_b16 a[178:179], v4 offset:16960
 v_mfma_f32_16x16x32_bf16 v[60:63], a[188:191], v[208:211], v[60:63]
 v_mfma_f32_16x16x32_bf16 v[68:71], a[188:191], v[216:219], v[68:71]
 ds_read_b64_tr_b16 a[180:181], v3 offset:16960
 ds_read_b64_tr_b16 a[182:183], v5 offset:16960
 v_mfma_f32_16x16x32_bf16 v[68:71], a[184:187], v[200:203], v[68:71]
 s_waitcnt lgkmcnt(8)
 v_mfma_f32_16x16x32_bf16 a[0:3], a[160:163], v[100:103], a[0:3]
 ds_read_b64_tr_b16 a[184:185], v2 offset:16992
 ds_read_b64_tr_b16 a[186:187], v4 offset:16992
 v_mfma_f32_16x16x32_bf16 a[128:131], a[160:163], v[132:135], a[128:131]
 s_xor_b32 s56, s43, 0x3c000
 v_mfma_f32_16x16x32_bf16 a[8:11], a[160:163], v[116:119], a[8:11]
 s_cbranch_vccnz L_stub_15_B1
L_stub_15_B1_ret:
 v_mfma_f32_16x16x32_bf16 a[40:43], a[164:167], v[116:119], a[40:43]
 s_add_u32 m0, s40, 0x22e20
 ds_read_b64_tr_b16 a[188:189], v3 offset:16992
 ds_read_b64_tr_b16 a[190:191], v5 offset:16992
 v_mfma_f32_16x16x32_bf16 a[32:35], a[164:167], v[100:103], a[32:35]
 s_waitcnt lgkmcnt(8)
 v_exp_f32 v72, v72
 v_mfma_f32_16x16x32_bf16 a[4:7], a[168:171], v[100:103], a[4:7]
 ds_read_b64_tr_b16 a[160:161], v2 offset:17152
 ds_read_b64_tr_b16 a[162:163], v4 offset:17152
 v_mfma_f32_16x16x32_bf16 a[132:135], a[168:171], v[132:135], a[132:135]
 buffer_load_dwordx4 v16, s[20:23], s56 offen offset:512 nt lds
 v_mfma_f32_16x16x32_bf16 a[12:15], a[168:171], v[116:119], a[12:15]
 v_exp_f32 v73, v73
 v_mfma_f32_16x16x32_bf16 a[44:47], a[172:175], v[116:119], a[44:47]
 s_add_u32 m0, s40, 0x23040
 ds_read_b64_tr_b16 a[164:165], v3 offset:17152
 ds_read_b64_tr_b16 a[166:167], v5 offset:17152
 v_mfma_f32_16x16x32_bf16 a[36:39], a[172:175], v[100:103], a[36:39]
 s_waitcnt lgkmcnt(8)
 v_exp_f32 v74, v74
 v_mfma_f32_16x16x32_bf16 a[16:19], a[176:179], v[100:103], a[16:19]
 s_waitcnt vmcnt(5)
 ds_read_b64_tr_b16 a[168:169], v2 offset:17184
 ds_read_b64_tr_b16 a[170:171], v4 offset:17184
 v_mfma_f32_16x16x32_bf16 a[136:139], a[176:179], v[132:135], a[136:139]
 buffer_load_dwordx4 v16, s[20:23], s56 offen offset:1024 nt lds
 v_mfma_f32_16x16x32_bf16 a[24:27], a[176:179], v[116:119], a[24:27]
 v_exp_f32 v75, v75
 v_mfma_f32_16x16x32_bf16 a[56:59], a[180:183], v[116:119], a[56:59]
 ds_read_b64_tr_b16 a[172:173], v3 offset:17184
 ds_read_b64_tr_b16 a[174:175], v5 offset:17184
 v_mfma_f32_16x16x32_bf16 a[48:51], a[180:183], v[100:103], a[48:51]
 s_waitcnt lgkmcnt(8)
 v_add_f32 v34, v34, v72
 v_add_f32 v34, v34, v73
 v_mfma_f32_16x16x32_bf16 a[20:23], a[184:187], v[100:103], a[20:23]
 s_add_u32 m0, s40, 0x23260
 ds_read_b64_tr_b16 a[176:177], v2 offset:17216
 ds_read_b64_tr_b16 a[178:179], v4 offset:17216
 v_mfma_f32_16x16x32_bf16 a[140:143], a[184:187], v[132:135], a[140:143]
 s_waitcnt vmcnt(5)
 v_cvt_pk_bf16_f32 v72, v72, v73
 v_add_f32 v34, v34, v74
 v_mfma_f32_16x16x32_bf16 a[28:31], a[184:187], v[116:119], a[28:31]
 buffer_load_dwordx4 v16, s[20:23], s56 offen offset:1536 nt lds
 v_add_f32 v34, v34, v75
 v_mfma_f32_16x16x32_bf16 a[60:63], a[188:191], v[116:119], a[60:63]
 s_add_u32 s43, s43, 0x200000
 ds_read_b64_tr_b16 a[180:181], v3 offset:17216
 ds_read_b64_tr_b16 a[182:183], v5 offset:17216
 v_mfma_f32_16x16x32_bf16 a[52:55], a[188:191], v[100:103], a[52:55]
 s_waitcnt lgkmcnt(8)
 v_cvt_pk_bf16_f32 v73, v74, v75
 v_mfma_f32_16x16x32_bf16 a[64:67], a[160:163], v[100:103], a[64:67]
 ds_read_b64_tr_b16 a[184:185], v2 offset:17248
 ds_read_b64_tr_b16 a[186:187], v4 offset:17248
 v_mfma_f32_16x16x32_bf16 a[144:147], a[160:163], v[132:135], a[144:147]
 v_exp_f32 v56, v56
 v_mfma_f32_16x16x32_bf16 a[72:75], a[160:163], v[116:119], a[72:75]
 v_exp_f32 v57, v57
 v_mfma_f32_16x16x32_bf16 a[104:107], a[164:167], v[116:119], a[104:107]
 ds_read_b64_tr_b16 a[188:189], v3 offset:17248
 ds_read_b64_tr_b16 a[190:191], v5 offset:17248
 v_mfma_f32_16x16x32_bf16 a[96:99], a[164:167], v[100:103], a[96:99]
 s_waitcnt lgkmcnt(8)
 v_exp_f32 v58, v58
 v_mfma_f32_16x16x32_bf16 a[68:71], a[168:171], v[100:103], a[68:71]
 s_waitcnt vmcnt(4)
 s_barrier
 ds_read_b64_tr_b16 a[160:161], v2 offset:33792
 ds_read_b64_tr_b16 a[162:163], v4 offset:33792
 v_mfma_f32_16x16x32_bf16 a[148:151], a[168:171], v[132:135], a[148:151]
 s_add_u32 s56, s100, 0
 ds_read_b64 v[174:175], v22 offset:0
 ds_write_b64 v21, v[72:73] offset:2048
 v_mfma_f32_16x16x32_bf16 a[76:79], a[168:171], v[116:119], a[76:79]
 s_add_u32 m0, s40, 0
 v_exp_f32 v59, v59
 v_mfma_f32_16x16x32_bf16 a[108:111], a[172:175], v[116:119], a[108:111]
 ds_read_b64_tr_b16 a[164:165], v3 offset:33792
 ds_read_b64_tr_b16 a[166:167], v5 offset:33792
 v_mfma_f32_16x16x32_bf16 a[100:103], a[172:175], v[100:103], a[100:103]
 s_waitcnt lgkmcnt(10)
 buffer_load_dwordx4 v17, s[28:31], s56 offen offset:0 lds
 v_add_f32 v32, v32, v56
 v_mfma_f32_16x16x32_bf16 a[80:83], a[176:179], v[100:103], a[80:83]
 s_add_u32 m0, s40, 0xa0
 ds_read_b64_tr_b16 a[168:169], v2 offset:33824
 ds_read_b64_tr_b16 a[170:171], v4 offset:33824
 v_mfma_f32_16x16x32_bf16 a[152:155], a[176:179], v[132:135], a[152:155]
 buffer_load_dwordx4 v17, s[28:31], s56 offen offset:896 lds
 v_add_f32 v32, v32, v57
 v_mfma_f32_16x16x32_bf16 a[88:91], a[176:179], v[116:119], a[88:91]
 v_exp_f32 v60, v60
 v_mfma_f32_16x16x32_bf16 a[120:123], a[180:183], v[116:119], a[120:123]
 ds_read_b64_tr_b16 a[172:173], v3 offset:33824
 ds_read_b64_tr_b16 a[174:175], v5 offset:33824
 v_mfma_f32_16x16x32_bf16 a[112:115], a[180:183], v[100:103], a[112:115]
 s_waitcnt lgkmcnt(10)
 v_exp_f32 v61, v61
 v_mfma_f32_16x16x32_bf16 a[84:87], a[184:187], v[100:103], a[84:87]
 s_add_u32 m0, s40, 0x140
 ds_read_b64_tr_b16 a[176:177], v2 offset:33856
 ds_read_b64_tr_b16 a[178:179], v4 offset:33856
 v_mfma_f32_16x16x32_bf16 a[156:159], a[184:187], v[132:135], a[156:159]
 buffer_load_dwordx4 v17, s[28:31], s56 offen offset:1792 lds
 v_cvt_pk_bf16_f32 v56, v56, v57
 v_mfma_f32_16x16x32_bf16 a[92:95], a[184:187], v[116:119], a[92:95]
 v_exp_f32 v62, v62
 v_mfma_f32_16x16x32_bf16 a[124:127], a[188:191], v[116:119], a[124:127]
 ds_read_b64_tr_b16 a[180:181], v3 offset:33856
 ds_read_b64_tr_b16 a[182:183], v5 offset:33856
 v_mfma_f32_16x16x32_bf16 a[116:119], a[188:191], v[100:103], a[116:119]
 s_waitcnt lgkmcnt(8)
 v_exp_f32 v63, v63
 v_mfma_f32_16x16x32_bf16 a[0:3], a[160:163], v[140:143], a[0:3]
 s_add_u32 m0, s40, 0x1e0
 ds_read_b64_tr_b16 a[184:185], v2 offset:33888
 ds_read_b64_tr_b16 a[186:187], v4 offset:33888
 v_mfma_f32_16x16x32_bf16 a[128:131], a[160:163], v[172:175], a[128:131]
 buffer_load_dwordx4 v17, s[28:31], s56 offen offset:2688 lds
 v_add_f32 v32, v32, v58
 v_mfma_f32_16x16x32_bf16 a[8:11], a[160:163], v[156:159], a[8:11]
 v_exp_f32 v64, v64
 v_mfma_f32_16x16x32_bf16 a[40:43], a[164:167], v[156:159], a[40:43]
 s_add_u32 s56, s100, 0x1c000
 ds_read_b64_tr_b16 a[188:189], v3 offset:33888
 ds_read_b64_tr_b16 a[190:191], v5 offset:33888
 v_mfma_f32_16x16x32_bf16 a[32:35], a[164:167], v[140:143], a[32:35]
 s_waitcnt lgkmcnt(8)
 v_exp_f32 v65, v65
 v_mfma_f32_16x16x32_bf16 a[4:7], a[168:171], v[140:143], a[4:7]
 s_add_u32 m0, s40, 0x4200
 ds_read_b64_tr_b16 a[160:161], v2 offset:34048
 ds_read_b64_tr_b16 a[162:163], v4 offset:34048
 v_mfma_f32_16x16x32_bf16 a[132:135], a[168:171], v[172:175], a[132:135]
 buffer_load_dwordx4 v17, s[28:31], s56 offen offset:0 lds
 v_add_f32 v32, v32, v59
 v_mfma_f32_16x16x32_bf16 a[12:15], a[168:171], v[156:159], a[12:15]
 s_add_u32 m0, s40, 0x42a0
 v_exp_f32 v66, v66
 v_mfma_f32_16x16x32_bf16 a[44:47], a[172:175], v[156:159], a[44:47]
 ds_read_b64_tr_b16 a[164:165], v3 offset:34048
 ds_read_b64_tr_b16 a[166:167], v5 offset:34048
 v_mfma_f32_16x16x32_bf16 a[36:39], a[172:175], v[140:143], a[36:39]
 s_waitcnt lgkmcnt(8)
 buffer_load_dwordx4 v17, s[28:31], s56 offen offset:896 lds
 v_cvt_pk_bf16_f32 v57, v58, v59
 v_mfma_f32_16x16x32_bf16 a[16:19], a[176:179], v[140:143], a[16:19]
 ds_read_b64_tr_b16 a[168:169], v2 offset:34080
 ds_read_b64_tr_b16 a[170:171], v4 offset:34080
 v_mfma_f32_16x16x32_bf16 a[136:139], a[176:179], v[172:175], a[136:139]
 v_exp_f32 v67, v67
 v_mfma_f32_16x16x32_bf16 a[24:27], a[176:179], v[156:159], a[24:27]
 s_add_u32 m0, s40, 0x4340
 v_exp_f32 v68, v68
 v_mfma_f32_16x16x32_bf16 a[56:59], a[180:183], v[156:159], a[56:59]
 ds_read_b64_tr_b16 a[172:173], v3 offset:34080
 ds_read_b64_tr_b16 a[174:175], v5 offset:34080
 v_mfma_f32_16x16x32_bf16 a[48:51], a[180:183], v[140:143], a[48:51]
 s_waitcnt lgkmcnt(8)
 buffer_load_dwordx4 v17, s[28:31], s56 offen offset:1792 lds
 v_add_f32 v32, v32, v60
 v_mfma_f32_16x16x32_bf16 a[20:23], a[184:187], v[140:143], a[20:23]
 ds_read_b64_tr_b16 a[176:177], v2 offset:34112
 ds_read_b64_tr_b16 a[178:179], v4 offset:34112
 v_mfma_f32_16x16x32_bf16 a[140:143], a[184:187], v[172:175], a[140:143]
 s_add_u32 m0, s40, 0x43e0
 v_exp_f32 v69, v69
 v_mfma_f32_16x16x32_bf16 a[28:31], a[184:187], v[156:159], a[28:31]
 buffer_load_dwordx4 v17, s[28:31], s56 offen offset:2688 lds
 v_add_f32 v32, v32, v61
 v_mfma_f32_16x16x32_bf16 a[60:63], a[188:191], v[156:159], a[60:63]
 ds_read_b64_tr_b16 a[180:181], v3 offset:34112
 ds_read_b64_tr_b16 a[182:183], v5 offset:34112
 v_mfma_f32_16x16x32_bf16 a[52:55], a[188:191], v[140:143], a[52:55]
 s_waitcnt lgkmcnt(8)
 v_exp_f32 v70, v70
 v_mfma_f32_16x16x32_bf16 a[64:67], a[160:163], v[140:143], a[64:67]
 ds_read_b64_tr_b16 a[184:185], v2 offset:34144
 ds_read_b64_tr_b16 a[186:187], v4 offset:34144
 v_mfma_f32_16x16x32_bf16 a[144:147], a[160:163], v[172:175], a[144:147]
 v_exp_f32 v71, v71
 v_mfma_f32_16x16x32_bf16 a[72:75], a[160:163], v[156:159], a[72:75]
 v_cvt_pk_bf16_f32 v58, v60, v61
 v_add_f32 v32, v32, v62
 v_mfma_f32_16x16x32_bf16 a[104:107], a[164:167], v[156:159], a[104:107]
 ds_read_b64_tr_b16 a[188:189], v3 offset:34144
 ds_read_b64_tr_b16 a[190:191], v5 offset:34144
 v_mfma_f32_16x16x32_bf16 a[96:99], a[164:167], v[140:143], a[96:99]
 s_waitcnt lgkmcnt(8)
 v_add_f32 v32, v32, v63
 v_cvt_pk_bf16_f32 v59, v62, v63
 v_mfma_f32_16x16x32_bf16 a[68:71], a[168:171], v[140:143], a[68:71]
 s_waitcnt vmcnt(8)
 s_barrier
 ds_read_b64_tr_b16 a[160:161], v2 offset:50688
 ds_read_b64_tr_b16 a[162:163], v4 offset:50688
 v_mfma_f32_16x16x32_bf16 a[148:151], a[168:171], v[172:175], a[148:151]
 s_add_u32 s56, s100, 0x1c0000
 ds_read_b64 v[74:75], v22 offset:2048
 v_add_f32 v33, v33, v64
 v_mfma_f32_16x16x32_bf16 a[76:79], a[168:171], v[156:159], a[76:79]
 s_add_u32 m0, s40, 0x8400
 ds_read_b128 v[228:231], v20 offset:0
 v_add_f32 v33, v33, v65
 v_mfma_f32_16x16x32_bf16 a[108:111], a[172:175], v[156:159], a[108:111]
L_pad19:
 s_cbranch_execz L_e3_back
 ds_read_b64_tr_b16 a[164:165], v2 offset:50720
 ds_read_b64_tr_b16 a[166:167], v4 offset:50720
 v_mfma_f32_16x16x32_bf16 a[100:103], a[172:175], v[140:143], a[100:103]
 s_waitcnt lgkmcnt(10)
 v_cvt_pk_bf16_f32 v64, v64, v65
 v_add_f32 v33, v33, v66
 v_mfma_f32_16x16x32_bf16 a[80:83], a[176:179], v[140:143], a[80:83]
 ds_read_b64_tr_b16 a[168:169], v2 offset:50752
 ds_read_b64_tr_b16 a[170:171], v4 offset:50752
 v_mfma_f32_16x16x32_bf16 a[152:155], a[176:179], v[172:175], a[152:155]
 v_add_f32 v33, v33, v67
 v_cvt_pk_bf16_f32 v65, v66, v67
 v_mfma_f32_16x16x32_bf16 a[88:91], a[176:179], v[156:159], a[88:91]
 ds_read_b128 v[236:239], v20 offset:1024
 v_add_f32 v33, v33, v68
 v_mfma_f32_16x16x32_bf16 a[120:123], a[180:183], v[156:159], a[120:123]
 ds_read_b64_tr_b16 a[172:173], v2 offset:50784
 ds_read_b64_tr_b16 a[174:175], v4 offset:50784
 v_mfma_f32_16x16x32_bf16 a[112:115], a[180:183], v[140:143], a[112:115]
 s_waitcnt lgkmcnt(11)
 v_add_f32 v33, v33, v69
 v_cvt_pk_bf16_f32 v66, v68, v69
 v_mfma_f32_16x16x32_bf16 a[84:87], a[184:187], v[140:143], a[84:87]
 ds_read_b64_tr_b16 a[176:177], v2 offset:50944
 ds_read_b64_tr_b16 a[178:179], v4 offset:50944
 v_mfma_f32_16x16x32_bf16 a[156:159], a[184:187], v[172:175], a[156:159]
 v_add_f32 v33, v33, v70
 v_add_f32 v33, v33, v71
 v_mfma_f32_16x16x32_bf16 a[92:95], a[184:187], v[156:159], a[92:95]
 ds_read_b128 v[244:247], v20 offset:2048
 v_cvt_pk_bf16_f32 v67, v70, v71
 v_mfma_f32_16x16x32_bf16 a[124:127], a[188:191], v[156:159], a[124:127]
 ds_read_b64_tr_b16 a[180:181], v2 offset:50976
 ds_read_b64_tr_b16 a[182:183], v4 offset:50976
 v_mfma_f32_16x16x32_bf16 a[116:119], a[188:191], v[140:143], a[116:119]
 s_waitcnt lgkmcnt(10)
 v_add_f32 v78, v32, v33
 v_add_f32 v78, v78, v34
 v_mfma_f32_16x16x32_bf16 a[0:3], a[160:163], v[56:59], a[0:3]
 ds_read_b64_tr_b16 a[184:185], v2 offset:51008
 ds_read_b64_tr_b16 a[186:187], v4 offset:51008
 v_mfma_f32_16x16x32_bf16 a[128:131], a[160:163], v[72:75], a[128:131]
 buffer_load_dwordx4 v17, s[28:31], s56 offen offset:0 lds
 v_mov_b32 v76, 0x4e800000
 v_mfma_f32_16x16x32_bf16 a[8:11], a[160:163], v[64:67], a[8:11]
 s_add_u32 m0, s40, 0x84a0
 ds_read_b128 v[252:255], v20 offset:3072
 v_mfma_f32_16x16x32_bf16 a[12:15], a[164:167], v[64:67], a[12:15]
 ds_read_b64_tr_b16 a[188:189], v2 offset:51040
 ds_read_b64_tr_b16 a[190:191], v4 offset:51040
 v_mfma_f32_16x16x32_bf16 a[132:135], a[164:167], v[72:75], a[132:135]
 v_cmp_nlt_f32_e64 s[62:63], v78, v76
 s_cmp_lg_u64 s[62:63], 0
 s_cselect_b32 s49, 1, 0
 v_mfma_f32_16x16x32_bf16 a[4:7], a[164:167], v[56:59], a[4:7]
 s_waitcnt lgkmcnt(10)
 buffer_load_dwordx4 v17, s[28:31], s56 offen offset:896 lds
 v_mov_b32 v78, s49
 v_mfma_f32_16x16x32_bf16 a[16:19], a[168:171], v[56:59], a[16:19]
 s_add_u32 m0, s40, 0x8540
 ds_read_b64_tr_b16 a[160:161], v3 offset:50688
 ds_read_b64_tr_b16 a[162:163], v5 offset:50688
 v_mfma_f32_16x16x32_bf16 a[136:139], a[168:171], v[72:75], a[136:139]
 ds_write_b32 v25, v78 offset:0
 v_mov_b32 v76, v34
 v_mfma_f32_16x16x32_bf16 a[24:27], a[168:171], v[64:67], a[24:27]
 s_nop 0
 v_permlane32_swap_b32 v76, v34
 v_mfma_f32_16x16x32_bf16 a[28:31], a[172:175], v[64:67], a[28:31]
 ds_read_b64_tr_b16 a[164:165], v3 offset:50720
 ds_read_b64_tr_b16 a[166:167], v5 offset:50720
 v_mfma_f32_16x16x32_bf16 a[140:143], a[172:175], v[72:75], a[140:143]
 v_add_f32 v34, v34, v76
 v_mov_b32 v76, v34
 v_mfma_f32_16x16x32_bf16 a[20:23], a[172:175], v[56:59], a[20:23]
 s_waitcnt lgkmcnt(10)
 v_permlane16_swap_b32 v76, v34
 v_mfma_f32_16x16x32_bf16 a[64:67], a[176:179], v[56:59], a[64:67]
 ds_read_b64_tr_b16 a[168:169], v3 offset:50752
 ds_read_b64_tr_b16 a[170:171], v5 offset:50752
 v_mfma_f32_16x16x32_bf16 a[144:147], a[176:179], v[72:75], a[144:147]
 buffer_load_dwordx4 v17, s[28:31], s56 offen offset:1792 lds
 v_add_f32 v34, v34, v76
 v_mfma_f32_16x16x32_bf16 a[72:75], a[176:179], v[64:67], a[72:75]
 s_add_u32 m0, s40, 0x85e0
 ds_write_b32 v23, v34 offset:0
 v_mov_b32 v76, v32
 v_mfma_f32_16x16x32_bf16 a[76:79], a[180:183], v[64:67], a[76:79]
 ds_read_b64_tr_b16 a[172:173], v3 offset:50784
 ds_read_b64_tr_b16 a[174:175], v5 offset:50784
 v_mfma_f32_16x16x32_bf16 a[148:151], a[180:183], v[72:75], a[148:151]
 buffer_load_dwordx4 v17, s[28:31], s56 offen offset:2688 lds
 v_mfma_f32_16x16x32_bf16 a[68:71], a[180:183], v[56:59], a[68:71]
 s_waitcnt lgkmcnt(10)
 v_permlane32_swap_b32 v76, v32
 v_mfma_f32_16x16x32_bf16 a[80:83], a[184:187], v[56:59], a[80:83]
 s_add_u32 s56, s100, 0x1dc000
 ds_read_b64_tr_b16 a[176:177], v3 offset:50944
 ds_read_b64_tr_b16 a[178:179], v5 offset:50944
 v_mfma_f32_16x16x32_bf16 a[152:155], a[184:187], v[72:75], a[152:155]
 s_add_u32 m0, s40, 0xc600
 v_add_f32 v32, v32, v76
 v_mov_b32 v76, v32
 v_mfma_f32_16x16x32_bf16 a[88:91], a[184:187], v[64:67], a[88:91]
 buffer_load_dwordx4 v17, s[28:31], s56 offen offset:0 lds
 v_mfma_f32_16x16x32_bf16 a[92:95], a[188:191], v[64:67], a[92:95]
 s_add_u32 m0, s40, 0xc6a0
 ds_read_b64_tr_b16 a[180:181], v3 offset:50976
 ds_read_b64_tr_b16 a[182:183], v5 offset:50976
 v_mfma_f32_16x16x32_bf16 a[156:159], a[188:191], v[72:75], a[156:159]
 buffer_load_dwordx4 v17, s[28:31], s56 offen offset:896 lds
 v_mfma_f32_16x16x32_bf16 a[84:87], a[188:191], v[56:59], a[84:87]
 s_waitcnt lgkmcnt(9)
 v_permlane16_swap_b32 v76, v32
 v_mfma_f32_16x16x32_bf16 a[32:35], a[160:163], v[56:59], a[32:35]
 s_add_u32 m0, s40, 0xc740
 ds_read_b64_tr_b16 a[184:185], v3 offset:51008
 ds_read_b64_tr_b16 a[186:187], v5 offset:51008
 v_mfma_f32_16x16x32_bf16 a[40:43], a[160:163], v[64:67], a[40:43]
 buffer_load_dwordx4 v17, s[28:31], s56 offen offset:1792 lds
 v_add_f32 v32, v32, v76
 v_mfma_f32_16x16x32_bf16 a[44:47], a[164:167], v[64:67], a[44:47]
 s_add_u32 m0, s40, 0xc7e0
 ds_read_b64_tr_b16 a[188:189], v3 offset:51040
 ds_read_b64_tr_b16 a[190:191], v5 offset:51040
 v_mfma_f32_16x16x32_bf16 a[36:39], a[164:167], v[56:59], a[36:39]
 s_waitcnt lgkmcnt(8)
 buffer_load_dwordx4 v17, s[28:31], s56 offen offset:2688 lds
 s_add_u32 s100, s100, 0x80
 s_sub_u32 s56, s100, 0x380
 s_min_u32 s100, s100, s56
 v_mfma_f32_16x16x32_bf16 a[48:51], a[168:171], v[56:59], a[48:51]
 s_waitcnt vmcnt(8)
 s_barrier
 ds_read_b64_tr_b16 a[160:161], v6 offset:0
 ds_read_b64_tr_b16 a[162:163], v6 offset:128
 v_mfma_f32_16x16x32_bf16 a[56:59], a[168:171], v[64:67], a[56:59]
 s_add_u32 s56, s100, 0
 ds_read_b32 v77, v24 offset:0
 v_mfma_f32_16x16x32_bf16 a[60:63], a[172:175], v[64:67], a[60:63]
 s_add_u32 m0, s40, 0x16600
 ds_read_b64_tr_b16 a[164:165], v6 offset:256
 ds_read_b64_tr_b16 a[166:167], v6 offset:384
 v_mfma_f32_16x16x32_bf16 a[52:55], a[172:175], v[56:59], a[52:55]
 s_waitcnt lgkmcnt(9)
 ds_read_b128 v[220:223], v26 offset:0
 buffer_load_dwordx4 v17, s[28:31], s56 offen offset:0 lds
 v_mfma_f32_16x16x32_bf16 a[96:99], a[176:179], v[56:59], a[96:99]
 ds_read_b64_tr_b16 a[168:169], v6 offset:32
 ds_read_b64_tr_b16 a[170:171], v6 offset:160
 v_mfma_f32_16x16x32_bf16 a[104:107], a[176:179], v[64:67], a[104:107]
 v_rcp_f32 v35, v32
 v_mfma_f32_16x16x32_bf16 a[108:111], a[180:183], v[64:67], a[108:111]
 ds_read_b64_tr_b16 a[172:173], v6 offset:288
 ds_read_b64_tr_b16 a[174:175], v6 offset:416
 v_mfma_f32_16x16x32_bf16 a[100:103], a[180:183], v[56:59], a[100:103]
 s_waitcnt lgkmcnt(10)
 v_mov_b32 v76, v33
 v_mfma_f32_16x16x32_bf16 a[112:115], a[184:187], v[56:59], a[112:115]
 ds_read_b64_tr_b16 a[176:177], v8 offset:0
 ds_read_b64_tr_b16 a[178:179], v8 offset:128
 v_mfma_f32_16x16x32_bf16 a[120:123], a[184:187], v[64:67], a[120:123]
 s_waitcnt lgkmcnt(6)
 v_or3_b32 v79, v220, v221, v222
 v_or_b32 v79, v79, v223
 v_mfma_f32_16x16x32_bf16 a[124:127], a[188:191], v[64:67], a[124:127]
 s_add_u32 m0, s40, 0x166a0
 ds_read_b64_tr_b16 a[180:181], v8 offset:256
 ds_read_b64_tr_b16 a[182:183], v8 offset:384
 v_mfma_f32_16x16x32_bf16 a[116:119], a[188:191], v[56:59], a[116:119]
 v_readfirstlane_b32 s50, v79
 s_or_b32 s50, s50, s4
 s_cbranch_scc1 L_fail_B1
L_fail_B1_ret:
 v_permlane32_swap_b32 v76, v33
 v_add_f32 v33, v33, v76
 v_mov_b32 v76, v33
 s_nop 1
 v_permlane16_swap_b32 v76, v33
 v_add_f32 v33, v33, v76
 v_rcp_f32 v36, v33
 v_add_f32 v34, v34, v77
 v_rcp_f32 v37, v34
 v_accvgpr_read_b32 v68, a128
 v_accvgpr_read_b32 v69, a129
 v_accvgpr_read_b32 v70, a130
 v_accvgpr_read_b32 v71, a131
 v_accvgpr_read_b32 v72, a132
 v_accvgpr_read_b32 v73, a133
 v_accvgpr_read_b32 v74, a134
 v_accvgpr_read_b32 v75, a135
 v_pk_mul_f32 v[68:69], v[68:69], v[36:37] op_sel:[0,1] op_sel_hi:[1,1]
 v_pk_mul_f32 v[70:71], v[70:71], v[36:37] op_sel:[0,1] op_sel_hi:[1,1]
 v_pk_mul_f32 v[72:73], v[72:73], v[36:37] op_sel:[0,1] op_sel_hi:[1,1]
 v_pk_mul_f32 v[74:75], v[74:75], v[36:37] op_sel:[0,1] op_sel_hi:[1,1]
 v_cvt_pk_bf16_f32 v224, v68, v69
 v_cvt_pk_bf16_f32 v225, v70, v71
 v_cvt_pk_bf16_f32 v226, v72, v73
 v_cvt_pk_bf16_f32 v227, v74, v75
 ds_write_b128 v19, v[224:227] offset:0
 v_accvgpr_read_b32 v68, a136
 v_accvgpr_read_b32 v69, a137
 v_accvgpr_read_b32 v70, a138
 v_accvgpr_read_b32 v71, a139
 v_accvgpr_read_b32 v72, a140
 v_accvgpr_read_b32 v73, a141
 v_accvgpr_read_b32 v74, a142
 v_accvgpr_read_b32 v75, a143
 v_pk_mul_f32 v[68:69], v[68:69], v[36:37] op_sel:[0,1] op_sel_hi:[1,1]
 v_pk_mul_f32 v[70:71], v[70:71], v[36:37] op_sel:[0,1] op_sel_hi:[1,1]
 v_pk_mul_f32 v[72:73], v[72:73], v[36:37] op_sel:[0,1] op_sel_hi:[1,1]
 v_pk_mul_f32 v[74:75], v[74:75], v[36:37] op_sel:[0,1] op_sel_hi:[1,1]
 v_cvt_pk_bf16_f32 v232, v68, v69
 v_cvt_pk_bf16_f32 v233, v70, v71
 v_cvt_pk_bf16_f32 v234, v72, v73
 v_cvt_pk_bf16_f32 v235, v74, v75
 ds_write_b128 v19, v[232:235] offset:1024
 v_accvgpr_read_b32 v68, a144
 v_accvgpr_read_b32 v69, a145
 v_accvgpr_read_b32 v70, a146
 v_accvgpr_read_b32 v71, a147
 v_accvgpr_read_b32 v72, a148
 v_accvgpr_read_b32 v73, a149
 v_accvgpr_read_b32 v74, a150
 v_accvgpr_read_b32 v75, a151
 v_pk_mul_f32 v[68:69], v[68:69], v[36:37] op_sel:[0,1] op_sel_hi:[1,1]
 v_pk_mul_f32 v[70:71], v[70:71], v[36:37] op_sel:[0,1] op_sel_hi:[1,1]
 v_pk_mul_f32 v[72:73], v[72:73], v[36:37] op_sel:[0,1] op_sel_hi:[1,1]
 v_pk_mul_f32 v[74:75], v[74:75], v[36:37] op_sel:[0,1] op_sel_hi:[1,1]
 v_cvt_pk_bf16_f32 v240, v68, v69
 v_cvt_pk_bf16_f32 v241, v70, v71
 v_cvt_pk_bf16_f32 v242, v72, v73
 v_cvt_pk_bf16_f32 v243, v74, v75
 ds_write_b128 v19, v[240:243] offset:2048
 v_accvgpr_read_b32 v68, a152
 v_accvgpr_read_b32 v69, a153
 v_accvgpr_read_b32 v70, a154
 v_accvgpr_read_b32 v71, a155
 v_accvgpr_read_b32 v72, a156
 v_accvgpr_read_b32 v73, a157
 v_accvgpr_read_b32 v74, a158
 v_accvgpr_read_b32 v75, a159
 v_pk_mul_f32 v[68:69], v[68:69], v[36:37] op_sel:[0,1] op_sel_hi:[1,1]
 v_pk_mul_f32 v[70:71], v[70:71], v[36:37] op_sel:[0,1] op_sel_hi:[1,1]
 v_pk_mul_f32 v[72:73], v[72:73], v[36:37] op_sel:[0,1] op_sel_hi:[1,1]
 v_pk_mul_f32 v[74:75], v[74:75], v[36:37] op_sel:[0,1] op_sel_hi:[1,1]
 v_cvt_pk_bf16_f32 v248, v68, v69
 v_cvt_pk_bf16_f32 v249, v70, v71
 v_cvt_pk_bf16_f32 v250, v72, v73
 v_cvt_pk_bf16_f32 v251, v74, v75
 ds_write_b128 v19, v[248:251] offset:3072
 v_accvgpr_read_b32 v68, a0
 v_accvgpr_read_b32 v69, a1
 v_accvgpr_read_b32 v70, a2
 v_accvgpr_read_b32 v71, a3
 v_accvgpr_read_b32 v72, a4
 v_accvgpr_read_b32 v73, a5
 v_accvgpr_read_b32 v74, a6
 v_accvgpr_read_b32 v75, a7
 v_pk_mul_f32 v[68:69], v[68:69], v[34:35] op_sel:[0,1] op_sel_hi:[1,1]
 v_pk_mul_f32 v[70:71], v[70:71], v[34:35] op_sel:[0,1] op_sel_hi:[1,1]
 v_pk_mul_f32 v[72:73], v[72:73], v[34:35] op_sel:[0,1] op_sel_hi:[1,1]
 v_pk_mul_f32 v[74:75], v[74:75], v[34:35] op_sel:[0,1] op_sel_hi:[1,1]
 v_cvt_pk_bf16_f32 v96, v68, v69
 v_cvt_pk_bf16_f32 v97, v70, v71
 v_cvt_pk_bf16_f32 v98, v72, v73
 v_cvt_pk_bf16_f32 v99, v74, v75
 v_accvgpr_read_b32 v68, a8
 v_accvgpr_read_b32 v69, a9
 v_accvgpr_read_b32 v70, a10
 v_accvgpr_read_b32 v71, a11
 v_accvgpr_read_b32 v72, a12
 v_accvgpr_read_b32 v73, a13
 v_accvgpr_read_b32 v74, a14
 v_accvgpr_read_b32 v75, a15
 v_pk_mul_f32 v[68:69], v[68:69], v[36:37] op_sel:[0,0] op_sel_hi:[1,0]
 v_pk_mul_f32 v[70:71], v[70:71], v[36:37] op_sel:[0,0] op_sel_hi:[1,0]
 v_pk_mul_f32 v[72:73], v[72:73], v[36:37] op_sel:[0,0] op_sel_hi:[1,0]
 v_pk_mul_f32 v[74:75], v[74:75], v[36:37] op_sel:[0,0] op_sel_hi:[1,0]
 v_cvt_pk_bf16_f32 v104, v68, v69
 v_cvt_pk_bf16_f32 v105, v70, v71
 v_cvt_pk_bf16_f32 v106, v72, v73
 v_cvt_pk_bf16_f32 v107, v74, v75
 v_accvgpr_read_b32 v68, a16
 v_accvgpr_read_b32 v69, a17
 v_accvgpr_read_b32 v70, a18
 v_accvgpr_read_b32 v71, a19
 v_accvgpr_read_b32 v72, a20
 v_accvgpr_read_b32 v73, a21
 v_accvgpr_read_b32 v74, a22
 v_accvgpr_read_b32 v75, a23
 v_pk_mul_f32 v[68:69], v[68:69], v[34:35] op_sel:[0,1] op_sel_hi:[1,1]
 v_pk_mul_f32 v[70:71], v[70:71], v[34:35] op_sel:[0,1] op_sel_hi:[1,1]
 v_pk_mul_f32 v[72:73], v[72:73], v[34:35] op_sel:[0,1] op_sel_hi:[1,1]
 v_pk_mul_f32 v[74:75], v[74:75], v[34:35] op_sel:[0,1] op_sel_hi:[1,1]
 v_cvt_pk_bf16_f32 v112, v68, v69
 v_cvt_pk_bf16_f32 v113, v70, v71
 v_cvt_pk_bf16_f32 v114, v72, v73
 v_cvt_pk_bf16_f32 v115, v74, v75
 v_accvgpr_read_b32 v68, a24
 v_accvgpr_read_b32 v69, a25
 v_accvgpr_read_b32 v70, a26
 v_accvgpr_read_b32 v71, a27
 v_accvgpr_read_b32 v72, a28
 v_accvgpr_read_b32 v73, a29
 v_accvgpr_read_b32 v74, a30
 v_accvgpr_read_b32 v75, a31
 v_pk_mul_f32 v[68:69], v[68:69], v[36:37] op_sel:[0,0] op_sel_hi:[1,0]
 v_pk_mul_f32 v[70:71], v[70:71], v[36:37] op_sel:[0,0] op_sel_hi:[1,0]
 v_pk_mul_f32 v[72:73], v[72:73], v[36:37] op_sel:[0,0] op_sel_hi:[1,0]
 v_pk_mul_f32 v[74:75], v[74:75], v[36:37] op_sel:[0,0] op_sel_hi:[1,0]
 v_cvt_pk_bf16_f32 v120, v68, v69
 v_cvt_pk_bf16_f32 v121, v70, v71
 v_cvt_pk_bf16_f32 v122, v72, v73
 v_cvt_pk_bf16_f32 v123, v74, v75
 v_accvgpr_read_b32 v68, a32
 v_accvgpr_read_b32 v69, a33
 v_accvgpr_read_b32 v70, a34
 v_accvgpr_read_b32 v71, a35
 v_accvgpr_read_b32 v72, a36
 v_accvgpr_read_b32 v73, a37
 v_accvgpr_read_b32 v74, a38
 v_accvgpr_read_b32 v75, a39
 v_pk_mul_f32 v[68:69], v[68:69], v[34:35] op_sel:[0,1] op_sel_hi:[1,1]
 v_pk_mul_f32 v[70:71], v[70:71], v[34:35] op_sel:[0,1] op_sel_hi:[1,1]
 v_pk_mul_f32 v[72:73], v[72:73], v[34:35] op_sel:[0,1] op_sel_hi:[1,1]
 v_pk_mul_f32 v[74:75], v[74:75], v[34:35] op_sel:[0,1] op_sel_hi:[1,1]
 v_cvt_pk_bf16_f32 v128, v68, v69
 v_cvt_pk_bf16_f32 v129, v70, v71
 v_cvt_pk_bf16_f32 v130, v72, v73
 v_cvt_pk_bf16_f32 v131, v74, v75
 v_accvgpr_read_b32 v68, a40
 v_accvgpr_read_b32 v69, a41
 v_accvgpr_read_b32 v70, a42
 v_accvgpr_read_b32 v71, a43
 v_accvgpr_read_b32 v72, a44
 v_accvgpr_read_b32 v73, a45
 v_accvgpr_read_b32 v74, a46
 v_accvgpr_read_b32 v75, a47
 v_pk_mul_f32 v[68:69], v[68:69], v[36:37] op_sel:[0,0] op_sel_hi:[1,0]
 v_pk_mul_f32 v[70:71], v[70:71], v[36:37] op_sel:[0,0] op_sel_hi:[1,0]
 v_pk_mul_f32 v[72:73], v[72:73], v[36:37] op_sel:[0,0] op_sel_hi:[1,0]
 v_pk_mul_f32 v[74:75], v[74:75], v[36:37] op_sel:[0,0] op_sel_hi:[1,0]
 v_cvt_pk_bf16_f32 v136, v68, v69
 v_cvt_pk_bf16_f32 v137, v70, v71
 v_cvt_pk_bf16_f32 v138, v72, v73
 v_cvt_pk_bf16_f32 v139, v74, v75
 v_accvgpr_read_b32 v68, a48
 v_accvgpr_read_b32 v69, a49
 v_accvgpr_read_b32 v70, a50
 v_accvgpr_read_b32 v71, a51
 v_accvgpr_read_b32 v72, a52
 v_accvgpr_read_b32 v73, a53
 v_accvgpr_read_b32 v74, a54
 v_accvgpr_read_b32 v75, a55
 v_pk_mul_f32 v[68:69], v[68:69], v[34:35] op_sel:[0,1] op_sel_hi:[1,1]
 v_pk_mul_f32 v[70:71], v[70:71], v[34:35] op_sel:[0,1] op_sel_hi:[1,1]
 v_pk_mul_f32 v[72:73], v[72:73], v[34:35] op_sel:[0,1] op_sel_hi:[1,1]
 v_pk_mul_f32 v[74:75], v[74:75], v[34:35] op_sel:[0,1] op_sel_hi:[1,1]
 v_cvt_pk_bf16_f32 v144, v68, v69
 v_cvt_pk_bf16_f32 v145, v70, v71
 v_cvt_pk_bf16_f32 v146, v72, v73
 v_cvt_pk_bf16_f32 v147, v74, v75
 v_accvgpr_read_b32 v68, a56
 v_accvgpr_read_b32 v69, a57
 v_accvgpr_read_b32 v70, a58
 v_accvgpr_read_b32 v71, a59
 v_accvgpr_read_b32 v72, a60
 v_accvgpr_read_b32 v73, a61
 v_accvgpr_read_b32 v74, a62
 v_accvgpr_read_b32 v75, a63
 v_pk_mul_f32 v[68:69], v[68:69], v[36:37] op_sel:[0,0] op_sel_hi:[1,0]
 v_pk_mul_f32 v[70:71], v[70:71], v[36:37] op_sel:[0,0] op_sel_hi:[1,0]
 v_pk_mul_f32 v[72:73], v[72:73], v[36:37] op_sel:[0,0] op_sel_hi:[1,0]
 v_pk_mul_f32 v[74:75], v[74:75], v[36:37] op_sel:[0,0] op_sel_hi:[1,0]
 v_cvt_pk_bf16_f32 v152, v68, v69
 v_cvt_pk_bf16_f32 v153, v70, v71
 v_cvt_pk_bf16_f32 v154, v72, v73
 v_cvt_pk_bf16_f32 v155, v74, v75
 v_accvgpr_read_b32 v68, a64
 v_accvgpr_read_b32 v69, a65
 v_accvgpr_read_b32 v70, a66
 v_accvgpr_read_b32 v71, a67
 v_accvgpr_read_b32 v72, a68
 v_accvgpr_read_b32 v73, a69
 v_accvgpr_read_b32 v74, a70
 v_accvgpr_read_b32 v75, a71
 v_pk_mul_f32 v[68:69], v[68:69], v[34:35] op_sel:[0,1] op_sel_hi:[1,1]
 v_pk_mul_f32 v[70:71], v[70:71], v[34:35] op_sel:[0,1] op_sel_hi:[1,1]
 v_pk_mul_f32 v[72:73], v[72:73], v[34:35] op_sel:[0,1] op_sel_hi:[1,1]
 v_pk_mul_f32 v[74:75], v[74:75], v[34:35] op_sel:[0,1] op_sel_hi:[1,1]
 v_cvt_pk_bf16_f32 v160, v68, v69
 v_cvt_pk_bf16_f32 v161, v70, v71
 v_cvt_pk_bf16_f32 v162, v72, v73
 v_cvt_pk_bf16_f32 v163, v74, v75
 v_accvgpr_read_b32 v68, a72
 v_accvgpr_read_b32 v69, a73
 v_accvgpr_read_b32 v70, a74
 v_accvgpr_read_b32 v71, a75
 v_accvgpr_read_b32 v72, a76
 v_accvgpr_read_b32 v73, a77
 v_accvgpr_read_b32 v74, a78
 v_accvgpr_read_b32 v75, a79
 v_pk_mul_f32 v[68:69], v[68:69], v[36:37] op_sel:[0,0] op_sel_hi:[1,0]
 v_pk_mul_f32 v[70:71], v[70:71], v[36:37] op_sel:[0,0] op_sel_hi:[1,0]
 v_pk_mul_f32 v[72:73], v[72:73], v[36:37] op_sel:[0,0] op_sel_hi:[1,0]
 v_pk_mul_f32 v[74:75], v[74:75], v[36:37] op_sel:[0,0] op_sel_hi:[1,0]
 v_cvt_pk_bf16_f32 v168, v68, v69
 v_cvt_pk_bf16_f32 v169, v70, v71
 v_cvt_pk_bf16_f32 v170, v72, v73
 v_cvt_pk_bf16_f32 v171, v74, v75
 v_mfma_f32_16x16x32_bf16 v[100:103], a[160:163], a[192:195], 0
 ds_read_b64_tr_b16 a[184:185], v8 offset:32
 ds_read_b64_tr_b16 a[186:187], v8 offset:160
 v_mfma_f32_16x16x32_bf16 v[100:103], a[164:167], a[200:203], v[100:103]
 buffer_load_dword v29, v27, s[84:87], 0 offen offset:0 sc1
 buffer_load_dwordx4 v17, s[28:31], s56 offen offset:896 lds
 v_mfma_f32_16x16x32_bf16 v[108:111], a[164:167], a[204:207], 0
 v_accvgpr_read_b32 v68, a80
 v_accvgpr_read_b32 v69, a81
 v_mfma_f32_16x16x32_bf16 v[108:111], a[160:163], a[196:199], v[108:111]
 ds_read_b64_tr_b16 a[188:189], v8 offset:288
 ds_read_b64_tr_b16 a[190:191], v8 offset:416
 v_mfma_f32_16x16x32_bf16 v[164:167], a[160:163], v[80:83], 0
 v_accvgpr_read_b32 v70, a82
 v_accvgpr_read_b32 v71, a83
 v_mfma_f32_16x16x32_bf16 v[164:167], a[164:167], v[84:87], v[164:167]
 s_waitcnt lgkmcnt(12)
 v_accvgpr_read_b32 v72, a84
 v_accvgpr_read_b32 v73, a85
 v_mfma_f32_16x16x32_bf16 v[116:119], a[168:171], a[192:195], 0
 ds_read_b64_tr_b16 a[160:161], v6 offset:16896
 ds_read_b64_tr_b16 a[162:163], v6 offset:17024
 v_mfma_f32_16x16x32_bf16 v[116:119], a[172:175], a[200:203], v[116:119]
 s_add_u32 m0, s40, 0x16740
 v_accvgpr_read_b32 v74, a86
 v_accvgpr_read_b32 v75, a87
 v_mfma_f32_16x16x32_bf16 v[124:127], a[172:175], a[204:207], 0
 buffer_load_dwordx4 v17, s[28:31], s56 offen offset:1792 lds
 v_mul_f32 v68, v35, v68
 v_mfma_f32_16x16x32_bf16 v[124:127], a[168:171], a[196:199], v[124:127]
 ds_read_b64_tr_b16 a[164:165], v6 offset:17152
 ds_read_b64_tr_b16 a[166:167], v6 offset:17280
 v_mfma_f32_16x16x32_bf16 v[172:175], a[168:171], v[80:83], 0
 v_mul_f32 v69, v35, v69
 v_mul_f32 v70, v35, v70
 v_mfma_f32_16x16x32_bf16 v[172:175], a[172:175], v[84:87], v[172:175]
 s_waitcnt lgkmcnt(12)
 v_mul_f32 v71, v35, v71
 v_mul_f32 v72, v35, v72
 v_mfma_f32_16x16x32_bf16 v[100:103], a[176:179], a[208:211], v[100:103]
 ds_read_b64_tr_b16 a[168:169], v6 offset:16928
 ds_read_b64_tr_b16 a[170:171], v6 offset:17056
 v_mfma_f32_16x16x32_bf16 v[100:103], a[180:183], a[216:219], v[100:103]
 v_mul_f32 v73, v35, v73
 v_mul_f32 v74, v35, v74
 v_mfma_f32_16x16x32_bf16 v[108:111], a[180:183], a[220:223], v[108:111]
 v_mul_f32 v75, v35, v75
 v_cvt_pk_bf16_f32 v176, v68, v69
 v_mfma_f32_16x16x32_bf16 v[108:111], a[176:179], a[212:215], v[108:111]
 ds_read_b64_tr_b16 a[172:173], v6 offset:17184
 ds_read_b64_tr_b16 a[174:175], v6 offset:17312
 v_mfma_f32_16x16x32_bf16 v[164:167], a[176:179], v[228:231], v[164:167]
 v_cvt_pk_bf16_f32 v177, v70, v71
 v_cvt_pk_bf16_f32 v178, v72, v73
 v_mfma_f32_16x16x32_bf16 v[164:167], a[180:183], v[236:239], v[164:167]
 s_waitcnt lgkmcnt(8)
 v_cvt_pk_bf16_f32 v179, v74, v75
 v_accvgpr_read_b32 v68, a88
 v_mfma_f32_16x16x32_bf16 v[116:119], a[184:187], a[208:211], v[116:119]
 s_add_u32 m0, s40, 0x167e0
 ds_read_b64_tr_b16 a[176:177], v8 offset:16896
 ds_read_b64_tr_b16 a[178:179], v8 offset:17024
 v_mfma_f32_16x16x32_bf16 v[116:119], a[188:191], a[216:219], v[116:119]
 buffer_load_dwordx4 v17, s[28:31], s56 offen offset:2688 lds
 v_accvgpr_read_b32 v69, a89
 v_mfma_f32_16x16x32_bf16 v[124:127], a[188:191], a[220:223], v[124:127]
 v_accvgpr_read_b32 v70, a90
 v_accvgpr_read_b32 v71, a91
 v_mfma_f32_16x16x32_bf16 v[124:127], a[184:187], a[212:215], v[124:127]
 ds_read_b64_tr_b16 a[180:181], v8 offset:17152
 ds_read_b64_tr_b16 a[182:183], v8 offset:17280
 v_mfma_f32_16x16x32_bf16 v[172:175], a[184:187], v[228:231], v[172:175]
 v_accvgpr_read_b32 v72, a92
 v_accvgpr_read_b32 v73, a93
 v_mfma_f32_16x16x32_bf16 v[172:175], a[188:191], v[236:239], v[172:175]
 s_waitcnt lgkmcnt(8)
 v_accvgpr_read_b32 v74, a94
 v_accvgpr_read_b32 v75, a95
 v_mfma_f32_16x16x32_bf16 v[100:103], a[160:163], a[224:227], v[100:103]
 ds_read_b64_tr_b16 a[184:185], v8 offset:16928
 ds_read_b64_tr_b16 a[186:187], v8 offset:17056
 v_mfma_f32_16x16x32_bf16 v[100:103], a[164:167], a[232:235], v[100:103]
 v_mul_f32 v68, v36, v68
 v_mul_f32 v69, v36, v69
 v_mfma_f32_16x16x32_bf16 v[108:111], a[164:167], a[236:239], v[108:111]
 s_add_u32 s56, s100, 0x1c000
 v_mul_f32 v70, v36, v70
 v_mul_f32 v71, v36, v71
 v_mfma_f32_16x16x32_bf16 v[108:111], a[160:163], a[228:231], v[108:111]
 s_add_u32 m0, s40, 0x1a800
 ds_read_b64_tr_b16 a[188:189], v8 offset:17184
 ds_read_b64_tr_b16 a[190:191], v8 offset:17312
 v_mfma_f32_16x16x32_bf16 v[164:167], a[160:163], v[88:91], v[164:167]
 buffer_load_dwordx4 v17, s[28:31], s56 offen offset:0 lds
 v_mul_f32 v72, v36, v72
 v_mfma_f32_16x16x32_bf16 v[164:167], a[164:167], v[92:95], v[164:167]
 s_waitcnt lgkmcnt(8)
 v_mul_f32 v73, v36, v73
 v_mul_f32 v74, v36, v74
 v_mfma_f32_16x16x32_bf16 v[116:119], a[168:171], a[224:227], v[116:119]
 ds_read_b64_tr_b16 a[160:161], v7 offset:0
 ds_read_b64_tr_b16 a[162:163], v7 offset:128
 v_mfma_f32_16x16x32_bf16 v[116:119], a[172:175], a[232:235], v[116:119]
 v_mul_f32 v75, v36, v75
 v_cvt_pk_bf16_f32 v184, v68, v69
 v_mfma_f32_16x16x32_bf16 v[124:127], a[172:175], a[236:239], v[124:127]
 v_cvt_pk_bf16_f32 v185, v70, v71
 v_cvt_pk_bf16_f32 v186, v72, v73
 v_mfma_f32_16x16x32_bf16 v[124:127], a[168:171], a[228:231], v[124:127]
 ds_read_b64_tr_b16 a[164:165], v7 offset:256
 ds_read_b64_tr_b16 a[166:167], v7 offset:384
 v_mfma_f32_16x16x32_bf16 v[172:175], a[168:171], v[88:91], v[172:175]
 v_cvt_pk_bf16_f32 v187, v74, v75
 v_accvgpr_read_b32 v68, a96
 v_mfma_f32_16x16x32_bf16 v[172:175], a[172:175], v[92:95], v[172:175]
 s_waitcnt lgkmcnt(8)
 v_accvgpr_read_b32 v69, a97
 v_accvgpr_read_b32 v70, a98
 v_mfma_f32_16x16x32_bf16 v[100:103], a[176:179], a[240:243], v[100:103]
 s_add_u32 m0, s40, 0x1a8a0
 ds_read_b64_tr_b16 a[168:169], v7 offset:32
 ds_read_b64_tr_b16 a[170:171], v7 offset:160
 v_mfma_f32_16x16x32_bf16 v[100:103], a[180:183], a[248:251], v[100:103]
 buffer_load_dwordx4 v17, s[28:31], s56 offen offset:896 lds
 v_accvgpr_read_b32 v71, a99
 v_mfma_f32_16x16x32_bf16 v[108:111], a[180:183], a[252:255], v[108:111]
 v_accvgpr_read_b32 v72, a100
 v_accvgpr_read_b32 v73, a101
 v_mfma_f32_16x16x32_bf16 v[108:111], a[176:179], a[244:247], v[108:111]
 ds_read_b64_tr_b16 a[172:173], v7 offset:288
 ds_read_b64_tr_b16 a[174:175], v7 offset:416
 v_mfma_f32_16x16x32_bf16 v[164:167], a[176:179], v[244:247], v[164:167]
 v_accvgpr_read_b32 v74, a102
 v_accvgpr_read_b32 v75, a103
 v_mfma_f32_16x16x32_bf16 v[164:167], a[180:183], v[252:255], v[164:167]
 s_waitcnt lgkmcnt(8)
 v_mul_f32 v68, v35, v68
 v_mul_f32 v69, v35, v69
 v_mfma_f32_16x16x32_bf16 v[116:119], a[184:187], a[240:243], v[116:119]
L_pad20:
 s_cbranch_execz L_pad24
 ds_read_b64_tr_b16 a[176:177], v9 offset:0
 ds_read_b64_tr_b16 a[178:179], v9 offset:128
 v_mfma_f32_16x16x32_bf16 v[116:119], a[188:191], a[248:251], v[116:119]
 v_mul_f32 v70, v35, v70
 v_mul_f32 v71, v35, v71
 v_mfma_f32_16x16x32_bf16 v[124:127], a[188:191], a[252:255], v[124:127]
 v_mul_f32 v72, v35, v72
 v_mul_f32 v73, v35, v73
 v_mfma_f32_16x16x32_bf16 v[124:127], a[184:187], a[244:247], v[124:127]
 s_add_u32 m0, s40, 0x1a940
 ds_read_b64_tr_b16 a[180:181], v9 offset:256
 ds_read_b64_tr_b16 a[182:183], v9 offset:384
 v_mfma_f32_16x16x32_bf16 v[172:175], a[184:187], v[244:247], v[172:175]
 buffer_load_dwordx4 v17, s[28:31], s56 offen offset:1792 lds
 v_mul_f32 v74, v35, v74
 v_mfma_f32_16x16x32_bf16 v[172:175], a[188:191], v[252:255], v[172:175]
 s_waitcnt lgkmcnt(8)
 v_mul_f32 v75, v35, v75
 v_cvt_pk_bf16_f32 v192, v68, v69
 v_mfma_f32_16x16x32_bf16 v[132:135], a[160:163], a[192:195], 0
 ds_read_b64_tr_b16 a[184:185], v9 offset:32
 ds_read_b64_tr_b16 a[186:187], v9 offset:160
 v_mfma_f32_16x16x32_bf16 v[132:135], a[164:167], a[200:203], v[132:135]
 v_cvt_pk_bf16_f32 v193, v70, v71
 v_cvt_pk_bf16_f32 v194, v72, v73
 v_mfma_f32_16x16x32_bf16 v[140:143], a[164:167], a[204:207], 0
 ds_read_b64_tr_b16 a[188:189], v9 offset:288
 ds_read_b64_tr_b16 a[190:191], v9 offset:416
 v_mfma_f32_16x16x32_bf16 v[140:143], a[160:163], a[196:199], v[140:143]
 s_waitcnt lgkmcnt(8)
 v_cvt_pk_bf16_f32 v195, v74, v75
 v_accvgpr_read_b32 v68, a104
 v_mfma_f32_16x16x32_bf16 v[148:151], a[168:171], a[192:195], 0
 ds_read_b64_tr_b16 a[160:161], v7 offset:16896
 ds_read_b64_tr_b16 a[162:163], v7 offset:17024
 v_mfma_f32_16x16x32_bf16 v[148:151], a[172:175], a[200:203], v[148:151]
 v_accvgpr_read_b32 v69, a105
 v_accvgpr_read_b32 v70, a106
 v_mfma_f32_16x16x32_bf16 v[156:159], a[172:175], a[204:207], 0
 s_add_u32 m0, s40, 0x1a9e0
 ds_read_b64_tr_b16 a[164:165], v7 offset:17152
 ds_read_b64_tr_b16 a[166:167], v7 offset:17280
 v_mfma_f32_16x16x32_bf16 v[156:159], a[168:171], a[196:199], v[156:159]
 s_waitcnt lgkmcnt(8)
 buffer_load_dwordx4 v17, s[28:31], s56 offen offset:2688 lds
 v_accvgpr_read_b32 v71, a107
 v_mfma_f32_16x16x32_bf16 v[132:135], a[176:179], a[208:211], v[132:135]
 ds_read_b64_tr_b16 a[168:169], v7 offset:16928
 ds_read_b64_tr_b16 a[170:171], v7 offset:17056
 v_mfma_f32_16x16x32_bf16 v[132:135], a[180:183], a[216:219], v[132:135]
 v_accvgpr_read_b32 v72, a108
 v_accvgpr_read_b32 v73, a109
 v_mfma_f32_16x16x32_bf16 v[140:143], a[180:183], a[220:223], v[140:143]
 ds_read_b64_tr_b16 a[172:173], v7 offset:17184
 ds_read_b64_tr_b16 a[174:175], v7 offset:17312
 v_mfma_f32_16x16x32_bf16 v[140:143], a[176:179], a[212:215], v[140:143]
 s_waitcnt lgkmcnt(8)
 v_accvgpr_read_b32 v74, a110
 v_accvgpr_read_b32 v75, a111
 v_mfma_f32_16x16x32_bf16 v[148:151], a[184:187], a[208:211], v[148:151]
 ds_read_b64_tr_b16 a[176:177], v9 offset:16896
 ds_read_b64_tr_b16 a[178:179], v9 offset:17024
 v_mfma_f32_16x16x32_bf16 v[148:151], a[188:191], a[216:219], v[148:151]
 v_mul_f32 v68, v36, v68
 v_mul_f32 v69, v36, v69
 v_mfma_f32_16x16x32_bf16 v[156:159], a[188:191], a[220:223], v[156:159]
 ds_read_b64_tr_b16 a[180:181], v9 offset:17152
 ds_read_b64_tr_b16 a[182:183], v9 offset:17280
 v_mfma_f32_16x16x32_bf16 v[156:159], a[184:187], a[212:215], v[156:159]
 s_waitcnt lgkmcnt(8)
 v_mul_f32 v70, v36, v70
 v_mul_f32 v71, v36, v71
 v_mfma_f32_16x16x32_bf16 v[132:135], a[160:163], a[224:227], v[132:135]
 ds_read_b64_tr_b16 a[184:185], v9 offset:16928
 ds_read_b64_tr_b16 a[186:187], v9 offset:17056
 v_mfma_f32_16x16x32_bf16 v[132:135], a[164:167], a[232:235], v[132:135]
 v_mul_f32 v72, v36, v72
 v_mul_f32 v73, v36, v73
 v_mfma_f32_16x16x32_bf16 v[140:143], a[164:167], a[236:239], v[140:143]
 ds_read_b64_tr_b16 a[188:189], v9 offset:17184
 ds_read_b64_tr_b16 a[190:191], v9 offset:17312
 v_mfma_f32_16x16x32_bf16 v[140:143], a[160:163], a[228:231], v[140:143]
 s_waitcnt lgkmcnt(8)
 v_mul_f32 v74, v36, v74
 v_mul_f32 v75, v36, v75
 v_mfma_f32_16x16x32_bf16 v[148:151], a[168:171], a[224:227], v[148:151]
 s_waitcnt vmcnt(9)
 s_barrier
 ds_read_b64_tr_b16 a[160:161], v6 offset:33792
 ds_read_b64_tr_b16 a[162:163], v6 offset:33920
 v_mfma_f32_16x16x32_bf16 v[148:151], a[172:175], a[232:235], v[148:151]
 s_add_u32 s56, s100, 0x1c0000
 ds_read_b128 a[128:131], v20 offset:0
 v_cvt_pk_bf16_f32 v200, v68, v69
 v_mfma_f32_16x16x32_bf16 v[156:159], a[172:175], a[236:239], v[156:159]
 s_add_u32 m0, s40, 0x1ea00
 ds_read_b64_tr_b16 a[164:165], v6 offset:34048
 ds_read_b64_tr_b16 a[166:167], v6 offset:34176
 v_mfma_f32_16x16x32_bf16 v[156:159], a[168:171], a[228:231], v[156:159]
 s_waitcnt lgkmcnt(9)
 ds_read_b128 a[136:139], v20 offset:1024
 buffer_load_dwordx4 v17, s[28:31], s56 offen offset:0 lds
 v_mfma_f32_16x16x32_bf16 v[132:135], a[176:179], a[240:243], v[132:135]
 ds_read_b64_tr_b16 a[168:169], v6 offset:33824
 ds_read_b64_tr_b16 a[170:171], v6 offset:33952
 v_mfma_f32_16x16x32_bf16 v[132:135], a[180:183], a[248:251], v[132:135]
 ds_read_b128 a[144:147], v20 offset:2048
 v_cvt_pk_bf16_f32 v201, v70, v71
 v_mfma_f32_16x16x32_bf16 v[140:143], a[180:183], a[252:255], v[140:143]
 ds_read_b64_tr_b16 a[172:173], v6 offset:34080
 ds_read_b64_tr_b16 a[174:175], v6 offset:34208
 v_mfma_f32_16x16x32_bf16 v[140:143], a[176:179], a[244:247], v[140:143]
 s_waitcnt lgkmcnt(11)
 ds_read_b128 a[152:155], v20 offset:3072
 v_cvt_pk_bf16_f32 v202, v72, v73
 v_mfma_f32_16x16x32_bf16 v[148:151], a[184:187], a[240:243], v[148:151]
 ds_read_b64_tr_b16 a[176:177], v8 offset:33792
 ds_read_b64_tr_b16 a[178:179], v8 offset:33920
 v_mfma_f32_16x16x32_bf16 v[148:151], a[188:191], a[248:251], v[148:151]
 v_cvt_pk_bf16_f32 v203, v74, v75
 v_accvgpr_read_b32 v68, a112
 v_mfma_f32_16x16x32_bf16 v[156:159], a[188:191], a[252:255], v[156:159]
 s_add_u32 m0, s40, 0x1eaa0
 ds_read_b64_tr_b16 a[180:181], v8 offset:34048
 ds_read_b64_tr_b16 a[182:183], v8 offset:34176
 v_mfma_f32_16x16x32_bf16 v[156:159], a[184:187], a[244:247], v[156:159]
 s_waitcnt lgkmcnt(11)
 buffer_load_dwordx4 v17, s[28:31], s56 offen offset:896 lds
 v_accvgpr_read_b32 v69, a113
 v_mfma_f32_16x16x32_bf16 v[100:103], a[160:163], v[96:99], v[100:103]
 ds_read_b64_tr_b16 a[184:185], v8 offset:33824
 ds_read_b64_tr_b16 a[186:187], v8 offset:33952
 v_mfma_f32_16x16x32_bf16 v[100:103], a[164:167], v[112:115], v[100:103]
 v_accvgpr_read_b32 v70, a114
 v_accvgpr_read_b32 v71, a115
 v_mfma_f32_16x16x32_bf16 v[108:111], a[164:167], v[120:123], v[108:111]
 v_accvgpr_read_b32 v72, a116
 v_accvgpr_read_b32 v73, a117
 v_mfma_f32_16x16x32_bf16 v[108:111], a[160:163], v[104:107], v[108:111]
 ds_read_b64_tr_b16 a[188:189], v8 offset:34080
 ds_read_b64_tr_b16 a[190:191], v8 offset:34208
 v_mfma_f32_16x16x32_bf16 v[164:167], a[160:163], v[224:227], v[164:167]
 v_accvgpr_read_b32 v74, a118
 v_accvgpr_read_b32 v75, a119
 v_mfma_f32_16x16x32_bf16 v[164:167], a[164:167], v[232:235], v[164:167]
 s_waitcnt lgkmcnt(9)
 v_mul_f32 v68, v35, v68
 v_mul_f32 v69, v35, v69
 v_mfma_f32_16x16x32_bf16 v[116:119], a[168:171], v[96:99], v[116:119]
 ds_read_b64_tr_b16 a[160:161], v6 offset:50688
 ds_read_b64_tr_b16 a[162:163], v6 offset:50816
 v_mfma_f32_16x16x32_bf16 v[116:119], a[172:175], v[112:115], v[116:119]
 s_add_u32 m0, s40, 0x1eb40
 v_mul_f32 v70, v35, v70
 v_mul_f32 v71, v35, v71
 v_mfma_f32_16x16x32_bf16 v[124:127], a[172:175], v[120:123], v[124:127]
 buffer_load_dwordx4 v17, s[28:31], s56 offen offset:1792 lds
 v_mul_f32 v72, v35, v72
 v_mfma_f32_16x16x32_bf16 v[124:127], a[168:171], v[104:107], v[124:127]
 ds_read_b64_tr_b16 a[164:165], v6 offset:50944
 ds_read_b64_tr_b16 a[166:167], v6 offset:51072
 v_mfma_f32_16x16x32_bf16 v[172:175], a[168:171], v[224:227], v[172:175]
 v_mul_f32 v73, v35, v73
 v_mul_f32 v74, v35, v74
 v_mfma_f32_16x16x32_bf16 v[172:175], a[172:175], v[232:235], v[172:175]
 s_waitcnt lgkmcnt(8)
 v_mul_f32 v75, v35, v75
 v_cvt_pk_bf16_f32 v208, v68, v69
 v_mfma_f32_16x16x32_bf16 v[100:103], a[176:179], v[128:131], v[100:103]
 ds_read_b64_tr_b16 a[168:169], v6 offset:50720
 ds_read_b64_tr_b16 a[170:171], v6 offset:50848
 v_mfma_f32_16x16x32_bf16 v[100:103], a[180:183], v[144:147], v[100:103]
 v_cvt_pk_bf16_f32 v209, v70, v71
 v_cvt_pk_bf16_f32 v210, v72, v73
 v_mfma_f32_16x16x32_bf16 v[108:111], a[180:183], v[152:155], v[108:111]
 v_cvt_pk_bf16_f32 v211, v74, v75
 v_accvgpr_read_b32 v68, a120
 v_mfma_f32_16x16x32_bf16 v[108:111], a[176:179], v[136:139], v[108:111]
 ds_read_b64_tr_b16 a[172:173], v6 offset:50976
 ds_read_b64_tr_b16 a[174:175], v6 offset:51104
 v_mfma_f32_16x16x32_bf16 v[164:167], a[176:179], a[128:131], v[164:167]
 s_add_u32 m0, s40, 0x1ebe0
 v_accvgpr_read_b32 v69, a121
 v_accvgpr_read_b32 v70, a122
 v_mfma_f32_16x16x32_bf16 v[164:167], a[180:183], a[136:139], v[164:167]
 s_waitcnt lgkmcnt(8)
 buffer_load_dwordx4 v17, s[28:31], s56 offen offset:2688 lds
 v_accvgpr_read_b32 v71, a123
 v_mfma_f32_16x16x32_bf16 v[116:119], a[184:187], v[128:131], v[116:119]
 ds_read_b64_tr_b16 a[176:177], v8 offset:50688
 ds_read_b64_tr_b16 a[178:179], v8 offset:50816
 v_mfma_f32_16x16x32_bf16 v[116:119], a[188:191], v[144:147], v[116:119]
 v_accvgpr_read_b32 v72, a124
 v_accvgpr_read_b32 v73, a125
 v_mfma_f32_16x16x32_bf16 v[124:127], a[188:191], v[152:155], v[124:127]
 v_accvgpr_read_b32 v74, a126
 v_accvgpr_read_b32 v75, a127
 v_mfma_f32_16x16x32_bf16 v[124:127], a[184:187], v[136:139], v[124:127]
 ds_read_b64_tr_b16 a[180:181], v8 offset:50944
 ds_read_b64_tr_b16 a[182:183], v8 offset:51072
 v_mfma_f32_16x16x32_bf16 v[172:175], a[184:187], a[128:131], v[172:175]
 v_mul_f32 v68, v36, v68
 v_mul_f32 v69, v36, v69
 v_mfma_f32_16x16x32_bf16 v[172:175], a[188:191], a[136:139], v[172:175]
 s_waitcnt lgkmcnt(8)
 v_mul_f32 v70, v36, v70
 v_mul_f32 v71, v36, v71
 v_mfma_f32_16x16x32_bf16 v[100:103], a[160:163], v[160:163], v[100:103]
 ds_read_b64_tr_b16 a[184:185], v8 offset:50720
 ds_read_b64_tr_b16 a[186:187], v8 offset:50848
 v_mfma_f32_16x16x32_bf16 v[100:103], a[164:167], v[176:179], v[100:103]
 v_mul_f32 v72, v36, v72
 v_mul_f32 v73, v36, v73
 v_mfma_f32_16x16x32_bf16 v[108:111], a[164:167], v[184:187], v[108:111]
 v_mul_f32 v74, v36, v74
 v_mul_f32 v75, v36, v75
 v_mfma_f32_16x16x32_bf16 v[108:111], a[160:163], v[168:171], v[108:111]
 ds_read_b64_tr_b16 a[188:189], v8 offset:50976
 ds_read_b64_tr_b16 a[190:191], v8 offset:51104
 v_mfma_f32_16x16x32_bf16 v[164:167], a[160:163], v[240:243], v[164:167]
 v_cvt_pk_bf16_f32 v216, v68, v69
 v_cvt_pk_bf16_f32 v217, v70, v71
 v_mfma_f32_16x16x32_bf16 v[164:167], a[164:167], v[248:251], v[164:167]
 s_waitcnt lgkmcnt(8)
 v_cvt_pk_bf16_f32 v218, v72, v73
 v_cvt_pk_bf16_f32 v219, v74, v75
 v_mfma_f32_16x16x32_bf16 v[116:119], a[168:171], v[160:163], v[116:119]
 ds_read_b64_tr_b16 a[160:161], v7 offset:33792
 ds_read_b64_tr_b16 a[162:163], v7 offset:33920
 v_mfma_f32_16x16x32_bf16 v[116:119], a[172:175], v[176:179], v[116:119]
 s_add_u32 s56, s100, 0x1dc000
 v_add_u32 v2, 0x16600, v6
 v_add_u32 v3, 0x16600, v7
 v_mfma_f32_16x16x32_bf16 v[124:127], a[172:175], v[184:187], v[124:127]
 s_add_u32 m0, s40, 0x22c00
 v_add_u32 v4, 0x16600, v8
 v_add_u32 v5, 0x16600, v9
 v_mfma_f32_16x16x32_bf16 v[124:127], a[168:171], v[168:171], v[124:127]
 ds_read_b64_tr_b16 a[164:165], v7 offset:34048
 ds_read_b64_tr_b16 a[166:167], v7 offset:34176
 v_mfma_f32_16x16x32_bf16 v[172:175], a[168:171], v[240:243], v[172:175]
 buffer_load_dwordx4 v17, s[28:31], s56 offen offset:0 lds
 v_mfma_f32_16x16x32_bf16 v[172:175], a[172:175], v[248:251], v[172:175]
 s_waitcnt lgkmcnt(8)
 v_mfma_f32_16x16x32_bf16 v[100:103], a[176:179], v[192:195], v[100:103]
 ds_read_b64_tr_b16 a[168:169], v7 offset:33824
 ds_read_b64_tr_b16 a[170:171], v7 offset:33952
 v_mfma_f32_16x16x32_bf16 v[100:103], a[180:183], v[208:211], v[100:103]
 v_mfma_f32_16x16x32_bf16 v[108:111], a[180:183], v[216:219], v[108:111]
 v_mfma_f32_16x16x32_bf16 v[108:111], a[176:179], v[200:203], v[108:111]
 s_add_u32 m0, s40, 0x22ca0
 ds_read_b64_tr_b16 a[172:173], v7 offset:34080
 ds_read_b64_tr_b16 a[174:175], v7 offset:34208
 v_mfma_f32_16x16x32_bf16 v[164:167], a[176:179], a[144:147], v[164:167]
 buffer_load_dwordx4 v17, s[28:31], s56 offen offset:896 lds
 v_mfma_f32_16x16x32_bf16 v[164:167], a[180:183], a[152:155], v[164:167]
 s_waitcnt lgkmcnt(8)
 v_mfma_f32_16x16x32_bf16 v[116:119], a[184:187], v[192:195], v[116:119]
 ds_read_b64_tr_b16 a[176:177], v9 offset:33792
 ds_read_b64_tr_b16 a[178:179], v9 offset:33920
 v_mfma_f32_16x16x32_bf16 v[116:119], a[188:191], v[208:211], v[116:119]
 v_mfma_f32_16x16x32_bf16 v[124:127], a[188:191], v[216:219], v[124:127]
 v_mfma_f32_16x16x32_bf16 v[124:127], a[184:187], v[200:203], v[124:127]
 ds_read_b64_tr_b16 a[180:181], v9 offset:34048
 ds_read_b64_tr_b16 a[182:183], v9 offset:34176
 v_mfma_f32_16x16x32_bf16 v[172:175], a[184:187], a[144:147], v[172:175]
 v_mfma_f32_16x16x32_bf16 v[172:175], a[188:191], a[152:155], v[172:175]
 s_waitcnt lgkmcnt(8)
 v_mfma_f32_16x16x32_bf16 v[132:135], a[160:163], v[96:99], v[132:135]
 s_add_u32 m0, s40, 0x22d40
 ds_read_b64_tr_b16 a[184:185], v9 offset:33824
 ds_read_b64_tr_b16 a[186:187], v9 offset:33952
 v_mfma_f32_16x16x32_bf16 v[132:135], a[164:167], v[112:115], v[132:135]
 buffer_load_dwordx4 v17, s[28:31], s56 offen offset:1792 lds
 v_mfma_f32_16x16x32_bf16 v[140:143], a[164:167], v[120:123], v[140:143]
 ds_read_b64_tr_b16 a[188:189], v9 offset:34080
 ds_read_b64_tr_b16 a[190:191], v9 offset:34208
 v_mfma_f32_16x16x32_bf16 v[140:143], a[160:163], v[104:107], v[140:143]
 s_waitcnt lgkmcnt(8)
 v_cvt_pk_bf16_f32 v100, v100, v101
 v_cvt_pk_bf16_f32 v101, v102, v103
 v_mfma_f32_16x16x32_bf16 v[148:151], a[168:171], v[96:99], v[148:151]
 s_add_u32 s55, s8, 0
 ds_read_b64_tr_b16 a[160:161], v7 offset:50688
 ds_read_b64_tr_b16 a[162:163], v7 offset:50816
 v_mfma_f32_16x16x32_bf16 v[148:151], a[172:175], v[112:115], v[148:151]
 v_cvt_pk_bf16_f32 v102, v116, v117
 v_cvt_pk_bf16_f32 v103, v118, v119
 v_mfma_f32_16x16x32_bf16 v[156:159], a[172:175], v[120:123], v[156:159]
 ds_read_b64_tr_b16 a[164:165], v7 offset:50944
 ds_read_b64_tr_b16 a[166:167], v7 offset:51072
 v_mfma_f32_16x16x32_bf16 v[156:159], a[168:171], v[104:107], v[156:159]
 s_waitcnt lgkmcnt(8)
 buffer_store_dwordx4 v[100:103], v1, s[24:27], s55 offen offset:0 sc1
 v_mov_b32 v76, v100
 v_mfma_f32_16x16x32_bf16 v[132:135], a[176:179], v[128:131], v[132:135]
 s_add_u32 m0, s40, 0x22de0
 ds_read_b64_tr_b16 a[168:169], v7 offset:50720
 ds_read_b64_tr_b16 a[170:171], v7 offset:50848
 v_mfma_f32_16x16x32_bf16 v[132:135], a[180:183], v[144:147], v[132:135]
 buffer_load_dwordx4 v17, s[28:31], s56 offen offset:2688 lds
 v_mov_b32 v77, v101
 v_mfma_f32_16x16x32_bf16 v[140:143], a[180:183], v[152:155], v[140:143]
 s_add_u32 s100, s100, 0x80
 ds_read_b64_tr_b16 a[172:173], v7 offset:50976
 ds_read_b64_tr_b16 a[174:175], v7 offset:51104
 v_mfma_f32_16x16x32_bf16 v[140:143], a[176:179], v[136:139], v[140:143]
 s_waitcnt lgkmcnt(8)
 v_cvt_pk_bf16_f32 v108, v108, v109
 v_cvt_pk_bf16_f32 v109, v110, v111
 v_mfma_f32_16x16x32_bf16 v[148:151], a[184:187], v[128:131], v[148:151]
 s_sub_u32 s56, s100, 0x380
 ds_read_b64_tr_b16 a[176:177], v9 offset:50688
 ds_read_b64_tr_b16 a[178:179], v9 offset:50816
 v_mfma_f32_16x16x32_bf16 v[148:151], a[188:191], v[144:147], v[148:151]
 s_min_u32 s100, s100, s56
 v_cvt_pk_bf16_f32 v110, v124, v125
 v_cvt_pk_bf16_f32 v111, v126, v127
 v_mfma_f32_16x16x32_bf16 v[156:159], a[188:191], v[152:155], v[156:159]
 s_add_u32 s55, s9, 0x2000
 ds_read_b64_tr_b16 a[180:181], v9 offset:50944
 ds_read_b64_tr_b16 a[182:183], v9 offset:51072
 v_mfma_f32_16x16x32_bf16 v[156:159], a[184:187], v[136:139], v[156:159]
 s_waitcnt lgkmcnt(8)
 buffer_store_dwordx4 v[108:111], v1, s[24:27], s55 offen offset:0 sc1
 v_mov_b32 v78, v102
 v_mfma_f32_16x16x32_bf16 v[132:135], a[160:163], v[160:163], v[132:135]
 ds_read_b64_tr_b16 a[184:185], v9 offset:50720
 ds_read_b64_tr_b16 a[186:187], v9 offset:50848
 v_mfma_f32_16x16x32_bf16 v[132:135], a[164:167], v[176:179], v[132:135]
 s_add_u32 s55, s10, 0x4000
 v_cvt_pk_bf16_f32 v164, v164, v165
 v_cvt_pk_bf16_f32 v165, v166, v167
 v_mfma_f32_16x16x32_bf16 v[140:143], a[164:167], v[184:187], v[140:143]
 ds_read_b64_tr_b16 a[188:189], v9 offset:50976
 ds_read_b64_tr_b16 a[190:191], v9 offset:51104
 v_mfma_f32_16x16x32_bf16 v[140:143], a[160:163], v[168:171], v[140:143]
 s_waitcnt vmcnt(10)
 s_barrier
 s_waitcnt lgkmcnt(8)
 ds_read_b64_tr_b16 a[96:97], v2 offset:0
 ds_read_b64_tr_b16 a[98:99], v2 offset:128
 v_mfma_f32_16x16x32_bf16 v[148:151], a[168:171], v[160:163], v[148:151]
 s_add_u32 s56, s100, 0
 ds_read_b64_tr_b16 a[100:101], v2 offset:256
 ds_read_b64_tr_b16 a[102:103], v2 offset:384
 v_mfma_f32_16x16x32_bf16 v[148:151], a[172:175], v[176:179], v[148:151]
 s_add_u32 m0, s40, 0
 ds_read_b64_tr_b16 a[104:105], v4 offset:0
 ds_read_b64_tr_b16 a[106:107], v4 offset:128
 v_mfma_f32_16x16x32_bf16 v[156:159], a[172:175], v[184:187], v[156:159]
 ds_read_b64_tr_b16 a[108:109], v4 offset:256
 ds_read_b64_tr_b16 a[110:111], v4 offset:384
 v_mfma_f32_16x16x32_bf16 v[156:159], a[168:171], v[168:171], v[156:159]
 s_waitcnt lgkmcnt(12)
 v_readfirstlane_b32 s50, v29
 s_or_b32 s50, s50, s5
 s_cbranch_scc0 L_poll5
L_poll5_ret:
 v_mfma_f32_16x16x32_bf16 v[132:135], a[176:179], v[192:195], v[132:135]
 ds_read_b64_tr_b16 a[112:113], v2 offset:32
 ds_read_b64_tr_b16 a[114:115], v2 offset:160
 v_mfma_f32_16x16x32_bf16 v[132:135], a[180:183], v[208:211], v[132:135]
 buffer_load_dwordx4 v17, s[28:31], s56 offen offset:0 lds
 v_cvt_pk_bf16_f32 v166, v172, v173
 v_mfma_f32_16x16x32_bf16 v[140:143], a[180:183], v[216:219], v[140:143]
 s_add_u32 m0, s40, 0xa0
 ds_read_b64_tr_b16 a[116:117], v2 offset:288
 ds_read_b64_tr_b16 a[118:119], v2 offset:416
 v_mfma_f32_16x16x32_bf16 v[140:143], a[176:179], v[200:203], v[140:143]
 s_waitcnt lgkmcnt(12)
 buffer_load_dwordx4 v17, s[28:31], s56 offen offset:896 lds
 v_cvt_pk_bf16_f32 v167, v174, v175
 v_mfma_f32_16x16x32_bf16 v[148:151], a[184:187], v[192:195], v[148:151]
 s_add_u32 m0, s40, 0x140
 ds_read_b64_tr_b16 a[120:121], v4 offset:32
 ds_read_b64_tr_b16 a[122:123], v4 offset:160
 v_mfma_f32_16x16x32_bf16 v[148:151], a[188:191], v[208:211], v[148:151]
 buffer_load_dwordx4 v17, s[28:31], s56 offen offset:1792 lds
 buffer_store_dwordx4 v[164:167], v1, s[24:27], s55 offen offset:0 sc1
 v_mfma_f32_16x16x32_bf16 v[156:159], a[188:191], v[216:219], v[156:159]
 ds_read_b64_tr_b16 a[124:125], v4 offset:288
 ds_read_b64_tr_b16 a[126:127], v4 offset:416
 v_mfma_f32_16x16x32_bf16 v[156:159], a[184:187], v[200:203], v[156:159]
 s_waitcnt lgkmcnt(12)
 v_mov_b32 v79, v103
 v_mfma_f32_16x16x32_bf16 v[180:183], a[96:99], a[192:195], 0
 s_add_u32 m0, s40, 0x1e0
 ds_read_b64_tr_b16 a[160:161], v2 offset:16896
 ds_read_b64_tr_b16 a[162:163], v2 offset:17024
 v_mfma_f32_16x16x32_bf16 v[180:183], a[100:103], a[200:203], v[180:183]
 s_waitcnt lgkmcnt(10)
 buffer_load_dwordx4 v17, s[28:31], s56 offen offset:2688 lds
 v_mfma_f32_16x16x32_bf16 v[180:183], a[104:107], a[208:211], v[180:183]
 s_cmp_eq_u32 s59, 1
 s_cselect_b64 vcc, -1, 0
 v_cndmask_b32 v76, v76, v108, vcc
 v_mfma_f32_16x16x32_bf16 v[180:183], a[108:111], a[216:219], v[180:183]
 s_add_u32 s55, s11, 0x6000
 ds_read_b64_tr_b16 a[164:165], v2 offset:17152
 ds_read_b64_tr_b16 a[166:167], v2 offset:17280
 v_mfma_f32_16x16x32_bf16 v[188:191], a[108:111], a[220:223], 0
 s_add_u32 s56, s100, 0x1c000
 v_cvt_pk_bf16_f32 v132, v132, v133
 v_cvt_pk_bf16_f32 v133, v134, v135
 v_mfma_f32_16x16x32_bf16 v[188:191], a[104:107], a[212:215], v[188:191]
 s_add_u32 m0, s40, 0x4200
 v_cvt_pk_bf16_f32 v134, v148, v149
 v_cvt_pk_bf16_f32 v135, v150, v151
 v_mfma_f32_16x16x32_bf16 v[188:191], a[100:103], a[204:207], v[188:191]
 ds_read_b64_tr_b16 a[168:169], v4 offset:16896
 ds_read_b64_tr_b16 a[170:171], v4 offset:17024
 v_mfma_f32_16x16x32_bf16 v[188:191], a[96:99], a[196:199], v[188:191]
 buffer_load_dwordx4 v17, s[28:31], s56 offen offset:0 lds
 buffer_store_dwordx4 v[132:135], v1, s[24:27], s55 offen offset:0 sc1
 v_mfma_f32_16x16x32_bf16 v[52:55], a[96:99], v[80:83], 0
 s_add_u32 m0, s40, 0x42a0
 v_cndmask_b32 v77, v77, v109, vcc
 v_cndmask_b32 v78, v78, v110, vcc
 v_mfma_f32_16x16x32_bf16 v[52:55], a[100:103], v[84:87], v[52:55]
 ds_read_b64_tr_b16 a[172:173], v4 offset:17152
 ds_read_b64_tr_b16 a[174:175], v4 offset:17280
 v_mfma_f32_16x16x32_bf16 v[52:55], a[104:107], v[228:231], v[52:55]
 s_add_u32 s55, s12, 0x8000
 buffer_load_dwordx4 v17, s[28:31], s56 offen offset:896 lds
 v_cvt_pk_bf16_f32 v140, v140, v141
 v_mfma_f32_16x16x32_bf16 v[52:55], a[108:111], v[236:239], v[52:55]
 s_waitcnt lgkmcnt(12)
 v_cvt_pk_bf16_f32 v141, v142, v143
 v_cvt_pk_bf16_f32 v142, v156, v157
 v_mfma_f32_16x16x32_bf16 v[196:199], a[112:115], a[192:195], 0
 s_add_u32 m0, s40, 0x4340
 ds_read_b64_tr_b16 a[176:177], v2 offset:16928
 ds_read_b64_tr_b16 a[178:179], v2 offset:17056
 v_mfma_f32_16x16x32_bf16 v[196:199], a[116:119], a[200:203], v[196:199]
 s_waitcnt lgkmcnt(10)
 buffer_load_dwordx4 v17, s[28:31], s56 offen offset:1792 lds
 v_cvt_pk_bf16_f32 v143, v158, v159
 v_mfma_f32_16x16x32_bf16 v[196:199], a[120:123], a[208:211], v[196:199]
 buffer_store_dwordx4 v[140:143], v1, s[24:27], s55 offen offset:0 sc1
 v_cndmask_b32 v79, v79, v111, vcc
 v_mfma_f32_16x16x32_bf16 v[196:199], a[124:127], a[216:219], v[196:199]
 ds_read_b64_tr_b16 a[180:181], v2 offset:17184
 ds_read_b64_tr_b16 a[182:183], v2 offset:17312
 v_mfma_f32_16x16x32_bf16 v[212:215], a[124:127], a[220:223], 0
 s_add_u32 m0, s40, 0x43e0
 v_mfma_f32_16x16x32_bf16 v[212:215], a[120:123], a[212:215], v[212:215]
 s_cmp_eq_u32 s59, 2
 s_cselect_b64 vcc, -1, 0
 buffer_load_dwordx4 v17, s[28:31], s56 offen offset:2688 lds
 v_mfma_f32_16x16x32_bf16 v[212:215], a[116:119], a[204:207], v[212:215]
 ds_read_b64_tr_b16 a[184:185], v4 offset:16928
 ds_read_b64_tr_b16 a[186:187], v4 offset:17056
 v_mfma_f32_16x16x32_bf16 v[212:215], a[112:115], a[196:199], v[212:215]
 v_cndmask_b32 v76, v76, v164, vcc
 v_cndmask_b32 v77, v77, v165, vcc
 v_mfma_f32_16x16x32_bf16 v[56:59], a[112:115], v[80:83], 0
 v_cndmask_b32 v78, v78, v166, vcc
 v_cndmask_b32 v79, v79, v167, vcc
 v_mfma_f32_16x16x32_bf16 v[56:59], a[116:119], v[84:87], v[56:59]
 ds_read_b64_tr_b16 a[188:189], v4 offset:17184
 ds_read_b64_tr_b16 a[190:191], v4 offset:17312
 v_mfma_f32_16x16x32_bf16 v[56:59], a[120:123], v[228:231], v[56:59]
 s_cmp_eq_u32 s59, 3
 s_cselect_b64 vcc, -1, 0
 v_cndmask_b32 v76, v76, v132, vcc
 v_mfma_f32_16x16x32_bf16 v[56:59], a[124:127], v[236:239], v[56:59]
 s_waitcnt lgkmcnt(12)
 v_cndmask_b32 v77, v77, v133, vcc
 v_cndmask_b32 v78, v78, v134, vcc
 v_mfma_f32_16x16x32_bf16 v[180:183], a[160:163], a[224:227], v[180:183]
 s_waitcnt vmcnt(12)
 s_barrier
 ds_read_b64_tr_b16 a[96:97], v2 offset:33792
 ds_read_b64_tr_b16 a[98:99], v2 offset:33920
 v_mfma_f32_16x16x32_bf16 v[180:183], a[164:167], a[232:235], v[180:183]
 s_waitcnt lgkmcnt(10)
 v_cndmask_b32 v79, v79, v135, vcc
 v_mfma_f32_16x16x32_bf16 v[180:183], a[168:171], a[240:243], v[180:183]
 s_add_u32 s56, s100, 0x1c0000
 v_mfma_f32_16x16x32_bf16 v[180:183], a[172:175], a[248:251], v[180:183]
 s_add_u32 m0, s40, 0x8400
 ds_read_b64_tr_b16 a[100:101], v2 offset:34048
 ds_read_b64_tr_b16 a[102:103], v2 offset:34176
 v_mfma_f32_16x16x32_bf16 v[188:191], a[172:175], a[252:255], v[188:191]
 s_cmp_eq_u32 s59, 4
 s_cselect_b64 vcc, -1, 0
 buffer_load_dwordx4 v17, s[28:31], s56 offen offset:0 lds
 v_mfma_f32_16x16x32_bf16 v[188:191], a[168:171], a[244:247], v[188:191]
 v_cndmask_b32 v76, v76, v140, vcc
 v_cndmask_b32 v77, v77, v141, vcc
 v_mfma_f32_16x16x32_bf16 v[188:191], a[164:167], a[236:239], v[188:191]
 ds_read_b64_tr_b16 a[104:105], v4 offset:33792
 ds_read_b64_tr_b16 a[106:107], v4 offset:33920
 v_mfma_f32_16x16x32_bf16 v[188:191], a[160:163], a[228:231], v[188:191]
 v_cndmask_b32 v78, v78, v142, vcc
 v_cndmask_b32 v79, v79, v143, vcc
 v_mfma_f32_16x16x32_bf16 v[52:55], a[160:163], v[88:91], v[52:55]
 v_mfma_f32_16x16x32_bf16 v[52:55], a[164:167], v[92:95], v[52:55]
 ds_read_b64_tr_b16 a[108:109], v4 offset:34048
 ds_read_b64_tr_b16 a[110:111], v4 offset:34176
 v_mfma_f32_16x16x32_bf16 v[52:55], a[168:171], v[244:247], v[52:55]
 v_mfma_f32_16x16x32_bf16 v[52:55], a[172:175], v[252:255], v[52:55]
 s_waitcnt lgkmcnt(12)
 v_mfma_f32_16x16x32_bf16 v[196:199], a[176:179], a[224:227], v[196:199]
 s_add_u32 m0, s40, 0x84a0
 ds_read_b64_tr_b16 a[112:113], v2 offset:33824
 ds_read_b64_tr_b16 a[114:115], v2 offset:33952
 v_mfma_f32_16x16x32_bf16 v[196:199], a[180:183], a[232:235], v[196:199]
 s_waitcnt lgkmcnt(10)
 buffer_load_dwordx4 v17, s[28:31], s56 offen offset:896 lds
 v_mfma_f32_16x16x32_bf16 v[196:199], a[184:187], a[240:243], v[196:199]
 v_mfma_f32_16x16x32_bf16 v[196:199], a[188:191], a[248:251], v[196:199]
 ds_read_b64_tr_b16 a[116:117], v2 offset:34080
 ds_read_b64_tr_b16 a[118:119], v2 offset:34208
 v_mfma_f32_16x16x32_bf16 v[212:215], a[188:191], a[252:255], v[212:215]
 v_mfma_f32_16x16x32_bf16 v[212:215], a[184:187], a[244:247], v[212:215]
 v_mfma_f32_16x16x32_bf16 v[212:215], a[180:183], a[236:239], v[212:215]
 ds_read_b64_tr_b16 a[120:121], v4 offset:33824
 ds_read_b64_tr_b16 a[122:123], v4 offset:33952
 v_mfma_f32_16x16x32_bf16 v[212:215], a[176:179], a[228:231], v[212:215]
 v_mfma_f32_16x16x32_bf16 v[56:59], a[176:179], v[88:91], v[56:59]
 v_mfma_f32_16x16x32_bf16 v[56:59], a[180:183], v[92:95], v[56:59]
 ds_read_b64_tr_b16 a[124:125], v4 offset:34080
 ds_read_b64_tr_b16 a[126:127], v4 offset:34208
 v_mfma_f32_16x16x32_bf16 v[56:59], a[184:187], v[244:247], v[56:59]
 s_add_u32 m0, s40, 0x8540
 v_mfma_f32_16x16x32_bf16 v[56:59], a[188:191], v[252:255], v[56:59]
 s_waitcnt lgkmcnt(12)
 buffer_load_dwordx4 v17, s[28:31], s56 offen offset:1792 lds
 v_mfma_f32_16x16x32_bf16 v[180:183], a[96:99], v[96:99], v[180:183]
 ds_read_b64_tr_b16 a[160:161], v2 offset:50688
 ds_read_b64_tr_b16 a[162:163], v2 offset:50816
 v_mfma_f32_16x16x32_bf16 v[180:183], a[100:103], v[112:115], v[180:183]
 s_waitcnt lgkmcnt(10)
 v_mfma_f32_16x16x32_bf16 v[180:183], a[104:107], v[128:131], v[180:183]
 v_mfma_f32_16x16x32_bf16 v[180:183], a[108:111], v[144:147], v[180:183]
 ds_read_b64_tr_b16 a[164:165], v2 offset:50944
 ds_read_b64_tr_b16 a[166:167], v2 offset:51072
 v_mfma_f32_16x16x32_bf16 v[188:191], a[108:111], v[152:155], v[188:191]
 v_mfma_f32_16x16x32_bf16 v[188:191], a[104:107], v[136:139], v[188:191]
 v_mfma_f32_16x16x32_bf16 v[188:191], a[100:103], v[120:123], v[188:191]
 ds_read_b64_tr_b16 a[168:169], v4 offset:50688
 ds_read_b64_tr_b16 a[170:171], v4 offset:50816
 v_mfma_f32_16x16x32_bf16 v[188:191], a[96:99], v[104:107], v[188:191]
 v_mfma_f32_16x16x32_bf16 v[52:55], a[96:99], v[224:227], v[52:55]
 v_mfma_f32_16x16x32_bf16 v[52:55], a[100:103], v[232:235], v[52:55]
 s_add_u32 m0, s40, 0x85e0
 ds_read_b64_tr_b16 a[172:173], v4 offset:50944
 ds_read_b64_tr_b16 a[174:175], v4 offset:51072
 v_mfma_f32_16x16x32_bf16 v[52:55], a[104:107], a[128:131], v[52:55]
 buffer_load_dwordx4 v17, s[28:31], s56 offen offset:2688 lds
 v_mfma_f32_16x16x32_bf16 v[52:55], a[108:111], a[136:139], v[52:55]
 s_waitcnt lgkmcnt(12)
 v_mfma_f32_16x16x32_bf16 v[196:199], a[112:115], v[96:99], v[196:199]
 ds_read_b64_tr_b16 a[176:177], v2 offset:50720
 ds_read_b64_tr_b16 a[178:179], v2 offset:50848
 v_mfma_f32_16x16x32_bf16 v[196:199], a[116:119], v[112:115], v[196:199]
 s_waitcnt lgkmcnt(10)
 v_mfma_f32_16x16x32_bf16 v[196:199], a[120:123], v[128:131], v[196:199]
 v_mfma_f32_16x16x32_bf16 v[196:199], a[124:127], v[144:147], v[196:199]
 ds_read_b64_tr_b16 a[180:181], v2 offset:50976
 ds_read_b64_tr_b16 a[182:183], v2 offset:51104
 v_mfma_f32_16x16x32_bf16 v[212:215], a[124:127], v[152:155], v[212:215]
L_pad21:
 s_cbranch_execz L_pad25
 v_mfma_f32_16x16x32_bf16 v[212:215], a[120:123], v[136:139], v[212:215]
 v_mfma_f32_16x16x32_bf16 v[212:215], a[116:119], v[120:123], v[212:215]
 ds_read_b64_tr_b16 a[184:185], v4 offset:50720
 ds_read_b64_tr_b16 a[186:187], v4 offset:50848
 v_mfma_f32_16x16x32_bf16 v[212:215], a[112:115], v[104:107], v[212:215]
 v_mfma_f32_16x16x32_bf16 v[56:59], a[112:115], v[224:227], v[56:59]
 v_mfma_f32_16x16x32_bf16 v[56:59], a[116:119], v[232:235], v[56:59]
 ds_read_b64_tr_b16 a[188:189], v4 offset:50976
 ds_read_b64_tr_b16 a[190:191], v4 offset:51104
 v_mfma_f32_16x16x32_bf16 v[56:59], a[120:123], a[128:131], v[56:59]
 v_mfma_f32_16x16x32_bf16 v[56:59], a[124:127], a[136:139], v[56:59]
 s_waitcnt lgkmcnt(12)
 v_mfma_f32_16x16x32_bf16 v[180:183], a[160:163], v[160:163], v[180:183]
 ds_read_b64_tr_b16 a[96:97], v3 offset:0
 ds_read_b64_tr_b16 a[98:99], v3 offset:128
 v_mfma_f32_16x16x32_bf16 v[180:183], a[164:167], v[176:179], v[180:183]
 s_waitcnt lgkmcnt(10)
 v_mfma_f32_16x16x32_bf16 v[180:183], a[168:171], v[192:195], v[180:183]
 s_add_u32 s56, s100, 0x1dc000
 v_mfma_f32_16x16x32_bf16 v[180:183], a[172:175], v[208:211], v[180:183]
 s_add_u32 m0, s40, 0xc600
 ds_read_b64_tr_b16 a[100:101], v3 offset:256
 ds_read_b64_tr_b16 a[102:103], v3 offset:384
 v_mfma_f32_16x16x32_bf16 v[188:191], a[172:175], v[216:219], v[188:191]
 buffer_load_dwordx4 v17, s[28:31], s56 offen offset:0 lds
 v_mfma_f32_16x16x32_bf16 v[188:191], a[168:171], v[200:203], v[188:191]
 v_mfma_f32_16x16x32_bf16 v[188:191], a[164:167], v[184:187], v[188:191]
 ds_read_b64_tr_b16 a[104:105], v5 offset:0
 ds_read_b64_tr_b16 a[106:107], v5 offset:128
 v_mfma_f32_16x16x32_bf16 v[188:191], a[160:163], v[168:171], v[188:191]
 v_mfma_f32_16x16x32_bf16 v[52:55], a[160:163], v[240:243], v[52:55]
 v_mfma_f32_16x16x32_bf16 v[52:55], a[164:167], v[248:251], v[52:55]
 ds_read_b64_tr_b16 a[108:109], v5 offset:256
 ds_read_b64_tr_b16 a[110:111], v5 offset:384
 v_mfma_f32_16x16x32_bf16 v[52:55], a[168:171], a[144:147], v[52:55]
 v_mfma_f32_16x16x32_bf16 v[52:55], a[172:175], a[152:155], v[52:55]
 s_waitcnt lgkmcnt(12)
 v_mfma_f32_16x16x32_bf16 v[196:199], a[176:179], v[160:163], v[196:199]
 ds_read_b64_tr_b16 a[112:113], v3 offset:32
 ds_read_b64_tr_b16 a[114:115], v3 offset:160
 v_mfma_f32_16x16x32_bf16 v[196:199], a[180:183], v[176:179], v[196:199]
 s_waitcnt lgkmcnt(10)
 v_mfma_f32_16x16x32_bf16 v[196:199], a[184:187], v[192:195], v[196:199]
 v_mfma_f32_16x16x32_bf16 v[196:199], a[188:191], v[208:211], v[196:199]
 ds_read_b64_tr_b16 a[116:117], v3 offset:288
 ds_read_b64_tr_b16 a[118:119], v3 offset:416
 v_mfma_f32_16x16x32_bf16 v[212:215], a[188:191], v[216:219], v[212:215]
 v_mfma_f32_16x16x32_bf16 v[212:215], a[184:187], v[200:203], v[212:215]
 s_add_u32 m0, s40, 0xc6a0
 v_mfma_f32_16x16x32_bf16 v[212:215], a[180:183], v[184:187], v[212:215]
 ds_read_b64_tr_b16 a[120:121], v5 offset:32
 ds_read_b64_tr_b16 a[122:123], v5 offset:160
 v_mfma_f32_16x16x32_bf16 v[212:215], a[176:179], v[168:171], v[212:215]
 buffer_load_dwordx4 v17, s[28:31], s56 offen offset:896 lds
 v_mfma_f32_16x16x32_bf16 v[56:59], a[176:179], v[240:243], v[56:59]
 v_mfma_f32_16x16x32_bf16 v[56:59], a[180:183], v[248:251], v[56:59]
 ds_read_b64_tr_b16 a[124:125], v5 offset:288
 ds_read_b64_tr_b16 a[126:127], v5 offset:416
 v_mfma_f32_16x16x32_bf16 v[56:59], a[184:187], a[144:147], v[56:59]
 v_mfma_f32_16x16x32_bf16 v[56:59], a[188:191], a[152:155], v[56:59]
 s_waitcnt lgkmcnt(12)
 v_mfma_f32_16x16x32_bf16 v[220:223], a[96:99], a[192:195], 0
 ds_read_b64_tr_b16 a[160:161], v3 offset:16896
 ds_read_b64_tr_b16 a[162:163], v3 offset:17024
 v_mfma_f32_16x16x32_bf16 v[220:223], a[100:103], a[200:203], v[220:223]
 s_waitcnt lgkmcnt(10)
 v_mfma_f32_16x16x32_bf16 v[220:223], a[104:107], a[208:211], v[220:223]
 ds_read_b64_tr_b16 a[164:165], v3 offset:17152
 ds_read_b64_tr_b16 a[166:167], v3 offset:17280
 v_mfma_f32_16x16x32_bf16 v[220:223], a[108:111], a[216:219], v[220:223]
 s_add_u32 s55, s13, 0x28000
 v_cvt_pk_bf16_f32 v180, v180, v181
 v_cvt_pk_bf16_f32 v181, v182, v183
 v_mfma_f32_16x16x32_bf16 v[20:23], a[108:111], a[220:223], 0
 ds_read_b64_tr_b16 a[168:169], v5 offset:16896
 ds_read_b64_tr_b16 a[170:171], v5 offset:17024
 v_mfma_f32_16x16x32_bf16 v[20:23], a[104:107], a[212:215], v[20:23]
 v_cvt_pk_bf16_f32 v182, v196, v197
 v_cvt_pk_bf16_f32 v183, v198, v199
 v_mfma_f32_16x16x32_bf16 v[20:23], a[100:103], a[204:207], v[20:23]
 ds_read_b64_tr_b16 a[172:173], v5 offset:17152
 ds_read_b64_tr_b16 a[174:175], v5 offset:17280
 v_mfma_f32_16x16x32_bf16 v[20:23], a[96:99], a[196:199], v[20:23]
 s_waitcnt lgkmcnt(12)
 buffer_store_dwordx4 v[180:183], v1, s[24:27], s55 offen offset:0 sc1
 v_mfma_f32_16x16x32_bf16 v[44:47], a[112:115], a[192:195], 0
 ds_read_b64_tr_b16 a[176:177], v3 offset:16928
 ds_read_b64_tr_b16 a[178:179], v3 offset:17056
 v_mfma_f32_16x16x32_bf16 v[44:47], a[116:119], a[200:203], v[44:47]
 s_waitcnt lgkmcnt(10)
 v_mfma_f32_16x16x32_bf16 v[44:47], a[120:123], a[208:211], v[44:47]
 s_add_u32 m0, s40, 0xc740
 ds_read_b64_tr_b16 a[180:181], v3 offset:17184
 ds_read_b64_tr_b16 a[182:183], v3 offset:17312
 v_mfma_f32_16x16x32_bf16 v[44:47], a[124:127], a[216:219], v[44:47]
 s_add_u32 s55, s14, 0x2a000
 buffer_load_dwordx4 v17, s[28:31], s56 offen offset:1792 lds
 v_cvt_pk_bf16_f32 v188, v188, v189
 v_mfma_f32_16x16x32_bf16 v[48:51], a[124:127], a[220:223], 0
 ds_read_b64_tr_b16 a[184:185], v5 offset:16928
 ds_read_b64_tr_b16 a[186:187], v5 offset:17056
 v_mfma_f32_16x16x32_bf16 v[48:51], a[120:123], a[212:215], v[48:51]
 v_cvt_pk_bf16_f32 v189, v190, v191
 v_cvt_pk_bf16_f32 v190, v212, v213
 v_mfma_f32_16x16x32_bf16 v[48:51], a[116:119], a[204:207], v[48:51]
 ds_read_b64_tr_b16 a[188:189], v5 offset:17184
 ds_read_b64_tr_b16 a[190:191], v5 offset:17312
 v_mfma_f32_16x16x32_bf16 v[48:51], a[112:115], a[196:199], v[48:51]
 s_waitcnt lgkmcnt(12)
 v_cvt_pk_bf16_f32 v191, v214, v215
 v_mfma_f32_16x16x32_bf16 v[220:223], a[160:163], a[224:227], v[220:223]
 ds_read_b64_tr_b16 a[96:97], v3 offset:33792
 ds_read_b64_tr_b16 a[98:99], v3 offset:33920
 v_mfma_f32_16x16x32_bf16 v[220:223], a[164:167], a[232:235], v[220:223]
 s_waitcnt lgkmcnt(10)
 buffer_store_dwordx4 v[188:191], v1, s[24:27], s55 offen offset:0 sc1
 v_cvt_pk_bf16_f32 v52, v52, v53
 v_mfma_f32_16x16x32_bf16 v[220:223], a[168:171], a[240:243], v[220:223]
 s_add_u32 s55, s15, 0x2c000
 ds_read_b64_tr_b16 a[100:101], v3 offset:34048
 ds_read_b64_tr_b16 a[102:103], v3 offset:34176
 v_mfma_f32_16x16x32_bf16 v[220:223], a[172:175], a[248:251], v[220:223]
 v_cvt_pk_bf16_f32 v53, v54, v55
 v_cvt_pk_bf16_f32 v54, v56, v57
 v_mfma_f32_16x16x32_bf16 v[20:23], a[172:175], a[252:255], v[20:23]
 ds_read_b64_tr_b16 a[104:105], v5 offset:33792
 ds_read_b64_tr_b16 a[106:107], v5 offset:33920
 v_mfma_f32_16x16x32_bf16 v[20:23], a[168:171], a[244:247], v[20:23]
 s_cmp_eq_u32 s59, 5
 s_cselect_b64 vcc, -1, 0
 v_cvt_pk_bf16_f32 v55, v58, v59
 v_mfma_f32_16x16x32_bf16 v[20:23], a[164:167], a[236:239], v[20:23]
 ds_read_b64_tr_b16 a[108:109], v5 offset:34048
 ds_read_b64_tr_b16 a[110:111], v5 offset:34176
 v_mfma_f32_16x16x32_bf16 v[20:23], a[160:163], a[228:231], v[20:23]
 s_waitcnt lgkmcnt(12)
 buffer_store_dwordx4 v[52:55], v1, s[24:27], s55 offen offset:0 sc1
 v_cndmask_b32 v76, v76, v180, vcc
 v_mfma_f32_16x16x32_bf16 v[44:47], a[176:179], a[224:227], v[44:47]
 ds_read_b64_tr_b16 a[112:113], v3 offset:33824
 ds_read_b64_tr_b16 a[114:115], v3 offset:33952
 v_mfma_f32_16x16x32_bf16 v[44:47], a[180:183], a[232:235], v[44:47]
 s_waitcnt lgkmcnt(10)
 v_cndmask_b32 v77, v77, v181, vcc
 v_cndmask_b32 v78, v78, v182, vcc
 v_mfma_f32_16x16x32_bf16 v[44:47], a[184:187], a[240:243], v[44:47]
 ds_read_b64_tr_b16 a[116:117], v3 offset:34080
 ds_read_b64_tr_b16 a[118:119], v3 offset:34208
 v_mfma_f32_16x16x32_bf16 v[44:47], a[188:191], a[248:251], v[44:47]
 s_add_u32 m0, s40, 0xc7e0
 v_cndmask_b32 v79, v79, v183, vcc
 v_mfma_f32_16x16x32_bf16 v[48:51], a[188:191], a[252:255], v[48:51]
 ds_read_b64_tr_b16 a[120:121], v5 offset:33824
 ds_read_b64_tr_b16 a[122:123], v5 offset:33952
 v_mfma_f32_16x16x32_bf16 v[48:51], a[184:187], a[244:247], v[48:51]
 s_cmp_eq_u32 s59, 6
 s_cselect_b64 vcc, -1, 0
 buffer_load_dwordx4 v17, s[28:31], s56 offen offset:2688 lds
 v_mfma_f32_16x16x32_bf16 v[48:51], a[180:183], a[236:239], v[48:51]
 s_add_u32 s100, s100, 0x80
 ds_read_b64_tr_b16 a[124:125], v5 offset:34080
 ds_read_b64_tr_b16 a[126:127], v5 offset:34208
 v_mfma_f32_16x16x32_bf16 v[48:51], a[176:179], a[228:231], v[48:51]
 s_waitcnt lgkmcnt(12)
 v_cndmask_b32 v76, v76, v188, vcc
 v_cndmask_b32 v77, v77, v189, vcc
 v_mfma_f32_16x16x32_bf16 v[220:223], a[96:99], v[96:99], v[220:223]
 s_sub_u32 s56, s100, 0x380
 ds_read_b64_tr_b16 a[160:161], v3 offset:50688
 ds_read_b64_tr_b16 a[162:163], v3 offset:50816
 v_mfma_f32_16x16x32_bf16 v[220:223], a[100:103], v[112:115], v[220:223]
 s_waitcnt lgkmcnt(10)
 v_cndmask_b32 v78, v78, v190, vcc
 v_cndmask_b32 v79, v79, v191, vcc
 v_mfma_f32_16x16x32_bf16 v[220:223], a[104:107], v[128:131], v[220:223]
 s_min_u32 s100, s100, s56
 ds_read_b64_tr_b16 a[164:165], v3 offset:50944
 ds_read_b64_tr_b16 a[166:167], v3 offset:51072
 v_mfma_f32_16x16x32_bf16 v[220:223], a[108:111], v[144:147], v[220:223]
 s_cmp_eq_u32 s59, 7
 s_cselect_b64 vcc, -1, 0
 v_cndmask_b32 v76, v76, v52, vcc
 v_mfma_f32_16x16x32_bf16 v[20:23], a[108:111], v[152:155], v[20:23]
 ds_read_b64_tr_b16 a[168:169], v5 offset:50688
 ds_read_b64_tr_b16 a[170:171], v5 offset:50816
 v_mfma_f32_16x16x32_bf16 v[20:23], a[104:107], v[136:139], v[20:23]
 v_cndmask_b32 v77, v77, v53, vcc
 v_cndmask_b32 v78, v78, v54, vcc
 v_mfma_f32_16x16x32_bf16 v[20:23], a[100:103], v[120:123], v[20:23]
 ds_read_b64_tr_b16 a[172:173], v5 offset:50944
 ds_read_b64_tr_b16 a[174:175], v5 offset:51072
 v_mfma_f32_16x16x32_bf16 v[20:23], a[96:99], v[104:107], v[20:23]
 s_waitcnt lgkmcnt(12)
 v_cndmask_b32 v79, v79, v55, vcc
 v_mfma_f32_16x16x32_bf16 v[44:47], a[112:115], v[96:99], v[44:47]
 ds_read_b64_tr_b16 a[176:177], v3 offset:50720
 ds_read_b64_tr_b16 a[178:179], v3 offset:50848
 v_mfma_f32_16x16x32_bf16 v[44:47], a[116:119], v[112:115], v[44:47]
 s_waitcnt lgkmcnt(10)
 v_mfma_f32_16x16x32_bf16 v[44:47], a[120:123], v[128:131], v[44:47]
 ds_read_b64_tr_b16 a[180:181], v3 offset:50976
 ds_read_b64_tr_b16 a[182:183], v3 offset:51104
 v_mfma_f32_16x16x32_bf16 v[44:47], a[124:127], v[144:147], v[44:47]
 v_mfma_f32_16x16x32_bf16 v[48:51], a[124:127], v[152:155], v[48:51]
 ds_read_b64_tr_b16 a[184:185], v5 offset:50720
 ds_read_b64_tr_b16 a[186:187], v5 offset:50848
 v_mfma_f32_16x16x32_bf16 v[48:51], a[120:123], v[136:139], v[48:51]
 v_mfma_f32_16x16x32_bf16 v[48:51], a[116:119], v[120:123], v[48:51]
 ds_read_b64_tr_b16 a[188:189], v5 offset:50976
 ds_read_b64_tr_b16 a[190:191], v5 offset:51104
 v_mfma_f32_16x16x32_bf16 v[48:51], a[112:115], v[104:107], v[48:51]
 s_waitcnt lgkmcnt(12)
 v_mfma_f32_16x16x32_bf16 v[220:223], a[160:163], v[160:163], v[220:223]
 s_waitcnt vmcnt(11)
 s_barrier
 ds_read_b64_tr_b16 a[96:97], v6 offset:0
 ds_read_b64_tr_b16 a[98:99], v6 offset:128
 v_mfma_f32_16x16x32_bf16 v[220:223], a[164:167], v[176:179], v[220:223]
 s_waitcnt lgkmcnt(10)
 v_mfma_f32_16x16x32_bf16 v[220:223], a[168:171], v[192:195], v[220:223]
 s_add_u32 s56, s100, 0
 ds_read_b64_tr_b16 a[100:101], v6 offset:256
 ds_read_b64_tr_b16 a[102:103], v6 offset:384
 v_mfma_f32_16x16x32_bf16 v[220:223], a[172:175], v[208:211], v[220:223]
 s_add_u32 m0, s40, 0x16600
 v_mfma_f32_16x16x32_bf16 v[20:23], a[172:175], v[216:219], v[20:23]
 ds_read_b64_tr_b16 a[104:105], v8 offset:0
 ds_read_b64_tr_b16 a[106:107], v8 offset:128
 v_mfma_f32_16x16x32_bf16 v[20:23], a[168:171], v[200:203], v[20:23]
 buffer_load_dwordx4 v17, s[28:31], s56 offen offset:0 lds
 v_mfma_f32_16x16x32_bf16 v[20:23], a[164:167], v[184:187], v[20:23]
 s_add_u32 m0, s40, 0x166a0
 ds_read_b64_tr_b16 a[108:109], v8 offset:256
 ds_read_b64_tr_b16 a[110:111], v8 offset:384
 v_mfma_f32_16x16x32_bf16 v[20:23], a[160:163], v[168:171], v[20:23]
 s_waitcnt lgkmcnt(12)
 buffer_load_dwordx4 v17, s[28:31], s56 offen offset:896 lds
 v_mfma_f32_16x16x32_bf16 v[44:47], a[176:179], v[160:163], v[44:47]
 ds_read_b64_tr_b16 a[112:113], v6 offset:32
 ds_read_b64_tr_b16 a[114:115], v6 offset:160
 v_mfma_f32_16x16x32_bf16 v[44:47], a[180:183], v[176:179], v[44:47]
 s_waitcnt lgkmcnt(10)
 v_mfma_f32_16x16x32_bf16 v[44:47], a[184:187], v[192:195], v[44:47]
 s_add_u32 m0, s40, 0x16740
 ds_read_b64_tr_b16 a[116:117], v6 offset:288
 ds_read_b64_tr_b16 a[118:119], v6 offset:416
 v_mfma_f32_16x16x32_bf16 v[44:47], a[188:191], v[208:211], v[44:47]
 buffer_load_dwordx4 v17, s[28:31], s56 offen offset:1792 lds
 v_mfma_f32_16x16x32_bf16 v[48:51], a[188:191], v[216:219], v[48:51]
 ds_read_b64_tr_b16 a[120:121], v8 offset:32
 ds_read_b64_tr_b16 a[122:123], v8 offset:160
 v_mfma_f32_16x16x32_bf16 v[48:51], a[184:187], v[200:203], v[48:51]
 v_mfma_f32_16x16x32_bf16 v[48:51], a[180:183], v[184:187], v[48:51]
 s_add_u32 m0, s40, 0x167e0
 ds_read_b64_tr_b16 a[124:125], v8 offset:288
 ds_read_b64_tr_b16 a[126:127], v8 offset:416
 v_mfma_f32_16x16x32_bf16 v[48:51], a[176:179], v[168:171], v[48:51]
 s_waitcnt lgkmcnt(12)
 buffer_load_dwordx4 v17, s[28:31], s56 offen offset:2688 lds
 v_mfma_f32_16x16x32_bf16 v[100:103], a[96:99], a[192:195], 0
 ds_read_b64_tr_b16 a[160:161], v6 offset:16896
 ds_read_b64_tr_b16 a[162:163], v6 offset:17024
 v_mfma_f32_16x16x32_bf16 v[100:103], a[100:103], a[200:203], v[100:103]
 s_waitcnt lgkmcnt(10)
 v_mfma_f32_16x16x32_bf16 v[100:103], a[104:107], a[208:211], v[100:103]
 s_add_u32 s56, s100, 0x1c000
 v_mfma_f32_16x16x32_bf16 v[100:103], a[108:111], a[216:219], v[100:103]
 s_add_u32 m0, s40, 0x1a800
 ds_read_b64_tr_b16 a[164:165], v6 offset:17152
 ds_read_b64_tr_b16 a[166:167], v6 offset:17280
 v_mfma_f32_16x16x32_bf16 v[108:111], a[108:111], a[220:223], 0
 s_add_u32 s55, s8, 0x2e000
 buffer_load_dwordx4 v17, s[28:31], s56 offen offset:0 lds
 v_cvt_pk_bf16_f32 v220, v220, v221
 v_mfma_f32_16x16x32_bf16 v[108:111], a[104:107], a[212:215], v[108:111]
 v_cvt_pk_bf16_f32 v221, v222, v223
 v_cvt_pk_bf16_f32 v222, v44, v45
 v_mfma_f32_16x16x32_bf16 v[108:111], a[100:103], a[204:207], v[108:111]
 s_add_u32 m0, s40, 0x1a8a0
 ds_read_b64_tr_b16 a[168:169], v8 offset:16896
 ds_read_b64_tr_b16 a[170:171], v8 offset:17024
 v_mfma_f32_16x16x32_bf16 v[108:111], a[96:99], a[196:199], v[108:111]
 buffer_load_dwordx4 v17, s[28:31], s56 offen offset:896 lds
 v_cvt_pk_bf16_f32 v223, v46, v47
 v_mfma_f32_16x16x32_bf16 v[164:167], a[96:99], v[80:83], 0
 buffer_store_dwordx4 v[220:223], v1, s[24:27], s55 offen offset:0 sc1
 v_mov_b32 v32, v220
 v_mfma_f32_16x16x32_bf16 v[164:167], a[100:103], v[84:87], v[164:167]
 ds_read_b64_tr_b16 a[172:173], v8 offset:17152
 ds_read_b64_tr_b16 a[174:175], v8 offset:17280
 v_mfma_f32_16x16x32_bf16 v[164:167], a[104:107], v[228:231], v[164:167]
 s_add_u32 s55, s9, 0x30000
 v_cvt_pk_bf16_f32 v20, v20, v21
 v_cvt_pk_bf16_f32 v21, v22, v23
 v_mfma_f32_16x16x32_bf16 v[164:167], a[108:111], v[236:239], v[164:167]
 s_waitcnt lgkmcnt(12)
 v_cvt_pk_bf16_f32 v22, v48, v49
 v_cvt_pk_bf16_f32 v23, v50, v51
 v_mfma_f32_16x16x32_bf16 v[116:119], a[112:115], a[192:195], 0
 s_add_u32 m0, s40, 0x1a940
 ds_read_b64_tr_b16 a[176:177], v6 offset:16928
 ds_read_b64_tr_b16 a[178:179], v6 offset:17056
 v_mfma_f32_16x16x32_bf16 v[116:119], a[116:119], a[200:203], v[116:119]
 s_waitcnt lgkmcnt(10)
 buffer_load_dwordx4 v17, s[28:31], s56 offen offset:1792 lds
 buffer_store_dwordx4 v[20:23], v1, s[24:27], s55 offen offset:0 sc1
 v_mfma_f32_16x16x32_bf16 v[116:119], a[120:123], a[208:211], v[116:119]
 v_mov_b32 v33, v221
 v_mov_b32 v34, v222
 v_mfma_f32_16x16x32_bf16 v[116:119], a[124:127], a[216:219], v[116:119]
 s_add_u32 m0, s40, 0x1a9e0
 ds_read_b64_tr_b16 a[180:181], v6 offset:17184
 ds_read_b64_tr_b16 a[182:183], v6 offset:17312
 v_mfma_f32_16x16x32_bf16 v[124:127], a[124:127], a[220:223], 0
 buffer_load_dwordx4 v17, s[28:31], s56 offen offset:2688 lds
 v_mov_b32 v35, v223
 v_mfma_f32_16x16x32_bf16 v[124:127], a[120:123], a[212:215], v[124:127]
 s_cmp_eq_u32 s59, 1
 s_cselect_b64 vcc, -1, 0
 v_cndmask_b32 v32, v32, v20, vcc
 v_mfma_f32_16x16x32_bf16 v[124:127], a[116:119], a[204:207], v[124:127]
 ds_read_b64_tr_b16 a[184:185], v8 offset:16928
 ds_read_b64_tr_b16 a[186:187], v8 offset:17056
 v_mfma_f32_16x16x32_bf16 v[124:127], a[112:115], a[196:199], v[124:127]
 v_cndmask_b32 v33, v33, v21, vcc
 v_cndmask_b32 v34, v34, v22, vcc
 v_mfma_f32_16x16x32_bf16 v[172:175], a[112:115], v[80:83], 0
 v_cndmask_b32 v35, v35, v23, vcc
 v_mfma_f32_16x16x32_bf16 v[172:175], a[116:119], v[84:87], v[172:175]
 ds_read_b64_tr_b16 a[188:189], v8 offset:17184
 ds_read_b64_tr_b16 a[190:191], v8 offset:17312
 v_mfma_f32_16x16x32_bf16 v[172:175], a[120:123], v[228:231], v[172:175]
 v_mfma_f32_16x16x32_bf16 v[172:175], a[124:127], v[236:239], v[172:175]
 s_waitcnt lgkmcnt(12)
 v_mfma_f32_16x16x32_bf16 v[100:103], a[160:163], a[224:227], v[100:103]
 s_waitcnt vmcnt(10)
 s_barrier
 ds_read_b64_tr_b16 a[96:97], v6 offset:33792
 ds_read_b64_tr_b16 a[98:99], v6 offset:33920
 v_mfma_f32_16x16x32_bf16 v[100:103], a[164:167], a[232:235], v[100:103]
 s_waitcnt lgkmcnt(10)
 v_mov_b32 v11, 1
 v_mfma_f32_16x16x32_bf16 v[100:103], a[168:171], a[240:243], v[100:103]
 s_add_u32 s56, s100, 0x1c0000
 buffer_atomic_add v11, v27, s[36:39], 0 offen
 v_mfma_f32_16x16x32_bf16 v[100:103], a[172:175], a[248:251], v[100:103]
 s_add_u32 m0, s40, 0x1ea00
 ds_read_b64_tr_b16 a[100:101], v6 offset:34048
 ds_read_b64_tr_b16 a[102:103], v6 offset:34176
 v_mfma_f32_16x16x32_bf16 v[108:111], a[172:175], a[252:255], v[108:111]
 buffer_load_dwordx4 v17, s[28:31], s56 offen offset:0 lds
 v_mfma_f32_16x16x32_bf16 v[108:111], a[168:171], a[244:247], v[108:111]
 v_mfma_f32_16x16x32_bf16 v[108:111], a[164:167], a[236:239], v[108:111]
 ds_read_b64_tr_b16 a[104:105], v8 offset:33792
 ds_read_b64_tr_b16 a[106:107], v8 offset:33920
 v_mfma_f32_16x16x32_bf16 v[108:111], a[160:163], a[228:231], v[108:111]
 v_mfma_f32_16x16x32_bf16 v[164:167], a[160:163], v[88:91], v[164:167]
 v_mfma_f32_16x16x32_bf16 v[164:167], a[164:167], v[92:95], v[164:167]
 ds_read_b64_tr_b16 a[108:109], v8 offset:34048
 ds_read_b64_tr_b16 a[110:111], v8 offset:34176
 v_mfma_f32_16x16x32_bf16 v[164:167], a[168:171], v[244:247], v[164:167]
 v_mfma_f32_16x16x32_bf16 v[164:167], a[172:175], v[252:255], v[164:167]
 s_waitcnt lgkmcnt(12)
 v_mfma_f32_16x16x32_bf16 v[116:119], a[176:179], a[224:227], v[116:119]
 s_add_u32 m0, s40, 0x1eaa0
 ds_read_b64_tr_b16 a[112:113], v6 offset:33824
 ds_read_b64_tr_b16 a[114:115], v6 offset:33952
 v_mfma_f32_16x16x32_bf16 v[116:119], a[180:183], a[232:235], v[116:119]
 s_waitcnt lgkmcnt(10)
 buffer_load_dwordx4 v17, s[28:31], s56 offen offset:896 lds
 v_mfma_f32_16x16x32_bf16 v[116:119], a[184:187], a[240:243], v[116:119]
 v_mfma_f32_16x16x32_bf16 v[116:119], a[188:191], a[248:251], v[116:119]
 ds_read_b64_tr_b16 a[116:117], v6 offset:34080
 ds_read_b64_tr_b16 a[118:119], v6 offset:34208
 v_mfma_f32_16x16x32_bf16 v[124:127], a[188:191], a[252:255], v[124:127]
 v_mfma_f32_16x16x32_bf16 v[124:127], a[184:187], a[244:247], v[124:127]
 v_mfma_f32_16x16x32_bf16 v[124:127], a[180:183], a[236:239], v[124:127]
 ds_read_b64_tr_b16 a[120:121], v8 offset:33824
 ds_read_b64_tr_b16 a[122:123], v8 offset:33952
 v_mfma_f32_16x16x32_bf16 v[124:127], a[176:179], a[228:231], v[124:127]
 v_mfma_f32_16x16x32_bf16 v[172:175], a[176:179], v[88:91], v[172:175]
 v_mfma_f32_16x16x32_bf16 v[172:175], a[180:183], v[92:95], v[172:175]
 ds_read_b64_tr_b16 a[124:125], v8 offset:34080
 ds_read_b64_tr_b16 a[126:127], v8 offset:34208
 v_mfma_f32_16x16x32_bf16 v[172:175], a[184:187], v[244:247], v[172:175]
 s_add_u32 m0, s40, 0x1eb40
 v_mfma_f32_16x16x32_bf16 v[172:175], a[188:191], v[252:255], v[172:175]
 s_waitcnt lgkmcnt(12)
 buffer_load_dwordx4 v17, s[28:31], s56 offen offset:1792 lds
 v_mfma_f32_16x16x32_bf16 v[100:103], a[96:99], v[96:99], v[100:103]
 ds_read_b64_tr_b16 a[160:161], v6 offset:50688
 ds_read_b64_tr_b16 a[162:163], v6 offset:50816
 v_mfma_f32_16x16x32_bf16 v[100:103], a[100:103], v[112:115], v[100:103]
 s_waitcnt lgkmcnt(10)
 v_mfma_f32_16x16x32_bf16 v[100:103], a[104:107], v[128:131], v[100:103]
 v_mfma_f32_16x16x32_bf16 v[100:103], a[108:111], v[144:147], v[100:103]
 ds_read_b64_tr_b16 a[164:165], v6 offset:50944
 ds_read_b64_tr_b16 a[166:167], v6 offset:51072
 v_mfma_f32_16x16x32_bf16 v[108:111], a[108:111], v[152:155], v[108:111]
 v_mfma_f32_16x16x32_bf16 v[108:111], a[104:107], v[136:139], v[108:111]
 v_mfma_f32_16x16x32_bf16 v[108:111], a[100:103], v[120:123], v[108:111]
 ds_read_b64_tr_b16 a[168:169], v8 offset:50688
 ds_read_b64_tr_b16 a[170:171], v8 offset:50816
 v_mfma_f32_16x16x32_bf16 v[108:111], a[96:99], v[104:107], v[108:111]
 v_mfma_f32_16x16x32_bf16 v[164:167], a[96:99], v[224:227], v[164:167]
 v_mfma_f32_16x16x32_bf16 v[164:167], a[100:103], v[232:235], v[164:167]
 s_add_u32 m0, s40, 0x1ebe0
 ds_read_b64_tr_b16 a[172:173], v8 offset:50944
 ds_read_b64_tr_b16 a[174:175], v8 offset:51072
 v_mfma_f32_16x16x32_bf16 v[164:167], a[104:107], a[128:131], v[164:167]
 buffer_load_dwordx4 v17, s[28:31], s56 offen offset:2688 lds
 v_mfma_f32_16x16x32_bf16 v[164:167], a[108:111], a[136:139], v[164:167]
 s_waitcnt lgkmcnt(12)
 v_mfma_f32_16x16x32_bf16 v[116:119], a[112:115], v[96:99], v[116:119]
 ds_read_b64_tr_b16 a[176:177], v6 offset:50720
 ds_read_b64_tr_b16 a[178:179], v6 offset:50848
 v_mfma_f32_16x16x32_bf16 v[116:119], a[116:119], v[112:115], v[116:119]
 s_waitcnt lgkmcnt(10)
 v_mfma_f32_16x16x32_bf16 v[116:119], a[120:123], v[128:131], v[116:119]
 v_mfma_f32_16x16x32_bf16 v[116:119], a[124:127], v[144:147], v[116:119]
 ds_read_b64_tr_b16 a[180:181], v6 offset:50976
 ds_read_b64_tr_b16 a[182:183], v6 offset:51104
 v_mfma_f32_16x16x32_bf16 v[124:127], a[124:127], v[152:155], v[124:127]
 v_mfma_f32_16x16x32_bf16 v[124:127], a[120:123], v[136:139], v[124:127]
 v_mfma_f32_16x16x32_bf16 v[124:127], a[116:119], v[120:123], v[124:127]
 ds_read_b64_tr_b16 a[184:185], v8 offset:50720
 ds_read_b64_tr_b16 a[186:187], v8 offset:50848
 v_mfma_f32_16x16x32_bf16 v[124:127], a[112:115], v[104:107], v[124:127]
 v_mfma_f32_16x16x32_bf16 v[172:175], a[112:115], v[224:227], v[172:175]
 v_mfma_f32_16x16x32_bf16 v[172:175], a[116:119], v[232:235], v[172:175]
 ds_read_b64_tr_b16 a[188:189], v8 offset:50976
 ds_read_b64_tr_b16 a[190:191], v8 offset:51104
 v_mfma_f32_16x16x32_bf16 v[172:175], a[120:123], a[128:131], v[172:175]
 v_mfma_f32_16x16x32_bf16 v[172:175], a[124:127], a[136:139], v[172:175]
 s_waitcnt lgkmcnt(12)
 v_mfma_f32_16x16x32_bf16 v[100:103], a[160:163], v[160:163], v[100:103]
 ds_read_b64_tr_b16 a[96:97], v7 offset:0
 ds_read_b64_tr_b16 a[98:99], v7 offset:128
 v_mfma_f32_16x16x32_bf16 v[100:103], a[164:167], v[176:179], v[100:103]
 s_waitcnt lgkmcnt(10)
 v_mfma_f32_16x16x32_bf16 v[100:103], a[168:171], v[192:195], v[100:103]
 s_add_u32 s56, s100, 0x1dc000
 v_mfma_f32_16x16x32_bf16 v[100:103], a[172:175], v[208:211], v[100:103]
 s_add_u32 m0, s40, 0x22c00
 ds_read_b64_tr_b16 a[100:101], v7 offset:256
 ds_read_b64_tr_b16 a[102:103], v7 offset:384
 v_mfma_f32_16x16x32_bf16 v[108:111], a[172:175], v[216:219], v[108:111]
 buffer_load_dwordx4 v17, s[28:31], s56 offen offset:0 lds
 v_mfma_f32_16x16x32_bf16 v[108:111], a[168:171], v[200:203], v[108:111]
 v_mfma_f32_16x16x32_bf16 v[108:111], a[164:167], v[184:187], v[108:111]
 ds_read_b64_tr_b16 a[104:105], v9 offset:0
 ds_read_b64_tr_b16 a[106:107], v9 offset:128
 v_mfma_f32_16x16x32_bf16 v[108:111], a[160:163], v[168:171], v[108:111]
 v_mfma_f32_16x16x32_bf16 v[164:167], a[160:163], v[240:243], v[164:167]
 v_mfma_f32_16x16x32_bf16 v[164:167], a[164:167], v[248:251], v[164:167]
 ds_read_b64_tr_b16 a[108:109], v9 offset:256
 ds_read_b64_tr_b16 a[110:111], v9 offset:384
 v_mfma_f32_16x16x32_bf16 v[164:167], a[168:171], a[144:147], v[164:167]
 v_mfma_f32_16x16x32_bf16 v[164:167], a[172:175], a[152:155], v[164:167]
 s_waitcnt lgkmcnt(12)
 v_mfma_f32_16x16x32_bf16 v[116:119], a[176:179], v[160:163], v[116:119]
 ds_read_b64_tr_b16 a[112:113], v7 offset:32
 ds_read_b64_tr_b16 a[114:115], v7 offset:160
 v_mfma_f32_16x16x32_bf16 v[116:119], a[180:183], v[176:179], v[116:119]
 s_waitcnt lgkmcnt(10)
 v_mfma_f32_16x16x32_bf16 v[116:119], a[184:187], v[192:195], v[116:119]
 v_mfma_f32_16x16x32_bf16 v[116:119], a[188:191], v[208:211], v[116:119]
 ds_read_b64_tr_b16 a[116:117], v7 offset:288
 ds_read_b64_tr_b16 a[118:119], v7 offset:416
 v_mfma_f32_16x16x32_bf16 v[124:127], a[188:191], v[216:219], v[124:127]
 v_mfma_f32_16x16x32_bf16 v[124:127], a[184:187], v[200:203], v[124:127]
 s_add_u32 m0, s40, 0x22ca0
 v_mfma_f32_16x16x32_bf16 v[124:127], a[180:183], v[184:187], v[124:127]
 ds_read_b64_tr_b16 a[120:121], v9 offset:32
 ds_read_b64_tr_b16 a[122:123], v9 offset:160
 v_mfma_f32_16x16x32_bf16 v[124:127], a[176:179], v[168:171], v[124:127]
 buffer_load_dwordx4 v17, s[28:31], s56 offen offset:896 lds
 v_mfma_f32_16x16x32_bf16 v[172:175], a[176:179], v[240:243], v[172:175]
 v_mfma_f32_16x16x32_bf16 v[172:175], a[180:183], v[248:251], v[172:175]
 ds_read_b64_tr_b16 a[124:125], v9 offset:288
 ds_read_b64_tr_b16 a[126:127], v9 offset:416
 v_mfma_f32_16x16x32_bf16 v[172:175], a[184:187], a[144:147], v[172:175]
 buffer_load_dword v29, v28, s[36:39], 0 offen offset:0 sc1
 v_mfma_f32_16x16x32_bf16 v[172:175], a[188:191], a[152:155], v[172:175]
 s_waitcnt lgkmcnt(12)
 v_mfma_f32_16x16x32_bf16 v[132:135], a[96:99], a[192:195], 0
 ds_read_b64_tr_b16 a[160:161], v7 offset:16896
 ds_read_b64_tr_b16 a[162:163], v7 offset:17024
 v_mfma_f32_16x16x32_bf16 v[132:135], a[100:103], a[200:203], v[132:135]
 s_waitcnt lgkmcnt(10)
 v_mfma_f32_16x16x32_bf16 v[132:135], a[104:107], a[208:211], v[132:135]
 ds_read_b64_tr_b16 a[164:165], v7 offset:17152
 ds_read_b64_tr_b16 a[166:167], v7 offset:17280
 v_mfma_f32_16x16x32_bf16 v[132:135], a[108:111], a[216:219], v[132:135]
 s_add_u32 s55, s10, 0x50000
 v_cvt_pk_bf16_f32 v100, v100, v101
 v_cvt_pk_bf16_f32 v101, v102, v103
 v_mfma_f32_16x16x32_bf16 v[140:143], a[108:111], a[220:223], 0
 ds_read_b64_tr_b16 a[168:169], v9 offset:16896
 ds_read_b64_tr_b16 a[170:171], v9 offset:17024
 v_mfma_f32_16x16x32_bf16 v[140:143], a[104:107], a[212:215], v[140:143]
 v_cvt_pk_bf16_f32 v102, v116, v117
 v_cvt_pk_bf16_f32 v103, v118, v119
 v_mfma_f32_16x16x32_bf16 v[140:143], a[100:103], a[204:207], v[140:143]
 ds_read_b64_tr_b16 a[172:173], v9 offset:17152
 ds_read_b64_tr_b16 a[174:175], v9 offset:17280
 v_mfma_f32_16x16x32_bf16 v[140:143], a[96:99], a[196:199], v[140:143]
 s_waitcnt lgkmcnt(12)
 buffer_store_dwordx4 v[100:103], v1, s[24:27], s55 offen offset:0 sc1
 v_mfma_f32_16x16x32_bf16 v[148:151], a[112:115], a[192:195], 0
 ds_read_b64_tr_b16 a[176:177], v7 offset:16928
 ds_read_b64_tr_b16 a[178:179], v7 offset:17056
 v_mfma_f32_16x16x32_bf16 v[148:151], a[116:119], a[200:203], v[148:151]
 s_waitcnt lgkmcnt(10)
 v_mfma_f32_16x16x32_bf16 v[148:151], a[120:123], a[208:211], v[148:151]
 s_add_u32 m0, s40, 0x22d40
 ds_read_b64_tr_b16 a[180:181], v7 offset:17184
 ds_read_b64_tr_b16 a[182:183], v7 offset:17312
 v_mfma_f32_16x16x32_bf16 v[148:151], a[124:127], a[216:219], v[148:151]
 s_add_u32 s55, s11, 0x52000
 buffer_load_dwordx4 v17, s[28:31], s56 offen offset:1792 lds
 v_cvt_pk_bf16_f32 v108, v108, v109
 v_mfma_f32_16x16x32_bf16 v[156:159], a[124:127], a[220:223], 0
 ds_read_b64_tr_b16 a[184:185], v9 offset:16928
 ds_read_b64_tr_b16 a[186:187], v9 offset:17056
 v_mfma_f32_16x16x32_bf16 v[156:159], a[120:123], a[212:215], v[156:159]
 v_cvt_pk_bf16_f32 v109, v110, v111
 v_cvt_pk_bf16_f32 v110, v124, v125
 v_mfma_f32_16x16x32_bf16 v[156:159], a[116:119], a[204:207], v[156:159]
 ds_read_b64_tr_b16 a[188:189], v9 offset:17184
 ds_read_b64_tr_b16 a[190:191], v9 offset:17312
 v_mfma_f32_16x16x32_bf16 v[156:159], a[112:115], a[196:199], v[156:159]
 s_waitcnt lgkmcnt(12)
 v_cvt_pk_bf16_f32 v111, v126, v127
 v_mfma_f32_16x16x32_bf16 v[132:135], a[160:163], a[224:227], v[132:135]
 ds_read_b64_tr_b16 a[96:97], v7 offset:33792
 ds_read_b64_tr_b16 a[98:99], v7 offset:33920
 v_mfma_f32_16x16x32_bf16 v[132:135], a[164:167], a[232:235], v[132:135]
 s_waitcnt lgkmcnt(10)
 buffer_store_dwordx4 v[108:111], v1, s[24:27], s55 offen offset:0 sc1
 v_cvt_pk_bf16_f32 v164, v164, v165
 v_mfma_f32_16x16x32_bf16 v[132:135], a[168:171], a[240:243], v[132:135]
 s_add_u32 s55, s12, 0x54000
 ds_read_b64_tr_b16 a[100:101], v7 offset:34048
 ds_read_b64_tr_b16 a[102:103], v7 offset:34176
 v_mfma_f32_16x16x32_bf16 v[132:135], a[172:175], a[248:251], v[132:135]
 v_cvt_pk_bf16_f32 v165, v166, v167
 v_cvt_pk_bf16_f32 v166, v172, v173
 v_mfma_f32_16x16x32_bf16 v[140:143], a[172:175], a[252:255], v[140:143]
 ds_read_b64_tr_b16 a[104:105], v9 offset:33792
 ds_read_b64_tr_b16 a[106:107], v9 offset:33920
 v_mfma_f32_16x16x32_bf16 v[140:143], a[168:171], a[244:247], v[140:143]
 s_cmp_eq_u32 s59, 2
 s_cselect_b64 vcc, -1, 0
 v_cvt_pk_bf16_f32 v167, v174, v175
 v_mfma_f32_16x16x32_bf16 v[140:143], a[164:167], a[236:239], v[140:143]
L_pad22:
 s_cbranch_execz L_e4_back
 ds_read_b64_tr_b16 a[108:109], v9 offset:34048
 ds_read_b64_tr_b16 a[110:111], v9 offset:34176
 v_mfma_f32_16x16x32_bf16 v[140:143], a[160:163], a[228:231], v[140:143]
 s_waitcnt lgkmcnt(12)
 buffer_store_dwordx4 v[164:167], v1, s[24:27], s55 offen offset:0 sc1
 v_cndmask_b32 v32, v32, v100, vcc
 v_mfma_f32_16x16x32_bf16 v[148:151], a[176:179], a[224:227], v[148:151]
 ds_read_b64_tr_b16 a[112:113], v7 offset:33824
 ds_read_b64_tr_b16 a[114:115], v7 offset:33952
 v_mfma_f32_16x16x32_bf16 v[148:151], a[180:183], a[232:235], v[148:151]
 s_waitcnt lgkmcnt(10)
 v_cndmask_b32 v33, v33, v101, vcc
 v_cndmask_b32 v34, v34, v102, vcc
 v_mfma_f32_16x16x32_bf16 v[148:151], a[184:187], a[240:243], v[148:151]
 ds_read_b64_tr_b16 a[116:117], v7 offset:34080
 ds_read_b64_tr_b16 a[118:119], v7 offset:34208
 v_mfma_f32_16x16x32_bf16 v[148:151], a[188:191], a[248:251], v[148:151]
 s_add_u32 m0, s40, 0x22de0
 v_cndmask_b32 v35, v35, v103, vcc
 v_mfma_f32_16x16x32_bf16 v[156:159], a[188:191], a[252:255], v[156:159]
 ds_read_b64_tr_b16 a[120:121], v9 offset:33824
 ds_read_b64_tr_b16 a[122:123], v9 offset:33952
 v_mfma_f32_16x16x32_bf16 v[156:159], a[184:187], a[244:247], v[156:159]
 s_cmp_eq_u32 s59, 3
 s_cselect_b64 vcc, -1, 0
 buffer_load_dwordx4 v17, s[28:31], s56 offen offset:2688 lds
 v_mfma_f32_16x16x32_bf16 v[156:159], a[180:183], a[236:239], v[156:159]
 s_add_u32 s100, s100, 0x80
 ds_read_b64_tr_b16 a[124:125], v9 offset:34080
 ds_read_b64_tr_b16 a[126:127], v9 offset:34208
 v_mfma_f32_16x16x32_bf16 v[156:159], a[176:179], a[228:231], v[156:159]
 s_waitcnt lgkmcnt(12)
 v_cndmask_b32 v32, v32, v108, vcc
 v_cndmask_b32 v33, v33, v109, vcc
 v_mfma_f32_16x16x32_bf16 v[132:135], a[96:99], v[96:99], v[132:135]
 s_sub_u32 s56, s100, 0x380
 ds_read_b64_tr_b16 a[160:161], v7 offset:50688
 ds_read_b64_tr_b16 a[162:163], v7 offset:50816
 v_mfma_f32_16x16x32_bf16 v[132:135], a[100:103], v[112:115], v[132:135]
 s_waitcnt lgkmcnt(10)
 v_cndmask_b32 v34, v34, v110, vcc
 v_cndmask_b32 v35, v35, v111, vcc
 v_mfma_f32_16x16x32_bf16 v[132:135], a[104:107], v[128:131], v[132:135]
 s_min_u32 s100, s100, s56
 ds_read_b64_tr_b16 a[164:165], v7 offset:50944
 ds_read_b64_tr_b16 a[166:167], v7 offset:51072
 v_mfma_f32_16x16x32_bf16 v[132:135], a[108:111], v[144:147], v[132:135]
 s_cmp_eq_u32 s59, 4
 s_cselect_b64 vcc, -1, 0
 v_cndmask_b32 v32, v32, v164, vcc
 v_mfma_f32_16x16x32_bf16 v[140:143], a[108:111], v[152:155], v[140:143]
 ds_read_b64_tr_b16 a[168:169], v9 offset:50688
 ds_read_b64_tr_b16 a[170:171], v9 offset:50816
 v_mfma_f32_16x16x32_bf16 v[140:143], a[104:107], v[136:139], v[140:143]
 v_cndmask_b32 v33, v33, v165, vcc
 v_cndmask_b32 v34, v34, v166, vcc
 v_mfma_f32_16x16x32_bf16 v[140:143], a[100:103], v[120:123], v[140:143]
 ds_read_b64_tr_b16 a[172:173], v9 offset:50944
 ds_read_b64_tr_b16 a[174:175], v9 offset:51072
 v_mfma_f32_16x16x32_bf16 v[140:143], a[96:99], v[104:107], v[140:143]
 s_waitcnt lgkmcnt(12)
 v_cndmask_b32 v35, v35, v167, vcc
 v_mfma_f32_16x16x32_bf16 v[148:151], a[112:115], v[96:99], v[148:151]
 ds_read_b64_tr_b16 a[176:177], v7 offset:50720
 ds_read_b64_tr_b16 a[178:179], v7 offset:50848
 v_mfma_f32_16x16x32_bf16 v[148:151], a[116:119], v[112:115], v[148:151]
 s_waitcnt lgkmcnt(10)
 v_mfma_f32_16x16x32_bf16 v[148:151], a[120:123], v[128:131], v[148:151]
 ds_read_b64_tr_b16 a[180:181], v7 offset:50976
 ds_read_b64_tr_b16 a[182:183], v7 offset:51104
 v_mfma_f32_16x16x32_bf16 v[148:151], a[124:127], v[144:147], v[148:151]
 v_mfma_f32_16x16x32_bf16 v[156:159], a[124:127], v[152:155], v[156:159]
 ds_read_b64_tr_b16 a[184:185], v9 offset:50720
 ds_read_b64_tr_b16 a[186:187], v9 offset:50848
 v_mfma_f32_16x16x32_bf16 v[156:159], a[120:123], v[136:139], v[156:159]
 v_mfma_f32_16x16x32_bf16 v[156:159], a[116:119], v[120:123], v[156:159]
 ds_read_b64_tr_b16 a[188:189], v9 offset:50976
 ds_read_b64_tr_b16 a[190:191], v9 offset:51104
 v_mfma_f32_16x16x32_bf16 v[156:159], a[112:115], v[104:107], v[156:159]
 s_waitcnt lgkmcnt(12)
 v_mfma_f32_16x16x32_bf16 v[132:135], a[160:163], v[160:163], v[132:135]
 s_waitcnt vmcnt(13)
 s_barrier
 ds_read_b64_tr_b16 a[96:97], v2 offset:0
 ds_read_b64_tr_b16 a[98:99], v2 offset:128
 v_mfma_f32_16x16x32_bf16 v[132:135], a[164:167], v[176:179], v[132:135]
 s_waitcnt lgkmcnt(10) vmcnt(5)
 v_readfirstlane_b32 s50, v29
 s_bitcmp0_b32 s50, 3
 s_cbranch_scc1 L_poll0
L_poll0_ret:
 v_mfma_f32_16x16x32_bf16 v[132:135], a[168:171], v[192:195], v[132:135]
 s_add_u32 s56, s100, 0
 ds_read_b64_tr_b16 a[100:101], v2 offset:256
 ds_read_b64_tr_b16 a[102:103], v2 offset:384
 v_mfma_f32_16x16x32_bf16 v[132:135], a[172:175], v[208:211], v[132:135]
 s_add_u32 m0, s40, 0
 buffer_load_dwordx4 a[0:3], v1, s[24:27], s64 offen offset:0 sc1
 v_mfma_f32_16x16x32_bf16 v[140:143], a[172:175], v[216:219], v[140:143]
 ds_read_b64_tr_b16 a[104:105], v4 offset:0
 ds_read_b64_tr_b16 a[106:107], v4 offset:128
 v_mfma_f32_16x16x32_bf16 v[140:143], a[168:171], v[200:203], v[140:143]
 buffer_load_dwordx4 v17, s[28:31], s56 offen offset:0 lds
 v_mfma_f32_16x16x32_bf16 v[140:143], a[164:167], v[184:187], v[140:143]
 s_add_u32 m0, s40, 0xa0
 ds_read_b64_tr_b16 a[108:109], v4 offset:256
 ds_read_b64_tr_b16 a[110:111], v4 offset:384
 v_mfma_f32_16x16x32_bf16 v[140:143], a[160:163], v[168:171], v[140:143]
 s_waitcnt lgkmcnt(12)
 buffer_load_dwordx4 v17, s[28:31], s56 offen offset:896 lds
 v_mfma_f32_16x16x32_bf16 v[148:151], a[176:179], v[160:163], v[148:151]
 ds_read_b64_tr_b16 a[112:113], v2 offset:32
 ds_read_b64_tr_b16 a[114:115], v2 offset:160
 v_mfma_f32_16x16x32_bf16 v[148:151], a[180:183], v[176:179], v[148:151]
 s_waitcnt lgkmcnt(10)
 v_mfma_f32_16x16x32_bf16 v[148:151], a[184:187], v[192:195], v[148:151]
 s_add_u32 m0, s40, 0x140
 ds_read_b64_tr_b16 a[116:117], v2 offset:288
 ds_read_b64_tr_b16 a[118:119], v2 offset:416
 v_mfma_f32_16x16x32_bf16 v[148:151], a[188:191], v[208:211], v[148:151]
 buffer_load_dwordx4 v17, s[28:31], s56 offen offset:1792 lds
 v_mfma_f32_16x16x32_bf16 v[156:159], a[188:191], v[216:219], v[156:159]
 ds_read_b64_tr_b16 a[120:121], v4 offset:32
 ds_read_b64_tr_b16 a[122:123], v4 offset:160
 v_mfma_f32_16x16x32_bf16 v[156:159], a[184:187], v[200:203], v[156:159]
 v_mfma_f32_16x16x32_bf16 v[156:159], a[180:183], v[184:187], v[156:159]
 s_add_u32 m0, s40, 0x1e0
 ds_read_b64_tr_b16 a[124:125], v4 offset:288
 ds_read_b64_tr_b16 a[126:127], v4 offset:416
 v_mfma_f32_16x16x32_bf16 v[156:159], a[176:179], v[168:171], v[156:159]
 s_waitcnt lgkmcnt(12)
 buffer_load_dwordx4 v17, s[28:31], s56 offen offset:2688 lds
 v_mfma_f32_16x16x32_bf16 v[180:183], a[96:99], a[192:195], 0
 ds_read_b64_tr_b16 a[160:161], v2 offset:16896
 ds_read_b64_tr_b16 a[162:163], v2 offset:17024
 v_mfma_f32_16x16x32_bf16 v[180:183], a[100:103], a[200:203], v[180:183]
 s_waitcnt lgkmcnt(10)
 v_mfma_f32_16x16x32_bf16 v[180:183], a[104:107], a[208:211], v[180:183]
 s_add_u32 s56, s100, 0x1c000
 buffer_load_dwordx4 a[4:7], v1, s[24:27], s64 offen offset:1024 sc1
 v_mfma_f32_16x16x32_bf16 v[180:183], a[108:111], a[216:219], v[180:183]
 s_add_u32 m0, s40, 0x4200
 ds_read_b64_tr_b16 a[164:165], v2 offset:17152
 ds_read_b64_tr_b16 a[166:167], v2 offset:17280
 v_mfma_f32_16x16x32_bf16 v[188:191], a[108:111], a[220:223], 0
 s_add_u32 s55, s13, 0x56000
 buffer_load_dwordx4 v17, s[28:31], s56 offen offset:0 lds
 v_cvt_pk_bf16_f32 v132, v132, v133
 v_mfma_f32_16x16x32_bf16 v[188:191], a[104:107], a[212:215], v[188:191]
 v_cvt_pk_bf16_f32 v133, v134, v135
 v_cvt_pk_bf16_f32 v134, v148, v149
 v_mfma_f32_16x16x32_bf16 v[188:191], a[100:103], a[204:207], v[188:191]
 s_add_u32 m0, s40, 0x42a0
 ds_read_b64_tr_b16 a[168:169], v4 offset:16896
 ds_read_b64_tr_b16 a[170:171], v4 offset:17024
 v_mfma_f32_16x16x32_bf16 v[188:191], a[96:99], a[196:199], v[188:191]
 buffer_load_dwordx4 v17, s[28:31], s56 offen offset:896 lds
 v_cvt_pk_bf16_f32 v135, v150, v151
 v_mfma_f32_16x16x32_bf16 v[52:55], a[96:99], v[80:83], 0
 s_cmp_eq_u32 s59, 5
 s_cselect_b64 vcc, -1, 0
 buffer_store_dwordx4 v[132:135], v1, s[24:27], s55 offen offset:0 sc1
 v_mfma_f32_16x16x32_bf16 v[52:55], a[100:103], v[84:87], v[52:55]
 ds_read_b64_tr_b16 a[172:173], v4 offset:17152
 ds_read_b64_tr_b16 a[174:175], v4 offset:17280
 v_mfma_f32_16x16x32_bf16 v[52:55], a[104:107], v[228:231], v[52:55]
 s_add_u32 s55, s14, 0x58000
 v_cvt_pk_bf16_f32 v140, v140, v141
 v_cvt_pk_bf16_f32 v141, v142, v143
 v_mfma_f32_16x16x32_bf16 v[52:55], a[108:111], v[236:239], v[52:55]
 s_waitcnt lgkmcnt(12)
 v_cvt_pk_bf16_f32 v142, v156, v157
 v_cvt_pk_bf16_f32 v143, v158, v159
 v_mfma_f32_16x16x32_bf16 v[196:199], a[112:115], a[192:195], 0
 s_add_u32 m0, s40, 0x4340
 ds_read_b64_tr_b16 a[176:177], v2 offset:16928
 ds_read_b64_tr_b16 a[178:179], v2 offset:17056
 v_mfma_f32_16x16x32_bf16 v[196:199], a[116:119], a[200:203], v[196:199]
 s_waitcnt lgkmcnt(10)
 buffer_load_dwordx4 v17, s[28:31], s56 offen offset:1792 lds
 buffer_store_dwordx4 v[140:143], v1, s[24:27], s55 offen offset:0 sc1
 v_mfma_f32_16x16x32_bf16 v[196:199], a[120:123], a[208:211], v[196:199]
 v_cndmask_b32 v32, v32, v132, vcc
 v_cndmask_b32 v33, v33, v133, vcc
 v_mfma_f32_16x16x32_bf16 v[196:199], a[124:127], a[216:219], v[196:199]
 s_add_u32 m0, s40, 0x43e0
 ds_read_b64_tr_b16 a[180:181], v2 offset:17184
 ds_read_b64_tr_b16 a[182:183], v2 offset:17312
 v_mfma_f32_16x16x32_bf16 v[212:215], a[124:127], a[220:223], 0
 buffer_load_dwordx4 v17, s[28:31], s56 offen offset:2688 lds
 v_cndmask_b32 v34, v34, v134, vcc
 v_mfma_f32_16x16x32_bf16 v[212:215], a[120:123], a[212:215], v[212:215]
 v_cndmask_b32 v35, v35, v135, vcc
 v_mfma_f32_16x16x32_bf16 v[212:215], a[116:119], a[204:207], v[212:215]
 ds_read_b64_tr_b16 a[184:185], v4 offset:16928
 ds_read_b64_tr_b16 a[186:187], v4 offset:17056
 v_mfma_f32_16x16x32_bf16 v[212:215], a[112:115], a[196:199], v[212:215]
 s_cmp_eq_u32 s59, 6
 s_cselect_b64 vcc, -1, 0
 buffer_load_dwordx4 a[8:11], v1, s[24:27], s64 offen offset:2048 sc1
 v_mfma_f32_16x16x32_bf16 v[56:59], a[112:115], v[80:83], 0
 v_cndmask_b32 v32, v32, v140, vcc
 v_cndmask_b32 v33, v33, v141, vcc
 v_mfma_f32_16x16x32_bf16 v[56:59], a[116:119], v[84:87], v[56:59]
 ds_read_b64_tr_b16 a[188:189], v4 offset:17184
 ds_read_b64_tr_b16 a[190:191], v4 offset:17312
 v_mfma_f32_16x16x32_bf16 v[56:59], a[120:123], v[228:231], v[56:59]
 v_cndmask_b32 v34, v34, v142, vcc
 v_cndmask_b32 v35, v35, v143, vcc
 v_mfma_f32_16x16x32_bf16 v[56:59], a[124:127], v[236:239], v[56:59]
 s_waitcnt lgkmcnt(12)
 v_mfma_f32_16x16x32_bf16 v[180:183], a[160:163], a[224:227], v[180:183]
 s_waitcnt vmcnt(13)
 s_barrier
 ds_read_b64_tr_b16 a[96:97], v2 offset:33792
 ds_read_b64_tr_b16 a[98:99], v2 offset:33920
 v_mfma_f32_16x16x32_bf16 v[180:183], a[164:167], a[232:235], v[180:183]
 s_waitcnt lgkmcnt(10)
 v_mfma_f32_16x16x32_bf16 v[180:183], a[168:171], a[240:243], v[180:183]
 s_add_u32 s56, s100, 0x1c0000
 v_mfma_f32_16x16x32_bf16 v[180:183], a[172:175], a[248:251], v[180:183]
 s_add_u32 m0, s40, 0x8400
 ds_read_b64_tr_b16 a[100:101], v2 offset:34048
 ds_read_b64_tr_b16 a[102:103], v2 offset:34176
 v_mfma_f32_16x16x32_bf16 v[188:191], a[172:175], a[252:255], v[188:191]
 buffer_load_dwordx4 v17, s[28:31], s56 offen offset:0 lds
 v_mfma_f32_16x16x32_bf16 v[188:191], a[168:171], a[244:247], v[188:191]
 v_mfma_f32_16x16x32_bf16 v[188:191], a[164:167], a[236:239], v[188:191]
 ds_read_b64_tr_b16 a[104:105], v4 offset:33792
 ds_read_b64_tr_b16 a[106:107], v4 offset:33920
 v_mfma_f32_16x16x32_bf16 v[188:191], a[160:163], a[228:231], v[188:191]
 v_mfma_f32_16x16x32_bf16 v[52:55], a[160:163], v[88:91], v[52:55]
 v_mfma_f32_16x16x32_bf16 v[52:55], a[164:167], v[92:95], v[52:55]
 ds_read_b64_tr_b16 a[108:109], v4 offset:34048
 ds_read_b64_tr_b16 a[110:111], v4 offset:34176
 v_mfma_f32_16x16x32_bf16 v[52:55], a[168:171], v[244:247], v[52:55]
 buffer_load_dwordx4 a[12:15], v1, s[24:27], s64 offen offset:3072 sc1
 v_mfma_f32_16x16x32_bf16 v[52:55], a[172:175], v[252:255], v[52:55]
 s_waitcnt lgkmcnt(12)
 v_mfma_f32_16x16x32_bf16 v[196:199], a[176:179], a[224:227], v[196:199]
 s_add_u32 m0, s40, 0x84a0
 ds_read_b64_tr_b16 a[112:113], v2 offset:33824
 ds_read_b64_tr_b16 a[114:115], v2 offset:33952
 v_mfma_f32_16x16x32_bf16 v[196:199], a[180:183], a[232:235], v[196:199]
 s_waitcnt lgkmcnt(10)
 buffer_load_dwordx4 v17, s[28:31], s56 offen offset:896 lds
 v_mfma_f32_16x16x32_bf16 v[196:199], a[184:187], a[240:243], v[196:199]
 v_mfma_f32_16x16x32_bf16 v[196:199], a[188:191], a[248:251], v[196:199]
 ds_read_b64_tr_b16 a[116:117], v2 offset:34080
 ds_read_b64_tr_b16 a[118:119], v2 offset:34208
 v_mfma_f32_16x16x32_bf16 v[212:215], a[188:191], a[252:255], v[212:215]
 v_mfma_f32_16x16x32_bf16 v[212:215], a[184:187], a[244:247], v[212:215]
 v_mfma_f32_16x16x32_bf16 v[212:215], a[180:183], a[236:239], v[212:215]
 ds_read_b64_tr_b16 a[120:121], v4 offset:33824
 ds_read_b64_tr_b16 a[122:123], v4 offset:33952
 v_mfma_f32_16x16x32_bf16 v[212:215], a[176:179], a[228:231], v[212:215]
 v_mfma_f32_16x16x32_bf16 v[56:59], a[176:179], v[88:91], v[56:59]
 v_mfma_f32_16x16x32_bf16 v[56:59], a[180:183], v[92:95], v[56:59]
 ds_read_b64_tr_b16 a[124:125], v4 offset:34080
 ds_read_b64_tr_b16 a[126:127], v4 offset:34208
 v_mfma_f32_16x16x32_bf16 v[56:59], a[184:187], v[244:247], v[56:59]
 s_add_u32 m0, s40, 0x8540
 v_mfma_f32_16x16x32_bf16 v[56:59], a[188:191], v[252:255], v[56:59]
 s_waitcnt lgkmcnt(12)
 buffer_load_dwordx4 v17, s[28:31], s56 offen offset:1792 lds
 v_mfma_f32_16x16x32_bf16 v[180:183], a[96:99], v[96:99], v[180:183]
 ds_read_b64_tr_b16 a[160:161], v2 offset:50688
 ds_read_b64_tr_b16 a[162:163], v2 offset:50816
 v_mfma_f32_16x16x32_bf16 v[180:183], a[100:103], v[112:115], v[180:183]
 s_waitcnt lgkmcnt(10)
 v_mfma_f32_16x16x32_bf16 v[180:183], a[104:107], v[128:131], v[180:183]
 buffer_load_dwordx4 a[16:19], v18, s[24:27], s64 offen offset:0 sc1
 v_mfma_f32_16x16x32_bf16 v[180:183], a[108:111], v[144:147], v[180:183]
 ds_read_b64_tr_b16 a[164:165], v2 offset:50944
 ds_read_b64_tr_b16 a[166:167], v2 offset:51072
 v_mfma_f32_16x16x32_bf16 v[188:191], a[108:111], v[152:155], v[188:191]
 v_mfma_f32_16x16x32_bf16 v[188:191], a[104:107], v[136:139], v[188:191]
 v_mfma_f32_16x16x32_bf16 v[188:191], a[100:103], v[120:123], v[188:191]
 ds_read_b64_tr_b16 a[168:169], v4 offset:50688
 ds_read_b64_tr_b16 a[170:171], v4 offset:50816
 v_mfma_f32_16x16x32_bf16 v[188:191], a[96:99], v[104:107], v[188:191]
 v_mfma_f32_16x16x32_bf16 v[52:55], a[96:99], v[224:227], v[52:55]
 v_mfma_f32_16x16x32_bf16 v[52:55], a[100:103], v[232:235], v[52:55]
 s_add_u32 m0, s40, 0x85e0
 ds_read_b64_tr_b16 a[172:173], v4 offset:50944
 ds_read_b64_tr_b16 a[174:175], v4 offset:51072
 v_mfma_f32_16x16x32_bf16 v[52:55], a[104:107], a[128:131], v[52:55]
 buffer_load_dwordx4 v17, s[28:31], s56 offen offset:2688 lds
 v_mfma_f32_16x16x32_bf16 v[52:55], a[108:111], a[136:139], v[52:55]
 s_waitcnt lgkmcnt(12)
 v_mfma_f32_16x16x32_bf16 v[196:199], a[112:115], v[96:99], v[196:199]
 ds_read_b64_tr_b16 a[176:177], v2 offset:50720
 ds_read_b64_tr_b16 a[178:179], v2 offset:50848
 v_mfma_f32_16x16x32_bf16 v[196:199], a[116:119], v[112:115], v[196:199]
 s_waitcnt lgkmcnt(10)
 v_mfma_f32_16x16x32_bf16 v[196:199], a[120:123], v[128:131], v[196:199]
 v_mfma_f32_16x16x32_bf16 v[196:199], a[124:127], v[144:147], v[196:199]
 ds_read_b64_tr_b16 a[180:181], v2 offset:50976
 ds_read_b64_tr_b16 a[182:183], v2 offset:51104
 v_mfma_f32_16x16x32_bf16 v[212:215], a[124:127], v[152:155], v[212:215]
 v_mfma_f32_16x16x32_bf16 v[212:215], a[120:123], v[136:139], v[212:215]
 v_mfma_f32_16x16x32_bf16 v[212:215], a[116:119], v[120:123], v[212:215]
 ds_read_b64_tr_b16 a[184:185], v4 offset:50720
 ds_read_b64_tr_b16 a[186:187], v4 offset:50848
 v_mfma_f32_16x16x32_bf16 v[212:215], a[112:115], v[104:107], v[212:215]
 buffer_load_dwordx4 a[20:23], v18, s[24:27], s64 offen offset:1024 sc1
 v_mfma_f32_16x16x32_bf16 v[56:59], a[112:115], v[224:227], v[56:59]
 v_mfma_f32_16x16x32_bf16 v[56:59], a[116:119], v[232:235], v[56:59]
 ds_read_b64_tr_b16 a[188:189], v4 offset:50976
 ds_read_b64_tr_b16 a[190:191], v4 offset:51104
 v_mfma_f32_16x16x32_bf16 v[56:59], a[120:123], a[128:131], v[56:59]
 v_mfma_f32_16x16x32_bf16 v[56:59], a[124:127], a[136:139], v[56:59]
 s_waitcnt lgkmcnt(12)
 v_mfma_f32_16x16x32_bf16 v[180:183], a[160:163], v[160:163], v[180:183]
 s_waitcnt vmcnt(9)
 s_barrier
 ds_read_b64_tr_b16 a[96:97], v3 offset:0
 ds_read_b64_tr_b16 a[98:99], v3 offset:128
 v_mfma_f32_16x16x32_bf16 v[180:183], a[164:167], v[176:179], v[180:183]
 s_waitcnt lgkmcnt(10)
 v_mov_b32 v11, 16
 v_mfma_f32_16x16x32_bf16 v[180:183], a[168:171], v[192:195], v[180:183]
 s_add_u32 s56, s100, 0x1dc000
 buffer_atomic_add v11, v27, s[36:39], 0 offen
 v_mfma_f32_16x16x32_bf16 v[180:183], a[172:175], v[208:211], v[180:183]
 s_add_u32 m0, s40, 0xc600
 ds_read_b64_tr_b16 a[100:101], v3 offset:256
 ds_read_b64_tr_b16 a[102:103], v3 offset:384
 v_mfma_f32_16x16x32_bf16 v[188:191], a[172:175], v[216:219], v[188:191]
 buffer_load_dwordx4 v17, s[28:31], s56 offen offset:0 lds
 v_mfma_f32_16x16x32_bf16 v[188:191], a[168:171], v[200:203], v[188:191]
 v_mfma_f32_16x16x32_bf16 v[188:191], a[164:167], v[184:187], v[188:191]
 ds_read_b64_tr_b16 a[104:105], v5 offset:0
 ds_read_b64_tr_b16 a[106:107], v5 offset:128
 v_mfma_f32_16x16x32_bf16 v[188:191], a[160:163], v[168:171], v[188:191]
 v_mfma_f32_16x16x32_bf16 v[52:55], a[160:163], v[240:243], v[52:55]
 v_mfma_f32_16x16x32_bf16 v[52:55], a[164:167], v[248:251], v[52:55]
 ds_read_b64_tr_b16 a[108:109], v5 offset:256
 ds_read_b64_tr_b16 a[110:111], v5 offset:384
 v_mfma_f32_16x16x32_bf16 v[52:55], a[168:171], a[144:147], v[52:55]
 buffer_load_dwordx4 a[24:27], v18, s[24:27], s64 offen offset:2048 sc1
 v_mfma_f32_16x16x32_bf16 v[52:55], a[172:175], a[152:155], v[52:55]
 s_waitcnt lgkmcnt(12)
 v_mfma_f32_16x16x32_bf16 v[196:199], a[176:179], v[160:163], v[196:199]
 ds_read_b64_tr_b16 a[112:113], v3 offset:32
 ds_read_b64_tr_b16 a[114:115], v3 offset:160
 v_mfma_f32_16x16x32_bf16 v[196:199], a[180:183], v[176:179], v[196:199]
 s_waitcnt lgkmcnt(10)
 v_mfma_f32_16x16x32_bf16 v[196:199], a[184:187], v[192:195], v[196:199]
 v_mfma_f32_16x16x32_bf16 v[196:199], a[188:191], v[208:211], v[196:199]
 ds_read_b64_tr_b16 a[116:117], v3 offset:288
 ds_read_b64_tr_b16 a[118:119], v3 offset:416
 v_mfma_f32_16x16x32_bf16 v[212:215], a[188:191], v[216:219], v[212:215]
 v_mfma_f32_16x16x32_bf16 v[212:215], a[184:187], v[200:203], v[212:215]
 s_add_u32 m0, s40, 0xc6a0
 v_mfma_f32_16x16x32_bf16 v[212:215], a[180:183], v[184:187], v[212:215]
 ds_read_b64_tr_b16 a[120:121], v5 offset:32
 ds_read_b64_tr_b16 a[122:123], v5 offset:160
 v_mfma_f32_16x16x32_bf16 v[212:215], a[176:179], v[168:171], v[212:215]
 buffer_load_dwordx4 v17, s[28:31], s56 offen offset:896 lds
 v_mfma_f32_16x16x32_bf16 v[56:59], a[176:179], v[240:243], v[56:59]
 v_mfma_f32_16x16x32_bf16 v[56:59], a[180:183], v[248:251], v[56:59]
 ds_read_b64_tr_b16 a[124:125], v5 offset:288
 ds_read_b64_tr_b16 a[126:127], v5 offset:416
 v_mfma_f32_16x16x32_bf16 v[56:59], a[184:187], a[144:147], v[56:59]
 v_mfma_f32_16x16x32_bf16 v[56:59], a[188:191], a[152:155], v[56:59]
 s_waitcnt lgkmcnt(12)
 v_mfma_f32_16x16x32_bf16 v[220:223], a[96:99], a[192:195], 0
 ds_read_b64_tr_b16 a[160:161], v3 offset:16896
 ds_read_b64_tr_b16 a[162:163], v3 offset:17024
 v_mfma_f32_16x16x32_bf16 v[220:223], a[100:103], a[200:203], v[220:223]
 s_waitcnt lgkmcnt(10)
 v_mfma_f32_16x16x32_bf16 v[220:223], a[104:107], a[208:211], v[220:223]
 ds_read_b64_tr_b16 a[164:165], v3 offset:17152
 ds_read_b64_tr_b16 a[166:167], v3 offset:17280
 v_mfma_f32_16x16x32_bf16 v[220:223], a[108:111], a[216:219], v[220:223]
 s_add_u32 s55, s8, 0x78000
 v_cvt_pk_bf16_f32 v180, v180, v181
 v_cvt_pk_bf16_f32 v181, v182, v183
 v_mfma_f32_16x16x32_bf16 v[20:23], a[108:111], a[220:223], 0
 ds_read_b64_tr_b16 a[168:169], v5 offset:16896
 ds_read_b64_tr_b16 a[170:171], v5 offset:17024
 v_mfma_f32_16x16x32_bf16 v[20:23], a[104:107], a[212:215], v[20:23]
 v_cvt_pk_bf16_f32 v182, v196, v197
 v_cvt_pk_bf16_f32 v183, v198, v199
 v_mfma_f32_16x16x32_bf16 v[20:23], a[100:103], a[204:207], v[20:23]
 ds_read_b64_tr_b16 a[172:173], v5 offset:17152
 ds_read_b64_tr_b16 a[174:175], v5 offset:17280
 v_mfma_f32_16x16x32_bf16 v[20:23], a[96:99], a[196:199], v[20:23]
 s_waitcnt lgkmcnt(12)
 buffer_store_dwordx4 v[180:183], v1, s[24:27], s55 offen offset:0 sc1
 v_mov_b32 v36, v180
 v_mfma_f32_16x16x32_bf16 v[44:47], a[112:115], a[192:195], 0
 ds_read_b64_tr_b16 a[176:177], v3 offset:16928
 ds_read_b64_tr_b16 a[178:179], v3 offset:17056
 v_mfma_f32_16x16x32_bf16 v[44:47], a[116:119], a[200:203], v[44:47]
 s_waitcnt lgkmcnt(10)
 v_mov_b32 v37, v181
 v_mov_b32 v38, v182
 v_mfma_f32_16x16x32_bf16 v[44:47], a[120:123], a[208:211], v[44:47]
 s_add_u32 m0, s40, 0xc740
 ds_read_b64_tr_b16 a[180:181], v3 offset:17184
 ds_read_b64_tr_b16 a[182:183], v3 offset:17312
 v_mfma_f32_16x16x32_bf16 v[44:47], a[124:127], a[216:219], v[44:47]
 s_add_u32 s55, s9, 0x7a000
 buffer_load_dwordx4 v17, s[28:31], s56 offen offset:1792 lds
 v_cvt_pk_bf16_f32 v188, v188, v189
 v_mfma_f32_16x16x32_bf16 v[48:51], a[124:127], a[220:223], 0
 ds_read_b64_tr_b16 a[184:185], v5 offset:16928
 ds_read_b64_tr_b16 a[186:187], v5 offset:17056
 v_mfma_f32_16x16x32_bf16 v[48:51], a[120:123], a[212:215], v[48:51]
 v_cvt_pk_bf16_f32 v189, v190, v191
 v_cvt_pk_bf16_f32 v190, v212, v213
 v_mfma_f32_16x16x32_bf16 v[48:51], a[116:119], a[204:207], v[48:51]
 ds_read_b64_tr_b16 a[188:189], v5 offset:17184
 ds_read_b64_tr_b16 a[190:191], v5 offset:17312
 v_mfma_f32_16x16x32_bf16 v[48:51], a[112:115], a[196:199], v[48:51]
 s_waitcnt lgkmcnt(12)
 v_cvt_pk_bf16_f32 v191, v214, v215
 v_mov_b32 v39, v183
 v_mfma_f32_16x16x32_bf16 v[220:223], a[160:163], a[224:227], v[220:223]
 ds_read_b64_tr_b16 a[96:97], v3 offset:33792
 ds_read_b64_tr_b16 a[98:99], v3 offset:33920
 v_mfma_f32_16x16x32_bf16 v[220:223], a[164:167], a[232:235], v[220:223]
 s_waitcnt lgkmcnt(10)
 buffer_store_dwordx4 v[188:191], v1, s[24:27], s55 offen offset:0 sc1
 v_cvt_pk_bf16_f32 v52, v52, v53
 v_mfma_f32_16x16x32_bf16 v[220:223], a[168:171], a[240:243], v[220:223]
 s_add_u32 s55, s10, 0x7c000
 ds_read_b64_tr_b16 a[100:101], v3 offset:34048
 ds_read_b64_tr_b16 a[102:103], v3 offset:34176
 v_mfma_f32_16x16x32_bf16 v[220:223], a[172:175], a[248:251], v[220:223]
 v_cvt_pk_bf16_f32 v53, v54, v55
 v_cvt_pk_bf16_f32 v54, v56, v57
 v_mfma_f32_16x16x32_bf16 v[20:23], a[172:175], a[252:255], v[20:23]
 ds_read_b64_tr_b16 a[104:105], v5 offset:33792
 ds_read_b64_tr_b16 a[106:107], v5 offset:33920
 v_mfma_f32_16x16x32_bf16 v[20:23], a[168:171], a[244:247], v[20:23]
 s_cmp_eq_u32 s59, 1
 s_cselect_b64 vcc, -1, 0
 v_cvt_pk_bf16_f32 v55, v58, v59
 v_mfma_f32_16x16x32_bf16 v[20:23], a[164:167], a[236:239], v[20:23]
 ds_read_b64_tr_b16 a[108:109], v5 offset:34048
 ds_read_b64_tr_b16 a[110:111], v5 offset:34176
 v_mfma_f32_16x16x32_bf16 v[20:23], a[160:163], a[228:231], v[20:23]
 s_waitcnt lgkmcnt(12)
 buffer_store_dwordx4 v[52:55], v1, s[24:27], s55 offen offset:0 sc1
 v_cndmask_b32 v36, v36, v188, vcc
 v_mfma_f32_16x16x32_bf16 v[44:47], a[176:179], a[224:227], v[44:47]
 ds_read_b64_tr_b16 a[112:113], v3 offset:33824
 ds_read_b64_tr_b16 a[114:115], v3 offset:33952
 v_mfma_f32_16x16x32_bf16 v[44:47], a[180:183], a[232:235], v[44:47]
 s_waitcnt lgkmcnt(10)
 v_cndmask_b32 v37, v37, v189, vcc
 v_cndmask_b32 v38, v38, v190, vcc
 v_mfma_f32_16x16x32_bf16 v[44:47], a[184:187], a[240:243], v[44:47]
 ds_read_b64_tr_b16 a[116:117], v3 offset:34080
 ds_read_b64_tr_b16 a[118:119], v3 offset:34208
 v_mfma_f32_16x16x32_bf16 v[44:47], a[188:191], a[248:251], v[44:47]
 s_add_u32 m0, s40, 0xc7e0
 v_cndmask_b32 v39, v39, v191, vcc
 v_mfma_f32_16x16x32_bf16 v[48:51], a[188:191], a[252:255], v[48:51]
 ds_read_b64_tr_b16 a[120:121], v5 offset:33824
 ds_read_b64_tr_b16 a[122:123], v5 offset:33952
 v_mfma_f32_16x16x32_bf16 v[48:51], a[184:187], a[244:247], v[48:51]
 s_cmp_eq_u32 s59, 2
 s_cselect_b64 vcc, -1, 0
 buffer_load_dwordx4 v17, s[28:31], s56 offen offset:2688 lds
 v_mfma_f32_16x16x32_bf16 v[48:51], a[180:183], a[236:239], v[48:51]
 s_add_u32 s100, s100, 0x80
 ds_read_b64_tr_b16 a[124:125], v5 offset:34080
 ds_read_b64_tr_b16 a[126:127], v5 offset:34208
 v_mfma_f32_16x16x32_bf16 v[48:51], a[176:179], a[228:231], v[48:51]
 s_waitcnt lgkmcnt(12)
 v_cndmask_b32 v36, v36, v52, vcc
 v_cndmask_b32 v37, v37, v53, vcc
 v_mfma_f32_16x16x32_bf16 v[220:223], a[96:99], v[96:99], v[220:223]
 s_sub_u32 s56, s100, 0x380
 ds_read_b64_tr_b16 a[160:161], v3 offset:50688
 ds_read_b64_tr_b16 a[162:163], v3 offset:50816
 v_mfma_f32_16x16x32_bf16 v[220:223], a[100:103], v[112:115], v[220:223]
 s_waitcnt lgkmcnt(10)
 v_cndmask_b32 v38, v38, v54, vcc
 v_cndmask_b32 v39, v39, v55, vcc
 v_mfma_f32_16x16x32_bf16 v[220:223], a[104:107], v[128:131], v[220:223]
 s_min_u32 s100, s100, s56
 ds_read_b64_tr_b16 a[164:165], v3 offset:50944
 ds_read_b64_tr_b16 a[166:167], v3 offset:51072
 v_mfma_f32_16x16x32_bf16 v[220:223], a[108:111], v[144:147], v[220:223]
 v_mfma_f32_16x16x32_bf16 v[20:23], a[108:111], v[152:155], v[20:23]
 ds_read_b64_tr_b16 a[168:169], v5 offset:50688
 ds_read_b64_tr_b16 a[170:171], v5 offset:50816
 v_mfma_f32_16x16x32_bf16 v[20:23], a[104:107], v[136:139], v[20:23]
 v_mfma_f32_16x16x32_bf16 v[20:23], a[100:103], v[120:123], v[20:23]
 ds_read_b64_tr_b16 a[172:173], v5 offset:50944
 ds_read_b64_tr_b16 a[174:175], v5 offset:51072
 v_mfma_f32_16x16x32_bf16 v[20:23], a[96:99], v[104:107], v[20:23]
 s_waitcnt lgkmcnt(12)
 v_mfma_f32_16x16x32_bf16 v[44:47], a[112:115], v[96:99], v[44:47]
 ds_read_b64_tr_b16 a[176:177], v3 offset:50720
 ds_read_b64_tr_b16 a[178:179], v3 offset:50848
 v_mfma_f32_16x16x32_bf16 v[44:47], a[116:119], v[112:115], v[44:47]
 s_waitcnt lgkmcnt(10)
 v_mfma_f32_16x16x32_bf16 v[44:47], a[120:123], v[128:131], v[44:47]
 ds_read_b64_tr_b16 a[180:181], v3 offset:50976
 ds_read_b64_tr_b16 a[182:183], v3 offset:51104
 v_mfma_f32_16x16x32_bf16 v[44:47], a[124:127], v[144:147], v[44:47]
 v_mfma_f32_16x16x32_bf16 v[48:51], a[124:127], v[152:155], v[48:51]
 ds_read_b64_tr_b16 a[184:185], v5 offset:50720
 ds_read_b64_tr_b16 a[186:187], v5 offset:50848
 v_mfma_f32_16x16x32_bf16 v[48:51], a[120:123], v[136:139], v[48:51]
 v_mfma_f32_16x16x32_bf16 v[48:51], a[116:119], v[120:123], v[48:51]
 ds_read_b64_tr_b16 a[188:189], v5 offset:50976
 ds_read_b64_tr_b16 a[190:191], v5 offset:51104
 v_mfma_f32_16x16x32_bf16 v[48:51], a[112:115], v[104:107], v[48:51]
 s_waitcnt lgkmcnt(12)
 v_mfma_f32_16x16x32_bf16 v[220:223], a[160:163], v[160:163], v[220:223]
 s_waitcnt vmcnt(17)
 s_barrier
 ds_read_b64_tr_b16 a[96:97], v6 offset:0
 ds_read_b64_tr_b16 a[98:99], v6 offset:128
 v_mfma_f32_16x16x32_bf16 v[220:223], a[164:167], v[176:179], v[220:223]
 s_waitcnt lgkmcnt(10)
 v_mfma_f32_16x16x32_bf16 v[220:223], a[168:171], v[192:195], v[220:223]
 s_add_u32 s56, s100, 0
 ds_read_b64_tr_b16 a[100:101], v6 offset:256
 ds_read_b64_tr_b16 a[102:103], v6 offset:384
 v_mfma_f32_16x16x32_bf16 v[220:223], a[172:175], v[208:211], v[220:223]
 s_add_u32 m0, s40, 0x16600
 v_mfma_f32_16x16x32_bf16 v[20:23], a[172:175], v[216:219], v[20:23]
 ds_read_b64_tr_b16 a[104:105], v8 offset:0
 ds_read_b64_tr_b16 a[106:107], v8 offset:128
 v_mfma_f32_16x16x32_bf16 v[20:23], a[168:171], v[200:203], v[20:23]
 buffer_load_dwordx4 v17, s[28:31], s56 offen offset:0 lds
 v_mfma_f32_16x16x32_bf16 v[20:23], a[164:167], v[184:187], v[20:23]
 ds_read_b64_tr_b16 a[108:109], v8 offset:256
 ds_read_b64_tr_b16 a[110:111], v8 offset:384
 v_mfma_f32_16x16x32_bf16 v[20:23], a[160:163], v[168:171], v[20:23]
 s_waitcnt lgkmcnt(12)
 v_mfma_f32_16x16x32_bf16 v[44:47], a[176:179], v[160:163], v[44:47]
 s_add_u32 m0, s40, 0x166a0
 ds_read_b64_tr_b16 a[112:113], v6 offset:32
 ds_read_b64_tr_b16 a[114:115], v6 offset:160
 v_mfma_f32_16x16x32_bf16 v[44:47], a[180:183], v[176:179], v[44:47]
 s_waitcnt lgkmcnt(10)
 buffer_load_dwordx4 v17, s[28:31], s56 offen offset:896 lds
 v_mfma_f32_16x16x32_bf16 v[44:47], a[184:187], v[192:195], v[44:47]
 ds_read_b64_tr_b16 a[116:117], v6 offset:288
 ds_read_b64_tr_b16 a[118:119], v6 offset:416
 v_mfma_f32_16x16x32_bf16 v[44:47], a[188:191], v[208:211], v[44:47]
 v_mfma_f32_16x16x32_bf16 v[48:51], a[188:191], v[216:219], v[48:51]
 ds_read_b64_tr_b16 a[120:121], v8 offset:32
 ds_read_b64_tr_b16 a[122:123], v8 offset:160
 v_mfma_f32_16x16x32_bf16 v[48:51], a[184:187], v[200:203], v[48:51]
 s_add_u32 m0, s40, 0x16740
 v_mfma_f32_16x16x32_bf16 v[48:51], a[180:183], v[184:187], v[48:51]
 ds_read_b64_tr_b16 a[124:125], v8 offset:288
 ds_read_b64_tr_b16 a[126:127], v8 offset:416
 v_mfma_f32_16x16x32_bf16 v[48:51], a[176:179], v[168:171], v[48:51]
 s_waitcnt vmcnt(8)
 buffer_load_dword v29, v28, s[36:39], 0 offen offset:0 sc1
 buffer_load_dwordx4 v17, s[28:31], s56 offen offset:1792 lds
 v_mfma_f32_16x16x32_bf16 v[60:63], v[12:15], a[0:3], 0
L_pad23:
 s_cbranch_execz L_e4_back
 v_mfma_f32_16x16x32_bf16 v[60:63], v[12:15], a[4:7], v[60:63]
 v_mfma_f32_16x16x32_bf16 v[60:63], v[12:15], a[8:11], v[60:63]
 v_mfma_f32_16x16x32_bf16 v[60:63], v[12:15], a[12:15], v[60:63]
 s_add_u32 s55, s11, 0x7e000
 v_cvt_pk_bf16_f32 v220, v220, v221
 v_cvt_pk_bf16_f32 v221, v222, v223
 v_mfma_f32_16x16x32_bf16 v[60:63], v[12:15], a[16:19], v[60:63]
 s_add_u32 m0, s40, 0x167e0
 v_cvt_pk_bf16_f32 v222, v44, v45
 v_cvt_pk_bf16_f32 v223, v46, v47
 v_mfma_f32_16x16x32_bf16 v[60:63], v[12:15], a[20:23], v[60:63]
 buffer_load_dwordx4 v17, s[28:31], s56 offen offset:2688 lds
 buffer_store_dwordx4 v[220:223], v1, s[24:27], s55 offen offset:0 sc1
 v_mfma_f32_16x16x32_bf16 v[60:63], v[12:15], a[24:27], v[60:63]
 s_cmp_eq_u32 s59, 3
 s_cselect_b64 vcc, -1, 0
 v_cndmask_b32 v36, v36, v220, vcc
 v_mfma_f32_16x16x32_bf16 v[60:63], v[12:15], v[76:79], v[60:63]
 v_cndmask_b32 v37, v37, v221, vcc
 v_cndmask_b32 v38, v38, v222, vcc
 v_mfma_f32_16x16x32_bf16 v[64:67], v[204:207], a[0:3], 0
 v_cndmask_b32 v39, v39, v223, vcc
 v_mfma_f32_16x16x32_bf16 v[64:67], v[204:207], a[4:7], v[64:67]
 v_mfma_f32_16x16x32_bf16 v[64:67], v[204:207], a[8:11], v[64:67]
 s_add_u32 s56, s100, 0x1c000
 v_cvt_pk_bf16_f32 v20, v20, v21
 v_cvt_pk_bf16_f32 v21, v22, v23
 v_mfma_f32_16x16x32_bf16 v[64:67], v[204:207], a[12:15], v[64:67]
 s_add_u32 m0, s40, 0x1a800
 v_cvt_pk_bf16_f32 v22, v48, v49
 v_cvt_pk_bf16_f32 v23, v50, v51
 v_mfma_f32_16x16x32_bf16 v[64:67], v[204:207], a[16:19], v[64:67]
 s_add_u32 s55, s12, 0x80000
 buffer_load_dwordx4 v17, s[28:31], s56 offen offset:0 lds
 buffer_store_dwordx4 v[20:23], v1, s[24:27], s55 offen offset:0 sc1
 v_mfma_f32_16x16x32_bf16 v[64:67], v[204:207], a[20:23], v[64:67]
 s_cmp_eq_u32 s59, 4
 s_cselect_b64 vcc, -1, 0
 v_cndmask_b32 v36, v36, v20, vcc
 v_mfma_f32_16x16x32_bf16 v[64:67], v[204:207], a[24:27], v[64:67]
 v_cndmask_b32 v37, v37, v21, vcc
 v_cndmask_b32 v38, v38, v22, vcc
 v_mfma_f32_16x16x32_bf16 v[64:67], v[204:207], v[76:79], v[64:67]
 s_waitcnt lgkmcnt(12)
 v_cndmask_b32 v39, v39, v23, vcc
 v_mfma_f32_16x16x32_bf16 v[100:103], a[96:99], a[192:195], 0
 s_add_u32 m0, s40, 0x1a8a0
 ds_read_b64_tr_b16 a[160:161], v6 offset:16896
 ds_read_b64_tr_b16 a[162:163], v6 offset:17024
 v_mfma_f32_16x16x32_bf16 v[100:103], a[100:103], a[200:203], v[100:103]
 s_waitcnt lgkmcnt(10)
 buffer_load_dwordx4 v17, s[28:31], s56 offen offset:896 lds
 v_mfma_f32_16x16x32_bf16 v[100:103], a[104:107], a[208:211], v[100:103]
 v_mfma_f32_16x16x32_bf16 v[100:103], a[108:111], a[216:219], v[100:103]
 ds_read_b64_tr_b16 a[164:165], v6 offset:17152
 ds_read_b64_tr_b16 a[166:167], v6 offset:17280
 v_mfma_f32_16x16x32_bf16 v[108:111], a[108:111], a[220:223], 0
 v_cvt_pk_bf16_f32 v60, v60, v61
 v_cvt_pk_bf16_f32 v61, v62, v63
 v_mfma_f32_16x16x32_bf16 v[108:111], a[104:107], a[212:215], v[108:111]
 v_cvt_pk_bf16_f32 v62, v64, v65
 v_cvt_pk_bf16_f32 v63, v66, v67
 v_mfma_f32_16x16x32_bf16 v[108:111], a[100:103], a[204:207], v[108:111]
 ds_read_b64_tr_b16 a[168:169], v8 offset:16896
 ds_read_b64_tr_b16 a[170:171], v8 offset:17024
 v_mfma_f32_16x16x32_bf16 v[108:111], a[96:99], a[196:199], v[108:111]
 s_add_u32 m0, s40, 0x1a940
 buffer_store_dwordx4 v[60:63], v10, s[32:35], s69 offen offset:0 nt
 v_mfma_f32_16x16x32_bf16 v[164:167], a[96:99], v[80:83], 0
 buffer_load_dwordx4 v17, s[28:31], s56 offen offset:1792 lds
 v_mfma_f32_16x16x32_bf16 v[164:167], a[100:103], v[84:87], v[164:167]
 ds_read_b64_tr_b16 a[172:173], v8 offset:17152
 ds_read_b64_tr_b16 a[174:175], v8 offset:17280
 v_mfma_f32_16x16x32_bf16 v[164:167], a[104:107], v[228:231], v[164:167]
 v_mfma_f32_16x16x32_bf16 v[164:167], a[108:111], v[236:239], v[164:167]
 s_waitcnt lgkmcnt(12)
 v_mfma_f32_16x16x32_bf16 v[116:119], a[112:115], a[192:195], 0
 ds_read_b64_tr_b16 a[176:177], v6 offset:16928
 ds_read_b64_tr_b16 a[178:179], v6 offset:17056
 v_mfma_f32_16x16x32_bf16 v[116:119], a[116:119], a[200:203], v[116:119]
 s_waitcnt lgkmcnt(10)
 v_mfma_f32_16x16x32_bf16 v[116:119], a[120:123], a[208:211], v[116:119]
 s_add_u32 m0, s40, 0x1a9e0
 v_mfma_f32_16x16x32_bf16 v[116:119], a[124:127], a[216:219], v[116:119]
 ds_read_b64_tr_b16 a[180:181], v6 offset:17184
 ds_read_b64_tr_b16 a[182:183], v6 offset:17312
 v_mfma_f32_16x16x32_bf16 v[124:127], a[124:127], a[220:223], 0
 buffer_load_dwordx4 v17, s[28:31], s56 offen offset:2688 lds
 v_mfma_f32_16x16x32_bf16 v[124:127], a[120:123], a[212:215], v[124:127]
 v_mfma_f32_16x16x32_bf16 v[124:127], a[116:119], a[204:207], v[124:127]
 ds_read_b64_tr_b16 a[184:185], v8 offset:16928
 ds_read_b64_tr_b16 a[186:187], v8 offset:17056
 v_mfma_f32_16x16x32_bf16 v[124:127], a[112:115], a[196:199], v[124:127]
 v_mfma_f32_16x16x32_bf16 v[172:175], a[112:115], v[80:83], 0
 v_mfma_f32_16x16x32_bf16 v[172:175], a[116:119], v[84:87], v[172:175]
 ds_read_b64_tr_b16 a[188:189], v8 offset:17184
 ds_read_b64_tr_b16 a[190:191], v8 offset:17312
 v_mfma_f32_16x16x32_bf16 v[172:175], a[120:123], v[228:231], v[172:175]
 v_mfma_f32_16x16x32_bf16 v[172:175], a[124:127], v[236:239], v[172:175]
 s_waitcnt lgkmcnt(12)
 v_mfma_f32_16x16x32_bf16 v[100:103], a[160:163], a[224:227], v[100:103]
 s_waitcnt vmcnt(12)
 s_barrier
 ds_read_b64_tr_b16 a[96:97], v6 offset:33792
 ds_read_b64_tr_b16 a[98:99], v6 offset:33920
 v_mfma_f32_16x16x32_bf16 v[100:103], a[164:167], a[232:235], v[100:103]
 s_waitcnt lgkmcnt(10)
 v_mfma_f32_16x16x32_bf16 v[100:103], a[168:171], a[240:243], v[100:103]
 s_add_u32 s56, s100, 0x1c0000
 v_mfma_f32_16x16x32_bf16 v[100:103], a[172:175], a[248:251], v[100:103]
 s_add_u32 m0, s40, 0x1ea00
 ds_read_b64_tr_b16 a[100:101], v6 offset:34048
 ds_read_b64_tr_b16 a[102:103], v6 offset:34176
 v_mfma_f32_16x16x32_bf16 v[108:111], a[172:175], a[252:255], v[108:111]
 buffer_load_dwordx4 v17, s[28:31], s56 offen offset:0 lds
 v_mfma_f32_16x16x32_bf16 v[108:111], a[168:171], a[244:247], v[108:111]
 v_mfma_f32_16x16x32_bf16 v[108:111], a[164:167], a[236:239], v[108:111]
 ds_read_b64_tr_b16 a[104:105], v8 offset:33792
 ds_read_b64_tr_b16 a[106:107], v8 offset:33920
 v_mfma_f32_16x16x32_bf16 v[108:111], a[160:163], a[228:231], v[108:111]
 v_mfma_f32_16x16x32_bf16 v[164:167], a[160:163], v[88:91], v[164:167]
 s_waitcnt vmcnt(10)
 v_readfirstlane_b32 s50, v29
 s_bitcmp0_b32 s50, 7
 s_cbranch_scc1 L_poll1
L_poll1_ret:
 v_mfma_f32_16x16x32_bf16 v[164:167], a[164:167], v[92:95], v[164:167]
 ds_read_b64_tr_b16 a[108:109], v8 offset:34048
 ds_read_b64_tr_b16 a[110:111], v8 offset:34176
 v_mfma_f32_16x16x32_bf16 v[164:167], a[168:171], v[244:247], v[164:167]
 buffer_load_dwordx4 a[32:35], v1, s[24:27], s65 offen offset:0 sc1
 v_mfma_f32_16x16x32_bf16 v[164:167], a[172:175], v[252:255], v[164:167]
 s_waitcnt lgkmcnt(12)
 v_mfma_f32_16x16x32_bf16 v[116:119], a[176:179], a[224:227], v[116:119]
 s_add_u32 m0, s40, 0x1eaa0
 ds_read_b64_tr_b16 a[112:113], v6 offset:33824
 ds_read_b64_tr_b16 a[114:115], v6 offset:33952
 v_mfma_f32_16x16x32_bf16 v[116:119], a[180:183], a[232:235], v[116:119]
 s_waitcnt lgkmcnt(10)
 buffer_load_dwordx4 v17, s[28:31], s56 offen offset:896 lds
 v_mfma_f32_16x16x32_bf16 v[116:119], a[184:187], a[240:243], v[116:119]
 v_mfma_f32_16x16x32_bf16 v[116:119], a[188:191], a[248:251], v[116:119]
 ds_read_b64_tr_b16 a[116:117], v6 offset:34080
 ds_read_b64_tr_b16 a[118:119], v6 offset:34208
 v_mfma_f32_16x16x32_bf16 v[124:127], a[188:191], a[252:255], v[124:127]
 v_mfma_f32_16x16x32_bf16 v[124:127], a[184:187], a[244:247], v[124:127]
 v_mfma_f32_16x16x32_bf16 v[124:127], a[180:183], a[236:239], v[124:127]
 ds_read_b64_tr_b16 a[120:121], v8 offset:33824
 ds_read_b64_tr_b16 a[122:123], v8 offset:33952
 v_mfma_f32_16x16x32_bf16 v[124:127], a[176:179], a[228:231], v[124:127]
 v_mfma_f32_16x16x32_bf16 v[172:175], a[176:179], v[88:91], v[172:175]
 v_mfma_f32_16x16x32_bf16 v[172:175], a[180:183], v[92:95], v[172:175]
 ds_read_b64_tr_b16 a[124:125], v8 offset:34080
 ds_read_b64_tr_b16 a[126:127], v8 offset:34208
 v_mfma_f32_16x16x32_bf16 v[172:175], a[184:187], v[244:247], v[172:175]
 s_add_u32 m0, s40, 0x1eb40
 buffer_load_dwordx4 a[36:39], v1, s[24:27], s65 offen offset:1024 sc1
 v_mfma_f32_16x16x32_bf16 v[172:175], a[188:191], v[252:255], v[172:175]
 s_waitcnt lgkmcnt(12)
 buffer_load_dwordx4 v17, s[28:31], s56 offen offset:1792 lds
 v_mfma_f32_16x16x32_bf16 v[100:103], a[96:99], v[96:99], v[100:103]
 ds_read_b64_tr_b16 a[160:161], v6 offset:50688
 ds_read_b64_tr_b16 a[162:163], v6 offset:50816
 v_mfma_f32_16x16x32_bf16 v[100:103], a[100:103], v[112:115], v[100:103]
 s_waitcnt lgkmcnt(10)
 v_mfma_f32_16x16x32_bf16 v[100:103], a[104:107], v[128:131], v[100:103]
 v_mfma_f32_16x16x32_bf16 v[100:103], a[108:111], v[144:147], v[100:103]
 ds_read_b64_tr_b16 a[164:165], v6 offset:50944
 ds_read_b64_tr_b16 a[166:167], v6 offset:51072
 v_mfma_f32_16x16x32_bf16 v[108:111], a[108:111], v[152:155], v[108:111]
 v_mfma_f32_16x16x32_bf16 v[108:111], a[104:107], v[136:139], v[108:111]
 v_mfma_f32_16x16x32_bf16 v[108:111], a[100:103], v[120:123], v[108:111]
 ds_read_b64_tr_b16 a[168:169], v8 offset:50688
 ds_read_b64_tr_b16 a[170:171], v8 offset:50816
 v_mfma_f32_16x16x32_bf16 v[108:111], a[96:99], v[104:107], v[108:111]
 v_mfma_f32_16x16x32_bf16 v[164:167], a[96:99], v[224:227], v[164:167]
 v_mfma_f32_16x16x32_bf16 v[164:167], a[100:103], v[232:235], v[164:167]
 s_add_u32 m0, s40, 0x1ebe0
 ds_read_b64_tr_b16 a[172:173], v8 offset:50944
 ds_read_b64_tr_b16 a[174:175], v8 offset:51072
 v_mfma_f32_16x16x32_bf16 v[164:167], a[104:107], a[128:131], v[164:167]
 buffer_load_dwordx4 a[40:43], v1, s[24:27], s65 offen offset:2048 sc1
 buffer_load_dwordx4 v17, s[28:31], s56 offen offset:2688 lds
 v_mfma_f32_16x16x32_bf16 v[164:167], a[108:111], a[136:139], v[164:167]
 s_waitcnt lgkmcnt(12)
 v_mfma_f32_16x16x32_bf16 v[116:119], a[112:115], v[96:99], v[116:119]
 ds_read_b64_tr_b16 a[176:177], v6 offset:50720
 ds_read_b64_tr_b16 a[178:179], v6 offset:50848
 v_mfma_f32_16x16x32_bf16 v[116:119], a[116:119], v[112:115], v[116:119]
 s_waitcnt lgkmcnt(10)
 v_mfma_f32_16x16x32_bf16 v[116:119], a[120:123], v[128:131], v[116:119]
 v_mfma_f32_16x16x32_bf16 v[116:119], a[124:127], v[144:147], v[116:119]
 ds_read_b64_tr_b16 a[180:181], v6 offset:50976
 ds_read_b64_tr_b16 a[182:183], v6 offset:51104
 v_mfma_f32_16x16x32_bf16 v[124:127], a[124:127], v[152:155], v[124:127]
 v_mfma_f32_16x16x32_bf16 v[124:127], a[120:123], v[136:139], v[124:127]
 v_mfma_f32_16x16x32_bf16 v[124:127], a[116:119], v[120:123], v[124:127]
 ds_read_b64_tr_b16 a[184:185], v8 offset:50720
 ds_read_b64_tr_b16 a[186:187], v8 offset:50848
 v_mfma_f32_16x16x32_bf16 v[124:127], a[112:115], v[104:107], v[124:127]
 v_mfma_f32_16x16x32_bf16 v[172:175], a[112:115], v[224:227], v[172:175]
 v_mfma_f32_16x16x32_bf16 v[172:175], a[116:119], v[232:235], v[172:175]
 ds_read_b64_tr_b16 a[188:189], v8 offset:50976
 ds_read_b64_tr_b16 a[190:191], v8 offset:51104
 v_mfma_f32_16x16x32_bf16 v[172:175], a[120:123], a[128:131], v[172:175]
 buffer_load_dwordx4 a[44:47], v1, s[24:27], s65 offen offset:3072 sc1
 v_mfma_f32_16x16x32_bf16 v[172:175], a[124:127], a[136:139], v[172:175]
 s_waitcnt lgkmcnt(12)
 v_mfma_f32_16x16x32_bf16 v[100:103], a[160:163], v[160:163], v[100:103]
 s_waitcnt vmcnt(12)
 s_barrier
 ds_read_b64_tr_b16 a[96:97], v7 offset:0
 ds_read_b64_tr_b16 a[98:99], v7 offset:128
 v_mfma_f32_16x16x32_bf16 v[100:103], a[164:167], v[176:179], v[100:103]
 s_waitcnt lgkmcnt(10)
 v_mov_b32 v11, 0x100
 v_mfma_f32_16x16x32_bf16 v[100:103], a[168:171], v[192:195], v[100:103]
 s_add_u32 s56, s100, 0x1dc000
 buffer_atomic_add v11, v27, s[36:39], 0 offen
 v_mfma_f32_16x16x32_bf16 v[100:103], a[172:175], v[208:211], v[100:103]
 s_add_u32 m0, s40, 0x22c00
 ds_read_b64_tr_b16 a[100:101], v7 offset:256
 ds_read_b64_tr_b16 a[102:103], v7 offset:384
 v_mfma_f32_16x16x32_bf16 v[108:111], a[172:175], v[216:219], v[108:111]
 buffer_load_dwordx4 v17, s[28:31], s56 offen offset:0 lds
 v_mfma_f32_16x16x32_bf16 v[108:111], a[168:171], v[200:203], v[108:111]
 v_mfma_f32_16x16x32_bf16 v[108:111], a[164:167], v[184:187], v[108:111]
 ds_read_b64_tr_b16 a[104:105], v9 offset:0
 ds_read_b64_tr_b16 a[106:107], v9 offset:128
 v_mfma_f32_16x16x32_bf16 v[108:111], a[160:163], v[168:171], v[108:111]
 v_mfma_f32_16x16x32_bf16 v[164:167], a[160:163], v[240:243], v[164:167]
 v_mfma_f32_16x16x32_bf16 v[164:167], a[164:167], v[248:251], v[164:167]
 ds_read_b64_tr_b16 a[108:109], v9 offset:256
 ds_read_b64_tr_b16 a[110:111], v9 offset:384
 v_mfma_f32_16x16x32_bf16 v[164:167], a[168:171], a[144:147], v[164:167]
 buffer_load_dwordx4 a[48:51], v18, s[24:27], s65 offen offset:0 sc1
 v_mfma_f32_16x16x32_bf16 v[164:167], a[172:175], a[152:155], v[164:167]
 s_waitcnt lgkmcnt(12)
 v_mfma_f32_16x16x32_bf16 v[116:119], a[176:179], v[160:163], v[116:119]
 ds_read_b64_tr_b16 a[112:113], v7 offset:32
 ds_read_b64_tr_b16 a[114:115], v7 offset:160
 v_mfma_f32_16x16x32_bf16 v[116:119], a[180:183], v[176:179], v[116:119]
 s_waitcnt lgkmcnt(10)
 v_mfma_f32_16x16x32_bf16 v[116:119], a[184:187], v[192:195], v[116:119]
 v_mfma_f32_16x16x32_bf16 v[116:119], a[188:191], v[208:211], v[116:119]
 ds_read_b64_tr_b16 a[116:117], v7 offset:288
 ds_read_b64_tr_b16 a[118:119], v7 offset:416
 v_mfma_f32_16x16x32_bf16 v[124:127], a[188:191], v[216:219], v[124:127]
 v_mfma_f32_16x16x32_bf16 v[124:127], a[184:187], v[200:203], v[124:127]
 s_add_u32 m0, s40, 0x22ca0
 v_mfma_f32_16x16x32_bf16 v[124:127], a[180:183], v[184:187], v[124:127]
 ds_read_b64_tr_b16 a[120:121], v9 offset:32
 ds_read_b64_tr_b16 a[122:123], v9 offset:160
 v_mfma_f32_16x16x32_bf16 v[124:127], a[176:179], v[168:171], v[124:127]
 buffer_load_dwordx4 v17, s[28:31], s56 offen offset:896 lds
 v_mfma_f32_16x16x32_bf16 v[172:175], a[176:179], v[240:243], v[172:175]
 v_mfma_f32_16x16x32_bf16 v[172:175], a[180:183], v[248:251], v[172:175]
 ds_read_b64_tr_b16 a[124:125], v9 offset:288
 ds_read_b64_tr_b16 a[126:127], v9 offset:416
 v_mfma_f32_16x16x32_bf16 v[172:175], a[184:187], a[144:147], v[172:175]
 buffer_load_dwordx4 a[52:55], v18, s[24:27], s65 offen offset:1024 sc1
 v_mfma_f32_16x16x32_bf16 v[172:175], a[188:191], a[152:155], v[172:175]
 s_waitcnt lgkmcnt(12)
 v_mfma_f32_16x16x32_bf16 v[132:135], a[96:99], a[192:195], 0
 ds_read_b64_tr_b16 a[160:161], v7 offset:16896
 ds_read_b64_tr_b16 a[162:163], v7 offset:17024
 v_mfma_f32_16x16x32_bf16 v[132:135], a[100:103], a[200:203], v[132:135]
 s_waitcnt lgkmcnt(10)
 v_mfma_f32_16x16x32_bf16 v[132:135], a[104:107], a[208:211], v[132:135]
 ds_read_b64_tr_b16 a[164:165], v7 offset:17152
 ds_read_b64_tr_b16 a[166:167], v7 offset:17280
 v_mfma_f32_16x16x32_bf16 v[132:135], a[108:111], a[216:219], v[132:135]
 s_add_u32 s55, s8, 0xa0000
 v_cvt_pk_bf16_f32 v100, v100, v101
 v_cvt_pk_bf16_f32 v101, v102, v103
 v_mfma_f32_16x16x32_bf16 v[140:143], a[108:111], a[220:223], 0
 ds_read_b64_tr_b16 a[168:169], v9 offset:16896
 ds_read_b64_tr_b16 a[170:171], v9 offset:17024
 v_mfma_f32_16x16x32_bf16 v[140:143], a[104:107], a[212:215], v[140:143]
 v_cvt_pk_bf16_f32 v102, v116, v117
 v_cvt_pk_bf16_f32 v103, v118, v119
 v_mfma_f32_16x16x32_bf16 v[140:143], a[100:103], a[204:207], v[140:143]
 ds_read_b64_tr_b16 a[172:173], v9 offset:17152
 ds_read_b64_tr_b16 a[174:175], v9 offset:17280
 v_mfma_f32_16x16x32_bf16 v[140:143], a[96:99], a[196:199], v[140:143]
 s_waitcnt lgkmcnt(12)
 buffer_store_dwordx4 v[100:103], v1, s[24:27], s55 offen offset:0 sc1
 v_mov_b32 v76, v100
 v_mfma_f32_16x16x32_bf16 v[148:151], a[112:115], a[192:195], 0
 ds_read_b64_tr_b16 a[176:177], v7 offset:16928
 ds_read_b64_tr_b16 a[178:179], v7 offset:17056
 v_mfma_f32_16x16x32_bf16 v[148:151], a[116:119], a[200:203], v[148:151]
 s_waitcnt lgkmcnt(10)
 v_mov_b32 v77, v101
 v_mov_b32 v78, v102
 v_mfma_f32_16x16x32_bf16 v[148:151], a[120:123], a[208:211], v[148:151]
 s_add_u32 m0, s40, 0x22d40
 ds_read_b64_tr_b16 a[180:181], v7 offset:17184
 ds_read_b64_tr_b16 a[182:183], v7 offset:17312
 v_mfma_f32_16x16x32_bf16 v[148:151], a[124:127], a[216:219], v[148:151]
 s_add_u32 s55, s9, 0xa2000
 buffer_load_dwordx4 a[56:59], v18, s[24:27], s65 offen offset:2048 sc1
 buffer_load_dwordx4 v17, s[28:31], s56 offen offset:1792 lds
 v_mfma_f32_16x16x32_bf16 v[156:159], a[124:127], a[220:223], 0
 ds_read_b64_tr_b16 a[184:185], v9 offset:16928
 ds_read_b64_tr_b16 a[186:187], v9 offset:17056
 v_mfma_f32_16x16x32_bf16 v[156:159], a[120:123], a[212:215], v[156:159]
 v_cvt_pk_bf16_f32 v108, v108, v109
 v_cvt_pk_bf16_f32 v109, v110, v111
 v_mfma_f32_16x16x32_bf16 v[156:159], a[116:119], a[204:207], v[156:159]
 ds_read_b64_tr_b16 a[188:189], v9 offset:17184
 ds_read_b64_tr_b16 a[190:191], v9 offset:17312
 v_mfma_f32_16x16x32_bf16 v[156:159], a[112:115], a[196:199], v[156:159]
 s_waitcnt lgkmcnt(12)
 v_cvt_pk_bf16_f32 v110, v124, v125
 v_cvt_pk_bf16_f32 v111, v126, v127
 v_mfma_f32_16x16x32_bf16 v[132:135], a[160:163], a[224:227], v[132:135]
 ds_read_b64_tr_b16 a[96:97], v7 offset:33792
 ds_read_b64_tr_b16 a[98:99], v7 offset:33920
 v_mfma_f32_16x16x32_bf16 v[132:135], a[164:167], a[232:235], v[132:135]
 s_waitcnt lgkmcnt(10)
 buffer_store_dwordx4 v[108:111], v1, s[24:27], s55 offen offset:0 sc1
 v_cvt_pk_bf16_f32 v164, v164, v165
 v_mfma_f32_16x16x32_bf16 v[132:135], a[168:171], a[240:243], v[132:135]
 s_add_u32 s55, s10, 0xa4000
 ds_read_b64_tr_b16 a[100:101], v7 offset:34048
 ds_read_b64_tr_b16 a[102:103], v7 offset:34176
 v_mfma_f32_16x16x32_bf16 v[132:135], a[172:175], a[248:251], v[132:135]
 v_cvt_pk_bf16_f32 v165, v166, v167
 v_cvt_pk_bf16_f32 v166, v172, v173
 v_mfma_f32_16x16x32_bf16 v[140:143], a[172:175], a[252:255], v[140:143]
 ds_read_b64_tr_b16 a[104:105], v9 offset:33792
 ds_read_b64_tr_b16 a[106:107], v9 offset:33920
 v_mfma_f32_16x16x32_bf16 v[140:143], a[168:171], a[244:247], v[140:143]
 v_cvt_pk_bf16_f32 v167, v174, v175
 v_mov_b32 v79, v103
 v_mfma_f32_16x16x32_bf16 v[140:143], a[164:167], a[236:239], v[140:143]
 ds_read_b64_tr_b16 a[108:109], v9 offset:34048
 ds_read_b64_tr_b16 a[110:111], v9 offset:34176
 v_mfma_f32_16x16x32_bf16 v[140:143], a[160:163], a[228:231], v[140:143]
 s_waitcnt lgkmcnt(12)
 buffer_store_dwordx4 v[164:167], v1, s[24:27], s55 offen offset:0 sc1
 v_mfma_f32_16x16x32_bf16 v[148:151], a[176:179], a[224:227], v[148:151]
 ds_read_b64_tr_b16 a[112:113], v7 offset:33824
 ds_read_b64_tr_b16 a[114:115], v7 offset:33952
 v_mfma_f32_16x16x32_bf16 v[148:151], a[180:183], a[232:235], v[148:151]
 s_waitcnt lgkmcnt(10)
 v_mfma_f32_16x16x32_bf16 v[148:151], a[184:187], a[240:243], v[148:151]
 ds_read_b64_tr_b16 a[116:117], v7 offset:34080
 ds_read_b64_tr_b16 a[118:119], v7 offset:34208
 v_mfma_f32_16x16x32_bf16 v[148:151], a[188:191], a[248:251], v[148:151]
 s_add_u32 m0, s40, 0x22de0
 v_mfma_f32_16x16x32_bf16 v[156:159], a[188:191], a[252:255], v[156:159]
 ds_read_b64_tr_b16 a[120:121], v9 offset:33824
 ds_read_b64_tr_b16 a[122:123], v9 offset:33952
 v_mfma_f32_16x16x32_bf16 v[156:159], a[184:187], a[244:247], v[156:159]
 s_cmp_eq_u32 s59, 1
 s_cselect_b64 vcc, -1, 0
 buffer_load_dwordx4 v17, s[28:31], s56 offen offset:2688 lds
 v_mfma_f32_16x16x32_bf16 v[156:159], a[180:183], a[236:239], v[156:159]
 s_add_u32 s100, s100, 0x80
 ds_read_b64_tr_b16 a[124:125], v9 offset:34080
 ds_read_b64_tr_b16 a[126:127], v9 offset:34208
 v_mfma_f32_16x16x32_bf16 v[156:159], a[176:179], a[228:231], v[156:159]
 s_waitcnt lgkmcnt(12)
 v_cndmask_b32 v76, v76, v108, vcc
 v_cndmask_b32 v77, v77, v109, vcc
 v_mfma_f32_16x16x32_bf16 v[132:135], a[96:99], v[96:99], v[132:135]
 s_sub_u32 s56, s100, 0x380
 ds_read_b64_tr_b16 a[160:161], v7 offset:50688
 ds_read_b64_tr_b16 a[162:163], v7 offset:50816
 v_mfma_f32_16x16x32_bf16 v[132:135], a[100:103], v[112:115], v[132:135]
 s_waitcnt lgkmcnt(10)
 v_cndmask_b32 v78, v78, v110, vcc
 v_cndmask_b32 v79, v79, v111, vcc
 v_mfma_f32_16x16x32_bf16 v[132:135], a[104:107], v[128:131], v[132:135]
 s_min_u32 s100, s100, s56
 ds_read_b64_tr_b16 a[164:165], v7 offset:50944
 ds_read_b64_tr_b16 a[166:167], v7 offset:51072
 v_mfma_f32_16x16x32_bf16 v[132:135], a[108:111], v[144:147], v[132:135]
 s_cmp_eq_u32 s59, 2
 s_cselect_b64 vcc, -1, 0
 v_cndmask_b32 v76, v76, v164, vcc
 v_mfma_f32_16x16x32_bf16 v[140:143], a[108:111], v[152:155], v[140:143]
 ds_read_b64_tr_b16 a[168:169], v9 offset:50688
 ds_read_b64_tr_b16 a[170:171], v9 offset:50816
 v_mfma_f32_16x16x32_bf16 v[140:143], a[104:107], v[136:139], v[140:143]
 v_cndmask_b32 v77, v77, v165, vcc
 v_cndmask_b32 v78, v78, v166, vcc
 v_mfma_f32_16x16x32_bf16 v[140:143], a[100:103], v[120:123], v[140:143]
 ds_read_b64_tr_b16 a[172:173], v9 offset:50944
 ds_read_b64_tr_b16 a[174:175], v9 offset:51072
 v_mfma_f32_16x16x32_bf16 v[140:143], a[96:99], v[104:107], v[140:143]
 s_waitcnt lgkmcnt(12)
 v_cndmask_b32 v79, v79, v167, vcc
 v_mfma_f32_16x16x32_bf16 v[148:151], a[112:115], v[96:99], v[148:151]
 ds_read_b64_tr_b16 a[176:177], v7 offset:50720
 ds_read_b64_tr_b16 a[178:179], v7 offset:50848
 v_mfma_f32_16x16x32_bf16 v[148:151], a[116:119], v[112:115], v[148:151]
 s_waitcnt lgkmcnt(10)
 v_mfma_f32_16x16x32_bf16 v[148:151], a[120:123], v[128:131], v[148:151]
 ds_read_b64_tr_b16 a[180:181], v7 offset:50976
 ds_read_b64_tr_b16 a[182:183], v7 offset:51104
 v_mfma_f32_16x16x32_bf16 v[148:151], a[124:127], v[144:147], v[148:151]
 v_mfma_f32_16x16x32_bf16 v[156:159], a[124:127], v[152:155], v[156:159]
 ds_read_b64_tr_b16 a[184:185], v9 offset:50720
 ds_read_b64_tr_b16 a[186:187], v9 offset:50848
 v_mfma_f32_16x16x32_bf16 v[156:159], a[120:123], v[136:139], v[156:159]
 v_mfma_f32_16x16x32_bf16 v[156:159], a[116:119], v[120:123], v[156:159]
 ds_read_b64_tr_b16 a[188:189], v9 offset:50976
 ds_read_b64_tr_b16 a[190:191], v9 offset:51104
 v_mfma_f32_16x16x32_bf16 v[156:159], a[112:115], v[104:107], v[156:159]
 s_waitcnt lgkmcnt(12)
 v_mfma_f32_16x16x32_bf16 v[132:135], a[160:163], v[160:163], v[132:135]
 s_waitcnt vmcnt(19)
 s_barrier
 ds_read_b64_tr_b16 a[96:97], v2 offset:0
 ds_read_b64_tr_b16 a[98:99], v2 offset:128
 v_mfma_f32_16x16x32_bf16 v[132:135], a[164:167], v[176:179], v[132:135]
 s_waitcnt lgkmcnt(10)
 v_mfma_f32_16x16x32_bf16 v[132:135], a[168:171], v[192:195], v[132:135]
 s_add_u32 s56, s100, 0
 ds_read_b64_tr_b16 a[100:101], v2 offset:256
 ds_read_b64_tr_b16 a[102:103], v2 offset:384
 v_mfma_f32_16x16x32_bf16 v[132:135], a[172:175], v[208:211], v[132:135]
 s_add_u32 m0, s40, 0
 v_mfma_f32_16x16x32_bf16 v[140:143], a[172:175], v[216:219], v[140:143]
 ds_read_b64_tr_b16 a[104:105], v4 offset:0
 ds_read_b64_tr_b16 a[106:107], v4 offset:128
 v_mfma_f32_16x16x32_bf16 v[140:143], a[168:171], v[200:203], v[140:143]
 buffer_load_dwordx4 v17, s[28:31], s56 offen offset:0 lds
 v_mfma_f32_16x16x32_bf16 v[140:143], a[164:167], v[184:187], v[140:143]
 ds_read_b64_tr_b16 a[108:109], v4 offset:256
 ds_read_b64_tr_b16 a[110:111], v4 offset:384
 v_mfma_f32_16x16x32_bf16 v[140:143], a[160:163], v[168:171], v[140:143]
 s_waitcnt lgkmcnt(12)
 v_mfma_f32_16x16x32_bf16 v[148:151], a[176:179], v[160:163], v[148:151]
 s_add_u32 m0, s40, 0xa0
 ds_read_b64_tr_b16 a[112:113], v2 offset:32
 ds_read_b64_tr_b16 a[114:115], v2 offset:160
 v_mfma_f32_16x16x32_bf16 v[148:151], a[180:183], v[176:179], v[148:151]
 s_waitcnt lgkmcnt(10)
 buffer_load_dwordx4 v17, s[28:31], s56 offen offset:896 lds
 v_mfma_f32_16x16x32_bf16 v[148:151], a[184:187], v[192:195], v[148:151]
 ds_read_b64_tr_b16 a[116:117], v2 offset:288
 ds_read_b64_tr_b16 a[118:119], v2 offset:416
 v_mfma_f32_16x16x32_bf16 v[148:151], a[188:191], v[208:211], v[148:151]
 v_mfma_f32_16x16x32_bf16 v[156:159], a[188:191], v[216:219], v[156:159]
 ds_read_b64_tr_b16 a[120:121], v4 offset:32
 ds_read_b64_tr_b16 a[122:123], v4 offset:160
 v_mfma_f32_16x16x32_bf16 v[156:159], a[184:187], v[200:203], v[156:159]
 s_add_u32 m0, s40, 0x140
 v_mfma_f32_16x16x32_bf16 v[156:159], a[180:183], v[184:187], v[156:159]
 ds_read_b64_tr_b16 a[124:125], v4 offset:288
 ds_read_b64_tr_b16 a[126:127], v4 offset:416
 v_mfma_f32_16x16x32_bf16 v[156:159], a[176:179], v[168:171], v[156:159]
 s_waitcnt vmcnt(6)
 buffer_load_dword v29, v28, s[36:39], 0 offen offset:0 sc1
 buffer_load_dwordx4 v17, s[28:31], s56 offen offset:1792 lds
 v_mfma_f32_16x16x32_bf16 v[68:71], v[12:15], a[32:35], 0
 v_mfma_f32_16x16x32_bf16 v[68:71], v[12:15], a[36:39], v[68:71]
 v_mfma_f32_16x16x32_bf16 v[68:71], v[12:15], a[40:43], v[68:71]
 v_mfma_f32_16x16x32_bf16 v[68:71], v[12:15], a[44:47], v[68:71]
 s_add_u32 s55, s11, 0xa6000
 v_cvt_pk_bf16_f32 v132, v132, v133
 v_cvt_pk_bf16_f32 v133, v134, v135
 v_mfma_f32_16x16x32_bf16 v[68:71], v[12:15], a[48:51], v[68:71]
 s_add_u32 m0, s40, 0x1e0
 v_cvt_pk_bf16_f32 v134, v148, v149
 v_cvt_pk_bf16_f32 v135, v150, v151
 v_mfma_f32_16x16x32_bf16 v[68:71], v[12:15], a[52:55], v[68:71]
 buffer_load_dwordx4 v17, s[28:31], s56 offen offset:2688 lds
 buffer_store_dwordx4 v[132:135], v1, s[24:27], s55 offen offset:0 sc1
 v_mfma_f32_16x16x32_bf16 v[68:71], v[12:15], a[56:59], v[68:71]
 s_cmp_eq_u32 s59, 3
 s_cselect_b64 vcc, -1, 0
 v_cndmask_b32 v76, v76, v132, vcc
 v_mfma_f32_16x16x32_bf16 v[68:71], v[12:15], v[32:35], v[68:71]
 v_cndmask_b32 v77, v77, v133, vcc
 v_cndmask_b32 v78, v78, v134, vcc
 v_mfma_f32_16x16x32_bf16 v[72:75], v[204:207], a[32:35], 0
 v_cndmask_b32 v79, v79, v135, vcc
 v_mfma_f32_16x16x32_bf16 v[72:75], v[204:207], a[36:39], v[72:75]
 v_mfma_f32_16x16x32_bf16 v[72:75], v[204:207], a[40:43], v[72:75]
 s_add_u32 s56, s100, 0x1c000
 v_cvt_pk_bf16_f32 v140, v140, v141
 v_cvt_pk_bf16_f32 v141, v142, v143
 v_mfma_f32_16x16x32_bf16 v[72:75], v[204:207], a[44:47], v[72:75]
 s_add_u32 m0, s40, 0x4200
 v_cvt_pk_bf16_f32 v142, v156, v157
 v_cvt_pk_bf16_f32 v143, v158, v159
 v_mfma_f32_16x16x32_bf16 v[72:75], v[204:207], a[48:51], v[72:75]
 s_add_u32 s55, s12, 0xa8000
 buffer_load_dwordx4 v17, s[28:31], s56 offen offset:0 lds
 buffer_store_dwordx4 v[140:143], v1, s[24:27], s55 offen offset:0 sc1
 v_mfma_f32_16x16x32_bf16 v[72:75], v[204:207], a[52:55], v[72:75]
 s_cmp_eq_u32 s59, 4
 s_cselect_b64 vcc, -1, 0
 v_cndmask_b32 v76, v76, v140, vcc
 v_mfma_f32_16x16x32_bf16 v[72:75], v[204:207], a[56:59], v[72:75]
 v_cndmask_b32 v77, v77, v141, vcc
 v_cndmask_b32 v78, v78, v142, vcc
 v_mfma_f32_16x16x32_bf16 v[72:75], v[204:207], v[32:35], v[72:75]
 s_waitcnt lgkmcnt(12)
 v_cndmask_b32 v79, v79, v143, vcc
 v_mfma_f32_16x16x32_bf16 v[180:183], a[96:99], a[192:195], 0
 s_add_u32 m0, s40, 0x42a0
 ds_read_b64_tr_b16 a[160:161], v2 offset:16896
 ds_read_b64_tr_b16 a[162:163], v2 offset:17024
 v_mfma_f32_16x16x32_bf16 v[180:183], a[100:103], a[200:203], v[180:183]
 s_waitcnt lgkmcnt(10)
 buffer_load_dwordx4 v17, s[28:31], s56 offen offset:896 lds
 v_mfma_f32_16x16x32_bf16 v[180:183], a[104:107], a[208:211], v[180:183]
 v_mfma_f32_16x16x32_bf16 v[180:183], a[108:111], a[216:219], v[180:183]
 ds_read_b64_tr_b16 a[164:165], v2 offset:17152
 ds_read_b64_tr_b16 a[166:167], v2 offset:17280
 v_mfma_f32_16x16x32_bf16 v[188:191], a[108:111], a[220:223], 0
 v_cvt_pk_bf16_f32 v68, v68, v69
 v_cvt_pk_bf16_f32 v69, v70, v71
 v_mfma_f32_16x16x32_bf16 v[188:191], a[104:107], a[212:215], v[188:191]
 v_cvt_pk_bf16_f32 v70, v72, v73
 v_cvt_pk_bf16_f32 v71, v74, v75
 v_mfma_f32_16x16x32_bf16 v[188:191], a[100:103], a[204:207], v[188:191]
 ds_read_b64_tr_b16 a[168:169], v4 offset:16896
 ds_read_b64_tr_b16 a[170:171], v4 offset:17024
 v_mfma_f32_16x16x32_bf16 v[188:191], a[96:99], a[196:199], v[188:191]
 s_add_u32 m0, s40, 0x4340
 buffer_store_dwordx4 v[68:71], v10, s[32:35], s70 offen offset:0 nt
 v_mfma_f32_16x16x32_bf16 v[52:55], a[96:99], v[80:83], 0
 buffer_load_dwordx4 v17, s[28:31], s56 offen offset:1792 lds
 v_mfma_f32_16x16x32_bf16 v[52:55], a[100:103], v[84:87], v[52:55]
 ds_read_b64_tr_b16 a[172:173], v4 offset:17152
 ds_read_b64_tr_b16 a[174:175], v4 offset:17280
 v_mfma_f32_16x16x32_bf16 v[52:55], a[104:107], v[228:231], v[52:55]
 v_mfma_f32_16x16x32_bf16 v[52:55], a[108:111], v[236:239], v[52:55]
 s_waitcnt lgkmcnt(12)
 v_mfma_f32_16x16x32_bf16 v[196:199], a[112:115], a[192:195], 0
 ds_read_b64_tr_b16 a[176:177], v2 offset:16928
 ds_read_b64_tr_b16 a[178:179], v2 offset:17056
 v_mfma_f32_16x16x32_bf16 v[196:199], a[116:119], a[200:203], v[196:199]
 s_waitcnt lgkmcnt(10)
 v_mfma_f32_16x16x32_bf16 v[196:199], a[120:123], a[208:211], v[196:199]
 s_add_u32 m0, s40, 0x43e0
 v_mfma_f32_16x16x32_bf16 v[196:199], a[124:127], a[216:219], v[196:199]
 ds_read_b64_tr_b16 a[180:181], v2 offset:17184
 ds_read_b64_tr_b16 a[182:183], v2 offset:17312
 v_mfma_f32_16x16x32_bf16 v[212:215], a[124:127], a[220:223], 0
 buffer_load_dwordx4 v17, s[28:31], s56 offen offset:2688 lds
 v_mfma_f32_16x16x32_bf16 v[212:215], a[120:123], a[212:215], v[212:215]
 v_mfma_f32_16x16x32_bf16 v[212:215], a[116:119], a[204:207], v[212:215]
 ds_read_b64_tr_b16 a[184:185], v4 offset:16928
 ds_read_b64_tr_b16 a[186:187], v4 offset:17056
 v_mfma_f32_16x16x32_bf16 v[212:215], a[112:115], a[196:199], v[212:215]
 v_mfma_f32_16x16x32_bf16 v[56:59], a[112:115], v[80:83], 0
L_pad24:
 s_cbranch_execz L_e4_back
 v_mfma_f32_16x16x32_bf16 v[56:59], a[116:119], v[84:87], v[56:59]
 ds_read_b64_tr_b16 a[188:189], v4 offset:17184
 ds_read_b64_tr_b16 a[190:191], v4 offset:17312
 v_mfma_f32_16x16x32_bf16 v[56:59], a[120:123], v[228:231], v[56:59]
 v_mfma_f32_16x16x32_bf16 v[56:59], a[124:127], v[236:239], v[56:59]
 s_waitcnt lgkmcnt(12)
 v_mfma_f32_16x16x32_bf16 v[180:183], a[160:163], a[224:227], v[180:183]
 s_waitcnt vmcnt(12)
 s_barrier
 ds_read_b64_tr_b16 a[96:97], v2 offset:33792
 ds_read_b64_tr_b16 a[98:99], v2 offset:33920
 v_mfma_f32_16x16x32_bf16 v[180:183], a[164:167], a[232:235], v[180:183]
 s_waitcnt lgkmcnt(10)
 v_mfma_f32_16x16x32_bf16 v[180:183], a[168:171], a[240:243], v[180:183]
 s_add_u32 s56, s100, 0x1c0000
 v_mfma_f32_16x16x32_bf16 v[180:183], a[172:175], a[248:251], v[180:183]
 s_add_u32 m0, s40, 0x8400
 ds_read_b64_tr_b16 a[100:101], v2 offset:34048
 ds_read_b64_tr_b16 a[102:103], v2 offset:34176
 v_mfma_f32_16x16x32_bf16 v[188:191], a[172:175], a[252:255], v[188:191]
 buffer_load_dwordx4 v17, s[28:31], s56 offen offset:0 lds
 v_mfma_f32_16x16x32_bf16 v[188:191], a[168:171], a[244:247], v[188:191]
 v_mfma_f32_16x16x32_bf16 v[188:191], a[164:167], a[236:239], v[188:191]
 ds_read_b64_tr_b16 a[104:105], v4 offset:33792
 ds_read_b64_tr_b16 a[106:107], v4 offset:33920
 v_mfma_f32_16x16x32_bf16 v[188:191], a[160:163], a[228:231], v[188:191]
 v_mfma_f32_16x16x32_bf16 v[52:55], a[160:163], v[88:91], v[52:55]
 s_waitcnt vmcnt(10)
 v_readfirstlane_b32 s50, v29
 s_bitcmp0_b32 s50, 11
 s_cbranch_scc1 L_poll2
L_poll2_ret:
 v_mfma_f32_16x16x32_bf16 v[52:55], a[164:167], v[92:95], v[52:55]
 ds_read_b64_tr_b16 a[108:109], v4 offset:34048
 ds_read_b64_tr_b16 a[110:111], v4 offset:34176
 v_mfma_f32_16x16x32_bf16 v[52:55], a[168:171], v[244:247], v[52:55]
 buffer_load_dwordx4 a[64:67], v1, s[24:27], s66 offen offset:0 sc1
 v_mfma_f32_16x16x32_bf16 v[52:55], a[172:175], v[252:255], v[52:55]
 s_waitcnt lgkmcnt(12)
 v_mfma_f32_16x16x32_bf16 v[196:199], a[176:179], a[224:227], v[196:199]
 s_add_u32 m0, s40, 0x84a0
 ds_read_b64_tr_b16 a[112:113], v2 offset:33824
 ds_read_b64_tr_b16 a[114:115], v2 offset:33952
 v_mfma_f32_16x16x32_bf16 v[196:199], a[180:183], a[232:235], v[196:199]
 s_waitcnt lgkmcnt(10)
 buffer_load_dwordx4 v17, s[28:31], s56 offen offset:896 lds
 v_mfma_f32_16x16x32_bf16 v[196:199], a[184:187], a[240:243], v[196:199]
 v_mfma_f32_16x16x32_bf16 v[196:199], a[188:191], a[248:251], v[196:199]
 ds_read_b64_tr_b16 a[116:117], v2 offset:34080
 ds_read_b64_tr_b16 a[118:119], v2 offset:34208
 v_mfma_f32_16x16x32_bf16 v[212:215], a[188:191], a[252:255], v[212:215]
 v_mfma_f32_16x16x32_bf16 v[212:215], a[184:187], a[244:247], v[212:215]
 v_mfma_f32_16x16x32_bf16 v[212:215], a[180:183], a[236:239], v[212:215]
 ds_read_b64_tr_b16 a[120:121], v4 offset:33824
 ds_read_b64_tr_b16 a[122:123], v4 offset:33952
 v_mfma_f32_16x16x32_bf16 v[212:215], a[176:179], a[228:231], v[212:215]
 v_mfma_f32_16x16x32_bf16 v[56:59], a[176:179], v[88:91], v[56:59]
 v_mfma_f32_16x16x32_bf16 v[56:59], a[180:183], v[92:95], v[56:59]
 ds_read_b64_tr_b16 a[124:125], v4 offset:34080
 ds_read_b64_tr_b16 a[126:127], v4 offset:34208
 v_mfma_f32_16x16x32_bf16 v[56:59], a[184:187], v[244:247], v[56:59]
 s_add_u32 m0, s40, 0x8540
 buffer_load_dwordx4 a[68:71], v1, s[24:27], s66 offen offset:1024 sc1
 v_mfma_f32_16x16x32_bf16 v[56:59], a[188:191], v[252:255], v[56:59]
 s_waitcnt lgkmcnt(12)
 buffer_load_dwordx4 v17, s[28:31], s56 offen offset:1792 lds
 v_mfma_f32_16x16x32_bf16 v[180:183], a[96:99], v[96:99], v[180:183]
 ds_read_b64_tr_b16 a[160:161], v2 offset:50688
 ds_read_b64_tr_b16 a[162:163], v2 offset:50816
 v_mfma_f32_16x16x32_bf16 v[180:183], a[100:103], v[112:115], v[180:183]
 s_waitcnt lgkmcnt(10)
 v_mfma_f32_16x16x32_bf16 v[180:183], a[104:107], v[128:131], v[180:183]
 v_mfma_f32_16x16x32_bf16 v[180:183], a[108:111], v[144:147], v[180:183]
 ds_read_b64_tr_b16 a[164:165], v2 offset:50944
 ds_read_b64_tr_b16 a[166:167], v2 offset:51072
 v_mfma_f32_16x16x32_bf16 v[188:191], a[108:111], v[152:155], v[188:191]
 v_mfma_f32_16x16x32_bf16 v[188:191], a[104:107], v[136:139], v[188:191]
 v_mfma_f32_16x16x32_bf16 v[188:191], a[100:103], v[120:123], v[188:191]
 ds_read_b64_tr_b16 a[168:169], v4 offset:50688
 ds_read_b64_tr_b16 a[170:171], v4 offset:50816
 v_mfma_f32_16x16x32_bf16 v[188:191], a[96:99], v[104:107], v[188:191]
 v_mfma_f32_16x16x32_bf16 v[52:55], a[96:99], v[224:227], v[52:55]
 v_mfma_f32_16x16x32_bf16 v[52:55], a[100:103], v[232:235], v[52:55]
 s_add_u32 m0, s40, 0x85e0
 ds_read_b64_tr_b16 a[172:173], v4 offset:50944
 ds_read_b64_tr_b16 a[174:175], v4 offset:51072
 v_mfma_f32_16x16x32_bf16 v[52:55], a[104:107], a[128:131], v[52:55]
 buffer_load_dwordx4 a[72:75], v1, s[24:27], s66 offen offset:2048 sc1
 buffer_load_dwordx4 v17, s[28:31], s56 offen offset:2688 lds
 v_mfma_f32_16x16x32_bf16 v[52:55], a[108:111], a[136:139], v[52:55]
 s_waitcnt lgkmcnt(12)
 v_mfma_f32_16x16x32_bf16 v[196:199], a[112:115], v[96:99], v[196:199]
 ds_read_b64_tr_b16 a[176:177], v2 offset:50720
 ds_read_b64_tr_b16 a[178:179], v2 offset:50848
 v_mfma_f32_16x16x32_bf16 v[196:199], a[116:119], v[112:115], v[196:199]
 s_waitcnt lgkmcnt(10)
 v_mfma_f32_16x16x32_bf16 v[196:199], a[120:123], v[128:131], v[196:199]
 v_mfma_f32_16x16x32_bf16 v[196:199], a[124:127], v[144:147], v[196:199]
 ds_read_b64_tr_b16 a[180:181], v2 offset:50976
 ds_read_b64_tr_b16 a[182:183], v2 offset:51104
 v_mfma_f32_16x16x32_bf16 v[212:215], a[124:127], v[152:155], v[212:215]
 v_mfma_f32_16x16x32_bf16 v[212:215], a[120:123], v[136:139], v[212:215]
 v_mfma_f32_16x16x32_bf16 v[212:215], a[116:119], v[120:123], v[212:215]
 ds_read_b64_tr_b16 a[184:185], v4 offset:50720
 ds_read_b64_tr_b16 a[186:187], v4 offset:50848
 v_mfma_f32_16x16x32_bf16 v[212:215], a[112:115], v[104:107], v[212:215]
 v_mfma_f32_16x16x32_bf16 v[56:59], a[112:115], v[224:227], v[56:59]
 v_mfma_f32_16x16x32_bf16 v[56:59], a[116:119], v[232:235], v[56:59]
 ds_read_b64_tr_b16 a[188:189], v4 offset:50976
 ds_read_b64_tr_b16 a[190:191], v4 offset:51104
 v_mfma_f32_16x16x32_bf16 v[56:59], a[120:123], a[128:131], v[56:59]
 buffer_load_dwordx4 a[76:79], v1, s[24:27], s66 offen offset:3072 sc1
 v_mfma_f32_16x16x32_bf16 v[56:59], a[124:127], a[136:139], v[56:59]
 s_waitcnt lgkmcnt(12)
 v_mfma_f32_16x16x32_bf16 v[180:183], a[160:163], v[160:163], v[180:183]
 ds_read_b64_tr_b16 a[96:97], v3 offset:0
 ds_read_b64_tr_b16 a[98:99], v3 offset:128
 v_mfma_f32_16x16x32_bf16 v[180:183], a[164:167], v[176:179], v[180:183]
 s_waitcnt lgkmcnt(10)
 v_mfma_f32_16x16x32_bf16 v[180:183], a[168:171], v[192:195], v[180:183]
 s_add_u32 s56, s100, 0x1dc000
 v_mfma_f32_16x16x32_bf16 v[180:183], a[172:175], v[208:211], v[180:183]
 s_add_u32 m0, s40, 0xc600
 ds_read_b64_tr_b16 a[100:101], v3 offset:256
 ds_read_b64_tr_b16 a[102:103], v3 offset:384
 v_mfma_f32_16x16x32_bf16 v[188:191], a[172:175], v[216:219], v[188:191]
 buffer_load_dwordx4 v17, s[28:31], s56 offen offset:0 lds
 v_mfma_f32_16x16x32_bf16 v[188:191], a[168:171], v[200:203], v[188:191]
 v_mfma_f32_16x16x32_bf16 v[188:191], a[164:167], v[184:187], v[188:191]
 ds_read_b64_tr_b16 a[104:105], v5 offset:0
 ds_read_b64_tr_b16 a[106:107], v5 offset:128
 v_mfma_f32_16x16x32_bf16 v[188:191], a[160:163], v[168:171], v[188:191]
 v_mfma_f32_16x16x32_bf16 v[52:55], a[160:163], v[240:243], v[52:55]
 v_mfma_f32_16x16x32_bf16 v[52:55], a[164:167], v[248:251], v[52:55]
 ds_read_b64_tr_b16 a[108:109], v5 offset:256
 ds_read_b64_tr_b16 a[110:111], v5 offset:384
 v_mfma_f32_16x16x32_bf16 v[52:55], a[168:171], a[144:147], v[52:55]
 buffer_load_dwordx4 a[80:83], v18, s[24:27], s66 offen offset:0 sc1
 v_mfma_f32_16x16x32_bf16 v[52:55], a[172:175], a[152:155], v[52:55]
 s_waitcnt lgkmcnt(12)
 v_mfma_f32_16x16x32_bf16 v[196:199], a[176:179], v[160:163], v[196:199]
 ds_read_b64_tr_b16 a[112:113], v3 offset:32
 ds_read_b64_tr_b16 a[114:115], v3 offset:160
 v_mfma_f32_16x16x32_bf16 v[196:199], a[180:183], v[176:179], v[196:199]
 s_waitcnt lgkmcnt(10)
 v_mfma_f32_16x16x32_bf16 v[196:199], a[184:187], v[192:195], v[196:199]
 v_mfma_f32_16x16x32_bf16 v[196:199], a[188:191], v[208:211], v[196:199]
 ds_read_b64_tr_b16 a[116:117], v3 offset:288
 ds_read_b64_tr_b16 a[118:119], v3 offset:416
 v_mfma_f32_16x16x32_bf16 v[212:215], a[188:191], v[216:219], v[212:215]
 v_mfma_f32_16x16x32_bf16 v[212:215], a[184:187], v[200:203], v[212:215]
 s_add_u32 m0, s40, 0xc6a0
 v_mfma_f32_16x16x32_bf16 v[212:215], a[180:183], v[184:187], v[212:215]
 ds_read_b64_tr_b16 a[120:121], v5 offset:32
 ds_read_b64_tr_b16 a[122:123], v5 offset:160
 v_mfma_f32_16x16x32_bf16 v[212:215], a[176:179], v[168:171], v[212:215]
 buffer_load_dwordx4 v17, s[28:31], s56 offen offset:896 lds
 v_mfma_f32_16x16x32_bf16 v[56:59], a[176:179], v[240:243], v[56:59]
 v_mfma_f32_16x16x32_bf16 v[56:59], a[180:183], v[248:251], v[56:59]
 ds_read_b64_tr_b16 a[124:125], v5 offset:288
 ds_read_b64_tr_b16 a[126:127], v5 offset:416
 v_mfma_f32_16x16x32_bf16 v[56:59], a[184:187], a[144:147], v[56:59]
 buffer_load_dwordx4 a[84:87], v18, s[24:27], s66 offen offset:1024 sc1
 v_mfma_f32_16x16x32_bf16 v[56:59], a[188:191], a[152:155], v[56:59]
 s_waitcnt lgkmcnt(12)
 v_mfma_f32_16x16x32_bf16 v[220:223], a[96:99], a[192:195], 0
 ds_read_b64_tr_b16 a[160:161], v3 offset:16896
 ds_read_b64_tr_b16 a[162:163], v3 offset:17024
 v_mfma_f32_16x16x32_bf16 v[220:223], a[100:103], a[200:203], v[220:223]
 s_waitcnt lgkmcnt(10)
 v_mfma_f32_16x16x32_bf16 v[220:223], a[104:107], a[208:211], v[220:223]
 ds_read_b64_tr_b16 a[164:165], v3 offset:17152
 ds_read_b64_tr_b16 a[166:167], v3 offset:17280
 v_mfma_f32_16x16x32_bf16 v[220:223], a[108:111], a[216:219], v[220:223]
 s_add_u32 s55, s13, 0xc8000
 v_cvt_pk_bf16_f32 v180, v180, v181
 v_cvt_pk_bf16_f32 v181, v182, v183
 v_mfma_f32_16x16x32_bf16 v[20:23], a[108:111], a[220:223], 0
 ds_read_b64_tr_b16 a[168:169], v5 offset:16896
 ds_read_b64_tr_b16 a[170:171], v5 offset:17024
 v_mfma_f32_16x16x32_bf16 v[20:23], a[104:107], a[212:215], v[20:23]
 v_cvt_pk_bf16_f32 v182, v196, v197
 v_cvt_pk_bf16_f32 v183, v198, v199
 v_mfma_f32_16x16x32_bf16 v[20:23], a[100:103], a[204:207], v[20:23]
 ds_read_b64_tr_b16 a[172:173], v5 offset:17152
 ds_read_b64_tr_b16 a[174:175], v5 offset:17280
 v_mfma_f32_16x16x32_bf16 v[20:23], a[96:99], a[196:199], v[20:23]
 s_waitcnt lgkmcnt(12)
 buffer_store_dwordx4 v[180:183], v1, s[24:27], s55 offen offset:0 sc1
 v_mfma_f32_16x16x32_bf16 v[44:47], a[112:115], a[192:195], 0
 ds_read_b64_tr_b16 a[176:177], v3 offset:16928
 ds_read_b64_tr_b16 a[178:179], v3 offset:17056
 v_mfma_f32_16x16x32_bf16 v[44:47], a[116:119], a[200:203], v[44:47]
 s_waitcnt lgkmcnt(10)
 v_mfma_f32_16x16x32_bf16 v[44:47], a[120:123], a[208:211], v[44:47]
 s_add_u32 s55, s14, 0xca000
 ds_read_b64_tr_b16 a[180:181], v3 offset:17184
 ds_read_b64_tr_b16 a[182:183], v3 offset:17312
 v_mfma_f32_16x16x32_bf16 v[44:47], a[124:127], a[216:219], v[44:47]
 s_add_u32 m0, s40, 0xc740
 v_cvt_pk_bf16_f32 v188, v188, v189
 v_cvt_pk_bf16_f32 v189, v190, v191
 v_mfma_f32_16x16x32_bf16 v[48:51], a[124:127], a[220:223], 0
 ds_read_b64_tr_b16 a[184:185], v5 offset:16928
 ds_read_b64_tr_b16 a[186:187], v5 offset:17056
 v_cvt_pk_bf16_f32 v190, v212, v213
 v_cvt_pk_bf16_f32 v191, v214, v215
 v_cvt_pk_bf16_f32 v52, v52, v53
 v_cvt_pk_bf16_f32 v53, v54, v55
 v_cvt_pk_bf16_f32 v54, v56, v57
 v_cvt_pk_bf16_f32 v55, v58, v59
 buffer_store_dwordx4 v[188:191], v1, s[24:27], s55 offen offset:0 sc1
 s_add_u32 s55, s15, 0xcc000
 buffer_store_dwordx4 v[52:55], v1, s[24:27], s55 offen offset:0 sc1
 v_mfma_f32_16x16x32_bf16 v[48:51], a[120:123], a[212:215], v[48:51]
 buffer_load_dwordx4 a[88:91], v18, s[24:27], s66 offen offset:2048 sc1
 buffer_load_dwordx4 v17, s[28:31], s56 offen offset:1792 lds
 v_mfma_f32_16x16x32_bf16 v[48:51], a[116:119], a[204:207], v[48:51]
 ds_read_b64_tr_b16 a[188:189], v5 offset:17184
 ds_read_b64_tr_b16 a[190:191], v5 offset:17312
 v_mfma_f32_16x16x32_bf16 v[48:51], a[112:115], a[196:199], v[48:51]
 s_waitcnt lgkmcnt(12)
 v_mfma_f32_16x16x32_bf16 v[220:223], a[160:163], a[224:227], v[220:223]
 ds_read_b64_tr_b16 a[96:97], v3 offset:33792
 ds_read_b64_tr_b16 a[98:99], v3 offset:33920
 v_mfma_f32_16x16x32_bf16 v[220:223], a[164:167], a[232:235], v[220:223]
 s_waitcnt lgkmcnt(10)
 v_mfma_f32_16x16x32_bf16 v[220:223], a[168:171], a[240:243], v[220:223]
 ds_read_b64_tr_b16 a[100:101], v3 offset:34048
 ds_read_b64_tr_b16 a[102:103], v3 offset:34176
 v_mfma_f32_16x16x32_bf16 v[220:223], a[172:175], a[248:251], v[220:223]
 s_cmp_eq_u32 s59, 5
 s_cselect_b64 vcc, -1, 0
 v_cndmask_b32 v76, v76, v180, vcc
 v_mfma_f32_16x16x32_bf16 v[20:23], a[172:175], a[252:255], v[20:23]
 ds_read_b64_tr_b16 a[104:105], v5 offset:33792
 ds_read_b64_tr_b16 a[106:107], v5 offset:33920
 v_mfma_f32_16x16x32_bf16 v[20:23], a[168:171], a[244:247], v[20:23]
 v_cndmask_b32 v77, v77, v181, vcc
 v_cndmask_b32 v78, v78, v182, vcc
 v_mfma_f32_16x16x32_bf16 v[20:23], a[164:167], a[236:239], v[20:23]
 ds_read_b64_tr_b16 a[108:109], v5 offset:34048
 ds_read_b64_tr_b16 a[110:111], v5 offset:34176
 v_mfma_f32_16x16x32_bf16 v[20:23], a[160:163], a[228:231], v[20:23]
 s_waitcnt lgkmcnt(12)
 v_cndmask_b32 v79, v79, v183, vcc
 v_mfma_f32_16x16x32_bf16 v[44:47], a[176:179], a[224:227], v[44:47]
 ds_read_b64_tr_b16 a[112:113], v3 offset:33824
 ds_read_b64_tr_b16 a[114:115], v3 offset:33952
 v_mfma_f32_16x16x32_bf16 v[44:47], a[180:183], a[232:235], v[44:47]
 s_waitcnt lgkmcnt(10)
 v_mfma_f32_16x16x32_bf16 v[44:47], a[184:187], a[240:243], v[44:47]
 ds_read_b64_tr_b16 a[116:117], v3 offset:34080
 ds_read_b64_tr_b16 a[118:119], v3 offset:34208
 v_mfma_f32_16x16x32_bf16 v[44:47], a[188:191], a[248:251], v[44:47]
 s_add_u32 m0, s40, 0xc7e0
 v_mfma_f32_16x16x32_bf16 v[48:51], a[188:191], a[252:255], v[48:51]
 ds_read_b64_tr_b16 a[120:121], v5 offset:33824
 ds_read_b64_tr_b16 a[122:123], v5 offset:33952
 v_mfma_f32_16x16x32_bf16 v[48:51], a[184:187], a[244:247], v[48:51]
 s_cmp_eq_u32 s59, 6
 s_cselect_b64 vcc, -1, 0
 buffer_load_dwordx4 v17, s[28:31], s56 offen offset:2688 lds
 v_mfma_f32_16x16x32_bf16 v[48:51], a[180:183], a[236:239], v[48:51]
 s_add_u32 s100, s100, 0x80
 ds_read_b64_tr_b16 a[124:125], v5 offset:34080
 ds_read_b64_tr_b16 a[126:127], v5 offset:34208
 v_mfma_f32_16x16x32_bf16 v[48:51], a[176:179], a[228:231], v[48:51]
 s_waitcnt lgkmcnt(12)
 v_cndmask_b32 v76, v76, v188, vcc
 v_cndmask_b32 v77, v77, v189, vcc
 v_mfma_f32_16x16x32_bf16 v[220:223], a[96:99], v[96:99], v[220:223]
 s_sub_u32 s56, s100, 0x380
 ds_read_b64_tr_b16 a[160:161], v3 offset:50688
 ds_read_b64_tr_b16 a[162:163], v3 offset:50816
 v_mfma_f32_16x16x32_bf16 v[220:223], a[100:103], v[112:115], v[220:223]
 s_waitcnt lgkmcnt(10)
 v_cndmask_b32 v78, v78, v190, vcc
 v_cndmask_b32 v79, v79, v191, vcc
 v_mfma_f32_16x16x32_bf16 v[220:223], a[104:107], v[128:131], v[220:223]
 s_min_u32 s100, s100, s56
 ds_read_b64_tr_b16 a[164:165], v3 offset:50944
 ds_read_b64_tr_b16 a[166:167], v3 offset:51072
 v_mfma_f32_16x16x32_bf16 v[220:223], a[108:111], v[144:147], v[220:223]
 s_cmp_eq_u32 s59, 7
 s_cselect_b64 vcc, -1, 0
 v_cndmask_b32 v76, v76, v52, vcc
 v_mfma_f32_16x16x32_bf16 v[20:23], a[108:111], v[152:155], v[20:23]
 ds_read_b64_tr_b16 a[168:169], v5 offset:50688
 ds_read_b64_tr_b16 a[170:171], v5 offset:50816
 v_mfma_f32_16x16x32_bf16 v[20:23], a[104:107], v[136:139], v[20:23]
 v_cndmask_b32 v77, v77, v53, vcc
 v_cndmask_b32 v78, v78, v54, vcc
 v_mfma_f32_16x16x32_bf16 v[20:23], a[100:103], v[120:123], v[20:23]
 ds_read_b64_tr_b16 a[172:173], v5 offset:50944
 ds_read_b64_tr_b16 a[174:175], v5 offset:51072
 v_mfma_f32_16x16x32_bf16 v[20:23], a[96:99], v[104:107], v[20:23]
 s_waitcnt lgkmcnt(12)
 v_cndmask_b32 v79, v79, v55, vcc
 v_mfma_f32_16x16x32_bf16 v[44:47], a[112:115], v[96:99], v[44:47]
 ds_read_b64_tr_b16 a[176:177], v3 offset:50720
 ds_read_b64_tr_b16 a[178:179], v3 offset:50848
 v_mfma_f32_16x16x32_bf16 v[44:47], a[116:119], v[112:115], v[44:47]
 s_waitcnt lgkmcnt(10)
 v_mfma_f32_16x16x32_bf16 v[44:47], a[120:123], v[128:131], v[44:47]
 ds_read_b64_tr_b16 a[180:181], v3 offset:50976
 ds_read_b64_tr_b16 a[182:183], v3 offset:51104
 v_mfma_f32_16x16x32_bf16 v[44:47], a[124:127], v[144:147], v[44:47]
 v_mfma_f32_16x16x32_bf16 v[48:51], a[124:127], v[152:155], v[48:51]
 ds_read_b64_tr_b16 a[184:185], v5 offset:50720
 ds_read_b64_tr_b16 a[186:187], v5 offset:50848
 v_mfma_f32_16x16x32_bf16 v[48:51], a[120:123], v[136:139], v[48:51]
 v_mfma_f32_16x16x32_bf16 v[48:51], a[116:119], v[120:123], v[48:51]
 ds_read_b64_tr_b16 a[188:189], v5 offset:50976
 ds_read_b64_tr_b16 a[190:191], v5 offset:51104
 v_mfma_f32_16x16x32_bf16 v[48:51], a[112:115], v[104:107], v[48:51]
 s_waitcnt lgkmcnt(12)
 v_mfma_f32_16x16x32_bf16 v[220:223], a[160:163], v[160:163], v[220:223]
 s_waitcnt vmcnt(3)
 s_barrier
 ds_read_b64_tr_b16 a[96:97], v6 offset:0
 ds_read_b64_tr_b16 a[98:99], v6 offset:128
 v_mfma_f32_16x16x32_bf16 v[220:223], a[164:167], v[176:179], v[220:223]
 s_waitcnt lgkmcnt(10)
 v_mov_b32 v11, 0x1000
 v_mfma_f32_16x16x32_bf16 v[220:223], a[168:171], v[192:195], v[220:223]
 ds_read_b64_tr_b16 a[100:101], v6 offset:256
 ds_read_b64_tr_b16 a[102:103], v6 offset:384
 v_mfma_f32_16x16x32_bf16 v[220:223], a[172:175], v[208:211], v[220:223]
 buffer_atomic_add v11, v27, s[36:39], 0 offen
 v_mfma_f32_16x16x32_bf16 v[20:23], a[172:175], v[216:219], v[20:23]
 ds_read_b64_tr_b16 a[104:105], v8 offset:0
 ds_read_b64_tr_b16 a[106:107], v8 offset:128
 v_mfma_f32_16x16x32_bf16 v[20:23], a[168:171], v[200:203], v[20:23]
 v_mfma_f32_16x16x32_bf16 v[20:23], a[164:167], v[184:187], v[20:23]
 ds_read_b64_tr_b16 a[108:109], v8 offset:256
 ds_read_b64_tr_b16 a[110:111], v8 offset:384
 v_mfma_f32_16x16x32_bf16 v[20:23], a[160:163], v[168:171], v[20:23]
 s_waitcnt lgkmcnt(12)
 v_mfma_f32_16x16x32_bf16 v[44:47], a[176:179], v[160:163], v[44:47]
 ds_read_b64_tr_b16 a[112:113], v6 offset:32
 ds_read_b64_tr_b16 a[114:115], v6 offset:160
 v_mfma_f32_16x16x32_bf16 v[44:47], a[180:183], v[176:179], v[44:47]
 s_waitcnt lgkmcnt(10)
 v_mfma_f32_16x16x32_bf16 v[44:47], a[184:187], v[192:195], v[44:47]
 ds_read_b64_tr_b16 a[116:117], v6 offset:288
 ds_read_b64_tr_b16 a[118:119], v6 offset:416
 v_mfma_f32_16x16x32_bf16 v[44:47], a[188:191], v[208:211], v[44:47]
 v_mfma_f32_16x16x32_bf16 v[48:51], a[188:191], v[216:219], v[48:51]
 ds_read_b64_tr_b16 a[120:121], v8 offset:32
 ds_read_b64_tr_b16 a[122:123], v8 offset:160
 v_mfma_f32_16x16x32_bf16 v[48:51], a[184:187], v[200:203], v[48:51]
 v_mfma_f32_16x16x32_bf16 v[48:51], a[180:183], v[184:187], v[48:51]
 ds_read_b64_tr_b16 a[124:125], v8 offset:288
 ds_read_b64_tr_b16 a[126:127], v8 offset:416
 v_mfma_f32_16x16x32_bf16 v[48:51], a[176:179], v[168:171], v[48:51]
 s_waitcnt vmcnt(3)
 v_mfma_f32_16x16x32_bf16 v[60:63], v[12:15], a[64:67], 0
 v_mfma_f32_16x16x32_bf16 v[60:63], v[12:15], a[68:71], v[60:63]
 v_mfma_f32_16x16x32_bf16 v[60:63], v[12:15], a[72:75], v[60:63]
 v_mfma_f32_16x16x32_bf16 v[60:63], v[12:15], a[76:79], v[60:63]
 s_add_u32 s55, s8, 0xce000
 v_cvt_pk_bf16_f32 v220, v220, v221
 v_cvt_pk_bf16_f32 v221, v222, v223
 v_mfma_f32_16x16x32_bf16 v[60:63], v[12:15], a[80:83], v[60:63]
 v_cvt_pk_bf16_f32 v222, v44, v45
 v_cvt_pk_bf16_f32 v223, v46, v47
 v_mfma_f32_16x16x32_bf16 v[60:63], v[12:15], a[84:87], v[60:63]
 buffer_store_dwordx4 v[220:223], v1, s[24:27], s55 offen offset:0 sc1
 v_mov_b32 v32, v220
 v_mfma_f32_16x16x32_bf16 v[60:63], v[12:15], a[88:91], v[60:63]
 v_mov_b32 v33, v221
 v_mov_b32 v34, v222
 v_mfma_f32_16x16x32_bf16 v[60:63], v[12:15], v[36:39], v[60:63]
 v_mov_b32 v35, v223
 v_mfma_f32_16x16x32_bf16 v[64:67], v[204:207], a[64:67], 0
 v_mfma_f32_16x16x32_bf16 v[64:67], v[204:207], a[68:71], v[64:67]
 v_mfma_f32_16x16x32_bf16 v[64:67], v[204:207], a[72:75], v[64:67]
 s_add_u32 s55, s9, 0xd0000
 v_cvt_pk_bf16_f32 v20, v20, v21
 v_cvt_pk_bf16_f32 v21, v22, v23
 v_mfma_f32_16x16x32_bf16 v[64:67], v[204:207], a[76:79], v[64:67]
 v_cvt_pk_bf16_f32 v22, v48, v49
 v_cvt_pk_bf16_f32 v23, v50, v51
 v_mfma_f32_16x16x32_bf16 v[64:67], v[204:207], a[80:83], v[64:67]
 s_cmp_eq_u32 s59, 1
 s_cselect_b64 vcc, -1, 0
 buffer_store_dwordx4 v[20:23], v1, s[24:27], s55 offen offset:0 sc1
 v_mfma_f32_16x16x32_bf16 v[64:67], v[204:207], a[84:87], v[64:67]
 v_cndmask_b32 v32, v32, v20, vcc
 v_cndmask_b32 v33, v33, v21, vcc
 v_mfma_f32_16x16x32_bf16 v[64:67], v[204:207], a[88:91], v[64:67]
 v_cndmask_b32 v34, v34, v22, vcc
 v_cndmask_b32 v35, v35, v23, vcc
 v_mfma_f32_16x16x32_bf16 v[64:67], v[204:207], v[36:39], v[64:67]
 s_waitcnt lgkmcnt(12)
 v_mfma_f32_16x16x32_bf16 v[100:103], a[96:99], a[192:195], 0
 ds_read_b64_tr_b16 a[160:161], v6 offset:16896
 ds_read_b64_tr_b16 a[162:163], v6 offset:17024
 v_mfma_f32_16x16x32_bf16 v[100:103], a[100:103], a[200:203], v[100:103]
 s_waitcnt lgkmcnt(10)
 v_mfma_f32_16x16x32_bf16 v[100:103], a[104:107], a[208:211], v[100:103]
 v_mfma_f32_16x16x32_bf16 v[100:103], a[108:111], a[216:219], v[100:103]
 ds_read_b64_tr_b16 a[164:165], v6 offset:17152
 ds_read_b64_tr_b16 a[166:167], v6 offset:17280
 v_mfma_f32_16x16x32_bf16 v[108:111], a[108:111], a[220:223], 0
 v_cvt_pk_bf16_f32 v60, v60, v61
 v_cvt_pk_bf16_f32 v61, v62, v63
 v_mfma_f32_16x16x32_bf16 v[108:111], a[104:107], a[212:215], v[108:111]
 v_cvt_pk_bf16_f32 v62, v64, v65
 v_cvt_pk_bf16_f32 v63, v66, v67
 v_mfma_f32_16x16x32_bf16 v[108:111], a[100:103], a[204:207], v[108:111]
 ds_read_b64_tr_b16 a[168:169], v8 offset:16896
 ds_read_b64_tr_b16 a[170:171], v8 offset:17024
 v_mfma_f32_16x16x32_bf16 v[108:111], a[96:99], a[196:199], v[108:111]
 buffer_store_dwordx4 v[60:63], v10, s[32:35], s71 offen offset:0 nt
 v_mfma_f32_16x16x32_bf16 v[164:167], a[96:99], v[80:83], 0
 v_mfma_f32_16x16x32_bf16 v[164:167], a[100:103], v[84:87], v[164:167]
 ds_read_b64_tr_b16 a[172:173], v8 offset:17152
 ds_read_b64_tr_b16 a[174:175], v8 offset:17280
 v_mfma_f32_16x16x32_bf16 v[164:167], a[104:107], v[228:231], v[164:167]
 v_mfma_f32_16x16x32_bf16 v[164:167], a[108:111], v[236:239], v[164:167]
 s_waitcnt lgkmcnt(12)
 v_mfma_f32_16x16x32_bf16 v[116:119], a[112:115], a[192:195], 0
 ds_read_b64_tr_b16 a[176:177], v6 offset:16928
 ds_read_b64_tr_b16 a[178:179], v6 offset:17056
 v_mfma_f32_16x16x32_bf16 v[116:119], a[116:119], a[200:203], v[116:119]
 s_waitcnt lgkmcnt(10)
 v_mfma_f32_16x16x32_bf16 v[116:119], a[120:123], a[208:211], v[116:119]
 v_mfma_f32_16x16x32_bf16 v[116:119], a[124:127], a[216:219], v[116:119]
 ds_read_b64_tr_b16 a[180:181], v6 offset:17184
 ds_read_b64_tr_b16 a[182:183], v6 offset:17312
 v_mfma_f32_16x16x32_bf16 v[124:127], a[124:127], a[220:223], 0
 v_mfma_f32_16x16x32_bf16 v[124:127], a[120:123], a[212:215], v[124:127]
 v_mfma_f32_16x16x32_bf16 v[124:127], a[116:119], a[204:207], v[124:127]
 ds_read_b64_tr_b16 a[184:185], v8 offset:16928
 ds_read_b64_tr_b16 a[186:187], v8 offset:17056
 v_mfma_f32_16x16x32_bf16 v[124:127], a[112:115], a[196:199], v[124:127]
 v_mfma_f32_16x16x32_bf16 v[172:175], a[112:115], v[80:83], 0
 v_mfma_f32_16x16x32_bf16 v[172:175], a[116:119], v[84:87], v[172:175]
 ds_read_b64_tr_b16 a[188:189], v8 offset:17184
 ds_read_b64_tr_b16 a[190:191], v8 offset:17312
 v_mfma_f32_16x16x32_bf16 v[172:175], a[120:123], v[228:231], v[172:175]
 v_mfma_f32_16x16x32_bf16 v[172:175], a[124:127], v[236:239], v[172:175]
 s_waitcnt lgkmcnt(12)
 v_mfma_f32_16x16x32_bf16 v[100:103], a[160:163], a[224:227], v[100:103]
 s_waitcnt vmcnt(4)
 s_barrier
 ds_read_b64_tr_b16 a[96:97], v6 offset:33792
 ds_read_b64_tr_b16 a[98:99], v6 offset:33920
 v_mfma_f32_16x16x32_bf16 v[100:103], a[164:167], a[232:235], v[100:103]
 s_waitcnt lgkmcnt(10)
 v_mfma_f32_16x16x32_bf16 v[100:103], a[168:171], a[240:243], v[100:103]
 v_mfma_f32_16x16x32_bf16 v[100:103], a[172:175], a[248:251], v[100:103]
 ds_read_b64_tr_b16 a[100:101], v6 offset:34048
 ds_read_b64_tr_b16 a[102:103], v6 offset:34176
 v_mfma_f32_16x16x32_bf16 v[108:111], a[172:175], a[252:255], v[108:111]
 v_mfma_f32_16x16x32_bf16 v[108:111], a[168:171], a[244:247], v[108:111]
 v_mfma_f32_16x16x32_bf16 v[108:111], a[164:167], a[236:239], v[108:111]
 ds_read_b64_tr_b16 a[104:105], v8 offset:33792
 ds_read_b64_tr_b16 a[106:107], v8 offset:33920
 v_mfma_f32_16x16x32_bf16 v[108:111], a[160:163], a[228:231], v[108:111]
 buffer_load_dword v29, v28, s[36:39], 0 offen offset:0 sc1
 v_mfma_f32_16x16x32_bf16 v[164:167], a[160:163], v[88:91], v[164:167]
 v_mfma_f32_16x16x32_bf16 v[164:167], a[164:167], v[92:95], v[164:167]
 ds_read_b64_tr_b16 a[108:109], v8 offset:34048
 ds_read_b64_tr_b16 a[110:111], v8 offset:34176
 v_mfma_f32_16x16x32_bf16 v[164:167], a[168:171], v[244:247], v[164:167]
 v_mfma_f32_16x16x32_bf16 v[164:167], a[172:175], v[252:255], v[164:167]
 s_waitcnt lgkmcnt(12)
 v_mfma_f32_16x16x32_bf16 v[116:119], a[176:179], a[224:227], v[116:119]
 ds_read_b64_tr_b16 a[112:113], v6 offset:33824
 ds_read_b64_tr_b16 a[114:115], v6 offset:33952
 v_mfma_f32_16x16x32_bf16 v[116:119], a[180:183], a[232:235], v[116:119]
 s_waitcnt lgkmcnt(10)
 v_mfma_f32_16x16x32_bf16 v[116:119], a[184:187], a[240:243], v[116:119]
 v_mfma_f32_16x16x32_bf16 v[116:119], a[188:191], a[248:251], v[116:119]
 ds_read_b64_tr_b16 a[116:117], v6 offset:34080
 ds_read_b64_tr_b16 a[118:119], v6 offset:34208
 v_mfma_f32_16x16x32_bf16 v[124:127], a[188:191], a[252:255], v[124:127]
 v_mfma_f32_16x16x32_bf16 v[124:127], a[184:187], a[244:247], v[124:127]
 v_mfma_f32_16x16x32_bf16 v[124:127], a[180:183], a[236:239], v[124:127]
 ds_read_b64_tr_b16 a[120:121], v8 offset:33824
 ds_read_b64_tr_b16 a[122:123], v8 offset:33952
 v_mfma_f32_16x16x32_bf16 v[124:127], a[176:179], a[228:231], v[124:127]
 v_mfma_f32_16x16x32_bf16 v[172:175], a[176:179], v[88:91], v[172:175]
 v_mfma_f32_16x16x32_bf16 v[172:175], a[180:183], v[92:95], v[172:175]
 ds_read_b64_tr_b16 a[124:125], v8 offset:34080
 ds_read_b64_tr_b16 a[126:127], v8 offset:34208
 v_mfma_f32_16x16x32_bf16 v[172:175], a[184:187], v[244:247], v[172:175]
 v_mfma_f32_16x16x32_bf16 v[172:175], a[188:191], v[252:255], v[172:175]
 s_waitcnt lgkmcnt(12)
 v_mfma_f32_16x16x32_bf16 v[100:103], a[96:99], v[96:99], v[100:103]
 ds_read_b64_tr_b16 a[160:161], v6 offset:50688
 ds_read_b64_tr_b16 a[162:163], v6 offset:50816
 v_mfma_f32_16x16x32_bf16 v[100:103], a[100:103], v[112:115], v[100:103]
 s_waitcnt lgkmcnt(10)
 v_mfma_f32_16x16x32_bf16 v[100:103], a[104:107], v[128:131], v[100:103]
 v_mfma_f32_16x16x32_bf16 v[100:103], a[108:111], v[144:147], v[100:103]
 ds_read_b64_tr_b16 a[164:165], v6 offset:50944
 ds_read_b64_tr_b16 a[166:167], v6 offset:51072
 v_mfma_f32_16x16x32_bf16 v[108:111], a[108:111], v[152:155], v[108:111]
 v_mfma_f32_16x16x32_bf16 v[108:111], a[104:107], v[136:139], v[108:111]
 v_mfma_f32_16x16x32_bf16 v[108:111], a[100:103], v[120:123], v[108:111]
 ds_read_b64_tr_b16 a[168:169], v8 offset:50688
 ds_read_b64_tr_b16 a[170:171], v8 offset:50816
 v_mfma_f32_16x16x32_bf16 v[108:111], a[96:99], v[104:107], v[108:111]
 v_mfma_f32_16x16x32_bf16 v[164:167], a[96:99], v[224:227], v[164:167]
 v_mfma_f32_16x16x32_bf16 v[164:167], a[100:103], v[232:235], v[164:167]
 ds_read_b64_tr_b16 a[172:173], v8 offset:50944
 ds_read_b64_tr_b16 a[174:175], v8 offset:51072
 v_mfma_f32_16x16x32_bf16 v[164:167], a[104:107], a[128:131], v[164:167]
 v_mfma_f32_16x16x32_bf16 v[164:167], a[108:111], a[136:139], v[164:167]
 s_waitcnt lgkmcnt(12)
 v_mfma_f32_16x16x32_bf16 v[116:119], a[112:115], v[96:99], v[116:119]
 ds_read_b64_tr_b16 a[176:177], v6 offset:50720
 ds_read_b64_tr_b16 a[178:179], v6 offset:50848
 v_mfma_f32_16x16x32_bf16 v[116:119], a[116:119], v[112:115], v[116:119]
 s_waitcnt lgkmcnt(10)
 v_mfma_f32_16x16x32_bf16 v[116:119], a[120:123], v[128:131], v[116:119]
 v_mfma_f32_16x16x32_bf16 v[116:119], a[124:127], v[144:147], v[116:119]
 ds_read_b64_tr_b16 a[180:181], v6 offset:50976
 ds_read_b64_tr_b16 a[182:183], v6 offset:51104
 v_mfma_f32_16x16x32_bf16 v[124:127], a[124:127], v[152:155], v[124:127]
 v_mfma_f32_16x16x32_bf16 v[124:127], a[120:123], v[136:139], v[124:127]
 v_mfma_f32_16x16x32_bf16 v[124:127], a[116:119], v[120:123], v[124:127]
 ds_read_b64_tr_b16 a[184:185], v8 offset:50720
 ds_read_b64_tr_b16 a[186:187], v8 offset:50848
 v_mfma_f32_16x16x32_bf16 v[124:127], a[112:115], v[104:107], v[124:127]
 v_mfma_f32_16x16x32_bf16 v[172:175], a[112:115], v[224:227], v[172:175]
 v_mfma_f32_16x16x32_bf16 v[172:175], a[116:119], v[232:235], v[172:175]
 ds_read_b64_tr_b16 a[188:189], v8 offset:50976
 ds_read_b64_tr_b16 a[190:191], v8 offset:51104
 v_mfma_f32_16x16x32_bf16 v[172:175], a[120:123], a[128:131], v[172:175]
 v_mfma_f32_16x16x32_bf16 v[172:175], a[124:127], a[136:139], v[172:175]
 s_waitcnt lgkmcnt(12)
 v_mfma_f32_16x16x32_bf16 v[100:103], a[160:163], v[160:163], v[100:103]
 ds_read_b64_tr_b16 a[96:97], v7 offset:0
 ds_read_b64_tr_b16 a[98:99], v7 offset:128
 v_mfma_f32_16x16x32_bf16 v[100:103], a[164:167], v[176:179], v[100:103]
 s_waitcnt lgkmcnt(10)
 v_mfma_f32_16x16x32_bf16 v[100:103], a[168:171], v[192:195], v[100:103]
 v_mfma_f32_16x16x32_bf16 v[100:103], a[172:175], v[208:211], v[100:103]
 ds_read_b64_tr_b16 a[100:101], v7 offset:256
 ds_read_b64_tr_b16 a[102:103], v7 offset:384
 v_mfma_f32_16x16x32_bf16 v[108:111], a[172:175], v[216:219], v[108:111]
 v_mfma_f32_16x16x32_bf16 v[108:111], a[168:171], v[200:203], v[108:111]
 v_mfma_f32_16x16x32_bf16 v[108:111], a[164:167], v[184:187], v[108:111]
 ds_read_b64_tr_b16 a[104:105], v9 offset:0
 ds_read_b64_tr_b16 a[106:107], v9 offset:128
 v_mfma_f32_16x16x32_bf16 v[108:111], a[160:163], v[168:171], v[108:111]
 v_mfma_f32_16x16x32_bf16 v[164:167], a[160:163], v[240:243], v[164:167]
 s_waitcnt vmcnt(0)
 v_readfirstlane_b32 s50, v29
 s_bitcmp0_b32 s50, 15
 s_cbranch_scc1 L_poll3
L_poll3_ret:
 v_mfma_f32_16x16x32_bf16 v[164:167], a[164:167], v[248:251], v[164:167]
L_pad25:
 s_cbranch_execz L_e4_back
 ds_read_b64_tr_b16 a[108:109], v9 offset:256
 ds_read_b64_tr_b16 a[110:111], v9 offset:384
 v_mfma_f32_16x16x32_bf16 v[164:167], a[168:171], a[144:147], v[164:167]
 buffer_load_dwordx4 a[0:3], v1, s[24:27], s67 offen offset:0 sc1
 v_mfma_f32_16x16x32_bf16 v[164:167], a[172:175], a[152:155], v[164:167]
 s_waitcnt lgkmcnt(12)
 v_mfma_f32_16x16x32_bf16 v[116:119], a[176:179], v[160:163], v[116:119]
 ds_read_b64_tr_b16 a[112:113], v7 offset:32
 ds_read_b64_tr_b16 a[114:115], v7 offset:160
 v_mfma_f32_16x16x32_bf16 v[116:119], a[180:183], v[176:179], v[116:119]
 s_waitcnt lgkmcnt(10)
 v_mfma_f32_16x16x32_bf16 v[116:119], a[184:187], v[192:195], v[116:119]
 v_mfma_f32_16x16x32_bf16 v[116:119], a[188:191], v[208:211], v[116:119]
 ds_read_b64_tr_b16 a[116:117], v7 offset:288
 ds_read_b64_tr_b16 a[118:119], v7 offset:416
 v_mfma_f32_16x16x32_bf16 v[124:127], a[188:191], v[216:219], v[124:127]
 v_mfma_f32_16x16x32_bf16 v[124:127], a[184:187], v[200:203], v[124:127]
 buffer_load_dwordx4 a[4:7], v1, s[24:27], s67 offen offset:1024 sc1
 v_mfma_f32_16x16x32_bf16 v[124:127], a[180:183], v[184:187], v[124:127]
 ds_read_b64_tr_b16 a[120:121], v9 offset:32
 ds_read_b64_tr_b16 a[122:123], v9 offset:160
 v_mfma_f32_16x16x32_bf16 v[124:127], a[176:179], v[168:171], v[124:127]
 v_mfma_f32_16x16x32_bf16 v[172:175], a[176:179], v[240:243], v[172:175]
 v_mfma_f32_16x16x32_bf16 v[172:175], a[180:183], v[248:251], v[172:175]
 ds_read_b64_tr_b16 a[124:125], v9 offset:288
 ds_read_b64_tr_b16 a[126:127], v9 offset:416
 v_mfma_f32_16x16x32_bf16 v[172:175], a[184:187], a[144:147], v[172:175]
 v_mfma_f32_16x16x32_bf16 v[172:175], a[188:191], a[152:155], v[172:175]
 s_waitcnt lgkmcnt(12)
 v_mfma_f32_16x16x32_bf16 v[132:135], a[96:99], a[192:195], 0
 ds_read_b64_tr_b16 a[160:161], v7 offset:16896
 ds_read_b64_tr_b16 a[162:163], v7 offset:17024
 v_mfma_f32_16x16x32_bf16 v[132:135], a[100:103], a[200:203], v[132:135]
 s_waitcnt lgkmcnt(10)
 buffer_load_dwordx4 a[8:11], v1, s[24:27], s67 offen offset:2048 sc1
 v_mfma_f32_16x16x32_bf16 v[132:135], a[104:107], a[208:211], v[132:135]
 ds_read_b64_tr_b16 a[164:165], v7 offset:17152
 ds_read_b64_tr_b16 a[166:167], v7 offset:17280
 v_mfma_f32_16x16x32_bf16 v[132:135], a[108:111], a[216:219], v[132:135]
 s_add_u32 s55, s10, 0xf0000
 v_cvt_pk_bf16_f32 v100, v100, v101
 v_cvt_pk_bf16_f32 v101, v102, v103
 v_mfma_f32_16x16x32_bf16 v[140:143], a[108:111], a[220:223], 0
 ds_read_b64_tr_b16 a[168:169], v9 offset:16896
 ds_read_b64_tr_b16 a[170:171], v9 offset:17024
 v_mfma_f32_16x16x32_bf16 v[140:143], a[104:107], a[212:215], v[140:143]
 v_cvt_pk_bf16_f32 v102, v116, v117
 v_cvt_pk_bf16_f32 v103, v118, v119
 v_mfma_f32_16x16x32_bf16 v[140:143], a[100:103], a[204:207], v[140:143]
 ds_read_b64_tr_b16 a[172:173], v9 offset:17152
 ds_read_b64_tr_b16 a[174:175], v9 offset:17280
 v_mfma_f32_16x16x32_bf16 v[140:143], a[96:99], a[196:199], v[140:143]
 s_waitcnt lgkmcnt(12)
 buffer_load_dwordx4 a[12:15], v1, s[24:27], s67 offen offset:3072 sc1
 buffer_store_dwordx4 v[100:103], v1, s[24:27], s55 offen offset:0 sc1
 v_mfma_f32_16x16x32_bf16 v[148:151], a[112:115], a[192:195], 0
 ds_read_b64_tr_b16 a[176:177], v7 offset:16928
 ds_read_b64_tr_b16 a[178:179], v7 offset:17056
 v_mfma_f32_16x16x32_bf16 v[148:151], a[116:119], a[200:203], v[148:151]
 s_waitcnt lgkmcnt(10)
 v_mfma_f32_16x16x32_bf16 v[148:151], a[120:123], a[208:211], v[148:151]
 s_add_u32 s55, s11, 0xf2000
 ds_read_b64_tr_b16 a[180:181], v7 offset:17184
 ds_read_b64_tr_b16 a[182:183], v7 offset:17312
 v_mfma_f32_16x16x32_bf16 v[148:151], a[124:127], a[216:219], v[148:151]
 v_cvt_pk_bf16_f32 v108, v108, v109
 v_cvt_pk_bf16_f32 v109, v110, v111
 v_mfma_f32_16x16x32_bf16 v[156:159], a[124:127], a[220:223], 0
 ds_read_b64_tr_b16 a[184:185], v9 offset:16928
 ds_read_b64_tr_b16 a[186:187], v9 offset:17056
 v_mfma_f32_16x16x32_bf16 v[156:159], a[120:123], a[212:215], v[156:159]
 v_cvt_pk_bf16_f32 v110, v124, v125
 v_cvt_pk_bf16_f32 v111, v126, v127
 v_mfma_f32_16x16x32_bf16 v[156:159], a[116:119], a[204:207], v[156:159]
 ds_read_b64_tr_b16 a[188:189], v9 offset:17184
 ds_read_b64_tr_b16 a[190:191], v9 offset:17312
 v_mfma_f32_16x16x32_bf16 v[156:159], a[112:115], a[196:199], v[156:159]
 s_waitcnt lgkmcnt(12)
 buffer_load_dwordx4 a[16:19], v18, s[24:27], s67 offen offset:0 sc1
 buffer_store_dwordx4 v[108:111], v1, s[24:27], s55 offen offset:0 sc1
 v_mfma_f32_16x16x32_bf16 v[132:135], a[160:163], a[224:227], v[132:135]
 ds_read_b64_tr_b16 a[96:97], v7 offset:33792
 ds_read_b64_tr_b16 a[98:99], v7 offset:33920
 v_mfma_f32_16x16x32_bf16 v[132:135], a[164:167], a[232:235], v[132:135]
 s_waitcnt lgkmcnt(10)
 v_cvt_pk_bf16_f32 v164, v164, v165
 v_cvt_pk_bf16_f32 v165, v166, v167
 v_mfma_f32_16x16x32_bf16 v[132:135], a[168:171], a[240:243], v[132:135]
 s_add_u32 s55, s12, 0xf4000
 ds_read_b64_tr_b16 a[100:101], v7 offset:34048
 ds_read_b64_tr_b16 a[102:103], v7 offset:34176
 v_mfma_f32_16x16x32_bf16 v[132:135], a[172:175], a[248:251], v[132:135]
 v_cvt_pk_bf16_f32 v166, v172, v173
 v_cvt_pk_bf16_f32 v167, v174, v175
 v_mfma_f32_16x16x32_bf16 v[140:143], a[172:175], a[252:255], v[140:143]
 ds_read_b64_tr_b16 a[104:105], v9 offset:33792
 ds_read_b64_tr_b16 a[106:107], v9 offset:33920
 v_mfma_f32_16x16x32_bf16 v[140:143], a[168:171], a[244:247], v[140:143]
 buffer_load_dwordx4 a[20:23], v18, s[24:27], s67 offen offset:1024 sc1
 buffer_store_dwordx4 v[164:167], v1, s[24:27], s55 offen offset:0 sc1
 v_mfma_f32_16x16x32_bf16 v[140:143], a[164:167], a[236:239], v[140:143]
 ds_read_b64_tr_b16 a[108:109], v9 offset:34048
 ds_read_b64_tr_b16 a[110:111], v9 offset:34176
 v_mfma_f32_16x16x32_bf16 v[140:143], a[160:163], a[228:231], v[140:143]
 s_waitcnt lgkmcnt(12)
 v_mfma_f32_16x16x32_bf16 v[148:151], a[176:179], a[224:227], v[148:151]
 ds_read_b64_tr_b16 a[112:113], v7 offset:33824
 ds_read_b64_tr_b16 a[114:115], v7 offset:33952
 v_mfma_f32_16x16x32_bf16 v[148:151], a[180:183], a[232:235], v[148:151]
 s_waitcnt lgkmcnt(10)
 v_mfma_f32_16x16x32_bf16 v[148:151], a[184:187], a[240:243], v[148:151]
 ds_read_b64_tr_b16 a[116:117], v7 offset:34080
 ds_read_b64_tr_b16 a[118:119], v7 offset:34208
 v_mfma_f32_16x16x32_bf16 v[148:151], a[188:191], a[248:251], v[148:151]
 s_cmp_eq_u32 s59, 2
 s_cselect_b64 vcc, -1, 0
 v_cndmask_b32 v32, v32, v100, vcc
 v_mfma_f32_16x16x32_bf16 v[156:159], a[188:191], a[252:255], v[156:159]
 ds_read_b64_tr_b16 a[120:121], v9 offset:33824
 ds_read_b64_tr_b16 a[122:123], v9 offset:33952
 v_mfma_f32_16x16x32_bf16 v[156:159], a[184:187], a[244:247], v[156:159]
 buffer_load_dwordx4 a[24:27], v18, s[24:27], s67 offen offset:2048 sc1
 v_cndmask_b32 v33, v33, v101, vcc
 v_mfma_f32_16x16x32_bf16 v[156:159], a[180:183], a[236:239], v[156:159]
 ds_read_b64_tr_b16 a[124:125], v9 offset:34080
 ds_read_b64_tr_b16 a[126:127], v9 offset:34208
 v_mfma_f32_16x16x32_bf16 v[156:159], a[176:179], a[228:231], v[156:159]
 s_waitcnt lgkmcnt(12)
 v_cndmask_b32 v34, v34, v102, vcc
 v_cndmask_b32 v35, v35, v103, vcc
 v_mfma_f32_16x16x32_bf16 v[132:135], a[96:99], v[96:99], v[132:135]
 ds_read_b64_tr_b16 a[160:161], v7 offset:50688
 ds_read_b64_tr_b16 a[162:163], v7 offset:50816
 v_mfma_f32_16x16x32_bf16 v[132:135], a[100:103], v[112:115], v[132:135]
 s_waitcnt lgkmcnt(10)
 v_mfma_f32_16x16x32_bf16 v[132:135], a[104:107], v[128:131], v[132:135]
 ds_read_b64_tr_b16 a[164:165], v7 offset:50944
 ds_read_b64_tr_b16 a[166:167], v7 offset:51072
 v_mfma_f32_16x16x32_bf16 v[132:135], a[108:111], v[144:147], v[132:135]
 s_cmp_eq_u32 s59, 3
 s_cselect_b64 vcc, -1, 0
 v_cndmask_b32 v32, v32, v108, vcc
 v_mfma_f32_16x16x32_bf16 v[140:143], a[108:111], v[152:155], v[140:143]
 ds_read_b64_tr_b16 a[168:169], v9 offset:50688
 ds_read_b64_tr_b16 a[170:171], v9 offset:50816
 v_mfma_f32_16x16x32_bf16 v[140:143], a[104:107], v[136:139], v[140:143]
 v_cndmask_b32 v33, v33, v109, vcc
 v_cndmask_b32 v34, v34, v110, vcc
 v_mfma_f32_16x16x32_bf16 v[140:143], a[100:103], v[120:123], v[140:143]
 ds_read_b64_tr_b16 a[172:173], v9 offset:50944
 ds_read_b64_tr_b16 a[174:175], v9 offset:51072
 v_mfma_f32_16x16x32_bf16 v[140:143], a[96:99], v[104:107], v[140:143]
 s_waitcnt lgkmcnt(12)
 v_cndmask_b32 v35, v35, v111, vcc
 v_mfma_f32_16x16x32_bf16 v[148:151], a[112:115], v[96:99], v[148:151]
 ds_read_b64_tr_b16 a[176:177], v7 offset:50720
 ds_read_b64_tr_b16 a[178:179], v7 offset:50848
 v_mfma_f32_16x16x32_bf16 v[148:151], a[116:119], v[112:115], v[148:151]
 s_waitcnt lgkmcnt(10)
 v_mfma_f32_16x16x32_bf16 v[148:151], a[120:123], v[128:131], v[148:151]
 ds_read_b64_tr_b16 a[180:181], v7 offset:50976
 ds_read_b64_tr_b16 a[182:183], v7 offset:51104
 v_mfma_f32_16x16x32_bf16 v[148:151], a[124:127], v[144:147], v[148:151]
 s_cmp_eq_u32 s59, 4
 s_cselect_b64 vcc, -1, 0
 v_cndmask_b32 v32, v32, v164, vcc
 v_mfma_f32_16x16x32_bf16 v[156:159], a[124:127], v[152:155], v[156:159]
 ds_read_b64_tr_b16 a[184:185], v9 offset:50720
 ds_read_b64_tr_b16 a[186:187], v9 offset:50848
 v_mfma_f32_16x16x32_bf16 v[156:159], a[120:123], v[136:139], v[156:159]
 v_cndmask_b32 v33, v33, v165, vcc
 v_cndmask_b32 v34, v34, v166, vcc
 v_mfma_f32_16x16x32_bf16 v[156:159], a[116:119], v[120:123], v[156:159]
 ds_read_b64_tr_b16 a[188:189], v9 offset:50976
 ds_read_b64_tr_b16 a[190:191], v9 offset:51104
 v_mfma_f32_16x16x32_bf16 v[156:159], a[112:115], v[104:107], v[156:159]
 s_waitcnt lgkmcnt(12)
 v_cndmask_b32 v35, v35, v167, vcc
 v_mfma_f32_16x16x32_bf16 v[132:135], a[160:163], v[160:163], v[132:135]
 v_mfma_f32_16x16x32_bf16 v[132:135], a[164:167], v[176:179], v[132:135]
 s_waitcnt lgkmcnt(8)
 v_mfma_f32_16x16x32_bf16 v[132:135], a[168:171], v[192:195], v[132:135]
 v_mfma_f32_16x16x32_bf16 v[132:135], a[172:175], v[208:211], v[132:135]
 v_mfma_f32_16x16x32_bf16 v[140:143], a[172:175], v[216:219], v[140:143]
 v_mfma_f32_16x16x32_bf16 v[140:143], a[168:171], v[200:203], v[140:143]
 v_mfma_f32_16x16x32_bf16 v[140:143], a[164:167], v[184:187], v[140:143]
 v_mfma_f32_16x16x32_bf16 v[140:143], a[160:163], v[168:171], v[140:143]
 s_waitcnt lgkmcnt(4)
 v_mfma_f32_16x16x32_bf16 v[148:151], a[176:179], v[160:163], v[148:151]
 v_mfma_f32_16x16x32_bf16 v[148:151], a[180:183], v[176:179], v[148:151]
 s_waitcnt lgkmcnt(0)
 v_mfma_f32_16x16x32_bf16 v[148:151], a[184:187], v[192:195], v[148:151]
 v_mfma_f32_16x16x32_bf16 v[148:151], a[188:191], v[208:211], v[148:151]
 v_mfma_f32_16x16x32_bf16 v[156:159], a[188:191], v[216:219], v[156:159]
 v_mfma_f32_16x16x32_bf16 v[156:159], a[184:187], v[200:203], v[156:159]
 v_mfma_f32_16x16x32_bf16 v[156:159], a[180:183], v[184:187], v[156:159]
 v_mfma_f32_16x16x32_bf16 v[156:159], a[176:179], v[168:171], v[156:159]
 v_cvt_pk_bf16_f32 v132, v132, v133
 v_cvt_pk_bf16_f32 v133, v134, v135
 s_nop 1
 v_cvt_pk_bf16_f32 v134, v148, v149
 v_cvt_pk_bf16_f32 v135, v150, v151
 s_add_u32 s55, s13, 0xf6000
 buffer_store_dwordx4 v[132:135], v1, s[24:27], s55 offen offset:0 sc1
 v_cvt_pk_bf16_f32 v140, v140, v141
 v_cvt_pk_bf16_f32 v141, v142, v143
 v_cvt_pk_bf16_f32 v142, v156, v157
 v_cvt_pk_bf16_f32 v143, v158, v159
 s_add_u32 s55, s14, 0xf8000
 buffer_store_dwordx4 v[140:143], v1, s[24:27], s55 offen offset:0 sc1
 s_cmp_eq_u32 s59, 5
 s_cselect_b64 vcc, -1, 0
 v_cndmask_b32 v32, v32, v132, vcc
 v_cndmask_b32 v33, v33, v133, vcc
 v_cndmask_b32 v34, v34, v134, vcc
 v_cndmask_b32 v35, v35, v135, vcc
 s_cmp_eq_u32 s59, 6
 s_cselect_b64 vcc, -1, 0
 v_cndmask_b32 v32, v32, v140, vcc
 v_cndmask_b32 v33, v33, v141, vcc
 v_cndmask_b32 v34, v34, v142, vcc
 v_cndmask_b32 v35, v35, v143, vcc
 s_waitcnt vmcnt(0)
 s_barrier
 v_mov_b32 v11, 0x10000
 buffer_atomic_add v11, v27, s[36:39], 0 offen
 v_mfma_f32_16x16x32_bf16 v[192:195], v[12:15], a[0:3], 0
 v_mfma_f32_16x16x32_bf16 v[192:195], v[12:15], a[4:7], v[192:195]
 v_mfma_f32_16x16x32_bf16 v[192:195], v[12:15], a[8:11], v[192:195]
 v_mfma_f32_16x16x32_bf16 v[192:195], v[12:15], a[12:15], v[192:195]
 v_mfma_f32_16x16x32_bf16 v[192:195], v[12:15], a[16:19], v[192:195]
 v_mfma_f32_16x16x32_bf16 v[192:195], v[12:15], a[20:23], v[192:195]
 v_mfma_f32_16x16x32_bf16 v[192:195], v[12:15], a[24:27], v[192:195]
 v_mfma_f32_16x16x32_bf16 v[192:195], v[12:15], v[76:79], v[192:195]
 v_mfma_f32_16x16x32_bf16 v[196:199], v[204:207], a[0:3], 0
 v_mfma_f32_16x16x32_bf16 v[196:199], v[204:207], a[4:7], v[196:199]
 v_mfma_f32_16x16x32_bf16 v[196:199], v[204:207], a[8:11], v[196:199]
 v_mfma_f32_16x16x32_bf16 v[196:199], v[204:207], a[12:15], v[196:199]
 v_mfma_f32_16x16x32_bf16 v[196:199], v[204:207], a[16:19], v[196:199]
 v_mfma_f32_16x16x32_bf16 v[196:199], v[204:207], a[20:23], v[196:199]
 v_mfma_f32_16x16x32_bf16 v[196:199], v[204:207], a[24:27], v[196:199]
 v_mfma_f32_16x16x32_bf16 v[196:199], v[204:207], v[76:79], v[196:199]
 buffer_load_dword v29, v28, s[36:39], 0 offen offset:0 sc1
 v_cvt_pk_bf16_f32 v192, v192, v193
 v_cvt_pk_bf16_f32 v193, v194, v195
 s_nop 4
 v_cvt_pk_bf16_f32 v194, v196, v197
 v_cvt_pk_bf16_f32 v195, v198, v199
 buffer_store_dwordx4 v[192:195], v10, s[32:35], s72 offen offset:0 nt
 s_waitcnt vmcnt(1)
 v_readfirstlane_b32 s50, v29
 s_bitcmp0_b32 s50, 19
 s_cbranch_scc1 L_poll4
L_poll4_ret:
 buffer_load_dwordx4 a[32:35], v1, s[24:27], s68 offen offset:0 sc1
 buffer_load_dwordx4 a[36:39], v1, s[24:27], s68 offen offset:1024 sc1
 buffer_load_dwordx4 a[40:43], v1, s[24:27], s68 offen offset:2048 sc1
 buffer_load_dwordx4 a[44:47], v1, s[24:27], s68 offen offset:3072 sc1
 buffer_load_dwordx4 a[48:51], v18, s[24:27], s68 offen offset:0 sc1
 buffer_load_dwordx4 a[52:55], v18, s[24:27], s68 offen offset:1024 sc1
 buffer_load_dwordx4 a[56:59], v18, s[24:27], s68 offen offset:2048 sc1
 v_mfma_f32_16x16x32_bf16 v[60:63], v[12:15], v[32:35], 0
 v_mfma_f32_16x16x32_bf16 v[64:67], v[204:207], v[32:35], 0
 s_waitcnt vmcnt(6)
 v_mfma_f32_16x16x32_bf16 v[60:63], v[12:15], a[32:35], v[60:63]
 v_mfma_f32_16x16x32_bf16 v[64:67], v[204:207], a[32:35], v[64:67]
 s_waitcnt vmcnt(5)
 v_mfma_f32_16x16x32_bf16 v[60:63], v[12:15], a[36:39], v[60:63]
 v_mfma_f32_16x16x32_bf16 v[64:67], v[204:207], a[36:39], v[64:67]
 s_waitcnt vmcnt(4)
 v_mfma_f32_16x16x32_bf16 v[60:63], v[12:15], a[40:43], v[60:63]
 v_mfma_f32_16x16x32_bf16 v[64:67], v[204:207], a[40:43], v[64:67]
 s_waitcnt vmcnt(3)
 v_mfma_f32_16x16x32_bf16 v[60:63], v[12:15], a[44:47], v[60:63]
 v_mfma_f32_16x16x32_bf16 v[64:67], v[204:207], a[44:47], v[64:67]
 s_waitcnt vmcnt(2)
 v_mfma_f32_16x16x32_bf16 v[60:63], v[12:15], a[48:51], v[60:63]
 v_mfma_f32_16x16x32_bf16 v[64:67], v[204:207], a[48:51], v[64:67]
 s_waitcnt vmcnt(1)
 v_mfma_f32_16x16x32_bf16 v[60:63], v[12:15], a[52:55], v[60:63]
 v_mfma_f32_16x16x32_bf16 v[64:67], v[204:207], a[52:55], v[64:67]
 s_waitcnt vmcnt(0)
 v_mfma_f32_16x16x32_bf16 v[60:63], v[12:15], a[56:59], v[60:63]
 v_mfma_f32_16x16x32_bf16 v[64:67], v[204:207], a[56:59], v[64:67]
 s_nop 6
 v_cvt_pk_bf16_f32 v60, v60, v61
 v_cvt_pk_bf16_f32 v61, v62, v63
 v_cvt_pk_bf16_f32 v62, v64, v65
 v_cvt_pk_bf16_f32 v63, v66, v67
 buffer_store_dwordx4 v[60:63], v10, s[32:35], s73 offen offset:0 nt
 s_endpgm
L_poll0:
 s_mov_b32 s43, 0
L_poll0_l:
 buffer_load_dword v29, v28, s[36:39], 0 offen sc1
 s_add_u32 s43, s43, 1
 s_waitcnt vmcnt(0)
 v_readfirstlane_b32 s50, v29
 s_bitcmp1_b32 s50, 3
 s_cbranch_scc1 L_poll0_ret
 s_cmp_lt_u32 s43, 0x80000
 s_cbranch_scc1 L_poll0_l
 s_branch L_poll0_ret
L_poll1:
 s_mov_b32 s44, 0
L_poll1_l:
 buffer_load_dword v29, v28, s[36:39], 0 offen sc1
 s_add_u32 s44, s44, 1
 s_waitcnt vmcnt(0)
 v_readfirstlane_b32 s50, v29
 s_bitcmp1_b32 s50, 7
 s_cbranch_scc1 L_poll1_ret
 s_cmp_lt_u32 s44, 0x80000
 s_cbranch_scc1 L_poll1_l
 s_branch L_poll1_ret
L_poll2:
 s_mov_b32 s91, 0
L_poll2_l:
 buffer_load_dword v29, v28, s[36:39], 0 offen sc1
 s_add_u32 s91, s91, 1
 s_waitcnt vmcnt(0)
 v_readfirstlane_b32 s50, v29
 s_bitcmp1_b32 s50, 11
 s_cbranch_scc1 L_poll2_ret
 s_cmp_lt_u32 s91, 0x80000
 s_cbranch_scc1 L_poll2_l
 s_branch L_poll2_ret
L_poll3:
 s_mov_b32 s45, 0
L_poll3_l:
 buffer_load_dword v29, v28, s[36:39], 0 offen sc1
 s_add_u32 s45, s45, 1
 s_waitcnt vmcnt(0)
 v_readfirstlane_b32 s50, v29
 s_bitcmp1_b32 s50, 15
 s_cbranch_scc1 L_poll3_ret
 s_cmp_lt_u32 s45, 0x80000
 s_cbranch_scc1 L_poll3_l
 s_branch L_poll3_ret
L_poll4:
 s_mov_b32 s41, 0
L_poll4_l:
 buffer_load_dword v29, v28, s[36:39], 0 offen sc1
 s_add_u32 s41, s41, 1
 s_waitcnt vmcnt(0)
 v_readfirstlane_b32 s50, v29
 s_bitcmp1_b32 s50, 19
 s_cbranch_scc1 L_poll4_ret
 s_cmp_lt_u32 s41, 0x80000
 s_cbranch_scc1 L_poll4_l
 s_branch L_poll4_ret
L_poll5:
 s_mov_b32 s42, 0
L_poll5_l:
 buffer_load_dword v29, v28, s[84:87], 0 offen sc1
 s_add_u32 s42, s42, 1
 s_waitcnt vmcnt(0)
 v_readfirstlane_b32 s50, v29
 s_bitcmp1_b32 s50, 0
 s_cbranch_scc1 L_poll5_ret
 s_cmp_lt_u32 s42, 0x80000
 s_cbranch_scc1 L_poll5_l
 s_branch L_poll5_ret
L_codeend:
L_stub_0_B0:
 s_nop 7
 v_max3_f32 v38, v38, v56, v57
 v_max3_f32 v38, v38, v58, v59
 v_max3_f32 v38, v38, v60, v61
 v_max3_f32 v38, v38, v62, v63
 v_sub_f32 v56, v56, v41
 v_sub_f32 v57, v57, v41
 v_sub_f32 v58, v58, v41
 v_sub_f32 v59, v59, v41
 v_sub_f32 v60, v60, v41
 v_sub_f32 v61, v61, v41
 v_sub_f32 v62, v62, v41
 v_sub_f32 v63, v63, v41
 v_max3_f32 v39, v39, v64, v65
 v_max3_f32 v39, v39, v66, v67
 v_max3_f32 v39, v39, v68, v69
 v_max3_f32 v39, v39, v70, v71
 v_sub_f32 v64, v64, v42
 v_sub_f32 v65, v65, v42
 v_sub_f32 v66, v66, v42
 v_sub_f32 v67, v67, v42
 v_sub_f32 v68, v68, v42
 v_sub_f32 v69, v69, v42
 v_sub_f32 v70, v70, v42
 v_sub_f32 v71, v71, v42
 v_max3_f32 v40, v40, v72, v73
 v_max3_f32 v40, v40, v74, v75
 v_sub_f32 v72, v72, v43
 v_sub_f32 v73, v73, v43
 v_sub_f32 v74, v74, v43
 v_sub_f32 v75, v75, v43
 s_nop 1
 s_branch L_stub_0_B0_ret
L_stub_1_B0:
 s_nop 7
 v_max3_f32 v38, v38, v100, v101
 v_max3_f32 v38, v38, v102, v103
 v_max3_f32 v38, v38, v108, v109
 v_max3_f32 v38, v38, v110, v111
 v_sub_f32 v100, v100, v41
 v_sub_f32 v101, v101, v41
 v_sub_f32 v102, v102, v41
 v_sub_f32 v103, v103, v41
 v_sub_f32 v108, v108, v41
 v_sub_f32 v109, v109, v41
 v_sub_f32 v110, v110, v41
 v_sub_f32 v111, v111, v41
 v_max3_f32 v39, v39, v116, v117
 v_max3_f32 v39, v39, v118, v119
 v_max3_f32 v39, v39, v124, v125
 v_max3_f32 v39, v39, v126, v127
 v_sub_f32 v116, v116, v42
 v_sub_f32 v117, v117, v42
 v_sub_f32 v118, v118, v42
 v_sub_f32 v119, v119, v42
 v_sub_f32 v124, v124, v42
 v_sub_f32 v125, v125, v42
 v_sub_f32 v126, v126, v42
 v_sub_f32 v127, v127, v42
 v_max3_f32 v40, v40, v132, v133
 v_max3_f32 v40, v40, v134, v135
 v_sub_f32 v132, v132, v43
 v_sub_f32 v133, v133, v43
 v_sub_f32 v134, v134, v43
 v_sub_f32 v135, v135, v43
 s_nop 1
 s_branch L_stub_1_B0_ret
L_stub_2_B0:
 s_nop 7
 v_max3_f32 v38, v38, v140, v141
 v_max3_f32 v38, v38, v142, v143
 v_max3_f32 v38, v38, v148, v149
 v_max3_f32 v38, v38, v150, v151
 v_sub_f32 v140, v140, v41
 v_sub_f32 v141, v141, v41
 v_sub_f32 v142, v142, v41
 v_sub_f32 v143, v143, v41
 v_sub_f32 v148, v148, v41
 v_sub_f32 v149, v149, v41
 v_sub_f32 v150, v150, v41
 v_sub_f32 v151, v151, v41
 v_max3_f32 v39, v39, v156, v157
 v_max3_f32 v39, v39, v158, v159
 v_max3_f32 v39, v39, v164, v165
 v_max3_f32 v39, v39, v166, v167
 v_sub_f32 v156, v156, v42
 v_sub_f32 v157, v157, v42
 v_sub_f32 v158, v158, v42
 v_sub_f32 v159, v159, v42
 v_sub_f32 v164, v164, v42
 v_sub_f32 v165, v165, v42
 v_sub_f32 v166, v166, v42
 v_sub_f32 v167, v167, v42
 v_max3_f32 v40, v40, v172, v173
 v_max3_f32 v40, v40, v174, v175
 v_sub_f32 v172, v172, v43
 v_sub_f32 v173, v173, v43
 v_sub_f32 v174, v174, v43
 v_sub_f32 v175, v175, v43
 s_nop 1
 s_branch L_stub_2_B0_ret
L_stub_3_B0:
 s_nop 7
 v_max3_f32 v38, v38, v56, v57
 v_max3_f32 v38, v38, v58, v59
 v_max3_f32 v38, v38, v60, v61
 v_max3_f32 v38, v38, v62, v63
 v_sub_f32 v56, v56, v41
 v_sub_f32 v57, v57, v41
 v_sub_f32 v58, v58, v41
 v_sub_f32 v59, v59, v41
 v_sub_f32 v60, v60, v41
 v_sub_f32 v61, v61, v41
 v_sub_f32 v62, v62, v41
 v_sub_f32 v63, v63, v41
 v_max3_f32 v39, v39, v64, v65
 v_max3_f32 v39, v39, v66, v67
 v_max3_f32 v39, v39, v68, v69
 v_max3_f32 v39, v39, v70, v71
 v_sub_f32 v64, v64, v42
 v_sub_f32 v65, v65, v42
 v_sub_f32 v66, v66, v42
 v_sub_f32 v67, v67, v42
 v_sub_f32 v68, v68, v42
 v_sub_f32 v69, v69, v42
 v_sub_f32 v70, v70, v42
 v_sub_f32 v71, v71, v42
 v_max3_f32 v40, v40, v72, v73
 v_max3_f32 v40, v40, v74, v75
 v_sub_f32 v72, v72, v43
 v_sub_f32 v73, v73, v43
 v_sub_f32 v74, v74, v43
 v_sub_f32 v75, v75, v43
 s_nop 1
 s_branch L_stub_3_B0_ret
L_stub_4_B0:
 s_nop 7
 v_max3_f32 v38, v38, v100, v101
 v_max3_f32 v38, v38, v102, v103
 v_max3_f32 v38, v38, v108, v109
 v_max3_f32 v38, v38, v110, v111
 v_sub_f32 v100, v100, v41
 v_sub_f32 v101, v101, v41
 v_sub_f32 v102, v102, v41
 v_sub_f32 v103, v103, v41
 v_sub_f32 v108, v108, v41
 v_sub_f32 v109, v109, v41
 v_sub_f32 v110, v110, v41
 v_sub_f32 v111, v111, v41
 v_max3_f32 v39, v39, v116, v117
 v_max3_f32 v39, v39, v118, v119
 v_max3_f32 v39, v39, v124, v125
 v_max3_f32 v39, v39, v126, v127
 v_sub_f32 v116, v116, v42
 v_sub_f32 v117, v117, v42
 v_sub_f32 v118, v118, v42
 v_sub_f32 v119, v119, v42
 v_sub_f32 v124, v124, v42
 v_sub_f32 v125, v125, v42
 v_sub_f32 v126, v126, v42
 v_sub_f32 v127, v127, v42
 v_max3_f32 v40, v40, v132, v133
 v_max3_f32 v40, v40, v134, v135
 v_sub_f32 v132, v132, v43
 v_sub_f32 v133, v133, v43
 v_sub_f32 v134, v134, v43
 v_sub_f32 v135, v135, v43
 s_nop 1
 s_branch L_stub_4_B0_ret
L_stub_5_B0:
 s_nop 7
 v_max3_f32 v38, v38, v140, v141
 v_max3_f32 v38, v38, v142, v143
 v_max3_f32 v38, v38, v148, v149
 v_max3_f32 v38, v38, v150, v151
 v_sub_f32 v140, v140, v41
 v_sub_f32 v141, v141, v41
 v_sub_f32 v142, v142, v41
 v_sub_f32 v143, v143, v41
 v_sub_f32 v148, v148, v41
 v_sub_f32 v149, v149, v41
 v_sub_f32 v150, v150, v41
 v_sub_f32 v151, v151, v41
 v_max3_f32 v39, v39, v156, v157
 v_max3_f32 v39, v39, v158, v159
 v_max3_f32 v39, v39, v164, v165
 v_max3_f32 v39, v39, v166, v167
 v_sub_f32 v156, v156, v42
 v_sub_f32 v157, v157, v42
 v_sub_f32 v158, v158, v42
 v_sub_f32 v159, v159, v42
 v_sub_f32 v164, v164, v42
 v_sub_f32 v165, v165, v42
 v_sub_f32 v166, v166, v42
 v_sub_f32 v167, v167, v42
 v_max3_f32 v40, v40, v172, v173
 v_max3_f32 v40, v40, v174, v175
 v_sub_f32 v172, v172, v43
 v_sub_f32 v173, v173, v43
 v_sub_f32 v174, v174, v43
 v_sub_f32 v175, v175, v43
 s_nop 1
 s_branch L_stub_5_B0_ret
L_stub_6_B0:
 s_nop 7
 v_max3_f32 v38, v38, v56, v57
 v_max3_f32 v38, v38, v58, v59
 v_max3_f32 v38, v38, v60, v61
 v_max3_f32 v38, v38, v62, v63
 v_sub_f32 v56, v56, v41
 v_sub_f32 v57, v57, v41
 v_sub_f32 v58, v58, v41
 v_sub_f32 v59, v59, v41
 v_sub_f32 v60, v60, v41
 v_sub_f32 v61, v61, v41
 v_sub_f32 v62, v62, v41
 v_sub_f32 v63, v63, v41
 v_max3_f32 v39, v39, v64, v65
 v_max3_f32 v39, v39, v66, v67
 v_max3_f32 v39, v39, v68, v69
 v_max3_f32 v39, v39, v70, v71
 v_sub_f32 v64, v64, v42
 v_sub_f32 v65, v65, v42
 v_sub_f32 v66, v66, v42
 v_sub_f32 v67, v67, v42
 v_sub_f32 v68, v68, v42
 v_sub_f32 v69, v69, v42
 v_sub_f32 v70, v70, v42
 v_sub_f32 v71, v71, v42
 v_max3_f32 v40, v40, v72, v73
 v_max3_f32 v40, v40, v74, v75
 v_sub_f32 v72, v72, v43
 v_sub_f32 v73, v73, v43
 v_sub_f32 v74, v74, v43
 v_sub_f32 v75, v75, v43
 s_nop 1
 s_branch L_stub_6_B0_ret
L_stub_7_B0:
 s_nop 7
 v_max3_f32 v38, v38, v100, v101
 v_max3_f32 v38, v38, v102, v103
 v_max3_f32 v38, v38, v108, v109
 v_max3_f32 v38, v38, v110, v111
 v_sub_f32 v100, v100, v41
 v_sub_f32 v101, v101, v41
 v_sub_f32 v102, v102, v41
 v_sub_f32 v103, v103, v41
 v_sub_f32 v108, v108, v41
 v_sub_f32 v109, v109, v41
 v_sub_f32 v110, v110, v41
 v_sub_f32 v111, v111, v41
 v_max3_f32 v39, v39, v116, v117
 v_max3_f32 v39, v39, v118, v119
 v_max3_f32 v39, v39, v124, v125
 v_max3_f32 v39, v39, v126, v127
 v_sub_f32 v116, v116, v42
 v_sub_f32 v117, v117, v42
 v_sub_f32 v118, v118, v42
 v_sub_f32 v119, v119, v42
 v_sub_f32 v124, v124, v42
 v_sub_f32 v125, v125, v42
 v_sub_f32 v126, v126, v42
 v_sub_f32 v127, v127, v42
 v_max3_f32 v40, v40, v132, v133
 v_max3_f32 v40, v40, v134, v135
 v_sub_f32 v132, v132, v43
 v_sub_f32 v133, v133, v43
 v_sub_f32 v134, v134, v43
 v_sub_f32 v135, v135, v43
 s_nop 1
 s_branch L_stub_7_B0_ret
L_stub_8_B0:
 s_nop 7
 v_max3_f32 v38, v38, v140, v141
 v_max3_f32 v38, v38, v142, v143
 v_max3_f32 v38, v38, v148, v149
 v_max3_f32 v38, v38, v150, v151
 v_sub_f32 v140, v140, v41
 v_sub_f32 v141, v141, v41
 v_sub_f32 v142, v142, v41
 v_sub_f32 v143, v143, v41
 v_sub_f32 v148, v148, v41
 v_sub_f32 v149, v149, v41
 v_sub_f32 v150, v150, v41
 v_sub_f32 v151, v151, v41
 v_max3_f32 v39, v39, v156, v157
 v_max3_f32 v39, v39, v158, v159
 v_max3_f32 v39, v39, v164, v165
 v_max3_f32 v39, v39, v166, v167
 v_sub_f32 v156, v156, v42
 v_sub_f32 v157, v157, v42
 v_sub_f32 v158, v158, v42
 v_sub_f32 v159, v159, v42
 v_sub_f32 v164, v164, v42
 v_sub_f32 v165, v165, v42
 v_sub_f32 v166, v166, v42
 v_sub_f32 v167, v167, v42
 v_max3_f32 v40, v40, v172, v173
 v_max3_f32 v40, v40, v174, v175
 v_sub_f32 v172, v172, v43
 v_sub_f32 v173, v173, v43
 v_sub_f32 v174, v174, v43
 v_sub_f32 v175, v175, v43
 s_nop 1
 s_branch L_stub_8_B0_ret
L_stub_9_B0:
 s_nop 7
 v_max3_f32 v38, v38, v56, v57
 v_max3_f32 v38, v38, v58, v59
 v_max3_f32 v38, v38, v60, v61
 v_max3_f32 v38, v38, v62, v63
 v_sub_f32 v56, v56, v41
 v_sub_f32 v57, v57, v41
 v_sub_f32 v58, v58, v41
 v_sub_f32 v59, v59, v41
 v_sub_f32 v60, v60, v41
 v_sub_f32 v61, v61, v41
 v_sub_f32 v62, v62, v41
 v_sub_f32 v63, v63, v41
 v_max3_f32 v39, v39, v64, v65
 v_max3_f32 v39, v39, v66, v67
 v_max3_f32 v39, v39, v68, v69
 v_max3_f32 v39, v39, v70, v71
 v_sub_f32 v64, v64, v42
 v_sub_f32 v65, v65, v42
 v_sub_f32 v66, v66, v42
 v_sub_f32 v67, v67, v42
 v_sub_f32 v68, v68, v42
 v_sub_f32 v69, v69, v42
 v_sub_f32 v70, v70, v42
 v_sub_f32 v71, v71, v42
 v_max3_f32 v40, v40, v72, v73
 v_max3_f32 v40, v40, v74, v75
 v_sub_f32 v72, v72, v43
 v_sub_f32 v73, v73, v43
 v_sub_f32 v74, v74, v43
 v_sub_f32 v75, v75, v43
 s_nop 1
 s_branch L_stub_9_B0_ret
L_stub_10_B0:
 s_nop 7
 v_max3_f32 v38, v38, v100, v101
 v_max3_f32 v38, v38, v102, v103
 v_max3_f32 v38, v38, v108, v109
 v_max3_f32 v38, v38, v110, v111
 v_sub_f32 v100, v100, v41
 v_sub_f32 v101, v101, v41
 v_sub_f32 v102, v102, v41
 v_sub_f32 v103, v103, v41
 v_sub_f32 v108, v108, v41
 v_sub_f32 v109, v109, v41
 v_sub_f32 v110, v110, v41
 v_sub_f32 v111, v111, v41
 v_max3_f32 v39, v39, v116, v117
 v_max3_f32 v39, v39, v118, v119
 v_max3_f32 v39, v39, v124, v125
 v_max3_f32 v39, v39, v126, v127
 v_sub_f32 v116, v116, v42
 v_sub_f32 v117, v117, v42
 v_sub_f32 v118, v118, v42
 v_sub_f32 v119, v119, v42
 v_sub_f32 v124, v124, v42
 v_sub_f32 v125, v125, v42
 v_sub_f32 v126, v126, v42
 v_sub_f32 v127, v127, v42
 v_max3_f32 v40, v40, v132, v133
 v_max3_f32 v40, v40, v134, v135
 v_sub_f32 v132, v132, v43
 v_sub_f32 v133, v133, v43
 v_sub_f32 v134, v134, v43
 v_sub_f32 v135, v135, v43
 s_nop 1
 s_branch L_stub_10_B0_ret
L_stub_11_B0:
 s_nop 7
 v_max3_f32 v38, v38, v140, v141
 v_max3_f32 v38, v38, v142, v143
 v_max3_f32 v38, v38, v148, v149
 v_max3_f32 v38, v38, v150, v151
 v_sub_f32 v140, v140, v41
 v_sub_f32 v141, v141, v41
 v_sub_f32 v142, v142, v41
 v_sub_f32 v143, v143, v41
 v_sub_f32 v148, v148, v41
 v_sub_f32 v149, v149, v41
 v_sub_f32 v150, v150, v41
 v_sub_f32 v151, v151, v41
 v_max3_f32 v39, v39, v156, v157
 v_max3_f32 v39, v39, v158, v159
 v_max3_f32 v39, v39, v164, v165
 v_max3_f32 v39, v39, v166, v167
 v_sub_f32 v156, v156, v42
 v_sub_f32 v157, v157, v42
 v_sub_f32 v158, v158, v42
 v_sub_f32 v159, v159, v42
 v_sub_f32 v164, v164, v42
 v_sub_f32 v165, v165, v42
 v_sub_f32 v166, v166, v42
 v_sub_f32 v167, v167, v42
 v_max3_f32 v40, v40, v172, v173
 v_max3_f32 v40, v40, v174, v175
 v_sub_f32 v172, v172, v43
 v_sub_f32 v173, v173, v43
 v_sub_f32 v174, v174, v43
 v_sub_f32 v175, v175, v43
 s_nop 1
 s_branch L_stub_11_B0_ret
L_stub_12_B0:
 s_nop 7
 v_max3_f32 v38, v38, v56, v57
 v_max3_f32 v38, v38, v58, v59
 v_max3_f32 v38, v38, v60, v61
 v_max3_f32 v38, v38, v62, v63
 v_sub_f32 v56, v56, v41
 v_sub_f32 v57, v57, v41
 v_sub_f32 v58, v58, v41
 v_sub_f32 v59, v59, v41
 v_sub_f32 v60, v60, v41
 v_sub_f32 v61, v61, v41
 v_sub_f32 v62, v62, v41
 v_sub_f32 v63, v63, v41
 v_max3_f32 v39, v39, v64, v65
 v_max3_f32 v39, v39, v66, v67
 v_max3_f32 v39, v39, v68, v69
 v_max3_f32 v39, v39, v70, v71
 v_sub_f32 v64, v64, v42
 v_sub_f32 v65, v65, v42
 v_sub_f32 v66, v66, v42
 v_sub_f32 v67, v67, v42
 v_sub_f32 v68, v68, v42
 v_sub_f32 v69, v69, v42
 v_sub_f32 v70, v70, v42
 v_sub_f32 v71, v71, v42
 v_max3_f32 v40, v40, v72, v73
 v_max3_f32 v40, v40, v74, v75
 v_sub_f32 v72, v72, v43
 v_sub_f32 v73, v73, v43
 v_sub_f32 v74, v74, v43
 v_sub_f32 v75, v75, v43
 s_nop 1
 s_branch L_stub_12_B0_ret
L_stub_13_B0:
 s_nop 7
 v_max3_f32 v38, v38, v100, v101
 v_max3_f32 v38, v38, v102, v103
 v_max3_f32 v38, v38, v108, v109
 v_max3_f32 v38, v38, v110, v111
 v_sub_f32 v100, v100, v41
 v_sub_f32 v101, v101, v41
 v_sub_f32 v102, v102, v41
 v_sub_f32 v103, v103, v41
 v_sub_f32 v108, v108, v41
 v_sub_f32 v109, v109, v41
 v_sub_f32 v110, v110, v41
 v_sub_f32 v111, v111, v41
 v_max3_f32 v39, v39, v116, v117
 v_max3_f32 v39, v39, v118, v119
 v_max3_f32 v39, v39, v124, v125
 v_max3_f32 v39, v39, v126, v127
 v_sub_f32 v116, v116, v42
 v_sub_f32 v117, v117, v42
 v_sub_f32 v118, v118, v42
 v_sub_f32 v119, v119, v42
 v_sub_f32 v124, v124, v42
 v_sub_f32 v125, v125, v42
 v_sub_f32 v126, v126, v42
 v_sub_f32 v127, v127, v42
 v_max3_f32 v40, v40, v132, v133
 v_max3_f32 v40, v40, v134, v135
 v_sub_f32 v132, v132, v43
 v_sub_f32 v133, v133, v43
 v_sub_f32 v134, v134, v43
 v_sub_f32 v135, v135, v43
 s_nop 1
 s_branch L_stub_13_B0_ret
L_stub_14_B0:
 s_nop 7
 v_max3_f32 v38, v38, v140, v141
 v_max3_f32 v38, v38, v142, v143
 v_max3_f32 v38, v38, v148, v149
 v_max3_f32 v38, v38, v150, v151
 v_sub_f32 v140, v140, v41
 v_sub_f32 v141, v141, v41
 v_sub_f32 v142, v142, v41
 v_sub_f32 v143, v143, v41
 v_sub_f32 v148, v148, v41
 v_sub_f32 v149, v149, v41
 v_sub_f32 v150, v150, v41
 v_sub_f32 v151, v151, v41
 v_max3_f32 v39, v39, v156, v157
 v_max3_f32 v39, v39, v158, v159
 v_max3_f32 v39, v39, v164, v165
 v_max3_f32 v39, v39, v166, v167
 v_sub_f32 v156, v156, v42
 v_sub_f32 v157, v157, v42
 v_sub_f32 v158, v158, v42
 v_sub_f32 v159, v159, v42
 v_sub_f32 v164, v164, v42
 v_sub_f32 v165, v165, v42
 v_sub_f32 v166, v166, v42
 v_sub_f32 v167, v167, v42
 v_max3_f32 v40, v40, v172, v173
 v_max3_f32 v40, v40, v174, v175
 v_sub_f32 v172, v172, v43
 v_sub_f32 v173, v173, v43
 v_sub_f32 v174, v174, v43
 v_sub_f32 v175, v175, v43
 s_nop 1
 s_branch L_stub_14_B0_ret
L_stub_15_B0:
 s_nop 7
 v_max3_f32 v38, v38, v56, v57
 v_max3_f32 v38, v38, v58, v59
 v_max3_f32 v38, v38, v60, v61
 v_max3_f32 v38, v38, v62, v63
 v_sub_f32 v56, v56, v41
 v_sub_f32 v57, v57, v41
 v_sub_f32 v58, v58, v41
 v_sub_f32 v59, v59, v41
 v_sub_f32 v60, v60, v41
 v_sub_f32 v61, v61, v41
 v_sub_f32 v62, v62, v41
 v_sub_f32 v63, v63, v41
 v_max3_f32 v39, v39, v64, v65
 v_max3_f32 v39, v39, v66, v67
 v_max3_f32 v39, v39, v68, v69
 v_max3_f32 v39, v39, v70, v71
 v_sub_f32 v64, v64, v42
 v_sub_f32 v65, v65, v42
 v_sub_f32 v66, v66, v42
 v_sub_f32 v67, v67, v42
 v_sub_f32 v68, v68, v42
 v_sub_f32 v69, v69, v42
 v_sub_f32 v70, v70, v42
 v_sub_f32 v71, v71, v42
 v_max3_f32 v40, v40, v72, v73
 v_max3_f32 v40, v40, v74, v75
 v_sub_f32 v72, v72, v43
 v_sub_f32 v73, v73, v43
 v_sub_f32 v74, v74, v43
 v_sub_f32 v75, v75, v43
 s_nop 1
 s_branch L_stub_15_B0_ret
L_fail_B0:
 s_cmp_lg_u32 s4, 2
 s_cbranch_scc1 L_redo
 s_mov_b32 s4, 0
 s_mov_b64 vcc, 0
 s_branch L_fail_B0_ret
L_stub_0_B1:
 s_nop 7
 v_max3_f32 v38, v38, v56, v57
 v_max3_f32 v38, v38, v58, v59
 v_max3_f32 v38, v38, v60, v61
 v_max3_f32 v38, v38, v62, v63
 v_sub_f32 v56, v56, v41
 v_sub_f32 v57, v57, v41
 v_sub_f32 v58, v58, v41
 v_sub_f32 v59, v59, v41
 v_sub_f32 v60, v60, v41
 v_sub_f32 v61, v61, v41
 v_sub_f32 v62, v62, v41
 v_sub_f32 v63, v63, v41
 v_max3_f32 v39, v39, v64, v65
 v_max3_f32 v39, v39, v66, v67
 v_max3_f32 v39, v39, v68, v69
 v_max3_f32 v39, v39, v70, v71
 v_sub_f32 v64, v64, v42
 v_sub_f32 v65, v65, v42
 v_sub_f32 v66, v66, v42
 v_sub_f32 v67, v67, v42
 v_sub_f32 v68, v68, v42
 v_sub_f32 v69, v69, v42
 v_sub_f32 v70, v70, v42
 v_sub_f32 v71, v71, v42
 v_max3_f32 v40, v40, v72, v73
 v_max3_f32 v40, v40, v74, v75
 v_sub_f32 v72, v72, v43
 v_sub_f32 v73, v73, v43
 v_sub_f32 v74, v74, v43
 v_sub_f32 v75, v75, v43
 s_nop 1
 s_branch L_stub_0_B1_ret
L_stub_1_B1:
 s_nop 7
 v_max3_f32 v38, v38, v100, v101
 v_max3_f32 v38, v38, v102, v103
 v_max3_f32 v38, v38, v108, v109
 v_max3_f32 v38, v38, v110, v111
 v_sub_f32 v100, v100, v41
 v_sub_f32 v101, v101, v41
 v_sub_f32 v102, v102, v41
 v_sub_f32 v103, v103, v41
 v_sub_f32 v108, v108, v41
 v_sub_f32 v109, v109, v41
 v_sub_f32 v110, v110, v41
 v_sub_f32 v111, v111, v41
 v_max3_f32 v39, v39, v116, v117
 v_max3_f32 v39, v39, v118, v119
 v_max3_f32 v39, v39, v124, v125
 v_max3_f32 v39, v39, v126, v127
 v_sub_f32 v116, v116, v42
 v_sub_f32 v117, v117, v42
 v_sub_f32 v118, v118, v42
 v_sub_f32 v119, v119, v42
 v_sub_f32 v124, v124, v42
 v_sub_f32 v125, v125, v42
 v_sub_f32 v126, v126, v42
 v_sub_f32 v127, v127, v42
 v_max3_f32 v40, v40, v132, v133
 v_max3_f32 v40, v40, v134, v135
 v_sub_f32 v132, v132, v43
 v_sub_f32 v133, v133, v43
 v_sub_f32 v134, v134, v43
 v_sub_f32 v135, v135, v43
 s_nop 1
 s_branch L_stub_1_B1_ret
L_stub_2_B1:
 s_nop 7
 v_max3_f32 v38, v38, v140, v141
 v_max3_f32 v38, v38, v142, v143
 v_max3_f32 v38, v38, v148, v149
 v_max3_f32 v38, v38, v150, v151
 v_sub_f32 v140, v140, v41
 v_sub_f32 v141, v141, v41
 v_sub_f32 v142, v142, v41
 v_sub_f32 v143, v143, v41
 v_sub_f32 v148, v148, v41
 v_sub_f32 v149, v149, v41
 v_sub_f32 v150, v150, v41
 v_sub_f32 v151, v151, v41
 v_max3_f32 v39, v39, v156, v157
 v_max3_f32 v39, v39, v158, v159
 v_max3_f32 v39, v39, v164, v165
 v_max3_f32 v39, v39, v166, v167
 v_sub_f32 v156, v156, v42
 v_sub_f32 v157, v157, v42
 v_sub_f32 v158, v158, v42
 v_sub_f32 v159, v159, v42
 v_sub_f32 v164, v164, v42
 v_sub_f32 v165, v165, v42
 v_sub_f32 v166, v166, v42
 v_sub_f32 v167, v167, v42
 v_max3_f32 v40, v40, v172, v173
 v_max3_f32 v40, v40, v174, v175
 v_sub_f32 v172, v172, v43
 v_sub_f32 v173, v173, v43
 v_sub_f32 v174, v174, v43
 v_sub_f32 v175, v175, v43
 s_nop 1
 s_branch L_stub_2_B1_ret
L_stub_3_B1:
 s_nop 7
 v_max3_f32 v38, v38, v56, v57
 v_max3_f32 v38, v38, v58, v59
 v_max3_f32 v38, v38, v60, v61
 v_max3_f32 v38, v38, v62, v63
 v_sub_f32 v56, v56, v41
 v_sub_f32 v57, v57, v41
 v_sub_f32 v58, v58, v41
 v_sub_f32 v59, v59, v41
 v_sub_f32 v60, v60, v41
 v_sub_f32 v61, v61, v41
 v_sub_f32 v62, v62, v41
 v_sub_f32 v63, v63, v41
 v_max3_f32 v39, v39, v64, v65
 v_max3_f32 v39, v39, v66, v67
 v_max3_f32 v39, v39, v68, v69
 v_max3_f32 v39, v39, v70, v71
 v_sub_f32 v64, v64, v42
 v_sub_f32 v65, v65, v42
 v_sub_f32 v66, v66, v42
 v_sub_f32 v67, v67, v42
 v_sub_f32 v68, v68, v42
 v_sub_f32 v69, v69, v42
 v_sub_f32 v70, v70, v42
 v_sub_f32 v71, v71, v42
 v_max3_f32 v40, v40, v72, v73
 v_max3_f32 v40, v40, v74, v75
 v_sub_f32 v72, v72, v43
 v_sub_f32 v73, v73, v43
 v_sub_f32 v74, v74, v43
 v_sub_f32 v75, v75, v43
 s_nop 1
 s_branch L_stub_3_B1_ret
L_stub_4_B1:
 s_nop 7
 v_max3_f32 v38, v38, v100, v101
 v_max3_f32 v38, v38, v102, v103
 v_max3_f32 v38, v38, v108, v109
 v_max3_f32 v38, v38, v110, v111
 v_sub_f32 v100, v100, v41
 v_sub_f32 v101, v101, v41
 v_sub_f32 v102, v102, v41
 v_sub_f32 v103, v103, v41
 v_sub_f32 v108, v108, v41
 v_sub_f32 v109, v109, v41
 v_sub_f32 v110, v110, v41
 v_sub_f32 v111, v111, v41
 v_max3_f32 v39, v39, v116, v117
 v_max3_f32 v39, v39, v118, v119
 v_max3_f32 v39, v39, v124, v125
 v_max3_f32 v39, v39, v126, v127
 v_sub_f32 v116, v116, v42
 v_sub_f32 v117, v117, v42
 v_sub_f32 v118, v118, v42
 v_sub_f32 v119, v119, v42
 v_sub_f32 v124, v124, v42
 v_sub_f32 v125, v125, v42
 v_sub_f32 v126, v126, v42
 v_sub_f32 v127, v127, v42
 v_max3_f32 v40, v40, v132, v133
 v_max3_f32 v40, v40, v134, v135
 v_sub_f32 v132, v132, v43
 v_sub_f32 v133, v133, v43
 v_sub_f32 v134, v134, v43
 v_sub_f32 v135, v135, v43
 s_nop 1
 s_branch L_stub_4_B1_ret
L_stub_5_B1:
 s_nop 7
 v_max3_f32 v38, v38, v140, v141
 v_max3_f32 v38, v38, v142, v143
 v_max3_f32 v38, v38, v148, v149
 v_max3_f32 v38, v38, v150, v151
 v_sub_f32 v140, v140, v41
 v_sub_f32 v141, v141, v41
 v_sub_f32 v142, v142, v41
 v_sub_f32 v143, v143, v41
 v_sub_f32 v148, v148, v41
 v_sub_f32 v149, v149, v41
 v_sub_f32 v150, v150, v41
 v_sub_f32 v151, v151, v41
 v_max3_f32 v39, v39, v156, v157
 v_max3_f32 v39, v39, v158, v159
 v_max3_f32 v39, v39, v164, v165
 v_max3_f32 v39, v39, v166, v167
 v_sub_f32 v156, v156, v42
 v_sub_f32 v157, v157, v42
 v_sub_f32 v158, v158, v42
 v_sub_f32 v159, v159, v42
 v_sub_f32 v164, v164, v42
 v_sub_f32 v165, v165, v42
 v_sub_f32 v166, v166, v42
 v_sub_f32 v167, v167, v42
 v_max3_f32 v40, v40, v172, v173
 v_max3_f32 v40, v40, v174, v175
 v_sub_f32 v172, v172, v43
 v_sub_f32 v173, v173, v43
 v_sub_f32 v174, v174, v43
 v_sub_f32 v175, v175, v43
 s_nop 1
 s_branch L_stub_5_B1_ret
L_stub_6_B1:
 s_nop 7
 v_max3_f32 v38, v38, v56, v57
 v_max3_f32 v38, v38, v58, v59
 v_max3_f32 v38, v38, v60, v61
 v_max3_f32 v38, v38, v62, v63
 v_sub_f32 v56, v56, v41
 v_sub_f32 v57, v57, v41
 v_sub_f32 v58, v58, v41
 v_sub_f32 v59, v59, v41
 v_sub_f32 v60, v60, v41
 v_sub_f32 v61, v61, v41
 v_sub_f32 v62, v62, v41
 v_sub_f32 v63, v63, v41
 v_max3_f32 v39, v39, v64, v65
 v_max3_f32 v39, v39, v66, v67
 v_max3_f32 v39, v39, v68, v69
 v_max3_f32 v39, v39, v70, v71
 v_sub_f32 v64, v64, v42
 v_sub_f32 v65, v65, v42
 v_sub_f32 v66, v66, v42
 v_sub_f32 v67, v67, v42
 v_sub_f32 v68, v68, v42
 v_sub_f32 v69, v69, v42
 v_sub_f32 v70, v70, v42
 v_sub_f32 v71, v71, v42
 v_max3_f32 v40, v40, v72, v73
 v_max3_f32 v40, v40, v74, v75
 v_sub_f32 v72, v72, v43
 v_sub_f32 v73, v73, v43
 v_sub_f32 v74, v74, v43
 v_sub_f32 v75, v75, v43
 s_nop 1
 s_branch L_stub_6_B1_ret
L_stub_7_B1:
 s_nop 7
 v_max3_f32 v38, v38, v100, v101
 v_max3_f32 v38, v38, v102, v103
 v_max3_f32 v38, v38, v108, v109
 v_max3_f32 v38, v38, v110, v111
 v_sub_f32 v100, v100, v41
 v_sub_f32 v101, v101, v41
 v_sub_f32 v102, v102, v41
 v_sub_f32 v103, v103, v41
 v_sub_f32 v108, v108, v41
 v_sub_f32 v109, v109, v41
 v_sub_f32 v110, v110, v41
 v_sub_f32 v111, v111, v41
 v_max3_f32 v39, v39, v116, v117
 v_max3_f32 v39, v39, v118, v119
 v_max3_f32 v39, v39, v124, v125
 v_max3_f32 v39, v39, v126, v127
 v_sub_f32 v116, v116, v42
 v_sub_f32 v117, v117, v42
 v_sub_f32 v118, v118, v42
 v_sub_f32 v119, v119, v42
 v_sub_f32 v124, v124, v42
 v_sub_f32 v125, v125, v42
 v_sub_f32 v126, v126, v42
 v_sub_f32 v127, v127, v42
 v_max3_f32 v40, v40, v132, v133
 v_max3_f32 v40, v40, v134, v135
 v_sub_f32 v132, v132, v43
 v_sub_f32 v133, v133, v43
 v_sub_f32 v134, v134, v43
 v_sub_f32 v135, v135, v43
 s_nop 1
 s_branch L_stub_7_B1_ret
L_stub_8_B1:
 s_nop 7
 v_max3_f32 v38, v38, v140, v141
 v_max3_f32 v38, v38, v142, v143
 v_max3_f32 v38, v38, v148, v149
 v_max3_f32 v38, v38, v150, v151
 v_sub_f32 v140, v140, v41
 v_sub_f32 v141, v141, v41
 v_sub_f32 v142, v142, v41
 v_sub_f32 v143, v143, v41
 v_sub_f32 v148, v148, v41
 v_sub_f32 v149, v149, v41
 v_sub_f32 v150, v150, v41
 v_sub_f32 v151, v151, v41
 v_max3_f32 v39, v39, v156, v157
 v_max3_f32 v39, v39, v158, v159
 v_max3_f32 v39, v39, v164, v165
 v_max3_f32 v39, v39, v166, v167
 v_sub_f32 v156, v156, v42
 v_sub_f32 v157, v157, v42
 v_sub_f32 v158, v158, v42
 v_sub_f32 v159, v159, v42
 v_sub_f32 v164, v164, v42
 v_sub_f32 v165, v165, v42
 v_sub_f32 v166, v166, v42
 v_sub_f32 v167, v167, v42
 v_max3_f32 v40, v40, v172, v173
 v_max3_f32 v40, v40, v174, v175
 v_sub_f32 v172, v172, v43
 v_sub_f32 v173, v173, v43
 v_sub_f32 v174, v174, v43
 v_sub_f32 v175, v175, v43
 s_nop 1
 s_branch L_stub_8_B1_ret
L_stub_9_B1:
 s_nop 7
 v_max3_f32 v38, v38, v56, v57
 v_max3_f32 v38, v38, v58, v59
 v_max3_f32 v38, v38, v60, v61
 v_max3_f32 v38, v38, v62, v63
 v_sub_f32 v56, v56, v41
 v_sub_f32 v57, v57, v41
 v_sub_f32 v58, v58, v41
 v_sub_f32 v59, v59, v41
 v_sub_f32 v60, v60, v41
 v_sub_f32 v61, v61, v41
 v_sub_f32 v62, v62, v41
 v_sub_f32 v63, v63, v41
 v_max3_f32 v39, v39, v64, v65
 v_max3_f32 v39, v39, v66, v67
 v_max3_f32 v39, v39, v68, v69
 v_max3_f32 v39, v39, v70, v71
 v_sub_f32 v64, v64, v42
 v_sub_f32 v65, v65, v42
 v_sub_f32 v66, v66, v42
 v_sub_f32 v67, v67, v42
 v_sub_f32 v68, v68, v42
 v_sub_f32 v69, v69, v42
 v_sub_f32 v70, v70, v42
 v_sub_f32 v71, v71, v42
 v_max3_f32 v40, v40, v72, v73
 v_max3_f32 v40, v40, v74, v75
 v_sub_f32 v72, v72, v43
 v_sub_f32 v73, v73, v43
 v_sub_f32 v74, v74, v43
 v_sub_f32 v75, v75, v43
 s_nop 1
 s_branch L_stub_9_B1_ret
L_stub_10_B1:
 s_nop 7
 v_max3_f32 v38, v38, v100, v101
 v_max3_f32 v38, v38, v102, v103
 v_max3_f32 v38, v38, v108, v109
 v_max3_f32 v38, v38, v110, v111
 v_sub_f32 v100, v100, v41
 v_sub_f32 v101, v101, v41
 v_sub_f32 v102, v102, v41
 v_sub_f32 v103, v103, v41
 v_sub_f32 v108, v108, v41
 v_sub_f32 v109, v109, v41
 v_sub_f32 v110, v110, v41
 v_sub_f32 v111, v111, v41
 v_max3_f32 v39, v39, v116, v117
 v_max3_f32 v39, v39, v118, v119
 v_max3_f32 v39, v39, v124, v125
 v_max3_f32 v39, v39, v126, v127
 v_sub_f32 v116, v116, v42
 v_sub_f32 v117, v117, v42
 v_sub_f32 v118, v118, v42
 v_sub_f32 v119, v119, v42
 v_sub_f32 v124, v124, v42
 v_sub_f32 v125, v125, v42
 v_sub_f32 v126, v126, v42
 v_sub_f32 v127, v127, v42
 v_max3_f32 v40, v40, v132, v133
 v_max3_f32 v40, v40, v134, v135
 v_sub_f32 v132, v132, v43
 v_sub_f32 v133, v133, v43
 v_sub_f32 v134, v134, v43
 v_sub_f32 v135, v135, v43
 s_nop 1
 s_branch L_stub_10_B1_ret
L_stub_11_B1:
 s_nop 7
 v_max3_f32 v38, v38, v140, v141
 v_max3_f32 v38, v38, v142, v143
 v_max3_f32 v38, v38, v148, v149
 v_max3_f32 v38, v38, v150, v151
 v_sub_f32 v140, v140, v41
 v_sub_f32 v141, v141, v41
 v_sub_f32 v142, v142, v41
 v_sub_f32 v143, v143, v41
 v_sub_f32 v148, v148, v41
 v_sub_f32 v149, v149, v41
 v_sub_f32 v150, v150, v41
 v_sub_f32 v151, v151, v41
 v_max3_f32 v39, v39, v156, v157
 v_max3_f32 v39, v39, v158, v159
 v_max3_f32 v39, v39, v164, v165
 v_max3_f32 v39, v39, v166, v167
 v_sub_f32 v156, v156, v42
 v_sub_f32 v157, v157, v42
 v_sub_f32 v158, v158, v42
 v_sub_f32 v159, v159, v42
 v_sub_f32 v164, v164, v42
 v_sub_f32 v165, v165, v42
 v_sub_f32 v166, v166, v42
 v_sub_f32 v167, v167, v42
 v_max3_f32 v40, v40, v172, v173
 v_max3_f32 v40, v40, v174, v175
 v_sub_f32 v172, v172, v43
 v_sub_f32 v173, v173, v43
 v_sub_f32 v174, v174, v43
 v_sub_f32 v175, v175, v43
 s_nop 1
 s_branch L_stub_11_B1_ret
L_stub_12_B1:
 s_nop 7
 v_max3_f32 v38, v38, v56, v57
 v_max3_f32 v38, v38, v58, v59
 v_max3_f32 v38, v38, v60, v61
 v_max3_f32 v38, v38, v62, v63
 v_sub_f32 v56, v56, v41
 v_sub_f32 v57, v57, v41
 v_sub_f32 v58, v58, v41
 v_sub_f32 v59, v59, v41
 v_sub_f32 v60, v60, v41
 v_sub_f32 v61, v61, v41
 v_sub_f32 v62, v62, v41
 v_sub_f32 v63, v63, v41
 v_max3_f32 v39, v39, v64, v65
 v_max3_f32 v39, v39, v66, v67
 v_max3_f32 v39, v39, v68, v69
 v_max3_f32 v39, v39, v70, v71
 v_sub_f32 v64, v64, v42
 v_sub_f32 v65, v65, v42
 v_sub_f32 v66, v66, v42
 v_sub_f32 v67, v67, v42
 v_sub_f32 v68, v68, v42
 v_sub_f32 v69, v69, v42
 v_sub_f32 v70, v70, v42
 v_sub_f32 v71, v71, v42
 v_max3_f32 v40, v40, v72, v73
 v_max3_f32 v40, v40, v74, v75
 v_sub_f32 v72, v72, v43
 v_sub_f32 v73, v73, v43
 v_sub_f32 v74, v74, v43
 v_sub_f32 v75, v75, v43
 s_nop 1
 s_branch L_stub_12_B1_ret
L_stub_13_B1:
 s_nop 7
 v_max3_f32 v38, v38, v100, v101
 v_max3_f32 v38, v38, v102, v103
 v_max3_f32 v38, v38, v108, v109
 v_max3_f32 v38, v38, v110, v111
 v_sub_f32 v100, v100, v41
 v_sub_f32 v101, v101, v41
 v_sub_f32 v102, v102, v41
 v_sub_f32 v103, v103, v41
 v_sub_f32 v108, v108, v41
 v_sub_f32 v109, v109, v41
 v_sub_f32 v110, v110, v41
 v_sub_f32 v111, v111, v41
 v_max3_f32 v39, v39, v116, v117
 v_max3_f32 v39, v39, v118, v119
 v_max3_f32 v39, v39, v124, v125
 v_max3_f32 v39, v39, v126, v127
 v_sub_f32 v116, v116, v42
 v_sub_f32 v117, v117, v42
 v_sub_f32 v118, v118, v42
 v_sub_f32 v119, v119, v42
 v_sub_f32 v124, v124, v42
 v_sub_f32 v125, v125, v42
 v_sub_f32 v126, v126, v42
 v_sub_f32 v127, v127, v42
 v_max3_f32 v40, v40, v132, v133
 v_max3_f32 v40, v40, v134, v135
 v_sub_f32 v132, v132, v43
 v_sub_f32 v133, v133, v43
 v_sub_f32 v134, v134, v43
 v_sub_f32 v135, v135, v43
 s_nop 1
 s_branch L_stub_13_B1_ret
L_stub_14_B1:
 s_nop 7
 v_max3_f32 v38, v38, v140, v141
 v_max3_f32 v38, v38, v142, v143
 v_max3_f32 v38, v38, v148, v149
 v_max3_f32 v38, v38, v150, v151
 v_sub_f32 v140, v140, v41
 v_sub_f32 v141, v141, v41
 v_sub_f32 v142, v142, v41
 v_sub_f32 v143, v143, v41
 v_sub_f32 v148, v148, v41
 v_sub_f32 v149, v149, v41
 v_sub_f32 v150, v150, v41
 v_sub_f32 v151, v151, v41
 v_max3_f32 v39, v39, v156, v157
 v_max3_f32 v39, v39, v158, v159
 v_max3_f32 v39, v39, v164, v165
 v_max3_f32 v39, v39, v166, v167
 v_sub_f32 v156, v156, v42
 v_sub_f32 v157, v157, v42
 v_sub_f32 v158, v158, v42
 v_sub_f32 v159, v159, v42
 v_sub_f32 v164, v164, v42
 v_sub_f32 v165, v165, v42
 v_sub_f32 v166, v166, v42
 v_sub_f32 v167, v167, v42
 v_max3_f32 v40, v40, v172, v173
 v_max3_f32 v40, v40, v174, v175
 v_sub_f32 v172, v172, v43
 v_sub_f32 v173, v173, v43
 v_sub_f32 v174, v174, v43
 v_sub_f32 v175, v175, v43
 s_nop 1
 s_branch L_stub_14_B1_ret
L_stub_15_B1:
 s_nop 7
 v_max3_f32 v38, v38, v56, v57
 v_max3_f32 v38, v38, v58, v59
 v_max3_f32 v38, v38, v60, v61
 v_max3_f32 v38, v38, v62, v63
 v_sub_f32 v56, v56, v41
 v_sub_f32 v57, v57, v41
 v_sub_f32 v58, v58, v41
 v_sub_f32 v59, v59, v41
 v_sub_f32 v60, v60, v41
 v_sub_f32 v61, v61, v41
 v_sub_f32 v62, v62, v41
 v_sub_f32 v63, v63, v41
 v_max3_f32 v39, v39, v64, v65
 v_max3_f32 v39, v39, v66, v67
 v_max3_f32 v39, v39, v68, v69
 v_max3_f32 v39, v39, v70, v71
 v_sub_f32 v64, v64, v42
 v_sub_f32 v65, v65, v42
 v_sub_f32 v66, v66, v42
 v_sub_f32 v67, v67, v42
 v_sub_f32 v68, v68, v42
 v_sub_f32 v69, v69, v42
 v_sub_f32 v70, v70, v42
 v_sub_f32 v71, v71, v42
 v_max3_f32 v40, v40, v72, v73
 v_max3_f32 v40, v40, v74, v75
 v_sub_f32 v72, v72, v43
 v_sub_f32 v73, v73, v43
 v_sub_f32 v74, v74, v43
 v_sub_f32 v75, v75, v43
 s_nop 1
 s_branch L_stub_15_B1_ret
L_fail_B1:
 s_cmp_lg_u32 s4, 2
 s_cbranch_scc1 L_redo
 s_mov_b32 s4, 0
 s_mov_b64 vcc, 0
 s_branch L_fail_B1_ret
L_hop:
 s_waitcnt vmcnt(0) lgkmcnt(0)
 s_nop 15
 s_branch L_tailB
L_redo:
 s_waitcnt vmcnt(0) lgkmcnt(0)
 s_nop 15
 s_barrier
 s_mov_b64 vcc, -1
 s_add_u32 s4, s4, 1
 s_cmp_eq_u32 s4, 2
 s_cbranch_scc1 L_redo2
 v_mov_b32 v38, 0xff800000
 v_mov_b32 v41, 0
 v_mov_b32 v39, 0xff800000
 v_mov_b32 v42, 0
 v_mov_b32 v40, 0xff800000
 v_mov_b32 v43, 0
 s_branch L_restart
L_redo2:
 v_mov_b32 v76, v38
 s_nop 1
 v_permlane32_swap_b32 v76, v38
 v_max_f32 v38, v38, v76
 v_mov_b32 v76, v38
 s_nop 1
 v_permlane16_swap_b32 v76, v38
 v_max_f32 v38, v38, v76
 v_mov_b32 v76, v39
 s_nop 1
 v_permlane32_swap_b32 v76, v39
 v_max_f32 v39, v39, v76
 v_mov_b32 v76, v39
 s_nop 1
 v_permlane16_swap_b32 v76, v39
 v_max_f32 v39, v39, v76
 v_mov_b32 v76, v40
 s_nop 1
 v_permlane32_swap_b32 v76, v40
 v_max_f32 v40, v40, v76
 v_mov_b32 v76, v40
 s_nop 1
 v_permlane16_swap_b32 v76, v40
 v_max_f32 v40, v40, v76
 ds_write_b32 v23, v40 offset:0
 s_waitcnt lgkmcnt(0)
 s_barrier
 ds_read_b32 v76, v24 offset:0
 s_waitcnt lgkmcnt(0)
 v_max_f32 v43, v40, v76
 v_mov_b32 v41, v38
 v_mov_b32 v42, v39
 s_barrier
 s_branch L_restart
.section .rodata,"a"
.p2align 6
.amdhsa_kernel concat_heads__mha_block_cached__gqa_block_cached__near_ridge_kernel
  .amdhsa_next_free_vgpr 512
  .amdhsa_next_free_sgpr 102
  .amdhsa_accum_offset 256
  .amdhsa_group_segment_fixed_size 0
  .amdhsa_kernarg_size 104
  .amdhsa_user_sgpr_count 2
  .amdhsa_user_sgpr_kernarg_segment_ptr 1
  .amdhsa_system_sgpr_workgroup_id_x 1
  .amdhsa_float_denorm_mode_32 3
.end_amdhsa_kernel
```
